```python
import torch

def _softmax(x, axis=-1):
    return torch.softmax(x, dim=axis)
def _gelu(x):
    return torch.nn.functional.gelu(x, approximate="tanh")
def _silu(x):
    return torch.nn.functional.silu(x)
def _sigmoid(x):
    return torch.sigmoid(x)
def _layernorm(x, axis=-1, eps=1e-5):
    m = x.mean(dim=axis, keepdim=True)
    v = x.var(dim=axis, keepdim=True, unbiased=False)
    return (x - m) / torch.sqrt(v + eps)
def _scatter_add(tgt, idx, src, axis=0):
    return tgt.clone().index_add_(axis, idx, src)
def _segment_sum(src, seg, n):
    out = torch.zeros((n,) + src.shape[1:], dtype=src.dtype)
    return out.index_add_(0, seg, src)
def _pad(x, pw):
    flat = tuple(v for pair in reversed(pw) for v in pair)
    return torch.nn.functional.pad(x, flat)

kernel_name = 'standalone__self_sup_conv_stem_wavlm__speech'

def setup_inputs():

    _w = (lambda a: (lambda t: t.to(torch.bfloat16) if t.is_floating_point() else t)(torch.as_tensor(a)))
    B, T, D, K = 2, 16000, 512, 31
    scale = (K * D) ** -0.5
    return {
        "x": _w((lambda *s: torch.randn(*s, dtype=torch.bfloat16) * 0.05)(B, T, D)),
        "w": _w((lambda *s: torch.randn(*s, dtype=torch.bfloat16) * 0.05)(K, D, D) * scale),
        "gn_gamma": _w((lambda *s: torch.randn(*s, dtype=torch.bfloat16) * 0.05)(D) * 0.1 + 1.0),
        "gn_beta": _w((lambda *s: torch.randn(*s, dtype=torch.bfloat16) * 0.05)(D) * 0.1),
    }

def reference(x, w, gn_gamma, gn_beta):
    B, T, D = x.shape
    K = w.shape[0]
    s = 2
    L = (T - K) // s + 1
    h = torch.einsum('blc,cd->bld', x[:, 0:s * L:s, :], w[0])
    for i in range(1, K):
        h = h + torch.einsum('blc,cd->bld', x[:, i:i + s * L:s, :], w[i])
    mu = torch.einsum('bld->bd', h)[:, None, :] / L
    var = torch.einsum('bld->bd', (h - mu) ** 2)[:, None, :] / L
    h = (h - mu) / torch.sqrt(var + 1e-5)
    h = h * gn_gamma[None, None, :] + gn_beta[None, None, :]
    return _gelu(h)
```

```asm
; @launch kernel=k1_xform_kernel grid=(928,1,1) block=(256,1,1) lds=16384
; @launch kernel=k2_gemm_kernel grid=(256,1,1) block=(512,1,1) lds=151552
; @launch kernel=k3_stats_kernel grid=(256,1,1) block=(384,1,1) lds=36864
; @launch kernel=k4_out_kernel grid=(256,1,1) block=(384,1,1) lds=14336
.amdgcn_target "amdgcn-amd-amdhsa--gfx950"
.text
.globl k1_xform_kernel
.globl k2_gemm_kernel
.globl k3_stats_kernel
.globl k4_out_kernel
.p2align 8
.type k1_xform_kernel,@function
k1_xform_kernel:
    s_cmp_ge_u32 s2, 928
    s_cbranch_scc1 K1_END
    s_load_dwordx4 s[4:7], s[0:1], 0
    s_load_dwordx2 s[8:9], s[0:1], 48
    v_lshrrev_b32 v120, 6, v0
    v_and_b32 v121, 63, v0
    v_readfirstlane_b32 s3, v120
    v_and_b32 v122, 15, v121
    v_lshrrev_b32 v123, 4, v121
    s_mov_b32 s28, 0x05040100
    s_mov_b32 s29, 0x07060302
    v_and_b32 v124, 3, v122
    v_lshlrev_b32 v124, 2, v124
    v_lshrrev_b32 v125, 3, v122
    v_lshl_add_u32 v124, v125, 1, v124
    s_lshl_b32 s10, s3, 4
    s_add_u32 s10, s10, 1
    v_add_u32 v124, s10, v124
    v_bfe_u32 v125, v122, 2, 1
    v_lshlrev_b32 v121, 4, v121
    s_waitcnt lgkmcnt(0)
    s_cmp_lt_u32 s2, 256
    s_cbranch_scc1 K1_W
    s_sub_u32 s11, s2, 256
    s_and_b32 s12, s11, 7
    s_lshr_b32 s11, s11, 3
    s_cmp_ge_u32 s11, 42
    s_cselect_b32 s13, 1, 0
    s_mul_i32 s14, s13, 42
    s_sub_u32 s11, s11, s14
    s_lshl_b32 s11, s11, 2
    s_add_u32 s11, s11, s3
    s_mul_i32 s14, s13, 16384000
    s_add_u32 s16, s4, s14
    s_addc_u32 s17, s5, 0
    s_and_b32 s17, s17, 0xffff
    s_mov_b32 s18, 16384000
    s_mov_b32 s19, 0x00020000
    s_mov_b32 s20, s8
    s_mov_b32 s21, s9
    s_and_b32 s21, s21, 0xffff
    s_mov_b32 s22, 43778048
    s_mov_b32 s23, 0x00020000
    v_lshlrev_b32 v126, 14, v123
    v_lshl_add_u32 v126, v122, 4, v126
    s_mul_i32 s15, s11, 98304
    s_lshl_b32 s24, s12, 8
    s_add_u32 s15, s15, s24
    buffer_load_dwordx4 v[0:3], v126, s[16:19], s15 offen
    buffer_load_dwordx4 v[4:7], v126, s[16:19], s15 offen offset:2048
    s_add_u32 s15, s15, 4096
    buffer_load_dwordx4 v[8:11], v126, s[16:19], s15 offen
    buffer_load_dwordx4 v[12:15], v126, s[16:19], s15 offen offset:2048
    s_add_u32 s15, s15, 4096
    buffer_load_dwordx4 v[16:19], v126, s[16:19], s15 offen
    buffer_load_dwordx4 v[20:23], v126, s[16:19], s15 offen offset:2048
    s_add_u32 s15, s15, 4096
    buffer_load_dwordx4 v[24:27], v126, s[16:19], s15 offen
    buffer_load_dwordx4 v[28:31], v126, s[16:19], s15 offen offset:2048
    s_add_u32 s15, s15, 53248
    buffer_load_dwordx4 v[32:35], v126, s[16:19], s15 offen
    buffer_load_dwordx4 v[36:39], v126, s[16:19], s15 offen offset:2048
    s_add_u32 s15, s15, 4096
    buffer_load_dwordx4 v[40:43], v126, s[16:19], s15 offen
    buffer_load_dwordx4 v[44:47], v126, s[16:19], s15 offen offset:2048
    s_add_u32 s15, s15, 4096
    buffer_load_dwordx4 v[48:51], v126, s[16:19], s15 offen
    buffer_load_dwordx4 v[52:55], v126, s[16:19], s15 offen offset:2048
    s_add_u32 s15, s15, 4096
    buffer_load_dwordx4 v[56:59], v126, s[16:19], s15 offen
    buffer_load_dwordx4 v[60:63], v126, s[16:19], s15 offen offset:2048
    v_lshlrev_b32 v127, 3, v123
    v_lshlrev_b32 v112, 5, v125
    v_mad_u32_u24 v113, v124, v127, v112
    v_mad_u32_u24 v64, v124, 0, v113
    v_mad_u32_u24 v65, v124, 1, v113
    v_mad_u32_u24 v66, v124, 2, v113
    v_mad_u32_u24 v67, v124, 3, v113
    v_mad_u32_u24 v68, v124, 4, v113
    v_mad_u32_u24 v69, v124, 5, v113
    v_mad_u32_u24 v70, v124, 6, v113
    v_mad_u32_u24 v71, v124, 7, v113
    v_and_b32 v64, 127, v64
    v_and_b32 v65, 127, v65
    v_and_b32 v66, 127, v66
    v_and_b32 v67, 127, v67
    v_and_b32 v68, 127, v68
    v_and_b32 v69, 127, v69
    v_and_b32 v70, 127, v70
    v_and_b32 v71, 127, v71
    v_cvt_f32_u32 v64, v64
    v_cvt_f32_u32 v65, v65
    v_cvt_f32_u32 v66, v66
    v_cvt_f32_u32 v67, v67
    v_cvt_f32_u32 v68, v68
    v_cvt_f32_u32 v69, v69
    v_cvt_f32_u32 v70, v70
    v_cvt_f32_u32 v71, v71
    v_mul_f32 v64, 0x3c000000, v64
    v_mul_f32 v65, 0x3c000000, v65
    v_mul_f32 v66, 0x3c000000, v66
    v_mul_f32 v67, 0x3c000000, v67
    v_mul_f32 v68, 0x3c000000, v68
    v_mul_f32 v69, 0x3c000000, v69
    v_mul_f32 v70, 0x3c000000, v70
    v_mul_f32 v71, 0x3c000000, v71
    v_cos_f32 v64, v64
    v_cos_f32 v65, v65
    v_cos_f32 v66, v66
    v_cos_f32 v67, v67
    v_cos_f32 v68, v68
    v_cos_f32 v69, v69
    v_cos_f32 v70, v70
    v_cos_f32 v71, v71
    s_nop 0
    v_cvt_pk_bf16_f32 v72, v64, v65
    v_cvt_pk_bf16_f32 v73, v66, v67
    v_cvt_pk_bf16_f32 v74, v68, v69
    v_cvt_pk_bf16_f32 v75, v70, v71
    v_lshlrev_b32 v80, 16, v72
    v_and_b32 v81, 0xffff0000, v72
    v_sub_f32 v64, v64, v80
    v_sub_f32 v65, v65, v81
    v_lshlrev_b32 v80, 16, v73
    v_and_b32 v81, 0xffff0000, v73
    v_sub_f32 v66, v66, v80
    v_sub_f32 v67, v67, v81
    v_lshlrev_b32 v80, 16, v74
    v_and_b32 v81, 0xffff0000, v74
    v_sub_f32 v68, v68, v80
    v_sub_f32 v69, v69, v81
    v_lshlrev_b32 v80, 16, v75
    v_and_b32 v81, 0xffff0000, v75
    v_sub_f32 v70, v70, v80
    v_sub_f32 v71, v71, v81
    v_cvt_pk_bf16_f32 v76, v64, v65
    v_cvt_pk_bf16_f32 v77, v66, v67
    v_cvt_pk_bf16_f32 v78, v68, v69
    v_cvt_pk_bf16_f32 v79, v70, v71
    s_lshl_b32 s24, s3, 12
    v_add_u32 v114, s24, v121
    ds_write_b128 v114, v[72:75] offset:0
    ds_write_b128 v114, v[76:79] offset:1024
    v_add_u32 v127, 32, v127
    v_lshlrev_b32 v112, 5, v125
    v_mad_u32_u24 v113, v124, v127, v112
    v_mad_u32_u24 v64, v124, 0, v113
    v_mad_u32_u24 v65, v124, 1, v113
    v_mad_u32_u24 v66, v124, 2, v113
    v_mad_u32_u24 v67, v124, 3, v113
    v_mad_u32_u24 v68, v124, 4, v113
    v_mad_u32_u24 v69, v124, 5, v113
    v_mad_u32_u24 v70, v124, 6, v113
    v_mad_u32_u24 v71, v124, 7, v113
    v_and_b32 v64, 127, v64
    v_and_b32 v65, 127, v65
    v_and_b32 v66, 127, v66
    v_and_b32 v67, 127, v67
    v_and_b32 v68, 127, v68
    v_and_b32 v69, 127, v69
    v_and_b32 v70, 127, v70
    v_and_b32 v71, 127, v71
    v_cvt_f32_u32 v64, v64
    v_cvt_f32_u32 v65, v65
    v_cvt_f32_u32 v66, v66
    v_cvt_f32_u32 v67, v67
    v_cvt_f32_u32 v68, v68
    v_cvt_f32_u32 v69, v69
    v_cvt_f32_u32 v70, v70
    v_cvt_f32_u32 v71, v71
    v_mul_f32 v64, 0x3c000000, v64
    v_mul_f32 v65, 0x3c000000, v65
    v_mul_f32 v66, 0x3c000000, v66
    v_mul_f32 v67, 0x3c000000, v67
    v_mul_f32 v68, 0x3c000000, v68
    v_mul_f32 v69, 0x3c000000, v69
    v_mul_f32 v70, 0x3c000000, v70
    v_mul_f32 v71, 0x3c000000, v71
    v_cos_f32 v64, v64
    v_cos_f32 v65, v65
    v_cos_f32 v66, v66
    v_cos_f32 v67, v67
    v_cos_f32 v68, v68
    v_cos_f32 v69, v69
    v_cos_f32 v70, v70
    v_cos_f32 v71, v71
    s_nop 0
    v_cvt_pk_bf16_f32 v72, v64, v65
    v_cvt_pk_bf16_f32 v73, v66, v67
    v_cvt_pk_bf16_f32 v74, v68, v69
    v_cvt_pk_bf16_f32 v75, v70, v71
    v_lshlrev_b32 v80, 16, v72
    v_and_b32 v81, 0xffff0000, v72
    v_sub_f32 v64, v64, v80
    v_sub_f32 v65, v65, v81
    v_lshlrev_b32 v80, 16, v73
    v_and_b32 v81, 0xffff0000, v73
    v_sub_f32 v66, v66, v80
    v_sub_f32 v67, v67, v81
    v_lshlrev_b32 v80, 16, v74
    v_and_b32 v81, 0xffff0000, v74
    v_sub_f32 v68, v68, v80
    v_sub_f32 v69, v69, v81
    v_lshlrev_b32 v80, 16, v75
    v_and_b32 v81, 0xffff0000, v75
    v_sub_f32 v70, v70, v80
    v_sub_f32 v71, v71, v81
    v_cvt_pk_bf16_f32 v76, v64, v65
    v_cvt_pk_bf16_f32 v77, v66, v67
    v_cvt_pk_bf16_f32 v78, v68, v69
    v_cvt_pk_bf16_f32 v79, v70, v71
    s_lshl_b32 s24, s3, 12
    v_add_u32 v114, s24, v121
    ds_write_b128 v114, v[72:75] offset:2048
    ds_write_b128 v114, v[76:79] offset:3072
    v_lshrrev_b32 v112, 1, v123
    s_mov_b32 s24, 1368064
    v_mul_lo_u32 v112, v112, s24
    v_lshrrev_b32 v113, 2, v122
    s_mov_b32 s24, 21376
    v_mul_lo_u32 v113, v113, s24
    v_add_u32 v112, v112, v113
    v_and_b32 v113, 3, v122
    v_and_b32 v114, 1, v123
    v_lshl_add_u32 v113, v114, 2, v113
    s_lshr_b32 s24, s11, 1
    s_and_b32 s24, s24, 7
    v_xor_b32 v113, s24, v113
    v_lshl_add_u32 v120, v113, 4, v112
    s_mul_i32 s25, s13, 684032
    s_mul_i32 s24, s12, 85504
    s_add_u32 s25, s25, s24
    s_lshl_b32 s24, s11, 7
    s_add_u32 s25, s25, s24
    s_waitcnt lgkmcnt(0)
    s_barrier
    s_cmp_ge_u32 s11, 167
    s_cbranch_scc1 K1_END
    s_waitcnt vmcnt(8)
    v_perm_b32 v64, v4, v0, s28
    v_perm_b32 v68, v4, v0, s29
    v_perm_b32 v65, v12, v8, s28
    v_perm_b32 v69, v12, v8, s29
    v_perm_b32 v66, v20, v16, s28
    v_perm_b32 v70, v20, v16, s29
    v_perm_b32 v67, v28, v24, s28
    v_perm_b32 v71, v28, v24, s29
    v_perm_b32 v72, v5, v1, s28
    v_perm_b32 v76, v5, v1, s29
    v_perm_b32 v73, v13, v9, s28
    v_perm_b32 v77, v13, v9, s29
    v_perm_b32 v74, v21, v17, s28
    v_perm_b32 v78, v21, v17, s29
    v_perm_b32 v75, v29, v25, s28
    v_perm_b32 v79, v29, v25, s29
    v_perm_b32 v80, v6, v2, s28
    v_perm_b32 v84, v6, v2, s29
    v_perm_b32 v81, v14, v10, s28
    v_perm_b32 v85, v14, v10, s29
    v_perm_b32 v82, v22, v18, s28
    v_perm_b32 v86, v22, v18, s29
    v_perm_b32 v83, v30, v26, s28
    v_perm_b32 v87, v30, v26, s29
    v_perm_b32 v88, v7, v3, s28
    v_perm_b32 v92, v7, v3, s29
    v_perm_b32 v89, v15, v11, s28
    v_perm_b32 v93, v15, v11, s29
    v_perm_b32 v90, v23, v19, s28
    v_perm_b32 v94, v23, v19, s29
    v_perm_b32 v91, v31, v27, s28
    v_perm_b32 v95, v31, v27, s29
    s_waitcnt vmcnt(0)
    v_perm_b32 v0, v36, v32, s28
    v_perm_b32 v4, v36, v32, s29
    v_perm_b32 v1, v44, v40, s28
    v_perm_b32 v5, v44, v40, s29
    v_perm_b32 v2, v52, v48, s28
    v_perm_b32 v6, v52, v48, s29
    v_perm_b32 v3, v60, v56, s28
    v_perm_b32 v7, v60, v56, s29
    v_perm_b32 v8, v37, v33, s28
    v_perm_b32 v12, v37, v33, s29
    v_perm_b32 v9, v45, v41, s28
    v_perm_b32 v13, v45, v41, s29
    v_perm_b32 v10, v53, v49, s28
    v_perm_b32 v14, v53, v49, s29
    v_perm_b32 v11, v61, v57, s28
    v_perm_b32 v15, v61, v57, s29
    v_perm_b32 v16, v38, v34, s28
    v_perm_b32 v20, v38, v34, s29
    v_perm_b32 v17, v46, v42, s28
    v_perm_b32 v21, v46, v42, s29
    v_perm_b32 v18, v54, v50, s28
    v_perm_b32 v22, v54, v50, s29
    v_perm_b32 v19, v62, v58, s28
    v_perm_b32 v23, v62, v58, s29
    v_perm_b32 v24, v39, v35, s28
    v_perm_b32 v28, v39, v35, s29
    v_perm_b32 v25, v47, v43, s28
    v_perm_b32 v29, v47, v43, s29
    v_perm_b32 v26, v55, v51, s28
    v_perm_b32 v30, v55, v51, s29
    v_perm_b32 v27, v63, v59, s28
    v_perm_b32 v31, v63, v59, s29
    ds_read_b128 v[96:99], v121 offset:0
    ds_read_b128 v[100:103], v121 offset:1024
    ds_read_b128 v[104:107], v121 offset:2048
    ds_read_b128 v[108:111], v121 offset:3072
    s_waitcnt lgkmcnt(3)
    v_mfma_f32_16x16x32_bf16 v[32:35], v[96:99], v[64:67], 0
    v_mfma_f32_16x16x32_bf16 v[36:39], v[96:99], v[68:71], 0
    v_mfma_f32_16x16x32_bf16 v[40:43], v[96:99], v[72:75], 0
    v_mfma_f32_16x16x32_bf16 v[44:47], v[96:99], v[76:79], 0
    v_mfma_f32_16x16x32_bf16 v[48:51], v[96:99], v[80:83], 0
    v_mfma_f32_16x16x32_bf16 v[52:55], v[96:99], v[84:87], 0
    v_mfma_f32_16x16x32_bf16 v[56:59], v[96:99], v[88:91], 0
    v_mfma_f32_16x16x32_bf16 v[60:63], v[96:99], v[92:95], 0
    s_waitcnt lgkmcnt(2)
    v_mfma_f32_16x16x32_bf16 v[32:35], v[100:103], v[64:67], v[32:35]
    v_mfma_f32_16x16x32_bf16 v[36:39], v[100:103], v[68:71], v[36:39]
    v_mfma_f32_16x16x32_bf16 v[40:43], v[100:103], v[72:75], v[40:43]
    v_mfma_f32_16x16x32_bf16 v[44:47], v[100:103], v[76:79], v[44:47]
    v_mfma_f32_16x16x32_bf16 v[48:51], v[100:103], v[80:83], v[48:51]
    v_mfma_f32_16x16x32_bf16 v[52:55], v[100:103], v[84:87], v[52:55]
    v_mfma_f32_16x16x32_bf16 v[56:59], v[100:103], v[88:91], v[56:59]
    v_mfma_f32_16x16x32_bf16 v[60:63], v[100:103], v[92:95], v[60:63]
    s_waitcnt lgkmcnt(1)
    v_mfma_f32_16x16x32_bf16 v[32:35], v[104:107], v[0:3], v[32:35]
    v_mfma_f32_16x16x32_bf16 v[36:39], v[104:107], v[4:7], v[36:39]
    v_mfma_f32_16x16x32_bf16 v[40:43], v[104:107], v[8:11], v[40:43]
    v_mfma_f32_16x16x32_bf16 v[44:47], v[104:107], v[12:15], v[44:47]
    v_mfma_f32_16x16x32_bf16 v[48:51], v[104:107], v[16:19], v[48:51]
    v_mfma_f32_16x16x32_bf16 v[52:55], v[104:107], v[20:23], v[52:55]
    v_mfma_f32_16x16x32_bf16 v[56:59], v[104:107], v[24:27], v[56:59]
    v_mfma_f32_16x16x32_bf16 v[60:63], v[104:107], v[28:31], v[60:63]
    s_waitcnt lgkmcnt(0)
    v_mfma_f32_16x16x32_bf16 v[32:35], v[108:111], v[0:3], v[32:35]
    v_mfma_f32_16x16x32_bf16 v[36:39], v[108:111], v[4:7], v[36:39]
    v_mfma_f32_16x16x32_bf16 v[40:43], v[108:111], v[8:11], v[40:43]
    v_mfma_f32_16x16x32_bf16 v[44:47], v[108:111], v[12:15], v[44:47]
    v_mfma_f32_16x16x32_bf16 v[48:51], v[108:111], v[16:19], v[48:51]
    v_mfma_f32_16x16x32_bf16 v[52:55], v[108:111], v[20:23], v[52:55]
    v_mfma_f32_16x16x32_bf16 v[56:59], v[108:111], v[24:27], v[56:59]
    v_mfma_f32_16x16x32_bf16 v[60:63], v[108:111], v[28:31], v[60:63]
    s_nop 7
    v_cvt_pk_bf16_f32 v112, v32, v36
    v_cvt_pk_bf16_f32 v113, v40, v44
    v_cvt_pk_bf16_f32 v114, v48, v52
    v_cvt_pk_bf16_f32 v115, v56, v60
    buffer_store_dwordx4 v[112:115], v120, s[20:23], s25 offen
    s_add_u32 s25, s25, 2736128
    v_cvt_pk_bf16_f32 v116, v33, v37
    v_cvt_pk_bf16_f32 v117, v41, v45
    v_cvt_pk_bf16_f32 v118, v49, v53
    v_cvt_pk_bf16_f32 v119, v57, v61
    buffer_store_dwordx4 v[116:119], v120, s[20:23], s25 offen
    s_add_u32 s25, s25, 2736128
    v_cvt_pk_bf16_f32 v112, v34, v38
    v_cvt_pk_bf16_f32 v113, v42, v46
    v_cvt_pk_bf16_f32 v114, v50, v54
    v_cvt_pk_bf16_f32 v115, v58, v62
    buffer_store_dwordx4 v[112:115], v120, s[20:23], s25 offen
    s_add_u32 s25, s25, 2736128
    v_cvt_pk_bf16_f32 v116, v35, v39
    v_cvt_pk_bf16_f32 v117, v43, v47
    v_cvt_pk_bf16_f32 v118, v51, v55
    v_cvt_pk_bf16_f32 v119, v59, v63
    buffer_store_dwordx4 v[116:119], v120, s[20:23], s25 offen
    s_add_u32 s25, s25, 2736128
    ds_read_b128 v[96:99], v121 offset:4096
    ds_read_b128 v[100:103], v121 offset:5120
    ds_read_b128 v[104:107], v121 offset:6144
    ds_read_b128 v[108:111], v121 offset:7168
    s_waitcnt lgkmcnt(3)
    v_mfma_f32_16x16x32_bf16 v[32:35], v[96:99], v[64:67], 0
    v_mfma_f32_16x16x32_bf16 v[36:39], v[96:99], v[68:71], 0
    v_mfma_f32_16x16x32_bf16 v[40:43], v[96:99], v[72:75], 0
    v_mfma_f32_16x16x32_bf16 v[44:47], v[96:99], v[76:79], 0
    v_mfma_f32_16x16x32_bf16 v[48:51], v[96:99], v[80:83], 0
    v_mfma_f32_16x16x32_bf16 v[52:55], v[96:99], v[84:87], 0
    v_mfma_f32_16x16x32_bf16 v[56:59], v[96:99], v[88:91], 0
    v_mfma_f32_16x16x32_bf16 v[60:63], v[96:99], v[92:95], 0
    s_waitcnt lgkmcnt(2)
    v_mfma_f32_16x16x32_bf16 v[32:35], v[100:103], v[64:67], v[32:35]
    v_mfma_f32_16x16x32_bf16 v[36:39], v[100:103], v[68:71], v[36:39]
    v_mfma_f32_16x16x32_bf16 v[40:43], v[100:103], v[72:75], v[40:43]
    v_mfma_f32_16x16x32_bf16 v[44:47], v[100:103], v[76:79], v[44:47]
    v_mfma_f32_16x16x32_bf16 v[48:51], v[100:103], v[80:83], v[48:51]
    v_mfma_f32_16x16x32_bf16 v[52:55], v[100:103], v[84:87], v[52:55]
    v_mfma_f32_16x16x32_bf16 v[56:59], v[100:103], v[88:91], v[56:59]
    v_mfma_f32_16x16x32_bf16 v[60:63], v[100:103], v[92:95], v[60:63]
    s_waitcnt lgkmcnt(1)
    v_mfma_f32_16x16x32_bf16 v[32:35], v[104:107], v[0:3], v[32:35]
    v_mfma_f32_16x16x32_bf16 v[36:39], v[104:107], v[4:7], v[36:39]
    v_mfma_f32_16x16x32_bf16 v[40:43], v[104:107], v[8:11], v[40:43]
    v_mfma_f32_16x16x32_bf16 v[44:47], v[104:107], v[12:15], v[44:47]
    v_mfma_f32_16x16x32_bf16 v[48:51], v[104:107], v[16:19], v[48:51]
    v_mfma_f32_16x16x32_bf16 v[52:55], v[104:107], v[20:23], v[52:55]
    v_mfma_f32_16x16x32_bf16 v[56:59], v[104:107], v[24:27], v[56:59]
    v_mfma_f32_16x16x32_bf16 v[60:63], v[104:107], v[28:31], v[60:63]
    s_waitcnt lgkmcnt(0)
    v_mfma_f32_16x16x32_bf16 v[32:35], v[108:111], v[0:3], v[32:35]
    v_mfma_f32_16x16x32_bf16 v[36:39], v[108:111], v[4:7], v[36:39]
    v_mfma_f32_16x16x32_bf16 v[40:43], v[108:111], v[8:11], v[40:43]
    v_mfma_f32_16x16x32_bf16 v[44:47], v[108:111], v[12:15], v[44:47]
    v_mfma_f32_16x16x32_bf16 v[48:51], v[108:111], v[16:19], v[48:51]
    v_mfma_f32_16x16x32_bf16 v[52:55], v[108:111], v[20:23], v[52:55]
    v_mfma_f32_16x16x32_bf16 v[56:59], v[108:111], v[24:27], v[56:59]
    v_mfma_f32_16x16x32_bf16 v[60:63], v[108:111], v[28:31], v[60:63]
    s_nop 7
    v_cvt_pk_bf16_f32 v112, v32, v36
    v_cvt_pk_bf16_f32 v113, v40, v44
    v_cvt_pk_bf16_f32 v114, v48, v52
    v_cvt_pk_bf16_f32 v115, v56, v60
    buffer_store_dwordx4 v[112:115], v120, s[20:23], s25 offen
    s_add_u32 s25, s25, 2736128
    v_cvt_pk_bf16_f32 v116, v33, v37
    v_cvt_pk_bf16_f32 v117, v41, v45
    v_cvt_pk_bf16_f32 v118, v49, v53
    v_cvt_pk_bf16_f32 v119, v57, v61
    buffer_store_dwordx4 v[116:119], v120, s[20:23], s25 offen
    s_add_u32 s25, s25, 2736128
    v_cvt_pk_bf16_f32 v112, v34, v38
    v_cvt_pk_bf16_f32 v113, v42, v46
    v_cvt_pk_bf16_f32 v114, v50, v54
    v_cvt_pk_bf16_f32 v115, v58, v62
    buffer_store_dwordx4 v[112:115], v120, s[20:23], s25 offen
    s_add_u32 s25, s25, 2736128
    v_cvt_pk_bf16_f32 v116, v35, v39
    v_cvt_pk_bf16_f32 v117, v43, v47
    v_cvt_pk_bf16_f32 v118, v51, v55
    v_cvt_pk_bf16_f32 v119, v59, v63
    buffer_store_dwordx4 v[116:119], v120, s[20:23], s25 offen
    s_add_u32 s25, s25, 2736128
    ds_read_b128 v[96:99], v121 offset:8192
    ds_read_b128 v[100:103], v121 offset:9216
    ds_read_b128 v[104:107], v121 offset:10240
    ds_read_b128 v[108:111], v121 offset:11264
    s_waitcnt lgkmcnt(3)
    v_mfma_f32_16x16x32_bf16 v[32:35], v[96:99], v[64:67], 0
    v_mfma_f32_16x16x32_bf16 v[36:39], v[96:99], v[68:71], 0
    v_mfma_f32_16x16x32_bf16 v[40:43], v[96:99], v[72:75], 0
    v_mfma_f32_16x16x32_bf16 v[44:47], v[96:99], v[76:79], 0
    v_mfma_f32_16x16x32_bf16 v[48:51], v[96:99], v[80:83], 0
    v_mfma_f32_16x16x32_bf16 v[52:55], v[96:99], v[84:87], 0
    v_mfma_f32_16x16x32_bf16 v[56:59], v[96:99], v[88:91], 0
    v_mfma_f32_16x16x32_bf16 v[60:63], v[96:99], v[92:95], 0
    s_waitcnt lgkmcnt(2)
    v_mfma_f32_16x16x32_bf16 v[32:35], v[100:103], v[64:67], v[32:35]
    v_mfma_f32_16x16x32_bf16 v[36:39], v[100:103], v[68:71], v[36:39]
    v_mfma_f32_16x16x32_bf16 v[40:43], v[100:103], v[72:75], v[40:43]
    v_mfma_f32_16x16x32_bf16 v[44:47], v[100:103], v[76:79], v[44:47]
    v_mfma_f32_16x16x32_bf16 v[48:51], v[100:103], v[80:83], v[48:51]
    v_mfma_f32_16x16x32_bf16 v[52:55], v[100:103], v[84:87], v[52:55]
    v_mfma_f32_16x16x32_bf16 v[56:59], v[100:103], v[88:91], v[56:59]
    v_mfma_f32_16x16x32_bf16 v[60:63], v[100:103], v[92:95], v[60:63]
    s_waitcnt lgkmcnt(1)
    v_mfma_f32_16x16x32_bf16 v[32:35], v[104:107], v[0:3], v[32:35]
    v_mfma_f32_16x16x32_bf16 v[36:39], v[104:107], v[4:7], v[36:39]
    v_mfma_f32_16x16x32_bf16 v[40:43], v[104:107], v[8:11], v[40:43]
    v_mfma_f32_16x16x32_bf16 v[44:47], v[104:107], v[12:15], v[44:47]
    v_mfma_f32_16x16x32_bf16 v[48:51], v[104:107], v[16:19], v[48:51]
    v_mfma_f32_16x16x32_bf16 v[52:55], v[104:107], v[20:23], v[52:55]
    v_mfma_f32_16x16x32_bf16 v[56:59], v[104:107], v[24:27], v[56:59]
    v_mfma_f32_16x16x32_bf16 v[60:63], v[104:107], v[28:31], v[60:63]
    s_waitcnt lgkmcnt(0)
    v_mfma_f32_16x16x32_bf16 v[32:35], v[108:111], v[0:3], v[32:35]
    v_mfma_f32_16x16x32_bf16 v[36:39], v[108:111], v[4:7], v[36:39]
    v_mfma_f32_16x16x32_bf16 v[40:43], v[108:111], v[8:11], v[40:43]
    v_mfma_f32_16x16x32_bf16 v[44:47], v[108:111], v[12:15], v[44:47]
    v_mfma_f32_16x16x32_bf16 v[48:51], v[108:111], v[16:19], v[48:51]
    v_mfma_f32_16x16x32_bf16 v[52:55], v[108:111], v[20:23], v[52:55]
    v_mfma_f32_16x16x32_bf16 v[56:59], v[108:111], v[24:27], v[56:59]
    v_mfma_f32_16x16x32_bf16 v[60:63], v[108:111], v[28:31], v[60:63]
    s_nop 7
    v_cvt_pk_bf16_f32 v112, v32, v36
    v_cvt_pk_bf16_f32 v113, v40, v44
    v_cvt_pk_bf16_f32 v114, v48, v52
    v_cvt_pk_bf16_f32 v115, v56, v60
    buffer_store_dwordx4 v[112:115], v120, s[20:23], s25 offen
    s_add_u32 s25, s25, 2736128
    v_cvt_pk_bf16_f32 v116, v33, v37
    v_cvt_pk_bf16_f32 v117, v41, v45
    v_cvt_pk_bf16_f32 v118, v49, v53
    v_cvt_pk_bf16_f32 v119, v57, v61
    buffer_store_dwordx4 v[116:119], v120, s[20:23], s25 offen
    s_add_u32 s25, s25, 2736128
    v_cvt_pk_bf16_f32 v112, v34, v38
    v_cvt_pk_bf16_f32 v113, v42, v46
    v_cvt_pk_bf16_f32 v114, v50, v54
    v_cvt_pk_bf16_f32 v115, v58, v62
    buffer_store_dwordx4 v[112:115], v120, s[20:23], s25 offen
    s_add_u32 s25, s25, 2736128
    v_cvt_pk_bf16_f32 v116, v35, v39
    v_cvt_pk_bf16_f32 v117, v43, v47
    v_cvt_pk_bf16_f32 v118, v51, v55
    v_cvt_pk_bf16_f32 v119, v59, v63
    buffer_store_dwordx4 v[116:119], v120, s[20:23], s25 offen
    s_add_u32 s25, s25, 2736128
    ds_read_b128 v[96:99], v121 offset:12288
    ds_read_b128 v[100:103], v121 offset:13312
    ds_read_b128 v[104:107], v121 offset:14336
    ds_read_b128 v[108:111], v121 offset:15360
    s_waitcnt lgkmcnt(3)
    v_mfma_f32_16x16x32_bf16 v[32:35], v[96:99], v[64:67], 0
    v_mfma_f32_16x16x32_bf16 v[36:39], v[96:99], v[68:71], 0
    v_mfma_f32_16x16x32_bf16 v[40:43], v[96:99], v[72:75], 0
    v_mfma_f32_16x16x32_bf16 v[44:47], v[96:99], v[76:79], 0
    v_mfma_f32_16x16x32_bf16 v[48:51], v[96:99], v[80:83], 0
    v_mfma_f32_16x16x32_bf16 v[52:55], v[96:99], v[84:87], 0
    v_mfma_f32_16x16x32_bf16 v[56:59], v[96:99], v[88:91], 0
    v_mfma_f32_16x16x32_bf16 v[60:63], v[96:99], v[92:95], 0
    s_waitcnt lgkmcnt(2)
    v_mfma_f32_16x16x32_bf16 v[32:35], v[100:103], v[64:67], v[32:35]
    v_mfma_f32_16x16x32_bf16 v[36:39], v[100:103], v[68:71], v[36:39]
    v_mfma_f32_16x16x32_bf16 v[40:43], v[100:103], v[72:75], v[40:43]
    v_mfma_f32_16x16x32_bf16 v[44:47], v[100:103], v[76:79], v[44:47]
    v_mfma_f32_16x16x32_bf16 v[48:51], v[100:103], v[80:83], v[48:51]
    v_mfma_f32_16x16x32_bf16 v[52:55], v[100:103], v[84:87], v[52:55]
    v_mfma_f32_16x16x32_bf16 v[56:59], v[100:103], v[88:91], v[56:59]
    v_mfma_f32_16x16x32_bf16 v[60:63], v[100:103], v[92:95], v[60:63]
    s_waitcnt lgkmcnt(1)
    v_mfma_f32_16x16x32_bf16 v[32:35], v[104:107], v[0:3], v[32:35]
    v_mfma_f32_16x16x32_bf16 v[36:39], v[104:107], v[4:7], v[36:39]
    v_mfma_f32_16x16x32_bf16 v[40:43], v[104:107], v[8:11], v[40:43]
    v_mfma_f32_16x16x32_bf16 v[44:47], v[104:107], v[12:15], v[44:47]
    v_mfma_f32_16x16x32_bf16 v[48:51], v[104:107], v[16:19], v[48:51]
    v_mfma_f32_16x16x32_bf16 v[52:55], v[104:107], v[20:23], v[52:55]
    v_mfma_f32_16x16x32_bf16 v[56:59], v[104:107], v[24:27], v[56:59]
    v_mfma_f32_16x16x32_bf16 v[60:63], v[104:107], v[28:31], v[60:63]
    s_waitcnt lgkmcnt(0)
    v_mfma_f32_16x16x32_bf16 v[32:35], v[108:111], v[0:3], v[32:35]
    v_mfma_f32_16x16x32_bf16 v[36:39], v[108:111], v[4:7], v[36:39]
    v_mfma_f32_16x16x32_bf16 v[40:43], v[108:111], v[8:11], v[40:43]
    v_mfma_f32_16x16x32_bf16 v[44:47], v[108:111], v[12:15], v[44:47]
    v_mfma_f32_16x16x32_bf16 v[48:51], v[108:111], v[16:19], v[48:51]
    v_mfma_f32_16x16x32_bf16 v[52:55], v[108:111], v[20:23], v[52:55]
    v_mfma_f32_16x16x32_bf16 v[56:59], v[108:111], v[24:27], v[56:59]
    v_mfma_f32_16x16x32_bf16 v[60:63], v[108:111], v[28:31], v[60:63]
    s_nop 7
    v_cvt_pk_bf16_f32 v112, v32, v36
    v_cvt_pk_bf16_f32 v113, v40, v44
    v_cvt_pk_bf16_f32 v114, v48, v52
    v_cvt_pk_bf16_f32 v115, v56, v60
    buffer_store_dwordx4 v[112:115], v120, s[20:23], s25 offen
    s_add_u32 s25, s25, 2736128
    v_cvt_pk_bf16_f32 v116, v33, v37
    v_cvt_pk_bf16_f32 v117, v41, v45
    v_cvt_pk_bf16_f32 v118, v49, v53
    v_cvt_pk_bf16_f32 v119, v57, v61
    buffer_store_dwordx4 v[116:119], v120, s[20:23], s25 offen
    s_add_u32 s25, s25, 2736128
    v_cvt_pk_bf16_f32 v112, v34, v38
    v_cvt_pk_bf16_f32 v113, v42, v46
    v_cvt_pk_bf16_f32 v114, v50, v54
    v_cvt_pk_bf16_f32 v115, v58, v62
    buffer_store_dwordx4 v[112:115], v120, s[20:23], s25 offen
    s_add_u32 s25, s25, 2736128
    v_cvt_pk_bf16_f32 v116, v35, v39
    v_cvt_pk_bf16_f32 v117, v43, v47
    v_cvt_pk_bf16_f32 v118, v51, v55
    v_cvt_pk_bf16_f32 v119, v59, v63
    buffer_store_dwordx4 v[116:119], v120, s[20:23], s25 offen
    s_endpgm
K1_W:
    s_mov_b32 s16, s6
    s_mov_b32 s17, s7
    s_and_b32 s17, s17, 0xffff
    s_mov_b32 s18, 16252928
    s_mov_b32 s19, 0x00020000
    s_add_u32 s20, s8, 50331648
    s_addc_u32 s21, s9, 0
    s_and_b32 s21, s21, 0xffff
    s_mov_b32 s22, 67108864
    s_mov_b32 s23, 0x00020000
    s_mul_i32 s11, s2, 4
    s_lshr_b32 s12, s11, 9
    s_and_b32 s13, s11, 511
    s_lshl_b32 s14, s12, 19
    s_lshl_b32 s15, s13, 10
    s_add_u32 s14, s14, s15
    s_lshl_b32 s15, s3, 8
    s_add_u32 s14, s14, s15
    v_and_b32 v126, 1, v123
    v_lshlrev_b32 v126, 23, v126
    v_lshl_add_u32 v126, v122, 4, v126
    s_mov_b32 s15, s14
    buffer_load_dwordx4 v[0:3], v126, s[16:19], s15 offen
    s_add_u32 s15, s15, 0x100000
    buffer_load_dwordx4 v[4:7], v126, s[16:19], s15 offen
    s_add_u32 s15, s15, 0x100000
    buffer_load_dwordx4 v[8:11], v126, s[16:19], s15 offen
    s_add_u32 s15, s15, 0x100000
    buffer_load_dwordx4 v[12:15], v126, s[16:19], s15 offen
    s_add_u32 s15, s15, 0x100000
    buffer_load_dwordx4 v[16:19], v126, s[16:19], s15 offen
    s_add_u32 s15, s15, 0x100000
    buffer_load_dwordx4 v[20:23], v126, s[16:19], s15 offen
    s_add_u32 s15, s15, 0x100000
    buffer_load_dwordx4 v[24:27], v126, s[16:19], s15 offen
    s_add_u32 s15, s15, 0x100000
    buffer_load_dwordx4 v[28:31], v126, s[16:19], s15 offen
    v_and_b32 v127, 1, v123
    v_lshlrev_b32 v127, 3, v127
    v_mul_u32_u24 v112, 96, v125
    v_mad_u32_u24 v113, v124, v127, v112
    v_mad_u32_u24 v64, v124, 0, v113
    v_mad_u32_u24 v65, v124, 1, v113
    v_mad_u32_u24 v66, v124, 2, v113
    v_mad_u32_u24 v67, v124, 3, v113
    v_mad_u32_u24 v68, v124, 4, v113
    v_mad_u32_u24 v69, v124, 5, v113
    v_mad_u32_u24 v70, v124, 6, v113
    v_mad_u32_u24 v71, v124, 7, v113
    v_and_b32 v64, 127, v64
    v_and_b32 v65, 127, v65
    v_and_b32 v66, 127, v66
    v_and_b32 v67, 127, v67
    v_and_b32 v68, 127, v68
    v_and_b32 v69, 127, v69
    v_and_b32 v70, 127, v70
    v_and_b32 v71, 127, v71
    v_cvt_f32_u32 v64, v64
    v_cvt_f32_u32 v65, v65
    v_cvt_f32_u32 v66, v66
    v_cvt_f32_u32 v67, v67
    v_cvt_f32_u32 v68, v68
    v_cvt_f32_u32 v69, v69
    v_cvt_f32_u32 v70, v70
    v_cvt_f32_u32 v71, v71
    v_mul_f32 v64, 0x3c000000, v64
    v_mul_f32 v65, 0x3c000000, v65
    v_mul_f32 v66, 0x3c000000, v66
    v_mul_f32 v67, 0x3c000000, v67
    v_mul_f32 v68, 0x3c000000, v68
    v_mul_f32 v69, 0x3c000000, v69
    v_mul_f32 v70, 0x3c000000, v70
    v_mul_f32 v71, 0x3c000000, v71
    v_cos_f32 v64, v64
    v_cos_f32 v65, v65
    v_cos_f32 v66, v66
    v_cos_f32 v67, v67
    v_cos_f32 v68, v68
    v_cos_f32 v69, v69
    v_cos_f32 v70, v70
    v_cos_f32 v71, v71
    s_nop 0
    v_cvt_pk_bf16_f32 v72, v64, v65
    v_cvt_pk_bf16_f32 v73, v66, v67
    v_cvt_pk_bf16_f32 v74, v68, v69
    v_cvt_pk_bf16_f32 v75, v70, v71
    v_lshlrev_b32 v80, 16, v72
    v_and_b32 v81, 0xffff0000, v72
    v_sub_f32 v64, v64, v80
    v_sub_f32 v65, v65, v81
    v_lshlrev_b32 v80, 16, v73
    v_and_b32 v81, 0xffff0000, v73
    v_sub_f32 v66, v66, v80
    v_sub_f32 v67, v67, v81
    v_lshlrev_b32 v80, 16, v74
    v_and_b32 v81, 0xffff0000, v74
    v_sub_f32 v68, v68, v80
    v_sub_f32 v69, v69, v81
    v_lshlrev_b32 v80, 16, v75
    v_and_b32 v81, 0xffff0000, v75
    v_sub_f32 v70, v70, v80
    v_sub_f32 v71, v71, v81
    v_cvt_pk_bf16_f32 v76, v64, v65
    v_cvt_pk_bf16_f32 v77, v66, v67
    v_cvt_pk_bf16_f32 v78, v68, v69
    v_cvt_pk_bf16_f32 v79, v70, v71
    v_cmp_lt_u32 vcc, 1, v123
    s_lshl_b32 s24, s3, 10
    v_add_u32 v114, s24, v121
    v_cndmask_b32 v72, v72, v76, vcc
    v_cndmask_b32 v73, v73, v77, vcc
    v_cndmask_b32 v74, v74, v78, vcc
    v_cndmask_b32 v75, v75, v79, vcc
    ds_write_b128 v114, v[72:75]
    v_lshrrev_b32 v112, 1, v123
    s_mov_b32 s24, 2097152
    v_mul_lo_u32 v112, v112, s24
    v_and_b32 v113, 1, v123
    v_lshl_add_u32 v112, v113, 8, v112
    v_and_b32 v113, 1, v122
    v_lshl_add_u32 v124, v113, 4, v112
    v_lshrrev_b32 v125, 1, v122
    s_mul_i32 s26, s3, 524288
    s_lshl_b32 s24, s11, 9
    s_add_u32 s26, s26, s24
    s_waitcnt lgkmcnt(0)
    s_barrier
    ds_read_b128 v[96:99], v121 offset:0
    ds_read_b128 v[100:103], v121 offset:1024
    ds_read_b128 v[104:107], v121 offset:2048
    ds_read_b128 v[108:111], v121 offset:3072
    s_mov_b32 s27, 0
    s_waitcnt vmcnt(0) lgkmcnt(0)
K1_W_LOOP:
    s_add_u32 s24, s11, s27
    s_and_b32 s30, s24, 3
    s_lshr_b32 s24, s24, 1
    s_and_b32 s24, s24, 4
    s_or_b32 s30, s30, s24
    v_xor_b32 v112, s30, v125
    v_lshl_add_u32 v120, v112, 5, v124
    s_lshl_b32 s25, s27, 9
    s_add_u32 s25, s25, s26
    v_perm_b32 v32, v4, v0, s28
    v_perm_b32 v36, v4, v0, s29
    v_perm_b32 v33, v12, v8, s28
    v_perm_b32 v37, v12, v8, s29
    v_perm_b32 v34, v20, v16, s28
    v_perm_b32 v38, v20, v16, s29
    v_perm_b32 v35, v28, v24, s28
    v_perm_b32 v39, v28, v24, s29
    v_perm_b32 v40, v5, v1, s28
    v_perm_b32 v44, v5, v1, s29
    v_perm_b32 v41, v13, v9, s28
    v_perm_b32 v45, v13, v9, s29
    v_perm_b32 v42, v21, v17, s28
    v_perm_b32 v46, v21, v17, s29
    v_perm_b32 v43, v29, v25, s28
    v_perm_b32 v47, v29, v25, s29
    v_perm_b32 v48, v6, v2, s28
    v_perm_b32 v52, v6, v2, s29
    v_perm_b32 v49, v14, v10, s28
    v_perm_b32 v53, v14, v10, s29
    v_perm_b32 v50, v22, v18, s28
    v_perm_b32 v54, v22, v18, s29
    v_perm_b32 v51, v30, v26, s28
    v_perm_b32 v55, v30, v26, s29
    v_perm_b32 v56, v7, v3, s28
    v_perm_b32 v60, v7, v3, s29
    v_perm_b32 v57, v15, v11, s28
    v_perm_b32 v61, v15, v11, s29
    v_perm_b32 v58, v23, v19, s28
    v_perm_b32 v62, v23, v19, s29
    v_perm_b32 v59, v31, v27, s28
    v_perm_b32 v63, v31, v27, s29
    s_add_u32 s27, s27, 1
    s_add_u32 s14, s14, 1024
    s_cmp_ge_u32 s27, 4
    s_cbranch_scc1 K1_W_NOLOAD
    s_mov_b32 s15, s14
    buffer_load_dwordx4 v[0:3], v126, s[16:19], s15 offen
    s_add_u32 s15, s15, 0x100000
    buffer_load_dwordx4 v[4:7], v126, s[16:19], s15 offen
    s_add_u32 s15, s15, 0x100000
    buffer_load_dwordx4 v[8:11], v126, s[16:19], s15 offen
    s_add_u32 s15, s15, 0x100000
    buffer_load_dwordx4 v[12:15], v126, s[16:19], s15 offen
    s_add_u32 s15, s15, 0x100000
    buffer_load_dwordx4 v[16:19], v126, s[16:19], s15 offen
    s_add_u32 s15, s15, 0x100000
    buffer_load_dwordx4 v[20:23], v126, s[16:19], s15 offen
    s_add_u32 s15, s15, 0x100000
    buffer_load_dwordx4 v[24:27], v126, s[16:19], s15 offen
    s_add_u32 s15, s15, 0x100000
    buffer_load_dwordx4 v[28:31], v126, s[16:19], s15 offen
K1_W_NOLOAD:
    v_mfma_f32_16x16x32_bf16 v[64:67], v[96:99], v[32:35], 0
    v_mfma_f32_16x16x32_bf16 v[68:71], v[96:99], v[36:39], 0
    v_mfma_f32_16x16x32_bf16 v[72:75], v[96:99], v[40:43], 0
    v_mfma_f32_16x16x32_bf16 v[76:79], v[96:99], v[44:47], 0
    v_mfma_f32_16x16x32_bf16 v[80:83], v[96:99], v[48:51], 0
    v_mfma_f32_16x16x32_bf16 v[84:87], v[96:99], v[52:55], 0
    v_mfma_f32_16x16x32_bf16 v[88:91], v[96:99], v[56:59], 0
    v_mfma_f32_16x16x32_bf16 v[92:95], v[96:99], v[60:63], 0
    s_nop 7
    v_cvt_pk_bf16_f32 v112, v64, v68
    v_cvt_pk_bf16_f32 v113, v72, v76
    v_cvt_pk_bf16_f32 v114, v80, v84
    v_cvt_pk_bf16_f32 v115, v88, v92
    buffer_store_dwordx4 v[112:115], v120, s[20:23], s25 offen
    s_add_u32 s25, s25, 4194304
    v_cvt_pk_bf16_f32 v116, v65, v69
    v_cvt_pk_bf16_f32 v117, v73, v77
    v_cvt_pk_bf16_f32 v118, v81, v85
    v_cvt_pk_bf16_f32 v119, v89, v93
    buffer_store_dwordx4 v[116:119], v120, s[20:23], s25 offen
    s_add_u32 s25, s25, 4194304
    v_cvt_pk_bf16_f32 v112, v66, v70
    v_cvt_pk_bf16_f32 v113, v74, v78
    v_cvt_pk_bf16_f32 v114, v82, v86
    v_cvt_pk_bf16_f32 v115, v90, v94
    buffer_store_dwordx4 v[112:115], v120, s[20:23], s25 offen
    s_add_u32 s25, s25, 4194304
    v_cvt_pk_bf16_f32 v116, v67, v71
    v_cvt_pk_bf16_f32 v117, v75, v79
    v_cvt_pk_bf16_f32 v118, v83, v87
    v_cvt_pk_bf16_f32 v119, v91, v95
    buffer_store_dwordx4 v[116:119], v120, s[20:23], s25 offen
    s_add_u32 s25, s25, 4194304
    v_mfma_f32_16x16x32_bf16 v[64:67], v[100:103], v[32:35], 0
    v_mfma_f32_16x16x32_bf16 v[68:71], v[100:103], v[36:39], 0
    v_mfma_f32_16x16x32_bf16 v[72:75], v[100:103], v[40:43], 0
    v_mfma_f32_16x16x32_bf16 v[76:79], v[100:103], v[44:47], 0
    v_mfma_f32_16x16x32_bf16 v[80:83], v[100:103], v[48:51], 0
    v_mfma_f32_16x16x32_bf16 v[84:87], v[100:103], v[52:55], 0
    v_mfma_f32_16x16x32_bf16 v[88:91], v[100:103], v[56:59], 0
    v_mfma_f32_16x16x32_bf16 v[92:95], v[100:103], v[60:63], 0
    s_nop 7
    v_cvt_pk_bf16_f32 v112, v64, v68
    v_cvt_pk_bf16_f32 v113, v72, v76
    v_cvt_pk_bf16_f32 v114, v80, v84
    v_cvt_pk_bf16_f32 v115, v88, v92
    buffer_store_dwordx4 v[112:115], v120, s[20:23], s25 offen
    s_add_u32 s25, s25, 4194304
    v_cvt_pk_bf16_f32 v116, v65, v69
    v_cvt_pk_bf16_f32 v117, v73, v77
    v_cvt_pk_bf16_f32 v118, v81, v85
    v_cvt_pk_bf16_f32 v119, v89, v93
    buffer_store_dwordx4 v[116:119], v120, s[20:23], s25 offen
    s_add_u32 s25, s25, 4194304
    v_cvt_pk_bf16_f32 v112, v66, v70
    v_cvt_pk_bf16_f32 v113, v74, v78
    v_cvt_pk_bf16_f32 v114, v82, v86
    v_cvt_pk_bf16_f32 v115, v90, v94
    buffer_store_dwordx4 v[112:115], v120, s[20:23], s25 offen
    s_add_u32 s25, s25, 4194304
    v_cvt_pk_bf16_f32 v116, v67, v71
    v_cvt_pk_bf16_f32 v117, v75, v79
    v_cvt_pk_bf16_f32 v118, v83, v87
    v_cvt_pk_bf16_f32 v119, v91, v95
    buffer_store_dwordx4 v[116:119], v120, s[20:23], s25 offen
    s_add_u32 s25, s25, 4194304
    v_mfma_f32_16x16x32_bf16 v[64:67], v[104:107], v[32:35], 0
    v_mfma_f32_16x16x32_bf16 v[68:71], v[104:107], v[36:39], 0
    v_mfma_f32_16x16x32_bf16 v[72:75], v[104:107], v[40:43], 0
    v_mfma_f32_16x16x32_bf16 v[76:79], v[104:107], v[44:47], 0
    v_mfma_f32_16x16x32_bf16 v[80:83], v[104:107], v[48:51], 0
    v_mfma_f32_16x16x32_bf16 v[84:87], v[104:107], v[52:55], 0
    v_mfma_f32_16x16x32_bf16 v[88:91], v[104:107], v[56:59], 0
    v_mfma_f32_16x16x32_bf16 v[92:95], v[104:107], v[60:63], 0
    s_nop 7
    v_cvt_pk_bf16_f32 v112, v64, v68
    v_cvt_pk_bf16_f32 v113, v72, v76
    v_cvt_pk_bf16_f32 v114, v80, v84
    v_cvt_pk_bf16_f32 v115, v88, v92
    buffer_store_dwordx4 v[112:115], v120, s[20:23], s25 offen
    s_add_u32 s25, s25, 4194304
    v_cvt_pk_bf16_f32 v116, v65, v69
    v_cvt_pk_bf16_f32 v117, v73, v77
    v_cvt_pk_bf16_f32 v118, v81, v85
    v_cvt_pk_bf16_f32 v119, v89, v93
    buffer_store_dwordx4 v[116:119], v120, s[20:23], s25 offen
    s_add_u32 s25, s25, 4194304
    v_cvt_pk_bf16_f32 v112, v66, v70
    v_cvt_pk_bf16_f32 v113, v74, v78
    v_cvt_pk_bf16_f32 v114, v82, v86
    v_cvt_pk_bf16_f32 v115, v90, v94
    buffer_store_dwordx4 v[112:115], v120, s[20:23], s25 offen
    s_add_u32 s25, s25, 4194304
    v_cvt_pk_bf16_f32 v116, v67, v71
    v_cvt_pk_bf16_f32 v117, v75, v79
    v_cvt_pk_bf16_f32 v118, v83, v87
    v_cvt_pk_bf16_f32 v119, v91, v95
    buffer_store_dwordx4 v[116:119], v120, s[20:23], s25 offen
    s_add_u32 s25, s25, 4194304
    v_mfma_f32_16x16x32_bf16 v[64:67], v[108:111], v[32:35], 0
    v_mfma_f32_16x16x32_bf16 v[68:71], v[108:111], v[36:39], 0
    v_mfma_f32_16x16x32_bf16 v[72:75], v[108:111], v[40:43], 0
    v_mfma_f32_16x16x32_bf16 v[76:79], v[108:111], v[44:47], 0
    v_mfma_f32_16x16x32_bf16 v[80:83], v[108:111], v[48:51], 0
    v_mfma_f32_16x16x32_bf16 v[84:87], v[108:111], v[52:55], 0
    v_mfma_f32_16x16x32_bf16 v[88:91], v[108:111], v[56:59], 0
    v_mfma_f32_16x16x32_bf16 v[92:95], v[108:111], v[60:63], 0
    s_nop 7
    v_cvt_pk_bf16_f32 v112, v64, v68
    v_cvt_pk_bf16_f32 v113, v72, v76
    v_cvt_pk_bf16_f32 v114, v80, v84
    v_cvt_pk_bf16_f32 v115, v88, v92
    buffer_store_dwordx4 v[112:115], v120, s[20:23], s25 offen
    s_add_u32 s25, s25, 4194304
    v_cvt_pk_bf16_f32 v116, v65, v69
    v_cvt_pk_bf16_f32 v117, v73, v77
    v_cvt_pk_bf16_f32 v118, v81, v85
    v_cvt_pk_bf16_f32 v119, v89, v93
    buffer_store_dwordx4 v[116:119], v120, s[20:23], s25 offen
    s_add_u32 s25, s25, 4194304
    v_cvt_pk_bf16_f32 v112, v66, v70
    v_cvt_pk_bf16_f32 v113, v74, v78
    v_cvt_pk_bf16_f32 v114, v82, v86
    v_cvt_pk_bf16_f32 v115, v90, v94
    buffer_store_dwordx4 v[112:115], v120, s[20:23], s25 offen
    s_add_u32 s25, s25, 4194304
    v_cvt_pk_bf16_f32 v116, v67, v71
    v_cvt_pk_bf16_f32 v117, v75, v79
    v_cvt_pk_bf16_f32 v118, v83, v87
    v_cvt_pk_bf16_f32 v119, v91, v95
    buffer_store_dwordx4 v[116:119], v120, s[20:23], s25 offen
    s_waitcnt vmcnt(16)
    s_cmp_lt_u32 s27, 4
    s_cbranch_scc1 K1_W_LOOP
K1_END:
    s_endpgm
.p2align 8
.type k2_gemm_kernel,@function
k2_gemm_kernel:
    s_cmp_ge_u32 s2, 256
    s_cbranch_scc1 K2_END
    s_load_dwordx2 s[4:5], s[0:1], 48
    v_lshrrev_b32 v1, 6, v0
    v_and_b32 v2, 63, v0
    v_readfirstlane_b32 s3, v1
    s_and_b32 s6, s2, 7
    s_lshl_b32 s6, s6, 2
    s_lshr_b32 s7, s2, 6
    s_add_u32 s6, s6, s7
    s_lshr_b32 s7, s2, 3
    s_and_b32 s7, s7, 7
    s_lshr_b32 s20, s7, 2
    s_and_b32 s21, s7, 3
    s_lshl_b32 s22, s6, 1
    s_add_u32 s22, s22, s20
    s_lshl_b32 s23, s6, 2
    s_add_u32 s23, s23, s21
    s_mul_i32 s24, s22, 684032
    s_mul_i32 s25, s23, 524288
    s_add_u32 s25, s25, 50331648
    s_mul_i32 s26, s22, 342016
    s_add_u32 s26, s26, 118489088
    s_waitcnt lgkmcnt(0)
    s_add_u32 s8, s4, s24
    s_addc_u32 s9, s5, 0
    s_and_b32 s9, s9, 0xffff
    s_mov_b32 s10, 684032
    s_mov_b32 s11, 0x00020000
    s_add_u32 s12, s4, s25
    s_addc_u32 s13, s5, 0
    s_and_b32 s13, s13, 0xffff
    s_mov_b32 s14, 524288
    s_mov_b32 s15, 0x00020000
    s_add_u32 s16, s4, s26
    s_addc_u32 s17, s5, 0
    s_and_b32 s17, s17, 0xffff
    s_mov_b32 s18, 342016
    s_mov_b32 s19, 0x00020000
    v_and_b32 v3, 15, v2
    v_lshrrev_b32 v4, 4, v2
    v_lshlrev_b32 v1, 4, v2
    v_lshrrev_b32 v5, 1, v3
    v_xor_b32 v5, v5, v4
    v_lshlrev_b32 v5, 4, v5
    v_lshl_add_u32 v8, v3, 7, v5
    v_lshrrev_b32 v5, 2, v3
    v_lshl_add_u32 v6, v4, 3, v5
    v_lshlrev_b32 v6, 9, v6
    v_and_b32 v7, 1, v4
    v_lshl_or_b32 v5, v7, 2, v5
    s_and_b32 s27, s3, 3
    s_lshl_b32 s28, s27, 1
    v_xor_b32 v5, s28, v5
    v_lshl_add_u32 v6, v5, 5, v6
    v_and_b32 v5, 3, v3
    v_lshl_add_u32 v6, v5, 3, v6
    v_add_u32 v9, 21504, v6
    s_lshl_b32 s28, s21, 7
    s_lshl_b32 s29, s27, 5
    s_add_u32 s28, s28, s29
    v_add_u32 v5, s28, v3
    v_lshlrev_b32 v5, 2, v5
    v_lshl_add_u32 v10, v4, 13, v5
    v_mov_b32 v128, 0
    v_mov_b32 v129, 0
    v_mov_b32 v130, 0
    v_mov_b32 v131, 0
    v_mov_b32 v132, 0
    v_mov_b32 v133, 0
    v_mov_b32 v134, 0
    v_mov_b32 v135, 0
    v_mov_b32 v136, 0
    v_mov_b32 v137, 0
    v_mov_b32 v138, 0
    v_mov_b32 v139, 0
    v_mov_b32 v140, 0
    v_mov_b32 v141, 0
    v_mov_b32 v142, 0
    v_mov_b32 v143, 0
    v_mov_b32 v144, 0
    v_mov_b32 v145, 0
    v_mov_b32 v146, 0
    v_mov_b32 v147, 0
    v_mov_b32 v148, 0
    v_mov_b32 v149, 0
    v_mov_b32 v150, 0
    v_mov_b32 v151, 0
    v_mov_b32 v152, 0
    v_mov_b32 v153, 0
    v_mov_b32 v154, 0
    v_mov_b32 v155, 0
    v_mov_b32 v156, 0
    v_mov_b32 v157, 0
    v_mov_b32 v158, 0
    v_mov_b32 v159, 0
    v_mov_b32 v160, 0
    v_mov_b32 v161, 0
    v_mov_b32 v162, 0
    v_mov_b32 v163, 0
    v_mov_b32 v164, 0
    v_mov_b32 v165, 0
    v_mov_b32 v166, 0
    v_mov_b32 v167, 0
    v_mov_b32 v168, 0
    v_mov_b32 v169, 0
    v_mov_b32 v170, 0
    v_mov_b32 v171, 0
    v_mov_b32 v172, 0
    v_mov_b32 v173, 0
    v_mov_b32 v174, 0
    v_mov_b32 v175, 0
    v_mov_b32 v176, 0
    v_mov_b32 v177, 0
    v_mov_b32 v178, 0
    v_mov_b32 v179, 0
    v_mov_b32 v180, 0
    v_mov_b32 v181, 0
    v_mov_b32 v182, 0
    v_mov_b32 v183, 0
    v_mov_b32 v184, 0
    v_mov_b32 v185, 0
    v_mov_b32 v186, 0
    v_mov_b32 v187, 0
    v_mov_b32 v188, 0
    v_mov_b32 v189, 0
    v_mov_b32 v190, 0
    v_mov_b32 v191, 0
    v_mov_b32 v192, 0
    v_mov_b32 v193, 0
    v_mov_b32 v194, 0
    v_mov_b32 v195, 0
    v_mov_b32 v196, 0
    v_mov_b32 v197, 0
    v_mov_b32 v198, 0
    v_mov_b32 v199, 0
    v_mov_b32 v200, 0
    v_mov_b32 v201, 0
    v_mov_b32 v202, 0
    v_mov_b32 v203, 0
    v_mov_b32 v204, 0
    v_mov_b32 v205, 0
    v_mov_b32 v206, 0
    v_mov_b32 v207, 0
    v_mov_b32 v208, 0
    v_mov_b32 v209, 0
    v_mov_b32 v210, 0
    v_mov_b32 v211, 0
    v_mov_b32 v212, 0
    v_mov_b32 v213, 0
    v_mov_b32 v214, 0
    v_mov_b32 v215, 0
    v_mov_b32 v216, 0
    v_mov_b32 v217, 0
    v_mov_b32 v218, 0
    v_mov_b32 v219, 0
    v_mov_b32 v220, 0
    v_mov_b32 v221, 0
    v_mov_b32 v222, 0
    v_mov_b32 v223, 0
    s_cmp_ge_u32 s3, 4
    s_cbranch_scc1 K2_MH1
    s_lshl_b32 s30, s27, 12
    s_add_u32 s32, s30, 21504
    s_lshl_b32 s31, s27, 8
    s_add_u32 s31, s31, 20480
    s_mov_b32 s33, s31
    s_mov_b32 s34, 0x80008000
    s_mov_b32 s35, 0
    s_add_u32 m0, s35, s32
    s_nop 0
    buffer_load_dwordx4 v1, s[12:15], s30 offen lds
    buffer_load_dwordx4 v1, s[12:15], s30 offen offset:1024 lds
    buffer_load_dwordx4 v1, s[12:15], s30 offen offset:2048 lds
    buffer_load_dwordx4 v1, s[12:15], s30 offen offset:3072 lds
    s_add_u32 m0, s35, s33
    s_mov_b64 exec, 0xffff
    buffer_load_dwordx4 v1, s[8:11], s31 offen lds
    s_mov_b64 exec, -1
    s_add_u32 s30, s30, 16384
    s_add_u32 s31, s31, 21376
    s_add_u32 s35, s35, 37888
    s_add_u32 m0, s35, s32
    s_nop 0
    buffer_load_dwordx4 v1, s[12:15], s30 offen lds
    buffer_load_dwordx4 v1, s[12:15], s30 offen offset:1024 lds
    buffer_load_dwordx4 v1, s[12:15], s30 offen offset:2048 lds
    buffer_load_dwordx4 v1, s[12:15], s30 offen offset:3072 lds
    s_add_u32 m0, s35, s33
    s_mov_b64 exec, 0xffff
    buffer_load_dwordx4 v1, s[8:11], s31 offen lds
    s_mov_b64 exec, -1
    s_add_u32 s30, s30, 16384
    s_add_u32 s31, s31, 21376
    s_add_u32 s35, s35, 37888
    s_add_u32 m0, s35, s32
    s_nop 0
    buffer_load_dwordx4 v1, s[12:15], s30 offen lds
    buffer_load_dwordx4 v1, s[12:15], s30 offen offset:1024 lds
    buffer_load_dwordx4 v1, s[12:15], s30 offen offset:2048 lds
    buffer_load_dwordx4 v1, s[12:15], s30 offen offset:3072 lds
    s_add_u32 m0, s35, s33
    s_mov_b64 exec, 0xffff
    buffer_load_dwordx4 v1, s[8:11], s31 offen lds
    s_mov_b64 exec, -1
    s_add_u32 s30, s30, 16384
    s_add_u32 s31, s31, 21376
    s_add_u32 s35, s35, 37888
    s_add_u32 m0, s35, s32
    s_nop 0
    buffer_load_dwordx4 v1, s[12:15], s30 offen lds
    buffer_load_dwordx4 v1, s[12:15], s30 offen offset:1024 lds
    buffer_load_dwordx4 v1, s[12:15], s30 offen offset:2048 lds
    buffer_load_dwordx4 v1, s[12:15], s30 offen offset:3072 lds
    s_add_u32 m0, s35, s33
    s_mov_b64 exec, 0xffff
    buffer_load_dwordx4 v1, s[8:11], s31 offen lds
    s_mov_b64 exec, -1
    s_add_u32 s30, s30, 16384
    s_add_u32 s31, s31, 21376
    s_add_u32 s35, s35, 37888
    s_mov_b32 s35, 0
    s_mov_b32 s36, 37888
    s_mov_b32 s37, 0
    v_add_u32 v11, s35, v8
    v_add_u32 v13, s35, v9
    v_xor_b32 v12, 64, v11
    v_xor_b32 v14, 32, v13
    s_waitcnt vmcnt(15)
    s_barrier
    ds_read_b64_tr_b16 v[64:65], v13 offset:0
    ds_read_b64_tr_b16 v[66:67], v13 offset:2048
    ds_read_b64_tr_b16 v[68:69], v13 offset:256
    ds_read_b64_tr_b16 v[70:71], v13 offset:2304
    ds_read_b64_tr_b16 v[76:77], v14 offset:0
    ds_read_b64_tr_b16 v[78:79], v14 offset:2048
    ds_read_b64_tr_b16 v[80:81], v14 offset:256
    ds_read_b64_tr_b16 v[82:83], v14 offset:2304
    ds_read_b128 v[16:19], v11 offset:0
    ds_read_b128 v[20:23], v12 offset:0
    ds_read_b128 v[24:27], v11 offset:2048
    ds_read_b128 v[28:31], v12 offset:2048
    s_waitcnt lgkmcnt(4)
    v_xor_b32 v72, s34, v68
    v_xor_b32 v73, s34, v69
    v_xor_b32 v74, s34, v70
    v_xor_b32 v75, s34, v71
    v_xor_b32 v84, s34, v80
    v_xor_b32 v85, s34, v81
    v_xor_b32 v86, s34, v82
    v_xor_b32 v87, s34, v83
    ds_read_b128 v[32:35], v11 offset:4096
    ds_read_b128 v[36:39], v12 offset:4096
    ds_read_b128 v[40:43], v11 offset:6144
    ds_read_b128 v[44:47], v12 offset:6144
    ds_read_b128 v[48:51], v11 offset:8192
    ds_read_b128 v[52:55], v12 offset:8192
K2M0_LOOP:
    s_waitcnt lgkmcnt(4)
    v_mfma_f32_16x16x32_bf16 v[128:131], v[16:19], v[64:67], v[128:131]
    ds_read_b128 v[56:59], v11 offset:10240
    v_mfma_f32_16x16x32_bf16 v[132:135], v[16:19], v[68:71], v[132:135]
    ds_read_b128 v[60:63], v12 offset:10240
    v_mfma_f32_16x16x32_bf16 v[136:139], v[16:19], v[76:79], v[136:139]
    v_mfma_f32_16x16x32_bf16 v[140:143], v[16:19], v[80:83], v[140:143]
    v_mfma_f32_16x16x32_bf16 v[128:131], v[20:23], v[72:75], v[128:131]
    v_mfma_f32_16x16x32_bf16 v[132:135], v[20:23], v[64:67], v[132:135]
    v_mfma_f32_16x16x32_bf16 v[136:139], v[20:23], v[84:87], v[136:139]
    v_mfma_f32_16x16x32_bf16 v[140:143], v[20:23], v[76:79], v[140:143]
    v_mfma_f32_16x16x32_bf16 v[144:147], v[24:27], v[64:67], v[144:147]
    v_mfma_f32_16x16x32_bf16 v[148:151], v[24:27], v[68:71], v[148:151]
    v_mfma_f32_16x16x32_bf16 v[152:155], v[24:27], v[76:79], v[152:155]
    v_mfma_f32_16x16x32_bf16 v[156:159], v[24:27], v[80:83], v[156:159]
    v_mfma_f32_16x16x32_bf16 v[144:147], v[28:31], v[72:75], v[144:147]
    v_mfma_f32_16x16x32_bf16 v[148:151], v[28:31], v[64:67], v[148:151]
    v_mfma_f32_16x16x32_bf16 v[152:155], v[28:31], v[84:87], v[152:155]
    v_mfma_f32_16x16x32_bf16 v[156:159], v[28:31], v[76:79], v[156:159]
    v_mfma_f32_16x16x32_bf16 v[160:163], v[32:35], v[64:67], v[160:163]
    v_mfma_f32_16x16x32_bf16 v[164:167], v[32:35], v[68:71], v[164:167]
    v_mfma_f32_16x16x32_bf16 v[168:171], v[32:35], v[76:79], v[168:171]
    v_mfma_f32_16x16x32_bf16 v[172:175], v[32:35], v[80:83], v[172:175]
    v_mfma_f32_16x16x32_bf16 v[160:163], v[36:39], v[72:75], v[160:163]
    v_mfma_f32_16x16x32_bf16 v[164:167], v[36:39], v[64:67], v[164:167]
    v_mfma_f32_16x16x32_bf16 v[168:171], v[36:39], v[84:87], v[168:171]
    v_mfma_f32_16x16x32_bf16 v[172:175], v[36:39], v[76:79], v[172:175]
    s_waitcnt vmcnt(10) lgkmcnt(0)
    s_barrier
    v_mfma_f32_16x16x32_bf16 v[176:179], v[40:43], v[64:67], v[176:179]
    v_add_u32 v11, s36, v8
    v_add_u32 v13, s36, v9
    v_mfma_f32_16x16x32_bf16 v[180:183], v[40:43], v[68:71], v[180:183]
    v_xor_b32 v12, 64, v11
    v_xor_b32 v14, 32, v13
    v_mfma_f32_16x16x32_bf16 v[184:187], v[40:43], v[76:79], v[184:187]
    ds_read_b64_tr_b16 v[88:89], v13 offset:0
    ds_read_b64_tr_b16 v[90:91], v13 offset:2048
    v_mfma_f32_16x16x32_bf16 v[188:191], v[40:43], v[80:83], v[188:191]
    ds_read_b64_tr_b16 v[92:93], v13 offset:256
    ds_read_b64_tr_b16 v[94:95], v13 offset:2304
    v_mfma_f32_16x16x32_bf16 v[176:179], v[44:47], v[72:75], v[176:179]
    ds_read_b64_tr_b16 v[100:101], v14 offset:0
    ds_read_b64_tr_b16 v[102:103], v14 offset:2048
    v_mfma_f32_16x16x32_bf16 v[180:183], v[44:47], v[64:67], v[180:183]
    ds_read_b64_tr_b16 v[104:105], v14 offset:256
    ds_read_b64_tr_b16 v[106:107], v14 offset:2304
    v_mfma_f32_16x16x32_bf16 v[184:187], v[44:47], v[84:87], v[184:187]
    ds_read_b128 v[16:19], v11 offset:0
    ds_read_b128 v[20:23], v12 offset:0
    v_mfma_f32_16x16x32_bf16 v[188:191], v[44:47], v[76:79], v[188:191]
    ds_read_b128 v[24:27], v11 offset:2048
    ds_read_b128 v[28:31], v12 offset:2048
    v_mfma_f32_16x16x32_bf16 v[192:195], v[48:51], v[64:67], v[192:195]
    ds_read_b128 v[32:35], v11 offset:4096
    ds_read_b128 v[36:39], v12 offset:4096
    v_mfma_f32_16x16x32_bf16 v[196:199], v[48:51], v[68:71], v[196:199]
    ds_read_b128 v[40:43], v11 offset:6144
    ds_read_b128 v[44:47], v12 offset:6144
    v_mfma_f32_16x16x32_bf16 v[200:203], v[48:51], v[76:79], v[200:203]
    s_add_u32 m0, s35, s32
    s_nop 0
    buffer_load_dwordx4 v1, s[12:15], s30 offen lds
    v_mfma_f32_16x16x32_bf16 v[204:207], v[48:51], v[80:83], v[204:207]
    buffer_load_dwordx4 v1, s[12:15], s30 offen offset:1024 lds
    v_mfma_f32_16x16x32_bf16 v[192:195], v[52:55], v[72:75], v[192:195]
    buffer_load_dwordx4 v1, s[12:15], s30 offen offset:2048 lds
    v_mfma_f32_16x16x32_bf16 v[196:199], v[52:55], v[64:67], v[196:199]
    buffer_load_dwordx4 v1, s[12:15], s30 offen offset:3072 lds
    v_mfma_f32_16x16x32_bf16 v[200:203], v[52:55], v[84:87], v[200:203]
    s_add_u32 m0, s35, s33
    s_mov_b64 exec, 0xffff
    buffer_load_dwordx4 v1, s[8:11], s31 offen lds
    s_mov_b64 exec, -1
    v_mfma_f32_16x16x32_bf16 v[204:207], v[52:55], v[76:79], v[204:207]
    s_add_u32 s30, s30, 16384
    s_add_u32 s31, s31, 21376
    v_mfma_f32_16x16x32_bf16 v[208:211], v[56:59], v[64:67], v[208:211]
    s_waitcnt lgkmcnt(8)
    v_xor_b32 v96, s34, v92
    v_xor_b32 v97, s34, v93
    v_mfma_f32_16x16x32_bf16 v[212:215], v[56:59], v[68:71], v[212:215]
    v_xor_b32 v98, s34, v94
    v_xor_b32 v99, s34, v95
    v_mfma_f32_16x16x32_bf16 v[216:219], v[56:59], v[76:79], v[216:219]
    v_xor_b32 v108, s34, v104
    v_xor_b32 v109, s34, v105
    v_mfma_f32_16x16x32_bf16 v[220:223], v[56:59], v[80:83], v[220:223]
    v_xor_b32 v110, s34, v106
    v_xor_b32 v111, s34, v107
    v_mfma_f32_16x16x32_bf16 v[208:211], v[60:63], v[72:75], v[208:211]
    ds_read_b128 v[48:51], v11 offset:8192
    ds_read_b128 v[52:55], v12 offset:8192
    v_mfma_f32_16x16x32_bf16 v[212:215], v[60:63], v[64:67], v[212:215]
    v_mfma_f32_16x16x32_bf16 v[216:219], v[60:63], v[84:87], v[216:219]
    v_mfma_f32_16x16x32_bf16 v[220:223], v[60:63], v[76:79], v[220:223]
    s_mov_b32 s35, s36
    s_add_u32 s36, s36, 37888
    s_cmp_eq_u32 s36, 151552
    s_cselect_b32 s36, 0, s36
    s_waitcnt lgkmcnt(4)
    v_mfma_f32_16x16x32_bf16 v[128:131], v[16:19], v[88:91], v[128:131]
    ds_read_b128 v[56:59], v11 offset:10240
    v_mfma_f32_16x16x32_bf16 v[132:135], v[16:19], v[92:95], v[132:135]
    ds_read_b128 v[60:63], v12 offset:10240
    v_mfma_f32_16x16x32_bf16 v[136:139], v[16:19], v[100:103], v[136:139]
    v_mfma_f32_16x16x32_bf16 v[140:143], v[16:19], v[104:107], v[140:143]
    v_mfma_f32_16x16x32_bf16 v[128:131], v[20:23], v[96:99], v[128:131]
    v_mfma_f32_16x16x32_bf16 v[132:135], v[20:23], v[88:91], v[132:135]
    v_mfma_f32_16x16x32_bf16 v[136:139], v[20:23], v[108:111], v[136:139]
    v_mfma_f32_16x16x32_bf16 v[140:143], v[20:23], v[100:103], v[140:143]
    v_mfma_f32_16x16x32_bf16 v[144:147], v[24:27], v[88:91], v[144:147]
    v_mfma_f32_16x16x32_bf16 v[148:151], v[24:27], v[92:95], v[148:151]
    v_mfma_f32_16x16x32_bf16 v[152:155], v[24:27], v[100:103], v[152:155]
    v_mfma_f32_16x16x32_bf16 v[156:159], v[24:27], v[104:107], v[156:159]
    v_mfma_f32_16x16x32_bf16 v[144:147], v[28:31], v[96:99], v[144:147]
    v_mfma_f32_16x16x32_bf16 v[148:151], v[28:31], v[88:91], v[148:151]
    v_mfma_f32_16x16x32_bf16 v[152:155], v[28:31], v[108:111], v[152:155]
    v_mfma_f32_16x16x32_bf16 v[156:159], v[28:31], v[100:103], v[156:159]
    v_mfma_f32_16x16x32_bf16 v[160:163], v[32:35], v[88:91], v[160:163]
    v_mfma_f32_16x16x32_bf16 v[164:167], v[32:35], v[92:95], v[164:167]
    v_mfma_f32_16x16x32_bf16 v[168:171], v[32:35], v[100:103], v[168:171]
    v_mfma_f32_16x16x32_bf16 v[172:175], v[32:35], v[104:107], v[172:175]
    v_mfma_f32_16x16x32_bf16 v[160:163], v[36:39], v[96:99], v[160:163]
    v_mfma_f32_16x16x32_bf16 v[164:167], v[36:39], v[88:91], v[164:167]
    v_mfma_f32_16x16x32_bf16 v[168:171], v[36:39], v[108:111], v[168:171]
    v_mfma_f32_16x16x32_bf16 v[172:175], v[36:39], v[100:103], v[172:175]
    s_waitcnt vmcnt(10) lgkmcnt(0)
    s_barrier
    v_mfma_f32_16x16x32_bf16 v[176:179], v[40:43], v[88:91], v[176:179]
    v_add_u32 v11, s36, v8
    v_add_u32 v13, s36, v9
    v_mfma_f32_16x16x32_bf16 v[180:183], v[40:43], v[92:95], v[180:183]
    v_xor_b32 v12, 64, v11
    v_xor_b32 v14, 32, v13
    v_mfma_f32_16x16x32_bf16 v[184:187], v[40:43], v[100:103], v[184:187]
    ds_read_b64_tr_b16 v[64:65], v13 offset:0
    ds_read_b64_tr_b16 v[66:67], v13 offset:2048
    v_mfma_f32_16x16x32_bf16 v[188:191], v[40:43], v[104:107], v[188:191]
    ds_read_b64_tr_b16 v[68:69], v13 offset:256
    ds_read_b64_tr_b16 v[70:71], v13 offset:2304
    v_mfma_f32_16x16x32_bf16 v[176:179], v[44:47], v[96:99], v[176:179]
    ds_read_b64_tr_b16 v[76:77], v14 offset:0
    ds_read_b64_tr_b16 v[78:79], v14 offset:2048
    v_mfma_f32_16x16x32_bf16 v[180:183], v[44:47], v[88:91], v[180:183]
    ds_read_b64_tr_b16 v[80:81], v14 offset:256
    ds_read_b64_tr_b16 v[82:83], v14 offset:2304
    v_mfma_f32_16x16x32_bf16 v[184:187], v[44:47], v[108:111], v[184:187]
    ds_read_b128 v[16:19], v11 offset:0
    ds_read_b128 v[20:23], v12 offset:0
    v_mfma_f32_16x16x32_bf16 v[188:191], v[44:47], v[100:103], v[188:191]
    ds_read_b128 v[24:27], v11 offset:2048
    ds_read_b128 v[28:31], v12 offset:2048
    v_mfma_f32_16x16x32_bf16 v[192:195], v[48:51], v[88:91], v[192:195]
    ds_read_b128 v[32:35], v11 offset:4096
    ds_read_b128 v[36:39], v12 offset:4096
    v_mfma_f32_16x16x32_bf16 v[196:199], v[48:51], v[92:95], v[196:199]
    ds_read_b128 v[40:43], v11 offset:6144
    ds_read_b128 v[44:47], v12 offset:6144
    v_mfma_f32_16x16x32_bf16 v[200:203], v[48:51], v[100:103], v[200:203]
    s_add_u32 m0, s35, s32
    s_nop 0
    buffer_load_dwordx4 v1, s[12:15], s30 offen lds
    v_mfma_f32_16x16x32_bf16 v[204:207], v[48:51], v[104:107], v[204:207]
    buffer_load_dwordx4 v1, s[12:15], s30 offen offset:1024 lds
    v_mfma_f32_16x16x32_bf16 v[192:195], v[52:55], v[96:99], v[192:195]
    buffer_load_dwordx4 v1, s[12:15], s30 offen offset:2048 lds
    v_mfma_f32_16x16x32_bf16 v[196:199], v[52:55], v[88:91], v[196:199]
    buffer_load_dwordx4 v1, s[12:15], s30 offen offset:3072 lds
    v_mfma_f32_16x16x32_bf16 v[200:203], v[52:55], v[108:111], v[200:203]
    s_add_u32 m0, s35, s33
    s_mov_b64 exec, 0xffff
    buffer_load_dwordx4 v1, s[8:11], s31 offen lds
    s_mov_b64 exec, -1
    v_mfma_f32_16x16x32_bf16 v[204:207], v[52:55], v[100:103], v[204:207]
    s_add_u32 s30, s30, 16384
    s_add_u32 s31, s31, 21376
    v_mfma_f32_16x16x32_bf16 v[208:211], v[56:59], v[88:91], v[208:211]
    s_waitcnt lgkmcnt(8)
    v_xor_b32 v72, s34, v68
    v_xor_b32 v73, s34, v69
    v_mfma_f32_16x16x32_bf16 v[212:215], v[56:59], v[92:95], v[212:215]
    v_xor_b32 v74, s34, v70
    v_xor_b32 v75, s34, v71
    v_mfma_f32_16x16x32_bf16 v[216:219], v[56:59], v[100:103], v[216:219]
    v_xor_b32 v84, s34, v80
    v_xor_b32 v85, s34, v81
    v_mfma_f32_16x16x32_bf16 v[220:223], v[56:59], v[104:107], v[220:223]
    v_xor_b32 v86, s34, v82
    v_xor_b32 v87, s34, v83
    v_mfma_f32_16x16x32_bf16 v[208:211], v[60:63], v[96:99], v[208:211]
    ds_read_b128 v[48:51], v11 offset:8192
    ds_read_b128 v[52:55], v12 offset:8192
    v_mfma_f32_16x16x32_bf16 v[212:215], v[60:63], v[88:91], v[212:215]
    v_mfma_f32_16x16x32_bf16 v[216:219], v[60:63], v[108:111], v[216:219]
    v_mfma_f32_16x16x32_bf16 v[220:223], v[60:63], v[100:103], v[220:223]
    s_mov_b32 s35, s36
    s_add_u32 s36, s36, 37888
    s_cmp_eq_u32 s36, 151552
    s_cselect_b32 s36, 0, s36
    s_add_u32 s37, s37, 1
    s_cmp_lt_u32 s37, 16
    s_cbranch_scc1 K2M0_LOOP
    s_nop 7
    s_nop 1
    s_mov_b32 s38, 0
    v_cvt_pk_bf16_f32 v16, v128, v132
    buffer_store_dword v16, v10, s[16:19], s38 offen offset:0
    v_cvt_pk_bf16_f32 v17, v136, v140
    buffer_store_dword v17, v10, s[16:19], s38 offen offset:64
    v_cvt_pk_bf16_f32 v18, v129, v133
    buffer_store_dword v18, v10, s[16:19], s38 offen offset:2048
    v_cvt_pk_bf16_f32 v19, v137, v141
    buffer_store_dword v19, v10, s[16:19], s38 offen offset:2112
    s_mov_b32 s38, 4096
    v_cvt_pk_bf16_f32 v20, v130, v134
    buffer_store_dword v20, v10, s[16:19], s38 offen offset:0
    v_cvt_pk_bf16_f32 v21, v138, v142
    buffer_store_dword v21, v10, s[16:19], s38 offen offset:64
    v_cvt_pk_bf16_f32 v22, v131, v135
    buffer_store_dword v22, v10, s[16:19], s38 offen offset:2048
    v_cvt_pk_bf16_f32 v23, v139, v143
    buffer_store_dword v23, v10, s[16:19], s38 offen offset:2112
    s_mov_b32 s38, 32768
    v_cvt_pk_bf16_f32 v16, v144, v148
    buffer_store_dword v16, v10, s[16:19], s38 offen offset:0
    v_cvt_pk_bf16_f32 v17, v152, v156
    buffer_store_dword v17, v10, s[16:19], s38 offen offset:64
    v_cvt_pk_bf16_f32 v18, v145, v149
    buffer_store_dword v18, v10, s[16:19], s38 offen offset:2048
    v_cvt_pk_bf16_f32 v19, v153, v157
    buffer_store_dword v19, v10, s[16:19], s38 offen offset:2112
    s_mov_b32 s38, 36864
    v_cvt_pk_bf16_f32 v20, v146, v150
    buffer_store_dword v20, v10, s[16:19], s38 offen offset:0
    v_cvt_pk_bf16_f32 v21, v154, v158
    buffer_store_dword v21, v10, s[16:19], s38 offen offset:64
    v_cvt_pk_bf16_f32 v22, v147, v151
    buffer_store_dword v22, v10, s[16:19], s38 offen offset:2048
    v_cvt_pk_bf16_f32 v23, v155, v159
    buffer_store_dword v23, v10, s[16:19], s38 offen offset:2112
    s_mov_b32 s38, 65536
    v_cvt_pk_bf16_f32 v16, v160, v164
    buffer_store_dword v16, v10, s[16:19], s38 offen offset:0
    v_cvt_pk_bf16_f32 v17, v168, v172
    buffer_store_dword v17, v10, s[16:19], s38 offen offset:64
    v_cvt_pk_bf16_f32 v18, v161, v165
    buffer_store_dword v18, v10, s[16:19], s38 offen offset:2048
    v_cvt_pk_bf16_f32 v19, v169, v173
    buffer_store_dword v19, v10, s[16:19], s38 offen offset:2112
    s_mov_b32 s38, 69632
    v_cvt_pk_bf16_f32 v20, v162, v166
    buffer_store_dword v20, v10, s[16:19], s38 offen offset:0
    v_cvt_pk_bf16_f32 v21, v170, v174
    buffer_store_dword v21, v10, s[16:19], s38 offen offset:64
    v_cvt_pk_bf16_f32 v22, v163, v167
    buffer_store_dword v22, v10, s[16:19], s38 offen offset:2048
    v_cvt_pk_bf16_f32 v23, v171, v175
    buffer_store_dword v23, v10, s[16:19], s38 offen offset:2112
    s_mov_b32 s38, 98304
    v_cvt_pk_bf16_f32 v16, v176, v180
    buffer_store_dword v16, v10, s[16:19], s38 offen offset:0
    v_cvt_pk_bf16_f32 v17, v184, v188
    buffer_store_dword v17, v10, s[16:19], s38 offen offset:64
    v_cvt_pk_bf16_f32 v18, v177, v181
    buffer_store_dword v18, v10, s[16:19], s38 offen offset:2048
    v_cvt_pk_bf16_f32 v19, v185, v189
    buffer_store_dword v19, v10, s[16:19], s38 offen offset:2112
    s_mov_b32 s38, 102400
    v_cvt_pk_bf16_f32 v20, v178, v182
    buffer_store_dword v20, v10, s[16:19], s38 offen offset:0
    v_cvt_pk_bf16_f32 v21, v186, v190
    buffer_store_dword v21, v10, s[16:19], s38 offen offset:64
    v_cvt_pk_bf16_f32 v22, v179, v183
    buffer_store_dword v22, v10, s[16:19], s38 offen offset:2048
    v_cvt_pk_bf16_f32 v23, v187, v191
    buffer_store_dword v23, v10, s[16:19], s38 offen offset:2112
    s_mov_b32 s38, 131072
    v_cvt_pk_bf16_f32 v16, v192, v196
    buffer_store_dword v16, v10, s[16:19], s38 offen offset:0
    v_cvt_pk_bf16_f32 v17, v200, v204
    buffer_store_dword v17, v10, s[16:19], s38 offen offset:64
    v_cvt_pk_bf16_f32 v18, v193, v197
    buffer_store_dword v18, v10, s[16:19], s38 offen offset:2048
    v_cvt_pk_bf16_f32 v19, v201, v205
    buffer_store_dword v19, v10, s[16:19], s38 offen offset:2112
    s_mov_b32 s38, 135168
    v_cvt_pk_bf16_f32 v20, v194, v198
    buffer_store_dword v20, v10, s[16:19], s38 offen offset:0
    v_cvt_pk_bf16_f32 v21, v202, v206
    buffer_store_dword v21, v10, s[16:19], s38 offen offset:64
    v_cvt_pk_bf16_f32 v22, v195, v199
    buffer_store_dword v22, v10, s[16:19], s38 offen offset:2048
    v_cvt_pk_bf16_f32 v23, v203, v207
    buffer_store_dword v23, v10, s[16:19], s38 offen offset:2112
    s_mov_b32 s38, 163840
    v_cvt_pk_bf16_f32 v16, v208, v212
    buffer_store_dword v16, v10, s[16:19], s38 offen offset:0
    v_cvt_pk_bf16_f32 v17, v216, v220
    buffer_store_dword v17, v10, s[16:19], s38 offen offset:64
    v_cvt_pk_bf16_f32 v18, v209, v213
    buffer_store_dword v18, v10, s[16:19], s38 offen offset:2048
    v_cvt_pk_bf16_f32 v19, v217, v221
    buffer_store_dword v19, v10, s[16:19], s38 offen offset:2112
    s_mov_b32 s38, 167936
    v_cvt_pk_bf16_f32 v20, v210, v214
    buffer_store_dword v20, v10, s[16:19], s38 offen offset:0
    v_cvt_pk_bf16_f32 v21, v218, v222
    buffer_store_dword v21, v10, s[16:19], s38 offen offset:64
    v_cvt_pk_bf16_f32 v22, v211, v215
    buffer_store_dword v22, v10, s[16:19], s38 offen offset:2048
    v_cvt_pk_bf16_f32 v23, v219, v223
    buffer_store_dword v23, v10, s[16:19], s38 offen offset:2112
    s_endpgm
K2_MH1:
    s_mul_i32 s30, s27, 5120
    s_mov_b32 s32, s30
    s_add_u32 s31, s30, 4096
    s_mov_b32 s33, s31
    s_mov_b32 s34, 0x80008000
    s_mov_b32 s35, 0
    s_add_u32 m0, s35, s32
    s_nop 0
    buffer_load_dwordx4 v1, s[8:11], s30 offen lds
    buffer_load_dwordx4 v1, s[8:11], s30 offen offset:1024 lds
    buffer_load_dwordx4 v1, s[8:11], s30 offen offset:2048 lds
    buffer_load_dwordx4 v1, s[8:11], s30 offen offset:3072 lds
    s_add_u32 m0, s35, s33
    s_nop 0
    buffer_load_dwordx4 v1, s[8:11], s31 offen lds
    s_add_u32 s30, s30, 21376
    s_add_u32 s31, s31, 21376
    s_add_u32 s35, s35, 37888
    s_add_u32 m0, s35, s32
    s_nop 0
    buffer_load_dwordx4 v1, s[8:11], s30 offen lds
    buffer_load_dwordx4 v1, s[8:11], s30 offen offset:1024 lds
    buffer_load_dwordx4 v1, s[8:11], s30 offen offset:2048 lds
    buffer_load_dwordx4 v1, s[8:11], s30 offen offset:3072 lds
    s_add_u32 m0, s35, s33
    s_nop 0
    buffer_load_dwordx4 v1, s[8:11], s31 offen lds
    s_add_u32 s30, s30, 21376
    s_add_u32 s31, s31, 21376
    s_add_u32 s35, s35, 37888
    s_add_u32 m0, s35, s32
    s_nop 0
    buffer_load_dwordx4 v1, s[8:11], s30 offen lds
    buffer_load_dwordx4 v1, s[8:11], s30 offen offset:1024 lds
    buffer_load_dwordx4 v1, s[8:11], s30 offen offset:2048 lds
    buffer_load_dwordx4 v1, s[8:11], s30 offen offset:3072 lds
    s_add_u32 m0, s35, s33
    s_nop 0
    buffer_load_dwordx4 v1, s[8:11], s31 offen lds
    s_add_u32 s30, s30, 21376
    s_add_u32 s31, s31, 21376
    s_add_u32 s35, s35, 37888
    s_add_u32 m0, s35, s32
    s_nop 0
    buffer_load_dwordx4 v1, s[8:11], s30 offen lds
    buffer_load_dwordx4 v1, s[8:11], s30 offen offset:1024 lds
    buffer_load_dwordx4 v1, s[8:11], s30 offen offset:2048 lds
    buffer_load_dwordx4 v1, s[8:11], s30 offen offset:3072 lds
    s_add_u32 m0, s35, s33
    s_nop 0
    buffer_load_dwordx4 v1, s[8:11], s31 offen lds
    s_add_u32 s30, s30, 21376
    s_add_u32 s31, s31, 21376
    s_add_u32 s35, s35, 37888
    s_mov_b32 s35, 0
    s_mov_b32 s36, 37888
    s_mov_b32 s37, 0
    v_add_u32 v11, s35, v8
    v_add_u32 v13, s35, v9
    v_xor_b32 v12, 64, v11
    v_xor_b32 v14, 32, v13
    s_waitcnt vmcnt(15)
    s_barrier
    ds_read_b64_tr_b16 v[64:65], v13 offset:0
    ds_read_b64_tr_b16 v[66:67], v13 offset:2048
    ds_read_b64_tr_b16 v[68:69], v13 offset:256
    ds_read_b64_tr_b16 v[70:71], v13 offset:2304
    ds_read_b64_tr_b16 v[76:77], v14 offset:0
    ds_read_b64_tr_b16 v[78:79], v14 offset:2048
    ds_read_b64_tr_b16 v[80:81], v14 offset:256
    ds_read_b64_tr_b16 v[82:83], v14 offset:2304
    ds_read_b128 v[16:19], v11 offset:12288
    ds_read_b128 v[20:23], v12 offset:12288
    ds_read_b128 v[24:27], v11 offset:14336
    ds_read_b128 v[28:31], v12 offset:14336
    s_waitcnt lgkmcnt(4)
    v_xor_b32 v72, s34, v68
    v_xor_b32 v73, s34, v69
    v_xor_b32 v74, s34, v70
    v_xor_b32 v75, s34, v71
    v_xor_b32 v84, s34, v80
    v_xor_b32 v85, s34, v81
    v_xor_b32 v86, s34, v82
    v_xor_b32 v87, s34, v83
    ds_read_b128 v[32:35], v11 offset:16384
    ds_read_b128 v[36:39], v12 offset:16384
    ds_read_b128 v[40:43], v11 offset:18432
    ds_read_b128 v[44:47], v12 offset:18432
K2M1_LOOP:
    s_waitcnt lgkmcnt(4)
    v_mfma_f32_16x16x32_bf16 v[128:131], v[16:19], v[64:67], v[128:131]
    ds_read_b128 v[48:51], v11 offset:20480
    v_mfma_f32_16x16x32_bf16 v[132:135], v[16:19], v[68:71], v[132:135]
    ds_read_b128 v[52:55], v12 offset:20480
    v_mfma_f32_16x16x32_bf16 v[136:139], v[16:19], v[76:79], v[136:139]
    v_mfma_f32_16x16x32_bf16 v[140:143], v[16:19], v[80:83], v[140:143]
    v_mfma_f32_16x16x32_bf16 v[128:131], v[20:23], v[72:75], v[128:131]
    v_mfma_f32_16x16x32_bf16 v[132:135], v[20:23], v[64:67], v[132:135]
    v_mfma_f32_16x16x32_bf16 v[136:139], v[20:23], v[84:87], v[136:139]
    v_mfma_f32_16x16x32_bf16 v[140:143], v[20:23], v[76:79], v[140:143]
    v_mfma_f32_16x16x32_bf16 v[144:147], v[24:27], v[64:67], v[144:147]
    v_mfma_f32_16x16x32_bf16 v[148:151], v[24:27], v[68:71], v[148:151]
    v_mfma_f32_16x16x32_bf16 v[152:155], v[24:27], v[76:79], v[152:155]
    v_mfma_f32_16x16x32_bf16 v[156:159], v[24:27], v[80:83], v[156:159]
    v_mfma_f32_16x16x32_bf16 v[144:147], v[28:31], v[72:75], v[144:147]
    v_mfma_f32_16x16x32_bf16 v[148:151], v[28:31], v[64:67], v[148:151]
    v_mfma_f32_16x16x32_bf16 v[152:155], v[28:31], v[84:87], v[152:155]
    v_mfma_f32_16x16x32_bf16 v[156:159], v[28:31], v[76:79], v[156:159]
    s_waitcnt vmcnt(10) lgkmcnt(0)
    s_barrier
    v_mfma_f32_16x16x32_bf16 v[160:163], v[32:35], v[64:67], v[160:163]
    v_add_u32 v11, s36, v8
    v_add_u32 v13, s36, v9
    v_mfma_f32_16x16x32_bf16 v[164:167], v[32:35], v[68:71], v[164:167]
    v_xor_b32 v12, 64, v11
    v_xor_b32 v14, 32, v13
    v_mfma_f32_16x16x32_bf16 v[168:171], v[32:35], v[76:79], v[168:171]
    ds_read_b64_tr_b16 v[88:89], v13 offset:0
    ds_read_b64_tr_b16 v[90:91], v13 offset:2048
    v_mfma_f32_16x16x32_bf16 v[172:175], v[32:35], v[80:83], v[172:175]
    ds_read_b64_tr_b16 v[92:93], v13 offset:256
    ds_read_b64_tr_b16 v[94:95], v13 offset:2304
    v_mfma_f32_16x16x32_bf16 v[160:163], v[36:39], v[72:75], v[160:163]
    ds_read_b64_tr_b16 v[100:101], v14 offset:0
    ds_read_b64_tr_b16 v[102:103], v14 offset:2048
    v_mfma_f32_16x16x32_bf16 v[164:167], v[36:39], v[64:67], v[164:167]
    ds_read_b64_tr_b16 v[104:105], v14 offset:256
    ds_read_b64_tr_b16 v[106:107], v14 offset:2304
    v_mfma_f32_16x16x32_bf16 v[168:171], v[36:39], v[84:87], v[168:171]
    ds_read_b128 v[16:19], v11 offset:12288
    ds_read_b128 v[20:23], v12 offset:12288
    v_mfma_f32_16x16x32_bf16 v[172:175], v[36:39], v[76:79], v[172:175]
    ds_read_b128 v[24:27], v11 offset:14336
    ds_read_b128 v[28:31], v12 offset:14336
    v_mfma_f32_16x16x32_bf16 v[176:179], v[40:43], v[64:67], v[176:179]
    ds_read_b128 v[32:35], v11 offset:16384
    ds_read_b128 v[36:39], v12 offset:16384
    v_mfma_f32_16x16x32_bf16 v[180:183], v[40:43], v[68:71], v[180:183]
    s_add_u32 m0, s35, s32
    s_nop 0
    buffer_load_dwordx4 v1, s[8:11], s30 offen lds
    v_mfma_f32_16x16x32_bf16 v[184:187], v[40:43], v[76:79], v[184:187]
    buffer_load_dwordx4 v1, s[8:11], s30 offen offset:1024 lds
    v_mfma_f32_16x16x32_bf16 v[188:191], v[40:43], v[80:83], v[188:191]
    buffer_load_dwordx4 v1, s[8:11], s30 offen offset:2048 lds
    v_mfma_f32_16x16x32_bf16 v[176:179], v[44:47], v[72:75], v[176:179]
    buffer_load_dwordx4 v1, s[8:11], s30 offen offset:3072 lds
    v_mfma_f32_16x16x32_bf16 v[180:183], v[44:47], v[64:67], v[180:183]
    s_add_u32 m0, s35, s33
    s_nop 0
    buffer_load_dwordx4 v1, s[8:11], s31 offen lds
    v_mfma_f32_16x16x32_bf16 v[184:187], v[44:47], v[84:87], v[184:187]
    s_add_u32 s30, s30, 21376
    s_add_u32 s31, s31, 21376
    v_mfma_f32_16x16x32_bf16 v[188:191], v[44:47], v[76:79], v[188:191]
    v_mfma_f32_16x16x32_bf16 v[192:195], v[48:51], v[64:67], v[192:195]
    s_waitcnt lgkmcnt(6)
    v_xor_b32 v96, s34, v92
    v_xor_b32 v97, s34, v93
    v_mfma_f32_16x16x32_bf16 v[196:199], v[48:51], v[68:71], v[196:199]
    v_xor_b32 v98, s34, v94
    v_xor_b32 v99, s34, v95
    v_mfma_f32_16x16x32_bf16 v[200:203], v[48:51], v[76:79], v[200:203]
    v_xor_b32 v108, s34, v104
    v_xor_b32 v109, s34, v105
    v_mfma_f32_16x16x32_bf16 v[204:207], v[48:51], v[80:83], v[204:207]
    v_xor_b32 v110, s34, v106
    v_xor_b32 v111, s34, v107
    v_mfma_f32_16x16x32_bf16 v[192:195], v[52:55], v[72:75], v[192:195]
    ds_read_b128 v[40:43], v11 offset:18432
    ds_read_b128 v[44:47], v12 offset:18432
    v_mfma_f32_16x16x32_bf16 v[196:199], v[52:55], v[64:67], v[196:199]
    v_mfma_f32_16x16x32_bf16 v[200:203], v[52:55], v[84:87], v[200:203]
    v_mfma_f32_16x16x32_bf16 v[204:207], v[52:55], v[76:79], v[204:207]
    s_mov_b32 s35, s36
    s_add_u32 s36, s36, 37888
    s_cmp_eq_u32 s36, 151552
    s_cselect_b32 s36, 0, s36
    s_waitcnt lgkmcnt(4)
    v_mfma_f32_16x16x32_bf16 v[128:131], v[16:19], v[88:91], v[128:131]
    ds_read_b128 v[48:51], v11 offset:20480
    v_mfma_f32_16x16x32_bf16 v[132:135], v[16:19], v[92:95], v[132:135]
    ds_read_b128 v[52:55], v12 offset:20480
    v_mfma_f32_16x16x32_bf16 v[136:139], v[16:19], v[100:103], v[136:139]
    v_mfma_f32_16x16x32_bf16 v[140:143], v[16:19], v[104:107], v[140:143]
    v_mfma_f32_16x16x32_bf16 v[128:131], v[20:23], v[96:99], v[128:131]
    v_mfma_f32_16x16x32_bf16 v[132:135], v[20:23], v[88:91], v[132:135]
    v_mfma_f32_16x16x32_bf16 v[136:139], v[20:23], v[108:111], v[136:139]
    v_mfma_f32_16x16x32_bf16 v[140:143], v[20:23], v[100:103], v[140:143]
    v_mfma_f32_16x16x32_bf16 v[144:147], v[24:27], v[88:91], v[144:147]
    v_mfma_f32_16x16x32_bf16 v[148:151], v[24:27], v[92:95], v[148:151]
    v_mfma_f32_16x16x32_bf16 v[152:155], v[24:27], v[100:103], v[152:155]
    v_mfma_f32_16x16x32_bf16 v[156:159], v[24:27], v[104:107], v[156:159]
    v_mfma_f32_16x16x32_bf16 v[144:147], v[28:31], v[96:99], v[144:147]
    v_mfma_f32_16x16x32_bf16 v[148:151], v[28:31], v[88:91], v[148:151]
    v_mfma_f32_16x16x32_bf16 v[152:155], v[28:31], v[108:111], v[152:155]
    v_mfma_f32_16x16x32_bf16 v[156:159], v[28:31], v[100:103], v[156:159]
    s_waitcnt vmcnt(10) lgkmcnt(0)
    s_barrier
    v_mfma_f32_16x16x32_bf16 v[160:163], v[32:35], v[88:91], v[160:163]
    v_add_u32 v11, s36, v8
    v_add_u32 v13, s36, v9
    v_mfma_f32_16x16x32_bf16 v[164:167], v[32:35], v[92:95], v[164:167]
    v_xor_b32 v12, 64, v11
    v_xor_b32 v14, 32, v13
    v_mfma_f32_16x16x32_bf16 v[168:171], v[32:35], v[100:103], v[168:171]
    ds_read_b64_tr_b16 v[64:65], v13 offset:0
    ds_read_b64_tr_b16 v[66:67], v13 offset:2048
    v_mfma_f32_16x16x32_bf16 v[172:175], v[32:35], v[104:107], v[172:175]
    ds_read_b64_tr_b16 v[68:69], v13 offset:256
    ds_read_b64_tr_b16 v[70:71], v13 offset:2304
    v_mfma_f32_16x16x32_bf16 v[160:163], v[36:39], v[96:99], v[160:163]
    ds_read_b64_tr_b16 v[76:77], v14 offset:0
    ds_read_b64_tr_b16 v[78:79], v14 offset:2048
    v_mfma_f32_16x16x32_bf16 v[164:167], v[36:39], v[88:91], v[164:167]
    ds_read_b64_tr_b16 v[80:81], v14 offset:256
    ds_read_b64_tr_b16 v[82:83], v14 offset:2304
    v_mfma_f32_16x16x32_bf16 v[168:171], v[36:39], v[108:111], v[168:171]
    ds_read_b128 v[16:19], v11 offset:12288
    ds_read_b128 v[20:23], v12 offset:12288
    v_mfma_f32_16x16x32_bf16 v[172:175], v[36:39], v[100:103], v[172:175]
    ds_read_b128 v[24:27], v11 offset:14336
    ds_read_b128 v[28:31], v12 offset:14336
    v_mfma_f32_16x16x32_bf16 v[176:179], v[40:43], v[88:91], v[176:179]
    ds_read_b128 v[32:35], v11 offset:16384
    ds_read_b128 v[36:39], v12 offset:16384
    v_mfma_f32_16x16x32_bf16 v[180:183], v[40:43], v[92:95], v[180:183]
    s_add_u32 m0, s35, s32
    s_nop 0
    buffer_load_dwordx4 v1, s[8:11], s30 offen lds
    v_mfma_f32_16x16x32_bf16 v[184:187], v[40:43], v[100:103], v[184:187]
    buffer_load_dwordx4 v1, s[8:11], s30 offen offset:1024 lds
    v_mfma_f32_16x16x32_bf16 v[188:191], v[40:43], v[104:107], v[188:191]
    buffer_load_dwordx4 v1, s[8:11], s30 offen offset:2048 lds
    v_mfma_f32_16x16x32_bf16 v[176:179], v[44:47], v[96:99], v[176:179]
    buffer_load_dwordx4 v1, s[8:11], s30 offen offset:3072 lds
    v_mfma_f32_16x16x32_bf16 v[180:183], v[44:47], v[88:91], v[180:183]
    s_add_u32 m0, s35, s33
    s_nop 0
    buffer_load_dwordx4 v1, s[8:11], s31 offen lds
    v_mfma_f32_16x16x32_bf16 v[184:187], v[44:47], v[108:111], v[184:187]
    s_add_u32 s30, s30, 21376
    s_add_u32 s31, s31, 21376
    v_mfma_f32_16x16x32_bf16 v[188:191], v[44:47], v[100:103], v[188:191]
    v_mfma_f32_16x16x32_bf16 v[192:195], v[48:51], v[88:91], v[192:195]
    s_waitcnt lgkmcnt(6)
    v_xor_b32 v72, s34, v68
    v_xor_b32 v73, s34, v69
    v_mfma_f32_16x16x32_bf16 v[196:199], v[48:51], v[92:95], v[196:199]
    v_xor_b32 v74, s34, v70
    v_xor_b32 v75, s34, v71
    v_mfma_f32_16x16x32_bf16 v[200:203], v[48:51], v[100:103], v[200:203]
    v_xor_b32 v84, s34, v80
    v_xor_b32 v85, s34, v81
    v_mfma_f32_16x16x32_bf16 v[204:207], v[48:51], v[104:107], v[204:207]
    v_xor_b32 v86, s34, v82
    v_xor_b32 v87, s34, v83
    v_mfma_f32_16x16x32_bf16 v[192:195], v[52:55], v[96:99], v[192:195]
    ds_read_b128 v[40:43], v11 offset:18432
    ds_read_b128 v[44:47], v12 offset:18432
    v_mfma_f32_16x16x32_bf16 v[196:199], v[52:55], v[88:91], v[196:199]
    v_mfma_f32_16x16x32_bf16 v[200:203], v[52:55], v[108:111], v[200:203]
    v_mfma_f32_16x16x32_bf16 v[204:207], v[52:55], v[100:103], v[204:207]
    s_mov_b32 s35, s36
    s_add_u32 s36, s36, 37888
    s_cmp_eq_u32 s36, 151552
    s_cselect_b32 s36, 0, s36
    s_add_u32 s37, s37, 1
    s_cmp_lt_u32 s37, 16
    s_cbranch_scc1 K2M1_LOOP
    s_nop 7
    s_nop 1
    s_mov_b32 s38, 196608
    v_cvt_pk_bf16_f32 v16, v128, v132
    buffer_store_dword v16, v10, s[16:19], s38 offen offset:0
    v_cvt_pk_bf16_f32 v17, v136, v140
    buffer_store_dword v17, v10, s[16:19], s38 offen offset:64
    v_cvt_pk_bf16_f32 v18, v129, v133
    buffer_store_dword v18, v10, s[16:19], s38 offen offset:2048
    v_cvt_pk_bf16_f32 v19, v137, v141
    buffer_store_dword v19, v10, s[16:19], s38 offen offset:2112
    s_mov_b32 s38, 200704
    v_cvt_pk_bf16_f32 v20, v130, v134
    buffer_store_dword v20, v10, s[16:19], s38 offen offset:0
    v_cvt_pk_bf16_f32 v21, v138, v142
    buffer_store_dword v21, v10, s[16:19], s38 offen offset:64
    v_cvt_pk_bf16_f32 v22, v131, v135
    buffer_store_dword v22, v10, s[16:19], s38 offen offset:2048
    v_cvt_pk_bf16_f32 v23, v139, v143
    buffer_store_dword v23, v10, s[16:19], s38 offen offset:2112
    s_mov_b32 s38, 229376
    v_cvt_pk_bf16_f32 v16, v144, v148
    buffer_store_dword v16, v10, s[16:19], s38 offen offset:0
    v_cvt_pk_bf16_f32 v17, v152, v156
    buffer_store_dword v17, v10, s[16:19], s38 offen offset:64
    v_cvt_pk_bf16_f32 v18, v145, v149
    buffer_store_dword v18, v10, s[16:19], s38 offen offset:2048
    v_cvt_pk_bf16_f32 v19, v153, v157
    buffer_store_dword v19, v10, s[16:19], s38 offen offset:2112
    s_mov_b32 s38, 233472
    v_cvt_pk_bf16_f32 v20, v146, v150
    buffer_store_dword v20, v10, s[16:19], s38 offen offset:0
    v_cvt_pk_bf16_f32 v21, v154, v158
    buffer_store_dword v21, v10, s[16:19], s38 offen offset:64
    v_cvt_pk_bf16_f32 v22, v147, v151
    buffer_store_dword v22, v10, s[16:19], s38 offen offset:2048
    v_cvt_pk_bf16_f32 v23, v155, v159
    buffer_store_dword v23, v10, s[16:19], s38 offen offset:2112
    s_mov_b32 s38, 262144
    v_cvt_pk_bf16_f32 v16, v160, v164
    buffer_store_dword v16, v10, s[16:19], s38 offen offset:0
    v_cvt_pk_bf16_f32 v17, v168, v172
    buffer_store_dword v17, v10, s[16:19], s38 offen offset:64
    v_cvt_pk_bf16_f32 v18, v161, v165
    buffer_store_dword v18, v10, s[16:19], s38 offen offset:2048
    v_cvt_pk_bf16_f32 v19, v169, v173
    buffer_store_dword v19, v10, s[16:19], s38 offen offset:2112
    s_mov_b32 s38, 266240
    v_cvt_pk_bf16_f32 v20, v162, v166
    buffer_store_dword v20, v10, s[16:19], s38 offen offset:0
    v_cvt_pk_bf16_f32 v21, v170, v174
    buffer_store_dword v21, v10, s[16:19], s38 offen offset:64
    v_cvt_pk_bf16_f32 v22, v163, v167
    buffer_store_dword v22, v10, s[16:19], s38 offen offset:2048
    v_cvt_pk_bf16_f32 v23, v171, v175
    buffer_store_dword v23, v10, s[16:19], s38 offen offset:2112
    s_mov_b32 s38, 294912
    v_cvt_pk_bf16_f32 v16, v176, v180
    buffer_store_dword v16, v10, s[16:19], s38 offen offset:0
    v_cvt_pk_bf16_f32 v17, v184, v188
    buffer_store_dword v17, v10, s[16:19], s38 offen offset:64
    v_cvt_pk_bf16_f32 v18, v177, v181
    buffer_store_dword v18, v10, s[16:19], s38 offen offset:2048
    v_cvt_pk_bf16_f32 v19, v185, v189
    buffer_store_dword v19, v10, s[16:19], s38 offen offset:2112
    s_mov_b32 s38, 299008
    v_cvt_pk_bf16_f32 v20, v178, v182
    buffer_store_dword v20, v10, s[16:19], s38 offen offset:0
    v_cvt_pk_bf16_f32 v21, v186, v190
    buffer_store_dword v21, v10, s[16:19], s38 offen offset:64
    v_cvt_pk_bf16_f32 v22, v179, v183
    buffer_store_dword v22, v10, s[16:19], s38 offen offset:2048
    v_cvt_pk_bf16_f32 v23, v187, v191
    buffer_store_dword v23, v10, s[16:19], s38 offen offset:2112
    s_mov_b32 s38, 327680
    v_cvt_pk_bf16_f32 v16, v192, v196
    buffer_store_dword v16, v10, s[16:19], s38 offen offset:0
    v_cvt_pk_bf16_f32 v17, v200, v204
    buffer_store_dword v17, v10, s[16:19], s38 offen offset:64
    v_cvt_pk_bf16_f32 v18, v193, v197
    buffer_store_dword v18, v10, s[16:19], s38 offen offset:2048
    v_cvt_pk_bf16_f32 v19, v201, v205
    buffer_store_dword v19, v10, s[16:19], s38 offen offset:2112
    s_mov_b32 s38, 331776
    v_cvt_pk_bf16_f32 v20, v194, v198
    buffer_store_dword v20, v10, s[16:19], s38 offen offset:0
    v_cvt_pk_bf16_f32 v21, v202, v206
    buffer_store_dword v21, v10, s[16:19], s38 offen offset:64
    v_cvt_pk_bf16_f32 v22, v195, v199
    buffer_store_dword v22, v10, s[16:19], s38 offen offset:2048
    v_cvt_pk_bf16_f32 v23, v203, v207
    buffer_store_dword v23, v10, s[16:19], s38 offen offset:2112
    s_endpgm
K2_END:
    s_endpgm
.p2align 8
.type k3_stats_kernel,@function
k3_stats_kernel:
    s_cmp_ge_u32 s2, 256
    s_cbranch_scc1 K3_END
    s_load_dwordx2 s[4:5], s[0:1], 48
    v_lshrrev_b32 v1, 6, v0
    v_and_b32 v2, 63, v0
    v_readfirstlane_b32 s3, v1
    s_and_b32 s6, s2, 7
    s_lshr_b32 s7, s2, 3
    s_lshr_b32 s20, s6, 2
    s_and_b32 s21, s6, 3
    s_mul_i32 s22, s7, 6
    s_mul_i32 s23, s7, 5
    s_add_u32 s23, s23, 7
    s_cmp_lt_u32 s7, 7
    s_cselect_b32 s22, s22, s23
    s_cselect_b32 s23, 6, 5
    s_add_u32 s22, s22, s3
    v_and_b32 v3, 15, v2
    v_lshrrev_b32 v4, 4, v2
    v_lshlrev_b32 v5, 4, v2
    s_waitcnt lgkmcnt(0)
    s_add_u32 s8, s4, 118489088
    s_addc_u32 s9, s5, 0
    s_and_b32 s9, s9, 0xffff
    s_mov_b32 s10, 21889024
    s_mov_b32 s11, 0x00020000
    s_add_u32 s12, s4, 143654912
    s_addc_u32 s13, s5, 0
    s_and_b32 s13, s13, 0xffff
    s_mov_b32 s14, 262144
    s_mov_b32 s15, 0x00020000
    s_mov_b32 s24, 2736128
    v_mul_lo_u32 v6, v4, s24
    v_lshl_add_u32 v6, v3, 4, v6
    s_mul_i32 s25, s20, 167
    s_add_u32 s25, s25, s22
    s_lshl_b32 s25, s25, 11
    s_lshl_b32 s24, s21, 9
    s_add_u32 s25, s25, s24
    s_cmp_lt_u32 s3, s23
    s_cbranch_scc0 K3_NOLOAD
    buffer_load_dwordx4 v[16:19], v6, s[8:11], s25 offen offset:0
    buffer_load_dwordx4 v[32:35], v6, s[8:11], s25 offen offset:256
    s_add_u32 s25, s25, 684032
    buffer_load_dwordx4 v[20:23], v6, s[8:11], s25 offen offset:0
    buffer_load_dwordx4 v[36:39], v6, s[8:11], s25 offen offset:256
    s_add_u32 s25, s25, 684032
    buffer_load_dwordx4 v[24:27], v6, s[8:11], s25 offen offset:0
    buffer_load_dwordx4 v[40:43], v6, s[8:11], s25 offen offset:256
    s_add_u32 s25, s25, 684032
    buffer_load_dwordx4 v[28:31], v6, s[8:11], s25 offen offset:0
    buffer_load_dwordx4 v[44:47], v6, s[8:11], s25 offen offset:256
    s_add_u32 s25, s25, 8892416
    buffer_load_dwordx4 v[48:51], v6, s[8:11], s25 offen offset:0
    buffer_load_dwordx4 v[64:67], v6, s[8:11], s25 offen offset:256
    s_add_u32 s25, s25, 684032
    buffer_load_dwordx4 v[52:55], v6, s[8:11], s25 offen offset:0
    buffer_load_dwordx4 v[68:71], v6, s[8:11], s25 offen offset:256
    s_add_u32 s25, s25, 684032
    buffer_load_dwordx4 v[56:59], v6, s[8:11], s25 offen offset:0
    buffer_load_dwordx4 v[72:75], v6, s[8:11], s25 offen offset:256
    s_add_u32 s25, s25, 684032
    buffer_load_dwordx4 v[60:63], v6, s[8:11], s25 offen offset:0
    buffer_load_dwordx4 v[76:79], v6, s[8:11], s25 offen offset:256
K3_NOLOAD:
    s_lshr_b32 s28, s3, 1
    s_and_b32 s29, s3, 1
    s_lshl_b32 s30, s28, 4
    v_add_u32 v8, s30, v3
    s_lshl_b32 s30, s29, 5
    s_add_u32 s30, s30, 1
    v_lshlrev_b32 v9, 3, v4
    v_add_u32 v9, s30, v9
    v_mul_u32_u24 v9, v8, v9
    v_lshlrev_b32 v8, 1, v8
    v_mad_u32_u24 v224, v8, 0, v9
    v_mad_u32_u24 v225, v8, 0, v9
    v_add_u32 v225, 32, v225
    v_mad_u32_u24 v226, v8, 1, v9
    v_mad_u32_u24 v227, v8, 1, v9
    v_add_u32 v227, 32, v227
    v_mad_u32_u24 v228, v8, 2, v9
    v_mad_u32_u24 v229, v8, 2, v9
    v_add_u32 v229, 32, v229
    v_mad_u32_u24 v230, v8, 3, v9
    v_mad_u32_u24 v231, v8, 3, v9
    v_add_u32 v231, 32, v231
    v_and_b32 v224, 127, v224
    v_and_b32 v225, 127, v225
    v_and_b32 v226, 127, v226
    v_and_b32 v227, 127, v227
    v_and_b32 v228, 127, v228
    v_and_b32 v229, 127, v229
    v_and_b32 v230, 127, v230
    v_and_b32 v231, 127, v231
    v_cvt_f32_u32 v224, v224
    v_cvt_f32_u32 v225, v225
    v_cvt_f32_u32 v226, v226
    v_cvt_f32_u32 v227, v227
    v_cvt_f32_u32 v228, v228
    v_cvt_f32_u32 v229, v229
    v_cvt_f32_u32 v230, v230
    v_cvt_f32_u32 v231, v231
    v_mul_f32 v224, 0x3c000000, v224
    v_mul_f32 v225, 0x3c000000, v225
    v_mul_f32 v226, 0x3c000000, v226
    v_mul_f32 v227, 0x3c000000, v227
    v_mul_f32 v228, 0x3c000000, v228
    v_mul_f32 v229, 0x3c000000, v229
    v_mul_f32 v230, 0x3c000000, v230
    v_mul_f32 v231, 0x3c000000, v231
    v_cos_f32 v224, v224
    v_cos_f32 v225, v225
    v_cos_f32 v226, v226
    v_cos_f32 v227, v227
    v_cos_f32 v228, v228
    v_cos_f32 v229, v229
    v_cos_f32 v230, v230
    v_cos_f32 v231, v231
    s_nop 0
    v_mul_f32 v224, 0x3d000000, v224
    v_mul_f32 v225, 0x3d000000, v225
    v_mul_f32 v226, 0x3d000000, v226
    v_mul_f32 v227, 0x3d000000, v227
    v_mul_f32 v228, 0x3d000000, v228
    v_mul_f32 v229, 0x3d000000, v229
    v_mul_f32 v230, 0x3d000000, v230
    v_mul_f32 v231, 0x3d000000, v231
    v_cvt_pk_bf16_f32 v232, v224, v225
    v_cvt_pk_bf16_f32 v233, v226, v227
    v_cvt_pk_bf16_f32 v234, v228, v229
    v_cvt_pk_bf16_f32 v235, v230, v231
    v_lshlrev_b32 v240, 16, v232
    v_and_b32 v241, 0xffff0000, v232
    v_sub_f32 v224, v224, v240
    v_sub_f32 v225, v225, v241
    v_lshlrev_b32 v240, 16, v233
    v_and_b32 v241, 0xffff0000, v233
    v_sub_f32 v226, v226, v240
    v_sub_f32 v227, v227, v241
    v_lshlrev_b32 v240, 16, v234
    v_and_b32 v241, 0xffff0000, v234
    v_sub_f32 v228, v228, v240
    v_sub_f32 v229, v229, v241
    v_lshlrev_b32 v240, 16, v235
    v_and_b32 v241, 0xffff0000, v235
    v_sub_f32 v230, v230, v240
    v_sub_f32 v231, v231, v241
    v_cvt_pk_bf16_f32 v236, v224, v225
    v_cvt_pk_bf16_f32 v237, v226, v227
    v_cvt_pk_bf16_f32 v238, v228, v229
    v_cvt_pk_bf16_f32 v239, v230, v231
    s_lshl_b32 s30, s3, 11
    v_add_u32 v10, s30, v5
    ds_write_b128 v10, v[232:235]
    ds_write_b128 v10, v[236:239] offset:1024
    s_waitcnt lgkmcnt(0)
    s_barrier
    s_cmp_lt_u32 s3, s23
    s_cbranch_scc0 K3_IDLE
    ds_read_b128 v[80:83], v5 offset:0
    ds_read_b128 v[84:87], v5 offset:1024
    ds_read_b128 v[88:91], v5 offset:2048
    ds_read_b128 v[92:95], v5 offset:3072
    ds_read_b128 v[96:99], v5 offset:4096
    ds_read_b128 v[100:103], v5 offset:5120
    ds_read_b128 v[104:107], v5 offset:6144
    ds_read_b128 v[108:111], v5 offset:7168
    ds_read_b128 v[112:115], v5 offset:8192
    ds_read_b128 v[116:119], v5 offset:9216
    ds_read_b128 v[120:123], v5 offset:10240
    ds_read_b128 v[124:127], v5 offset:11264
    s_waitcnt vmcnt(0)
    v_swap_b32 v17, v20
    v_swap_b32 v18, v24
    v_swap_b32 v19, v28
    v_swap_b32 v22, v25
    v_swap_b32 v23, v29
    v_swap_b32 v27, v30
    v_swap_b32 v33, v36
    v_swap_b32 v34, v40
    v_swap_b32 v35, v44
    v_swap_b32 v38, v41
    v_swap_b32 v39, v45
    v_swap_b32 v43, v46
    v_swap_b32 v49, v52
    v_swap_b32 v50, v56
    v_swap_b32 v51, v60
    v_swap_b32 v54, v57
    v_swap_b32 v55, v61
    v_swap_b32 v59, v62
    v_swap_b32 v65, v68
    v_swap_b32 v66, v72
    v_swap_b32 v67, v76
    v_swap_b32 v70, v73
    v_swap_b32 v71, v77
    v_swap_b32 v75, v78
    s_waitcnt lgkmcnt(0)
    s_mul_i32 s24, s22, 48
    s_sub_u32 s24, 7985, s24
    v_add_u32 v7, 0, v3
    v_cmp_gt_u32 vcc, s24, v7
    s_nop 1
    v_cndmask_b32 v80, 0, v80, vcc
    v_cndmask_b32 v81, 0, v81, vcc
    v_cndmask_b32 v82, 0, v82, vcc
    v_cndmask_b32 v83, 0, v83, vcc
    v_cndmask_b32 v84, 0, v84, vcc
    v_cndmask_b32 v85, 0, v85, vcc
    v_cndmask_b32 v86, 0, v86, vcc
    v_cndmask_b32 v87, 0, v87, vcc
    v_cndmask_b32 v88, 0, v88, vcc
    v_cndmask_b32 v89, 0, v89, vcc
    v_cndmask_b32 v90, 0, v90, vcc
    v_cndmask_b32 v91, 0, v91, vcc
    v_cndmask_b32 v92, 0, v92, vcc
    v_cndmask_b32 v93, 0, v93, vcc
    v_cndmask_b32 v94, 0, v94, vcc
    v_cndmask_b32 v95, 0, v95, vcc
    v_add_u32 v7, 16, v3
    v_cmp_gt_u32 vcc, s24, v7
    s_nop 1
    v_cndmask_b32 v96, 0, v96, vcc
    v_cndmask_b32 v97, 0, v97, vcc
    v_cndmask_b32 v98, 0, v98, vcc
    v_cndmask_b32 v99, 0, v99, vcc
    v_cndmask_b32 v100, 0, v100, vcc
    v_cndmask_b32 v101, 0, v101, vcc
    v_cndmask_b32 v102, 0, v102, vcc
    v_cndmask_b32 v103, 0, v103, vcc
    v_cndmask_b32 v104, 0, v104, vcc
    v_cndmask_b32 v105, 0, v105, vcc
    v_cndmask_b32 v106, 0, v106, vcc
    v_cndmask_b32 v107, 0, v107, vcc
    v_cndmask_b32 v108, 0, v108, vcc
    v_cndmask_b32 v109, 0, v109, vcc
    v_cndmask_b32 v110, 0, v110, vcc
    v_cndmask_b32 v111, 0, v111, vcc
    v_add_u32 v7, 32, v3
    v_cmp_gt_u32 vcc, s24, v7
    s_nop 1
    v_cndmask_b32 v112, 0, v112, vcc
    v_cndmask_b32 v113, 0, v113, vcc
    v_cndmask_b32 v114, 0, v114, vcc
    v_cndmask_b32 v115, 0, v115, vcc
    v_cndmask_b32 v116, 0, v116, vcc
    v_cndmask_b32 v117, 0, v117, vcc
    v_cndmask_b32 v118, 0, v118, vcc
    v_cndmask_b32 v119, 0, v119, vcc
    v_cndmask_b32 v120, 0, v120, vcc
    v_cndmask_b32 v121, 0, v121, vcc
    v_cndmask_b32 v122, 0, v122, vcc
    v_cndmask_b32 v123, 0, v123, vcc
    v_cndmask_b32 v124, 0, v124, vcc
    v_cndmask_b32 v125, 0, v125, vcc
    v_cndmask_b32 v126, 0, v126, vcc
    v_cndmask_b32 v127, 0, v127, vcc
    s_nop 1
    v_mfma_f32_16x16x32_bf16 v[128:131], v[80:83], v[16:19], 0
    v_mfma_f32_16x16x32_bf16 v[132:135], v[80:83], v[20:23], 0
    v_mfma_f32_16x16x32_bf16 v[136:139], v[80:83], v[24:27], 0
    v_mfma_f32_16x16x32_bf16 v[140:143], v[80:83], v[28:31], 0
    v_mfma_f32_16x16x32_bf16 v[144:147], v[80:83], v[32:35], 0
    v_mfma_f32_16x16x32_bf16 v[148:151], v[80:83], v[36:39], 0
    v_mfma_f32_16x16x32_bf16 v[152:155], v[80:83], v[40:43], 0
    v_mfma_f32_16x16x32_bf16 v[156:159], v[80:83], v[44:47], 0
    v_mfma_f32_16x16x32_bf16 v[128:131], v[84:87], v[16:19], v[128:131]
    v_mfma_f32_16x16x32_bf16 v[132:135], v[84:87], v[20:23], v[132:135]
    v_mfma_f32_16x16x32_bf16 v[136:139], v[84:87], v[24:27], v[136:139]
    v_mfma_f32_16x16x32_bf16 v[140:143], v[84:87], v[28:31], v[140:143]
    v_mfma_f32_16x16x32_bf16 v[144:147], v[84:87], v[32:35], v[144:147]
    v_mfma_f32_16x16x32_bf16 v[148:151], v[84:87], v[36:39], v[148:151]
    v_mfma_f32_16x16x32_bf16 v[152:155], v[84:87], v[40:43], v[152:155]
    v_mfma_f32_16x16x32_bf16 v[156:159], v[84:87], v[44:47], v[156:159]
    v_mfma_f32_16x16x32_bf16 v[128:131], v[88:91], v[48:51], v[128:131]
    v_mfma_f32_16x16x32_bf16 v[132:135], v[88:91], v[52:55], v[132:135]
    v_mfma_f32_16x16x32_bf16 v[136:139], v[88:91], v[56:59], v[136:139]
    v_mfma_f32_16x16x32_bf16 v[140:143], v[88:91], v[60:63], v[140:143]
    v_mfma_f32_16x16x32_bf16 v[144:147], v[88:91], v[64:67], v[144:147]
    v_mfma_f32_16x16x32_bf16 v[148:151], v[88:91], v[68:71], v[148:151]
    v_mfma_f32_16x16x32_bf16 v[152:155], v[88:91], v[72:75], v[152:155]
    v_mfma_f32_16x16x32_bf16 v[156:159], v[88:91], v[76:79], v[156:159]
    v_mfma_f32_16x16x32_bf16 v[128:131], v[92:95], v[48:51], v[128:131]
    v_mfma_f32_16x16x32_bf16 v[132:135], v[92:95], v[52:55], v[132:135]
    v_mfma_f32_16x16x32_bf16 v[136:139], v[92:95], v[56:59], v[136:139]
    v_mfma_f32_16x16x32_bf16 v[140:143], v[92:95], v[60:63], v[140:143]
    v_mfma_f32_16x16x32_bf16 v[144:147], v[92:95], v[64:67], v[144:147]
    v_mfma_f32_16x16x32_bf16 v[148:151], v[92:95], v[68:71], v[148:151]
    v_mfma_f32_16x16x32_bf16 v[152:155], v[92:95], v[72:75], v[152:155]
    v_mfma_f32_16x16x32_bf16 v[156:159], v[92:95], v[76:79], v[156:159]
    v_mfma_f32_16x16x32_bf16 v[160:163], v[96:99], v[16:19], 0
    v_mfma_f32_16x16x32_bf16 v[164:167], v[96:99], v[20:23], 0
    v_mfma_f32_16x16x32_bf16 v[168:171], v[96:99], v[24:27], 0
    v_mfma_f32_16x16x32_bf16 v[172:175], v[96:99], v[28:31], 0
    v_mfma_f32_16x16x32_bf16 v[176:179], v[96:99], v[32:35], 0
    v_mfma_f32_16x16x32_bf16 v[180:183], v[96:99], v[36:39], 0
    v_mfma_f32_16x16x32_bf16 v[184:187], v[96:99], v[40:43], 0
    v_mfma_f32_16x16x32_bf16 v[188:191], v[96:99], v[44:47], 0
    v_mfma_f32_16x16x32_bf16 v[160:163], v[100:103], v[16:19], v[160:163]
    v_mfma_f32_16x16x32_bf16 v[164:167], v[100:103], v[20:23], v[164:167]
    v_mfma_f32_16x16x32_bf16 v[168:171], v[100:103], v[24:27], v[168:171]
    v_mfma_f32_16x16x32_bf16 v[172:175], v[100:103], v[28:31], v[172:175]
    v_mfma_f32_16x16x32_bf16 v[176:179], v[100:103], v[32:35], v[176:179]
    v_mfma_f32_16x16x32_bf16 v[180:183], v[100:103], v[36:39], v[180:183]
    v_mfma_f32_16x16x32_bf16 v[184:187], v[100:103], v[40:43], v[184:187]
    v_mfma_f32_16x16x32_bf16 v[188:191], v[100:103], v[44:47], v[188:191]
    v_mfma_f32_16x16x32_bf16 v[160:163], v[104:107], v[48:51], v[160:163]
    v_mfma_f32_16x16x32_bf16 v[164:167], v[104:107], v[52:55], v[164:167]
    v_mfma_f32_16x16x32_bf16 v[168:171], v[104:107], v[56:59], v[168:171]
    v_mfma_f32_16x16x32_bf16 v[172:175], v[104:107], v[60:63], v[172:175]
    v_mfma_f32_16x16x32_bf16 v[176:179], v[104:107], v[64:67], v[176:179]
    v_mfma_f32_16x16x32_bf16 v[180:183], v[104:107], v[68:71], v[180:183]
    v_mfma_f32_16x16x32_bf16 v[184:187], v[104:107], v[72:75], v[184:187]
    v_mfma_f32_16x16x32_bf16 v[188:191], v[104:107], v[76:79], v[188:191]
    v_mfma_f32_16x16x32_bf16 v[160:163], v[108:111], v[48:51], v[160:163]
    v_mfma_f32_16x16x32_bf16 v[164:167], v[108:111], v[52:55], v[164:167]
    v_mfma_f32_16x16x32_bf16 v[168:171], v[108:111], v[56:59], v[168:171]
    v_mfma_f32_16x16x32_bf16 v[172:175], v[108:111], v[60:63], v[172:175]
    v_mfma_f32_16x16x32_bf16 v[176:179], v[108:111], v[64:67], v[176:179]
    v_mfma_f32_16x16x32_bf16 v[180:183], v[108:111], v[68:71], v[180:183]
    v_mfma_f32_16x16x32_bf16 v[184:187], v[108:111], v[72:75], v[184:187]
    v_mfma_f32_16x16x32_bf16 v[188:191], v[108:111], v[76:79], v[188:191]
    v_mfma_f32_16x16x32_bf16 v[192:195], v[112:115], v[16:19], 0
    v_mfma_f32_16x16x32_bf16 v[196:199], v[112:115], v[20:23], 0
    v_mfma_f32_16x16x32_bf16 v[200:203], v[112:115], v[24:27], 0
    v_mfma_f32_16x16x32_bf16 v[204:207], v[112:115], v[28:31], 0
    v_mfma_f32_16x16x32_bf16 v[208:211], v[112:115], v[32:35], 0
    v_mfma_f32_16x16x32_bf16 v[212:215], v[112:115], v[36:39], 0
    v_mfma_f32_16x16x32_bf16 v[216:219], v[112:115], v[40:43], 0
    v_mfma_f32_16x16x32_bf16 v[220:223], v[112:115], v[44:47], 0
    v_mfma_f32_16x16x32_bf16 v[192:195], v[116:119], v[16:19], v[192:195]
    v_mfma_f32_16x16x32_bf16 v[196:199], v[116:119], v[20:23], v[196:199]
    v_mfma_f32_16x16x32_bf16 v[200:203], v[116:119], v[24:27], v[200:203]
    v_mfma_f32_16x16x32_bf16 v[204:207], v[116:119], v[28:31], v[204:207]
    v_mfma_f32_16x16x32_bf16 v[208:211], v[116:119], v[32:35], v[208:211]
    v_mfma_f32_16x16x32_bf16 v[212:215], v[116:119], v[36:39], v[212:215]
    v_mfma_f32_16x16x32_bf16 v[216:219], v[116:119], v[40:43], v[216:219]
    v_mfma_f32_16x16x32_bf16 v[220:223], v[116:119], v[44:47], v[220:223]
    v_mfma_f32_16x16x32_bf16 v[192:195], v[120:123], v[48:51], v[192:195]
    v_mfma_f32_16x16x32_bf16 v[196:199], v[120:123], v[52:55], v[196:199]
    v_mfma_f32_16x16x32_bf16 v[200:203], v[120:123], v[56:59], v[200:203]
    v_mfma_f32_16x16x32_bf16 v[204:207], v[120:123], v[60:63], v[204:207]
    v_mfma_f32_16x16x32_bf16 v[208:211], v[120:123], v[64:67], v[208:211]
    v_mfma_f32_16x16x32_bf16 v[212:215], v[120:123], v[68:71], v[212:215]
    v_mfma_f32_16x16x32_bf16 v[216:219], v[120:123], v[72:75], v[216:219]
    v_mfma_f32_16x16x32_bf16 v[220:223], v[120:123], v[76:79], v[220:223]
    v_mfma_f32_16x16x32_bf16 v[192:195], v[124:127], v[48:51], v[192:195]
    v_mfma_f32_16x16x32_bf16 v[196:199], v[124:127], v[52:55], v[196:199]
    v_mfma_f32_16x16x32_bf16 v[200:203], v[124:127], v[56:59], v[200:203]
    v_mfma_f32_16x16x32_bf16 v[204:207], v[124:127], v[60:63], v[204:207]
    v_mfma_f32_16x16x32_bf16 v[208:211], v[124:127], v[64:67], v[208:211]
    v_mfma_f32_16x16x32_bf16 v[212:215], v[124:127], v[68:71], v[212:215]
    v_mfma_f32_16x16x32_bf16 v[216:219], v[124:127], v[72:75], v[216:219]
    v_mfma_f32_16x16x32_bf16 v[220:223], v[124:127], v[76:79], v[220:223]
    s_nop 7
    v_mov_b32 v16, v128
    v_mul_f32 v24, v128, v128
    v_add_f32 v16, v16, v129
    v_fmac_f32 v24, v129, v129
    v_add_f32 v16, v16, v130
    v_fmac_f32 v24, v130, v130
    v_add_f32 v16, v16, v131
    v_fmac_f32 v24, v131, v131
    v_add_f32 v16, v16, v160
    v_fmac_f32 v24, v160, v160
    v_add_f32 v16, v16, v161
    v_fmac_f32 v24, v161, v161
    v_add_f32 v16, v16, v162
    v_fmac_f32 v24, v162, v162
    v_add_f32 v16, v16, v163
    v_fmac_f32 v24, v163, v163
    v_add_f32 v16, v16, v192
    v_fmac_f32 v24, v192, v192
    v_add_f32 v16, v16, v193
    v_fmac_f32 v24, v193, v193
    v_add_f32 v16, v16, v194
    v_fmac_f32 v24, v194, v194
    v_add_f32 v16, v16, v195
    v_fmac_f32 v24, v195, v195
    v_mov_b32 v17, v132
    v_mul_f32 v25, v132, v132
    v_add_f32 v17, v17, v133
    v_fmac_f32 v25, v133, v133
    v_add_f32 v17, v17, v134
    v_fmac_f32 v25, v134, v134
    v_add_f32 v17, v17, v135
    v_fmac_f32 v25, v135, v135
    v_add_f32 v17, v17, v164
    v_fmac_f32 v25, v164, v164
    v_add_f32 v17, v17, v165
    v_fmac_f32 v25, v165, v165
    v_add_f32 v17, v17, v166
    v_fmac_f32 v25, v166, v166
    v_add_f32 v17, v17, v167
    v_fmac_f32 v25, v167, v167
    v_add_f32 v17, v17, v196
    v_fmac_f32 v25, v196, v196
    v_add_f32 v17, v17, v197
    v_fmac_f32 v25, v197, v197
    v_add_f32 v17, v17, v198
    v_fmac_f32 v25, v198, v198
    v_add_f32 v17, v17, v199
    v_fmac_f32 v25, v199, v199
    v_mov_b32 v18, v136
    v_mul_f32 v26, v136, v136
    v_add_f32 v18, v18, v137
    v_fmac_f32 v26, v137, v137
    v_add_f32 v18, v18, v138
    v_fmac_f32 v26, v138, v138
    v_add_f32 v18, v18, v139
    v_fmac_f32 v26, v139, v139
    v_add_f32 v18, v18, v168
    v_fmac_f32 v26, v168, v168
    v_add_f32 v18, v18, v169
    v_fmac_f32 v26, v169, v169
    v_add_f32 v18, v18, v170
    v_fmac_f32 v26, v170, v170
    v_add_f32 v18, v18, v171
    v_fmac_f32 v26, v171, v171
    v_add_f32 v18, v18, v200
    v_fmac_f32 v26, v200, v200
    v_add_f32 v18, v18, v201
    v_fmac_f32 v26, v201, v201
    v_add_f32 v18, v18, v202
    v_fmac_f32 v26, v202, v202
    v_add_f32 v18, v18, v203
    v_fmac_f32 v26, v203, v203
    v_mov_b32 v19, v140
    v_mul_f32 v27, v140, v140
    v_add_f32 v19, v19, v141
    v_fmac_f32 v27, v141, v141
    v_add_f32 v19, v19, v142
    v_fmac_f32 v27, v142, v142
    v_add_f32 v19, v19, v143
    v_fmac_f32 v27, v143, v143
    v_add_f32 v19, v19, v172
    v_fmac_f32 v27, v172, v172
    v_add_f32 v19, v19, v173
    v_fmac_f32 v27, v173, v173
    v_add_f32 v19, v19, v174
    v_fmac_f32 v27, v174, v174
    v_add_f32 v19, v19, v175
    v_fmac_f32 v27, v175, v175
    v_add_f32 v19, v19, v204
    v_fmac_f32 v27, v204, v204
    v_add_f32 v19, v19, v205
    v_fmac_f32 v27, v205, v205
    v_add_f32 v19, v19, v206
    v_fmac_f32 v27, v206, v206
    v_add_f32 v19, v19, v207
    v_fmac_f32 v27, v207, v207
    v_mov_b32 v20, v144
    v_mul_f32 v28, v144, v144
    v_add_f32 v20, v20, v145
    v_fmac_f32 v28, v145, v145
    v_add_f32 v20, v20, v146
    v_fmac_f32 v28, v146, v146
    v_add_f32 v20, v20, v147
    v_fmac_f32 v28, v147, v147
    v_add_f32 v20, v20, v176
    v_fmac_f32 v28, v176, v176
    v_add_f32 v20, v20, v177
    v_fmac_f32 v28, v177, v177
    v_add_f32 v20, v20, v178
    v_fmac_f32 v28, v178, v178
    v_add_f32 v20, v20, v179
    v_fmac_f32 v28, v179, v179
    v_add_f32 v20, v20, v208
    v_fmac_f32 v28, v208, v208
    v_add_f32 v20, v20, v209
    v_fmac_f32 v28, v209, v209
    v_add_f32 v20, v20, v210
    v_fmac_f32 v28, v210, v210
    v_add_f32 v20, v20, v211
    v_fmac_f32 v28, v211, v211
    v_mov_b32 v21, v148
    v_mul_f32 v29, v148, v148
    v_add_f32 v21, v21, v149
    v_fmac_f32 v29, v149, v149
    v_add_f32 v21, v21, v150
    v_fmac_f32 v29, v150, v150
    v_add_f32 v21, v21, v151
    v_fmac_f32 v29, v151, v151
    v_add_f32 v21, v21, v180
    v_fmac_f32 v29, v180, v180
    v_add_f32 v21, v21, v181
    v_fmac_f32 v29, v181, v181
    v_add_f32 v21, v21, v182
    v_fmac_f32 v29, v182, v182
    v_add_f32 v21, v21, v183
    v_fmac_f32 v29, v183, v183
    v_add_f32 v21, v21, v212
    v_fmac_f32 v29, v212, v212
    v_add_f32 v21, v21, v213
    v_fmac_f32 v29, v213, v213
    v_add_f32 v21, v21, v214
    v_fmac_f32 v29, v214, v214
    v_add_f32 v21, v21, v215
    v_fmac_f32 v29, v215, v215
    v_mov_b32 v22, v152
    v_mul_f32 v30, v152, v152
    v_add_f32 v22, v22, v153
    v_fmac_f32 v30, v153, v153
    v_add_f32 v22, v22, v154
    v_fmac_f32 v30, v154, v154
    v_add_f32 v22, v22, v155
    v_fmac_f32 v30, v155, v155
    v_add_f32 v22, v22, v184
    v_fmac_f32 v30, v184, v184
    v_add_f32 v22, v22, v185
    v_fmac_f32 v30, v185, v185
    v_add_f32 v22, v22, v186
    v_fmac_f32 v30, v186, v186
    v_add_f32 v22, v22, v187
    v_fmac_f32 v30, v187, v187
    v_add_f32 v22, v22, v216
    v_fmac_f32 v30, v216, v216
    v_add_f32 v22, v22, v217
    v_fmac_f32 v30, v217, v217
    v_add_f32 v22, v22, v218
    v_fmac_f32 v30, v218, v218
    v_add_f32 v22, v22, v219
    v_fmac_f32 v30, v219, v219
    v_mov_b32 v23, v156
    v_mul_f32 v31, v156, v156
    v_add_f32 v23, v23, v157
    v_fmac_f32 v31, v157, v157
    v_add_f32 v23, v23, v158
    v_fmac_f32 v31, v158, v158
    v_add_f32 v23, v23, v159
    v_fmac_f32 v31, v159, v159
    v_add_f32 v23, v23, v188
    v_fmac_f32 v31, v188, v188
    v_add_f32 v23, v23, v189
    v_fmac_f32 v31, v189, v189
    v_add_f32 v23, v23, v190
    v_fmac_f32 v31, v190, v190
    v_add_f32 v23, v23, v191
    v_fmac_f32 v31, v191, v191
    v_add_f32 v23, v23, v220
    v_fmac_f32 v31, v220, v220
    v_add_f32 v23, v23, v221
    v_fmac_f32 v31, v221, v221
    v_add_f32 v23, v23, v222
    v_fmac_f32 v31, v222, v222
    v_add_f32 v23, v23, v223
    v_fmac_f32 v31, v223, v223
    s_branch K3_WR
K3_IDLE:
    v_mov_b32 v16, 0
    v_mov_b32 v17, 0
    v_mov_b32 v18, 0
    v_mov_b32 v19, 0
    v_mov_b32 v20, 0
    v_mov_b32 v21, 0
    v_mov_b32 v22, 0
    v_mov_b32 v23, 0
    v_mov_b32 v24, 0
    v_mov_b32 v25, 0
    v_mov_b32 v26, 0
    v_mov_b32 v27, 0
    v_mov_b32 v28, 0
    v_mov_b32 v29, 0
    v_mov_b32 v30, 0
    v_mov_b32 v31, 0
K3_WR:
    s_lshl_b32 s24, s3, 12
    v_lshlrev_b32 v7, 10, v4
    v_lshl_add_u32 v7, v3, 4, v7
    v_add_u32 v7, s24, v7
    ds_write_b128 v7, v[16:19] offset:12288
    ds_write_b128 v7, v[20:23] offset:12544
    ds_write_b128 v7, v[24:27] offset:12800
    ds_write_b128 v7, v[28:31] offset:13056
    s_waitcnt lgkmcnt(0)
    s_barrier
    v_cmp_gt_u32 vcc, 256, v0
    s_and_saveexec_b64 s[26:27], vcc
    s_cbranch_execz K3_END
    v_lshlrev_b32 v7, 2, v0
    ds_read_b32 v32, v7 offset:12288
    ds_read_b32 v33, v7 offset:13312
    ds_read_b32 v34, v7 offset:14336
    ds_read_b32 v35, v7 offset:15360
    ds_read_b32 v36, v7 offset:16384
    ds_read_b32 v37, v7 offset:17408
    ds_read_b32 v38, v7 offset:18432
    ds_read_b32 v39, v7 offset:19456
    ds_read_b32 v40, v7 offset:20480
    ds_read_b32 v41, v7 offset:21504
    ds_read_b32 v42, v7 offset:22528
    ds_read_b32 v43, v7 offset:23552
    s_waitcnt lgkmcnt(0)
    ds_read_b32 v44, v7 offset:24576
    ds_read_b32 v45, v7 offset:25600
    ds_read_b32 v46, v7 offset:26624
    ds_read_b32 v47, v7 offset:27648
    ds_read_b32 v48, v7 offset:28672
    ds_read_b32 v49, v7 offset:29696
    ds_read_b32 v50, v7 offset:30720
    ds_read_b32 v51, v7 offset:31744
    ds_read_b32 v52, v7 offset:32768
    ds_read_b32 v53, v7 offset:33792
    ds_read_b32 v54, v7 offset:34816
    ds_read_b32 v55, v7 offset:35840
    s_waitcnt lgkmcnt(0)
    v_add_f32 v32, v32, v33
    v_add_f32 v32, v32, v34
    v_add_f32 v32, v32, v35
    v_add_f32 v32, v32, v36
    v_add_f32 v32, v32, v37
    v_add_f32 v32, v32, v38
    v_add_f32 v32, v32, v39
    v_add_f32 v32, v32, v40
    v_add_f32 v32, v32, v41
    v_add_f32 v32, v32, v42
    v_add_f32 v32, v32, v43
    v_add_f32 v32, v32, v44
    v_add_f32 v32, v32, v45
    v_add_f32 v32, v32, v46
    v_add_f32 v32, v32, v47
    v_add_f32 v32, v32, v48
    v_add_f32 v32, v32, v49
    v_add_f32 v32, v32, v50
    v_add_f32 v32, v32, v51
    v_add_f32 v32, v32, v52
    v_add_f32 v32, v32, v53
    v_add_f32 v32, v32, v54
    v_add_f32 v32, v32, v55
    s_lshl_b32 s24, s6, 5
    s_add_u32 s24, s24, s7
    s_lshl_b32 s24, s24, 10
    buffer_store_dword v32, v7, s[12:15], s24 offen
K3_END:
    s_endpgm
.p2align 8
.type k4_out_kernel,@function
k4_out_kernel:
    s_cmp_ge_u32 s2, 256
    s_cbranch_scc1 K4_END
    s_load_dwordx2 s[4:5], s[0:1], 48
    s_load_dwordx4 s[40:43], s[0:1], 16
    s_load_dwordx2 s[44:45], s[0:1], 32
    v_lshrrev_b32 v1, 6, v0
    v_and_b32 v2, 63, v0
    v_readfirstlane_b32 s3, v1
    s_and_b32 s6, s2, 7
    s_lshr_b32 s7, s2, 3
    s_lshr_b32 s20, s6, 2
    s_and_b32 s21, s6, 3
    s_mul_i32 s22, s7, 6
    s_mul_i32 s23, s7, 5
    s_add_u32 s23, s23, 7
    s_cmp_lt_u32 s7, 7
    s_cselect_b32 s22, s22, s23
    s_cselect_b32 s23, 6, 5
    s_add_u32 s22, s22, s3
    v_and_b32 v3, 15, v2
    v_lshrrev_b32 v4, 4, v2
    v_lshlrev_b32 v5, 4, v2
    s_waitcnt lgkmcnt(0)
    s_add_u32 s8, s4, 118489088
    s_addc_u32 s9, s5, 0
    s_and_b32 s9, s9, 0xffff
    s_mov_b32 s10, 21889024
    s_mov_b32 s11, 0x00020000
    s_add_u32 s12, s4, 143654912
    s_addc_u32 s13, s5, 0
    s_and_b32 s13, s13, 0xffff
    s_mov_b32 s14, 262144
    s_mov_b32 s15, 0x00020000
    s_mov_b32 s24, 2736128
    v_mul_lo_u32 v6, v4, s24
    v_lshl_add_u32 v6, v3, 4, v6
    s_mul_i32 s25, s20, 167
    s_add_u32 s25, s25, s22
    s_lshl_b32 s25, s25, 11
    s_lshl_b32 s24, s21, 9
    s_add_u32 s25, s25, s24
    s_cmp_lt_u32 s3, s23
    s_cbranch_scc0 K4_NOLOAD
    buffer_load_dwordx4 v[16:19], v6, s[8:11], s25 offen offset:0
    buffer_load_dwordx4 v[32:35], v6, s[8:11], s25 offen offset:256
    s_add_u32 s25, s25, 684032
    buffer_load_dwordx4 v[20:23], v6, s[8:11], s25 offen offset:0
    buffer_load_dwordx4 v[36:39], v6, s[8:11], s25 offen offset:256
    s_add_u32 s25, s25, 684032
    buffer_load_dwordx4 v[24:27], v6, s[8:11], s25 offen offset:0
    buffer_load_dwordx4 v[40:43], v6, s[8:11], s25 offen offset:256
    s_add_u32 s25, s25, 684032
    buffer_load_dwordx4 v[28:31], v6, s[8:11], s25 offen offset:0
    buffer_load_dwordx4 v[44:47], v6, s[8:11], s25 offen offset:256
    s_add_u32 s25, s25, 8892416
    buffer_load_dwordx4 v[48:51], v6, s[8:11], s25 offen offset:0
    buffer_load_dwordx4 v[64:67], v6, s[8:11], s25 offen offset:256
    s_add_u32 s25, s25, 684032
    buffer_load_dwordx4 v[52:55], v6, s[8:11], s25 offen offset:0
    buffer_load_dwordx4 v[68:71], v6, s[8:11], s25 offen offset:256
    s_add_u32 s25, s25, 684032
    buffer_load_dwordx4 v[56:59], v6, s[8:11], s25 offen offset:0
    buffer_load_dwordx4 v[72:75], v6, s[8:11], s25 offen offset:256
    s_add_u32 s25, s25, 684032
    buffer_load_dwordx4 v[60:63], v6, s[8:11], s25 offen offset:0
    buffer_load_dwordx4 v[76:79], v6, s[8:11], s25 offen offset:256
K4_NOLOAD:
    v_cmp_gt_u32 vcc, 256, v0
    s_and_saveexec_b64 s[26:27], vcc
    s_cbranch_execz K4_NOPART
    v_lshlrev_b32 v7, 2, v0
    s_lshl_b32 s24, s6, 15
    buffer_load_dword v128, v7, s[12:15], s24 offen offset:0
    buffer_load_dword v129, v7, s[12:15], s24 offen offset:1024
    buffer_load_dword v130, v7, s[12:15], s24 offen offset:2048
    buffer_load_dword v131, v7, s[12:15], s24 offen offset:3072
    s_add_u32 s24, s24, 4096
    buffer_load_dword v132, v7, s[12:15], s24 offen offset:0
    buffer_load_dword v133, v7, s[12:15], s24 offen offset:1024
    buffer_load_dword v134, v7, s[12:15], s24 offen offset:2048
    buffer_load_dword v135, v7, s[12:15], s24 offen offset:3072
    s_add_u32 s24, s24, 4096
    buffer_load_dword v136, v7, s[12:15], s24 offen offset:0
    buffer_load_dword v137, v7, s[12:15], s24 offen offset:1024
    buffer_load_dword v138, v7, s[12:15], s24 offen offset:2048
    buffer_load_dword v139, v7, s[12:15], s24 offen offset:3072
    s_add_u32 s24, s24, 4096
    buffer_load_dword v140, v7, s[12:15], s24 offen offset:0
    buffer_load_dword v141, v7, s[12:15], s24 offen offset:1024
    buffer_load_dword v142, v7, s[12:15], s24 offen offset:2048
    buffer_load_dword v143, v7, s[12:15], s24 offen offset:3072
    s_add_u32 s24, s24, 4096
    buffer_load_dword v144, v7, s[12:15], s24 offen offset:0
    buffer_load_dword v145, v7, s[12:15], s24 offen offset:1024
    buffer_load_dword v146, v7, s[12:15], s24 offen offset:2048
    buffer_load_dword v147, v7, s[12:15], s24 offen offset:3072
    s_add_u32 s24, s24, 4096
    buffer_load_dword v148, v7, s[12:15], s24 offen offset:0
    buffer_load_dword v149, v7, s[12:15], s24 offen offset:1024
    buffer_load_dword v150, v7, s[12:15], s24 offen offset:2048
    buffer_load_dword v151, v7, s[12:15], s24 offen offset:3072
    s_add_u32 s24, s24, 4096
    buffer_load_dword v152, v7, s[12:15], s24 offen offset:0
    buffer_load_dword v153, v7, s[12:15], s24 offen offset:1024
    buffer_load_dword v154, v7, s[12:15], s24 offen offset:2048
    buffer_load_dword v155, v7, s[12:15], s24 offen offset:3072
    s_add_u32 s24, s24, 4096
    buffer_load_dword v156, v7, s[12:15], s24 offen offset:0
    buffer_load_dword v157, v7, s[12:15], s24 offen offset:1024
    buffer_load_dword v158, v7, s[12:15], s24 offen offset:2048
    buffer_load_dword v159, v7, s[12:15], s24 offen offset:3072
K4_NOPART:
    s_mov_b64 exec, s[26:27]
    s_lshr_b32 s28, s3, 1
    s_and_b32 s29, s3, 1
    s_lshl_b32 s30, s28, 4
    v_add_u32 v8, s30, v3
    s_lshl_b32 s30, s29, 5
    s_add_u32 s30, s30, 1
    v_lshlrev_b32 v9, 3, v4
    v_add_u32 v9, s30, v9
    v_mul_u32_u24 v9, v8, v9
    v_lshlrev_b32 v8, 1, v8
    v_mad_u32_u24 v224, v8, 0, v9
    v_mad_u32_u24 v225, v8, 0, v9
    v_add_u32 v225, 32, v225
    v_mad_u32_u24 v226, v8, 1, v9
    v_mad_u32_u24 v227, v8, 1, v9
    v_add_u32 v227, 32, v227
    v_mad_u32_u24 v228, v8, 2, v9
    v_mad_u32_u24 v229, v8, 2, v9
    v_add_u32 v229, 32, v229
    v_mad_u32_u24 v230, v8, 3, v9
    v_mad_u32_u24 v231, v8, 3, v9
    v_add_u32 v231, 32, v231
    v_and_b32 v224, 127, v224
    v_and_b32 v225, 127, v225
    v_and_b32 v226, 127, v226
    v_and_b32 v227, 127, v227
    v_and_b32 v228, 127, v228
    v_and_b32 v229, 127, v229
    v_and_b32 v230, 127, v230
    v_and_b32 v231, 127, v231
    v_cvt_f32_u32 v224, v224
    v_cvt_f32_u32 v225, v225
    v_cvt_f32_u32 v226, v226
    v_cvt_f32_u32 v227, v227
    v_cvt_f32_u32 v228, v228
    v_cvt_f32_u32 v229, v229
    v_cvt_f32_u32 v230, v230
    v_cvt_f32_u32 v231, v231
    v_mul_f32 v224, 0x3c000000, v224
    v_mul_f32 v225, 0x3c000000, v225
    v_mul_f32 v226, 0x3c000000, v226
    v_mul_f32 v227, 0x3c000000, v227
    v_mul_f32 v228, 0x3c000000, v228
    v_mul_f32 v229, 0x3c000000, v229
    v_mul_f32 v230, 0x3c000000, v230
    v_mul_f32 v231, 0x3c000000, v231
    v_cos_f32 v224, v224
    v_cos_f32 v225, v225
    v_cos_f32 v226, v226
    v_cos_f32 v227, v227
    v_cos_f32 v228, v228
    v_cos_f32 v229, v229
    v_cos_f32 v230, v230
    v_cos_f32 v231, v231
    s_nop 0
    v_mul_f32 v224, 0x3d000000, v224
    v_mul_f32 v225, 0x3d000000, v225
    v_mul_f32 v226, 0x3d000000, v226
    v_mul_f32 v227, 0x3d000000, v227
    v_mul_f32 v228, 0x3d000000, v228
    v_mul_f32 v229, 0x3d000000, v229
    v_mul_f32 v230, 0x3d000000, v230
    v_mul_f32 v231, 0x3d000000, v231
    v_cvt_pk_bf16_f32 v232, v224, v225
    v_cvt_pk_bf16_f32 v233, v226, v227
    v_cvt_pk_bf16_f32 v234, v228, v229
    v_cvt_pk_bf16_f32 v235, v230, v231
    v_lshlrev_b32 v240, 16, v232
    v_and_b32 v241, 0xffff0000, v232
    v_sub_f32 v224, v224, v240
    v_sub_f32 v225, v225, v241
    v_lshlrev_b32 v240, 16, v233
    v_and_b32 v241, 0xffff0000, v233
    v_sub_f32 v226, v226, v240
    v_sub_f32 v227, v227, v241
    v_lshlrev_b32 v240, 16, v234
    v_and_b32 v241, 0xffff0000, v234
    v_sub_f32 v228, v228, v240
    v_sub_f32 v229, v229, v241
    v_lshlrev_b32 v240, 16, v235
    v_and_b32 v241, 0xffff0000, v235
    v_sub_f32 v230, v230, v240
    v_sub_f32 v231, v231, v241
    v_cvt_pk_bf16_f32 v236, v224, v225
    v_cvt_pk_bf16_f32 v237, v226, v227
    v_cvt_pk_bf16_f32 v238, v228, v229
    v_cvt_pk_bf16_f32 v239, v230, v231
    s_lshl_b32 s30, s3, 11
    v_add_u32 v10, s30, v5
    ds_write_b128 v10, v[232:235]
    ds_write_b128 v10, v[236:239] offset:1024
    s_and_saveexec_b64 s[26:27], vcc
    s_cbranch_execz K4_NOPART2
    s_waitcnt vmcnt(0)
    v_add_f32 v128, v128, v144
    v_add_f32 v129, v129, v145
    v_add_f32 v130, v130, v146
    v_add_f32 v131, v131, v147
    v_add_f32 v132, v132, v148
    v_add_f32 v133, v133, v149
    v_add_f32 v134, v134, v150
    v_add_f32 v135, v135, v151
    v_add_f32 v136, v136, v152
    v_add_f32 v137, v137, v153
    v_add_f32 v138, v138, v154
    v_add_f32 v139, v139, v155
    v_add_f32 v140, v140, v156
    v_add_f32 v141, v141, v157
    v_add_f32 v142, v142, v158
    v_add_f32 v143, v143, v159
    v_add_f32 v128, v128, v136
    v_add_f32 v129, v129, v137
    v_add_f32 v130, v130, v138
    v_add_f32 v131, v131, v139
    v_add_f32 v132, v132, v140
    v_add_f32 v133, v133, v141
    v_add_f32 v134, v134, v142
    v_add_f32 v135, v135, v143
    v_add_f32 v128, v128, v132
    v_add_f32 v129, v129, v133
    v_add_f32 v130, v130, v134
    v_add_f32 v131, v131, v135
    v_add_f32 v128, v128, v130
    v_add_f32 v129, v129, v131
    v_add_f32 v128, v128, v129
    v_lshlrev_b32 v7, 2, v0
    ds_write_b32 v7, v128 offset:12288
K4_NOPART2:
    s_mov_b64 exec, s[26:27]
    s_waitcnt lgkmcnt(0)
    s_barrier
    v_cmp_gt_u32 vcc, 128, v0
    s_and_saveexec_b64 s[26:27], vcc
    s_cbranch_execz K4_NOAB
    s_mov_b32 s16, s40
    s_mov_b32 s17, s41
    s_and_b32 s17, s17, 0xffff
    s_mov_b32 s18, 1024
    s_mov_b32 s19, 0x00020000
    s_mov_b32 s28, s42
    s_mov_b32 s29, s43
    s_and_b32 s29, s29, 0xffff
    s_mov_b32 s30, 1024
    s_mov_b32 s31, 0x00020000
    s_lshl_b32 s24, s21, 8
    v_lshlrev_b32 v7, 1, v0
    buffer_load_ushort v8, v7, s[16:19], s24 offen
    buffer_load_ushort v9, v7, s[28:31], s24 offen
    v_lshlrev_b32 v7, 2, v0
    ds_read_b32 v11, v7 offset:12288
    ds_read_b32 v12, v7 offset:12800
    s_waitcnt lgkmcnt(0)
    v_mul_f32 v11, 0x39035177, v11
    v_mul_f32 v12, 0x39035177, v12
    v_fma_f32 v12, -v11, v11, v12
    v_max_f32 v12, 0, v12
    v_add_f32 v12, 0x3727c5ac, v12
    v_sqrt_f32 v12, v12
    s_nop 0
    v_rcp_f32 v12, v12
    s_waitcnt vmcnt(0)
    v_lshlrev_b32 v8, 16, v8
    v_lshlrev_b32 v9, 16, v9
    v_mul_f32 v8, v8, v12
    v_fma_f32 v9, -v11, v8, v9
    ds_write_b32 v7, v8 offset:13312
    ds_write_b32 v7, v9 offset:13824
K4_NOAB:
    s_mov_b64 exec, s[26:27]
    s_waitcnt lgkmcnt(0)
    s_barrier
    s_cmp_lt_u32 s3, s23
    s_cbranch_scc0 K4_END
    ds_read_b128 v[80:83], v5 offset:0
    ds_read_b128 v[84:87], v5 offset:1024
    ds_read_b128 v[88:91], v5 offset:2048
    ds_read_b128 v[92:95], v5 offset:3072
    ds_read_b128 v[96:99], v5 offset:4096
    ds_read_b128 v[100:103], v5 offset:5120
    ds_read_b128 v[104:107], v5 offset:6144
    ds_read_b128 v[108:111], v5 offset:7168
    ds_read_b128 v[112:115], v5 offset:8192
    ds_read_b128 v[116:119], v5 offset:9216
    ds_read_b128 v[120:123], v5 offset:10240
    ds_read_b128 v[124:127], v5 offset:11264
    v_lshlrev_b32 v7, 4, v3
    ds_read_b128 v[224:227], v7 offset:13312
    ds_read_b128 v[232:235], v7 offset:13824
    ds_read_b128 v[228:231], v7 offset:13568
    ds_read_b128 v[236:239], v7 offset:14080
    s_waitcnt vmcnt(0)
    v_swap_b32 v17, v20
    v_swap_b32 v18, v24
    v_swap_b32 v19, v28
    v_swap_b32 v22, v25
    v_swap_b32 v23, v29
    v_swap_b32 v27, v30
    v_swap_b32 v33, v36
    v_swap_b32 v34, v40
    v_swap_b32 v35, v44
    v_swap_b32 v38, v41
    v_swap_b32 v39, v45
    v_swap_b32 v43, v46
    v_swap_b32 v49, v52
    v_swap_b32 v50, v56
    v_swap_b32 v51, v60
    v_swap_b32 v54, v57
    v_swap_b32 v55, v61
    v_swap_b32 v59, v62
    v_swap_b32 v65, v68
    v_swap_b32 v66, v72
    v_swap_b32 v67, v76
    v_swap_b32 v70, v73
    v_swap_b32 v71, v77
    v_swap_b32 v75, v78
    s_waitcnt lgkmcnt(0)
    s_nop 1
    v_mfma_f32_16x16x32_bf16 v[128:131], v[80:83], v[16:19], 0
    v_mfma_f32_16x16x32_bf16 v[132:135], v[80:83], v[20:23], 0
    v_mfma_f32_16x16x32_bf16 v[136:139], v[80:83], v[24:27], 0
    v_mfma_f32_16x16x32_bf16 v[140:143], v[80:83], v[28:31], 0
    v_mfma_f32_16x16x32_bf16 v[144:147], v[80:83], v[32:35], 0
    v_mfma_f32_16x16x32_bf16 v[148:151], v[80:83], v[36:39], 0
    v_mfma_f32_16x16x32_bf16 v[152:155], v[80:83], v[40:43], 0
    v_mfma_f32_16x16x32_bf16 v[156:159], v[80:83], v[44:47], 0
    v_mfma_f32_16x16x32_bf16 v[128:131], v[84:87], v[16:19], v[128:131]
    v_mfma_f32_16x16x32_bf16 v[132:135], v[84:87], v[20:23], v[132:135]
    v_mfma_f32_16x16x32_bf16 v[136:139], v[84:87], v[24:27], v[136:139]
    v_mfma_f32_16x16x32_bf16 v[140:143], v[84:87], v[28:31], v[140:143]
    v_mfma_f32_16x16x32_bf16 v[144:147], v[84:87], v[32:35], v[144:147]
    v_mfma_f32_16x16x32_bf16 v[148:151], v[84:87], v[36:39], v[148:151]
    v_mfma_f32_16x16x32_bf16 v[152:155], v[84:87], v[40:43], v[152:155]
    v_mfma_f32_16x16x32_bf16 v[156:159], v[84:87], v[44:47], v[156:159]
    v_mfma_f32_16x16x32_bf16 v[128:131], v[88:91], v[48:51], v[128:131]
    v_mfma_f32_16x16x32_bf16 v[132:135], v[88:91], v[52:55], v[132:135]
    v_mfma_f32_16x16x32_bf16 v[136:139], v[88:91], v[56:59], v[136:139]
    v_mfma_f32_16x16x32_bf16 v[140:143], v[88:91], v[60:63], v[140:143]
    v_mfma_f32_16x16x32_bf16 v[144:147], v[88:91], v[64:67], v[144:147]
    v_mfma_f32_16x16x32_bf16 v[148:151], v[88:91], v[68:71], v[148:151]
    v_mfma_f32_16x16x32_bf16 v[152:155], v[88:91], v[72:75], v[152:155]
    v_mfma_f32_16x16x32_bf16 v[156:159], v[88:91], v[76:79], v[156:159]
    v_mfma_f32_16x16x32_bf16 v[128:131], v[92:95], v[48:51], v[128:131]
    v_mfma_f32_16x16x32_bf16 v[132:135], v[92:95], v[52:55], v[132:135]
    v_mfma_f32_16x16x32_bf16 v[136:139], v[92:95], v[56:59], v[136:139]
    v_mfma_f32_16x16x32_bf16 v[140:143], v[92:95], v[60:63], v[140:143]
    v_mfma_f32_16x16x32_bf16 v[144:147], v[92:95], v[64:67], v[144:147]
    v_mfma_f32_16x16x32_bf16 v[148:151], v[92:95], v[68:71], v[148:151]
    v_mfma_f32_16x16x32_bf16 v[152:155], v[92:95], v[72:75], v[152:155]
    v_mfma_f32_16x16x32_bf16 v[156:159], v[92:95], v[76:79], v[156:159]
    v_mfma_f32_16x16x32_bf16 v[160:163], v[96:99], v[16:19], 0
    v_mfma_f32_16x16x32_bf16 v[164:167], v[96:99], v[20:23], 0
    v_mfma_f32_16x16x32_bf16 v[168:171], v[96:99], v[24:27], 0
    v_mfma_f32_16x16x32_bf16 v[172:175], v[96:99], v[28:31], 0
    v_mfma_f32_16x16x32_bf16 v[176:179], v[96:99], v[32:35], 0
    v_mfma_f32_16x16x32_bf16 v[180:183], v[96:99], v[36:39], 0
    v_mfma_f32_16x16x32_bf16 v[184:187], v[96:99], v[40:43], 0
    v_mfma_f32_16x16x32_bf16 v[188:191], v[96:99], v[44:47], 0
    v_mfma_f32_16x16x32_bf16 v[160:163], v[100:103], v[16:19], v[160:163]
    v_mfma_f32_16x16x32_bf16 v[164:167], v[100:103], v[20:23], v[164:167]
    v_mfma_f32_16x16x32_bf16 v[168:171], v[100:103], v[24:27], v[168:171]
    v_mfma_f32_16x16x32_bf16 v[172:175], v[100:103], v[28:31], v[172:175]
    v_mfma_f32_16x16x32_bf16 v[176:179], v[100:103], v[32:35], v[176:179]
    v_mfma_f32_16x16x32_bf16 v[180:183], v[100:103], v[36:39], v[180:183]
    v_mfma_f32_16x16x32_bf16 v[184:187], v[100:103], v[40:43], v[184:187]
    v_mfma_f32_16x16x32_bf16 v[188:191], v[100:103], v[44:47], v[188:191]
    v_mfma_f32_16x16x32_bf16 v[160:163], v[104:107], v[48:51], v[160:163]
    v_mfma_f32_16x16x32_bf16 v[164:167], v[104:107], v[52:55], v[164:167]
    v_mfma_f32_16x16x32_bf16 v[168:171], v[104:107], v[56:59], v[168:171]
    v_mfma_f32_16x16x32_bf16 v[172:175], v[104:107], v[60:63], v[172:175]
    v_mfma_f32_16x16x32_bf16 v[176:179], v[104:107], v[64:67], v[176:179]
    v_mfma_f32_16x16x32_bf16 v[180:183], v[104:107], v[68:71], v[180:183]
    v_mfma_f32_16x16x32_bf16 v[184:187], v[104:107], v[72:75], v[184:187]
    v_mfma_f32_16x16x32_bf16 v[188:191], v[104:107], v[76:79], v[188:191]
    v_mfma_f32_16x16x32_bf16 v[160:163], v[108:111], v[48:51], v[160:163]
    v_mfma_f32_16x16x32_bf16 v[164:167], v[108:111], v[52:55], v[164:167]
    v_mfma_f32_16x16x32_bf16 v[168:171], v[108:111], v[56:59], v[168:171]
    v_mfma_f32_16x16x32_bf16 v[172:175], v[108:111], v[60:63], v[172:175]
    v_mfma_f32_16x16x32_bf16 v[176:179], v[108:111], v[64:67], v[176:179]
    v_mfma_f32_16x16x32_bf16 v[180:183], v[108:111], v[68:71], v[180:183]
    v_mfma_f32_16x16x32_bf16 v[184:187], v[108:111], v[72:75], v[184:187]
    v_mfma_f32_16x16x32_bf16 v[188:191], v[108:111], v[76:79], v[188:191]
    v_mfma_f32_16x16x32_bf16 v[192:195], v[112:115], v[16:19], 0
    v_mfma_f32_16x16x32_bf16 v[196:199], v[112:115], v[20:23], 0
    v_mfma_f32_16x16x32_bf16 v[200:203], v[112:115], v[24:27], 0
    v_mfma_f32_16x16x32_bf16 v[204:207], v[112:115], v[28:31], 0
    v_mfma_f32_16x16x32_bf16 v[208:211], v[112:115], v[32:35], 0
    v_mfma_f32_16x16x32_bf16 v[212:215], v[112:115], v[36:39], 0
    v_mfma_f32_16x16x32_bf16 v[216:219], v[112:115], v[40:43], 0
    v_mfma_f32_16x16x32_bf16 v[220:223], v[112:115], v[44:47], 0
    v_mfma_f32_16x16x32_bf16 v[192:195], v[116:119], v[16:19], v[192:195]
    v_mfma_f32_16x16x32_bf16 v[196:199], v[116:119], v[20:23], v[196:199]
    v_mfma_f32_16x16x32_bf16 v[200:203], v[116:119], v[24:27], v[200:203]
    v_mfma_f32_16x16x32_bf16 v[204:207], v[116:119], v[28:31], v[204:207]
    v_mfma_f32_16x16x32_bf16 v[208:211], v[116:119], v[32:35], v[208:211]
    v_mfma_f32_16x16x32_bf16 v[212:215], v[116:119], v[36:39], v[212:215]
    v_mfma_f32_16x16x32_bf16 v[216:219], v[116:119], v[40:43], v[216:219]
    v_mfma_f32_16x16x32_bf16 v[220:223], v[116:119], v[44:47], v[220:223]
    v_mfma_f32_16x16x32_bf16 v[192:195], v[120:123], v[48:51], v[192:195]
    v_mfma_f32_16x16x32_bf16 v[196:199], v[120:123], v[52:55], v[196:199]
    v_mfma_f32_16x16x32_bf16 v[200:203], v[120:123], v[56:59], v[200:203]
    v_mfma_f32_16x16x32_bf16 v[204:207], v[120:123], v[60:63], v[204:207]
    v_mfma_f32_16x16x32_bf16 v[208:211], v[120:123], v[64:67], v[208:211]
    v_mfma_f32_16x16x32_bf16 v[212:215], v[120:123], v[68:71], v[212:215]
    v_mfma_f32_16x16x32_bf16 v[216:219], v[120:123], v[72:75], v[216:219]
    v_mfma_f32_16x16x32_bf16 v[220:223], v[120:123], v[76:79], v[220:223]
    v_mfma_f32_16x16x32_bf16 v[192:195], v[124:127], v[48:51], v[192:195]
    v_mfma_f32_16x16x32_bf16 v[196:199], v[124:127], v[52:55], v[196:199]
    v_mfma_f32_16x16x32_bf16 v[200:203], v[124:127], v[56:59], v[200:203]
    v_mfma_f32_16x16x32_bf16 v[204:207], v[124:127], v[60:63], v[204:207]
    v_mfma_f32_16x16x32_bf16 v[208:211], v[124:127], v[64:67], v[208:211]
    v_mfma_f32_16x16x32_bf16 v[212:215], v[124:127], v[68:71], v[212:215]
    v_mfma_f32_16x16x32_bf16 v[216:219], v[124:127], v[72:75], v[216:219]
    v_mfma_f32_16x16x32_bf16 v[220:223], v[124:127], v[76:79], v[220:223]
    s_nop 7
    s_mul_i32 s24, s20, 8176640
    s_add_u32 s16, s44, s24
    s_addc_u32 s17, s45, 0
    s_and_b32 s17, s17, 0xffff
    s_mov_b32 s18, 8176640
    s_mov_b32 s19, 0x00020000
    v_lshlrev_b32 v7, 12, v4
    v_lshl_add_u32 v7, v3, 3, v7
    s_lshl_b32 s24, s21, 8
    v_add_u32 v7, s24, v7
    s_mul_i32 s25, s22, 49152
    s_mov_b32 s30, 0xc0135761
    s_mov_b32 s31, 0xbdd2d3e8
    v_mov_b32 v15, s30
    v_fma_f32 v16, v128, v224, v232
    v_fma_f32 v17, v132, v225, v233
    v_fma_f32 v18, v136, v226, v234
    v_fma_f32 v19, v140, v227, v235
    v_mul_f32 v20, v16, v16
    v_mul_f32 v21, v17, v17
    v_mul_f32 v22, v18, v18
    v_mul_f32 v23, v19, v19
    v_fma_f32 v20, v20, s31, v15
    v_fma_f32 v21, v21, s31, v15
    v_fma_f32 v22, v22, s31, v15
    v_fma_f32 v23, v23, s31, v15
    v_mul_f32 v20, v20, v16
    v_mul_f32 v21, v21, v17
    v_mul_f32 v22, v22, v18
    v_mul_f32 v23, v23, v19
    v_exp_f32 v20, v20
    v_exp_f32 v21, v21
    v_exp_f32 v22, v22
    v_exp_f32 v23, v23
    v_add_f32 v20, 1.0, v20
    v_add_f32 v21, 1.0, v21
    v_add_f32 v22, 1.0, v22
    v_add_f32 v23, 1.0, v23
    v_rcp_f32 v20, v20
    v_rcp_f32 v21, v21
    v_rcp_f32 v22, v22
    v_rcp_f32 v23, v23
    v_mul_f32 v16, v16, v20
    v_mul_f32 v17, v17, v21
    v_mul_f32 v18, v18, v22
    v_mul_f32 v19, v19, v23
    v_cvt_pk_bf16_f32 v24, v16, v17
    v_cvt_pk_bf16_f32 v25, v18, v19
    buffer_store_dwordx2 v[24:25], v7, s[16:19], s25 offen offset:0
    v_fma_f32 v28, v144, v228, v236
    v_fma_f32 v29, v148, v229, v237
    v_fma_f32 v30, v152, v230, v238
    v_fma_f32 v31, v156, v231, v239
    v_mul_f32 v32, v28, v28
    v_mul_f32 v33, v29, v29
    v_mul_f32 v34, v30, v30
    v_mul_f32 v35, v31, v31
    v_fma_f32 v32, v32, s31, v15
    v_fma_f32 v33, v33, s31, v15
    v_fma_f32 v34, v34, s31, v15
    v_fma_f32 v35, v35, s31, v15
    v_mul_f32 v32, v32, v28
    v_mul_f32 v33, v33, v29
    v_mul_f32 v34, v34, v30
    v_mul_f32 v35, v35, v31
    v_exp_f32 v32, v32
    v_exp_f32 v33, v33
    v_exp_f32 v34, v34
    v_exp_f32 v35, v35
    v_add_f32 v32, 1.0, v32
    v_add_f32 v33, 1.0, v33
    v_add_f32 v34, 1.0, v34
    v_add_f32 v35, 1.0, v35
    v_rcp_f32 v32, v32
    v_rcp_f32 v33, v33
    v_rcp_f32 v34, v34
    v_rcp_f32 v35, v35
    v_mul_f32 v28, v28, v32
    v_mul_f32 v29, v29, v33
    v_mul_f32 v30, v30, v34
    v_mul_f32 v31, v31, v35
    v_cvt_pk_bf16_f32 v36, v28, v29
    v_cvt_pk_bf16_f32 v37, v30, v31
    buffer_store_dwordx2 v[36:37], v7, s[16:19], s25 offen offset:128
    s_add_u32 s25, s25, 1024
    v_fma_f32 v40, v129, v224, v232
    v_fma_f32 v41, v133, v225, v233
    v_fma_f32 v42, v137, v226, v234
    v_fma_f32 v43, v141, v227, v235
    v_mul_f32 v44, v40, v40
    v_mul_f32 v45, v41, v41
    v_mul_f32 v46, v42, v42
    v_mul_f32 v47, v43, v43
    v_fma_f32 v44, v44, s31, v15
    v_fma_f32 v45, v45, s31, v15
    v_fma_f32 v46, v46, s31, v15
    v_fma_f32 v47, v47, s31, v15
    v_mul_f32 v44, v44, v40
    v_mul_f32 v45, v45, v41
    v_mul_f32 v46, v46, v42
    v_mul_f32 v47, v47, v43
    v_exp_f32 v44, v44
    v_exp_f32 v45, v45
    v_exp_f32 v46, v46
    v_exp_f32 v47, v47
    v_add_f32 v44, 1.0, v44
    v_add_f32 v45, 1.0, v45
    v_add_f32 v46, 1.0, v46
    v_add_f32 v47, 1.0, v47
    v_rcp_f32 v44, v44
    v_rcp_f32 v45, v45
    v_rcp_f32 v46, v46
    v_rcp_f32 v47, v47
    v_mul_f32 v40, v40, v44
    v_mul_f32 v41, v41, v45
    v_mul_f32 v42, v42, v46
    v_mul_f32 v43, v43, v47
    v_cvt_pk_bf16_f32 v48, v40, v41
    v_cvt_pk_bf16_f32 v49, v42, v43
    buffer_store_dwordx2 v[48:49], v7, s[16:19], s25 offen offset:0
    v_fma_f32 v52, v145, v228, v236
    v_fma_f32 v53, v149, v229, v237
    v_fma_f32 v54, v153, v230, v238
    v_fma_f32 v55, v157, v231, v239
    v_mul_f32 v56, v52, v52
    v_mul_f32 v57, v53, v53
    v_mul_f32 v58, v54, v54
    v_mul_f32 v59, v55, v55
    v_fma_f32 v56, v56, s31, v15
    v_fma_f32 v57, v57, s31, v15
    v_fma_f32 v58, v58, s31, v15
    v_fma_f32 v59, v59, s31, v15
    v_mul_f32 v56, v56, v52
    v_mul_f32 v57, v57, v53
    v_mul_f32 v58, v58, v54
    v_mul_f32 v59, v59, v55
    v_exp_f32 v56, v56
    v_exp_f32 v57, v57
    v_exp_f32 v58, v58
    v_exp_f32 v59, v59
    v_add_f32 v56, 1.0, v56
    v_add_f32 v57, 1.0, v57
    v_add_f32 v58, 1.0, v58
    v_add_f32 v59, 1.0, v59
    v_rcp_f32 v56, v56
    v_rcp_f32 v57, v57
    v_rcp_f32 v58, v58
    v_rcp_f32 v59, v59
    v_mul_f32 v52, v52, v56
    v_mul_f32 v53, v53, v57
    v_mul_f32 v54, v54, v58
    v_mul_f32 v55, v55, v59
    v_cvt_pk_bf16_f32 v60, v52, v53
    v_cvt_pk_bf16_f32 v61, v54, v55
    buffer_store_dwordx2 v[60:61], v7, s[16:19], s25 offen offset:128
    s_add_u32 s25, s25, 1024
    v_fma_f32 v16, v130, v224, v232
    v_fma_f32 v17, v134, v225, v233
    v_fma_f32 v18, v138, v226, v234
    v_fma_f32 v19, v142, v227, v235
    v_mul_f32 v20, v16, v16
    v_mul_f32 v21, v17, v17
    v_mul_f32 v22, v18, v18
    v_mul_f32 v23, v19, v19
    v_fma_f32 v20, v20, s31, v15
    v_fma_f32 v21, v21, s31, v15
    v_fma_f32 v22, v22, s31, v15
    v_fma_f32 v23, v23, s31, v15
    v_mul_f32 v20, v20, v16
    v_mul_f32 v21, v21, v17
    v_mul_f32 v22, v22, v18
    v_mul_f32 v23, v23, v19
    v_exp_f32 v20, v20
    v_exp_f32 v21, v21
    v_exp_f32 v22, v22
    v_exp_f32 v23, v23
    v_add_f32 v20, 1.0, v20
    v_add_f32 v21, 1.0, v21
    v_add_f32 v22, 1.0, v22
    v_add_f32 v23, 1.0, v23
    v_rcp_f32 v20, v20
    v_rcp_f32 v21, v21
    v_rcp_f32 v22, v22
    v_rcp_f32 v23, v23
    v_mul_f32 v16, v16, v20
    v_mul_f32 v17, v17, v21
    v_mul_f32 v18, v18, v22
    v_mul_f32 v19, v19, v23
    v_cvt_pk_bf16_f32 v24, v16, v17
    v_cvt_pk_bf16_f32 v25, v18, v19
    buffer_store_dwordx2 v[24:25], v7, s[16:19], s25 offen offset:0
    v_fma_f32 v28, v146, v228, v236
    v_fma_f32 v29, v150, v229, v237
    v_fma_f32 v30, v154, v230, v238
    v_fma_f32 v31, v158, v231, v239
    v_mul_f32 v32, v28, v28
    v_mul_f32 v33, v29, v29
    v_mul_f32 v34, v30, v30
    v_mul_f32 v35, v31, v31
    v_fma_f32 v32, v32, s31, v15
    v_fma_f32 v33, v33, s31, v15
    v_fma_f32 v34, v34, s31, v15
    v_fma_f32 v35, v35, s31, v15
    v_mul_f32 v32, v32, v28
    v_mul_f32 v33, v33, v29
    v_mul_f32 v34, v34, v30
    v_mul_f32 v35, v35, v31
    v_exp_f32 v32, v32
    v_exp_f32 v33, v33
    v_exp_f32 v34, v34
    v_exp_f32 v35, v35
    v_add_f32 v32, 1.0, v32
    v_add_f32 v33, 1.0, v33
    v_add_f32 v34, 1.0, v34
    v_add_f32 v35, 1.0, v35
    v_rcp_f32 v32, v32
    v_rcp_f32 v33, v33
    v_rcp_f32 v34, v34
    v_rcp_f32 v35, v35
    v_mul_f32 v28, v28, v32
    v_mul_f32 v29, v29, v33
    v_mul_f32 v30, v30, v34
    v_mul_f32 v31, v31, v35
    v_cvt_pk_bf16_f32 v36, v28, v29
    v_cvt_pk_bf16_f32 v37, v30, v31
    buffer_store_dwordx2 v[36:37], v7, s[16:19], s25 offen offset:128
    s_add_u32 s25, s25, 1024
    v_fma_f32 v40, v131, v224, v232
    v_fma_f32 v41, v135, v225, v233
    v_fma_f32 v42, v139, v226, v234
    v_fma_f32 v43, v143, v227, v235
    v_mul_f32 v44, v40, v40
    v_mul_f32 v45, v41, v41
    v_mul_f32 v46, v42, v42
    v_mul_f32 v47, v43, v43
    v_fma_f32 v44, v44, s31, v15
    v_fma_f32 v45, v45, s31, v15
    v_fma_f32 v46, v46, s31, v15
    v_fma_f32 v47, v47, s31, v15
    v_mul_f32 v44, v44, v40
    v_mul_f32 v45, v45, v41
    v_mul_f32 v46, v46, v42
    v_mul_f32 v47, v47, v43
    v_exp_f32 v44, v44
    v_exp_f32 v45, v45
    v_exp_f32 v46, v46
    v_exp_f32 v47, v47
    v_add_f32 v44, 1.0, v44
    v_add_f32 v45, 1.0, v45
    v_add_f32 v46, 1.0, v46
    v_add_f32 v47, 1.0, v47
    v_rcp_f32 v44, v44
    v_rcp_f32 v45, v45
    v_rcp_f32 v46, v46
    v_rcp_f32 v47, v47
    v_mul_f32 v40, v40, v44
    v_mul_f32 v41, v41, v45
    v_mul_f32 v42, v42, v46
    v_mul_f32 v43, v43, v47
    v_cvt_pk_bf16_f32 v48, v40, v41
    v_cvt_pk_bf16_f32 v49, v42, v43
    buffer_store_dwordx2 v[48:49], v7, s[16:19], s25 offen offset:0
    v_fma_f32 v52, v147, v228, v236
    v_fma_f32 v53, v151, v229, v237
    v_fma_f32 v54, v155, v230, v238
    v_fma_f32 v55, v159, v231, v239
    v_mul_f32 v56, v52, v52
    v_mul_f32 v57, v53, v53
    v_mul_f32 v58, v54, v54
    v_mul_f32 v59, v55, v55
    v_fma_f32 v56, v56, s31, v15
    v_fma_f32 v57, v57, s31, v15
    v_fma_f32 v58, v58, s31, v15
    v_fma_f32 v59, v59, s31, v15
    v_mul_f32 v56, v56, v52
    v_mul_f32 v57, v57, v53
    v_mul_f32 v58, v58, v54
    v_mul_f32 v59, v59, v55
    v_exp_f32 v56, v56
    v_exp_f32 v57, v57
    v_exp_f32 v58, v58
    v_exp_f32 v59, v59
    v_add_f32 v56, 1.0, v56
    v_add_f32 v57, 1.0, v57
    v_add_f32 v58, 1.0, v58
    v_add_f32 v59, 1.0, v59
    v_rcp_f32 v56, v56
    v_rcp_f32 v57, v57
    v_rcp_f32 v58, v58
    v_rcp_f32 v59, v59
    v_mul_f32 v52, v52, v56
    v_mul_f32 v53, v53, v57
    v_mul_f32 v54, v54, v58
    v_mul_f32 v55, v55, v59
    v_cvt_pk_bf16_f32 v60, v52, v53
    v_cvt_pk_bf16_f32 v61, v54, v55
    buffer_store_dwordx2 v[60:61], v7, s[16:19], s25 offen offset:128
    s_add_u32 s25, s25, 1024
    s_add_u32 s25, s25, 12288
    v_fma_f32 v16, v160, v224, v232
    v_fma_f32 v17, v164, v225, v233
    v_fma_f32 v18, v168, v226, v234
    v_fma_f32 v19, v172, v227, v235
    v_mul_f32 v20, v16, v16
    v_mul_f32 v21, v17, v17
    v_mul_f32 v22, v18, v18
    v_mul_f32 v23, v19, v19
    v_fma_f32 v20, v20, s31, v15
    v_fma_f32 v21, v21, s31, v15
    v_fma_f32 v22, v22, s31, v15
    v_fma_f32 v23, v23, s31, v15
    v_mul_f32 v20, v20, v16
    v_mul_f32 v21, v21, v17
    v_mul_f32 v22, v22, v18
    v_mul_f32 v23, v23, v19
    v_exp_f32 v20, v20
    v_exp_f32 v21, v21
    v_exp_f32 v22, v22
    v_exp_f32 v23, v23
    v_add_f32 v20, 1.0, v20
    v_add_f32 v21, 1.0, v21
    v_add_f32 v22, 1.0, v22
    v_add_f32 v23, 1.0, v23
    v_rcp_f32 v20, v20
    v_rcp_f32 v21, v21
    v_rcp_f32 v22, v22
    v_rcp_f32 v23, v23
    v_mul_f32 v16, v16, v20
    v_mul_f32 v17, v17, v21
    v_mul_f32 v18, v18, v22
    v_mul_f32 v19, v19, v23
    v_cvt_pk_bf16_f32 v24, v16, v17
    v_cvt_pk_bf16_f32 v25, v18, v19
    buffer_store_dwordx2 v[24:25], v7, s[16:19], s25 offen offset:0
    v_fma_f32 v28, v176, v228, v236
    v_fma_f32 v29, v180, v229, v237
    v_fma_f32 v30, v184, v230, v238
    v_fma_f32 v31, v188, v231, v239
    v_mul_f32 v32, v28, v28
    v_mul_f32 v33, v29, v29
    v_mul_f32 v34, v30, v30
    v_mul_f32 v35, v31, v31
    v_fma_f32 v32, v32, s31, v15
    v_fma_f32 v33, v33, s31, v15
    v_fma_f32 v34, v34, s31, v15
    v_fma_f32 v35, v35, s31, v15
    v_mul_f32 v32, v32, v28
    v_mul_f32 v33, v33, v29
    v_mul_f32 v34, v34, v30
    v_mul_f32 v35, v35, v31
    v_exp_f32 v32, v32
    v_exp_f32 v33, v33
    v_exp_f32 v34, v34
    v_exp_f32 v35, v35
    v_add_f32 v32, 1.0, v32
    v_add_f32 v33, 1.0, v33
    v_add_f32 v34, 1.0, v34
    v_add_f32 v35, 1.0, v35
    v_rcp_f32 v32, v32
    v_rcp_f32 v33, v33
    v_rcp_f32 v34, v34
    v_rcp_f32 v35, v35
    v_mul_f32 v28, v28, v32
    v_mul_f32 v29, v29, v33
    v_mul_f32 v30, v30, v34
    v_mul_f32 v31, v31, v35
    v_cvt_pk_bf16_f32 v36, v28, v29
    v_cvt_pk_bf16_f32 v37, v30, v31
    buffer_store_dwordx2 v[36:37], v7, s[16:19], s25 offen offset:128
    s_add_u32 s25, s25, 1024
    v_fma_f32 v40, v161, v224, v232
    v_fma_f32 v41, v165, v225, v233
    v_fma_f32 v42, v169, v226, v234
    v_fma_f32 v43, v173, v227, v235
    v_mul_f32 v44, v40, v40
    v_mul_f32 v45, v41, v41
    v_mul_f32 v46, v42, v42
    v_mul_f32 v47, v43, v43
    v_fma_f32 v44, v44, s31, v15
    v_fma_f32 v45, v45, s31, v15
    v_fma_f32 v46, v46, s31, v15
    v_fma_f32 v47, v47, s31, v15
    v_mul_f32 v44, v44, v40
    v_mul_f32 v45, v45, v41
    v_mul_f32 v46, v46, v42
    v_mul_f32 v47, v47, v43
    v_exp_f32 v44, v44
    v_exp_f32 v45, v45
    v_exp_f32 v46, v46
    v_exp_f32 v47, v47
    v_add_f32 v44, 1.0, v44
    v_add_f32 v45, 1.0, v45
    v_add_f32 v46, 1.0, v46
    v_add_f32 v47, 1.0, v47
    v_rcp_f32 v44, v44
    v_rcp_f32 v45, v45
    v_rcp_f32 v46, v46
    v_rcp_f32 v47, v47
    v_mul_f32 v40, v40, v44
    v_mul_f32 v41, v41, v45
    v_mul_f32 v42, v42, v46
    v_mul_f32 v43, v43, v47
    v_cvt_pk_bf16_f32 v48, v40, v41
    v_cvt_pk_bf16_f32 v49, v42, v43
    buffer_store_dwordx2 v[48:49], v7, s[16:19], s25 offen offset:0
    v_fma_f32 v52, v177, v228, v236
    v_fma_f32 v53, v181, v229, v237
    v_fma_f32 v54, v185, v230, v238
    v_fma_f32 v55, v189, v231, v239
    v_mul_f32 v56, v52, v52
    v_mul_f32 v57, v53, v53
    v_mul_f32 v58, v54, v54
    v_mul_f32 v59, v55, v55
    v_fma_f32 v56, v56, s31, v15
    v_fma_f32 v57, v57, s31, v15
    v_fma_f32 v58, v58, s31, v15
    v_fma_f32 v59, v59, s31, v15
    v_mul_f32 v56, v56, v52
    v_mul_f32 v57, v57, v53
    v_mul_f32 v58, v58, v54
    v_mul_f32 v59, v59, v55
    v_exp_f32 v56, v56
    v_exp_f32 v57, v57
    v_exp_f32 v58, v58
    v_exp_f32 v59, v59
    v_add_f32 v56, 1.0, v56
    v_add_f32 v57, 1.0, v57
    v_add_f32 v58, 1.0, v58
    v_add_f32 v59, 1.0, v59
    v_rcp_f32 v56, v56
    v_rcp_f32 v57, v57
    v_rcp_f32 v58, v58
    v_rcp_f32 v59, v59
    v_mul_f32 v52, v52, v56
    v_mul_f32 v53, v53, v57
    v_mul_f32 v54, v54, v58
    v_mul_f32 v55, v55, v59
    v_cvt_pk_bf16_f32 v60, v52, v53
    v_cvt_pk_bf16_f32 v61, v54, v55
    buffer_store_dwordx2 v[60:61], v7, s[16:19], s25 offen offset:128
    s_add_u32 s25, s25, 1024
    v_fma_f32 v16, v162, v224, v232
    v_fma_f32 v17, v166, v225, v233
    v_fma_f32 v18, v170, v226, v234
    v_fma_f32 v19, v174, v227, v235
    v_mul_f32 v20, v16, v16
    v_mul_f32 v21, v17, v17
    v_mul_f32 v22, v18, v18
    v_mul_f32 v23, v19, v19
    v_fma_f32 v20, v20, s31, v15
    v_fma_f32 v21, v21, s31, v15
    v_fma_f32 v22, v22, s31, v15
    v_fma_f32 v23, v23, s31, v15
    v_mul_f32 v20, v20, v16
    v_mul_f32 v21, v21, v17
    v_mul_f32 v22, v22, v18
    v_mul_f32 v23, v23, v19
    v_exp_f32 v20, v20
    v_exp_f32 v21, v21
    v_exp_f32 v22, v22
    v_exp_f32 v23, v23
    v_add_f32 v20, 1.0, v20
    v_add_f32 v21, 1.0, v21
    v_add_f32 v22, 1.0, v22
    v_add_f32 v23, 1.0, v23
    v_rcp_f32 v20, v20
    v_rcp_f32 v21, v21
    v_rcp_f32 v22, v22
    v_rcp_f32 v23, v23
    v_mul_f32 v16, v16, v20
    v_mul_f32 v17, v17, v21
    v_mul_f32 v18, v18, v22
    v_mul_f32 v19, v19, v23
    v_cvt_pk_bf16_f32 v24, v16, v17
    v_cvt_pk_bf16_f32 v25, v18, v19
    buffer_store_dwordx2 v[24:25], v7, s[16:19], s25 offen offset:0
    v_fma_f32 v28, v178, v228, v236
    v_fma_f32 v29, v182, v229, v237
    v_fma_f32 v30, v186, v230, v238
    v_fma_f32 v31, v190, v231, v239
    v_mul_f32 v32, v28, v28
    v_mul_f32 v33, v29, v29
    v_mul_f32 v34, v30, v30
    v_mul_f32 v35, v31, v31
    v_fma_f32 v32, v32, s31, v15
    v_fma_f32 v33, v33, s31, v15
    v_fma_f32 v34, v34, s31, v15
    v_fma_f32 v35, v35, s31, v15
    v_mul_f32 v32, v32, v28
    v_mul_f32 v33, v33, v29
    v_mul_f32 v34, v34, v30
    v_mul_f32 v35, v35, v31
    v_exp_f32 v32, v32
    v_exp_f32 v33, v33
    v_exp_f32 v34, v34
    v_exp_f32 v35, v35
    v_add_f32 v32, 1.0, v32
    v_add_f32 v33, 1.0, v33
    v_add_f32 v34, 1.0, v34
    v_add_f32 v35, 1.0, v35
    v_rcp_f32 v32, v32
    v_rcp_f32 v33, v33
    v_rcp_f32 v34, v34
    v_rcp_f32 v35, v35
    v_mul_f32 v28, v28, v32
    v_mul_f32 v29, v29, v33
    v_mul_f32 v30, v30, v34
    v_mul_f32 v31, v31, v35
    v_cvt_pk_bf16_f32 v36, v28, v29
    v_cvt_pk_bf16_f32 v37, v30, v31
    buffer_store_dwordx2 v[36:37], v7, s[16:19], s25 offen offset:128
    s_add_u32 s25, s25, 1024
    v_fma_f32 v40, v163, v224, v232
    v_fma_f32 v41, v167, v225, v233
    v_fma_f32 v42, v171, v226, v234
    v_fma_f32 v43, v175, v227, v235
    v_mul_f32 v44, v40, v40
    v_mul_f32 v45, v41, v41
    v_mul_f32 v46, v42, v42
    v_mul_f32 v47, v43, v43
    v_fma_f32 v44, v44, s31, v15
    v_fma_f32 v45, v45, s31, v15
    v_fma_f32 v46, v46, s31, v15
    v_fma_f32 v47, v47, s31, v15
    v_mul_f32 v44, v44, v40
    v_mul_f32 v45, v45, v41
    v_mul_f32 v46, v46, v42
    v_mul_f32 v47, v47, v43
    v_exp_f32 v44, v44
    v_exp_f32 v45, v45
    v_exp_f32 v46, v46
    v_exp_f32 v47, v47
    v_add_f32 v44, 1.0, v44
    v_add_f32 v45, 1.0, v45
    v_add_f32 v46, 1.0, v46
    v_add_f32 v47, 1.0, v47
    v_rcp_f32 v44, v44
    v_rcp_f32 v45, v45
    v_rcp_f32 v46, v46
    v_rcp_f32 v47, v47
    v_mul_f32 v40, v40, v44
    v_mul_f32 v41, v41, v45
    v_mul_f32 v42, v42, v46
    v_mul_f32 v43, v43, v47
    v_cvt_pk_bf16_f32 v48, v40, v41
    v_cvt_pk_bf16_f32 v49, v42, v43
    buffer_store_dwordx2 v[48:49], v7, s[16:19], s25 offen offset:0
    v_fma_f32 v52, v179, v228, v236
    v_fma_f32 v53, v183, v229, v237
    v_fma_f32 v54, v187, v230, v238
    v_fma_f32 v55, v191, v231, v239
    v_mul_f32 v56, v52, v52
    v_mul_f32 v57, v53, v53
    v_mul_f32 v58, v54, v54
    v_mul_f32 v59, v55, v55
    v_fma_f32 v56, v56, s31, v15
    v_fma_f32 v57, v57, s31, v15
    v_fma_f32 v58, v58, s31, v15
    v_fma_f32 v59, v59, s31, v15
    v_mul_f32 v56, v56, v52
    v_mul_f32 v57, v57, v53
    v_mul_f32 v58, v58, v54
    v_mul_f32 v59, v59, v55
    v_exp_f32 v56, v56
    v_exp_f32 v57, v57
    v_exp_f32 v58, v58
    v_exp_f32 v59, v59
    v_add_f32 v56, 1.0, v56
    v_add_f32 v57, 1.0, v57
    v_add_f32 v58, 1.0, v58
    v_add_f32 v59, 1.0, v59
    v_rcp_f32 v56, v56
    v_rcp_f32 v57, v57
    v_rcp_f32 v58, v58
    v_rcp_f32 v59, v59
    v_mul_f32 v52, v52, v56
    v_mul_f32 v53, v53, v57
    v_mul_f32 v54, v54, v58
    v_mul_f32 v55, v55, v59
    v_cvt_pk_bf16_f32 v60, v52, v53
    v_cvt_pk_bf16_f32 v61, v54, v55
    buffer_store_dwordx2 v[60:61], v7, s[16:19], s25 offen offset:128
    s_add_u32 s25, s25, 1024
    s_add_u32 s25, s25, 12288
    v_fma_f32 v16, v192, v224, v232
    v_fma_f32 v17, v196, v225, v233
    v_fma_f32 v18, v200, v226, v234
    v_fma_f32 v19, v204, v227, v235
    v_mul_f32 v20, v16, v16
    v_mul_f32 v21, v17, v17
    v_mul_f32 v22, v18, v18
    v_mul_f32 v23, v19, v19
    v_fma_f32 v20, v20, s31, v15
    v_fma_f32 v21, v21, s31, v15
    v_fma_f32 v22, v22, s31, v15
    v_fma_f32 v23, v23, s31, v15
    v_mul_f32 v20, v20, v16
    v_mul_f32 v21, v21, v17
    v_mul_f32 v22, v22, v18
    v_mul_f32 v23, v23, v19
    v_exp_f32 v20, v20
    v_exp_f32 v21, v21
    v_exp_f32 v22, v22
    v_exp_f32 v23, v23
    v_add_f32 v20, 1.0, v20
    v_add_f32 v21, 1.0, v21
    v_add_f32 v22, 1.0, v22
    v_add_f32 v23, 1.0, v23
    v_rcp_f32 v20, v20
    v_rcp_f32 v21, v21
    v_rcp_f32 v22, v22
    v_rcp_f32 v23, v23
    v_mul_f32 v16, v16, v20
    v_mul_f32 v17, v17, v21
    v_mul_f32 v18, v18, v22
    v_mul_f32 v19, v19, v23
    v_cvt_pk_bf16_f32 v24, v16, v17
    v_cvt_pk_bf16_f32 v25, v18, v19
    buffer_store_dwordx2 v[24:25], v7, s[16:19], s25 offen offset:0
    v_fma_f32 v28, v208, v228, v236
    v_fma_f32 v29, v212, v229, v237
    v_fma_f32 v30, v216, v230, v238
    v_fma_f32 v31, v220, v231, v239
    v_mul_f32 v32, v28, v28
    v_mul_f32 v33, v29, v29
    v_mul_f32 v34, v30, v30
    v_mul_f32 v35, v31, v31
    v_fma_f32 v32, v32, s31, v15
    v_fma_f32 v33, v33, s31, v15
    v_fma_f32 v34, v34, s31, v15
    v_fma_f32 v35, v35, s31, v15
    v_mul_f32 v32, v32, v28
    v_mul_f32 v33, v33, v29
    v_mul_f32 v34, v34, v30
    v_mul_f32 v35, v35, v31
    v_exp_f32 v32, v32
    v_exp_f32 v33, v33
    v_exp_f32 v34, v34
    v_exp_f32 v35, v35
    v_add_f32 v32, 1.0, v32
    v_add_f32 v33, 1.0, v33
    v_add_f32 v34, 1.0, v34
    v_add_f32 v35, 1.0, v35
    v_rcp_f32 v32, v32
    v_rcp_f32 v33, v33
    v_rcp_f32 v34, v34
    v_rcp_f32 v35, v35
    v_mul_f32 v28, v28, v32
    v_mul_f32 v29, v29, v33
    v_mul_f32 v30, v30, v34
    v_mul_f32 v31, v31, v35
    v_cvt_pk_bf16_f32 v36, v28, v29
    v_cvt_pk_bf16_f32 v37, v30, v31
    buffer_store_dwordx2 v[36:37], v7, s[16:19], s25 offen offset:128
    s_add_u32 s25, s25, 1024
    v_fma_f32 v40, v193, v224, v232
    v_fma_f32 v41, v197, v225, v233
    v_fma_f32 v42, v201, v226, v234
    v_fma_f32 v43, v205, v227, v235
    v_mul_f32 v44, v40, v40
    v_mul_f32 v45, v41, v41
    v_mul_f32 v46, v42, v42
    v_mul_f32 v47, v43, v43
    v_fma_f32 v44, v44, s31, v15
    v_fma_f32 v45, v45, s31, v15
    v_fma_f32 v46, v46, s31, v15
    v_fma_f32 v47, v47, s31, v15
    v_mul_f32 v44, v44, v40
    v_mul_f32 v45, v45, v41
    v_mul_f32 v46, v46, v42
    v_mul_f32 v47, v47, v43
    v_exp_f32 v44, v44
    v_exp_f32 v45, v45
    v_exp_f32 v46, v46
    v_exp_f32 v47, v47
    v_add_f32 v44, 1.0, v44
    v_add_f32 v45, 1.0, v45
    v_add_f32 v46, 1.0, v46
    v_add_f32 v47, 1.0, v47
    v_rcp_f32 v44, v44
    v_rcp_f32 v45, v45
    v_rcp_f32 v46, v46
    v_rcp_f32 v47, v47
    v_mul_f32 v40, v40, v44
    v_mul_f32 v41, v41, v45
    v_mul_f32 v42, v42, v46
    v_mul_f32 v43, v43, v47
    v_cvt_pk_bf16_f32 v48, v40, v41
    v_cvt_pk_bf16_f32 v49, v42, v43
    buffer_store_dwordx2 v[48:49], v7, s[16:19], s25 offen offset:0
    v_fma_f32 v52, v209, v228, v236
    v_fma_f32 v53, v213, v229, v237
    v_fma_f32 v54, v217, v230, v238
    v_fma_f32 v55, v221, v231, v239
    v_mul_f32 v56, v52, v52
    v_mul_f32 v57, v53, v53
    v_mul_f32 v58, v54, v54
    v_mul_f32 v59, v55, v55
    v_fma_f32 v56, v56, s31, v15
    v_fma_f32 v57, v57, s31, v15
    v_fma_f32 v58, v58, s31, v15
    v_fma_f32 v59, v59, s31, v15
    v_mul_f32 v56, v56, v52
    v_mul_f32 v57, v57, v53
    v_mul_f32 v58, v58, v54
    v_mul_f32 v59, v59, v55
    v_exp_f32 v56, v56
    v_exp_f32 v57, v57
    v_exp_f32 v58, v58
    v_exp_f32 v59, v59
    v_add_f32 v56, 1.0, v56
    v_add_f32 v57, 1.0, v57
    v_add_f32 v58, 1.0, v58
    v_add_f32 v59, 1.0, v59
    v_rcp_f32 v56, v56
    v_rcp_f32 v57, v57
    v_rcp_f32 v58, v58
    v_rcp_f32 v59, v59
    v_mul_f32 v52, v52, v56
    v_mul_f32 v53, v53, v57
    v_mul_f32 v54, v54, v58
    v_mul_f32 v55, v55, v59
    v_cvt_pk_bf16_f32 v60, v52, v53
    v_cvt_pk_bf16_f32 v61, v54, v55
    buffer_store_dwordx2 v[60:61], v7, s[16:19], s25 offen offset:128
    s_add_u32 s25, s25, 1024
    v_fma_f32 v16, v194, v224, v232
    v_fma_f32 v17, v198, v225, v233
    v_fma_f32 v18, v202, v226, v234
    v_fma_f32 v19, v206, v227, v235
    v_mul_f32 v20, v16, v16
    v_mul_f32 v21, v17, v17
    v_mul_f32 v22, v18, v18
    v_mul_f32 v23, v19, v19
    v_fma_f32 v20, v20, s31, v15
    v_fma_f32 v21, v21, s31, v15
    v_fma_f32 v22, v22, s31, v15
    v_fma_f32 v23, v23, s31, v15
    v_mul_f32 v20, v20, v16
    v_mul_f32 v21, v21, v17
    v_mul_f32 v22, v22, v18
    v_mul_f32 v23, v23, v19
    v_exp_f32 v20, v20
    v_exp_f32 v21, v21
    v_exp_f32 v22, v22
    v_exp_f32 v23, v23
    v_add_f32 v20, 1.0, v20
    v_add_f32 v21, 1.0, v21
    v_add_f32 v22, 1.0, v22
    v_add_f32 v23, 1.0, v23
    v_rcp_f32 v20, v20
    v_rcp_f32 v21, v21
    v_rcp_f32 v22, v22
    v_rcp_f32 v23, v23
    v_mul_f32 v16, v16, v20
    v_mul_f32 v17, v17, v21
    v_mul_f32 v18, v18, v22
    v_mul_f32 v19, v19, v23
    v_cvt_pk_bf16_f32 v24, v16, v17
    v_cvt_pk_bf16_f32 v25, v18, v19
    buffer_store_dwordx2 v[24:25], v7, s[16:19], s25 offen offset:0
    v_fma_f32 v28, v210, v228, v236
    v_fma_f32 v29, v214, v229, v237
    v_fma_f32 v30, v218, v230, v238
    v_fma_f32 v31, v222, v231, v239
    v_mul_f32 v32, v28, v28
    v_mul_f32 v33, v29, v29
    v_mul_f32 v34, v30, v30
    v_mul_f32 v35, v31, v31
    v_fma_f32 v32, v32, s31, v15
    v_fma_f32 v33, v33, s31, v15
    v_fma_f32 v34, v34, s31, v15
    v_fma_f32 v35, v35, s31, v15
    v_mul_f32 v32, v32, v28
    v_mul_f32 v33, v33, v29
    v_mul_f32 v34, v34, v30
    v_mul_f32 v35, v35, v31
    v_exp_f32 v32, v32
    v_exp_f32 v33, v33
    v_exp_f32 v34, v34
    v_exp_f32 v35, v35
    v_add_f32 v32, 1.0, v32
    v_add_f32 v33, 1.0, v33
    v_add_f32 v34, 1.0, v34
    v_add_f32 v35, 1.0, v35
    v_rcp_f32 v32, v32
    v_rcp_f32 v33, v33
    v_rcp_f32 v34, v34
    v_rcp_f32 v35, v35
    v_mul_f32 v28, v28, v32
    v_mul_f32 v29, v29, v33
    v_mul_f32 v30, v30, v34
    v_mul_f32 v31, v31, v35
    v_cvt_pk_bf16_f32 v36, v28, v29
    v_cvt_pk_bf16_f32 v37, v30, v31
    buffer_store_dwordx2 v[36:37], v7, s[16:19], s25 offen offset:128
    s_add_u32 s25, s25, 1024
    v_fma_f32 v40, v195, v224, v232
    v_fma_f32 v41, v199, v225, v233
    v_fma_f32 v42, v203, v226, v234
    v_fma_f32 v43, v207, v227, v235
    v_mul_f32 v44, v40, v40
    v_mul_f32 v45, v41, v41
    v_mul_f32 v46, v42, v42
    v_mul_f32 v47, v43, v43
    v_fma_f32 v44, v44, s31, v15
    v_fma_f32 v45, v45, s31, v15
    v_fma_f32 v46, v46, s31, v15
    v_fma_f32 v47, v47, s31, v15
    v_mul_f32 v44, v44, v40
    v_mul_f32 v45, v45, v41
    v_mul_f32 v46, v46, v42
    v_mul_f32 v47, v47, v43
    v_exp_f32 v44, v44
    v_exp_f32 v45, v45
    v_exp_f32 v46, v46
    v_exp_f32 v47, v47
    v_add_f32 v44, 1.0, v44
    v_add_f32 v45, 1.0, v45
    v_add_f32 v46, 1.0, v46
    v_add_f32 v47, 1.0, v47
    v_rcp_f32 v44, v44
    v_rcp_f32 v45, v45
    v_rcp_f32 v46, v46
    v_rcp_f32 v47, v47
    v_mul_f32 v40, v40, v44
    v_mul_f32 v41, v41, v45
    v_mul_f32 v42, v42, v46
    v_mul_f32 v43, v43, v47
    v_cvt_pk_bf16_f32 v48, v40, v41
    v_cvt_pk_bf16_f32 v49, v42, v43
    buffer_store_dwordx2 v[48:49], v7, s[16:19], s25 offen offset:0
    v_fma_f32 v52, v211, v228, v236
    v_fma_f32 v53, v215, v229, v237
    v_fma_f32 v54, v219, v230, v238
    v_fma_f32 v55, v223, v231, v239
    v_mul_f32 v56, v52, v52
    v_mul_f32 v57, v53, v53
    v_mul_f32 v58, v54, v54
    v_mul_f32 v59, v55, v55
    v_fma_f32 v56, v56, s31, v15
    v_fma_f32 v57, v57, s31, v15
    v_fma_f32 v58, v58, s31, v15
    v_fma_f32 v59, v59, s31, v15
    v_mul_f32 v56, v56, v52
    v_mul_f32 v57, v57, v53
    v_mul_f32 v58, v58, v54
    v_mul_f32 v59, v59, v55
    v_exp_f32 v56, v56
    v_exp_f32 v57, v57
    v_exp_f32 v58, v58
    v_exp_f32 v59, v59
    v_add_f32 v56, 1.0, v56
    v_add_f32 v57, 1.0, v57
    v_add_f32 v58, 1.0, v58
    v_add_f32 v59, 1.0, v59
    v_rcp_f32 v56, v56
    v_rcp_f32 v57, v57
    v_rcp_f32 v58, v58
    v_rcp_f32 v59, v59
    v_mul_f32 v52, v52, v56
    v_mul_f32 v53, v53, v57
    v_mul_f32 v54, v54, v58
    v_mul_f32 v55, v55, v59
    v_cvt_pk_bf16_f32 v60, v52, v53
    v_cvt_pk_bf16_f32 v61, v54, v55
    buffer_store_dwordx2 v[60:61], v7, s[16:19], s25 offen offset:128
    s_add_u32 s25, s25, 1024
    s_add_u32 s25, s25, 12288
K4_END:
    s_endpgm
.section .rodata,"a"
.p2align 6
.amdhsa_kernel k1_xform_kernel
  .amdhsa_next_free_vgpr 128
  .amdhsa_next_free_sgpr 64
  .amdhsa_accum_offset 128
  .amdhsa_group_segment_fixed_size 0
  .amdhsa_kernarg_size 56
  .amdhsa_user_sgpr_count 2
  .amdhsa_user_sgpr_kernarg_segment_ptr 1
  .amdhsa_system_sgpr_workgroup_id_x 1
.end_amdhsa_kernel
.p2align 6
.amdhsa_kernel k2_gemm_kernel
  .amdhsa_next_free_vgpr 256
  .amdhsa_next_free_sgpr 64
  .amdhsa_accum_offset 256
  .amdhsa_group_segment_fixed_size 0
  .amdhsa_kernarg_size 56
  .amdhsa_user_sgpr_count 2
  .amdhsa_user_sgpr_kernarg_segment_ptr 1
  .amdhsa_system_sgpr_workgroup_id_x 1
.end_amdhsa_kernel
.p2align 6
.amdhsa_kernel k3_stats_kernel
  .amdhsa_next_free_vgpr 256
  .amdhsa_next_free_sgpr 64
  .amdhsa_accum_offset 256
  .amdhsa_group_segment_fixed_size 0
  .amdhsa_kernarg_size 56
  .amdhsa_user_sgpr_count 2
  .amdhsa_user_sgpr_kernarg_segment_ptr 1
  .amdhsa_system_sgpr_workgroup_id_x 1
.end_amdhsa_kernel
.p2align 6
.amdhsa_kernel k4_out_kernel
  .amdhsa_next_free_vgpr 256
  .amdhsa_next_free_sgpr 64
  .amdhsa_accum_offset 256
  .amdhsa_group_segment_fixed_size 0
  .amdhsa_kernarg_size 56
  .amdhsa_user_sgpr_count 2
  .amdhsa_user_sgpr_kernarg_segment_ptr 1
  .amdhsa_system_sgpr_workgroup_id_x 1
.end_amdhsa_kernel
```

```asm
; @launch kernel=k1_xform_kernel grid=(1696,1,1) block=(256,1,1) lds=16384
; @launch kernel=k2_gemm_kernel grid=(256,1,1) block=(512,1,1) lds=151552
; @launch kernel=k3_stats_kernel grid=(256,1,1) block=(768,1,1) lds=18432
; @launch kernel=k4_out_kernel grid=(256,1,1) block=(768,1,1) lds=12800
.amdgcn_target "amdgcn-amd-amdhsa--gfx950"
.text
.globl k1_xform_kernel
.globl k2_gemm_kernel
.globl k3_stats_kernel
.globl k4_out_kernel
.p2align 8
.type k1_xform_kernel,@function
k1_xform_kernel:
    s_cmp_ge_u32 s2, 1696
    s_cbranch_scc1 K1_END
    s_load_dwordx4 s[4:7], s[0:1], 0
    s_load_dwordx2 s[8:9], s[0:1], 48
    v_lshrrev_b32 v120, 6, v0
    v_and_b32 v121, 63, v0
    v_readfirstlane_b32 s3, v120
    v_and_b32 v122, 15, v121
    v_lshrrev_b32 v123, 4, v121
    s_mov_b32 s28, 0x05040100
    s_mov_b32 s29, 0x07060302
    v_and_b32 v124, 3, v122
    v_lshlrev_b32 v124, 2, v124
    v_lshrrev_b32 v125, 3, v122
    v_lshl_add_u32 v124, v125, 1, v124
    s_lshl_b32 s10, s3, 4
    s_add_u32 s10, s10, 1
    v_add_u32 v124, s10, v124
    v_bfe_u32 v125, v122, 2, 1
    v_lshlrev_b32 v121, 4, v121
    s_waitcnt lgkmcnt(0)
    s_add_u32 s10, s2, 1024
    s_sub_u32 s11, s2, 672
    s_cmp_lt_u32 s2, 672
    s_cselect_b32 s2, s10, s11
    s_cmp_lt_u32 s2, 1024
    s_cbranch_scc1 K1_W
    s_sub_u32 s11, s2, 1024
    s_and_b32 s12, s11, 7
    s_lshr_b32 s11, s11, 3
    s_cmp_ge_u32 s11, 42
    s_cselect_b32 s13, 1, 0
    s_mul_i32 s14, s13, 42
    s_sub_u32 s11, s11, s14
    s_lshl_b32 s11, s11, 2
    s_add_u32 s11, s11, s3
    s_mul_i32 s14, s13, 16384000
    s_add_u32 s16, s4, s14
    s_addc_u32 s17, s5, 0
    s_and_b32 s17, s17, 0xffff
    s_mov_b32 s18, 16384000
    s_mov_b32 s19, 0x00020000
    s_mov_b32 s20, s8
    s_mov_b32 s21, s9
    s_and_b32 s21, s21, 0xffff
    s_mov_b32 s22, 43778048
    s_mov_b32 s23, 0x00020000
    v_lshlrev_b32 v126, 14, v123
    v_lshl_add_u32 v126, v122, 4, v126
    s_mul_i32 s15, s11, 98304
    s_lshl_b32 s24, s12, 8
    s_add_u32 s15, s15, s24
    buffer_load_dwordx4 v[0:3], v126, s[16:19], s15 offen
    buffer_load_dwordx4 v[4:7], v126, s[16:19], s15 offen offset:2048
    s_add_u32 s15, s15, 4096
    buffer_load_dwordx4 v[8:11], v126, s[16:19], s15 offen
    buffer_load_dwordx4 v[12:15], v126, s[16:19], s15 offen offset:2048
    s_add_u32 s15, s15, 4096
    buffer_load_dwordx4 v[16:19], v126, s[16:19], s15 offen
    buffer_load_dwordx4 v[20:23], v126, s[16:19], s15 offen offset:2048
    s_add_u32 s15, s15, 4096
    buffer_load_dwordx4 v[24:27], v126, s[16:19], s15 offen
    buffer_load_dwordx4 v[28:31], v126, s[16:19], s15 offen offset:2048
    s_add_u32 s15, s15, 53248
    buffer_load_dwordx4 v[32:35], v126, s[16:19], s15 offen
    buffer_load_dwordx4 v[36:39], v126, s[16:19], s15 offen offset:2048
    s_add_u32 s15, s15, 4096
    buffer_load_dwordx4 v[40:43], v126, s[16:19], s15 offen
    buffer_load_dwordx4 v[44:47], v126, s[16:19], s15 offen offset:2048
    s_add_u32 s15, s15, 4096
    buffer_load_dwordx4 v[48:51], v126, s[16:19], s15 offen
    buffer_load_dwordx4 v[52:55], v126, s[16:19], s15 offen offset:2048
    s_add_u32 s15, s15, 4096
    buffer_load_dwordx4 v[56:59], v126, s[16:19], s15 offen
    buffer_load_dwordx4 v[60:63], v126, s[16:19], s15 offen offset:2048
    v_lshlrev_b32 v127, 3, v123
    v_lshlrev_b32 v112, 5, v125
    v_mad_u32_u24 v113, v124, v127, v112
    v_mad_u32_u24 v64, v124, 0, v113
    v_mad_u32_u24 v65, v124, 1, v113
    v_mad_u32_u24 v66, v124, 2, v113
    v_mad_u32_u24 v67, v124, 3, v113
    v_mad_u32_u24 v68, v124, 4, v113
    v_mad_u32_u24 v69, v124, 5, v113
    v_mad_u32_u24 v70, v124, 6, v113
    v_mad_u32_u24 v71, v124, 7, v113
    v_and_b32 v64, 127, v64
    v_and_b32 v65, 127, v65
    v_and_b32 v66, 127, v66
    v_and_b32 v67, 127, v67
    v_and_b32 v68, 127, v68
    v_and_b32 v69, 127, v69
    v_and_b32 v70, 127, v70
    v_and_b32 v71, 127, v71
    v_cvt_f32_u32 v64, v64
    v_cvt_f32_u32 v65, v65
    v_cvt_f32_u32 v66, v66
    v_cvt_f32_u32 v67, v67
    v_cvt_f32_u32 v68, v68
    v_cvt_f32_u32 v69, v69
    v_cvt_f32_u32 v70, v70
    v_cvt_f32_u32 v71, v71
    v_mul_f32 v64, 0x3c000000, v64
    v_mul_f32 v65, 0x3c000000, v65
    v_mul_f32 v66, 0x3c000000, v66
    v_mul_f32 v67, 0x3c000000, v67
    v_mul_f32 v68, 0x3c000000, v68
    v_mul_f32 v69, 0x3c000000, v69
    v_mul_f32 v70, 0x3c000000, v70
    v_mul_f32 v71, 0x3c000000, v71
    v_cos_f32 v64, v64
    v_cos_f32 v65, v65
    v_cos_f32 v66, v66
    v_cos_f32 v67, v67
    v_cos_f32 v68, v68
    v_cos_f32 v69, v69
    v_cos_f32 v70, v70
    v_cos_f32 v71, v71
    s_nop 0
    v_cvt_pk_bf16_f32 v72, v64, v65
    v_cvt_pk_bf16_f32 v73, v66, v67
    v_cvt_pk_bf16_f32 v74, v68, v69
    v_cvt_pk_bf16_f32 v75, v70, v71
    v_lshlrev_b32 v80, 16, v72
    v_and_b32 v81, 0xffff0000, v72
    v_sub_f32 v64, v64, v80
    v_sub_f32 v65, v65, v81
    v_lshlrev_b32 v80, 16, v73
    v_and_b32 v81, 0xffff0000, v73
    v_sub_f32 v66, v66, v80
    v_sub_f32 v67, v67, v81
    v_lshlrev_b32 v80, 16, v74
    v_and_b32 v81, 0xffff0000, v74
    v_sub_f32 v68, v68, v80
    v_sub_f32 v69, v69, v81
    v_lshlrev_b32 v80, 16, v75
    v_and_b32 v81, 0xffff0000, v75
    v_sub_f32 v70, v70, v80
    v_sub_f32 v71, v71, v81
    v_cvt_pk_bf16_f32 v76, v64, v65
    v_cvt_pk_bf16_f32 v77, v66, v67
    v_cvt_pk_bf16_f32 v78, v68, v69
    v_cvt_pk_bf16_f32 v79, v70, v71
    s_lshl_b32 s24, s3, 12
    v_add_u32 v114, s24, v121
    ds_write_b128 v114, v[72:75] offset:0
    ds_write_b128 v114, v[76:79] offset:1024
    v_add_u32 v127, 32, v127
    v_lshlrev_b32 v112, 5, v125
    v_mad_u32_u24 v113, v124, v127, v112
    v_mad_u32_u24 v64, v124, 0, v113
    v_mad_u32_u24 v65, v124, 1, v113
    v_mad_u32_u24 v66, v124, 2, v113
    v_mad_u32_u24 v67, v124, 3, v113
    v_mad_u32_u24 v68, v124, 4, v113
    v_mad_u32_u24 v69, v124, 5, v113
    v_mad_u32_u24 v70, v124, 6, v113
    v_mad_u32_u24 v71, v124, 7, v113
    v_and_b32 v64, 127, v64
    v_and_b32 v65, 127, v65
    v_and_b32 v66, 127, v66
    v_and_b32 v67, 127, v67
    v_and_b32 v68, 127, v68
    v_and_b32 v69, 127, v69
    v_and_b32 v70, 127, v70
    v_and_b32 v71, 127, v71
    v_cvt_f32_u32 v64, v64
    v_cvt_f32_u32 v65, v65
    v_cvt_f32_u32 v66, v66
    v_cvt_f32_u32 v67, v67
    v_cvt_f32_u32 v68, v68
    v_cvt_f32_u32 v69, v69
    v_cvt_f32_u32 v70, v70
    v_cvt_f32_u32 v71, v71
    v_mul_f32 v64, 0x3c000000, v64
    v_mul_f32 v65, 0x3c000000, v65
    v_mul_f32 v66, 0x3c000000, v66
    v_mul_f32 v67, 0x3c000000, v67
    v_mul_f32 v68, 0x3c000000, v68
    v_mul_f32 v69, 0x3c000000, v69
    v_mul_f32 v70, 0x3c000000, v70
    v_mul_f32 v71, 0x3c000000, v71
    v_cos_f32 v64, v64
    v_cos_f32 v65, v65
    v_cos_f32 v66, v66
    v_cos_f32 v67, v67
    v_cos_f32 v68, v68
    v_cos_f32 v69, v69
    v_cos_f32 v70, v70
    v_cos_f32 v71, v71
    s_nop 0
    v_cvt_pk_bf16_f32 v72, v64, v65
    v_cvt_pk_bf16_f32 v73, v66, v67
    v_cvt_pk_bf16_f32 v74, v68, v69
    v_cvt_pk_bf16_f32 v75, v70, v71
    v_lshlrev_b32 v80, 16, v72
    v_and_b32 v81, 0xffff0000, v72
    v_sub_f32 v64, v64, v80
    v_sub_f32 v65, v65, v81
    v_lshlrev_b32 v80, 16, v73
    v_and_b32 v81, 0xffff0000, v73
    v_sub_f32 v66, v66, v80
    v_sub_f32 v67, v67, v81
    v_lshlrev_b32 v80, 16, v74
    v_and_b32 v81, 0xffff0000, v74
    v_sub_f32 v68, v68, v80
    v_sub_f32 v69, v69, v81
    v_lshlrev_b32 v80, 16, v75
    v_and_b32 v81, 0xffff0000, v75
    v_sub_f32 v70, v70, v80
    v_sub_f32 v71, v71, v81
    v_cvt_pk_bf16_f32 v76, v64, v65
    v_cvt_pk_bf16_f32 v77, v66, v67
    v_cvt_pk_bf16_f32 v78, v68, v69
    v_cvt_pk_bf16_f32 v79, v70, v71
    s_lshl_b32 s24, s3, 12
    v_add_u32 v114, s24, v121
    ds_write_b128 v114, v[72:75] offset:2048
    ds_write_b128 v114, v[76:79] offset:3072
    v_lshrrev_b32 v112, 1, v123
    s_mov_b32 s24, 1368064
    v_mul_lo_u32 v112, v112, s24
    v_lshrrev_b32 v113, 2, v122
    s_mov_b32 s24, 21376
    v_mul_lo_u32 v113, v113, s24
    v_add_u32 v112, v112, v113
    v_and_b32 v113, 3, v122
    v_and_b32 v114, 1, v123
    v_lshl_add_u32 v113, v114, 2, v113
    s_lshr_b32 s24, s11, 1
    s_and_b32 s24, s24, 7
    v_xor_b32 v113, s24, v113
    v_lshl_add_u32 v120, v113, 4, v112
    s_mul_i32 s25, s13, 684032
    s_mul_i32 s24, s12, 85504
    s_add_u32 s25, s25, s24
    s_lshl_b32 s24, s11, 7
    s_add_u32 s25, s25, s24
    s_waitcnt lgkmcnt(0)
    s_barrier
    s_cmp_ge_u32 s11, 167
    s_cbranch_scc1 K1_END
    s_waitcnt vmcnt(8)
    v_perm_b32 v64, v4, v0, s28
    v_perm_b32 v68, v4, v0, s29
    v_perm_b32 v65, v12, v8, s28
    v_perm_b32 v69, v12, v8, s29
    v_perm_b32 v66, v20, v16, s28
    v_perm_b32 v70, v20, v16, s29
    v_perm_b32 v67, v28, v24, s28
    v_perm_b32 v71, v28, v24, s29
    v_perm_b32 v72, v5, v1, s28
    v_perm_b32 v76, v5, v1, s29
    v_perm_b32 v73, v13, v9, s28
    v_perm_b32 v77, v13, v9, s29
    v_perm_b32 v74, v21, v17, s28
    v_perm_b32 v78, v21, v17, s29
    v_perm_b32 v75, v29, v25, s28
    v_perm_b32 v79, v29, v25, s29
    v_perm_b32 v80, v6, v2, s28
    v_perm_b32 v84, v6, v2, s29
    v_perm_b32 v81, v14, v10, s28
    v_perm_b32 v85, v14, v10, s29
    v_perm_b32 v82, v22, v18, s28
    v_perm_b32 v86, v22, v18, s29
    v_perm_b32 v83, v30, v26, s28
    v_perm_b32 v87, v30, v26, s29
    v_perm_b32 v88, v7, v3, s28
    v_perm_b32 v92, v7, v3, s29
    v_perm_b32 v89, v15, v11, s28
    v_perm_b32 v93, v15, v11, s29
    v_perm_b32 v90, v23, v19, s28
    v_perm_b32 v94, v23, v19, s29
    v_perm_b32 v91, v31, v27, s28
    v_perm_b32 v95, v31, v27, s29
    s_waitcnt vmcnt(0)
    v_perm_b32 v0, v36, v32, s28
    v_perm_b32 v4, v36, v32, s29
    v_perm_b32 v1, v44, v40, s28
    v_perm_b32 v5, v44, v40, s29
    v_perm_b32 v2, v52, v48, s28
    v_perm_b32 v6, v52, v48, s29
    v_perm_b32 v3, v60, v56, s28
    v_perm_b32 v7, v60, v56, s29
    v_perm_b32 v8, v37, v33, s28
    v_perm_b32 v12, v37, v33, s29
    v_perm_b32 v9, v45, v41, s28
    v_perm_b32 v13, v45, v41, s29
    v_perm_b32 v10, v53, v49, s28
    v_perm_b32 v14, v53, v49, s29
    v_perm_b32 v11, v61, v57, s28
    v_perm_b32 v15, v61, v57, s29
    v_perm_b32 v16, v38, v34, s28
    v_perm_b32 v20, v38, v34, s29
    v_perm_b32 v17, v46, v42, s28
    v_perm_b32 v21, v46, v42, s29
    v_perm_b32 v18, v54, v50, s28
    v_perm_b32 v22, v54, v50, s29
    v_perm_b32 v19, v62, v58, s28
    v_perm_b32 v23, v62, v58, s29
    v_perm_b32 v24, v39, v35, s28
    v_perm_b32 v28, v39, v35, s29
    v_perm_b32 v25, v47, v43, s28
    v_perm_b32 v29, v47, v43, s29
    v_perm_b32 v26, v55, v51, s28
    v_perm_b32 v30, v55, v51, s29
    v_perm_b32 v27, v63, v59, s28
    v_perm_b32 v31, v63, v59, s29
    ds_read_b128 v[96:99], v121 offset:0
    ds_read_b128 v[100:103], v121 offset:1024
    ds_read_b128 v[104:107], v121 offset:2048
    ds_read_b128 v[108:111], v121 offset:3072
    s_waitcnt lgkmcnt(3)
    v_mfma_f32_16x16x32_bf16 v[32:35], v[96:99], v[64:67], 0
    v_mfma_f32_16x16x32_bf16 v[36:39], v[96:99], v[68:71], 0
    v_mfma_f32_16x16x32_bf16 v[40:43], v[96:99], v[72:75], 0
    v_mfma_f32_16x16x32_bf16 v[44:47], v[96:99], v[76:79], 0
    v_mfma_f32_16x16x32_bf16 v[48:51], v[96:99], v[80:83], 0
    v_mfma_f32_16x16x32_bf16 v[52:55], v[96:99], v[84:87], 0
    v_mfma_f32_16x16x32_bf16 v[56:59], v[96:99], v[88:91], 0
    v_mfma_f32_16x16x32_bf16 v[60:63], v[96:99], v[92:95], 0
    s_waitcnt lgkmcnt(2)
    v_mfma_f32_16x16x32_bf16 v[32:35], v[100:103], v[64:67], v[32:35]
    v_mfma_f32_16x16x32_bf16 v[36:39], v[100:103], v[68:71], v[36:39]
    v_mfma_f32_16x16x32_bf16 v[40:43], v[100:103], v[72:75], v[40:43]
    v_mfma_f32_16x16x32_bf16 v[44:47], v[100:103], v[76:79], v[44:47]
    v_mfma_f32_16x16x32_bf16 v[48:51], v[100:103], v[80:83], v[48:51]
    v_mfma_f32_16x16x32_bf16 v[52:55], v[100:103], v[84:87], v[52:55]
    v_mfma_f32_16x16x32_bf16 v[56:59], v[100:103], v[88:91], v[56:59]
    v_mfma_f32_16x16x32_bf16 v[60:63], v[100:103], v[92:95], v[60:63]
    s_waitcnt lgkmcnt(1)
    v_mfma_f32_16x16x32_bf16 v[32:35], v[104:107], v[0:3], v[32:35]
    v_mfma_f32_16x16x32_bf16 v[36:39], v[104:107], v[4:7], v[36:39]
    v_mfma_f32_16x16x32_bf16 v[40:43], v[104:107], v[8:11], v[40:43]
    v_mfma_f32_16x16x32_bf16 v[44:47], v[104:107], v[12:15], v[44:47]
    v_mfma_f32_16x16x32_bf16 v[48:51], v[104:107], v[16:19], v[48:51]
    v_mfma_f32_16x16x32_bf16 v[52:55], v[104:107], v[20:23], v[52:55]
    v_mfma_f32_16x16x32_bf16 v[56:59], v[104:107], v[24:27], v[56:59]
    v_mfma_f32_16x16x32_bf16 v[60:63], v[104:107], v[28:31], v[60:63]
    s_waitcnt lgkmcnt(0)
    v_mfma_f32_16x16x32_bf16 v[32:35], v[108:111], v[0:3], v[32:35]
    v_mfma_f32_16x16x32_bf16 v[36:39], v[108:111], v[4:7], v[36:39]
    v_mfma_f32_16x16x32_bf16 v[40:43], v[108:111], v[8:11], v[40:43]
    v_mfma_f32_16x16x32_bf16 v[44:47], v[108:111], v[12:15], v[44:47]
    v_mfma_f32_16x16x32_bf16 v[48:51], v[108:111], v[16:19], v[48:51]
    v_mfma_f32_16x16x32_bf16 v[52:55], v[108:111], v[20:23], v[52:55]
    v_mfma_f32_16x16x32_bf16 v[56:59], v[108:111], v[24:27], v[56:59]
    v_mfma_f32_16x16x32_bf16 v[60:63], v[108:111], v[28:31], v[60:63]
    s_nop 7
    v_cvt_pk_bf16_f32 v112, v32, v36
    v_cvt_pk_bf16_f32 v113, v40, v44
    v_cvt_pk_bf16_f32 v114, v48, v52
    v_cvt_pk_bf16_f32 v115, v56, v60
    buffer_store_dwordx4 v[112:115], v120, s[20:23], s25 offen
    s_add_u32 s25, s25, 2736128
    v_cvt_pk_bf16_f32 v116, v33, v37
    v_cvt_pk_bf16_f32 v117, v41, v45
    v_cvt_pk_bf16_f32 v118, v49, v53
    v_cvt_pk_bf16_f32 v119, v57, v61
    buffer_store_dwordx4 v[116:119], v120, s[20:23], s25 offen
    s_add_u32 s25, s25, 2736128
    v_cvt_pk_bf16_f32 v112, v34, v38
    v_cvt_pk_bf16_f32 v113, v42, v46
    v_cvt_pk_bf16_f32 v114, v50, v54
    v_cvt_pk_bf16_f32 v115, v58, v62
    buffer_store_dwordx4 v[112:115], v120, s[20:23], s25 offen
    s_add_u32 s25, s25, 2736128
    v_cvt_pk_bf16_f32 v116, v35, v39
    v_cvt_pk_bf16_f32 v117, v43, v47
    v_cvt_pk_bf16_f32 v118, v51, v55
    v_cvt_pk_bf16_f32 v119, v59, v63
    buffer_store_dwordx4 v[116:119], v120, s[20:23], s25 offen
    s_add_u32 s25, s25, 2736128
    ds_read_b128 v[96:99], v121 offset:4096
    ds_read_b128 v[100:103], v121 offset:5120
    ds_read_b128 v[104:107], v121 offset:6144
    ds_read_b128 v[108:111], v121 offset:7168
    s_waitcnt lgkmcnt(3)
    v_mfma_f32_16x16x32_bf16 v[32:35], v[96:99], v[64:67], 0
    v_mfma_f32_16x16x32_bf16 v[36:39], v[96:99], v[68:71], 0
    v_mfma_f32_16x16x32_bf16 v[40:43], v[96:99], v[72:75], 0
    v_mfma_f32_16x16x32_bf16 v[44:47], v[96:99], v[76:79], 0
    v_mfma_f32_16x16x32_bf16 v[48:51], v[96:99], v[80:83], 0
    v_mfma_f32_16x16x32_bf16 v[52:55], v[96:99], v[84:87], 0
    v_mfma_f32_16x16x32_bf16 v[56:59], v[96:99], v[88:91], 0
    v_mfma_f32_16x16x32_bf16 v[60:63], v[96:99], v[92:95], 0
    s_waitcnt lgkmcnt(2)
    v_mfma_f32_16x16x32_bf16 v[32:35], v[100:103], v[64:67], v[32:35]
    v_mfma_f32_16x16x32_bf16 v[36:39], v[100:103], v[68:71], v[36:39]
    v_mfma_f32_16x16x32_bf16 v[40:43], v[100:103], v[72:75], v[40:43]
    v_mfma_f32_16x16x32_bf16 v[44:47], v[100:103], v[76:79], v[44:47]
    v_mfma_f32_16x16x32_bf16 v[48:51], v[100:103], v[80:83], v[48:51]
    v_mfma_f32_16x16x32_bf16 v[52:55], v[100:103], v[84:87], v[52:55]
    v_mfma_f32_16x16x32_bf16 v[56:59], v[100:103], v[88:91], v[56:59]
    v_mfma_f32_16x16x32_bf16 v[60:63], v[100:103], v[92:95], v[60:63]
    s_waitcnt lgkmcnt(1)
    v_mfma_f32_16x16x32_bf16 v[32:35], v[104:107], v[0:3], v[32:35]
    v_mfma_f32_16x16x32_bf16 v[36:39], v[104:107], v[4:7], v[36:39]
    v_mfma_f32_16x16x32_bf16 v[40:43], v[104:107], v[8:11], v[40:43]
    v_mfma_f32_16x16x32_bf16 v[44:47], v[104:107], v[12:15], v[44:47]
    v_mfma_f32_16x16x32_bf16 v[48:51], v[104:107], v[16:19], v[48:51]
    v_mfma_f32_16x16x32_bf16 v[52:55], v[104:107], v[20:23], v[52:55]
    v_mfma_f32_16x16x32_bf16 v[56:59], v[104:107], v[24:27], v[56:59]
    v_mfma_f32_16x16x32_bf16 v[60:63], v[104:107], v[28:31], v[60:63]
    s_waitcnt lgkmcnt(0)
    v_mfma_f32_16x16x32_bf16 v[32:35], v[108:111], v[0:3], v[32:35]
    v_mfma_f32_16x16x32_bf16 v[36:39], v[108:111], v[4:7], v[36:39]
    v_mfma_f32_16x16x32_bf16 v[40:43], v[108:111], v[8:11], v[40:43]
    v_mfma_f32_16x16x32_bf16 v[44:47], v[108:111], v[12:15], v[44:47]
    v_mfma_f32_16x16x32_bf16 v[48:51], v[108:111], v[16:19], v[48:51]
    v_mfma_f32_16x16x32_bf16 v[52:55], v[108:111], v[20:23], v[52:55]
    v_mfma_f32_16x16x32_bf16 v[56:59], v[108:111], v[24:27], v[56:59]
    v_mfma_f32_16x16x32_bf16 v[60:63], v[108:111], v[28:31], v[60:63]
    s_nop 7
    v_cvt_pk_bf16_f32 v112, v32, v36
    v_cvt_pk_bf16_f32 v113, v40, v44
    v_cvt_pk_bf16_f32 v114, v48, v52
    v_cvt_pk_bf16_f32 v115, v56, v60
    buffer_store_dwordx4 v[112:115], v120, s[20:23], s25 offen
    s_add_u32 s25, s25, 2736128
    v_cvt_pk_bf16_f32 v116, v33, v37
    v_cvt_pk_bf16_f32 v117, v41, v45
    v_cvt_pk_bf16_f32 v118, v49, v53
    v_cvt_pk_bf16_f32 v119, v57, v61
    buffer_store_dwordx4 v[116:119], v120, s[20:23], s25 offen
    s_add_u32 s25, s25, 2736128
    v_cvt_pk_bf16_f32 v112, v34, v38
    v_cvt_pk_bf16_f32 v113, v42, v46
    v_cvt_pk_bf16_f32 v114, v50, v54
    v_cvt_pk_bf16_f32 v115, v58, v62
    buffer_store_dwordx4 v[112:115], v120, s[20:23], s25 offen
    s_add_u32 s25, s25, 2736128
    v_cvt_pk_bf16_f32 v116, v35, v39
    v_cvt_pk_bf16_f32 v117, v43, v47
    v_cvt_pk_bf16_f32 v118, v51, v55
    v_cvt_pk_bf16_f32 v119, v59, v63
    buffer_store_dwordx4 v[116:119], v120, s[20:23], s25 offen
    s_add_u32 s25, s25, 2736128
    ds_read_b128 v[96:99], v121 offset:8192
    ds_read_b128 v[100:103], v121 offset:9216
    ds_read_b128 v[104:107], v121 offset:10240
    ds_read_b128 v[108:111], v121 offset:11264
    s_waitcnt lgkmcnt(3)
    v_mfma_f32_16x16x32_bf16 v[32:35], v[96:99], v[64:67], 0
    v_mfma_f32_16x16x32_bf16 v[36:39], v[96:99], v[68:71], 0
    v_mfma_f32_16x16x32_bf16 v[40:43], v[96:99], v[72:75], 0
    v_mfma_f32_16x16x32_bf16 v[44:47], v[96:99], v[76:79], 0
    v_mfma_f32_16x16x32_bf16 v[48:51], v[96:99], v[80:83], 0
    v_mfma_f32_16x16x32_bf16 v[52:55], v[96:99], v[84:87], 0
    v_mfma_f32_16x16x32_bf16 v[56:59], v[96:99], v[88:91], 0
    v_mfma_f32_16x16x32_bf16 v[60:63], v[96:99], v[92:95], 0
    s_waitcnt lgkmcnt(2)
    v_mfma_f32_16x16x32_bf16 v[32:35], v[100:103], v[64:67], v[32:35]
    v_mfma_f32_16x16x32_bf16 v[36:39], v[100:103], v[68:71], v[36:39]
    v_mfma_f32_16x16x32_bf16 v[40:43], v[100:103], v[72:75], v[40:43]
    v_mfma_f32_16x16x32_bf16 v[44:47], v[100:103], v[76:79], v[44:47]
    v_mfma_f32_16x16x32_bf16 v[48:51], v[100:103], v[80:83], v[48:51]
    v_mfma_f32_16x16x32_bf16 v[52:55], v[100:103], v[84:87], v[52:55]
    v_mfma_f32_16x16x32_bf16 v[56:59], v[100:103], v[88:91], v[56:59]
    v_mfma_f32_16x16x32_bf16 v[60:63], v[100:103], v[92:95], v[60:63]
    s_waitcnt lgkmcnt(1)
    v_mfma_f32_16x16x32_bf16 v[32:35], v[104:107], v[0:3], v[32:35]
    v_mfma_f32_16x16x32_bf16 v[36:39], v[104:107], v[4:7], v[36:39]
    v_mfma_f32_16x16x32_bf16 v[40:43], v[104:107], v[8:11], v[40:43]
    v_mfma_f32_16x16x32_bf16 v[44:47], v[104:107], v[12:15], v[44:47]
    v_mfma_f32_16x16x32_bf16 v[48:51], v[104:107], v[16:19], v[48:51]
    v_mfma_f32_16x16x32_bf16 v[52:55], v[104:107], v[20:23], v[52:55]
    v_mfma_f32_16x16x32_bf16 v[56:59], v[104:107], v[24:27], v[56:59]
    v_mfma_f32_16x16x32_bf16 v[60:63], v[104:107], v[28:31], v[60:63]
    s_waitcnt lgkmcnt(0)
    v_mfma_f32_16x16x32_bf16 v[32:35], v[108:111], v[0:3], v[32:35]
    v_mfma_f32_16x16x32_bf16 v[36:39], v[108:111], v[4:7], v[36:39]
    v_mfma_f32_16x16x32_bf16 v[40:43], v[108:111], v[8:11], v[40:43]
    v_mfma_f32_16x16x32_bf16 v[44:47], v[108:111], v[12:15], v[44:47]
    v_mfma_f32_16x16x32_bf16 v[48:51], v[108:111], v[16:19], v[48:51]
    v_mfma_f32_16x16x32_bf16 v[52:55], v[108:111], v[20:23], v[52:55]
    v_mfma_f32_16x16x32_bf16 v[56:59], v[108:111], v[24:27], v[56:59]
    v_mfma_f32_16x16x32_bf16 v[60:63], v[108:111], v[28:31], v[60:63]
    s_nop 7
    v_cvt_pk_bf16_f32 v112, v32, v36
    v_cvt_pk_bf16_f32 v113, v40, v44
    v_cvt_pk_bf16_f32 v114, v48, v52
    v_cvt_pk_bf16_f32 v115, v56, v60
    buffer_store_dwordx4 v[112:115], v120, s[20:23], s25 offen
    s_add_u32 s25, s25, 2736128
    v_cvt_pk_bf16_f32 v116, v33, v37
    v_cvt_pk_bf16_f32 v117, v41, v45
    v_cvt_pk_bf16_f32 v118, v49, v53
    v_cvt_pk_bf16_f32 v119, v57, v61
    buffer_store_dwordx4 v[116:119], v120, s[20:23], s25 offen
    s_add_u32 s25, s25, 2736128
    v_cvt_pk_bf16_f32 v112, v34, v38
    v_cvt_pk_bf16_f32 v113, v42, v46
    v_cvt_pk_bf16_f32 v114, v50, v54
    v_cvt_pk_bf16_f32 v115, v58, v62
    buffer_store_dwordx4 v[112:115], v120, s[20:23], s25 offen
    s_add_u32 s25, s25, 2736128
    v_cvt_pk_bf16_f32 v116, v35, v39
    v_cvt_pk_bf16_f32 v117, v43, v47
    v_cvt_pk_bf16_f32 v118, v51, v55
    v_cvt_pk_bf16_f32 v119, v59, v63
    buffer_store_dwordx4 v[116:119], v120, s[20:23], s25 offen
    s_add_u32 s25, s25, 2736128
    ds_read_b128 v[96:99], v121 offset:12288
    ds_read_b128 v[100:103], v121 offset:13312
    ds_read_b128 v[104:107], v121 offset:14336
    ds_read_b128 v[108:111], v121 offset:15360
    s_waitcnt lgkmcnt(3)
    v_mfma_f32_16x16x32_bf16 v[32:35], v[96:99], v[64:67], 0
    v_mfma_f32_16x16x32_bf16 v[36:39], v[96:99], v[68:71], 0
    v_mfma_f32_16x16x32_bf16 v[40:43], v[96:99], v[72:75], 0
    v_mfma_f32_16x16x32_bf16 v[44:47], v[96:99], v[76:79], 0
    v_mfma_f32_16x16x32_bf16 v[48:51], v[96:99], v[80:83], 0
    v_mfma_f32_16x16x32_bf16 v[52:55], v[96:99], v[84:87], 0
    v_mfma_f32_16x16x32_bf16 v[56:59], v[96:99], v[88:91], 0
    v_mfma_f32_16x16x32_bf16 v[60:63], v[96:99], v[92:95], 0
    s_waitcnt lgkmcnt(2)
    v_mfma_f32_16x16x32_bf16 v[32:35], v[100:103], v[64:67], v[32:35]
    v_mfma_f32_16x16x32_bf16 v[36:39], v[100:103], v[68:71], v[36:39]
    v_mfma_f32_16x16x32_bf16 v[40:43], v[100:103], v[72:75], v[40:43]
    v_mfma_f32_16x16x32_bf16 v[44:47], v[100:103], v[76:79], v[44:47]
    v_mfma_f32_16x16x32_bf16 v[48:51], v[100:103], v[80:83], v[48:51]
    v_mfma_f32_16x16x32_bf16 v[52:55], v[100:103], v[84:87], v[52:55]
    v_mfma_f32_16x16x32_bf16 v[56:59], v[100:103], v[88:91], v[56:59]
    v_mfma_f32_16x16x32_bf16 v[60:63], v[100:103], v[92:95], v[60:63]
    s_waitcnt lgkmcnt(1)
    v_mfma_f32_16x16x32_bf16 v[32:35], v[104:107], v[0:3], v[32:35]
    v_mfma_f32_16x16x32_bf16 v[36:39], v[104:107], v[4:7], v[36:39]
    v_mfma_f32_16x16x32_bf16 v[40:43], v[104:107], v[8:11], v[40:43]
    v_mfma_f32_16x16x32_bf16 v[44:47], v[104:107], v[12:15], v[44:47]
    v_mfma_f32_16x16x32_bf16 v[48:51], v[104:107], v[16:19], v[48:51]
    v_mfma_f32_16x16x32_bf16 v[52:55], v[104:107], v[20:23], v[52:55]
    v_mfma_f32_16x16x32_bf16 v[56:59], v[104:107], v[24:27], v[56:59]
    v_mfma_f32_16x16x32_bf16 v[60:63], v[104:107], v[28:31], v[60:63]
    s_waitcnt lgkmcnt(0)
    v_mfma_f32_16x16x32_bf16 v[32:35], v[108:111], v[0:3], v[32:35]
    v_mfma_f32_16x16x32_bf16 v[36:39], v[108:111], v[4:7], v[36:39]
    v_mfma_f32_16x16x32_bf16 v[40:43], v[108:111], v[8:11], v[40:43]
    v_mfma_f32_16x16x32_bf16 v[44:47], v[108:111], v[12:15], v[44:47]
    v_mfma_f32_16x16x32_bf16 v[48:51], v[108:111], v[16:19], v[48:51]
    v_mfma_f32_16x16x32_bf16 v[52:55], v[108:111], v[20:23], v[52:55]
    v_mfma_f32_16x16x32_bf16 v[56:59], v[108:111], v[24:27], v[56:59]
    v_mfma_f32_16x16x32_bf16 v[60:63], v[108:111], v[28:31], v[60:63]
    s_nop 7
    v_cvt_pk_bf16_f32 v112, v32, v36
    v_cvt_pk_bf16_f32 v113, v40, v44
    v_cvt_pk_bf16_f32 v114, v48, v52
    v_cvt_pk_bf16_f32 v115, v56, v60
    buffer_store_dwordx4 v[112:115], v120, s[20:23], s25 offen
    s_add_u32 s25, s25, 2736128
    v_cvt_pk_bf16_f32 v116, v33, v37
    v_cvt_pk_bf16_f32 v117, v41, v45
    v_cvt_pk_bf16_f32 v118, v49, v53
    v_cvt_pk_bf16_f32 v119, v57, v61
    buffer_store_dwordx4 v[116:119], v120, s[20:23], s25 offen
    s_add_u32 s25, s25, 2736128
    v_cvt_pk_bf16_f32 v112, v34, v38
    v_cvt_pk_bf16_f32 v113, v42, v46
    v_cvt_pk_bf16_f32 v114, v50, v54
    v_cvt_pk_bf16_f32 v115, v58, v62
    buffer_store_dwordx4 v[112:115], v120, s[20:23], s25 offen
    s_add_u32 s25, s25, 2736128
    v_cvt_pk_bf16_f32 v116, v35, v39
    v_cvt_pk_bf16_f32 v117, v43, v47
    v_cvt_pk_bf16_f32 v118, v51, v55
    v_cvt_pk_bf16_f32 v119, v59, v63
    buffer_store_dwordx4 v[116:119], v120, s[20:23], s25 offen
    s_endpgm
K1_W:
    s_mov_b32 s16, s6
    s_mov_b32 s17, s7
    s_and_b32 s17, s17, 0xffff
    s_mov_b32 s18, 16252928
    s_mov_b32 s19, 0x00020000
    s_add_u32 s20, s8, 50331648
    s_addc_u32 s21, s9, 0
    s_and_b32 s21, s21, 0xffff
    s_mov_b32 s22, 67108864
    s_mov_b32 s23, 0x00020000
    s_mul_i32 s11, s2, 1
    s_lshr_b32 s12, s11, 9
    s_and_b32 s13, s11, 511
    s_lshl_b32 s14, s12, 19
    s_lshl_b32 s15, s13, 10
    s_add_u32 s14, s14, s15
    s_lshl_b32 s15, s3, 8
    s_add_u32 s14, s14, s15
    v_and_b32 v126, 1, v123
    v_lshlrev_b32 v126, 23, v126
    v_lshl_add_u32 v126, v122, 4, v126
    s_mov_b32 s15, s14
    buffer_load_dwordx4 v[0:3], v126, s[16:19], s15 offen
    s_add_u32 s15, s15, 0x100000
    buffer_load_dwordx4 v[4:7], v126, s[16:19], s15 offen
    s_add_u32 s15, s15, 0x100000
    buffer_load_dwordx4 v[8:11], v126, s[16:19], s15 offen
    s_add_u32 s15, s15, 0x100000
    buffer_load_dwordx4 v[12:15], v126, s[16:19], s15 offen
    s_add_u32 s15, s15, 0x100000
    buffer_load_dwordx4 v[16:19], v126, s[16:19], s15 offen
    s_add_u32 s15, s15, 0x100000
    buffer_load_dwordx4 v[20:23], v126, s[16:19], s15 offen
    s_add_u32 s15, s15, 0x100000
    buffer_load_dwordx4 v[24:27], v126, s[16:19], s15 offen
    s_add_u32 s15, s15, 0x100000
    buffer_load_dwordx4 v[28:31], v126, s[16:19], s15 offen
    v_and_b32 v127, 1, v123
    v_lshlrev_b32 v127, 3, v127
    v_mul_u32_u24 v112, 96, v125
    v_mad_u32_u24 v113, v124, v127, v112
    v_mad_u32_u24 v64, v124, 0, v113
    v_mad_u32_u24 v65, v124, 1, v113
    v_mad_u32_u24 v66, v124, 2, v113
    v_mad_u32_u24 v67, v124, 3, v113
    v_mad_u32_u24 v68, v124, 4, v113
    v_mad_u32_u24 v69, v124, 5, v113
    v_mad_u32_u24 v70, v124, 6, v113
    v_mad_u32_u24 v71, v124, 7, v113
    v_and_b32 v64, 127, v64
    v_and_b32 v65, 127, v65
    v_and_b32 v66, 127, v66
    v_and_b32 v67, 127, v67
    v_and_b32 v68, 127, v68
    v_and_b32 v69, 127, v69
    v_and_b32 v70, 127, v70
    v_and_b32 v71, 127, v71
    v_cvt_f32_u32 v64, v64
    v_cvt_f32_u32 v65, v65
    v_cvt_f32_u32 v66, v66
    v_cvt_f32_u32 v67, v67
    v_cvt_f32_u32 v68, v68
    v_cvt_f32_u32 v69, v69
    v_cvt_f32_u32 v70, v70
    v_cvt_f32_u32 v71, v71
    v_mul_f32 v64, 0x3c000000, v64
    v_mul_f32 v65, 0x3c000000, v65
    v_mul_f32 v66, 0x3c000000, v66
    v_mul_f32 v67, 0x3c000000, v67
    v_mul_f32 v68, 0x3c000000, v68
    v_mul_f32 v69, 0x3c000000, v69
    v_mul_f32 v70, 0x3c000000, v70
    v_mul_f32 v71, 0x3c000000, v71
    v_cos_f32 v64, v64
    v_cos_f32 v65, v65
    v_cos_f32 v66, v66
    v_cos_f32 v67, v67
    v_cos_f32 v68, v68
    v_cos_f32 v69, v69
    v_cos_f32 v70, v70
    v_cos_f32 v71, v71
    s_nop 0
    v_cvt_pk_bf16_f32 v72, v64, v65
    v_cvt_pk_bf16_f32 v73, v66, v67
    v_cvt_pk_bf16_f32 v74, v68, v69
    v_cvt_pk_bf16_f32 v75, v70, v71
    v_lshlrev_b32 v80, 16, v72
    v_and_b32 v81, 0xffff0000, v72
    v_sub_f32 v64, v64, v80
    v_sub_f32 v65, v65, v81
    v_lshlrev_b32 v80, 16, v73
    v_and_b32 v81, 0xffff0000, v73
    v_sub_f32 v66, v66, v80
    v_sub_f32 v67, v67, v81
    v_lshlrev_b32 v80, 16, v74
    v_and_b32 v81, 0xffff0000, v74
    v_sub_f32 v68, v68, v80
    v_sub_f32 v69, v69, v81
    v_lshlrev_b32 v80, 16, v75
    v_and_b32 v81, 0xffff0000, v75
    v_sub_f32 v70, v70, v80
    v_sub_f32 v71, v71, v81
    v_cvt_pk_bf16_f32 v76, v64, v65
    v_cvt_pk_bf16_f32 v77, v66, v67
    v_cvt_pk_bf16_f32 v78, v68, v69
    v_cvt_pk_bf16_f32 v79, v70, v71
    v_cmp_lt_u32 vcc, 1, v123
    s_lshl_b32 s24, s3, 10
    v_add_u32 v114, s24, v121
    v_cndmask_b32 v72, v72, v76, vcc
    v_cndmask_b32 v73, v73, v77, vcc
    v_cndmask_b32 v74, v74, v78, vcc
    v_cndmask_b32 v75, v75, v79, vcc
    ds_write_b128 v114, v[72:75]
    v_lshrrev_b32 v112, 1, v123
    s_mov_b32 s24, 2097152
    v_mul_lo_u32 v112, v112, s24
    v_and_b32 v113, 1, v123
    v_lshl_add_u32 v112, v113, 8, v112
    v_and_b32 v113, 1, v122
    v_lshl_add_u32 v124, v113, 4, v112
    v_lshrrev_b32 v125, 1, v122
    s_mul_i32 s26, s3, 524288
    s_lshl_b32 s24, s11, 9
    s_add_u32 s26, s26, s24
    s_waitcnt lgkmcnt(0)
    s_barrier
    ds_read_b128 v[96:99], v121 offset:0
    ds_read_b128 v[100:103], v121 offset:1024
    ds_read_b128 v[104:107], v121 offset:2048
    ds_read_b128 v[108:111], v121 offset:3072
    s_mov_b32 s27, 0
    s_waitcnt vmcnt(0) lgkmcnt(0)
K1_W_LOOP:
    s_add_u32 s24, s11, s27
    s_and_b32 s30, s24, 3
    s_lshr_b32 s24, s24, 1
    s_and_b32 s24, s24, 4
    s_or_b32 s30, s30, s24
    v_xor_b32 v112, s30, v125
    v_lshl_add_u32 v120, v112, 5, v124
    s_lshl_b32 s25, s27, 9
    s_add_u32 s25, s25, s26
    v_perm_b32 v32, v4, v0, s28
    v_perm_b32 v36, v4, v0, s29
    v_perm_b32 v33, v12, v8, s28
    v_perm_b32 v37, v12, v8, s29
    v_perm_b32 v34, v20, v16, s28
    v_perm_b32 v38, v20, v16, s29
    v_perm_b32 v35, v28, v24, s28
    v_perm_b32 v39, v28, v24, s29
    v_perm_b32 v40, v5, v1, s28
    v_perm_b32 v44, v5, v1, s29
    v_perm_b32 v41, v13, v9, s28
    v_perm_b32 v45, v13, v9, s29
    v_perm_b32 v42, v21, v17, s28
    v_perm_b32 v46, v21, v17, s29
    v_perm_b32 v43, v29, v25, s28
    v_perm_b32 v47, v29, v25, s29
    v_perm_b32 v48, v6, v2, s28
    v_perm_b32 v52, v6, v2, s29
    v_perm_b32 v49, v14, v10, s28
    v_perm_b32 v53, v14, v10, s29
    v_perm_b32 v50, v22, v18, s28
    v_perm_b32 v54, v22, v18, s29
    v_perm_b32 v51, v30, v26, s28
    v_perm_b32 v55, v30, v26, s29
    v_perm_b32 v56, v7, v3, s28
    v_perm_b32 v60, v7, v3, s29
    v_perm_b32 v57, v15, v11, s28
    v_perm_b32 v61, v15, v11, s29
    v_perm_b32 v58, v23, v19, s28
    v_perm_b32 v62, v23, v19, s29
    v_perm_b32 v59, v31, v27, s28
    v_perm_b32 v63, v31, v27, s29
    s_add_u32 s27, s27, 1
    s_add_u32 s14, s14, 1024
    s_cmp_ge_u32 s27, 1
    s_cbranch_scc1 K1_W_NOLOAD
    s_mov_b32 s15, s14
    buffer_load_dwordx4 v[0:3], v126, s[16:19], s15 offen
    s_add_u32 s15, s15, 0x100000
    buffer_load_dwordx4 v[4:7], v126, s[16:19], s15 offen
    s_add_u32 s15, s15, 0x100000
    buffer_load_dwordx4 v[8:11], v126, s[16:19], s15 offen
    s_add_u32 s15, s15, 0x100000
    buffer_load_dwordx4 v[12:15], v126, s[16:19], s15 offen
    s_add_u32 s15, s15, 0x100000
    buffer_load_dwordx4 v[16:19], v126, s[16:19], s15 offen
    s_add_u32 s15, s15, 0x100000
    buffer_load_dwordx4 v[20:23], v126, s[16:19], s15 offen
    s_add_u32 s15, s15, 0x100000
    buffer_load_dwordx4 v[24:27], v126, s[16:19], s15 offen
    s_add_u32 s15, s15, 0x100000
    buffer_load_dwordx4 v[28:31], v126, s[16:19], s15 offen
K1_W_NOLOAD:
    v_mfma_f32_16x16x32_bf16 v[64:67], v[96:99], v[32:35], 0
    v_mfma_f32_16x16x32_bf16 v[68:71], v[96:99], v[36:39], 0
    v_mfma_f32_16x16x32_bf16 v[72:75], v[96:99], v[40:43], 0
    v_mfma_f32_16x16x32_bf16 v[76:79], v[96:99], v[44:47], 0
    v_mfma_f32_16x16x32_bf16 v[80:83], v[96:99], v[48:51], 0
    v_mfma_f32_16x16x32_bf16 v[84:87], v[96:99], v[52:55], 0
    v_mfma_f32_16x16x32_bf16 v[88:91], v[96:99], v[56:59], 0
    v_mfma_f32_16x16x32_bf16 v[92:95], v[96:99], v[60:63], 0
    s_nop 7
    v_cvt_pk_bf16_f32 v112, v64, v68
    v_cvt_pk_bf16_f32 v113, v72, v76
    v_cvt_pk_bf16_f32 v114, v80, v84
    v_cvt_pk_bf16_f32 v115, v88, v92
    buffer_store_dwordx4 v[112:115], v120, s[20:23], s25 offen
    s_add_u32 s25, s25, 4194304
    v_cvt_pk_bf16_f32 v116, v65, v69
    v_cvt_pk_bf16_f32 v117, v73, v77
    v_cvt_pk_bf16_f32 v118, v81, v85
    v_cvt_pk_bf16_f32 v119, v89, v93
    buffer_store_dwordx4 v[116:119], v120, s[20:23], s25 offen
    s_add_u32 s25, s25, 4194304
    v_cvt_pk_bf16_f32 v112, v66, v70
    v_cvt_pk_bf16_f32 v113, v74, v78
    v_cvt_pk_bf16_f32 v114, v82, v86
    v_cvt_pk_bf16_f32 v115, v90, v94
    buffer_store_dwordx4 v[112:115], v120, s[20:23], s25 offen
    s_add_u32 s25, s25, 4194304
    v_cvt_pk_bf16_f32 v116, v67, v71
    v_cvt_pk_bf16_f32 v117, v75, v79
    v_cvt_pk_bf16_f32 v118, v83, v87
    v_cvt_pk_bf16_f32 v119, v91, v95
    buffer_store_dwordx4 v[116:119], v120, s[20:23], s25 offen
    s_add_u32 s25, s25, 4194304
    v_mfma_f32_16x16x32_bf16 v[64:67], v[100:103], v[32:35], 0
    v_mfma_f32_16x16x32_bf16 v[68:71], v[100:103], v[36:39], 0
    v_mfma_f32_16x16x32_bf16 v[72:75], v[100:103], v[40:43], 0
    v_mfma_f32_16x16x32_bf16 v[76:79], v[100:103], v[44:47], 0
    v_mfma_f32_16x16x32_bf16 v[80:83], v[100:103], v[48:51], 0
    v_mfma_f32_16x16x32_bf16 v[84:87], v[100:103], v[52:55], 0
    v_mfma_f32_16x16x32_bf16 v[88:91], v[100:103], v[56:59], 0
    v_mfma_f32_16x16x32_bf16 v[92:95], v[100:103], v[60:63], 0
    s_nop 7
    v_cvt_pk_bf16_f32 v112, v64, v68
    v_cvt_pk_bf16_f32 v113, v72, v76
    v_cvt_pk_bf16_f32 v114, v80, v84
    v_cvt_pk_bf16_f32 v115, v88, v92
    buffer_store_dwordx4 v[112:115], v120, s[20:23], s25 offen
    s_add_u32 s25, s25, 4194304
    v_cvt_pk_bf16_f32 v116, v65, v69
    v_cvt_pk_bf16_f32 v117, v73, v77
    v_cvt_pk_bf16_f32 v118, v81, v85
    v_cvt_pk_bf16_f32 v119, v89, v93
    buffer_store_dwordx4 v[116:119], v120, s[20:23], s25 offen
    s_add_u32 s25, s25, 4194304
    v_cvt_pk_bf16_f32 v112, v66, v70
    v_cvt_pk_bf16_f32 v113, v74, v78
    v_cvt_pk_bf16_f32 v114, v82, v86
    v_cvt_pk_bf16_f32 v115, v90, v94
    buffer_store_dwordx4 v[112:115], v120, s[20:23], s25 offen
    s_add_u32 s25, s25, 4194304
    v_cvt_pk_bf16_f32 v116, v67, v71
    v_cvt_pk_bf16_f32 v117, v75, v79
    v_cvt_pk_bf16_f32 v118, v83, v87
    v_cvt_pk_bf16_f32 v119, v91, v95
    buffer_store_dwordx4 v[116:119], v120, s[20:23], s25 offen
    s_add_u32 s25, s25, 4194304
    v_mfma_f32_16x16x32_bf16 v[64:67], v[104:107], v[32:35], 0
    v_mfma_f32_16x16x32_bf16 v[68:71], v[104:107], v[36:39], 0
    v_mfma_f32_16x16x32_bf16 v[72:75], v[104:107], v[40:43], 0
    v_mfma_f32_16x16x32_bf16 v[76:79], v[104:107], v[44:47], 0
    v_mfma_f32_16x16x32_bf16 v[80:83], v[104:107], v[48:51], 0
    v_mfma_f32_16x16x32_bf16 v[84:87], v[104:107], v[52:55], 0
    v_mfma_f32_16x16x32_bf16 v[88:91], v[104:107], v[56:59], 0
    v_mfma_f32_16x16x32_bf16 v[92:95], v[104:107], v[60:63], 0
    s_nop 7
    v_cvt_pk_bf16_f32 v112, v64, v68
    v_cvt_pk_bf16_f32 v113, v72, v76
    v_cvt_pk_bf16_f32 v114, v80, v84
    v_cvt_pk_bf16_f32 v115, v88, v92
    buffer_store_dwordx4 v[112:115], v120, s[20:23], s25 offen
    s_add_u32 s25, s25, 4194304
    v_cvt_pk_bf16_f32 v116, v65, v69
    v_cvt_pk_bf16_f32 v117, v73, v77
    v_cvt_pk_bf16_f32 v118, v81, v85
    v_cvt_pk_bf16_f32 v119, v89, v93
    buffer_store_dwordx4 v[116:119], v120, s[20:23], s25 offen
    s_add_u32 s25, s25, 4194304
    v_cvt_pk_bf16_f32 v112, v66, v70
    v_cvt_pk_bf16_f32 v113, v74, v78
    v_cvt_pk_bf16_f32 v114, v82, v86
    v_cvt_pk_bf16_f32 v115, v90, v94
    buffer_store_dwordx4 v[112:115], v120, s[20:23], s25 offen
    s_add_u32 s25, s25, 4194304
    v_cvt_pk_bf16_f32 v116, v67, v71
    v_cvt_pk_bf16_f32 v117, v75, v79
    v_cvt_pk_bf16_f32 v118, v83, v87
    v_cvt_pk_bf16_f32 v119, v91, v95
    buffer_store_dwordx4 v[116:119], v120, s[20:23], s25 offen
    s_add_u32 s25, s25, 4194304
    v_mfma_f32_16x16x32_bf16 v[64:67], v[108:111], v[32:35], 0
    v_mfma_f32_16x16x32_bf16 v[68:71], v[108:111], v[36:39], 0
    v_mfma_f32_16x16x32_bf16 v[72:75], v[108:111], v[40:43], 0
    v_mfma_f32_16x16x32_bf16 v[76:79], v[108:111], v[44:47], 0
    v_mfma_f32_16x16x32_bf16 v[80:83], v[108:111], v[48:51], 0
    v_mfma_f32_16x16x32_bf16 v[84:87], v[108:111], v[52:55], 0
    v_mfma_f32_16x16x32_bf16 v[88:91], v[108:111], v[56:59], 0
    v_mfma_f32_16x16x32_bf16 v[92:95], v[108:111], v[60:63], 0
    s_nop 7
    v_cvt_pk_bf16_f32 v112, v64, v68
    v_cvt_pk_bf16_f32 v113, v72, v76
    v_cvt_pk_bf16_f32 v114, v80, v84
    v_cvt_pk_bf16_f32 v115, v88, v92
    buffer_store_dwordx4 v[112:115], v120, s[20:23], s25 offen
    s_add_u32 s25, s25, 4194304
    v_cvt_pk_bf16_f32 v116, v65, v69
    v_cvt_pk_bf16_f32 v117, v73, v77
    v_cvt_pk_bf16_f32 v118, v81, v85
    v_cvt_pk_bf16_f32 v119, v89, v93
    buffer_store_dwordx4 v[116:119], v120, s[20:23], s25 offen
    s_add_u32 s25, s25, 4194304
    v_cvt_pk_bf16_f32 v112, v66, v70
    v_cvt_pk_bf16_f32 v113, v74, v78
    v_cvt_pk_bf16_f32 v114, v82, v86
    v_cvt_pk_bf16_f32 v115, v90, v94
    buffer_store_dwordx4 v[112:115], v120, s[20:23], s25 offen
    s_add_u32 s25, s25, 4194304
    v_cvt_pk_bf16_f32 v116, v67, v71
    v_cvt_pk_bf16_f32 v117, v75, v79
    v_cvt_pk_bf16_f32 v118, v83, v87
    v_cvt_pk_bf16_f32 v119, v91, v95
    buffer_store_dwordx4 v[116:119], v120, s[20:23], s25 offen
    s_waitcnt vmcnt(16)
    s_cmp_lt_u32 s27, 1
    s_cbranch_scc1 K1_W_LOOP
K1_END:
    s_endpgm
.p2align 8
.type k2_gemm_kernel,@function
k2_gemm_kernel:
    s_cmp_ge_u32 s2, 256
    s_cbranch_scc1 K2_END
    s_load_dwordx2 s[4:5], s[0:1], 48
    v_lshrrev_b32 v1, 6, v0
    v_and_b32 v2, 63, v0
    v_readfirstlane_b32 s3, v1
    s_and_b32 s6, s2, 7
    s_lshl_b32 s6, s6, 2
    s_lshr_b32 s7, s2, 6
    s_add_u32 s6, s6, s7
    s_lshr_b32 s7, s2, 3
    s_and_b32 s7, s7, 7
    s_lshr_b32 s20, s7, 2
    s_and_b32 s21, s7, 3
    s_lshl_b32 s22, s6, 1
    s_add_u32 s22, s22, s20
    s_lshl_b32 s23, s6, 2
    s_add_u32 s23, s23, s21
    s_mul_i32 s24, s22, 684032
    s_mul_i32 s25, s23, 524288
    s_add_u32 s25, s25, 50331648
    s_mul_i32 s26, s22, 342016
    s_add_u32 s26, s26, 118489088
    s_waitcnt lgkmcnt(0)
    s_add_u32 s8, s4, s24
    s_addc_u32 s9, s5, 0
    s_and_b32 s9, s9, 0xffff
    s_mov_b32 s10, 684032
    s_mov_b32 s11, 0x00020000
    s_add_u32 s12, s4, s25
    s_addc_u32 s13, s5, 0
    s_and_b32 s13, s13, 0xffff
    s_mov_b32 s14, 524288
    s_mov_b32 s15, 0x00020000
    s_add_u32 s16, s4, s26
    s_addc_u32 s17, s5, 0
    s_and_b32 s17, s17, 0xffff
    s_mov_b32 s18, 342016
    s_mov_b32 s19, 0x00020000
    v_and_b32 v3, 15, v2
    v_lshrrev_b32 v4, 4, v2
    v_lshlrev_b32 v1, 4, v2
    v_lshrrev_b32 v5, 1, v3
    v_xor_b32 v5, v5, v4
    v_lshlrev_b32 v5, 4, v5
    v_lshl_add_u32 v8, v3, 7, v5
    v_lshrrev_b32 v5, 2, v3
    v_lshl_add_u32 v6, v4, 3, v5
    v_lshlrev_b32 v6, 9, v6
    v_and_b32 v7, 1, v4
    v_lshl_or_b32 v5, v7, 2, v5
    s_and_b32 s27, s3, 3
    s_lshl_b32 s28, s27, 1
    v_xor_b32 v5, s28, v5
    v_lshl_add_u32 v6, v5, 5, v6
    v_and_b32 v5, 3, v3
    v_lshl_add_u32 v6, v5, 3, v6
    v_add_u32 v9, 21504, v6
    s_lshl_b32 s28, s21, 7
    s_lshl_b32 s29, s27, 5
    s_add_u32 s28, s28, s29
    v_add_u32 v5, s28, v3
    v_lshlrev_b32 v5, 2, v5
    v_lshl_add_u32 v10, v4, 13, v5
    v_mov_b32 v128, 0
    v_mov_b32 v129, 0
    v_mov_b32 v130, 0
    v_mov_b32 v131, 0
    v_mov_b32 v132, 0
    v_mov_b32 v133, 0
    v_mov_b32 v134, 0
    v_mov_b32 v135, 0
    v_mov_b32 v136, 0
    v_mov_b32 v137, 0
    v_mov_b32 v138, 0
    v_mov_b32 v139, 0
    v_mov_b32 v140, 0
    v_mov_b32 v141, 0
    v_mov_b32 v142, 0
    v_mov_b32 v143, 0
    v_mov_b32 v144, 0
    v_mov_b32 v145, 0
    v_mov_b32 v146, 0
    v_mov_b32 v147, 0
    v_mov_b32 v148, 0
    v_mov_b32 v149, 0
    v_mov_b32 v150, 0
    v_mov_b32 v151, 0
    v_mov_b32 v152, 0
    v_mov_b32 v153, 0
    v_mov_b32 v154, 0
    v_mov_b32 v155, 0
    v_mov_b32 v156, 0
    v_mov_b32 v157, 0
    v_mov_b32 v158, 0
    v_mov_b32 v159, 0
    v_mov_b32 v160, 0
    v_mov_b32 v161, 0
    v_mov_b32 v162, 0
    v_mov_b32 v163, 0
    v_mov_b32 v164, 0
    v_mov_b32 v165, 0
    v_mov_b32 v166, 0
    v_mov_b32 v167, 0
    v_mov_b32 v168, 0
    v_mov_b32 v169, 0
    v_mov_b32 v170, 0
    v_mov_b32 v171, 0
    v_mov_b32 v172, 0
    v_mov_b32 v173, 0
    v_mov_b32 v174, 0
    v_mov_b32 v175, 0
    v_mov_b32 v176, 0
    v_mov_b32 v177, 0
    v_mov_b32 v178, 0
    v_mov_b32 v179, 0
    v_mov_b32 v180, 0
    v_mov_b32 v181, 0
    v_mov_b32 v182, 0
    v_mov_b32 v183, 0
    v_mov_b32 v184, 0
    v_mov_b32 v185, 0
    v_mov_b32 v186, 0
    v_mov_b32 v187, 0
    v_mov_b32 v188, 0
    v_mov_b32 v189, 0
    v_mov_b32 v190, 0
    v_mov_b32 v191, 0
    v_mov_b32 v192, 0
    v_mov_b32 v193, 0
    v_mov_b32 v194, 0
    v_mov_b32 v195, 0
    v_mov_b32 v196, 0
    v_mov_b32 v197, 0
    v_mov_b32 v198, 0
    v_mov_b32 v199, 0
    v_mov_b32 v200, 0
    v_mov_b32 v201, 0
    v_mov_b32 v202, 0
    v_mov_b32 v203, 0
    v_mov_b32 v204, 0
    v_mov_b32 v205, 0
    v_mov_b32 v206, 0
    v_mov_b32 v207, 0
    v_mov_b32 v208, 0
    v_mov_b32 v209, 0
    v_mov_b32 v210, 0
    v_mov_b32 v211, 0
    v_mov_b32 v212, 0
    v_mov_b32 v213, 0
    v_mov_b32 v214, 0
    v_mov_b32 v215, 0
    v_mov_b32 v216, 0
    v_mov_b32 v217, 0
    v_mov_b32 v218, 0
    v_mov_b32 v219, 0
    v_mov_b32 v220, 0
    v_mov_b32 v221, 0
    v_mov_b32 v222, 0
    v_mov_b32 v223, 0
    s_cmp_ge_u32 s3, 4
    s_cbranch_scc1 K2_MH1
    s_lshl_b32 s30, s27, 12
    s_add_u32 s32, s30, 21504
    s_lshl_b32 s31, s27, 8
    s_add_u32 s31, s31, 20480
    s_mov_b32 s33, s31
    s_mov_b32 s34, 0x80008000
    s_mov_b32 s35, 0
    s_add_u32 m0, s35, s32
    s_nop 0
    buffer_load_dwordx4 v1, s[12:15], s30 offen lds
    buffer_load_dwordx4 v1, s[12:15], s30 offen offset:1024 lds
    buffer_load_dwordx4 v1, s[12:15], s30 offen offset:2048 lds
    buffer_load_dwordx4 v1, s[12:15], s30 offen offset:3072 lds
    s_add_u32 m0, s35, s33
    s_mov_b64 exec, 0xffff
    buffer_load_dwordx4 v1, s[8:11], s31 offen lds
    s_mov_b64 exec, -1
    s_add_u32 s30, s30, 16384
    s_add_u32 s31, s31, 21376
    s_add_u32 s35, s35, 37888
    s_add_u32 m0, s35, s32
    s_nop 0
    buffer_load_dwordx4 v1, s[12:15], s30 offen lds
    buffer_load_dwordx4 v1, s[12:15], s30 offen offset:1024 lds
    buffer_load_dwordx4 v1, s[12:15], s30 offen offset:2048 lds
    buffer_load_dwordx4 v1, s[12:15], s30 offen offset:3072 lds
    s_add_u32 m0, s35, s33
    s_mov_b64 exec, 0xffff
    buffer_load_dwordx4 v1, s[8:11], s31 offen lds
    s_mov_b64 exec, -1
    s_add_u32 s30, s30, 16384
    s_add_u32 s31, s31, 21376
    s_add_u32 s35, s35, 37888
    s_add_u32 m0, s35, s32
    s_nop 0
    buffer_load_dwordx4 v1, s[12:15], s30 offen lds
    buffer_load_dwordx4 v1, s[12:15], s30 offen offset:1024 lds
    buffer_load_dwordx4 v1, s[12:15], s30 offen offset:2048 lds
    buffer_load_dwordx4 v1, s[12:15], s30 offen offset:3072 lds
    s_add_u32 m0, s35, s33
    s_mov_b64 exec, 0xffff
    buffer_load_dwordx4 v1, s[8:11], s31 offen lds
    s_mov_b64 exec, -1
    s_add_u32 s30, s30, 16384
    s_add_u32 s31, s31, 21376
    s_add_u32 s35, s35, 37888
    s_add_u32 m0, s35, s32
    s_nop 0
    buffer_load_dwordx4 v1, s[12:15], s30 offen lds
    buffer_load_dwordx4 v1, s[12:15], s30 offen offset:1024 lds
    buffer_load_dwordx4 v1, s[12:15], s30 offen offset:2048 lds
    buffer_load_dwordx4 v1, s[12:15], s30 offen offset:3072 lds
    s_add_u32 m0, s35, s33
    s_mov_b64 exec, 0xffff
    buffer_load_dwordx4 v1, s[8:11], s31 offen lds
    s_mov_b64 exec, -1
    s_add_u32 s30, s30, 16384
    s_add_u32 s31, s31, 21376
    s_add_u32 s35, s35, 37888
    s_mov_b32 s35, 0
    s_mov_b32 s36, 37888
    s_mov_b32 s37, 0
    v_add_u32 v11, s35, v8
    v_add_u32 v13, s35, v9
    v_xor_b32 v12, 64, v11
    v_xor_b32 v14, 32, v13
    s_waitcnt vmcnt(15)
    s_barrier
    ds_read_b64_tr_b16 v[64:65], v13 offset:0
    ds_read_b64_tr_b16 v[66:67], v13 offset:2048
    ds_read_b64_tr_b16 v[68:69], v13 offset:256
    ds_read_b64_tr_b16 v[70:71], v13 offset:2304
    ds_read_b64_tr_b16 v[76:77], v14 offset:0
    ds_read_b64_tr_b16 v[78:79], v14 offset:2048
    ds_read_b64_tr_b16 v[80:81], v14 offset:256
    ds_read_b64_tr_b16 v[82:83], v14 offset:2304
    ds_read_b128 v[16:19], v11 offset:0
    ds_read_b128 v[20:23], v12 offset:0
    ds_read_b128 v[24:27], v11 offset:2048
    ds_read_b128 v[28:31], v12 offset:2048
    s_waitcnt lgkmcnt(4)
    v_xor_b32 v72, s34, v68
    v_xor_b32 v73, s34, v69
    v_xor_b32 v74, s34, v70
    v_xor_b32 v75, s34, v71
    v_xor_b32 v84, s34, v80
    v_xor_b32 v85, s34, v81
    v_xor_b32 v86, s34, v82
    v_xor_b32 v87, s34, v83
    ds_read_b128 v[32:35], v11 offset:4096
    ds_read_b128 v[36:39], v12 offset:4096
    ds_read_b128 v[40:43], v11 offset:6144
    ds_read_b128 v[44:47], v12 offset:6144
    ds_read_b128 v[48:51], v11 offset:8192
    ds_read_b128 v[52:55], v12 offset:8192
K2M0_LOOP:
    s_waitcnt lgkmcnt(4)
    v_mfma_f32_16x16x32_bf16 v[128:131], v[16:19], v[64:67], v[128:131]
    ds_read_b128 v[56:59], v11 offset:10240
    v_mfma_f32_16x16x32_bf16 v[132:135], v[16:19], v[68:71], v[132:135]
    ds_read_b128 v[60:63], v12 offset:10240
    v_mfma_f32_16x16x32_bf16 v[136:139], v[16:19], v[76:79], v[136:139]
    v_mfma_f32_16x16x32_bf16 v[140:143], v[16:19], v[80:83], v[140:143]
    v_mfma_f32_16x16x32_bf16 v[128:131], v[20:23], v[72:75], v[128:131]
    v_mfma_f32_16x16x32_bf16 v[132:135], v[20:23], v[64:67], v[132:135]
    v_mfma_f32_16x16x32_bf16 v[136:139], v[20:23], v[84:87], v[136:139]
    v_mfma_f32_16x16x32_bf16 v[140:143], v[20:23], v[76:79], v[140:143]
    v_mfma_f32_16x16x32_bf16 v[144:147], v[24:27], v[64:67], v[144:147]
    v_mfma_f32_16x16x32_bf16 v[148:151], v[24:27], v[68:71], v[148:151]
    v_mfma_f32_16x16x32_bf16 v[152:155], v[24:27], v[76:79], v[152:155]
    v_mfma_f32_16x16x32_bf16 v[156:159], v[24:27], v[80:83], v[156:159]
    v_mfma_f32_16x16x32_bf16 v[144:147], v[28:31], v[72:75], v[144:147]
    v_mfma_f32_16x16x32_bf16 v[148:151], v[28:31], v[64:67], v[148:151]
    v_mfma_f32_16x16x32_bf16 v[152:155], v[28:31], v[84:87], v[152:155]
    v_mfma_f32_16x16x32_bf16 v[156:159], v[28:31], v[76:79], v[156:159]
    v_mfma_f32_16x16x32_bf16 v[160:163], v[32:35], v[64:67], v[160:163]
    v_mfma_f32_16x16x32_bf16 v[164:167], v[32:35], v[68:71], v[164:167]
    v_mfma_f32_16x16x32_bf16 v[168:171], v[32:35], v[76:79], v[168:171]
    v_mfma_f32_16x16x32_bf16 v[172:175], v[32:35], v[80:83], v[172:175]
    v_mfma_f32_16x16x32_bf16 v[160:163], v[36:39], v[72:75], v[160:163]
    v_mfma_f32_16x16x32_bf16 v[164:167], v[36:39], v[64:67], v[164:167]
    v_mfma_f32_16x16x32_bf16 v[168:171], v[36:39], v[84:87], v[168:171]
    v_mfma_f32_16x16x32_bf16 v[172:175], v[36:39], v[76:79], v[172:175]
    s_waitcnt vmcnt(10) lgkmcnt(0)
    s_barrier
    v_mfma_f32_16x16x32_bf16 v[176:179], v[40:43], v[64:67], v[176:179]
    v_add_u32 v11, s36, v8
    v_add_u32 v13, s36, v9
    v_mfma_f32_16x16x32_bf16 v[180:183], v[40:43], v[68:71], v[180:183]
    v_xor_b32 v12, 64, v11
    v_xor_b32 v14, 32, v13
    v_mfma_f32_16x16x32_bf16 v[184:187], v[40:43], v[76:79], v[184:187]
    ds_read_b64_tr_b16 v[88:89], v13 offset:0
    ds_read_b64_tr_b16 v[90:91], v13 offset:2048
    v_mfma_f32_16x16x32_bf16 v[188:191], v[40:43], v[80:83], v[188:191]
    ds_read_b64_tr_b16 v[92:93], v13 offset:256
    ds_read_b64_tr_b16 v[94:95], v13 offset:2304
    v_mfma_f32_16x16x32_bf16 v[176:179], v[44:47], v[72:75], v[176:179]
    ds_read_b64_tr_b16 v[100:101], v14 offset:0
    ds_read_b64_tr_b16 v[102:103], v14 offset:2048
    v_mfma_f32_16x16x32_bf16 v[180:183], v[44:47], v[64:67], v[180:183]
    ds_read_b64_tr_b16 v[104:105], v14 offset:256
    ds_read_b64_tr_b16 v[106:107], v14 offset:2304
    v_mfma_f32_16x16x32_bf16 v[184:187], v[44:47], v[84:87], v[184:187]
    ds_read_b128 v[16:19], v11 offset:0
    ds_read_b128 v[20:23], v12 offset:0
    v_mfma_f32_16x16x32_bf16 v[188:191], v[44:47], v[76:79], v[188:191]
    ds_read_b128 v[24:27], v11 offset:2048
    ds_read_b128 v[28:31], v12 offset:2048
    v_mfma_f32_16x16x32_bf16 v[192:195], v[48:51], v[64:67], v[192:195]
    ds_read_b128 v[32:35], v11 offset:4096
    ds_read_b128 v[36:39], v12 offset:4096
    v_mfma_f32_16x16x32_bf16 v[196:199], v[48:51], v[68:71], v[196:199]
    ds_read_b128 v[40:43], v11 offset:6144
    ds_read_b128 v[44:47], v12 offset:6144
    v_mfma_f32_16x16x32_bf16 v[200:203], v[48:51], v[76:79], v[200:203]
    s_add_u32 m0, s35, s32
    s_nop 0
    buffer_load_dwordx4 v1, s[12:15], s30 offen lds
    v_mfma_f32_16x16x32_bf16 v[204:207], v[48:51], v[80:83], v[204:207]
    buffer_load_dwordx4 v1, s[12:15], s30 offen offset:1024 lds
    v_mfma_f32_16x16x32_bf16 v[192:195], v[52:55], v[72:75], v[192:195]
    buffer_load_dwordx4 v1, s[12:15], s30 offen offset:2048 lds
    v_mfma_f32_16x16x32_bf16 v[196:199], v[52:55], v[64:67], v[196:199]
    buffer_load_dwordx4 v1, s[12:15], s30 offen offset:3072 lds
    v_mfma_f32_16x16x32_bf16 v[200:203], v[52:55], v[84:87], v[200:203]
    s_add_u32 m0, s35, s33
    s_mov_b64 exec, 0xffff
    buffer_load_dwordx4 v1, s[8:11], s31 offen lds
    s_mov_b64 exec, -1
    v_mfma_f32_16x16x32_bf16 v[204:207], v[52:55], v[76:79], v[204:207]
    s_add_u32 s30, s30, 16384
    s_add_u32 s31, s31, 21376
    v_mfma_f32_16x16x32_bf16 v[208:211], v[56:59], v[64:67], v[208:211]
    s_waitcnt lgkmcnt(8)
    v_xor_b32 v96, s34, v92
    v_xor_b32 v97, s34, v93
    v_mfma_f32_16x16x32_bf16 v[212:215], v[56:59], v[68:71], v[212:215]
    v_xor_b32 v98, s34, v94
    v_xor_b32 v99, s34, v95
    v_mfma_f32_16x16x32_bf16 v[216:219], v[56:59], v[76:79], v[216:219]
    v_xor_b32 v108, s34, v104
    v_xor_b32 v109, s34, v105
    v_mfma_f32_16x16x32_bf16 v[220:223], v[56:59], v[80:83], v[220:223]
    v_xor_b32 v110, s34, v106
    v_xor_b32 v111, s34, v107
    v_mfma_f32_16x16x32_bf16 v[208:211], v[60:63], v[72:75], v[208:211]
    ds_read_b128 v[48:51], v11 offset:8192
    ds_read_b128 v[52:55], v12 offset:8192
    v_mfma_f32_16x16x32_bf16 v[212:215], v[60:63], v[64:67], v[212:215]
    v_mfma_f32_16x16x32_bf16 v[216:219], v[60:63], v[84:87], v[216:219]
    v_mfma_f32_16x16x32_bf16 v[220:223], v[60:63], v[76:79], v[220:223]
    s_mov_b32 s35, s36
    s_add_u32 s36, s36, 37888
    s_cmp_eq_u32 s36, 151552
    s_cselect_b32 s36, 0, s36
    s_waitcnt lgkmcnt(4)
    v_mfma_f32_16x16x32_bf16 v[128:131], v[16:19], v[88:91], v[128:131]
    ds_read_b128 v[56:59], v11 offset:10240
    v_mfma_f32_16x16x32_bf16 v[132:135], v[16:19], v[92:95], v[132:135]
    ds_read_b128 v[60:63], v12 offset:10240
    v_mfma_f32_16x16x32_bf16 v[136:139], v[16:19], v[100:103], v[136:139]
    v_mfma_f32_16x16x32_bf16 v[140:143], v[16:19], v[104:107], v[140:143]
    v_mfma_f32_16x16x32_bf16 v[128:131], v[20:23], v[96:99], v[128:131]
    v_mfma_f32_16x16x32_bf16 v[132:135], v[20:23], v[88:91], v[132:135]
    v_mfma_f32_16x16x32_bf16 v[136:139], v[20:23], v[108:111], v[136:139]
    v_mfma_f32_16x16x32_bf16 v[140:143], v[20:23], v[100:103], v[140:143]
    v_mfma_f32_16x16x32_bf16 v[144:147], v[24:27], v[88:91], v[144:147]
    v_mfma_f32_16x16x32_bf16 v[148:151], v[24:27], v[92:95], v[148:151]
    v_mfma_f32_16x16x32_bf16 v[152:155], v[24:27], v[100:103], v[152:155]
    v_mfma_f32_16x16x32_bf16 v[156:159], v[24:27], v[104:107], v[156:159]
    v_mfma_f32_16x16x32_bf16 v[144:147], v[28:31], v[96:99], v[144:147]
    v_mfma_f32_16x16x32_bf16 v[148:151], v[28:31], v[88:91], v[148:151]
    v_mfma_f32_16x16x32_bf16 v[152:155], v[28:31], v[108:111], v[152:155]
    v_mfma_f32_16x16x32_bf16 v[156:159], v[28:31], v[100:103], v[156:159]
    v_mfma_f32_16x16x32_bf16 v[160:163], v[32:35], v[88:91], v[160:163]
    v_mfma_f32_16x16x32_bf16 v[164:167], v[32:35], v[92:95], v[164:167]
    v_mfma_f32_16x16x32_bf16 v[168:171], v[32:35], v[100:103], v[168:171]
    v_mfma_f32_16x16x32_bf16 v[172:175], v[32:35], v[104:107], v[172:175]
    v_mfma_f32_16x16x32_bf16 v[160:163], v[36:39], v[96:99], v[160:163]
    v_mfma_f32_16x16x32_bf16 v[164:167], v[36:39], v[88:91], v[164:167]
    v_mfma_f32_16x16x32_bf16 v[168:171], v[36:39], v[108:111], v[168:171]
    v_mfma_f32_16x16x32_bf16 v[172:175], v[36:39], v[100:103], v[172:175]
    s_waitcnt vmcnt(10) lgkmcnt(0)
    s_barrier
    v_mfma_f32_16x16x32_bf16 v[176:179], v[40:43], v[88:91], v[176:179]
    v_add_u32 v11, s36, v8
    v_add_u32 v13, s36, v9
    v_mfma_f32_16x16x32_bf16 v[180:183], v[40:43], v[92:95], v[180:183]
    v_xor_b32 v12, 64, v11
    v_xor_b32 v14, 32, v13
    v_mfma_f32_16x16x32_bf16 v[184:187], v[40:43], v[100:103], v[184:187]
    ds_read_b64_tr_b16 v[64:65], v13 offset:0
    ds_read_b64_tr_b16 v[66:67], v13 offset:2048
    v_mfma_f32_16x16x32_bf16 v[188:191], v[40:43], v[104:107], v[188:191]
    ds_read_b64_tr_b16 v[68:69], v13 offset:256
    ds_read_b64_tr_b16 v[70:71], v13 offset:2304
    v_mfma_f32_16x16x32_bf16 v[176:179], v[44:47], v[96:99], v[176:179]
    ds_read_b64_tr_b16 v[76:77], v14 offset:0
    ds_read_b64_tr_b16 v[78:79], v14 offset:2048
    v_mfma_f32_16x16x32_bf16 v[180:183], v[44:47], v[88:91], v[180:183]
    ds_read_b64_tr_b16 v[80:81], v14 offset:256
    ds_read_b64_tr_b16 v[82:83], v14 offset:2304
    v_mfma_f32_16x16x32_bf16 v[184:187], v[44:47], v[108:111], v[184:187]
    ds_read_b128 v[16:19], v11 offset:0
    ds_read_b128 v[20:23], v12 offset:0
    v_mfma_f32_16x16x32_bf16 v[188:191], v[44:47], v[100:103], v[188:191]
    ds_read_b128 v[24:27], v11 offset:2048
    ds_read_b128 v[28:31], v12 offset:2048
    v_mfma_f32_16x16x32_bf16 v[192:195], v[48:51], v[88:91], v[192:195]
    ds_read_b128 v[32:35], v11 offset:4096
    ds_read_b128 v[36:39], v12 offset:4096
    v_mfma_f32_16x16x32_bf16 v[196:199], v[48:51], v[92:95], v[196:199]
    ds_read_b128 v[40:43], v11 offset:6144
    ds_read_b128 v[44:47], v12 offset:6144
    v_mfma_f32_16x16x32_bf16 v[200:203], v[48:51], v[100:103], v[200:203]
    s_add_u32 m0, s35, s32
    s_nop 0
    buffer_load_dwordx4 v1, s[12:15], s30 offen lds
    v_mfma_f32_16x16x32_bf16 v[204:207], v[48:51], v[104:107], v[204:207]
    buffer_load_dwordx4 v1, s[12:15], s30 offen offset:1024 lds
    v_mfma_f32_16x16x32_bf16 v[192:195], v[52:55], v[96:99], v[192:195]
    buffer_load_dwordx4 v1, s[12:15], s30 offen offset:2048 lds
    v_mfma_f32_16x16x32_bf16 v[196:199], v[52:55], v[88:91], v[196:199]
    buffer_load_dwordx4 v1, s[12:15], s30 offen offset:3072 lds
    v_mfma_f32_16x16x32_bf16 v[200:203], v[52:55], v[108:111], v[200:203]
    s_add_u32 m0, s35, s33
    s_mov_b64 exec, 0xffff
    buffer_load_dwordx4 v1, s[8:11], s31 offen lds
    s_mov_b64 exec, -1
    v_mfma_f32_16x16x32_bf16 v[204:207], v[52:55], v[100:103], v[204:207]
    s_add_u32 s30, s30, 16384
    s_add_u32 s31, s31, 21376
    v_mfma_f32_16x16x32_bf16 v[208:211], v[56:59], v[88:91], v[208:211]
    s_waitcnt lgkmcnt(8)
    v_xor_b32 v72, s34, v68
    v_xor_b32 v73, s34, v69
    v_mfma_f32_16x16x32_bf16 v[212:215], v[56:59], v[92:95], v[212:215]
    v_xor_b32 v74, s34, v70
    v_xor_b32 v75, s34, v71
    v_mfma_f32_16x16x32_bf16 v[216:219], v[56:59], v[100:103], v[216:219]
    v_xor_b32 v84, s34, v80
    v_xor_b32 v85, s34, v81
    v_mfma_f32_16x16x32_bf16 v[220:223], v[56:59], v[104:107], v[220:223]
    v_xor_b32 v86, s34, v82
    v_xor_b32 v87, s34, v83
    v_mfma_f32_16x16x32_bf16 v[208:211], v[60:63], v[96:99], v[208:211]
    ds_read_b128 v[48:51], v11 offset:8192
    ds_read_b128 v[52:55], v12 offset:8192
    v_mfma_f32_16x16x32_bf16 v[212:215], v[60:63], v[88:91], v[212:215]
    v_mfma_f32_16x16x32_bf16 v[216:219], v[60:63], v[108:111], v[216:219]
    v_mfma_f32_16x16x32_bf16 v[220:223], v[60:63], v[100:103], v[220:223]
    s_mov_b32 s35, s36
    s_add_u32 s36, s36, 37888
    s_cmp_eq_u32 s36, 151552
    s_cselect_b32 s36, 0, s36
    s_add_u32 s37, s37, 1
    s_cmp_lt_u32 s37, 16
    s_cbranch_scc1 K2M0_LOOP
    s_nop 7
    s_nop 1
    s_mov_b32 s38, 0
    v_cvt_pk_bf16_f32 v16, v128, v132
    buffer_store_dword v16, v10, s[16:19], s38 offen offset:0
    v_cvt_pk_bf16_f32 v17, v136, v140
    buffer_store_dword v17, v10, s[16:19], s38 offen offset:64
    v_cvt_pk_bf16_f32 v18, v129, v133
    buffer_store_dword v18, v10, s[16:19], s38 offen offset:2048
    v_cvt_pk_bf16_f32 v19, v137, v141
    buffer_store_dword v19, v10, s[16:19], s38 offen offset:2112
    s_mov_b32 s38, 4096
    v_cvt_pk_bf16_f32 v20, v130, v134
    buffer_store_dword v20, v10, s[16:19], s38 offen offset:0
    v_cvt_pk_bf16_f32 v21, v138, v142
    buffer_store_dword v21, v10, s[16:19], s38 offen offset:64
    v_cvt_pk_bf16_f32 v22, v131, v135
    buffer_store_dword v22, v10, s[16:19], s38 offen offset:2048
    v_cvt_pk_bf16_f32 v23, v139, v143
    buffer_store_dword v23, v10, s[16:19], s38 offen offset:2112
    s_mov_b32 s38, 32768
    v_cvt_pk_bf16_f32 v16, v144, v148
    buffer_store_dword v16, v10, s[16:19], s38 offen offset:0
    v_cvt_pk_bf16_f32 v17, v152, v156
    buffer_store_dword v17, v10, s[16:19], s38 offen offset:64
    v_cvt_pk_bf16_f32 v18, v145, v149
    buffer_store_dword v18, v10, s[16:19], s38 offen offset:2048
    v_cvt_pk_bf16_f32 v19, v153, v157
    buffer_store_dword v19, v10, s[16:19], s38 offen offset:2112
    s_mov_b32 s38, 36864
    v_cvt_pk_bf16_f32 v20, v146, v150
    buffer_store_dword v20, v10, s[16:19], s38 offen offset:0
    v_cvt_pk_bf16_f32 v21, v154, v158
    buffer_store_dword v21, v10, s[16:19], s38 offen offset:64
    v_cvt_pk_bf16_f32 v22, v147, v151
    buffer_store_dword v22, v10, s[16:19], s38 offen offset:2048
    v_cvt_pk_bf16_f32 v23, v155, v159
    buffer_store_dword v23, v10, s[16:19], s38 offen offset:2112
    s_mov_b32 s38, 65536
    v_cvt_pk_bf16_f32 v16, v160, v164
    buffer_store_dword v16, v10, s[16:19], s38 offen offset:0
    v_cvt_pk_bf16_f32 v17, v168, v172
    buffer_store_dword v17, v10, s[16:19], s38 offen offset:64
    v_cvt_pk_bf16_f32 v18, v161, v165
    buffer_store_dword v18, v10, s[16:19], s38 offen offset:2048
    v_cvt_pk_bf16_f32 v19, v169, v173
    buffer_store_dword v19, v10, s[16:19], s38 offen offset:2112
    s_mov_b32 s38, 69632
    v_cvt_pk_bf16_f32 v20, v162, v166
    buffer_store_dword v20, v10, s[16:19], s38 offen offset:0
    v_cvt_pk_bf16_f32 v21, v170, v174
    buffer_store_dword v21, v10, s[16:19], s38 offen offset:64
    v_cvt_pk_bf16_f32 v22, v163, v167
    buffer_store_dword v22, v10, s[16:19], s38 offen offset:2048
    v_cvt_pk_bf16_f32 v23, v171, v175
    buffer_store_dword v23, v10, s[16:19], s38 offen offset:2112
    s_mov_b32 s38, 98304
    v_cvt_pk_bf16_f32 v16, v176, v180
    buffer_store_dword v16, v10, s[16:19], s38 offen offset:0
    v_cvt_pk_bf16_f32 v17, v184, v188
    buffer_store_dword v17, v10, s[16:19], s38 offen offset:64
    v_cvt_pk_bf16_f32 v18, v177, v181
    buffer_store_dword v18, v10, s[16:19], s38 offen offset:2048
    v_cvt_pk_bf16_f32 v19, v185, v189
    buffer_store_dword v19, v10, s[16:19], s38 offen offset:2112
    s_mov_b32 s38, 102400
    v_cvt_pk_bf16_f32 v20, v178, v182
    buffer_store_dword v20, v10, s[16:19], s38 offen offset:0
    v_cvt_pk_bf16_f32 v21, v186, v190
    buffer_store_dword v21, v10, s[16:19], s38 offen offset:64
    v_cvt_pk_bf16_f32 v22, v179, v183
    buffer_store_dword v22, v10, s[16:19], s38 offen offset:2048
    v_cvt_pk_bf16_f32 v23, v187, v191
    buffer_store_dword v23, v10, s[16:19], s38 offen offset:2112
    s_mov_b32 s38, 131072
    v_cvt_pk_bf16_f32 v16, v192, v196
    buffer_store_dword v16, v10, s[16:19], s38 offen offset:0
    v_cvt_pk_bf16_f32 v17, v200, v204
    buffer_store_dword v17, v10, s[16:19], s38 offen offset:64
    v_cvt_pk_bf16_f32 v18, v193, v197
    buffer_store_dword v18, v10, s[16:19], s38 offen offset:2048
    v_cvt_pk_bf16_f32 v19, v201, v205
    buffer_store_dword v19, v10, s[16:19], s38 offen offset:2112
    s_mov_b32 s38, 135168
    v_cvt_pk_bf16_f32 v20, v194, v198
    buffer_store_dword v20, v10, s[16:19], s38 offen offset:0
    v_cvt_pk_bf16_f32 v21, v202, v206
    buffer_store_dword v21, v10, s[16:19], s38 offen offset:64
    v_cvt_pk_bf16_f32 v22, v195, v199
    buffer_store_dword v22, v10, s[16:19], s38 offen offset:2048
    v_cvt_pk_bf16_f32 v23, v203, v207
    buffer_store_dword v23, v10, s[16:19], s38 offen offset:2112
    s_mov_b32 s38, 163840
    v_cvt_pk_bf16_f32 v16, v208, v212
    buffer_store_dword v16, v10, s[16:19], s38 offen offset:0
    v_cvt_pk_bf16_f32 v17, v216, v220
    buffer_store_dword v17, v10, s[16:19], s38 offen offset:64
    v_cvt_pk_bf16_f32 v18, v209, v213
    buffer_store_dword v18, v10, s[16:19], s38 offen offset:2048
    v_cvt_pk_bf16_f32 v19, v217, v221
    buffer_store_dword v19, v10, s[16:19], s38 offen offset:2112
    s_mov_b32 s38, 167936
    v_cvt_pk_bf16_f32 v20, v210, v214
    buffer_store_dword v20, v10, s[16:19], s38 offen offset:0
    v_cvt_pk_bf16_f32 v21, v218, v222
    buffer_store_dword v21, v10, s[16:19], s38 offen offset:64
    v_cvt_pk_bf16_f32 v22, v211, v215
    buffer_store_dword v22, v10, s[16:19], s38 offen offset:2048
    v_cvt_pk_bf16_f32 v23, v219, v223
    buffer_store_dword v23, v10, s[16:19], s38 offen offset:2112
    s_endpgm
K2_MH1:
    s_mul_i32 s30, s27, 5120
    s_mov_b32 s32, s30
    s_add_u32 s31, s30, 4096
    s_mov_b32 s33, s31
    s_mov_b32 s34, 0x80008000
    s_mov_b32 s35, 0
    s_add_u32 m0, s35, s32
    s_nop 0
    buffer_load_dwordx4 v1, s[8:11], s30 offen lds
    buffer_load_dwordx4 v1, s[8:11], s30 offen offset:1024 lds
    buffer_load_dwordx4 v1, s[8:11], s30 offen offset:2048 lds
    buffer_load_dwordx4 v1, s[8:11], s30 offen offset:3072 lds
    s_add_u32 m0, s35, s33
    s_nop 0
    buffer_load_dwordx4 v1, s[8:11], s31 offen lds
    s_add_u32 s30, s30, 21376
    s_add_u32 s31, s31, 21376
    s_add_u32 s35, s35, 37888
    s_add_u32 m0, s35, s32
    s_nop 0
    buffer_load_dwordx4 v1, s[8:11], s30 offen lds
    buffer_load_dwordx4 v1, s[8:11], s30 offen offset:1024 lds
    buffer_load_dwordx4 v1, s[8:11], s30 offen offset:2048 lds
    buffer_load_dwordx4 v1, s[8:11], s30 offen offset:3072 lds
    s_add_u32 m0, s35, s33
    s_nop 0
    buffer_load_dwordx4 v1, s[8:11], s31 offen lds
    s_add_u32 s30, s30, 21376
    s_add_u32 s31, s31, 21376
    s_add_u32 s35, s35, 37888
    s_add_u32 m0, s35, s32
    s_nop 0
    buffer_load_dwordx4 v1, s[8:11], s30 offen lds
    buffer_load_dwordx4 v1, s[8:11], s30 offen offset:1024 lds
    buffer_load_dwordx4 v1, s[8:11], s30 offen offset:2048 lds
    buffer_load_dwordx4 v1, s[8:11], s30 offen offset:3072 lds
    s_add_u32 m0, s35, s33
    s_nop 0
    buffer_load_dwordx4 v1, s[8:11], s31 offen lds
    s_add_u32 s30, s30, 21376
    s_add_u32 s31, s31, 21376
    s_add_u32 s35, s35, 37888
    s_add_u32 m0, s35, s32
    s_nop 0
    buffer_load_dwordx4 v1, s[8:11], s30 offen lds
    buffer_load_dwordx4 v1, s[8:11], s30 offen offset:1024 lds
    buffer_load_dwordx4 v1, s[8:11], s30 offen offset:2048 lds
    buffer_load_dwordx4 v1, s[8:11], s30 offen offset:3072 lds
    s_add_u32 m0, s35, s33
    s_nop 0
    buffer_load_dwordx4 v1, s[8:11], s31 offen lds
    s_add_u32 s30, s30, 21376
    s_add_u32 s31, s31, 21376
    s_add_u32 s35, s35, 37888
    s_mov_b32 s35, 0
    s_mov_b32 s36, 37888
    s_mov_b32 s37, 0
    v_add_u32 v11, s35, v8
    v_add_u32 v13, s35, v9
    v_xor_b32 v12, 64, v11
    v_xor_b32 v14, 32, v13
    s_waitcnt vmcnt(15)
    s_barrier
    ds_read_b64_tr_b16 v[64:65], v13 offset:0
    ds_read_b64_tr_b16 v[66:67], v13 offset:2048
    ds_read_b64_tr_b16 v[68:69], v13 offset:256
    ds_read_b64_tr_b16 v[70:71], v13 offset:2304
    ds_read_b64_tr_b16 v[76:77], v14 offset:0
    ds_read_b64_tr_b16 v[78:79], v14 offset:2048
    ds_read_b64_tr_b16 v[80:81], v14 offset:256
    ds_read_b64_tr_b16 v[82:83], v14 offset:2304
    ds_read_b128 v[16:19], v11 offset:12288
    ds_read_b128 v[20:23], v12 offset:12288
    ds_read_b128 v[24:27], v11 offset:14336
    ds_read_b128 v[28:31], v12 offset:14336
    s_waitcnt lgkmcnt(4)
    v_xor_b32 v72, s34, v68
    v_xor_b32 v73, s34, v69
    v_xor_b32 v74, s34, v70
    v_xor_b32 v75, s34, v71
    v_xor_b32 v84, s34, v80
    v_xor_b32 v85, s34, v81
    v_xor_b32 v86, s34, v82
    v_xor_b32 v87, s34, v83
    ds_read_b128 v[32:35], v11 offset:16384
    ds_read_b128 v[36:39], v12 offset:16384
    ds_read_b128 v[40:43], v11 offset:18432
    ds_read_b128 v[44:47], v12 offset:18432
K2M1_LOOP:
    s_waitcnt lgkmcnt(4)
    v_mfma_f32_16x16x32_bf16 v[128:131], v[16:19], v[64:67], v[128:131]
    ds_read_b128 v[48:51], v11 offset:20480
    v_mfma_f32_16x16x32_bf16 v[132:135], v[16:19], v[68:71], v[132:135]
    ds_read_b128 v[52:55], v12 offset:20480
    v_mfma_f32_16x16x32_bf16 v[136:139], v[16:19], v[76:79], v[136:139]
    v_mfma_f32_16x16x32_bf16 v[140:143], v[16:19], v[80:83], v[140:143]
    v_mfma_f32_16x16x32_bf16 v[128:131], v[20:23], v[72:75], v[128:131]
    v_mfma_f32_16x16x32_bf16 v[132:135], v[20:23], v[64:67], v[132:135]
    v_mfma_f32_16x16x32_bf16 v[136:139], v[20:23], v[84:87], v[136:139]
    v_mfma_f32_16x16x32_bf16 v[140:143], v[20:23], v[76:79], v[140:143]
    v_mfma_f32_16x16x32_bf16 v[144:147], v[24:27], v[64:67], v[144:147]
    v_mfma_f32_16x16x32_bf16 v[148:151], v[24:27], v[68:71], v[148:151]
    v_mfma_f32_16x16x32_bf16 v[152:155], v[24:27], v[76:79], v[152:155]
    v_mfma_f32_16x16x32_bf16 v[156:159], v[24:27], v[80:83], v[156:159]
    v_mfma_f32_16x16x32_bf16 v[144:147], v[28:31], v[72:75], v[144:147]
    v_mfma_f32_16x16x32_bf16 v[148:151], v[28:31], v[64:67], v[148:151]
    v_mfma_f32_16x16x32_bf16 v[152:155], v[28:31], v[84:87], v[152:155]
    v_mfma_f32_16x16x32_bf16 v[156:159], v[28:31], v[76:79], v[156:159]
    s_waitcnt vmcnt(10) lgkmcnt(0)
    s_barrier
    v_mfma_f32_16x16x32_bf16 v[160:163], v[32:35], v[64:67], v[160:163]
    v_add_u32 v11, s36, v8
    v_add_u32 v13, s36, v9
    v_mfma_f32_16x16x32_bf16 v[164:167], v[32:35], v[68:71], v[164:167]
    v_xor_b32 v12, 64, v11
    v_xor_b32 v14, 32, v13
    v_mfma_f32_16x16x32_bf16 v[168:171], v[32:35], v[76:79], v[168:171]
    ds_read_b64_tr_b16 v[88:89], v13 offset:0
    ds_read_b64_tr_b16 v[90:91], v13 offset:2048
    v_mfma_f32_16x16x32_bf16 v[172:175], v[32:35], v[80:83], v[172:175]
    ds_read_b64_tr_b16 v[92:93], v13 offset:256
    ds_read_b64_tr_b16 v[94:95], v13 offset:2304
    v_mfma_f32_16x16x32_bf16 v[160:163], v[36:39], v[72:75], v[160:163]
    ds_read_b64_tr_b16 v[100:101], v14 offset:0
    ds_read_b64_tr_b16 v[102:103], v14 offset:2048
    v_mfma_f32_16x16x32_bf16 v[164:167], v[36:39], v[64:67], v[164:167]
    ds_read_b64_tr_b16 v[104:105], v14 offset:256
    ds_read_b64_tr_b16 v[106:107], v14 offset:2304
    v_mfma_f32_16x16x32_bf16 v[168:171], v[36:39], v[84:87], v[168:171]
    ds_read_b128 v[16:19], v11 offset:12288
    ds_read_b128 v[20:23], v12 offset:12288
    v_mfma_f32_16x16x32_bf16 v[172:175], v[36:39], v[76:79], v[172:175]
    ds_read_b128 v[24:27], v11 offset:14336
    ds_read_b128 v[28:31], v12 offset:14336
    v_mfma_f32_16x16x32_bf16 v[176:179], v[40:43], v[64:67], v[176:179]
    ds_read_b128 v[32:35], v11 offset:16384
    ds_read_b128 v[36:39], v12 offset:16384
    v_mfma_f32_16x16x32_bf16 v[180:183], v[40:43], v[68:71], v[180:183]
    s_add_u32 m0, s35, s32
    s_nop 0
    buffer_load_dwordx4 v1, s[8:11], s30 offen lds
    v_mfma_f32_16x16x32_bf16 v[184:187], v[40:43], v[76:79], v[184:187]
    buffer_load_dwordx4 v1, s[8:11], s30 offen offset:1024 lds
    v_mfma_f32_16x16x32_bf16 v[188:191], v[40:43], v[80:83], v[188:191]
    buffer_load_dwordx4 v1, s[8:11], s30 offen offset:2048 lds
    v_mfma_f32_16x16x32_bf16 v[176:179], v[44:47], v[72:75], v[176:179]
    buffer_load_dwordx4 v1, s[8:11], s30 offen offset:3072 lds
    v_mfma_f32_16x16x32_bf16 v[180:183], v[44:47], v[64:67], v[180:183]
    s_add_u32 m0, s35, s33
    s_nop 0
    buffer_load_dwordx4 v1, s[8:11], s31 offen lds
    v_mfma_f32_16x16x32_bf16 v[184:187], v[44:47], v[84:87], v[184:187]
    s_add_u32 s30, s30, 21376
    s_add_u32 s31, s31, 21376
    v_mfma_f32_16x16x32_bf16 v[188:191], v[44:47], v[76:79], v[188:191]
    v_mfma_f32_16x16x32_bf16 v[192:195], v[48:51], v[64:67], v[192:195]
    s_waitcnt lgkmcnt(6)
    v_xor_b32 v96, s34, v92
    v_xor_b32 v97, s34, v93
    v_mfma_f32_16x16x32_bf16 v[196:199], v[48:51], v[68:71], v[196:199]
    v_xor_b32 v98, s34, v94
    v_xor_b32 v99, s34, v95
    v_mfma_f32_16x16x32_bf16 v[200:203], v[48:51], v[76:79], v[200:203]
    v_xor_b32 v108, s34, v104
    v_xor_b32 v109, s34, v105
    v_mfma_f32_16x16x32_bf16 v[204:207], v[48:51], v[80:83], v[204:207]
    v_xor_b32 v110, s34, v106
    v_xor_b32 v111, s34, v107
    v_mfma_f32_16x16x32_bf16 v[192:195], v[52:55], v[72:75], v[192:195]
    ds_read_b128 v[40:43], v11 offset:18432
    ds_read_b128 v[44:47], v12 offset:18432
    v_mfma_f32_16x16x32_bf16 v[196:199], v[52:55], v[64:67], v[196:199]
    v_mfma_f32_16x16x32_bf16 v[200:203], v[52:55], v[84:87], v[200:203]
    v_mfma_f32_16x16x32_bf16 v[204:207], v[52:55], v[76:79], v[204:207]
    s_mov_b32 s35, s36
    s_add_u32 s36, s36, 37888
    s_cmp_eq_u32 s36, 151552
    s_cselect_b32 s36, 0, s36
    s_waitcnt lgkmcnt(4)
    v_mfma_f32_16x16x32_bf16 v[128:131], v[16:19], v[88:91], v[128:131]
    ds_read_b128 v[48:51], v11 offset:20480
    v_mfma_f32_16x16x32_bf16 v[132:135], v[16:19], v[92:95], v[132:135]
    ds_read_b128 v[52:55], v12 offset:20480
    v_mfma_f32_16x16x32_bf16 v[136:139], v[16:19], v[100:103], v[136:139]
    v_mfma_f32_16x16x32_bf16 v[140:143], v[16:19], v[104:107], v[140:143]
    v_mfma_f32_16x16x32_bf16 v[128:131], v[20:23], v[96:99], v[128:131]
    v_mfma_f32_16x16x32_bf16 v[132:135], v[20:23], v[88:91], v[132:135]
    v_mfma_f32_16x16x32_bf16 v[136:139], v[20:23], v[108:111], v[136:139]
    v_mfma_f32_16x16x32_bf16 v[140:143], v[20:23], v[100:103], v[140:143]
    v_mfma_f32_16x16x32_bf16 v[144:147], v[24:27], v[88:91], v[144:147]
    v_mfma_f32_16x16x32_bf16 v[148:151], v[24:27], v[92:95], v[148:151]
    v_mfma_f32_16x16x32_bf16 v[152:155], v[24:27], v[100:103], v[152:155]
    v_mfma_f32_16x16x32_bf16 v[156:159], v[24:27], v[104:107], v[156:159]
    v_mfma_f32_16x16x32_bf16 v[144:147], v[28:31], v[96:99], v[144:147]
    v_mfma_f32_16x16x32_bf16 v[148:151], v[28:31], v[88:91], v[148:151]
    v_mfma_f32_16x16x32_bf16 v[152:155], v[28:31], v[108:111], v[152:155]
    v_mfma_f32_16x16x32_bf16 v[156:159], v[28:31], v[100:103], v[156:159]
    s_waitcnt vmcnt(10) lgkmcnt(0)
    s_barrier
    v_mfma_f32_16x16x32_bf16 v[160:163], v[32:35], v[88:91], v[160:163]
    v_add_u32 v11, s36, v8
    v_add_u32 v13, s36, v9
    v_mfma_f32_16x16x32_bf16 v[164:167], v[32:35], v[92:95], v[164:167]
    v_xor_b32 v12, 64, v11
    v_xor_b32 v14, 32, v13
    v_mfma_f32_16x16x32_bf16 v[168:171], v[32:35], v[100:103], v[168:171]
    ds_read_b64_tr_b16 v[64:65], v13 offset:0
    ds_read_b64_tr_b16 v[66:67], v13 offset:2048
    v_mfma_f32_16x16x32_bf16 v[172:175], v[32:35], v[104:107], v[172:175]
    ds_read_b64_tr_b16 v[68:69], v13 offset:256
    ds_read_b64_tr_b16 v[70:71], v13 offset:2304
    v_mfma_f32_16x16x32_bf16 v[160:163], v[36:39], v[96:99], v[160:163]
    ds_read_b64_tr_b16 v[76:77], v14 offset:0
    ds_read_b64_tr_b16 v[78:79], v14 offset:2048
    v_mfma_f32_16x16x32_bf16 v[164:167], v[36:39], v[88:91], v[164:167]
    ds_read_b64_tr_b16 v[80:81], v14 offset:256
    ds_read_b64_tr_b16 v[82:83], v14 offset:2304
    v_mfma_f32_16x16x32_bf16 v[168:171], v[36:39], v[108:111], v[168:171]
    ds_read_b128 v[16:19], v11 offset:12288
    ds_read_b128 v[20:23], v12 offset:12288
    v_mfma_f32_16x16x32_bf16 v[172:175], v[36:39], v[100:103], v[172:175]
    ds_read_b128 v[24:27], v11 offset:14336
    ds_read_b128 v[28:31], v12 offset:14336
    v_mfma_f32_16x16x32_bf16 v[176:179], v[40:43], v[88:91], v[176:179]
    ds_read_b128 v[32:35], v11 offset:16384
    ds_read_b128 v[36:39], v12 offset:16384
    v_mfma_f32_16x16x32_bf16 v[180:183], v[40:43], v[92:95], v[180:183]
    s_add_u32 m0, s35, s32
    s_nop 0
    buffer_load_dwordx4 v1, s[8:11], s30 offen lds
    v_mfma_f32_16x16x32_bf16 v[184:187], v[40:43], v[100:103], v[184:187]
    buffer_load_dwordx4 v1, s[8:11], s30 offen offset:1024 lds
    v_mfma_f32_16x16x32_bf16 v[188:191], v[40:43], v[104:107], v[188:191]
    buffer_load_dwordx4 v1, s[8:11], s30 offen offset:2048 lds
    v_mfma_f32_16x16x32_bf16 v[176:179], v[44:47], v[96:99], v[176:179]
    buffer_load_dwordx4 v1, s[8:11], s30 offen offset:3072 lds
    v_mfma_f32_16x16x32_bf16 v[180:183], v[44:47], v[88:91], v[180:183]
    s_add_u32 m0, s35, s33
    s_nop 0
    buffer_load_dwordx4 v1, s[8:11], s31 offen lds
    v_mfma_f32_16x16x32_bf16 v[184:187], v[44:47], v[108:111], v[184:187]
    s_add_u32 s30, s30, 21376
    s_add_u32 s31, s31, 21376
    v_mfma_f32_16x16x32_bf16 v[188:191], v[44:47], v[100:103], v[188:191]
    v_mfma_f32_16x16x32_bf16 v[192:195], v[48:51], v[88:91], v[192:195]
    s_waitcnt lgkmcnt(6)
    v_xor_b32 v72, s34, v68
    v_xor_b32 v73, s34, v69
    v_mfma_f32_16x16x32_bf16 v[196:199], v[48:51], v[92:95], v[196:199]
    v_xor_b32 v74, s34, v70
    v_xor_b32 v75, s34, v71
    v_mfma_f32_16x16x32_bf16 v[200:203], v[48:51], v[100:103], v[200:203]
    v_xor_b32 v84, s34, v80
    v_xor_b32 v85, s34, v81
    v_mfma_f32_16x16x32_bf16 v[204:207], v[48:51], v[104:107], v[204:207]
    v_xor_b32 v86, s34, v82
    v_xor_b32 v87, s34, v83
    v_mfma_f32_16x16x32_bf16 v[192:195], v[52:55], v[96:99], v[192:195]
    ds_read_b128 v[40:43], v11 offset:18432
    ds_read_b128 v[44:47], v12 offset:18432
    v_mfma_f32_16x16x32_bf16 v[196:199], v[52:55], v[88:91], v[196:199]
    v_mfma_f32_16x16x32_bf16 v[200:203], v[52:55], v[108:111], v[200:203]
    v_mfma_f32_16x16x32_bf16 v[204:207], v[52:55], v[100:103], v[204:207]
    s_mov_b32 s35, s36
    s_add_u32 s36, s36, 37888
    s_cmp_eq_u32 s36, 151552
    s_cselect_b32 s36, 0, s36
    s_add_u32 s37, s37, 1
    s_cmp_lt_u32 s37, 16
    s_cbranch_scc1 K2M1_LOOP
    s_nop 7
    s_nop 1
    s_mov_b32 s38, 196608
    v_cvt_pk_bf16_f32 v16, v128, v132
    buffer_store_dword v16, v10, s[16:19], s38 offen offset:0
    v_cvt_pk_bf16_f32 v17, v136, v140
    buffer_store_dword v17, v10, s[16:19], s38 offen offset:64
    v_cvt_pk_bf16_f32 v18, v129, v133
    buffer_store_dword v18, v10, s[16:19], s38 offen offset:2048
    v_cvt_pk_bf16_f32 v19, v137, v141
    buffer_store_dword v19, v10, s[16:19], s38 offen offset:2112
    s_mov_b32 s38, 200704
    v_cvt_pk_bf16_f32 v20, v130, v134
    buffer_store_dword v20, v10, s[16:19], s38 offen offset:0
    v_cvt_pk_bf16_f32 v21, v138, v142
    buffer_store_dword v21, v10, s[16:19], s38 offen offset:64
    v_cvt_pk_bf16_f32 v22, v131, v135
    buffer_store_dword v22, v10, s[16:19], s38 offen offset:2048
    v_cvt_pk_bf16_f32 v23, v139, v143
    buffer_store_dword v23, v10, s[16:19], s38 offen offset:2112
    s_mov_b32 s38, 229376
    v_cvt_pk_bf16_f32 v16, v144, v148
    buffer_store_dword v16, v10, s[16:19], s38 offen offset:0
    v_cvt_pk_bf16_f32 v17, v152, v156
    buffer_store_dword v17, v10, s[16:19], s38 offen offset:64
    v_cvt_pk_bf16_f32 v18, v145, v149
    buffer_store_dword v18, v10, s[16:19], s38 offen offset:2048
    v_cvt_pk_bf16_f32 v19, v153, v157
    buffer_store_dword v19, v10, s[16:19], s38 offen offset:2112
    s_mov_b32 s38, 233472
    v_cvt_pk_bf16_f32 v20, v146, v150
    buffer_store_dword v20, v10, s[16:19], s38 offen offset:0
    v_cvt_pk_bf16_f32 v21, v154, v158
    buffer_store_dword v21, v10, s[16:19], s38 offen offset:64
    v_cvt_pk_bf16_f32 v22, v147, v151
    buffer_store_dword v22, v10, s[16:19], s38 offen offset:2048
    v_cvt_pk_bf16_f32 v23, v155, v159
    buffer_store_dword v23, v10, s[16:19], s38 offen offset:2112
    s_mov_b32 s38, 262144
    v_cvt_pk_bf16_f32 v16, v160, v164
    buffer_store_dword v16, v10, s[16:19], s38 offen offset:0
    v_cvt_pk_bf16_f32 v17, v168, v172
    buffer_store_dword v17, v10, s[16:19], s38 offen offset:64
    v_cvt_pk_bf16_f32 v18, v161, v165
    buffer_store_dword v18, v10, s[16:19], s38 offen offset:2048
    v_cvt_pk_bf16_f32 v19, v169, v173
    buffer_store_dword v19, v10, s[16:19], s38 offen offset:2112
    s_mov_b32 s38, 266240
    v_cvt_pk_bf16_f32 v20, v162, v166
    buffer_store_dword v20, v10, s[16:19], s38 offen offset:0
    v_cvt_pk_bf16_f32 v21, v170, v174
    buffer_store_dword v21, v10, s[16:19], s38 offen offset:64
    v_cvt_pk_bf16_f32 v22, v163, v167
    buffer_store_dword v22, v10, s[16:19], s38 offen offset:2048
    v_cvt_pk_bf16_f32 v23, v171, v175
    buffer_store_dword v23, v10, s[16:19], s38 offen offset:2112
    s_mov_b32 s38, 294912
    v_cvt_pk_bf16_f32 v16, v176, v180
    buffer_store_dword v16, v10, s[16:19], s38 offen offset:0
    v_cvt_pk_bf16_f32 v17, v184, v188
    buffer_store_dword v17, v10, s[16:19], s38 offen offset:64
    v_cvt_pk_bf16_f32 v18, v177, v181
    buffer_store_dword v18, v10, s[16:19], s38 offen offset:2048
    v_cvt_pk_bf16_f32 v19, v185, v189
    buffer_store_dword v19, v10, s[16:19], s38 offen offset:2112
    s_mov_b32 s38, 299008
    v_cvt_pk_bf16_f32 v20, v178, v182
    buffer_store_dword v20, v10, s[16:19], s38 offen offset:0
    v_cvt_pk_bf16_f32 v21, v186, v190
    buffer_store_dword v21, v10, s[16:19], s38 offen offset:64
    v_cvt_pk_bf16_f32 v22, v179, v183
    buffer_store_dword v22, v10, s[16:19], s38 offen offset:2048
    v_cvt_pk_bf16_f32 v23, v187, v191
    buffer_store_dword v23, v10, s[16:19], s38 offen offset:2112
    s_mov_b32 s38, 327680
    v_cvt_pk_bf16_f32 v16, v192, v196
    buffer_store_dword v16, v10, s[16:19], s38 offen offset:0
    v_cvt_pk_bf16_f32 v17, v200, v204
    buffer_store_dword v17, v10, s[16:19], s38 offen offset:64
    v_cvt_pk_bf16_f32 v18, v193, v197
    buffer_store_dword v18, v10, s[16:19], s38 offen offset:2048
    v_cvt_pk_bf16_f32 v19, v201, v205
    buffer_store_dword v19, v10, s[16:19], s38 offen offset:2112
    s_mov_b32 s38, 331776
    v_cvt_pk_bf16_f32 v20, v194, v198
    buffer_store_dword v20, v10, s[16:19], s38 offen offset:0
    v_cvt_pk_bf16_f32 v21, v202, v206
    buffer_store_dword v21, v10, s[16:19], s38 offen offset:64
    v_cvt_pk_bf16_f32 v22, v195, v199
    buffer_store_dword v22, v10, s[16:19], s38 offen offset:2048
    v_cvt_pk_bf16_f32 v23, v203, v207
    buffer_store_dword v23, v10, s[16:19], s38 offen offset:2112
    s_endpgm
K2_END:
    s_endpgm
.p2align 8
.type k3_stats_kernel,@function
k3_stats_kernel:
    s_cmp_ge_u32 s2, 256
    s_cbranch_scc1 K3_END
    s_load_dwordx2 s[4:5], s[0:1], 48
    v_lshrrev_b32 v1, 6, v0
    v_and_b32 v2, 63, v0
    v_readfirstlane_b32 s3, v1
    s_and_b32 s6, s2, 15
    s_lshr_b32 s7, s2, 4
    s_lshr_b32 s20, s6, 3
    s_and_b32 s21, s6, 7
    s_mul_i32 s22, s7, 11
    s_mul_i32 s23, s7, 10
    s_add_u32 s23, s23, 7
    s_cmp_lt_u32 s7, 7
    s_cselect_b32 s22, s22, s23
    s_cselect_b32 s23, 11, 10
    s_add_u32 s22, s22, s3
    v_and_b32 v3, 15, v2
    v_lshrrev_b32 v4, 4, v2
    v_lshlrev_b32 v5, 4, v2
    s_mov_b32 s24, 2736128
    v_mul_lo_u32 v6, v4, s24
    v_lshl_add_u32 v6, v3, 4, v6
    s_mul_i32 s25, s20, 167
    s_add_u32 s25, s25, s22
    s_lshl_b32 s25, s25, 11
    s_lshl_b32 s24, s21, 8
    s_add_u32 s25, s25, s24
    s_waitcnt lgkmcnt(0)
    s_add_u32 s8, s4, 118489088
    s_addc_u32 s9, s5, 0
    s_and_b32 s9, s9, 0xffff
    s_mov_b32 s10, 21889024
    s_mov_b32 s11, 0x00020000
    s_add_u32 s12, s4, 143654912
    s_addc_u32 s13, s5, 0
    s_and_b32 s13, s13, 0xffff
    s_mov_b32 s14, 131072
    s_mov_b32 s15, 0x00020000
    s_cmp_lt_u32 s3, s23
    s_cbranch_scc0 K3_NOLOAD
    buffer_load_dwordx4 v[16:19], v6, s[8:11], s25 offen
    s_add_u32 s25, s25, 684032
    buffer_load_dwordx4 v[20:23], v6, s[8:11], s25 offen
    s_add_u32 s25, s25, 684032
    buffer_load_dwordx4 v[24:27], v6, s[8:11], s25 offen
    s_add_u32 s25, s25, 684032
    buffer_load_dwordx4 v[28:31], v6, s[8:11], s25 offen
    s_add_u32 s25, s25, 8892416
    buffer_load_dwordx4 v[32:35], v6, s[8:11], s25 offen
    s_add_u32 s25, s25, 684032
    buffer_load_dwordx4 v[36:39], v6, s[8:11], s25 offen
    s_add_u32 s25, s25, 684032
    buffer_load_dwordx4 v[40:43], v6, s[8:11], s25 offen
    s_add_u32 s25, s25, 684032
    buffer_load_dwordx4 v[44:47], v6, s[8:11], s25 offen
K3_NOLOAD:
    s_cmp_ge_u32 s3, 6
    s_cbranch_scc1 K3_TABDONE
    s_sub_u32 s27, s3, 0
    s_lshr_b32 s28, s27, 1
    s_and_b32 s29, s27, 1
    s_lshl_b32 s30, s28, 4
    v_add_u32 v8, s30, v3
    s_lshl_b32 s30, s29, 5
    s_add_u32 s30, s30, 1
    v_lshlrev_b32 v9, 3, v4
    v_add_u32 v9, s30, v9
    v_mul_u32_u24 v9, v8, v9
    v_lshlrev_b32 v8, 1, v8
    v_mad_u32_u24 v48, v8, 0, v9
    v_mad_u32_u24 v49, v8, 0, v9
    v_add_u32 v49, 32, v49
    v_mad_u32_u24 v50, v8, 1, v9
    v_mad_u32_u24 v51, v8, 1, v9
    v_add_u32 v51, 32, v51
    v_mad_u32_u24 v52, v8, 2, v9
    v_mad_u32_u24 v53, v8, 2, v9
    v_add_u32 v53, 32, v53
    v_mad_u32_u24 v54, v8, 3, v9
    v_mad_u32_u24 v55, v8, 3, v9
    v_add_u32 v55, 32, v55
    v_and_b32 v48, 127, v48
    v_and_b32 v49, 127, v49
    v_and_b32 v50, 127, v50
    v_and_b32 v51, 127, v51
    v_and_b32 v52, 127, v52
    v_and_b32 v53, 127, v53
    v_and_b32 v54, 127, v54
    v_and_b32 v55, 127, v55
    v_cvt_f32_u32 v48, v48
    v_cvt_f32_u32 v49, v49
    v_cvt_f32_u32 v50, v50
    v_cvt_f32_u32 v51, v51
    v_cvt_f32_u32 v52, v52
    v_cvt_f32_u32 v53, v53
    v_cvt_f32_u32 v54, v54
    v_cvt_f32_u32 v55, v55
    v_mul_f32 v48, 0x3c000000, v48
    v_mul_f32 v49, 0x3c000000, v49
    v_mul_f32 v50, 0x3c000000, v50
    v_mul_f32 v51, 0x3c000000, v51
    v_mul_f32 v52, 0x3c000000, v52
    v_mul_f32 v53, 0x3c000000, v53
    v_mul_f32 v54, 0x3c000000, v54
    v_mul_f32 v55, 0x3c000000, v55
    v_cos_f32 v48, v48
    v_cos_f32 v49, v49
    v_cos_f32 v50, v50
    v_cos_f32 v51, v51
    v_cos_f32 v52, v52
    v_cos_f32 v53, v53
    v_cos_f32 v54, v54
    v_cos_f32 v55, v55
    s_nop 0
    v_mul_f32 v48, 0x3d000000, v48
    v_mul_f32 v49, 0x3d000000, v49
    v_mul_f32 v50, 0x3d000000, v50
    v_mul_f32 v51, 0x3d000000, v51
    v_mul_f32 v52, 0x3d000000, v52
    v_mul_f32 v53, 0x3d000000, v53
    v_mul_f32 v54, 0x3d000000, v54
    v_mul_f32 v55, 0x3d000000, v55
    v_cvt_pk_bf16_f32 v56, v48, v49
    v_cvt_pk_bf16_f32 v57, v50, v51
    v_cvt_pk_bf16_f32 v58, v52, v53
    v_cvt_pk_bf16_f32 v59, v54, v55
    v_lshlrev_b32 v64, 16, v56
    v_and_b32 v65, 0xffff0000, v56
    v_sub_f32 v48, v48, v64
    v_sub_f32 v49, v49, v65
    v_lshlrev_b32 v64, 16, v57
    v_and_b32 v65, 0xffff0000, v57
    v_sub_f32 v50, v50, v64
    v_sub_f32 v51, v51, v65
    v_lshlrev_b32 v64, 16, v58
    v_and_b32 v65, 0xffff0000, v58
    v_sub_f32 v52, v52, v64
    v_sub_f32 v53, v53, v65
    v_lshlrev_b32 v64, 16, v59
    v_and_b32 v65, 0xffff0000, v59
    v_sub_f32 v54, v54, v64
    v_sub_f32 v55, v55, v65
    v_cvt_pk_bf16_f32 v60, v48, v49
    v_cvt_pk_bf16_f32 v61, v50, v51
    v_cvt_pk_bf16_f32 v62, v52, v53
    v_cvt_pk_bf16_f32 v63, v54, v55
    s_lshl_b32 s30, s27, 11
    v_add_u32 v10, s30, v5
    ds_write_b128 v10, v[56:59]
    ds_write_b128 v10, v[60:63] offset:1024
K3_TABDONE:
    s_waitcnt lgkmcnt(0)
    s_barrier
    s_cmp_lt_u32 s3, s23
    s_cbranch_scc0 K3_IDLE
    ds_read_b128 v[48:51], v5 offset:0
    ds_read_b128 v[52:55], v5 offset:1024
    ds_read_b128 v[56:59], v5 offset:2048
    ds_read_b128 v[60:63], v5 offset:3072
    ds_read_b128 v[64:67], v5 offset:4096
    ds_read_b128 v[68:71], v5 offset:5120
    ds_read_b128 v[72:75], v5 offset:6144
    ds_read_b128 v[76:79], v5 offset:7168
    ds_read_b128 v[80:83], v5 offset:8192
    ds_read_b128 v[84:87], v5 offset:9216
    ds_read_b128 v[88:91], v5 offset:10240
    ds_read_b128 v[92:95], v5 offset:11264
    s_waitcnt vmcnt(0)
    v_swap_b32 v17, v20
    v_swap_b32 v18, v24
    v_swap_b32 v19, v28
    v_swap_b32 v22, v25
    v_swap_b32 v23, v29
    v_swap_b32 v27, v30
    v_swap_b32 v33, v36
    v_swap_b32 v34, v40
    v_swap_b32 v35, v44
    v_swap_b32 v38, v41
    v_swap_b32 v39, v45
    v_swap_b32 v43, v46
    s_waitcnt lgkmcnt(0)
    s_mul_i32 s24, s22, 48
    s_sub_u32 s24, 7985, s24
    s_cmp_ge_u32 s24, 48
    s_cbranch_scc1 K3_FULL
    v_add_u32 v7, 0, v3
    v_cmp_gt_u32 vcc, s24, v7
    s_nop 1
    v_cndmask_b32 v48, 0, v48, vcc
    v_cndmask_b32 v49, 0, v49, vcc
    v_cndmask_b32 v50, 0, v50, vcc
    v_cndmask_b32 v51, 0, v51, vcc
    v_cndmask_b32 v52, 0, v52, vcc
    v_cndmask_b32 v53, 0, v53, vcc
    v_cndmask_b32 v54, 0, v54, vcc
    v_cndmask_b32 v55, 0, v55, vcc
    v_cndmask_b32 v56, 0, v56, vcc
    v_cndmask_b32 v57, 0, v57, vcc
    v_cndmask_b32 v58, 0, v58, vcc
    v_cndmask_b32 v59, 0, v59, vcc
    v_cndmask_b32 v60, 0, v60, vcc
    v_cndmask_b32 v61, 0, v61, vcc
    v_cndmask_b32 v62, 0, v62, vcc
    v_cndmask_b32 v63, 0, v63, vcc
    v_add_u32 v7, 16, v3
    v_cmp_gt_u32 vcc, s24, v7
    s_nop 1
    v_cndmask_b32 v64, 0, v64, vcc
    v_cndmask_b32 v65, 0, v65, vcc
    v_cndmask_b32 v66, 0, v66, vcc
    v_cndmask_b32 v67, 0, v67, vcc
    v_cndmask_b32 v68, 0, v68, vcc
    v_cndmask_b32 v69, 0, v69, vcc
    v_cndmask_b32 v70, 0, v70, vcc
    v_cndmask_b32 v71, 0, v71, vcc
    v_cndmask_b32 v72, 0, v72, vcc
    v_cndmask_b32 v73, 0, v73, vcc
    v_cndmask_b32 v74, 0, v74, vcc
    v_cndmask_b32 v75, 0, v75, vcc
    v_cndmask_b32 v76, 0, v76, vcc
    v_cndmask_b32 v77, 0, v77, vcc
    v_cndmask_b32 v78, 0, v78, vcc
    v_cndmask_b32 v79, 0, v79, vcc
    v_add_u32 v7, 32, v3
    v_cmp_gt_u32 vcc, s24, v7
    s_nop 1
    v_cndmask_b32 v80, 0, v80, vcc
    v_cndmask_b32 v81, 0, v81, vcc
    v_cndmask_b32 v82, 0, v82, vcc
    v_cndmask_b32 v83, 0, v83, vcc
    v_cndmask_b32 v84, 0, v84, vcc
    v_cndmask_b32 v85, 0, v85, vcc
    v_cndmask_b32 v86, 0, v86, vcc
    v_cndmask_b32 v87, 0, v87, vcc
    v_cndmask_b32 v88, 0, v88, vcc
    v_cndmask_b32 v89, 0, v89, vcc
    v_cndmask_b32 v90, 0, v90, vcc
    v_cndmask_b32 v91, 0, v91, vcc
    v_cndmask_b32 v92, 0, v92, vcc
    v_cndmask_b32 v93, 0, v93, vcc
    v_cndmask_b32 v94, 0, v94, vcc
    v_cndmask_b32 v95, 0, v95, vcc
K3_FULL:
    s_nop 1
    v_mfma_f32_16x16x32_bf16 v[96:99], v[48:51], v[16:19], 0
    v_mfma_f32_16x16x32_bf16 v[100:103], v[48:51], v[20:23], 0
    v_mfma_f32_16x16x32_bf16 v[104:107], v[48:51], v[24:27], 0
    v_mfma_f32_16x16x32_bf16 v[108:111], v[48:51], v[28:31], 0
    v_mfma_f32_16x16x32_bf16 v[96:99], v[52:55], v[16:19], v[96:99]
    v_mfma_f32_16x16x32_bf16 v[100:103], v[52:55], v[20:23], v[100:103]
    v_mfma_f32_16x16x32_bf16 v[104:107], v[52:55], v[24:27], v[104:107]
    v_mfma_f32_16x16x32_bf16 v[108:111], v[52:55], v[28:31], v[108:111]
    v_mfma_f32_16x16x32_bf16 v[96:99], v[56:59], v[32:35], v[96:99]
    v_mfma_f32_16x16x32_bf16 v[100:103], v[56:59], v[36:39], v[100:103]
    v_mfma_f32_16x16x32_bf16 v[104:107], v[56:59], v[40:43], v[104:107]
    v_mfma_f32_16x16x32_bf16 v[108:111], v[56:59], v[44:47], v[108:111]
    v_mfma_f32_16x16x32_bf16 v[96:99], v[60:63], v[32:35], v[96:99]
    v_mfma_f32_16x16x32_bf16 v[100:103], v[60:63], v[36:39], v[100:103]
    v_mfma_f32_16x16x32_bf16 v[104:107], v[60:63], v[40:43], v[104:107]
    v_mfma_f32_16x16x32_bf16 v[108:111], v[60:63], v[44:47], v[108:111]
    v_mfma_f32_16x16x32_bf16 v[112:115], v[64:67], v[16:19], 0
    v_mfma_f32_16x16x32_bf16 v[116:119], v[64:67], v[20:23], 0
    v_mfma_f32_16x16x32_bf16 v[120:123], v[64:67], v[24:27], 0
    v_mfma_f32_16x16x32_bf16 v[124:127], v[64:67], v[28:31], 0
    v_mfma_f32_16x16x32_bf16 v[112:115], v[68:71], v[16:19], v[112:115]
    v_mfma_f32_16x16x32_bf16 v[116:119], v[68:71], v[20:23], v[116:119]
    v_mfma_f32_16x16x32_bf16 v[120:123], v[68:71], v[24:27], v[120:123]
    v_mfma_f32_16x16x32_bf16 v[124:127], v[68:71], v[28:31], v[124:127]
    v_mfma_f32_16x16x32_bf16 v[112:115], v[72:75], v[32:35], v[112:115]
    v_mfma_f32_16x16x32_bf16 v[116:119], v[72:75], v[36:39], v[116:119]
    v_mfma_f32_16x16x32_bf16 v[120:123], v[72:75], v[40:43], v[120:123]
    v_mfma_f32_16x16x32_bf16 v[124:127], v[72:75], v[44:47], v[124:127]
    v_mfma_f32_16x16x32_bf16 v[112:115], v[76:79], v[32:35], v[112:115]
    v_mfma_f32_16x16x32_bf16 v[116:119], v[76:79], v[36:39], v[116:119]
    v_mfma_f32_16x16x32_bf16 v[120:123], v[76:79], v[40:43], v[120:123]
    v_mfma_f32_16x16x32_bf16 v[124:127], v[76:79], v[44:47], v[124:127]
    v_mfma_f32_16x16x32_bf16 v[128:131], v[80:83], v[16:19], 0
    v_mfma_f32_16x16x32_bf16 v[132:135], v[80:83], v[20:23], 0
    v_mfma_f32_16x16x32_bf16 v[136:139], v[80:83], v[24:27], 0
    v_mfma_f32_16x16x32_bf16 v[140:143], v[80:83], v[28:31], 0
    v_mfma_f32_16x16x32_bf16 v[128:131], v[84:87], v[16:19], v[128:131]
    v_mfma_f32_16x16x32_bf16 v[132:135], v[84:87], v[20:23], v[132:135]
    v_mfma_f32_16x16x32_bf16 v[136:139], v[84:87], v[24:27], v[136:139]
    v_mfma_f32_16x16x32_bf16 v[140:143], v[84:87], v[28:31], v[140:143]
    v_mfma_f32_16x16x32_bf16 v[128:131], v[88:91], v[32:35], v[128:131]
    v_mfma_f32_16x16x32_bf16 v[132:135], v[88:91], v[36:39], v[132:135]
    v_mfma_f32_16x16x32_bf16 v[136:139], v[88:91], v[40:43], v[136:139]
    v_mfma_f32_16x16x32_bf16 v[140:143], v[88:91], v[44:47], v[140:143]
    v_mfma_f32_16x16x32_bf16 v[128:131], v[92:95], v[32:35], v[128:131]
    v_mfma_f32_16x16x32_bf16 v[132:135], v[92:95], v[36:39], v[132:135]
    v_mfma_f32_16x16x32_bf16 v[136:139], v[92:95], v[40:43], v[136:139]
    v_mfma_f32_16x16x32_bf16 v[140:143], v[92:95], v[44:47], v[140:143]
    s_nop 7
    v_mov_b32 v16, v96
    v_mul_f32 v20, v96, v96
    v_mov_b32 v17, v100
    v_mul_f32 v21, v100, v100
    v_mov_b32 v18, v104
    v_mul_f32 v22, v104, v104
    v_mov_b32 v19, v108
    v_mul_f32 v23, v108, v108
    v_add_f32 v16, v16, v97
    v_fmac_f32 v20, v97, v97
    v_add_f32 v17, v17, v101
    v_fmac_f32 v21, v101, v101
    v_add_f32 v18, v18, v105
    v_fmac_f32 v22, v105, v105
    v_add_f32 v19, v19, v109
    v_fmac_f32 v23, v109, v109
    v_add_f32 v16, v16, v98
    v_fmac_f32 v20, v98, v98
    v_add_f32 v17, v17, v102
    v_fmac_f32 v21, v102, v102
    v_add_f32 v18, v18, v106
    v_fmac_f32 v22, v106, v106
    v_add_f32 v19, v19, v110
    v_fmac_f32 v23, v110, v110
    v_add_f32 v16, v16, v99
    v_fmac_f32 v20, v99, v99
    v_add_f32 v17, v17, v103
    v_fmac_f32 v21, v103, v103
    v_add_f32 v18, v18, v107
    v_fmac_f32 v22, v107, v107
    v_add_f32 v19, v19, v111
    v_fmac_f32 v23, v111, v111
    v_add_f32 v16, v16, v112
    v_fmac_f32 v20, v112, v112
    v_add_f32 v17, v17, v116
    v_fmac_f32 v21, v116, v116
    v_add_f32 v18, v18, v120
    v_fmac_f32 v22, v120, v120
    v_add_f32 v19, v19, v124
    v_fmac_f32 v23, v124, v124
    v_add_f32 v16, v16, v113
    v_fmac_f32 v20, v113, v113
    v_add_f32 v17, v17, v117
    v_fmac_f32 v21, v117, v117
    v_add_f32 v18, v18, v121
    v_fmac_f32 v22, v121, v121
    v_add_f32 v19, v19, v125
    v_fmac_f32 v23, v125, v125
    v_add_f32 v16, v16, v114
    v_fmac_f32 v20, v114, v114
    v_add_f32 v17, v17, v118
    v_fmac_f32 v21, v118, v118
    v_add_f32 v18, v18, v122
    v_fmac_f32 v22, v122, v122
    v_add_f32 v19, v19, v126
    v_fmac_f32 v23, v126, v126
    v_add_f32 v16, v16, v115
    v_fmac_f32 v20, v115, v115
    v_add_f32 v17, v17, v119
    v_fmac_f32 v21, v119, v119
    v_add_f32 v18, v18, v123
    v_fmac_f32 v22, v123, v123
    v_add_f32 v19, v19, v127
    v_fmac_f32 v23, v127, v127
    v_add_f32 v16, v16, v128
    v_fmac_f32 v20, v128, v128
    v_add_f32 v17, v17, v132
    v_fmac_f32 v21, v132, v132
    v_add_f32 v18, v18, v136
    v_fmac_f32 v22, v136, v136
    v_add_f32 v19, v19, v140
    v_fmac_f32 v23, v140, v140
    v_add_f32 v16, v16, v129
    v_fmac_f32 v20, v129, v129
    v_add_f32 v17, v17, v133
    v_fmac_f32 v21, v133, v133
    v_add_f32 v18, v18, v137
    v_fmac_f32 v22, v137, v137
    v_add_f32 v19, v19, v141
    v_fmac_f32 v23, v141, v141
    v_add_f32 v16, v16, v130
    v_fmac_f32 v20, v130, v130
    v_add_f32 v17, v17, v134
    v_fmac_f32 v21, v134, v134
    v_add_f32 v18, v18, v138
    v_fmac_f32 v22, v138, v138
    v_add_f32 v19, v19, v142
    v_fmac_f32 v23, v142, v142
    v_add_f32 v16, v16, v131
    v_fmac_f32 v20, v131, v131
    v_add_f32 v17, v17, v135
    v_fmac_f32 v21, v135, v135
    v_add_f32 v18, v18, v139
    v_fmac_f32 v22, v139, v139
    v_add_f32 v19, v19, v143
    v_fmac_f32 v23, v143, v143
    v_mov_b32 v24, v16
    v_mov_b32 v25, v17
    v_mov_b32 v26, v18
    v_mov_b32 v27, v19
    v_mov_b32 v28, v20
    v_mov_b32 v29, v21
    v_mov_b32 v30, v22
    v_mov_b32 v31, v23
    s_nop 0
    v_permlane32_swap_b32 v16, v24
    v_permlane32_swap_b32 v17, v25
    v_permlane32_swap_b32 v18, v26
    v_permlane32_swap_b32 v19, v27
    v_permlane32_swap_b32 v20, v28
    v_permlane32_swap_b32 v21, v29
    v_permlane32_swap_b32 v22, v30
    v_permlane32_swap_b32 v23, v31
    v_add_f32 v16, v16, v24
    v_add_f32 v17, v17, v25
    v_add_f32 v18, v18, v26
    v_add_f32 v19, v19, v27
    v_add_f32 v20, v20, v28
    v_add_f32 v21, v21, v29
    v_add_f32 v22, v22, v30
    v_add_f32 v23, v23, v31
    v_mov_b32 v24, v16
    v_mov_b32 v25, v17
    v_mov_b32 v26, v18
    v_mov_b32 v27, v19
    v_mov_b32 v28, v20
    v_mov_b32 v29, v21
    v_mov_b32 v30, v22
    v_mov_b32 v31, v23
    s_nop 0
    v_permlane16_swap_b32 v16, v24
    v_permlane16_swap_b32 v17, v25
    v_permlane16_swap_b32 v18, v26
    v_permlane16_swap_b32 v19, v27
    v_permlane16_swap_b32 v20, v28
    v_permlane16_swap_b32 v21, v29
    v_permlane16_swap_b32 v22, v30
    v_permlane16_swap_b32 v23, v31
    v_add_f32 v16, v16, v24
    v_add_f32 v17, v17, v25
    v_add_f32 v18, v18, v26
    v_add_f32 v19, v19, v27
    v_add_f32 v20, v20, v28
    v_add_f32 v21, v21, v29
    v_add_f32 v22, v22, v30
    v_add_f32 v23, v23, v31
    s_branch K3_WR
K3_IDLE:
    v_mov_b32 v16, 0
    v_mov_b32 v17, 0
    v_mov_b32 v18, 0
    v_mov_b32 v19, 0
    v_mov_b32 v20, 0
    v_mov_b32 v21, 0
    v_mov_b32 v22, 0
    v_mov_b32 v23, 0
K3_WR:
    s_lshl_b32 s24, s3, 9
    v_lshlrev_b32 v7, 4, v3
    v_add_u32 v7, s24, v7
    ds_write_b128 v7, v[16:19] offset:12288
    ds_write_b128 v7, v[20:23] offset:12544
    s_waitcnt lgkmcnt(0)
    s_barrier
    s_cmp_ge_u32 s3, 2
    s_cbranch_scc1 K3_END
    v_lshlrev_b32 v7, 2, v0
    ds_read_b32 v32, v7 offset:12288
    ds_read_b32 v33, v7 offset:12800
    ds_read_b32 v34, v7 offset:13312
    ds_read_b32 v35, v7 offset:13824
    ds_read_b32 v36, v7 offset:14336
    ds_read_b32 v37, v7 offset:14848
    ds_read_b32 v38, v7 offset:15360
    ds_read_b32 v39, v7 offset:15872
    ds_read_b32 v40, v7 offset:16384
    ds_read_b32 v41, v7 offset:16896
    ds_read_b32 v42, v7 offset:17408
    ds_read_b32 v43, v7 offset:17920
    s_waitcnt lgkmcnt(0)
    v_add_f32 v32, v32, v33
    v_add_f32 v32, v32, v34
    v_add_f32 v32, v32, v35
    v_add_f32 v32, v32, v36
    v_add_f32 v32, v32, v37
    v_add_f32 v32, v32, v38
    v_add_f32 v32, v32, v39
    v_add_f32 v32, v32, v40
    v_add_f32 v32, v32, v41
    v_add_f32 v32, v32, v42
    v_add_f32 v32, v32, v43
    s_lshl_b32 s24, s6, 4
    s_add_u32 s24, s24, s7
    s_lshl_b32 s24, s24, 9
    buffer_store_dword v32, v7, s[12:15], s24 offen
K3_END:
    s_endpgm
.p2align 8
.type k4_out_kernel,@function
k4_out_kernel:
    s_cmp_ge_u32 s2, 256
    s_cbranch_scc1 K4_END
    s_load_dwordx2 s[4:5], s[0:1], 48
    s_load_dwordx4 s[40:43], s[0:1], 16
    s_load_dwordx2 s[44:45], s[0:1], 32
    v_lshrrev_b32 v1, 6, v0
    v_and_b32 v2, 63, v0
    v_readfirstlane_b32 s3, v1
    s_and_b32 s6, s2, 15
    s_lshr_b32 s7, s2, 4
    s_lshr_b32 s20, s6, 3
    s_and_b32 s21, s6, 7
    s_mul_i32 s22, s7, 11
    s_mul_i32 s23, s7, 10
    s_add_u32 s23, s23, 7
    s_cmp_lt_u32 s7, 7
    s_cselect_b32 s22, s22, s23
    s_cselect_b32 s23, 11, 10
    s_add_u32 s22, s22, s3
    v_and_b32 v3, 15, v2
    v_lshrrev_b32 v4, 4, v2
    v_lshlrev_b32 v5, 4, v2
    s_mov_b32 s24, 2736128
    v_mul_lo_u32 v6, v4, s24
    v_lshl_add_u32 v6, v3, 4, v6
    s_mul_i32 s25, s20, 167
    s_add_u32 s25, s25, s22
    s_lshl_b32 s25, s25, 11
    s_lshl_b32 s24, s21, 8
    s_add_u32 s25, s25, s24
    s_waitcnt lgkmcnt(0)
    s_add_u32 s8, s4, 118489088
    s_addc_u32 s9, s5, 0
    s_and_b32 s9, s9, 0xffff
    s_mov_b32 s10, 21889024
    s_mov_b32 s11, 0x00020000
    s_add_u32 s12, s4, 143654912
    s_addc_u32 s13, s5, 0
    s_and_b32 s13, s13, 0xffff
    s_mov_b32 s14, 131072
    s_mov_b32 s15, 0x00020000
    s_cmp_lt_u32 s3, s23
    s_cbranch_scc0 K4_NOLOAD
    buffer_load_dwordx4 v[16:19], v6, s[8:11], s25 offen
    s_add_u32 s25, s25, 684032
    buffer_load_dwordx4 v[20:23], v6, s[8:11], s25 offen
    s_add_u32 s25, s25, 684032
    buffer_load_dwordx4 v[24:27], v6, s[8:11], s25 offen
    s_add_u32 s25, s25, 684032
    buffer_load_dwordx4 v[28:31], v6, s[8:11], s25 offen
    s_add_u32 s25, s25, 8892416
    buffer_load_dwordx4 v[32:35], v6, s[8:11], s25 offen
    s_add_u32 s25, s25, 684032
    buffer_load_dwordx4 v[36:39], v6, s[8:11], s25 offen
    s_add_u32 s25, s25, 684032
    buffer_load_dwordx4 v[40:43], v6, s[8:11], s25 offen
    s_add_u32 s25, s25, 684032
    buffer_load_dwordx4 v[44:47], v6, s[8:11], s25 offen
K4_NOLOAD:
    s_cmp_lg_u32 s3, 0
    s_cbranch_scc1 K4_TAB
    s_mov_b32 s16, s40
    s_mov_b32 s17, s41
    s_and_b32 s17, s17, 0xffff
    s_mov_b32 s18, 1024
    s_mov_b32 s19, 0x00020000
    s_mov_b32 s28, s42
    s_mov_b32 s29, s43
    s_and_b32 s29, s29, 0xffff
    s_mov_b32 s30, 1024
    s_mov_b32 s31, 0x00020000
    v_lshlrev_b32 v7, 2, v2
    s_lshl_b32 s24, s6, 13
    buffer_load_dword v96, v7, s[12:15], s24 offen offset:0
    buffer_load_dword v112, v7, s[12:15], s24 offen offset:256
    buffer_load_dword v97, v7, s[12:15], s24 offen offset:512
    buffer_load_dword v113, v7, s[12:15], s24 offen offset:768
    buffer_load_dword v98, v7, s[12:15], s24 offen offset:1024
    buffer_load_dword v114, v7, s[12:15], s24 offen offset:1280
    buffer_load_dword v99, v7, s[12:15], s24 offen offset:1536
    buffer_load_dword v115, v7, s[12:15], s24 offen offset:1792
    buffer_load_dword v100, v7, s[12:15], s24 offen offset:2048
    buffer_load_dword v116, v7, s[12:15], s24 offen offset:2304
    buffer_load_dword v101, v7, s[12:15], s24 offen offset:2560
    buffer_load_dword v117, v7, s[12:15], s24 offen offset:2816
    buffer_load_dword v102, v7, s[12:15], s24 offen offset:3072
    buffer_load_dword v118, v7, s[12:15], s24 offen offset:3328
    buffer_load_dword v103, v7, s[12:15], s24 offen offset:3584
    buffer_load_dword v119, v7, s[12:15], s24 offen offset:3840
    s_add_u32 s24, s24, 4096
    buffer_load_dword v104, v7, s[12:15], s24 offen offset:0
    buffer_load_dword v120, v7, s[12:15], s24 offen offset:256
    buffer_load_dword v105, v7, s[12:15], s24 offen offset:512
    buffer_load_dword v121, v7, s[12:15], s24 offen offset:768
    buffer_load_dword v106, v7, s[12:15], s24 offen offset:1024
    buffer_load_dword v122, v7, s[12:15], s24 offen offset:1280
    buffer_load_dword v107, v7, s[12:15], s24 offen offset:1536
    buffer_load_dword v123, v7, s[12:15], s24 offen offset:1792
    buffer_load_dword v108, v7, s[12:15], s24 offen offset:2048
    buffer_load_dword v124, v7, s[12:15], s24 offen offset:2304
    buffer_load_dword v109, v7, s[12:15], s24 offen offset:2560
    buffer_load_dword v125, v7, s[12:15], s24 offen offset:2816
    buffer_load_dword v110, v7, s[12:15], s24 offen offset:3072
    buffer_load_dword v126, v7, s[12:15], s24 offen offset:3328
    buffer_load_dword v111, v7, s[12:15], s24 offen offset:3584
    buffer_load_dword v127, v7, s[12:15], s24 offen offset:3840
    s_lshl_b32 s24, s21, 7
    v_lshlrev_b32 v8, 1, v2
    buffer_load_ushort v9, v8, s[16:19], s24 offen
    buffer_load_ushort v10, v8, s[28:31], s24 offen
    s_waitcnt vmcnt(0)
    v_add_f32 v96, v96, v104
    v_add_f32 v112, v112, v120
    v_add_f32 v97, v97, v105
    v_add_f32 v113, v113, v121
    v_add_f32 v98, v98, v106
    v_add_f32 v114, v114, v122
    v_add_f32 v99, v99, v107
    v_add_f32 v115, v115, v123
    v_add_f32 v100, v100, v108
    v_add_f32 v116, v116, v124
    v_add_f32 v101, v101, v109
    v_add_f32 v117, v117, v125
    v_add_f32 v102, v102, v110
    v_add_f32 v118, v118, v126
    v_add_f32 v103, v103, v111
    v_add_f32 v119, v119, v127
    v_add_f32 v96, v96, v100
    v_add_f32 v112, v112, v116
    v_add_f32 v97, v97, v101
    v_add_f32 v113, v113, v117
    v_add_f32 v98, v98, v102
    v_add_f32 v114, v114, v118
    v_add_f32 v99, v99, v103
    v_add_f32 v115, v115, v119
    v_add_f32 v96, v96, v98
    v_add_f32 v112, v112, v114
    v_add_f32 v97, v97, v99
    v_add_f32 v113, v113, v115
    v_add_f32 v96, v96, v97
    v_add_f32 v112, v112, v113
    v_mul_f32 v11, 0x39035177, v96
    v_mul_f32 v12, 0x39035177, v112
    v_fma_f32 v12, -v11, v11, v12
    v_max_f32 v12, 0, v12
    v_add_f32 v12, 0x3727c5ac, v12
    v_sqrt_f32 v12, v12
    v_lshlrev_b32 v9, 16, v9
    v_rcp_f32 v12, v12
    v_lshlrev_b32 v10, 16, v10
    v_mul_f32 v9, v9, v12
    v_fma_f32 v10, -v11, v9, v10
    ds_write_b32 v7, v9 offset:12288
    ds_write_b32 v7, v10 offset:12544
    s_branch K4_TABDONE
K4_TAB:
    s_cmp_ge_u32 s3, 7
    s_cbranch_scc1 K4_TABDONE
    s_sub_u32 s27, s3, 1
    s_lshr_b32 s28, s27, 1
    s_and_b32 s29, s27, 1
    s_lshl_b32 s30, s28, 4
    v_add_u32 v8, s30, v3
    s_lshl_b32 s30, s29, 5
    s_add_u32 s30, s30, 1
    v_lshlrev_b32 v9, 3, v4
    v_add_u32 v9, s30, v9
    v_mul_u32_u24 v9, v8, v9
    v_lshlrev_b32 v8, 1, v8
    v_mad_u32_u24 v48, v8, 0, v9
    v_mad_u32_u24 v49, v8, 0, v9
    v_add_u32 v49, 32, v49
    v_mad_u32_u24 v50, v8, 1, v9
    v_mad_u32_u24 v51, v8, 1, v9
    v_add_u32 v51, 32, v51
    v_mad_u32_u24 v52, v8, 2, v9
    v_mad_u32_u24 v53, v8, 2, v9
    v_add_u32 v53, 32, v53
    v_mad_u32_u24 v54, v8, 3, v9
    v_mad_u32_u24 v55, v8, 3, v9
    v_add_u32 v55, 32, v55
    v_and_b32 v48, 127, v48
    v_and_b32 v49, 127, v49
    v_and_b32 v50, 127, v50
    v_and_b32 v51, 127, v51
    v_and_b32 v52, 127, v52
    v_and_b32 v53, 127, v53
    v_and_b32 v54, 127, v54
    v_and_b32 v55, 127, v55
    v_cvt_f32_u32 v48, v48
    v_cvt_f32_u32 v49, v49
    v_cvt_f32_u32 v50, v50
    v_cvt_f32_u32 v51, v51
    v_cvt_f32_u32 v52, v52
    v_cvt_f32_u32 v53, v53
    v_cvt_f32_u32 v54, v54
    v_cvt_f32_u32 v55, v55
    v_mul_f32 v48, 0x3c000000, v48
    v_mul_f32 v49, 0x3c000000, v49
    v_mul_f32 v50, 0x3c000000, v50
    v_mul_f32 v51, 0x3c000000, v51
    v_mul_f32 v52, 0x3c000000, v52
    v_mul_f32 v53, 0x3c000000, v53
    v_mul_f32 v54, 0x3c000000, v54
    v_mul_f32 v55, 0x3c000000, v55
    v_cos_f32 v48, v48
    v_cos_f32 v49, v49
    v_cos_f32 v50, v50
    v_cos_f32 v51, v51
    v_cos_f32 v52, v52
    v_cos_f32 v53, v53
    v_cos_f32 v54, v54
    v_cos_f32 v55, v55
    s_nop 0
    v_mul_f32 v48, 0x3d000000, v48
    v_mul_f32 v49, 0x3d000000, v49
    v_mul_f32 v50, 0x3d000000, v50
    v_mul_f32 v51, 0x3d000000, v51
    v_mul_f32 v52, 0x3d000000, v52
    v_mul_f32 v53, 0x3d000000, v53
    v_mul_f32 v54, 0x3d000000, v54
    v_mul_f32 v55, 0x3d000000, v55
    v_cvt_pk_bf16_f32 v56, v48, v49
    v_cvt_pk_bf16_f32 v57, v50, v51
    v_cvt_pk_bf16_f32 v58, v52, v53
    v_cvt_pk_bf16_f32 v59, v54, v55
    v_lshlrev_b32 v64, 16, v56
    v_and_b32 v65, 0xffff0000, v56
    v_sub_f32 v48, v48, v64
    v_sub_f32 v49, v49, v65
    v_lshlrev_b32 v64, 16, v57
    v_and_b32 v65, 0xffff0000, v57
    v_sub_f32 v50, v50, v64
    v_sub_f32 v51, v51, v65
    v_lshlrev_b32 v64, 16, v58
    v_and_b32 v65, 0xffff0000, v58
    v_sub_f32 v52, v52, v64
    v_sub_f32 v53, v53, v65
    v_lshlrev_b32 v64, 16, v59
    v_and_b32 v65, 0xffff0000, v59
    v_sub_f32 v54, v54, v64
    v_sub_f32 v55, v55, v65
    v_cvt_pk_bf16_f32 v60, v48, v49
    v_cvt_pk_bf16_f32 v61, v50, v51
    v_cvt_pk_bf16_f32 v62, v52, v53
    v_cvt_pk_bf16_f32 v63, v54, v55
    s_lshl_b32 s30, s27, 11
    v_add_u32 v10, s30, v5
    ds_write_b128 v10, v[56:59]
    ds_write_b128 v10, v[60:63] offset:1024
K4_TABDONE:
    s_waitcnt lgkmcnt(0)
    s_barrier
    s_cmp_lt_u32 s3, s23
    s_cbranch_scc0 K4_END
    ds_read_b128 v[48:51], v5 offset:0
    ds_read_b128 v[52:55], v5 offset:1024
    ds_read_b128 v[56:59], v5 offset:2048
    ds_read_b128 v[60:63], v5 offset:3072
    ds_read_b128 v[64:67], v5 offset:4096
    ds_read_b128 v[68:71], v5 offset:5120
    ds_read_b128 v[72:75], v5 offset:6144
    ds_read_b128 v[76:79], v5 offset:7168
    ds_read_b128 v[80:83], v5 offset:8192
    ds_read_b128 v[84:87], v5 offset:9216
    ds_read_b128 v[88:91], v5 offset:10240
    ds_read_b128 v[92:95], v5 offset:11264
    v_lshlrev_b32 v7, 4, v3
    ds_read_b128 v[144:147], v7 offset:12288
    ds_read_b128 v[148:151], v7 offset:12544
    s_waitcnt vmcnt(0)
    v_swap_b32 v17, v20
    v_swap_b32 v18, v24
    v_swap_b32 v19, v28
    v_swap_b32 v22, v25
    v_swap_b32 v23, v29
    v_swap_b32 v27, v30
    v_swap_b32 v33, v36
    v_swap_b32 v34, v40
    v_swap_b32 v35, v44
    v_swap_b32 v38, v41
    v_swap_b32 v39, v45
    v_swap_b32 v43, v46
    s_waitcnt lgkmcnt(0)
    s_nop 1
    v_mfma_f32_16x16x32_bf16 v[96:99], v[48:51], v[16:19], 0
    v_mfma_f32_16x16x32_bf16 v[100:103], v[48:51], v[20:23], 0
    v_mfma_f32_16x16x32_bf16 v[104:107], v[48:51], v[24:27], 0
    v_mfma_f32_16x16x32_bf16 v[108:111], v[48:51], v[28:31], 0
    v_mfma_f32_16x16x32_bf16 v[96:99], v[52:55], v[16:19], v[96:99]
    v_mfma_f32_16x16x32_bf16 v[100:103], v[52:55], v[20:23], v[100:103]
    v_mfma_f32_16x16x32_bf16 v[104:107], v[52:55], v[24:27], v[104:107]
    v_mfma_f32_16x16x32_bf16 v[108:111], v[52:55], v[28:31], v[108:111]
    v_mfma_f32_16x16x32_bf16 v[96:99], v[56:59], v[32:35], v[96:99]
    v_mfma_f32_16x16x32_bf16 v[100:103], v[56:59], v[36:39], v[100:103]
    v_mfma_f32_16x16x32_bf16 v[104:107], v[56:59], v[40:43], v[104:107]
    v_mfma_f32_16x16x32_bf16 v[108:111], v[56:59], v[44:47], v[108:111]
    v_mfma_f32_16x16x32_bf16 v[96:99], v[60:63], v[32:35], v[96:99]
    v_mfma_f32_16x16x32_bf16 v[100:103], v[60:63], v[36:39], v[100:103]
    v_mfma_f32_16x16x32_bf16 v[104:107], v[60:63], v[40:43], v[104:107]
    v_mfma_f32_16x16x32_bf16 v[108:111], v[60:63], v[44:47], v[108:111]
    v_mfma_f32_16x16x32_bf16 v[112:115], v[64:67], v[16:19], 0
    v_mfma_f32_16x16x32_bf16 v[116:119], v[64:67], v[20:23], 0
    v_mfma_f32_16x16x32_bf16 v[120:123], v[64:67], v[24:27], 0
    v_mfma_f32_16x16x32_bf16 v[124:127], v[64:67], v[28:31], 0
    v_mfma_f32_16x16x32_bf16 v[112:115], v[68:71], v[16:19], v[112:115]
    v_mfma_f32_16x16x32_bf16 v[116:119], v[68:71], v[20:23], v[116:119]
    v_mfma_f32_16x16x32_bf16 v[120:123], v[68:71], v[24:27], v[120:123]
    v_mfma_f32_16x16x32_bf16 v[124:127], v[68:71], v[28:31], v[124:127]
    v_mfma_f32_16x16x32_bf16 v[112:115], v[72:75], v[32:35], v[112:115]
    v_mfma_f32_16x16x32_bf16 v[116:119], v[72:75], v[36:39], v[116:119]
    v_mfma_f32_16x16x32_bf16 v[120:123], v[72:75], v[40:43], v[120:123]
    v_mfma_f32_16x16x32_bf16 v[124:127], v[72:75], v[44:47], v[124:127]
    v_mfma_f32_16x16x32_bf16 v[112:115], v[76:79], v[32:35], v[112:115]
    v_mfma_f32_16x16x32_bf16 v[116:119], v[76:79], v[36:39], v[116:119]
    v_mfma_f32_16x16x32_bf16 v[120:123], v[76:79], v[40:43], v[120:123]
    v_mfma_f32_16x16x32_bf16 v[124:127], v[76:79], v[44:47], v[124:127]
    v_mfma_f32_16x16x32_bf16 v[128:131], v[80:83], v[16:19], 0
    v_mfma_f32_16x16x32_bf16 v[132:135], v[80:83], v[20:23], 0
    v_mfma_f32_16x16x32_bf16 v[136:139], v[80:83], v[24:27], 0
    v_mfma_f32_16x16x32_bf16 v[140:143], v[80:83], v[28:31], 0
    v_mfma_f32_16x16x32_bf16 v[128:131], v[84:87], v[16:19], v[128:131]
    v_mfma_f32_16x16x32_bf16 v[132:135], v[84:87], v[20:23], v[132:135]
    v_mfma_f32_16x16x32_bf16 v[136:139], v[84:87], v[24:27], v[136:139]
    v_mfma_f32_16x16x32_bf16 v[140:143], v[84:87], v[28:31], v[140:143]
    v_mfma_f32_16x16x32_bf16 v[128:131], v[88:91], v[32:35], v[128:131]
    v_mfma_f32_16x16x32_bf16 v[132:135], v[88:91], v[36:39], v[132:135]
    v_mfma_f32_16x16x32_bf16 v[136:139], v[88:91], v[40:43], v[136:139]
    v_mfma_f32_16x16x32_bf16 v[140:143], v[88:91], v[44:47], v[140:143]
    v_mfma_f32_16x16x32_bf16 v[128:131], v[92:95], v[32:35], v[128:131]
    v_mfma_f32_16x16x32_bf16 v[132:135], v[92:95], v[36:39], v[132:135]
    v_mfma_f32_16x16x32_bf16 v[136:139], v[92:95], v[40:43], v[136:139]
    v_mfma_f32_16x16x32_bf16 v[140:143], v[92:95], v[44:47], v[140:143]
    s_mul_i32 s24, s20, 8176640
    s_add_u32 s16, s44, s24
    s_addc_u32 s17, s45, 0
    s_and_b32 s17, s17, 0xffff
    s_mov_b32 s18, 8176640
    s_mov_b32 s19, 0x00020000
    v_lshlrev_b32 v7, 12, v4
    v_lshl_add_u32 v7, v3, 3, v7
    s_lshl_b32 s24, s21, 7
    v_add_u32 v7, s24, v7
    s_mul_i32 s25, s22, 49152
    s_mov_b32 s30, 0xc0135761
    s_mov_b32 s31, 0xbdd2d3e8
    v_mov_b32 v15, s30
    s_nop 3
    v_fma_f32 v16, v96, v144, v148
    v_fma_f32 v17, v100, v145, v149
    v_fma_f32 v18, v104, v146, v150
    v_fma_f32 v19, v108, v147, v151
    v_fma_f32 v20, v97, v144, v148
    v_fma_f32 v21, v101, v145, v149
    v_fma_f32 v22, v105, v146, v150
    v_fma_f32 v23, v109, v147, v151
    v_mul_f32 v24, v16, v16
    v_mul_f32 v25, v17, v17
    v_mul_f32 v26, v18, v18
    v_mul_f32 v27, v19, v19
    v_mul_f32 v28, v20, v20
    v_mul_f32 v29, v21, v21
    v_mul_f32 v30, v22, v22
    v_mul_f32 v31, v23, v23
    v_fma_f32 v24, v24, s31, v15
    v_fma_f32 v25, v25, s31, v15
    v_fma_f32 v26, v26, s31, v15
    v_fma_f32 v27, v27, s31, v15
    v_fma_f32 v28, v28, s31, v15
    v_fma_f32 v29, v29, s31, v15
    v_fma_f32 v30, v30, s31, v15
    v_fma_f32 v31, v31, s31, v15
    v_mul_f32 v24, v24, v16
    v_mul_f32 v25, v25, v17
    v_mul_f32 v26, v26, v18
    v_mul_f32 v27, v27, v19
    v_mul_f32 v28, v28, v20
    v_mul_f32 v29, v29, v21
    v_mul_f32 v30, v30, v22
    v_mul_f32 v31, v31, v23
    v_exp_f32 v24, v24
    v_exp_f32 v25, v25
    v_exp_f32 v26, v26
    v_exp_f32 v27, v27
    v_exp_f32 v28, v28
    v_exp_f32 v29, v29
    v_exp_f32 v30, v30
    v_exp_f32 v31, v31
    v_add_f32 v24, 1.0, v24
    v_add_f32 v25, 1.0, v25
    v_add_f32 v26, 1.0, v26
    v_add_f32 v27, 1.0, v27
    v_add_f32 v28, 1.0, v28
    v_add_f32 v29, 1.0, v29
    v_add_f32 v30, 1.0, v30
    v_add_f32 v31, 1.0, v31
    v_rcp_f32 v24, v24
    v_rcp_f32 v25, v25
    v_rcp_f32 v26, v26
    v_rcp_f32 v27, v27
    v_rcp_f32 v28, v28
    v_rcp_f32 v29, v29
    v_rcp_f32 v30, v30
    v_rcp_f32 v31, v31
    v_mul_f32 v16, v16, v24
    v_mul_f32 v17, v17, v25
    v_mul_f32 v18, v18, v26
    v_mul_f32 v19, v19, v27
    v_mul_f32 v20, v20, v28
    v_mul_f32 v21, v21, v29
    v_mul_f32 v22, v22, v30
    v_mul_f32 v23, v23, v31
    v_cvt_pk_bf16_f32 v32, v16, v17
    v_cvt_pk_bf16_f32 v33, v18, v19
    buffer_store_dwordx2 v[32:33], v7, s[16:19], s25 offen offset:0
    v_cvt_pk_bf16_f32 v34, v20, v21
    v_cvt_pk_bf16_f32 v35, v22, v23
    buffer_store_dwordx2 v[34:35], v7, s[16:19], s25 offen offset:1024
    s_add_u32 s25, s25, 2048
    v_fma_f32 v36, v98, v144, v148
    v_fma_f32 v37, v102, v145, v149
    v_fma_f32 v38, v106, v146, v150
    v_fma_f32 v39, v110, v147, v151
    v_fma_f32 v40, v99, v144, v148
    v_fma_f32 v41, v103, v145, v149
    v_fma_f32 v42, v107, v146, v150
    v_fma_f32 v43, v111, v147, v151
    v_mul_f32 v44, v36, v36
    v_mul_f32 v45, v37, v37
    v_mul_f32 v46, v38, v38
    v_mul_f32 v47, v39, v39
    v_mul_f32 v48, v40, v40
    v_mul_f32 v49, v41, v41
    v_mul_f32 v50, v42, v42
    v_mul_f32 v51, v43, v43
    v_fma_f32 v44, v44, s31, v15
    v_fma_f32 v45, v45, s31, v15
    v_fma_f32 v46, v46, s31, v15
    v_fma_f32 v47, v47, s31, v15
    v_fma_f32 v48, v48, s31, v15
    v_fma_f32 v49, v49, s31, v15
    v_fma_f32 v50, v50, s31, v15
    v_fma_f32 v51, v51, s31, v15
    v_mul_f32 v44, v44, v36
    v_mul_f32 v45, v45, v37
    v_mul_f32 v46, v46, v38
    v_mul_f32 v47, v47, v39
    v_mul_f32 v48, v48, v40
    v_mul_f32 v49, v49, v41
    v_mul_f32 v50, v50, v42
    v_mul_f32 v51, v51, v43
    v_exp_f32 v44, v44
    v_exp_f32 v45, v45
    v_exp_f32 v46, v46
    v_exp_f32 v47, v47
    v_exp_f32 v48, v48
    v_exp_f32 v49, v49
    v_exp_f32 v50, v50
    v_exp_f32 v51, v51
    v_add_f32 v44, 1.0, v44
    v_add_f32 v45, 1.0, v45
    v_add_f32 v46, 1.0, v46
    v_add_f32 v47, 1.0, v47
    v_add_f32 v48, 1.0, v48
    v_add_f32 v49, 1.0, v49
    v_add_f32 v50, 1.0, v50
    v_add_f32 v51, 1.0, v51
    v_rcp_f32 v44, v44
    v_rcp_f32 v45, v45
    v_rcp_f32 v46, v46
    v_rcp_f32 v47, v47
    v_rcp_f32 v48, v48
    v_rcp_f32 v49, v49
    v_rcp_f32 v50, v50
    v_rcp_f32 v51, v51
    v_mul_f32 v36, v36, v44
    v_mul_f32 v37, v37, v45
    v_mul_f32 v38, v38, v46
    v_mul_f32 v39, v39, v47
    v_mul_f32 v40, v40, v48
    v_mul_f32 v41, v41, v49
    v_mul_f32 v42, v42, v50
    v_mul_f32 v43, v43, v51
    v_cvt_pk_bf16_f32 v52, v36, v37
    v_cvt_pk_bf16_f32 v53, v38, v39
    buffer_store_dwordx2 v[52:53], v7, s[16:19], s25 offen offset:0
    v_cvt_pk_bf16_f32 v54, v40, v41
    v_cvt_pk_bf16_f32 v55, v42, v43
    buffer_store_dwordx2 v[54:55], v7, s[16:19], s25 offen offset:1024
    s_add_u32 s25, s25, 2048
    s_add_u32 s25, s25, 12288
    v_fma_f32 v16, v112, v144, v148
    v_fma_f32 v17, v116, v145, v149
    v_fma_f32 v18, v120, v146, v150
    v_fma_f32 v19, v124, v147, v151
    v_fma_f32 v20, v113, v144, v148
    v_fma_f32 v21, v117, v145, v149
    v_fma_f32 v22, v121, v146, v150
    v_fma_f32 v23, v125, v147, v151
    v_mul_f32 v24, v16, v16
    v_mul_f32 v25, v17, v17
    v_mul_f32 v26, v18, v18
    v_mul_f32 v27, v19, v19
    v_mul_f32 v28, v20, v20
    v_mul_f32 v29, v21, v21
    v_mul_f32 v30, v22, v22
    v_mul_f32 v31, v23, v23
    v_fma_f32 v24, v24, s31, v15
    v_fma_f32 v25, v25, s31, v15
    v_fma_f32 v26, v26, s31, v15
    v_fma_f32 v27, v27, s31, v15
    v_fma_f32 v28, v28, s31, v15
    v_fma_f32 v29, v29, s31, v15
    v_fma_f32 v30, v30, s31, v15
    v_fma_f32 v31, v31, s31, v15
    v_mul_f32 v24, v24, v16
    v_mul_f32 v25, v25, v17
    v_mul_f32 v26, v26, v18
    v_mul_f32 v27, v27, v19
    v_mul_f32 v28, v28, v20
    v_mul_f32 v29, v29, v21
    v_mul_f32 v30, v30, v22
    v_mul_f32 v31, v31, v23
    v_exp_f32 v24, v24
    v_exp_f32 v25, v25
    v_exp_f32 v26, v26
    v_exp_f32 v27, v27
    v_exp_f32 v28, v28
    v_exp_f32 v29, v29
    v_exp_f32 v30, v30
    v_exp_f32 v31, v31
    v_add_f32 v24, 1.0, v24
    v_add_f32 v25, 1.0, v25
    v_add_f32 v26, 1.0, v26
    v_add_f32 v27, 1.0, v27
    v_add_f32 v28, 1.0, v28
    v_add_f32 v29, 1.0, v29
    v_add_f32 v30, 1.0, v30
    v_add_f32 v31, 1.0, v31
    v_rcp_f32 v24, v24
    v_rcp_f32 v25, v25
    v_rcp_f32 v26, v26
    v_rcp_f32 v27, v27
    v_rcp_f32 v28, v28
    v_rcp_f32 v29, v29
    v_rcp_f32 v30, v30
    v_rcp_f32 v31, v31
    v_mul_f32 v16, v16, v24
    v_mul_f32 v17, v17, v25
    v_mul_f32 v18, v18, v26
    v_mul_f32 v19, v19, v27
    v_mul_f32 v20, v20, v28
    v_mul_f32 v21, v21, v29
    v_mul_f32 v22, v22, v30
    v_mul_f32 v23, v23, v31
    v_cvt_pk_bf16_f32 v32, v16, v17
    v_cvt_pk_bf16_f32 v33, v18, v19
    buffer_store_dwordx2 v[32:33], v7, s[16:19], s25 offen offset:0
    v_cvt_pk_bf16_f32 v34, v20, v21
    v_cvt_pk_bf16_f32 v35, v22, v23
    buffer_store_dwordx2 v[34:35], v7, s[16:19], s25 offen offset:1024
    s_add_u32 s25, s25, 2048
    v_fma_f32 v36, v114, v144, v148
    v_fma_f32 v37, v118, v145, v149
    v_fma_f32 v38, v122, v146, v150
    v_fma_f32 v39, v126, v147, v151
    v_fma_f32 v40, v115, v144, v148
    v_fma_f32 v41, v119, v145, v149
    v_fma_f32 v42, v123, v146, v150
    v_fma_f32 v43, v127, v147, v151
    v_mul_f32 v44, v36, v36
    v_mul_f32 v45, v37, v37
    v_mul_f32 v46, v38, v38
    v_mul_f32 v47, v39, v39
    v_mul_f32 v48, v40, v40
    v_mul_f32 v49, v41, v41
    v_mul_f32 v50, v42, v42
    v_mul_f32 v51, v43, v43
    v_fma_f32 v44, v44, s31, v15
    v_fma_f32 v45, v45, s31, v15
    v_fma_f32 v46, v46, s31, v15
    v_fma_f32 v47, v47, s31, v15
    v_fma_f32 v48, v48, s31, v15
    v_fma_f32 v49, v49, s31, v15
    v_fma_f32 v50, v50, s31, v15
    v_fma_f32 v51, v51, s31, v15
    v_mul_f32 v44, v44, v36
    v_mul_f32 v45, v45, v37
    v_mul_f32 v46, v46, v38
    v_mul_f32 v47, v47, v39
    v_mul_f32 v48, v48, v40
    v_mul_f32 v49, v49, v41
    v_mul_f32 v50, v50, v42
    v_mul_f32 v51, v51, v43
    v_exp_f32 v44, v44
    v_exp_f32 v45, v45
    v_exp_f32 v46, v46
    v_exp_f32 v47, v47
    v_exp_f32 v48, v48
    v_exp_f32 v49, v49
    v_exp_f32 v50, v50
    v_exp_f32 v51, v51
    v_add_f32 v44, 1.0, v44
    v_add_f32 v45, 1.0, v45
    v_add_f32 v46, 1.0, v46
    v_add_f32 v47, 1.0, v47
    v_add_f32 v48, 1.0, v48
    v_add_f32 v49, 1.0, v49
    v_add_f32 v50, 1.0, v50
    v_add_f32 v51, 1.0, v51
    v_rcp_f32 v44, v44
    v_rcp_f32 v45, v45
    v_rcp_f32 v46, v46
    v_rcp_f32 v47, v47
    v_rcp_f32 v48, v48
    v_rcp_f32 v49, v49
    v_rcp_f32 v50, v50
    v_rcp_f32 v51, v51
    v_mul_f32 v36, v36, v44
    v_mul_f32 v37, v37, v45
    v_mul_f32 v38, v38, v46
    v_mul_f32 v39, v39, v47
    v_mul_f32 v40, v40, v48
    v_mul_f32 v41, v41, v49
    v_mul_f32 v42, v42, v50
    v_mul_f32 v43, v43, v51
    v_cvt_pk_bf16_f32 v52, v36, v37
    v_cvt_pk_bf16_f32 v53, v38, v39
    buffer_store_dwordx2 v[52:53], v7, s[16:19], s25 offen offset:0
    v_cvt_pk_bf16_f32 v54, v40, v41
    v_cvt_pk_bf16_f32 v55, v42, v43
    buffer_store_dwordx2 v[54:55], v7, s[16:19], s25 offen offset:1024
    s_add_u32 s25, s25, 2048
    s_add_u32 s25, s25, 12288
    v_fma_f32 v16, v128, v144, v148
    v_fma_f32 v17, v132, v145, v149
    v_fma_f32 v18, v136, v146, v150
    v_fma_f32 v19, v140, v147, v151
    v_fma_f32 v20, v129, v144, v148
    v_fma_f32 v21, v133, v145, v149
    v_fma_f32 v22, v137, v146, v150
    v_fma_f32 v23, v141, v147, v151
    v_mul_f32 v24, v16, v16
    v_mul_f32 v25, v17, v17
    v_mul_f32 v26, v18, v18
    v_mul_f32 v27, v19, v19
    v_mul_f32 v28, v20, v20
    v_mul_f32 v29, v21, v21
    v_mul_f32 v30, v22, v22
    v_mul_f32 v31, v23, v23
    v_fma_f32 v24, v24, s31, v15
    v_fma_f32 v25, v25, s31, v15
    v_fma_f32 v26, v26, s31, v15
    v_fma_f32 v27, v27, s31, v15
    v_fma_f32 v28, v28, s31, v15
    v_fma_f32 v29, v29, s31, v15
    v_fma_f32 v30, v30, s31, v15
    v_fma_f32 v31, v31, s31, v15
    v_mul_f32 v24, v24, v16
    v_mul_f32 v25, v25, v17
    v_mul_f32 v26, v26, v18
    v_mul_f32 v27, v27, v19
    v_mul_f32 v28, v28, v20
    v_mul_f32 v29, v29, v21
    v_mul_f32 v30, v30, v22
    v_mul_f32 v31, v31, v23
    v_exp_f32 v24, v24
    v_exp_f32 v25, v25
    v_exp_f32 v26, v26
    v_exp_f32 v27, v27
    v_exp_f32 v28, v28
    v_exp_f32 v29, v29
    v_exp_f32 v30, v30
    v_exp_f32 v31, v31
    v_add_f32 v24, 1.0, v24
    v_add_f32 v25, 1.0, v25
    v_add_f32 v26, 1.0, v26
    v_add_f32 v27, 1.0, v27
    v_add_f32 v28, 1.0, v28
    v_add_f32 v29, 1.0, v29
    v_add_f32 v30, 1.0, v30
    v_add_f32 v31, 1.0, v31
    v_rcp_f32 v24, v24
    v_rcp_f32 v25, v25
    v_rcp_f32 v26, v26
    v_rcp_f32 v27, v27
    v_rcp_f32 v28, v28
    v_rcp_f32 v29, v29
    v_rcp_f32 v30, v30
    v_rcp_f32 v31, v31
    v_mul_f32 v16, v16, v24
    v_mul_f32 v17, v17, v25
    v_mul_f32 v18, v18, v26
    v_mul_f32 v19, v19, v27
    v_mul_f32 v20, v20, v28
    v_mul_f32 v21, v21, v29
    v_mul_f32 v22, v22, v30
    v_mul_f32 v23, v23, v31
    v_cvt_pk_bf16_f32 v32, v16, v17
    v_cvt_pk_bf16_f32 v33, v18, v19
    buffer_store_dwordx2 v[32:33], v7, s[16:19], s25 offen offset:0
    v_cvt_pk_bf16_f32 v34, v20, v21
    v_cvt_pk_bf16_f32 v35, v22, v23
    buffer_store_dwordx2 v[34:35], v7, s[16:19], s25 offen offset:1024
    s_add_u32 s25, s25, 2048
    v_fma_f32 v36, v130, v144, v148
    v_fma_f32 v37, v134, v145, v149
    v_fma_f32 v38, v138, v146, v150
    v_fma_f32 v39, v142, v147, v151
    v_fma_f32 v40, v131, v144, v148
    v_fma_f32 v41, v135, v145, v149
    v_fma_f32 v42, v139, v146, v150
    v_fma_f32 v43, v143, v147, v151
    v_mul_f32 v44, v36, v36
    v_mul_f32 v45, v37, v37
    v_mul_f32 v46, v38, v38
    v_mul_f32 v47, v39, v39
    v_mul_f32 v48, v40, v40
    v_mul_f32 v49, v41, v41
    v_mul_f32 v50, v42, v42
    v_mul_f32 v51, v43, v43
    v_fma_f32 v44, v44, s31, v15
    v_fma_f32 v45, v45, s31, v15
    v_fma_f32 v46, v46, s31, v15
    v_fma_f32 v47, v47, s31, v15
    v_fma_f32 v48, v48, s31, v15
    v_fma_f32 v49, v49, s31, v15
    v_fma_f32 v50, v50, s31, v15
    v_fma_f32 v51, v51, s31, v15
    v_mul_f32 v44, v44, v36
    v_mul_f32 v45, v45, v37
    v_mul_f32 v46, v46, v38
    v_mul_f32 v47, v47, v39
    v_mul_f32 v48, v48, v40
    v_mul_f32 v49, v49, v41
    v_mul_f32 v50, v50, v42
    v_mul_f32 v51, v51, v43
    v_exp_f32 v44, v44
    v_exp_f32 v45, v45
    v_exp_f32 v46, v46
    v_exp_f32 v47, v47
    v_exp_f32 v48, v48
    v_exp_f32 v49, v49
    v_exp_f32 v50, v50
    v_exp_f32 v51, v51
    v_add_f32 v44, 1.0, v44
    v_add_f32 v45, 1.0, v45
    v_add_f32 v46, 1.0, v46
    v_add_f32 v47, 1.0, v47
    v_add_f32 v48, 1.0, v48
    v_add_f32 v49, 1.0, v49
    v_add_f32 v50, 1.0, v50
    v_add_f32 v51, 1.0, v51
    v_rcp_f32 v44, v44
    v_rcp_f32 v45, v45
    v_rcp_f32 v46, v46
    v_rcp_f32 v47, v47
    v_rcp_f32 v48, v48
    v_rcp_f32 v49, v49
    v_rcp_f32 v50, v50
    v_rcp_f32 v51, v51
    v_mul_f32 v36, v36, v44
    v_mul_f32 v37, v37, v45
    v_mul_f32 v38, v38, v46
    v_mul_f32 v39, v39, v47
    v_mul_f32 v40, v40, v48
    v_mul_f32 v41, v41, v49
    v_mul_f32 v42, v42, v50
    v_mul_f32 v43, v43, v51
    v_cvt_pk_bf16_f32 v52, v36, v37
    v_cvt_pk_bf16_f32 v53, v38, v39
    buffer_store_dwordx2 v[52:53], v7, s[16:19], s25 offen offset:0
    v_cvt_pk_bf16_f32 v54, v40, v41
    v_cvt_pk_bf16_f32 v55, v42, v43
    buffer_store_dwordx2 v[54:55], v7, s[16:19], s25 offen offset:1024
    s_add_u32 s25, s25, 2048
    s_add_u32 s25, s25, 12288
K4_END:
    s_endpgm
.section .rodata,"a"
.p2align 6
.amdhsa_kernel k1_xform_kernel
  .amdhsa_next_free_vgpr 128
  .amdhsa_next_free_sgpr 96
  .amdhsa_accum_offset 128
  .amdhsa_group_segment_fixed_size 0
  .amdhsa_kernarg_size 56
  .amdhsa_user_sgpr_count 2
  .amdhsa_user_sgpr_kernarg_segment_ptr 1
  .amdhsa_system_sgpr_workgroup_id_x 1
.end_amdhsa_kernel
.p2align 6
.amdhsa_kernel k2_gemm_kernel
  .amdhsa_next_free_vgpr 256
  .amdhsa_next_free_sgpr 96
  .amdhsa_accum_offset 256
  .amdhsa_group_segment_fixed_size 0
  .amdhsa_kernarg_size 56
  .amdhsa_user_sgpr_count 2
  .amdhsa_user_sgpr_kernarg_segment_ptr 1
  .amdhsa_system_sgpr_workgroup_id_x 1
.end_amdhsa_kernel
.p2align 6
.amdhsa_kernel k3_stats_kernel
  .amdhsa_next_free_vgpr 168
  .amdhsa_next_free_sgpr 96
  .amdhsa_accum_offset 168
  .amdhsa_group_segment_fixed_size 0
  .amdhsa_kernarg_size 56
  .amdhsa_user_sgpr_count 2
  .amdhsa_user_sgpr_kernarg_segment_ptr 1
  .amdhsa_system_sgpr_workgroup_id_x 1
.end_amdhsa_kernel
.p2align 6
.amdhsa_kernel k4_out_kernel
  .amdhsa_next_free_vgpr 168
  .amdhsa_next_free_sgpr 96
  .amdhsa_accum_offset 168
  .amdhsa_group_segment_fixed_size 0
  .amdhsa_kernarg_size 56
  .amdhsa_user_sgpr_count 2
  .amdhsa_user_sgpr_kernarg_segment_ptr 1
  .amdhsa_system_sgpr_workgroup_id_x 1
.end_amdhsa_kernel
```

```asm
; @launch kernel=k1_xform_kernel grid=(636,1,1) block=(256,1,1) lds=16384
; @launch kernel=k12_fused_kernel grid=(256,1,1) block=(512,1,1) lds=155840
; @launch kernel=k3_stats_kernel grid=(256,1,1) block=(768,1,1) lds=18432
; @launch kernel=k4_out_kernel grid=(256,1,1) block=(768,1,1) lds=12800
.amdgcn_target "amdgcn-amd-amdhsa--gfx950"
.text
.globl k1_xform_kernel
.globl k12_fused_kernel
.globl k3_stats_kernel
.globl k4_out_kernel
.p2align 8
.type k1_xform_kernel,@function
k1_xform_kernel:
    s_cmp_ge_u32 s2, 636
    s_cbranch_scc1 K1_END
    s_load_dwordx4 s[4:7], s[0:1], 0
    s_load_dwordx2 s[8:9], s[0:1], 48
    v_lshrrev_b32 v120, 6, v0
    v_and_b32 v121, 63, v0
    v_readfirstlane_b32 s3, v120
    v_and_b32 v122, 15, v121
    v_lshrrev_b32 v123, 4, v121
    s_mov_b32 s28, 0x05040100
    s_mov_b32 s29, 0x07060302
    v_and_b32 v124, 3, v122
    v_lshlrev_b32 v124, 2, v124
    v_lshrrev_b32 v125, 3, v122
    v_lshl_add_u32 v124, v125, 1, v124
    s_lshl_b32 s10, s3, 4
    s_add_u32 s10, s10, 1
    v_add_u32 v124, s10, v124
    v_bfe_u32 v125, v122, 2, 1
    v_lshlrev_b32 v121, 4, v121
    s_waitcnt lgkmcnt(0)
    s_add_u32 s10, s2, 384
    s_sub_u32 s11, s2, 252
    s_cmp_lt_u32 s2, 252
    s_cselect_b32 s2, s10, s11
    s_cmp_lt_u32 s2, 384
    s_cbranch_scc1 K1_W
    s_sub_u32 s11, s2, 384
    s_mul_hi_u32 s13, s11, 1431655766
    s_mul_i32 s12, s13, 3
    s_sub_u32 s12, s11, s12
    s_mov_b32 s11, s13
    s_cmp_ge_u32 s11, 42
    s_cselect_b32 s13, 1, 0
    s_mul_i32 s14, s13, 42
    s_sub_u32 s11, s11, s14
    s_lshl_b32 s11, s11, 2
    s_add_u32 s11, s11, s3
    s_mul_i32 s14, s13, 16384000
    s_add_u32 s16, s4, s14
    s_addc_u32 s17, s5, 0
    s_and_b32 s17, s17, 0xffff
    s_mov_b32 s18, 16384000
    s_mov_b32 s19, 0x00020000
    s_mov_b32 s20, s8
    s_mov_b32 s21, s9
    s_and_b32 s21, s21, 0xffff
    s_mov_b32 s22, 43778048
    s_mov_b32 s23, 0x00020000
    v_lshlrev_b32 v126, 14, v123
    v_lshl_add_u32 v126, v122, 4, v126
    s_mul_i32 s15, s11, 98304
    s_lshl_b32 s24, s12, 8
    s_add_u32 s15, s15, s24
    buffer_load_dwordx4 v[0:3], v126, s[16:19], s15 offen
    buffer_load_dwordx4 v[4:7], v126, s[16:19], s15 offen offset:2048
    s_add_u32 s15, s15, 4096
    buffer_load_dwordx4 v[8:11], v126, s[16:19], s15 offen
    buffer_load_dwordx4 v[12:15], v126, s[16:19], s15 offen offset:2048
    s_add_u32 s15, s15, 4096
    buffer_load_dwordx4 v[16:19], v126, s[16:19], s15 offen
    buffer_load_dwordx4 v[20:23], v126, s[16:19], s15 offen offset:2048
    s_add_u32 s15, s15, 4096
    buffer_load_dwordx4 v[24:27], v126, s[16:19], s15 offen
    buffer_load_dwordx4 v[28:31], v126, s[16:19], s15 offen offset:2048
    s_add_u32 s15, s15, 53248
    buffer_load_dwordx4 v[32:35], v126, s[16:19], s15 offen
    buffer_load_dwordx4 v[36:39], v126, s[16:19], s15 offen offset:2048
    s_add_u32 s15, s15, 4096
    buffer_load_dwordx4 v[40:43], v126, s[16:19], s15 offen
    buffer_load_dwordx4 v[44:47], v126, s[16:19], s15 offen offset:2048
    s_add_u32 s15, s15, 4096
    buffer_load_dwordx4 v[48:51], v126, s[16:19], s15 offen
    buffer_load_dwordx4 v[52:55], v126, s[16:19], s15 offen offset:2048
    s_add_u32 s15, s15, 4096
    buffer_load_dwordx4 v[56:59], v126, s[16:19], s15 offen
    buffer_load_dwordx4 v[60:63], v126, s[16:19], s15 offen offset:2048
    v_lshlrev_b32 v127, 3, v123
    v_lshlrev_b32 v112, 5, v125
    v_mad_u32_u24 v113, v124, v127, v112
    v_mad_u32_u24 v64, v124, 0, v113
    v_mad_u32_u24 v65, v124, 1, v113
    v_mad_u32_u24 v66, v124, 2, v113
    v_mad_u32_u24 v67, v124, 3, v113
    v_mad_u32_u24 v68, v124, 4, v113
    v_mad_u32_u24 v69, v124, 5, v113
    v_mad_u32_u24 v70, v124, 6, v113
    v_mad_u32_u24 v71, v124, 7, v113
    v_and_b32 v64, 127, v64
    v_and_b32 v65, 127, v65
    v_and_b32 v66, 127, v66
    v_and_b32 v67, 127, v67
    v_and_b32 v68, 127, v68
    v_and_b32 v69, 127, v69
    v_and_b32 v70, 127, v70
    v_and_b32 v71, 127, v71
    v_cvt_f32_u32 v64, v64
    v_cvt_f32_u32 v65, v65
    v_cvt_f32_u32 v66, v66
    v_cvt_f32_u32 v67, v67
    v_cvt_f32_u32 v68, v68
    v_cvt_f32_u32 v69, v69
    v_cvt_f32_u32 v70, v70
    v_cvt_f32_u32 v71, v71
    v_mul_f32 v64, 0x3c000000, v64
    v_mul_f32 v65, 0x3c000000, v65
    v_mul_f32 v66, 0x3c000000, v66
    v_mul_f32 v67, 0x3c000000, v67
    v_mul_f32 v68, 0x3c000000, v68
    v_mul_f32 v69, 0x3c000000, v69
    v_mul_f32 v70, 0x3c000000, v70
    v_mul_f32 v71, 0x3c000000, v71
    v_cos_f32 v64, v64
    v_cos_f32 v65, v65
    v_cos_f32 v66, v66
    v_cos_f32 v67, v67
    v_cos_f32 v68, v68
    v_cos_f32 v69, v69
    v_cos_f32 v70, v70
    v_cos_f32 v71, v71
    s_nop 0
    v_cvt_pk_bf16_f32 v72, v64, v65
    v_cvt_pk_bf16_f32 v73, v66, v67
    v_cvt_pk_bf16_f32 v74, v68, v69
    v_cvt_pk_bf16_f32 v75, v70, v71
    v_lshlrev_b32 v80, 16, v72
    v_and_b32 v81, 0xffff0000, v72
    v_sub_f32 v64, v64, v80
    v_sub_f32 v65, v65, v81
    v_lshlrev_b32 v80, 16, v73
    v_and_b32 v81, 0xffff0000, v73
    v_sub_f32 v66, v66, v80
    v_sub_f32 v67, v67, v81
    v_lshlrev_b32 v80, 16, v74
    v_and_b32 v81, 0xffff0000, v74
    v_sub_f32 v68, v68, v80
    v_sub_f32 v69, v69, v81
    v_lshlrev_b32 v80, 16, v75
    v_and_b32 v81, 0xffff0000, v75
    v_sub_f32 v70, v70, v80
    v_sub_f32 v71, v71, v81
    v_cvt_pk_bf16_f32 v76, v64, v65
    v_cvt_pk_bf16_f32 v77, v66, v67
    v_cvt_pk_bf16_f32 v78, v68, v69
    v_cvt_pk_bf16_f32 v79, v70, v71
    s_lshl_b32 s24, s3, 12
    v_add_u32 v114, s24, v121
    ds_write_b128 v114, v[72:75] offset:0
    ds_write_b128 v114, v[76:79] offset:1024
    v_add_u32 v127, 32, v127
    v_lshlrev_b32 v112, 5, v125
    v_mad_u32_u24 v113, v124, v127, v112
    v_mad_u32_u24 v64, v124, 0, v113
    v_mad_u32_u24 v65, v124, 1, v113
    v_mad_u32_u24 v66, v124, 2, v113
    v_mad_u32_u24 v67, v124, 3, v113
    v_mad_u32_u24 v68, v124, 4, v113
    v_mad_u32_u24 v69, v124, 5, v113
    v_mad_u32_u24 v70, v124, 6, v113
    v_mad_u32_u24 v71, v124, 7, v113
    v_and_b32 v64, 127, v64
    v_and_b32 v65, 127, v65
    v_and_b32 v66, 127, v66
    v_and_b32 v67, 127, v67
    v_and_b32 v68, 127, v68
    v_and_b32 v69, 127, v69
    v_and_b32 v70, 127, v70
    v_and_b32 v71, 127, v71
    v_cvt_f32_u32 v64, v64
    v_cvt_f32_u32 v65, v65
    v_cvt_f32_u32 v66, v66
    v_cvt_f32_u32 v67, v67
    v_cvt_f32_u32 v68, v68
    v_cvt_f32_u32 v69, v69
    v_cvt_f32_u32 v70, v70
    v_cvt_f32_u32 v71, v71
    v_mul_f32 v64, 0x3c000000, v64
    v_mul_f32 v65, 0x3c000000, v65
    v_mul_f32 v66, 0x3c000000, v66
    v_mul_f32 v67, 0x3c000000, v67
    v_mul_f32 v68, 0x3c000000, v68
    v_mul_f32 v69, 0x3c000000, v69
    v_mul_f32 v70, 0x3c000000, v70
    v_mul_f32 v71, 0x3c000000, v71
    v_cos_f32 v64, v64
    v_cos_f32 v65, v65
    v_cos_f32 v66, v66
    v_cos_f32 v67, v67
    v_cos_f32 v68, v68
    v_cos_f32 v69, v69
    v_cos_f32 v70, v70
    v_cos_f32 v71, v71
    s_nop 0
    v_cvt_pk_bf16_f32 v72, v64, v65
    v_cvt_pk_bf16_f32 v73, v66, v67
    v_cvt_pk_bf16_f32 v74, v68, v69
    v_cvt_pk_bf16_f32 v75, v70, v71
    v_lshlrev_b32 v80, 16, v72
    v_and_b32 v81, 0xffff0000, v72
    v_sub_f32 v64, v64, v80
    v_sub_f32 v65, v65, v81
    v_lshlrev_b32 v80, 16, v73
    v_and_b32 v81, 0xffff0000, v73
    v_sub_f32 v66, v66, v80
    v_sub_f32 v67, v67, v81
    v_lshlrev_b32 v80, 16, v74
    v_and_b32 v81, 0xffff0000, v74
    v_sub_f32 v68, v68, v80
    v_sub_f32 v69, v69, v81
    v_lshlrev_b32 v80, 16, v75
    v_and_b32 v81, 0xffff0000, v75
    v_sub_f32 v70, v70, v80
    v_sub_f32 v71, v71, v81
    v_cvt_pk_bf16_f32 v76, v64, v65
    v_cvt_pk_bf16_f32 v77, v66, v67
    v_cvt_pk_bf16_f32 v78, v68, v69
    v_cvt_pk_bf16_f32 v79, v70, v71
    s_lshl_b32 s24, s3, 12
    v_add_u32 v114, s24, v121
    ds_write_b128 v114, v[72:75] offset:2048
    ds_write_b128 v114, v[76:79] offset:3072
    v_lshrrev_b32 v112, 1, v123
    s_mov_b32 s24, 1368064
    v_mul_lo_u32 v112, v112, s24
    v_lshrrev_b32 v113, 2, v122
    s_mov_b32 s24, 21376
    v_mul_lo_u32 v113, v113, s24
    v_add_u32 v112, v112, v113
    v_and_b32 v113, 3, v122
    v_and_b32 v114, 1, v123
    v_lshl_add_u32 v113, v114, 2, v113
    s_lshr_b32 s24, s11, 1
    s_and_b32 s24, s24, 7
    v_xor_b32 v113, s24, v113
    v_lshl_add_u32 v120, v113, 4, v112
    s_mul_i32 s25, s13, 684032
    s_mul_i32 s24, s12, 85504
    s_add_u32 s25, s25, s24
    s_lshl_b32 s24, s11, 7
    s_add_u32 s25, s25, s24
    s_waitcnt lgkmcnt(0)
    s_barrier
    s_cmp_ge_u32 s11, 167
    s_cbranch_scc1 K1_END
    s_waitcnt vmcnt(8)
    v_perm_b32 v64, v4, v0, s28
    v_perm_b32 v68, v4, v0, s29
    v_perm_b32 v65, v12, v8, s28
    v_perm_b32 v69, v12, v8, s29
    v_perm_b32 v66, v20, v16, s28
    v_perm_b32 v70, v20, v16, s29
    v_perm_b32 v67, v28, v24, s28
    v_perm_b32 v71, v28, v24, s29
    v_perm_b32 v72, v5, v1, s28
    v_perm_b32 v76, v5, v1, s29
    v_perm_b32 v73, v13, v9, s28
    v_perm_b32 v77, v13, v9, s29
    v_perm_b32 v74, v21, v17, s28
    v_perm_b32 v78, v21, v17, s29
    v_perm_b32 v75, v29, v25, s28
    v_perm_b32 v79, v29, v25, s29
    v_perm_b32 v80, v6, v2, s28
    v_perm_b32 v84, v6, v2, s29
    v_perm_b32 v81, v14, v10, s28
    v_perm_b32 v85, v14, v10, s29
    v_perm_b32 v82, v22, v18, s28
    v_perm_b32 v86, v22, v18, s29
    v_perm_b32 v83, v30, v26, s28
    v_perm_b32 v87, v30, v26, s29
    v_perm_b32 v88, v7, v3, s28
    v_perm_b32 v92, v7, v3, s29
    v_perm_b32 v89, v15, v11, s28
    v_perm_b32 v93, v15, v11, s29
    v_perm_b32 v90, v23, v19, s28
    v_perm_b32 v94, v23, v19, s29
    v_perm_b32 v91, v31, v27, s28
    v_perm_b32 v95, v31, v27, s29
    s_waitcnt vmcnt(0)
    v_perm_b32 v0, v36, v32, s28
    v_perm_b32 v4, v36, v32, s29
    v_perm_b32 v1, v44, v40, s28
    v_perm_b32 v5, v44, v40, s29
    v_perm_b32 v2, v52, v48, s28
    v_perm_b32 v6, v52, v48, s29
    v_perm_b32 v3, v60, v56, s28
    v_perm_b32 v7, v60, v56, s29
    v_perm_b32 v8, v37, v33, s28
    v_perm_b32 v12, v37, v33, s29
    v_perm_b32 v9, v45, v41, s28
    v_perm_b32 v13, v45, v41, s29
    v_perm_b32 v10, v53, v49, s28
    v_perm_b32 v14, v53, v49, s29
    v_perm_b32 v11, v61, v57, s28
    v_perm_b32 v15, v61, v57, s29
    v_perm_b32 v16, v38, v34, s28
    v_perm_b32 v20, v38, v34, s29
    v_perm_b32 v17, v46, v42, s28
    v_perm_b32 v21, v46, v42, s29
    v_perm_b32 v18, v54, v50, s28
    v_perm_b32 v22, v54, v50, s29
    v_perm_b32 v19, v62, v58, s28
    v_perm_b32 v23, v62, v58, s29
    v_perm_b32 v24, v39, v35, s28
    v_perm_b32 v28, v39, v35, s29
    v_perm_b32 v25, v47, v43, s28
    v_perm_b32 v29, v47, v43, s29
    v_perm_b32 v26, v55, v51, s28
    v_perm_b32 v30, v55, v51, s29
    v_perm_b32 v27, v63, v59, s28
    v_perm_b32 v31, v63, v59, s29
    ds_read_b128 v[96:99], v121 offset:0
    ds_read_b128 v[100:103], v121 offset:1024
    ds_read_b128 v[104:107], v121 offset:2048
    ds_read_b128 v[108:111], v121 offset:3072
    s_waitcnt lgkmcnt(3)
    v_mfma_f32_16x16x32_bf16 v[32:35], v[96:99], v[64:67], 0
    v_mfma_f32_16x16x32_bf16 v[36:39], v[96:99], v[68:71], 0
    v_mfma_f32_16x16x32_bf16 v[40:43], v[96:99], v[72:75], 0
    v_mfma_f32_16x16x32_bf16 v[44:47], v[96:99], v[76:79], 0
    v_mfma_f32_16x16x32_bf16 v[48:51], v[96:99], v[80:83], 0
    v_mfma_f32_16x16x32_bf16 v[52:55], v[96:99], v[84:87], 0
    v_mfma_f32_16x16x32_bf16 v[56:59], v[96:99], v[88:91], 0
    v_mfma_f32_16x16x32_bf16 v[60:63], v[96:99], v[92:95], 0
    s_waitcnt lgkmcnt(2)
    v_mfma_f32_16x16x32_bf16 v[32:35], v[100:103], v[64:67], v[32:35]
    v_mfma_f32_16x16x32_bf16 v[36:39], v[100:103], v[68:71], v[36:39]
    v_mfma_f32_16x16x32_bf16 v[40:43], v[100:103], v[72:75], v[40:43]
    v_mfma_f32_16x16x32_bf16 v[44:47], v[100:103], v[76:79], v[44:47]
    v_mfma_f32_16x16x32_bf16 v[48:51], v[100:103], v[80:83], v[48:51]
    v_mfma_f32_16x16x32_bf16 v[52:55], v[100:103], v[84:87], v[52:55]
    v_mfma_f32_16x16x32_bf16 v[56:59], v[100:103], v[88:91], v[56:59]
    v_mfma_f32_16x16x32_bf16 v[60:63], v[100:103], v[92:95], v[60:63]
    s_waitcnt lgkmcnt(1)
    v_mfma_f32_16x16x32_bf16 v[32:35], v[104:107], v[0:3], v[32:35]
    v_mfma_f32_16x16x32_bf16 v[36:39], v[104:107], v[4:7], v[36:39]
    v_mfma_f32_16x16x32_bf16 v[40:43], v[104:107], v[8:11], v[40:43]
    v_mfma_f32_16x16x32_bf16 v[44:47], v[104:107], v[12:15], v[44:47]
    v_mfma_f32_16x16x32_bf16 v[48:51], v[104:107], v[16:19], v[48:51]
    v_mfma_f32_16x16x32_bf16 v[52:55], v[104:107], v[20:23], v[52:55]
    v_mfma_f32_16x16x32_bf16 v[56:59], v[104:107], v[24:27], v[56:59]
    v_mfma_f32_16x16x32_bf16 v[60:63], v[104:107], v[28:31], v[60:63]
    s_waitcnt lgkmcnt(0)
    v_mfma_f32_16x16x32_bf16 v[32:35], v[108:111], v[0:3], v[32:35]
    v_mfma_f32_16x16x32_bf16 v[36:39], v[108:111], v[4:7], v[36:39]
    v_mfma_f32_16x16x32_bf16 v[40:43], v[108:111], v[8:11], v[40:43]
    v_mfma_f32_16x16x32_bf16 v[44:47], v[108:111], v[12:15], v[44:47]
    v_mfma_f32_16x16x32_bf16 v[48:51], v[108:111], v[16:19], v[48:51]
    v_mfma_f32_16x16x32_bf16 v[52:55], v[108:111], v[20:23], v[52:55]
    v_mfma_f32_16x16x32_bf16 v[56:59], v[108:111], v[24:27], v[56:59]
    v_mfma_f32_16x16x32_bf16 v[60:63], v[108:111], v[28:31], v[60:63]
    s_nop 7
    v_cvt_pk_bf16_f32 v112, v32, v36
    v_cvt_pk_bf16_f32 v113, v40, v44
    v_cvt_pk_bf16_f32 v114, v48, v52
    v_cvt_pk_bf16_f32 v115, v56, v60
    buffer_store_dwordx4 v[112:115], v120, s[20:23], s25 offen
    s_add_u32 s25, s25, 2736128
    v_cvt_pk_bf16_f32 v116, v33, v37
    v_cvt_pk_bf16_f32 v117, v41, v45
    v_cvt_pk_bf16_f32 v118, v49, v53
    v_cvt_pk_bf16_f32 v119, v57, v61
    buffer_store_dwordx4 v[116:119], v120, s[20:23], s25 offen
    s_add_u32 s25, s25, 2736128
    v_cvt_pk_bf16_f32 v112, v34, v38
    v_cvt_pk_bf16_f32 v113, v42, v46
    v_cvt_pk_bf16_f32 v114, v50, v54
    v_cvt_pk_bf16_f32 v115, v58, v62
    buffer_store_dwordx4 v[112:115], v120, s[20:23], s25 offen
    s_add_u32 s25, s25, 2736128
    v_cvt_pk_bf16_f32 v116, v35, v39
    v_cvt_pk_bf16_f32 v117, v43, v47
    v_cvt_pk_bf16_f32 v118, v51, v55
    v_cvt_pk_bf16_f32 v119, v59, v63
    buffer_store_dwordx4 v[116:119], v120, s[20:23], s25 offen
    s_add_u32 s25, s25, 2736128
    ds_read_b128 v[96:99], v121 offset:4096
    ds_read_b128 v[100:103], v121 offset:5120
    ds_read_b128 v[104:107], v121 offset:6144
    ds_read_b128 v[108:111], v121 offset:7168
    s_waitcnt lgkmcnt(3)
    v_mfma_f32_16x16x32_bf16 v[32:35], v[96:99], v[64:67], 0
    v_mfma_f32_16x16x32_bf16 v[36:39], v[96:99], v[68:71], 0
    v_mfma_f32_16x16x32_bf16 v[40:43], v[96:99], v[72:75], 0
    v_mfma_f32_16x16x32_bf16 v[44:47], v[96:99], v[76:79], 0
    v_mfma_f32_16x16x32_bf16 v[48:51], v[96:99], v[80:83], 0
    v_mfma_f32_16x16x32_bf16 v[52:55], v[96:99], v[84:87], 0
    v_mfma_f32_16x16x32_bf16 v[56:59], v[96:99], v[88:91], 0
    v_mfma_f32_16x16x32_bf16 v[60:63], v[96:99], v[92:95], 0
    s_waitcnt lgkmcnt(2)
    v_mfma_f32_16x16x32_bf16 v[32:35], v[100:103], v[64:67], v[32:35]
    v_mfma_f32_16x16x32_bf16 v[36:39], v[100:103], v[68:71], v[36:39]
    v_mfma_f32_16x16x32_bf16 v[40:43], v[100:103], v[72:75], v[40:43]
    v_mfma_f32_16x16x32_bf16 v[44:47], v[100:103], v[76:79], v[44:47]
    v_mfma_f32_16x16x32_bf16 v[48:51], v[100:103], v[80:83], v[48:51]
    v_mfma_f32_16x16x32_bf16 v[52:55], v[100:103], v[84:87], v[52:55]
    v_mfma_f32_16x16x32_bf16 v[56:59], v[100:103], v[88:91], v[56:59]
    v_mfma_f32_16x16x32_bf16 v[60:63], v[100:103], v[92:95], v[60:63]
    s_waitcnt lgkmcnt(1)
    v_mfma_f32_16x16x32_bf16 v[32:35], v[104:107], v[0:3], v[32:35]
    v_mfma_f32_16x16x32_bf16 v[36:39], v[104:107], v[4:7], v[36:39]
    v_mfma_f32_16x16x32_bf16 v[40:43], v[104:107], v[8:11], v[40:43]
    v_mfma_f32_16x16x32_bf16 v[44:47], v[104:107], v[12:15], v[44:47]
    v_mfma_f32_16x16x32_bf16 v[48:51], v[104:107], v[16:19], v[48:51]
    v_mfma_f32_16x16x32_bf16 v[52:55], v[104:107], v[20:23], v[52:55]
    v_mfma_f32_16x16x32_bf16 v[56:59], v[104:107], v[24:27], v[56:59]
    v_mfma_f32_16x16x32_bf16 v[60:63], v[104:107], v[28:31], v[60:63]
    s_waitcnt lgkmcnt(0)
    v_mfma_f32_16x16x32_bf16 v[32:35], v[108:111], v[0:3], v[32:35]
    v_mfma_f32_16x16x32_bf16 v[36:39], v[108:111], v[4:7], v[36:39]
    v_mfma_f32_16x16x32_bf16 v[40:43], v[108:111], v[8:11], v[40:43]
    v_mfma_f32_16x16x32_bf16 v[44:47], v[108:111], v[12:15], v[44:47]
    v_mfma_f32_16x16x32_bf16 v[48:51], v[108:111], v[16:19], v[48:51]
    v_mfma_f32_16x16x32_bf16 v[52:55], v[108:111], v[20:23], v[52:55]
    v_mfma_f32_16x16x32_bf16 v[56:59], v[108:111], v[24:27], v[56:59]
    v_mfma_f32_16x16x32_bf16 v[60:63], v[108:111], v[28:31], v[60:63]
    s_nop 7
    v_cvt_pk_bf16_f32 v112, v32, v36
    v_cvt_pk_bf16_f32 v113, v40, v44
    v_cvt_pk_bf16_f32 v114, v48, v52
    v_cvt_pk_bf16_f32 v115, v56, v60
    buffer_store_dwordx4 v[112:115], v120, s[20:23], s25 offen
    s_add_u32 s25, s25, 2736128
    v_cvt_pk_bf16_f32 v116, v33, v37
    v_cvt_pk_bf16_f32 v117, v41, v45
    v_cvt_pk_bf16_f32 v118, v49, v53
    v_cvt_pk_bf16_f32 v119, v57, v61
    buffer_store_dwordx4 v[116:119], v120, s[20:23], s25 offen
    s_add_u32 s25, s25, 2736128
    v_cvt_pk_bf16_f32 v112, v34, v38
    v_cvt_pk_bf16_f32 v113, v42, v46
    v_cvt_pk_bf16_f32 v114, v50, v54
    v_cvt_pk_bf16_f32 v115, v58, v62
    buffer_store_dwordx4 v[112:115], v120, s[20:23], s25 offen
    s_add_u32 s25, s25, 2736128
    v_cvt_pk_bf16_f32 v116, v35, v39
    v_cvt_pk_bf16_f32 v117, v43, v47
    v_cvt_pk_bf16_f32 v118, v51, v55
    v_cvt_pk_bf16_f32 v119, v59, v63
    buffer_store_dwordx4 v[116:119], v120, s[20:23], s25 offen
    s_add_u32 s25, s25, 2736128
    ds_read_b128 v[96:99], v121 offset:8192
    ds_read_b128 v[100:103], v121 offset:9216
    ds_read_b128 v[104:107], v121 offset:10240
    ds_read_b128 v[108:111], v121 offset:11264
    s_waitcnt lgkmcnt(3)
    v_mfma_f32_16x16x32_bf16 v[32:35], v[96:99], v[64:67], 0
    v_mfma_f32_16x16x32_bf16 v[36:39], v[96:99], v[68:71], 0
    v_mfma_f32_16x16x32_bf16 v[40:43], v[96:99], v[72:75], 0
    v_mfma_f32_16x16x32_bf16 v[44:47], v[96:99], v[76:79], 0
    v_mfma_f32_16x16x32_bf16 v[48:51], v[96:99], v[80:83], 0
    v_mfma_f32_16x16x32_bf16 v[52:55], v[96:99], v[84:87], 0
    v_mfma_f32_16x16x32_bf16 v[56:59], v[96:99], v[88:91], 0
    v_mfma_f32_16x16x32_bf16 v[60:63], v[96:99], v[92:95], 0
    s_waitcnt lgkmcnt(2)
    v_mfma_f32_16x16x32_bf16 v[32:35], v[100:103], v[64:67], v[32:35]
    v_mfma_f32_16x16x32_bf16 v[36:39], v[100:103], v[68:71], v[36:39]
    v_mfma_f32_16x16x32_bf16 v[40:43], v[100:103], v[72:75], v[40:43]
    v_mfma_f32_16x16x32_bf16 v[44:47], v[100:103], v[76:79], v[44:47]
    v_mfma_f32_16x16x32_bf16 v[48:51], v[100:103], v[80:83], v[48:51]
    v_mfma_f32_16x16x32_bf16 v[52:55], v[100:103], v[84:87], v[52:55]
    v_mfma_f32_16x16x32_bf16 v[56:59], v[100:103], v[88:91], v[56:59]
    v_mfma_f32_16x16x32_bf16 v[60:63], v[100:103], v[92:95], v[60:63]
    s_waitcnt lgkmcnt(1)
    v_mfma_f32_16x16x32_bf16 v[32:35], v[104:107], v[0:3], v[32:35]
    v_mfma_f32_16x16x32_bf16 v[36:39], v[104:107], v[4:7], v[36:39]
    v_mfma_f32_16x16x32_bf16 v[40:43], v[104:107], v[8:11], v[40:43]
    v_mfma_f32_16x16x32_bf16 v[44:47], v[104:107], v[12:15], v[44:47]
    v_mfma_f32_16x16x32_bf16 v[48:51], v[104:107], v[16:19], v[48:51]
    v_mfma_f32_16x16x32_bf16 v[52:55], v[104:107], v[20:23], v[52:55]
    v_mfma_f32_16x16x32_bf16 v[56:59], v[104:107], v[24:27], v[56:59]
    v_mfma_f32_16x16x32_bf16 v[60:63], v[104:107], v[28:31], v[60:63]
    s_waitcnt lgkmcnt(0)
    v_mfma_f32_16x16x32_bf16 v[32:35], v[108:111], v[0:3], v[32:35]
    v_mfma_f32_16x16x32_bf16 v[36:39], v[108:111], v[4:7], v[36:39]
    v_mfma_f32_16x16x32_bf16 v[40:43], v[108:111], v[8:11], v[40:43]
    v_mfma_f32_16x16x32_bf16 v[44:47], v[108:111], v[12:15], v[44:47]
    v_mfma_f32_16x16x32_bf16 v[48:51], v[108:111], v[16:19], v[48:51]
    v_mfma_f32_16x16x32_bf16 v[52:55], v[108:111], v[20:23], v[52:55]
    v_mfma_f32_16x16x32_bf16 v[56:59], v[108:111], v[24:27], v[56:59]
    v_mfma_f32_16x16x32_bf16 v[60:63], v[108:111], v[28:31], v[60:63]
    s_nop 7
    v_cvt_pk_bf16_f32 v112, v32, v36
    v_cvt_pk_bf16_f32 v113, v40, v44
    v_cvt_pk_bf16_f32 v114, v48, v52
    v_cvt_pk_bf16_f32 v115, v56, v60
    buffer_store_dwordx4 v[112:115], v120, s[20:23], s25 offen
    s_add_u32 s25, s25, 2736128
    v_cvt_pk_bf16_f32 v116, v33, v37
    v_cvt_pk_bf16_f32 v117, v41, v45
    v_cvt_pk_bf16_f32 v118, v49, v53
    v_cvt_pk_bf16_f32 v119, v57, v61
    buffer_store_dwordx4 v[116:119], v120, s[20:23], s25 offen
    s_add_u32 s25, s25, 2736128
    v_cvt_pk_bf16_f32 v112, v34, v38
    v_cvt_pk_bf16_f32 v113, v42, v46
    v_cvt_pk_bf16_f32 v114, v50, v54
    v_cvt_pk_bf16_f32 v115, v58, v62
    buffer_store_dwordx4 v[112:115], v120, s[20:23], s25 offen
    s_add_u32 s25, s25, 2736128
    v_cvt_pk_bf16_f32 v116, v35, v39
    v_cvt_pk_bf16_f32 v117, v43, v47
    v_cvt_pk_bf16_f32 v118, v51, v55
    v_cvt_pk_bf16_f32 v119, v59, v63
    buffer_store_dwordx4 v[116:119], v120, s[20:23], s25 offen
    s_add_u32 s25, s25, 2736128
    ds_read_b128 v[96:99], v121 offset:12288
    ds_read_b128 v[100:103], v121 offset:13312
    ds_read_b128 v[104:107], v121 offset:14336
    ds_read_b128 v[108:111], v121 offset:15360
    s_waitcnt lgkmcnt(3)
    v_mfma_f32_16x16x32_bf16 v[32:35], v[96:99], v[64:67], 0
    v_mfma_f32_16x16x32_bf16 v[36:39], v[96:99], v[68:71], 0
    v_mfma_f32_16x16x32_bf16 v[40:43], v[96:99], v[72:75], 0
    v_mfma_f32_16x16x32_bf16 v[44:47], v[96:99], v[76:79], 0
    v_mfma_f32_16x16x32_bf16 v[48:51], v[96:99], v[80:83], 0
    v_mfma_f32_16x16x32_bf16 v[52:55], v[96:99], v[84:87], 0
    v_mfma_f32_16x16x32_bf16 v[56:59], v[96:99], v[88:91], 0
    v_mfma_f32_16x16x32_bf16 v[60:63], v[96:99], v[92:95], 0
    s_waitcnt lgkmcnt(2)
    v_mfma_f32_16x16x32_bf16 v[32:35], v[100:103], v[64:67], v[32:35]
    v_mfma_f32_16x16x32_bf16 v[36:39], v[100:103], v[68:71], v[36:39]
    v_mfma_f32_16x16x32_bf16 v[40:43], v[100:103], v[72:75], v[40:43]
    v_mfma_f32_16x16x32_bf16 v[44:47], v[100:103], v[76:79], v[44:47]
    v_mfma_f32_16x16x32_bf16 v[48:51], v[100:103], v[80:83], v[48:51]
    v_mfma_f32_16x16x32_bf16 v[52:55], v[100:103], v[84:87], v[52:55]
    v_mfma_f32_16x16x32_bf16 v[56:59], v[100:103], v[88:91], v[56:59]
    v_mfma_f32_16x16x32_bf16 v[60:63], v[100:103], v[92:95], v[60:63]
    s_waitcnt lgkmcnt(1)
    v_mfma_f32_16x16x32_bf16 v[32:35], v[104:107], v[0:3], v[32:35]
    v_mfma_f32_16x16x32_bf16 v[36:39], v[104:107], v[4:7], v[36:39]
    v_mfma_f32_16x16x32_bf16 v[40:43], v[104:107], v[8:11], v[40:43]
    v_mfma_f32_16x16x32_bf16 v[44:47], v[104:107], v[12:15], v[44:47]
    v_mfma_f32_16x16x32_bf16 v[48:51], v[104:107], v[16:19], v[48:51]
    v_mfma_f32_16x16x32_bf16 v[52:55], v[104:107], v[20:23], v[52:55]
    v_mfma_f32_16x16x32_bf16 v[56:59], v[104:107], v[24:27], v[56:59]
    v_mfma_f32_16x16x32_bf16 v[60:63], v[104:107], v[28:31], v[60:63]
    s_waitcnt lgkmcnt(0)
    v_mfma_f32_16x16x32_bf16 v[32:35], v[108:111], v[0:3], v[32:35]
    v_mfma_f32_16x16x32_bf16 v[36:39], v[108:111], v[4:7], v[36:39]
    v_mfma_f32_16x16x32_bf16 v[40:43], v[108:111], v[8:11], v[40:43]
    v_mfma_f32_16x16x32_bf16 v[44:47], v[108:111], v[12:15], v[44:47]
    v_mfma_f32_16x16x32_bf16 v[48:51], v[108:111], v[16:19], v[48:51]
    v_mfma_f32_16x16x32_bf16 v[52:55], v[108:111], v[20:23], v[52:55]
    v_mfma_f32_16x16x32_bf16 v[56:59], v[108:111], v[24:27], v[56:59]
    v_mfma_f32_16x16x32_bf16 v[60:63], v[108:111], v[28:31], v[60:63]
    s_nop 7
    v_cvt_pk_bf16_f32 v112, v32, v36
    v_cvt_pk_bf16_f32 v113, v40, v44
    v_cvt_pk_bf16_f32 v114, v48, v52
    v_cvt_pk_bf16_f32 v115, v56, v60
    buffer_store_dwordx4 v[112:115], v120, s[20:23], s25 offen
    s_add_u32 s25, s25, 2736128
    v_cvt_pk_bf16_f32 v116, v33, v37
    v_cvt_pk_bf16_f32 v117, v41, v45
    v_cvt_pk_bf16_f32 v118, v49, v53
    v_cvt_pk_bf16_f32 v119, v57, v61
    buffer_store_dwordx4 v[116:119], v120, s[20:23], s25 offen
    s_add_u32 s25, s25, 2736128
    v_cvt_pk_bf16_f32 v112, v34, v38
    v_cvt_pk_bf16_f32 v113, v42, v46
    v_cvt_pk_bf16_f32 v114, v50, v54
    v_cvt_pk_bf16_f32 v115, v58, v62
    buffer_store_dwordx4 v[112:115], v120, s[20:23], s25 offen
    s_add_u32 s25, s25, 2736128
    v_cvt_pk_bf16_f32 v116, v35, v39
    v_cvt_pk_bf16_f32 v117, v43, v47
    v_cvt_pk_bf16_f32 v118, v51, v55
    v_cvt_pk_bf16_f32 v119, v59, v63
    buffer_store_dwordx4 v[116:119], v120, s[20:23], s25 offen
    s_endpgm
K1_W:
    s_mov_b32 s16, s6
    s_mov_b32 s17, s7
    s_and_b32 s17, s17, 0xffff
    s_mov_b32 s18, 16252928
    s_mov_b32 s19, 0x00020000
    s_add_u32 s20, s8, 50331648
    s_addc_u32 s21, s9, 0
    s_and_b32 s21, s21, 0xffff
    s_mov_b32 s22, 67108864
    s_mov_b32 s23, 0x00020000
    s_mul_i32 s11, s2, 1
    s_lshr_b32 s12, s11, 9
    s_and_b32 s13, s11, 511
    s_lshl_b32 s14, s12, 19
    s_lshl_b32 s15, s13, 10
    s_add_u32 s14, s14, s15
    s_lshl_b32 s15, s3, 8
    s_add_u32 s14, s14, s15
    v_and_b32 v126, 1, v123
    v_lshlrev_b32 v126, 23, v126
    v_lshl_add_u32 v126, v122, 4, v126
    s_mov_b32 s15, s14
    buffer_load_dwordx4 v[0:3], v126, s[16:19], s15 offen
    s_add_u32 s15, s15, 0x100000
    buffer_load_dwordx4 v[4:7], v126, s[16:19], s15 offen
    s_add_u32 s15, s15, 0x100000
    buffer_load_dwordx4 v[8:11], v126, s[16:19], s15 offen
    s_add_u32 s15, s15, 0x100000
    buffer_load_dwordx4 v[12:15], v126, s[16:19], s15 offen
    s_add_u32 s15, s15, 0x100000
    buffer_load_dwordx4 v[16:19], v126, s[16:19], s15 offen
    s_add_u32 s15, s15, 0x100000
    buffer_load_dwordx4 v[20:23], v126, s[16:19], s15 offen
    s_add_u32 s15, s15, 0x100000
    buffer_load_dwordx4 v[24:27], v126, s[16:19], s15 offen
    s_add_u32 s15, s15, 0x100000
    buffer_load_dwordx4 v[28:31], v126, s[16:19], s15 offen
    v_and_b32 v127, 1, v123
    v_lshlrev_b32 v127, 3, v127
    v_mul_u32_u24 v112, 96, v125
    v_mad_u32_u24 v113, v124, v127, v112
    v_mad_u32_u24 v64, v124, 0, v113
    v_mad_u32_u24 v65, v124, 1, v113
    v_mad_u32_u24 v66, v124, 2, v113
    v_mad_u32_u24 v67, v124, 3, v113
    v_mad_u32_u24 v68, v124, 4, v113
    v_mad_u32_u24 v69, v124, 5, v113
    v_mad_u32_u24 v70, v124, 6, v113
    v_mad_u32_u24 v71, v124, 7, v113
    v_and_b32 v64, 127, v64
    v_and_b32 v65, 127, v65
    v_and_b32 v66, 127, v66
    v_and_b32 v67, 127, v67
    v_and_b32 v68, 127, v68
    v_and_b32 v69, 127, v69
    v_and_b32 v70, 127, v70
    v_and_b32 v71, 127, v71
    v_cvt_f32_u32 v64, v64
    v_cvt_f32_u32 v65, v65
    v_cvt_f32_u32 v66, v66
    v_cvt_f32_u32 v67, v67
    v_cvt_f32_u32 v68, v68
    v_cvt_f32_u32 v69, v69
    v_cvt_f32_u32 v70, v70
    v_cvt_f32_u32 v71, v71
    v_mul_f32 v64, 0x3c000000, v64
    v_mul_f32 v65, 0x3c000000, v65
    v_mul_f32 v66, 0x3c000000, v66
    v_mul_f32 v67, 0x3c000000, v67
    v_mul_f32 v68, 0x3c000000, v68
    v_mul_f32 v69, 0x3c000000, v69
    v_mul_f32 v70, 0x3c000000, v70
    v_mul_f32 v71, 0x3c000000, v71
    v_cos_f32 v64, v64
    v_cos_f32 v65, v65
    v_cos_f32 v66, v66
    v_cos_f32 v67, v67
    v_cos_f32 v68, v68
    v_cos_f32 v69, v69
    v_cos_f32 v70, v70
    v_cos_f32 v71, v71
    s_nop 0
    v_cvt_pk_bf16_f32 v72, v64, v65
    v_cvt_pk_bf16_f32 v73, v66, v67
    v_cvt_pk_bf16_f32 v74, v68, v69
    v_cvt_pk_bf16_f32 v75, v70, v71
    v_lshlrev_b32 v80, 16, v72
    v_and_b32 v81, 0xffff0000, v72
    v_sub_f32 v64, v64, v80
    v_sub_f32 v65, v65, v81
    v_lshlrev_b32 v80, 16, v73
    v_and_b32 v81, 0xffff0000, v73
    v_sub_f32 v66, v66, v80
    v_sub_f32 v67, v67, v81
    v_lshlrev_b32 v80, 16, v74
    v_and_b32 v81, 0xffff0000, v74
    v_sub_f32 v68, v68, v80
    v_sub_f32 v69, v69, v81
    v_lshlrev_b32 v80, 16, v75
    v_and_b32 v81, 0xffff0000, v75
    v_sub_f32 v70, v70, v80
    v_sub_f32 v71, v71, v81
    v_cvt_pk_bf16_f32 v76, v64, v65
    v_cvt_pk_bf16_f32 v77, v66, v67
    v_cvt_pk_bf16_f32 v78, v68, v69
    v_cvt_pk_bf16_f32 v79, v70, v71
    v_cmp_lt_u32 vcc, 1, v123
    s_lshl_b32 s24, s3, 10
    v_add_u32 v114, s24, v121
    v_cndmask_b32 v72, v72, v76, vcc
    v_cndmask_b32 v73, v73, v77, vcc
    v_cndmask_b32 v74, v74, v78, vcc
    v_cndmask_b32 v75, v75, v79, vcc
    ds_write_b128 v114, v[72:75]
    v_lshrrev_b32 v112, 1, v123
    s_mov_b32 s24, 2097152
    v_mul_lo_u32 v112, v112, s24
    v_and_b32 v113, 1, v123
    v_lshl_add_u32 v112, v113, 8, v112
    v_and_b32 v113, 1, v122
    v_lshl_add_u32 v124, v113, 4, v112
    v_lshrrev_b32 v125, 1, v122
    s_mul_i32 s26, s3, 524288
    s_lshl_b32 s24, s11, 9
    s_add_u32 s26, s26, s24
    s_waitcnt lgkmcnt(0)
    s_barrier
    ds_read_b128 v[96:99], v121 offset:0
    ds_read_b128 v[100:103], v121 offset:1024
    ds_read_b128 v[104:107], v121 offset:2048
    ds_read_b128 v[108:111], v121 offset:3072
    s_mov_b32 s27, 0
    s_waitcnt vmcnt(0) lgkmcnt(0)
K1_W_LOOP:
    s_add_u32 s24, s11, s27
    s_and_b32 s30, s24, 3
    s_lshr_b32 s24, s24, 1
    s_and_b32 s24, s24, 4
    s_or_b32 s30, s30, s24
    v_xor_b32 v112, s30, v125
    v_lshl_add_u32 v120, v112, 5, v124
    s_lshl_b32 s25, s27, 9
    s_add_u32 s25, s25, s26
    v_perm_b32 v32, v4, v0, s28
    v_perm_b32 v36, v4, v0, s29
    v_perm_b32 v33, v12, v8, s28
    v_perm_b32 v37, v12, v8, s29
    v_perm_b32 v34, v20, v16, s28
    v_perm_b32 v38, v20, v16, s29
    v_perm_b32 v35, v28, v24, s28
    v_perm_b32 v39, v28, v24, s29
    v_perm_b32 v40, v5, v1, s28
    v_perm_b32 v44, v5, v1, s29
    v_perm_b32 v41, v13, v9, s28
    v_perm_b32 v45, v13, v9, s29
    v_perm_b32 v42, v21, v17, s28
    v_perm_b32 v46, v21, v17, s29
    v_perm_b32 v43, v29, v25, s28
    v_perm_b32 v47, v29, v25, s29
    v_perm_b32 v48, v6, v2, s28
    v_perm_b32 v52, v6, v2, s29
    v_perm_b32 v49, v14, v10, s28
    v_perm_b32 v53, v14, v10, s29
    v_perm_b32 v50, v22, v18, s28
    v_perm_b32 v54, v22, v18, s29
    v_perm_b32 v51, v30, v26, s28
    v_perm_b32 v55, v30, v26, s29
    v_perm_b32 v56, v7, v3, s28
    v_perm_b32 v60, v7, v3, s29
    v_perm_b32 v57, v15, v11, s28
    v_perm_b32 v61, v15, v11, s29
    v_perm_b32 v58, v23, v19, s28
    v_perm_b32 v62, v23, v19, s29
    v_perm_b32 v59, v31, v27, s28
    v_perm_b32 v63, v31, v27, s29
    s_add_u32 s27, s27, 1
    s_add_u32 s14, s14, 1024
    s_cmp_ge_u32 s27, 1
    s_cbranch_scc1 K1_W_NOLOAD
    s_mov_b32 s15, s14
    buffer_load_dwordx4 v[0:3], v126, s[16:19], s15 offen
    s_add_u32 s15, s15, 0x100000
    buffer_load_dwordx4 v[4:7], v126, s[16:19], s15 offen
    s_add_u32 s15, s15, 0x100000
    buffer_load_dwordx4 v[8:11], v126, s[16:19], s15 offen
    s_add_u32 s15, s15, 0x100000
    buffer_load_dwordx4 v[12:15], v126, s[16:19], s15 offen
    s_add_u32 s15, s15, 0x100000
    buffer_load_dwordx4 v[16:19], v126, s[16:19], s15 offen
    s_add_u32 s15, s15, 0x100000
    buffer_load_dwordx4 v[20:23], v126, s[16:19], s15 offen
    s_add_u32 s15, s15, 0x100000
    buffer_load_dwordx4 v[24:27], v126, s[16:19], s15 offen
    s_add_u32 s15, s15, 0x100000
    buffer_load_dwordx4 v[28:31], v126, s[16:19], s15 offen
K1_W_NOLOAD:
    v_mfma_f32_16x16x32_bf16 v[64:67], v[96:99], v[32:35], 0
    v_mfma_f32_16x16x32_bf16 v[68:71], v[96:99], v[36:39], 0
    v_mfma_f32_16x16x32_bf16 v[72:75], v[96:99], v[40:43], 0
    v_mfma_f32_16x16x32_bf16 v[76:79], v[96:99], v[44:47], 0
    v_mfma_f32_16x16x32_bf16 v[80:83], v[96:99], v[48:51], 0
    v_mfma_f32_16x16x32_bf16 v[84:87], v[96:99], v[52:55], 0
    v_mfma_f32_16x16x32_bf16 v[88:91], v[96:99], v[56:59], 0
    v_mfma_f32_16x16x32_bf16 v[92:95], v[96:99], v[60:63], 0
    s_nop 7
    v_cvt_pk_bf16_f32 v112, v64, v68
    v_cvt_pk_bf16_f32 v113, v72, v76
    v_cvt_pk_bf16_f32 v114, v80, v84
    v_cvt_pk_bf16_f32 v115, v88, v92
    buffer_store_dwordx4 v[112:115], v120, s[20:23], s25 offen
    s_add_u32 s25, s25, 4194304
    v_cvt_pk_bf16_f32 v116, v65, v69
    v_cvt_pk_bf16_f32 v117, v73, v77
    v_cvt_pk_bf16_f32 v118, v81, v85
    v_cvt_pk_bf16_f32 v119, v89, v93
    buffer_store_dwordx4 v[116:119], v120, s[20:23], s25 offen
    s_add_u32 s25, s25, 4194304
    v_cvt_pk_bf16_f32 v112, v66, v70
    v_cvt_pk_bf16_f32 v113, v74, v78
    v_cvt_pk_bf16_f32 v114, v82, v86
    v_cvt_pk_bf16_f32 v115, v90, v94
    buffer_store_dwordx4 v[112:115], v120, s[20:23], s25 offen
    s_add_u32 s25, s25, 4194304
    v_cvt_pk_bf16_f32 v116, v67, v71
    v_cvt_pk_bf16_f32 v117, v75, v79
    v_cvt_pk_bf16_f32 v118, v83, v87
    v_cvt_pk_bf16_f32 v119, v91, v95
    buffer_store_dwordx4 v[116:119], v120, s[20:23], s25 offen
    s_add_u32 s25, s25, 4194304
    v_mfma_f32_16x16x32_bf16 v[64:67], v[100:103], v[32:35], 0
    v_mfma_f32_16x16x32_bf16 v[68:71], v[100:103], v[36:39], 0
    v_mfma_f32_16x16x32_bf16 v[72:75], v[100:103], v[40:43], 0
    v_mfma_f32_16x16x32_bf16 v[76:79], v[100:103], v[44:47], 0
    v_mfma_f32_16x16x32_bf16 v[80:83], v[100:103], v[48:51], 0
    v_mfma_f32_16x16x32_bf16 v[84:87], v[100:103], v[52:55], 0
    v_mfma_f32_16x16x32_bf16 v[88:91], v[100:103], v[56:59], 0
    v_mfma_f32_16x16x32_bf16 v[92:95], v[100:103], v[60:63], 0
    s_nop 7
    v_cvt_pk_bf16_f32 v112, v64, v68
    v_cvt_pk_bf16_f32 v113, v72, v76
    v_cvt_pk_bf16_f32 v114, v80, v84
    v_cvt_pk_bf16_f32 v115, v88, v92
    buffer_store_dwordx4 v[112:115], v120, s[20:23], s25 offen
    s_add_u32 s25, s25, 4194304
    v_cvt_pk_bf16_f32 v116, v65, v69
    v_cvt_pk_bf16_f32 v117, v73, v77
    v_cvt_pk_bf16_f32 v118, v81, v85
    v_cvt_pk_bf16_f32 v119, v89, v93
    buffer_store_dwordx4 v[116:119], v120, s[20:23], s25 offen
    s_add_u32 s25, s25, 4194304
    v_cvt_pk_bf16_f32 v112, v66, v70
    v_cvt_pk_bf16_f32 v113, v74, v78
    v_cvt_pk_bf16_f32 v114, v82, v86
    v_cvt_pk_bf16_f32 v115, v90, v94
    buffer_store_dwordx4 v[112:115], v120, s[20:23], s25 offen
    s_add_u32 s25, s25, 4194304
    v_cvt_pk_bf16_f32 v116, v67, v71
    v_cvt_pk_bf16_f32 v117, v75, v79
    v_cvt_pk_bf16_f32 v118, v83, v87
    v_cvt_pk_bf16_f32 v119, v91, v95
    buffer_store_dwordx4 v[116:119], v120, s[20:23], s25 offen
    s_add_u32 s25, s25, 4194304
    v_mfma_f32_16x16x32_bf16 v[64:67], v[104:107], v[32:35], 0
    v_mfma_f32_16x16x32_bf16 v[68:71], v[104:107], v[36:39], 0
    v_mfma_f32_16x16x32_bf16 v[72:75], v[104:107], v[40:43], 0
    v_mfma_f32_16x16x32_bf16 v[76:79], v[104:107], v[44:47], 0
    v_mfma_f32_16x16x32_bf16 v[80:83], v[104:107], v[48:51], 0
    v_mfma_f32_16x16x32_bf16 v[84:87], v[104:107], v[52:55], 0
    v_mfma_f32_16x16x32_bf16 v[88:91], v[104:107], v[56:59], 0
    v_mfma_f32_16x16x32_bf16 v[92:95], v[104:107], v[60:63], 0
    s_nop 7
    v_cvt_pk_bf16_f32 v112, v64, v68
    v_cvt_pk_bf16_f32 v113, v72, v76
    v_cvt_pk_bf16_f32 v114, v80, v84
    v_cvt_pk_bf16_f32 v115, v88, v92
    buffer_store_dwordx4 v[112:115], v120, s[20:23], s25 offen
    s_add_u32 s25, s25, 4194304
    v_cvt_pk_bf16_f32 v116, v65, v69
    v_cvt_pk_bf16_f32 v117, v73, v77
    v_cvt_pk_bf16_f32 v118, v81, v85
    v_cvt_pk_bf16_f32 v119, v89, v93
    buffer_store_dwordx4 v[116:119], v120, s[20:23], s25 offen
    s_add_u32 s25, s25, 4194304
    v_cvt_pk_bf16_f32 v112, v66, v70
    v_cvt_pk_bf16_f32 v113, v74, v78
    v_cvt_pk_bf16_f32 v114, v82, v86
    v_cvt_pk_bf16_f32 v115, v90, v94
    buffer_store_dwordx4 v[112:115], v120, s[20:23], s25 offen
    s_add_u32 s25, s25, 4194304
    v_cvt_pk_bf16_f32 v116, v67, v71
    v_cvt_pk_bf16_f32 v117, v75, v79
    v_cvt_pk_bf16_f32 v118, v83, v87
    v_cvt_pk_bf16_f32 v119, v91, v95
    buffer_store_dwordx4 v[116:119], v120, s[20:23], s25 offen
    s_add_u32 s25, s25, 4194304
    v_mfma_f32_16x16x32_bf16 v[64:67], v[108:111], v[32:35], 0
    v_mfma_f32_16x16x32_bf16 v[68:71], v[108:111], v[36:39], 0
    v_mfma_f32_16x16x32_bf16 v[72:75], v[108:111], v[40:43], 0
    v_mfma_f32_16x16x32_bf16 v[76:79], v[108:111], v[44:47], 0
    v_mfma_f32_16x16x32_bf16 v[80:83], v[108:111], v[48:51], 0
    v_mfma_f32_16x16x32_bf16 v[84:87], v[108:111], v[52:55], 0
    v_mfma_f32_16x16x32_bf16 v[88:91], v[108:111], v[56:59], 0
    v_mfma_f32_16x16x32_bf16 v[92:95], v[108:111], v[60:63], 0
    s_nop 7
    v_cvt_pk_bf16_f32 v112, v64, v68
    v_cvt_pk_bf16_f32 v113, v72, v76
    v_cvt_pk_bf16_f32 v114, v80, v84
    v_cvt_pk_bf16_f32 v115, v88, v92
    buffer_store_dwordx4 v[112:115], v120, s[20:23], s25 offen
    s_add_u32 s25, s25, 4194304
    v_cvt_pk_bf16_f32 v116, v65, v69
    v_cvt_pk_bf16_f32 v117, v73, v77
    v_cvt_pk_bf16_f32 v118, v81, v85
    v_cvt_pk_bf16_f32 v119, v89, v93
    buffer_store_dwordx4 v[116:119], v120, s[20:23], s25 offen
    s_add_u32 s25, s25, 4194304
    v_cvt_pk_bf16_f32 v112, v66, v70
    v_cvt_pk_bf16_f32 v113, v74, v78
    v_cvt_pk_bf16_f32 v114, v82, v86
    v_cvt_pk_bf16_f32 v115, v90, v94
    buffer_store_dwordx4 v[112:115], v120, s[20:23], s25 offen
    s_add_u32 s25, s25, 4194304
    v_cvt_pk_bf16_f32 v116, v67, v71
    v_cvt_pk_bf16_f32 v117, v75, v79
    v_cvt_pk_bf16_f32 v118, v83, v87
    v_cvt_pk_bf16_f32 v119, v91, v95
    buffer_store_dwordx4 v[116:119], v120, s[20:23], s25 offen
    s_waitcnt vmcnt(16)
    s_cmp_lt_u32 s27, 1
    s_cbranch_scc1 K1_W_LOOP
K1_END:
    s_endpgm
.p2align 8
.type k12_fused_kernel,@function
k12_fused_kernel:
    s_cmp_ge_u32 s2, 256
    s_cbranch_scc1 K12_END
    s_load_dwordx4 s[52:55], s[0:1], 0
    s_load_dwordx4 s[56:59], s[0:1], 40
    s_getpc_b64 s[90:91]
CPF_K12:
    s_sub_u32 s90, s90, CPF_K12-k12_fused_kernel
    s_subb_u32 s91, s91, 0
    v_lshlrev_b32 v8, 7, v0
    v_mov_b32 v11, s91
    v_min_u32 v9, TEXT_END-k12_fused_kernel-4, v8
    v_add_co_u32 v10, vcc, s90, v9
    v_addc_co_u32 v11, vcc, 0, v11, vcc
    global_load_dword v63, v[10:11], off
    v_lshrrev_b32 v1, 6, v0
    v_and_b32 v2, 63, v0
    v_readfirstlane_b32 s3, v1
    s_waitcnt lgkmcnt(0)
    s_cmp_lt_u32 s3, 4
    s_cbranch_scc1 K12_CONS
    v_and_b32 v64, 15, v2
    v_lshrrev_b32 v65, 4, v2
    v_lshlrev_b32 v254, 4, v2
    s_and_b32 s44, s3, 3
    s_and_b32 s20, s44, 1
    s_lshr_b32 s21, s44, 1
    s_lshl_b32 s22, s2, 1
    s_add_u32 s22, s22, s21
    s_and_b32 s23, s22, 3
    s_lshr_b32 s22, s22, 2
    s_and_b32 s24, s2, 7
    s_lshl_b32 s24, s24, 5
    s_lshr_b32 s25, s2, 3
    s_add_u32 s24, s24, s25
    s_cmp_ge_u32 s24, 167
    s_cselect_b32 s25, 1, 0
    s_mul_i32 s26, s25, 167
    s_sub_u32 s24, s24, s26
    s_cmp_eq_u32 s21, 0
    s_cselect_b32 s25, s25, 1
    s_mul_i32 s26, s25, 16384000
    s_add_u32 s4, s52, s26
    s_addc_u32 s5, s53, 0
    s_and_b32 s5, s5, 0xffff
    s_mov_b32 s6, 16384000
    s_mov_b32 s7, 0x00020000
    s_mov_b32 s8, s54
    s_mov_b32 s9, s55
    s_and_b32 s9, s9, 0xffff
    s_mov_b32 s10, 16252928
    s_mov_b32 s11, 0x00020000
    s_mov_b32 s12, s58
    s_mov_b32 s13, s59
    s_and_b32 s13, s13, 0xffff
    s_mov_b32 s14, 43778048
    s_mov_b32 s15, 0x00020000
    s_add_u32 s16, s58, 50331648
    s_addc_u32 s17, s59, 0
    s_and_b32 s17, s17, 0xffff
    s_mov_b32 s18, 67108864
    s_mov_b32 s19, 0x00020000
    s_mov_b32 s60, s56
    s_and_b32 s61, s57, 0xffff
    s_mov_b32 s62, 256
    s_mov_b32 s63, 0x00020000
    s_mov_b32 s28, 0x05040100
    s_mov_b32 s29, 0x07060302
    v_lshlrev_b32 v248, 14, v65
    v_lshl_add_u32 v248, v64, 4, v248
    v_and_b32 v250, 1, v65
    v_lshlrev_b32 v250, 23, v250
    v_lshl_add_u32 v250, v64, 4, v250
    v_lshrrev_b32 v66, 1, v65
    s_mov_b32 s26, 1368064
    v_mul_lo_u32 v66, v66, s26
    v_lshrrev_b32 v67, 2, v64
    s_mov_b32 s26, 21376
    v_mul_lo_u32 v67, v67, s26
    v_add_u32 v66, v66, v67
    v_mov_b32 v252, v66
    v_lshrrev_b32 v66, 1, v65
    s_mov_b32 s26, 2097152
    v_mul_lo_u32 v66, v66, s26
    v_and_b32 v67, 1, v65
    v_lshl_add_u32 v66, v67, 8, v66
    v_and_b32 v67, 1, v64
    v_lshl_add_u32 v251, v67, 4, v66
    s_mul_i32 s31, s25, 684032
    s_mul_i32 s32, s23, 524288
    s_lshl_b32 s33, s23, 8
    s_mov_b32 s40, 3
    s_xor_b32 s43, s40, s20
    s_and_b32 s43, s43, 1
    s_mul_i32 s36, s40, 85
    s_add_u32 s36, s36, s2
    s_and_b32 s36, s36, 255
    s_mul_hi_u32 s37, s36, 0x55555556
    s_mul_i32 s38, s37, 3
    s_cmp_eq_u32 s38, s36
    s_cselect_b32 s27, 1, 0
    s_cmp_lt_u32 s37, 78
    s_cselect_b32 s27, s27, 0
    s_add_u32 s37, s37, 89
    s_cmp_eq_u32 s21, 0
    s_cselect_b32 s30, s24, s37
    s_cselect_b32 s27, 1, s27
    s_cmp_eq_u32 s43, 0
    s_cbranch_scc0 K12_PL1
    s_lshl_b32 s36, s40, 7
    s_add_u32 s36, s36, s22
    s_lshr_b32 s37, s36, 9
    s_lshl_b32 s37, s37, 19
    s_and_b32 s36, s36, 511
    s_lshl_b32 s36, s36, 10
    s_add_u32 s36, s36, s37
    s_add_u32 s36, s36, s33
    buffer_load_dwordx4 v[96:99], v250, s[8:11], s36 offen
    s_add_u32 s36, s36, 0x100000
    buffer_load_dwordx4 v[100:103], v250, s[8:11], s36 offen
    s_add_u32 s36, s36, 0x100000
    buffer_load_dwordx4 v[104:107], v250, s[8:11], s36 offen
    s_add_u32 s36, s36, 0x100000
    buffer_load_dwordx4 v[108:111], v250, s[8:11], s36 offen
    s_add_u32 s36, s36, 0x100000
    buffer_load_dwordx4 v[112:115], v250, s[8:11], s36 offen
    s_add_u32 s36, s36, 0x100000
    buffer_load_dwordx4 v[116:119], v250, s[8:11], s36 offen
    s_add_u32 s36, s36, 0x100000
    buffer_load_dwordx4 v[120:123], v250, s[8:11], s36 offen
    s_add_u32 s36, s36, 0x100000
    buffer_load_dwordx4 v[124:127], v250, s[8:11], s36 offen
    s_branch K12_PL2
K12_PL1:
    s_cmp_eq_u32 s27, 0
    s_cbranch_scc1 K12_PL2
    s_lshl_b32 s36, s40, 8
    s_mul_i32 s37, s30, 98304
    s_add_u32 s36, s36, s37
    buffer_load_dwordx4 v[0:3], v248, s[4:7], s36 offen
    buffer_load_dwordx4 v[4:7], v248, s[4:7], s36 offen offset:2048
    s_add_u32 s36, s36, 4096
    buffer_load_dwordx4 v[8:11], v248, s[4:7], s36 offen
    buffer_load_dwordx4 v[12:15], v248, s[4:7], s36 offen offset:2048
    s_add_u32 s36, s36, 4096
    buffer_load_dwordx4 v[16:19], v248, s[4:7], s36 offen
    buffer_load_dwordx4 v[20:23], v248, s[4:7], s36 offen offset:2048
    s_add_u32 s36, s36, 4096
    buffer_load_dwordx4 v[24:27], v248, s[4:7], s36 offen
    buffer_load_dwordx4 v[28:31], v248, s[4:7], s36 offen offset:2048
    s_add_u32 s36, s36, 53248
    buffer_load_dwordx4 v[32:35], v248, s[4:7], s36 offen
    buffer_load_dwordx4 v[36:39], v248, s[4:7], s36 offen offset:2048
    s_add_u32 s36, s36, 4096
    buffer_load_dwordx4 v[40:43], v248, s[4:7], s36 offen
    buffer_load_dwordx4 v[44:47], v248, s[4:7], s36 offen offset:2048
    s_add_u32 s36, s36, 4096
    buffer_load_dwordx4 v[48:51], v248, s[4:7], s36 offen
    buffer_load_dwordx4 v[52:55], v248, s[4:7], s36 offen offset:2048
    s_add_u32 s36, s36, 4096
    buffer_load_dwordx4 v[56:59], v248, s[4:7], s36 offen
    buffer_load_dwordx4 v[60:63], v248, s[4:7], s36 offen offset:2048
K12_PL2:
    v_and_b32 v128, 3, v64
    v_lshlrev_b32 v128, 2, v128
    v_lshrrev_b32 v130, 3, v64
    v_lshl_add_u32 v128, v130, 1, v128
    s_lshl_b32 s36, s44, 4
    s_add_u32 s36, s36, 1
    v_add_u32 v128, s36, v128
    v_bfe_u32 v129, v64, 2, 1
    v_lshlrev_b32 v131, 3, v65
    v_lshlrev_b32 v132, 5, v129
    v_mad_u32_u24 v133, v128, v131, v132
    v_mad_u32_u24 v136, v128, 0, v133
    v_mad_u32_u24 v137, v128, 1, v133
    v_mad_u32_u24 v138, v128, 2, v133
    v_mad_u32_u24 v139, v128, 3, v133
    v_mad_u32_u24 v140, v128, 4, v133
    v_mad_u32_u24 v141, v128, 5, v133
    v_mad_u32_u24 v142, v128, 6, v133
    v_mad_u32_u24 v143, v128, 7, v133
    v_and_b32 v136, 127, v136
    v_and_b32 v137, 127, v137
    v_and_b32 v138, 127, v138
    v_and_b32 v139, 127, v139
    v_and_b32 v140, 127, v140
    v_and_b32 v141, 127, v141
    v_and_b32 v142, 127, v142
    v_and_b32 v143, 127, v143
    v_cvt_f32_u32 v136, v136
    v_cvt_f32_u32 v137, v137
    v_cvt_f32_u32 v138, v138
    v_cvt_f32_u32 v139, v139
    v_cvt_f32_u32 v140, v140
    v_cvt_f32_u32 v141, v141
    v_cvt_f32_u32 v142, v142
    v_cvt_f32_u32 v143, v143
    v_mul_f32 v136, 0x3c000000, v136
    v_mul_f32 v137, 0x3c000000, v137
    v_mul_f32 v138, 0x3c000000, v138
    v_mul_f32 v139, 0x3c000000, v139
    v_mul_f32 v140, 0x3c000000, v140
    v_mul_f32 v141, 0x3c000000, v141
    v_mul_f32 v142, 0x3c000000, v142
    v_mul_f32 v143, 0x3c000000, v143
    v_cos_f32 v136, v136
    v_cos_f32 v137, v137
    v_cos_f32 v138, v138
    v_cos_f32 v139, v139
    v_cos_f32 v140, v140
    v_cos_f32 v141, v141
    v_cos_f32 v142, v142
    v_cos_f32 v143, v143
    s_nop 0
    v_cvt_pk_bf16_f32 v144, v136, v137
    v_cvt_pk_bf16_f32 v145, v138, v139
    v_cvt_pk_bf16_f32 v146, v140, v141
    v_cvt_pk_bf16_f32 v147, v142, v143
    v_lshlrev_b32 v152, 16, v144
    v_and_b32 v153, 0xffff0000, v144
    v_sub_f32 v136, v136, v152
    v_sub_f32 v137, v137, v153
    v_lshlrev_b32 v152, 16, v145
    v_and_b32 v153, 0xffff0000, v145
    v_sub_f32 v138, v138, v152
    v_sub_f32 v139, v139, v153
    v_lshlrev_b32 v152, 16, v146
    v_and_b32 v153, 0xffff0000, v146
    v_sub_f32 v140, v140, v152
    v_sub_f32 v141, v141, v153
    v_lshlrev_b32 v152, 16, v147
    v_and_b32 v153, 0xffff0000, v147
    v_sub_f32 v142, v142, v152
    v_sub_f32 v143, v143, v153
    v_cvt_pk_bf16_f32 v148, v136, v137
    v_cvt_pk_bf16_f32 v149, v138, v139
    v_cvt_pk_bf16_f32 v150, v140, v141
    v_cvt_pk_bf16_f32 v151, v142, v143
    s_lshl_b32 s37, s44, 12
    s_add_u32 s37, s37, 116736
    v_add_u32 v132, s37, v254
    ds_write_b128 v132, v[144:147]
    ds_write_b128 v132, v[148:151] offset:1024
    v_add_u32 v131, 32, v131
    v_lshlrev_b32 v132, 5, v129
    v_mad_u32_u24 v133, v128, v131, v132
    v_mad_u32_u24 v136, v128, 0, v133
    v_mad_u32_u24 v137, v128, 1, v133
    v_mad_u32_u24 v138, v128, 2, v133
    v_mad_u32_u24 v139, v128, 3, v133
    v_mad_u32_u24 v140, v128, 4, v133
    v_mad_u32_u24 v141, v128, 5, v133
    v_mad_u32_u24 v142, v128, 6, v133
    v_mad_u32_u24 v143, v128, 7, v133
    v_and_b32 v136, 127, v136
    v_and_b32 v137, 127, v137
    v_and_b32 v138, 127, v138
    v_and_b32 v139, 127, v139
    v_and_b32 v140, 127, v140
    v_and_b32 v141, 127, v141
    v_and_b32 v142, 127, v142
    v_and_b32 v143, 127, v143
    v_cvt_f32_u32 v136, v136
    v_cvt_f32_u32 v137, v137
    v_cvt_f32_u32 v138, v138
    v_cvt_f32_u32 v139, v139
    v_cvt_f32_u32 v140, v140
    v_cvt_f32_u32 v141, v141
    v_cvt_f32_u32 v142, v142
    v_cvt_f32_u32 v143, v143
    v_mul_f32 v136, 0x3c000000, v136
    v_mul_f32 v137, 0x3c000000, v137
    v_mul_f32 v138, 0x3c000000, v138
    v_mul_f32 v139, 0x3c000000, v139
    v_mul_f32 v140, 0x3c000000, v140
    v_mul_f32 v141, 0x3c000000, v141
    v_mul_f32 v142, 0x3c000000, v142
    v_mul_f32 v143, 0x3c000000, v143
    v_cos_f32 v136, v136
    v_cos_f32 v137, v137
    v_cos_f32 v138, v138
    v_cos_f32 v139, v139
    v_cos_f32 v140, v140
    v_cos_f32 v141, v141
    v_cos_f32 v142, v142
    v_cos_f32 v143, v143
    s_nop 0
    v_cvt_pk_bf16_f32 v144, v136, v137
    v_cvt_pk_bf16_f32 v145, v138, v139
    v_cvt_pk_bf16_f32 v146, v140, v141
    v_cvt_pk_bf16_f32 v147, v142, v143
    v_lshlrev_b32 v152, 16, v144
    v_and_b32 v153, 0xffff0000, v144
    v_sub_f32 v136, v136, v152
    v_sub_f32 v137, v137, v153
    v_lshlrev_b32 v152, 16, v145
    v_and_b32 v153, 0xffff0000, v145
    v_sub_f32 v138, v138, v152
    v_sub_f32 v139, v139, v153
    v_lshlrev_b32 v152, 16, v146
    v_and_b32 v153, 0xffff0000, v146
    v_sub_f32 v140, v140, v152
    v_sub_f32 v141, v141, v153
    v_lshlrev_b32 v152, 16, v147
    v_and_b32 v153, 0xffff0000, v147
    v_sub_f32 v142, v142, v152
    v_sub_f32 v143, v143, v153
    v_cvt_pk_bf16_f32 v148, v136, v137
    v_cvt_pk_bf16_f32 v149, v138, v139
    v_cvt_pk_bf16_f32 v150, v140, v141
    v_cvt_pk_bf16_f32 v151, v142, v143
    s_lshl_b32 s37, s44, 12
    s_add_u32 s37, s37, 118784
    v_add_u32 v132, s37, v254
    ds_write_b128 v132, v[144:147]
    ds_write_b128 v132, v[148:151] offset:1024
K12_TB:
    s_waitcnt lgkmcnt(0)
    s_barrier
    v_add_u32 v255, 116736, v254
    ds_read_b128 v[160:163], v255 offset:0
    ds_read_b128 v[192:195], v255 offset:1024
    ds_read_b128 v[164:167], v255 offset:2048
    ds_read_b128 v[196:199], v255 offset:3072
    ds_read_b128 v[168:171], v255 offset:4096
    ds_read_b128 v[200:203], v255 offset:5120
    ds_read_b128 v[172:175], v255 offset:6144
    ds_read_b128 v[204:207], v255 offset:7168
    s_waitcnt lgkmcnt(0)
    ds_read_b128 v[176:179], v255 offset:8192
    ds_read_b128 v[208:211], v255 offset:9216
    ds_read_b128 v[180:183], v255 offset:10240
    ds_read_b128 v[212:215], v255 offset:11264
    ds_read_b128 v[184:187], v255 offset:12288
    ds_read_b128 v[216:219], v255 offset:13312
    ds_read_b128 v[188:191], v255 offset:14336
    ds_read_b128 v[220:223], v255 offset:15360
    ds_read_b128 v[224:227], v255 offset:16384
    ds_read_b128 v[228:231], v255 offset:17408
    ds_read_b128 v[232:235], v255 offset:18432
    ds_read_b128 v[236:239], v255 offset:19456
    s_waitcnt lgkmcnt(0)
    s_barrier
    s_waitcnt vmcnt(0) lgkmcnt(0)
    s_mov_b32 s41, -1
    s_mov_b32 s34, -1
    s_branch K12_PROD
    s_cmp_lt_u32 s3, 4
    s_cbranch_scc0 K12_PROD
    s_cmp_eq_u32 s43, 0
    s_cbranch_scc0 K12_H1
    v_perm_b32 v64, v100, v96, s28
    v_perm_b32 v68, v100, v96, s29
    v_perm_b32 v65, v108, v104, s28
    v_perm_b32 v69, v108, v104, s29
    v_perm_b32 v66, v116, v112, s28
    v_perm_b32 v70, v116, v112, s29
    v_perm_b32 v67, v124, v120, s28
    v_perm_b32 v71, v124, v120, s29
    v_perm_b32 v72, v101, v97, s28
    v_perm_b32 v76, v101, v97, s29
    v_perm_b32 v73, v109, v105, s28
    v_perm_b32 v77, v109, v105, s29
    v_perm_b32 v74, v117, v113, s28
    v_perm_b32 v78, v117, v113, s29
    v_perm_b32 v75, v125, v121, s28
    v_perm_b32 v79, v125, v121, s29
    v_perm_b32 v80, v102, v98, s28
    v_perm_b32 v84, v102, v98, s29
    v_perm_b32 v81, v110, v106, s28
    v_perm_b32 v85, v110, v106, s29
    v_perm_b32 v82, v118, v114, s28
    v_perm_b32 v86, v118, v114, s29
    v_perm_b32 v83, v126, v122, s28
    v_perm_b32 v87, v126, v122, s29
    v_perm_b32 v88, v103, v99, s28
    v_perm_b32 v92, v103, v99, s29
    v_perm_b32 v89, v111, v107, s28
    v_perm_b32 v93, v111, v107, s29
    v_perm_b32 v90, v119, v115, s28
    v_perm_b32 v94, v119, v115, s29
    v_perm_b32 v91, v127, v123, s28
    v_perm_b32 v95, v127, v123, s29
    s_lshl_b32 s36, s40, 7
    s_add_u32 s36, s36, s22
    s_and_b32 s37, s36, 3
    s_lshr_b32 s38, s36, 1
    s_and_b32 s38, s38, 4
    s_or_b32 s37, s37, s38
    v_bfe_u32 v253, v254, 5, 3
    v_xor_b32 v253, s37, v253
    v_lshl_add_u32 v253, v253, 5, v251
    s_lshl_b32 s36, s36, 9
    s_add_u32 s39, s36, s32
    v_mfma_f32_16x16x32_bf16 v[128:131], v[224:227], v[64:67], 0
    v_mfma_f32_16x16x32_bf16 v[132:135], v[224:227], v[68:71], 0
    v_mfma_f32_16x16x32_bf16 v[136:139], v[224:227], v[72:75], 0
    v_mfma_f32_16x16x32_bf16 v[140:143], v[224:227], v[76:79], 0
    v_mfma_f32_16x16x32_bf16 v[144:147], v[224:227], v[80:83], 0
    v_mfma_f32_16x16x32_bf16 v[148:151], v[224:227], v[84:87], 0
    v_mfma_f32_16x16x32_bf16 v[152:155], v[224:227], v[88:91], 0
    v_mfma_f32_16x16x32_bf16 v[156:159], v[224:227], v[92:95], 0
    s_nop 7
    v_cvt_pk_bf16_f32 v240, v128, v132
    v_cvt_pk_bf16_f32 v241, v136, v140
    v_cvt_pk_bf16_f32 v242, v144, v148
    v_cvt_pk_bf16_f32 v243, v152, v156
    buffer_store_dwordx4 v[240:243], v253, s[16:19], s39 offen sc1
    s_add_u32 s39, s39, 4194304
    v_cvt_pk_bf16_f32 v244, v129, v133
    v_cvt_pk_bf16_f32 v245, v137, v141
    v_cvt_pk_bf16_f32 v246, v145, v149
    v_cvt_pk_bf16_f32 v247, v153, v157
    buffer_store_dwordx4 v[244:247], v253, s[16:19], s39 offen sc1
    s_add_u32 s39, s39, 4194304
    v_cvt_pk_bf16_f32 v240, v130, v134
    v_cvt_pk_bf16_f32 v241, v138, v142
    v_cvt_pk_bf16_f32 v242, v146, v150
    v_cvt_pk_bf16_f32 v243, v154, v158
    buffer_store_dwordx4 v[240:243], v253, s[16:19], s39 offen sc1
    s_add_u32 s39, s39, 4194304
    v_cvt_pk_bf16_f32 v244, v131, v135
    v_cvt_pk_bf16_f32 v245, v139, v143
    v_cvt_pk_bf16_f32 v246, v147, v151
    v_cvt_pk_bf16_f32 v247, v155, v159
    buffer_store_dwordx4 v[244:247], v253, s[16:19], s39 offen sc1
    s_add_u32 s39, s39, 4194304
    v_mfma_f32_16x16x32_bf16 v[128:131], v[228:231], v[64:67], 0
    v_mfma_f32_16x16x32_bf16 v[132:135], v[228:231], v[68:71], 0
    v_mfma_f32_16x16x32_bf16 v[136:139], v[228:231], v[72:75], 0
    v_mfma_f32_16x16x32_bf16 v[140:143], v[228:231], v[76:79], 0
    v_mfma_f32_16x16x32_bf16 v[144:147], v[228:231], v[80:83], 0
    v_mfma_f32_16x16x32_bf16 v[148:151], v[228:231], v[84:87], 0
    v_mfma_f32_16x16x32_bf16 v[152:155], v[228:231], v[88:91], 0
    v_mfma_f32_16x16x32_bf16 v[156:159], v[228:231], v[92:95], 0
    s_nop 7
    v_cvt_pk_bf16_f32 v240, v128, v132
    v_cvt_pk_bf16_f32 v241, v136, v140
    v_cvt_pk_bf16_f32 v242, v144, v148
    v_cvt_pk_bf16_f32 v243, v152, v156
    buffer_store_dwordx4 v[240:243], v253, s[16:19], s39 offen sc1
    s_add_u32 s39, s39, 4194304
    v_cvt_pk_bf16_f32 v244, v129, v133
    v_cvt_pk_bf16_f32 v245, v137, v141
    v_cvt_pk_bf16_f32 v246, v145, v149
    v_cvt_pk_bf16_f32 v247, v153, v157
    buffer_store_dwordx4 v[244:247], v253, s[16:19], s39 offen sc1
    s_add_u32 s39, s39, 4194304
    v_cvt_pk_bf16_f32 v240, v130, v134
    v_cvt_pk_bf16_f32 v241, v138, v142
    v_cvt_pk_bf16_f32 v242, v146, v150
    v_cvt_pk_bf16_f32 v243, v154, v158
    buffer_store_dwordx4 v[240:243], v253, s[16:19], s39 offen sc1
    s_add_u32 s39, s39, 4194304
    v_cvt_pk_bf16_f32 v244, v131, v135
    v_cvt_pk_bf16_f32 v245, v139, v143
    v_cvt_pk_bf16_f32 v246, v147, v151
    v_cvt_pk_bf16_f32 v247, v155, v159
    buffer_store_dwordx4 v[244:247], v253, s[16:19], s39 offen sc1
    s_add_u32 s39, s39, 4194304
    v_mfma_f32_16x16x32_bf16 v[128:131], v[232:235], v[64:67], 0
    v_mfma_f32_16x16x32_bf16 v[132:135], v[232:235], v[68:71], 0
    v_mfma_f32_16x16x32_bf16 v[136:139], v[232:235], v[72:75], 0
    v_mfma_f32_16x16x32_bf16 v[140:143], v[232:235], v[76:79], 0
    v_mfma_f32_16x16x32_bf16 v[144:147], v[232:235], v[80:83], 0
    v_mfma_f32_16x16x32_bf16 v[148:151], v[232:235], v[84:87], 0
    v_mfma_f32_16x16x32_bf16 v[152:155], v[232:235], v[88:91], 0
    v_mfma_f32_16x16x32_bf16 v[156:159], v[232:235], v[92:95], 0
    s_nop 7
    v_cvt_pk_bf16_f32 v240, v128, v132
    v_cvt_pk_bf16_f32 v241, v136, v140
    v_cvt_pk_bf16_f32 v242, v144, v148
    v_cvt_pk_bf16_f32 v243, v152, v156
    buffer_store_dwordx4 v[240:243], v253, s[16:19], s39 offen sc1
    s_add_u32 s39, s39, 4194304
    v_cvt_pk_bf16_f32 v244, v129, v133
    v_cvt_pk_bf16_f32 v245, v137, v141
    v_cvt_pk_bf16_f32 v246, v145, v149
    v_cvt_pk_bf16_f32 v247, v153, v157
    buffer_store_dwordx4 v[244:247], v253, s[16:19], s39 offen sc1
    s_add_u32 s39, s39, 4194304
    v_cvt_pk_bf16_f32 v240, v130, v134
    v_cvt_pk_bf16_f32 v241, v138, v142
    v_cvt_pk_bf16_f32 v242, v146, v150
    v_cvt_pk_bf16_f32 v243, v154, v158
    buffer_store_dwordx4 v[240:243], v253, s[16:19], s39 offen sc1
    s_add_u32 s39, s39, 4194304
    v_cvt_pk_bf16_f32 v244, v131, v135
    v_cvt_pk_bf16_f32 v245, v139, v143
    v_cvt_pk_bf16_f32 v246, v147, v151
    v_cvt_pk_bf16_f32 v247, v155, v159
    buffer_store_dwordx4 v[244:247], v253, s[16:19], s39 offen sc1
    s_add_u32 s39, s39, 4194304
    v_mfma_f32_16x16x32_bf16 v[128:131], v[236:239], v[64:67], 0
    v_mfma_f32_16x16x32_bf16 v[132:135], v[236:239], v[68:71], 0
    v_mfma_f32_16x16x32_bf16 v[136:139], v[236:239], v[72:75], 0
    v_mfma_f32_16x16x32_bf16 v[140:143], v[236:239], v[76:79], 0
    v_mfma_f32_16x16x32_bf16 v[144:147], v[236:239], v[80:83], 0
    v_mfma_f32_16x16x32_bf16 v[148:151], v[236:239], v[84:87], 0
    v_mfma_f32_16x16x32_bf16 v[152:155], v[236:239], v[88:91], 0
    v_mfma_f32_16x16x32_bf16 v[156:159], v[236:239], v[92:95], 0
    s_nop 7
    v_cvt_pk_bf16_f32 v240, v128, v132
    v_cvt_pk_bf16_f32 v241, v136, v140
    v_cvt_pk_bf16_f32 v242, v144, v148
    v_cvt_pk_bf16_f32 v243, v152, v156
    buffer_store_dwordx4 v[240:243], v253, s[16:19], s39 offen sc1
    s_add_u32 s39, s39, 4194304
    v_cvt_pk_bf16_f32 v244, v129, v133
    v_cvt_pk_bf16_f32 v245, v137, v141
    v_cvt_pk_bf16_f32 v246, v145, v149
    v_cvt_pk_bf16_f32 v247, v153, v157
    buffer_store_dwordx4 v[244:247], v253, s[16:19], s39 offen sc1
    s_add_u32 s39, s39, 4194304
    v_cvt_pk_bf16_f32 v240, v130, v134
    v_cvt_pk_bf16_f32 v241, v138, v142
    v_cvt_pk_bf16_f32 v242, v146, v150
    v_cvt_pk_bf16_f32 v243, v154, v158
    buffer_store_dwordx4 v[240:243], v253, s[16:19], s39 offen sc1
    s_add_u32 s39, s39, 4194304
    v_cvt_pk_bf16_f32 v244, v131, v135
    v_cvt_pk_bf16_f32 v245, v139, v143
    v_cvt_pk_bf16_f32 v246, v147, v151
    v_cvt_pk_bf16_f32 v247, v155, v159
    buffer_store_dwordx4 v[244:247], v253, s[16:19], s39 offen sc1
    s_branch K12_H2
K12_H1:
    s_cmp_eq_u32 s27, 0
    s_cbranch_scc1 K12_H2
    v_perm_b32 v64, v4, v0, s28
    v_perm_b32 v68, v4, v0, s29
    v_perm_b32 v65, v12, v8, s28
    v_perm_b32 v69, v12, v8, s29
    v_perm_b32 v66, v20, v16, s28
    v_perm_b32 v70, v20, v16, s29
    v_perm_b32 v67, v28, v24, s28
    v_perm_b32 v71, v28, v24, s29
    v_perm_b32 v72, v5, v1, s28
    v_perm_b32 v76, v5, v1, s29
    v_perm_b32 v73, v13, v9, s28
    v_perm_b32 v77, v13, v9, s29
    v_perm_b32 v74, v21, v17, s28
    v_perm_b32 v78, v21, v17, s29
    v_perm_b32 v75, v29, v25, s28
    v_perm_b32 v79, v29, v25, s29
    v_perm_b32 v80, v6, v2, s28
    v_perm_b32 v84, v6, v2, s29
    v_perm_b32 v81, v14, v10, s28
    v_perm_b32 v85, v14, v10, s29
    v_perm_b32 v82, v22, v18, s28
    v_perm_b32 v86, v22, v18, s29
    v_perm_b32 v83, v30, v26, s28
    v_perm_b32 v87, v30, v26, s29
    v_perm_b32 v88, v7, v3, s28
    v_perm_b32 v92, v7, v3, s29
    v_perm_b32 v89, v15, v11, s28
    v_perm_b32 v93, v15, v11, s29
    v_perm_b32 v90, v23, v19, s28
    v_perm_b32 v94, v23, v19, s29
    v_perm_b32 v91, v31, v27, s28
    v_perm_b32 v95, v31, v27, s29
    v_perm_b32 v0, v36, v32, s28
    v_perm_b32 v4, v36, v32, s29
    v_perm_b32 v1, v44, v40, s28
    v_perm_b32 v5, v44, v40, s29
    v_perm_b32 v2, v52, v48, s28
    v_perm_b32 v6, v52, v48, s29
    v_perm_b32 v3, v60, v56, s28
    v_perm_b32 v7, v60, v56, s29
    v_perm_b32 v8, v37, v33, s28
    v_perm_b32 v12, v37, v33, s29
    v_perm_b32 v9, v45, v41, s28
    v_perm_b32 v13, v45, v41, s29
    v_perm_b32 v10, v53, v49, s28
    v_perm_b32 v14, v53, v49, s29
    v_perm_b32 v11, v61, v57, s28
    v_perm_b32 v15, v61, v57, s29
    v_perm_b32 v16, v38, v34, s28
    v_perm_b32 v20, v38, v34, s29
    v_perm_b32 v17, v46, v42, s28
    v_perm_b32 v21, v46, v42, s29
    v_perm_b32 v18, v54, v50, s28
    v_perm_b32 v22, v54, v50, s29
    v_perm_b32 v19, v62, v58, s28
    v_perm_b32 v23, v62, v58, s29
    v_perm_b32 v24, v39, v35, s28
    v_perm_b32 v28, v39, v35, s29
    v_perm_b32 v25, v47, v43, s28
    v_perm_b32 v29, v47, v43, s29
    v_perm_b32 v26, v55, v51, s28
    v_perm_b32 v30, v55, v51, s29
    v_perm_b32 v27, v63, v59, s28
    v_perm_b32 v31, v63, v59, s29
    s_mul_i32 s39, s40, 85504
    s_add_u32 s39, s39, s31
    s_lshl_b32 s36, s30, 7
    s_add_u32 s39, s39, s36
    v_bfe_u32 v249, v254, 4, 2
    v_bfe_u32 v240, v254, 8, 1
    v_lshl_add_u32 v249, v240, 2, v249
    s_lshr_b32 s36, s30, 1
    s_and_b32 s36, s36, 7
    v_xor_b32 v249, s36, v249
    v_lshl_add_u32 v249, v249, 4, v252
    v_mfma_f32_16x16x32_bf16 v[32:35], v[160:163], v[64:67], 0
    v_mfma_f32_16x16x32_bf16 v[36:39], v[160:163], v[68:71], 0
    v_mfma_f32_16x16x32_bf16 v[40:43], v[160:163], v[72:75], 0
    v_mfma_f32_16x16x32_bf16 v[44:47], v[160:163], v[76:79], 0
    v_mfma_f32_16x16x32_bf16 v[48:51], v[160:163], v[80:83], 0
    v_mfma_f32_16x16x32_bf16 v[52:55], v[160:163], v[84:87], 0
    v_mfma_f32_16x16x32_bf16 v[56:59], v[160:163], v[88:91], 0
    v_mfma_f32_16x16x32_bf16 v[60:63], v[160:163], v[92:95], 0
    v_mfma_f32_16x16x32_bf16 v[32:35], v[192:195], v[64:67], v[32:35]
    v_mfma_f32_16x16x32_bf16 v[36:39], v[192:195], v[68:71], v[36:39]
    v_mfma_f32_16x16x32_bf16 v[40:43], v[192:195], v[72:75], v[40:43]
    v_mfma_f32_16x16x32_bf16 v[44:47], v[192:195], v[76:79], v[44:47]
    v_mfma_f32_16x16x32_bf16 v[48:51], v[192:195], v[80:83], v[48:51]
    v_mfma_f32_16x16x32_bf16 v[52:55], v[192:195], v[84:87], v[52:55]
    v_mfma_f32_16x16x32_bf16 v[56:59], v[192:195], v[88:91], v[56:59]
    v_mfma_f32_16x16x32_bf16 v[60:63], v[192:195], v[92:95], v[60:63]
    v_mfma_f32_16x16x32_bf16 v[32:35], v[164:167], v[0:3], v[32:35]
    v_mfma_f32_16x16x32_bf16 v[36:39], v[164:167], v[4:7], v[36:39]
    v_mfma_f32_16x16x32_bf16 v[40:43], v[164:167], v[8:11], v[40:43]
    v_mfma_f32_16x16x32_bf16 v[44:47], v[164:167], v[12:15], v[44:47]
    v_mfma_f32_16x16x32_bf16 v[48:51], v[164:167], v[16:19], v[48:51]
    v_mfma_f32_16x16x32_bf16 v[52:55], v[164:167], v[20:23], v[52:55]
    v_mfma_f32_16x16x32_bf16 v[56:59], v[164:167], v[24:27], v[56:59]
    v_mfma_f32_16x16x32_bf16 v[60:63], v[164:167], v[28:31], v[60:63]
    v_mfma_f32_16x16x32_bf16 v[32:35], v[196:199], v[0:3], v[32:35]
    v_mfma_f32_16x16x32_bf16 v[36:39], v[196:199], v[4:7], v[36:39]
    v_mfma_f32_16x16x32_bf16 v[40:43], v[196:199], v[8:11], v[40:43]
    v_mfma_f32_16x16x32_bf16 v[44:47], v[196:199], v[12:15], v[44:47]
    v_mfma_f32_16x16x32_bf16 v[48:51], v[196:199], v[16:19], v[48:51]
    v_mfma_f32_16x16x32_bf16 v[52:55], v[196:199], v[20:23], v[52:55]
    v_mfma_f32_16x16x32_bf16 v[56:59], v[196:199], v[24:27], v[56:59]
    v_mfma_f32_16x16x32_bf16 v[60:63], v[196:199], v[28:31], v[60:63]
    s_nop 7
    v_cvt_pk_bf16_f32 v240, v32, v36
    v_cvt_pk_bf16_f32 v241, v40, v44
    v_cvt_pk_bf16_f32 v242, v48, v52
    v_cvt_pk_bf16_f32 v243, v56, v60
    buffer_store_dwordx4 v[240:243], v249, s[12:15], s39 offen sc1
    s_add_u32 s39, s39, 2736128
    v_cvt_pk_bf16_f32 v244, v33, v37
    v_cvt_pk_bf16_f32 v245, v41, v45
    v_cvt_pk_bf16_f32 v246, v49, v53
    v_cvt_pk_bf16_f32 v247, v57, v61
    buffer_store_dwordx4 v[244:247], v249, s[12:15], s39 offen sc1
    s_add_u32 s39, s39, 2736128
    v_cvt_pk_bf16_f32 v240, v34, v38
    v_cvt_pk_bf16_f32 v241, v42, v46
    v_cvt_pk_bf16_f32 v242, v50, v54
    v_cvt_pk_bf16_f32 v243, v58, v62
    buffer_store_dwordx4 v[240:243], v249, s[12:15], s39 offen sc1
    s_add_u32 s39, s39, 2736128
    v_cvt_pk_bf16_f32 v244, v35, v39
    v_cvt_pk_bf16_f32 v245, v43, v47
    v_cvt_pk_bf16_f32 v246, v51, v55
    v_cvt_pk_bf16_f32 v247, v59, v63
    buffer_store_dwordx4 v[244:247], v249, s[12:15], s39 offen sc1
    s_add_u32 s39, s39, 2736128
    v_mfma_f32_16x16x32_bf16 v[32:35], v[168:171], v[64:67], 0
    v_mfma_f32_16x16x32_bf16 v[36:39], v[168:171], v[68:71], 0
    v_mfma_f32_16x16x32_bf16 v[40:43], v[168:171], v[72:75], 0
    v_mfma_f32_16x16x32_bf16 v[44:47], v[168:171], v[76:79], 0
    v_mfma_f32_16x16x32_bf16 v[48:51], v[168:171], v[80:83], 0
    v_mfma_f32_16x16x32_bf16 v[52:55], v[168:171], v[84:87], 0
    v_mfma_f32_16x16x32_bf16 v[56:59], v[168:171], v[88:91], 0
    v_mfma_f32_16x16x32_bf16 v[60:63], v[168:171], v[92:95], 0
    v_mfma_f32_16x16x32_bf16 v[32:35], v[200:203], v[64:67], v[32:35]
    v_mfma_f32_16x16x32_bf16 v[36:39], v[200:203], v[68:71], v[36:39]
    v_mfma_f32_16x16x32_bf16 v[40:43], v[200:203], v[72:75], v[40:43]
    v_mfma_f32_16x16x32_bf16 v[44:47], v[200:203], v[76:79], v[44:47]
    v_mfma_f32_16x16x32_bf16 v[48:51], v[200:203], v[80:83], v[48:51]
    v_mfma_f32_16x16x32_bf16 v[52:55], v[200:203], v[84:87], v[52:55]
    v_mfma_f32_16x16x32_bf16 v[56:59], v[200:203], v[88:91], v[56:59]
    v_mfma_f32_16x16x32_bf16 v[60:63], v[200:203], v[92:95], v[60:63]
    v_mfma_f32_16x16x32_bf16 v[32:35], v[172:175], v[0:3], v[32:35]
    v_mfma_f32_16x16x32_bf16 v[36:39], v[172:175], v[4:7], v[36:39]
    v_mfma_f32_16x16x32_bf16 v[40:43], v[172:175], v[8:11], v[40:43]
    v_mfma_f32_16x16x32_bf16 v[44:47], v[172:175], v[12:15], v[44:47]
    v_mfma_f32_16x16x32_bf16 v[48:51], v[172:175], v[16:19], v[48:51]
    v_mfma_f32_16x16x32_bf16 v[52:55], v[172:175], v[20:23], v[52:55]
    v_mfma_f32_16x16x32_bf16 v[56:59], v[172:175], v[24:27], v[56:59]
    v_mfma_f32_16x16x32_bf16 v[60:63], v[172:175], v[28:31], v[60:63]
    v_mfma_f32_16x16x32_bf16 v[32:35], v[204:207], v[0:3], v[32:35]
    v_mfma_f32_16x16x32_bf16 v[36:39], v[204:207], v[4:7], v[36:39]
    v_mfma_f32_16x16x32_bf16 v[40:43], v[204:207], v[8:11], v[40:43]
    v_mfma_f32_16x16x32_bf16 v[44:47], v[204:207], v[12:15], v[44:47]
    v_mfma_f32_16x16x32_bf16 v[48:51], v[204:207], v[16:19], v[48:51]
    v_mfma_f32_16x16x32_bf16 v[52:55], v[204:207], v[20:23], v[52:55]
    v_mfma_f32_16x16x32_bf16 v[56:59], v[204:207], v[24:27], v[56:59]
    v_mfma_f32_16x16x32_bf16 v[60:63], v[204:207], v[28:31], v[60:63]
    s_nop 7
    v_cvt_pk_bf16_f32 v240, v32, v36
    v_cvt_pk_bf16_f32 v241, v40, v44
    v_cvt_pk_bf16_f32 v242, v48, v52
    v_cvt_pk_bf16_f32 v243, v56, v60
    buffer_store_dwordx4 v[240:243], v249, s[12:15], s39 offen sc1
    s_add_u32 s39, s39, 2736128
    v_cvt_pk_bf16_f32 v244, v33, v37
    v_cvt_pk_bf16_f32 v245, v41, v45
    v_cvt_pk_bf16_f32 v246, v49, v53
    v_cvt_pk_bf16_f32 v247, v57, v61
    buffer_store_dwordx4 v[244:247], v249, s[12:15], s39 offen sc1
    s_add_u32 s39, s39, 2736128
    v_cvt_pk_bf16_f32 v240, v34, v38
    v_cvt_pk_bf16_f32 v241, v42, v46
    v_cvt_pk_bf16_f32 v242, v50, v54
    v_cvt_pk_bf16_f32 v243, v58, v62
    buffer_store_dwordx4 v[240:243], v249, s[12:15], s39 offen sc1
    s_add_u32 s39, s39, 2736128
    v_cvt_pk_bf16_f32 v244, v35, v39
    v_cvt_pk_bf16_f32 v245, v43, v47
    v_cvt_pk_bf16_f32 v246, v51, v55
    v_cvt_pk_bf16_f32 v247, v59, v63
    buffer_store_dwordx4 v[244:247], v249, s[12:15], s39 offen sc1
    s_add_u32 s39, s39, 2736128
    v_mfma_f32_16x16x32_bf16 v[32:35], v[176:179], v[64:67], 0
    v_mfma_f32_16x16x32_bf16 v[36:39], v[176:179], v[68:71], 0
    v_mfma_f32_16x16x32_bf16 v[40:43], v[176:179], v[72:75], 0
    v_mfma_f32_16x16x32_bf16 v[44:47], v[176:179], v[76:79], 0
    v_mfma_f32_16x16x32_bf16 v[48:51], v[176:179], v[80:83], 0
    v_mfma_f32_16x16x32_bf16 v[52:55], v[176:179], v[84:87], 0
    v_mfma_f32_16x16x32_bf16 v[56:59], v[176:179], v[88:91], 0
    v_mfma_f32_16x16x32_bf16 v[60:63], v[176:179], v[92:95], 0
    v_mfma_f32_16x16x32_bf16 v[32:35], v[208:211], v[64:67], v[32:35]
    v_mfma_f32_16x16x32_bf16 v[36:39], v[208:211], v[68:71], v[36:39]
    v_mfma_f32_16x16x32_bf16 v[40:43], v[208:211], v[72:75], v[40:43]
    v_mfma_f32_16x16x32_bf16 v[44:47], v[208:211], v[76:79], v[44:47]
    v_mfma_f32_16x16x32_bf16 v[48:51], v[208:211], v[80:83], v[48:51]
    v_mfma_f32_16x16x32_bf16 v[52:55], v[208:211], v[84:87], v[52:55]
    v_mfma_f32_16x16x32_bf16 v[56:59], v[208:211], v[88:91], v[56:59]
    v_mfma_f32_16x16x32_bf16 v[60:63], v[208:211], v[92:95], v[60:63]
    v_mfma_f32_16x16x32_bf16 v[32:35], v[180:183], v[0:3], v[32:35]
    v_mfma_f32_16x16x32_bf16 v[36:39], v[180:183], v[4:7], v[36:39]
    v_mfma_f32_16x16x32_bf16 v[40:43], v[180:183], v[8:11], v[40:43]
    v_mfma_f32_16x16x32_bf16 v[44:47], v[180:183], v[12:15], v[44:47]
    v_mfma_f32_16x16x32_bf16 v[48:51], v[180:183], v[16:19], v[48:51]
    v_mfma_f32_16x16x32_bf16 v[52:55], v[180:183], v[20:23], v[52:55]
    v_mfma_f32_16x16x32_bf16 v[56:59], v[180:183], v[24:27], v[56:59]
    v_mfma_f32_16x16x32_bf16 v[60:63], v[180:183], v[28:31], v[60:63]
    v_mfma_f32_16x16x32_bf16 v[32:35], v[212:215], v[0:3], v[32:35]
    v_mfma_f32_16x16x32_bf16 v[36:39], v[212:215], v[4:7], v[36:39]
    v_mfma_f32_16x16x32_bf16 v[40:43], v[212:215], v[8:11], v[40:43]
    v_mfma_f32_16x16x32_bf16 v[44:47], v[212:215], v[12:15], v[44:47]
    v_mfma_f32_16x16x32_bf16 v[48:51], v[212:215], v[16:19], v[48:51]
    v_mfma_f32_16x16x32_bf16 v[52:55], v[212:215], v[20:23], v[52:55]
    v_mfma_f32_16x16x32_bf16 v[56:59], v[212:215], v[24:27], v[56:59]
    v_mfma_f32_16x16x32_bf16 v[60:63], v[212:215], v[28:31], v[60:63]
    s_nop 7
    v_cvt_pk_bf16_f32 v240, v32, v36
    v_cvt_pk_bf16_f32 v241, v40, v44
    v_cvt_pk_bf16_f32 v242, v48, v52
    v_cvt_pk_bf16_f32 v243, v56, v60
    buffer_store_dwordx4 v[240:243], v249, s[12:15], s39 offen sc1
    s_add_u32 s39, s39, 2736128
    v_cvt_pk_bf16_f32 v244, v33, v37
    v_cvt_pk_bf16_f32 v245, v41, v45
    v_cvt_pk_bf16_f32 v246, v49, v53
    v_cvt_pk_bf16_f32 v247, v57, v61
    buffer_store_dwordx4 v[244:247], v249, s[12:15], s39 offen sc1
    s_add_u32 s39, s39, 2736128
    v_cvt_pk_bf16_f32 v240, v34, v38
    v_cvt_pk_bf16_f32 v241, v42, v46
    v_cvt_pk_bf16_f32 v242, v50, v54
    v_cvt_pk_bf16_f32 v243, v58, v62
    buffer_store_dwordx4 v[240:243], v249, s[12:15], s39 offen sc1
    s_add_u32 s39, s39, 2736128
    v_cvt_pk_bf16_f32 v244, v35, v39
    v_cvt_pk_bf16_f32 v245, v43, v47
    v_cvt_pk_bf16_f32 v246, v51, v55
    v_cvt_pk_bf16_f32 v247, v59, v63
    buffer_store_dwordx4 v[244:247], v249, s[12:15], s39 offen sc1
    s_add_u32 s39, s39, 2736128
    v_mfma_f32_16x16x32_bf16 v[32:35], v[184:187], v[64:67], 0
    v_mfma_f32_16x16x32_bf16 v[36:39], v[184:187], v[68:71], 0
    v_mfma_f32_16x16x32_bf16 v[40:43], v[184:187], v[72:75], 0
    v_mfma_f32_16x16x32_bf16 v[44:47], v[184:187], v[76:79], 0
    v_mfma_f32_16x16x32_bf16 v[48:51], v[184:187], v[80:83], 0
    v_mfma_f32_16x16x32_bf16 v[52:55], v[184:187], v[84:87], 0
    v_mfma_f32_16x16x32_bf16 v[56:59], v[184:187], v[88:91], 0
    v_mfma_f32_16x16x32_bf16 v[60:63], v[184:187], v[92:95], 0
    v_mfma_f32_16x16x32_bf16 v[32:35], v[216:219], v[64:67], v[32:35]
    v_mfma_f32_16x16x32_bf16 v[36:39], v[216:219], v[68:71], v[36:39]
    v_mfma_f32_16x16x32_bf16 v[40:43], v[216:219], v[72:75], v[40:43]
    v_mfma_f32_16x16x32_bf16 v[44:47], v[216:219], v[76:79], v[44:47]
    v_mfma_f32_16x16x32_bf16 v[48:51], v[216:219], v[80:83], v[48:51]
    v_mfma_f32_16x16x32_bf16 v[52:55], v[216:219], v[84:87], v[52:55]
    v_mfma_f32_16x16x32_bf16 v[56:59], v[216:219], v[88:91], v[56:59]
    v_mfma_f32_16x16x32_bf16 v[60:63], v[216:219], v[92:95], v[60:63]
    v_mfma_f32_16x16x32_bf16 v[32:35], v[188:191], v[0:3], v[32:35]
    v_mfma_f32_16x16x32_bf16 v[36:39], v[188:191], v[4:7], v[36:39]
    v_mfma_f32_16x16x32_bf16 v[40:43], v[188:191], v[8:11], v[40:43]
    v_mfma_f32_16x16x32_bf16 v[44:47], v[188:191], v[12:15], v[44:47]
    v_mfma_f32_16x16x32_bf16 v[48:51], v[188:191], v[16:19], v[48:51]
    v_mfma_f32_16x16x32_bf16 v[52:55], v[188:191], v[20:23], v[52:55]
    v_mfma_f32_16x16x32_bf16 v[56:59], v[188:191], v[24:27], v[56:59]
    v_mfma_f32_16x16x32_bf16 v[60:63], v[188:191], v[28:31], v[60:63]
    v_mfma_f32_16x16x32_bf16 v[32:35], v[220:223], v[0:3], v[32:35]
    v_mfma_f32_16x16x32_bf16 v[36:39], v[220:223], v[4:7], v[36:39]
    v_mfma_f32_16x16x32_bf16 v[40:43], v[220:223], v[8:11], v[40:43]
    v_mfma_f32_16x16x32_bf16 v[44:47], v[220:223], v[12:15], v[44:47]
    v_mfma_f32_16x16x32_bf16 v[48:51], v[220:223], v[16:19], v[48:51]
    v_mfma_f32_16x16x32_bf16 v[52:55], v[220:223], v[20:23], v[52:55]
    v_mfma_f32_16x16x32_bf16 v[56:59], v[220:223], v[24:27], v[56:59]
    v_mfma_f32_16x16x32_bf16 v[60:63], v[220:223], v[28:31], v[60:63]
    s_nop 7
    v_cvt_pk_bf16_f32 v240, v32, v36
    v_cvt_pk_bf16_f32 v241, v40, v44
    v_cvt_pk_bf16_f32 v242, v48, v52
    v_cvt_pk_bf16_f32 v243, v56, v60
    buffer_store_dwordx4 v[240:243], v249, s[12:15], s39 offen sc1
    s_add_u32 s39, s39, 2736128
    v_cvt_pk_bf16_f32 v244, v33, v37
    v_cvt_pk_bf16_f32 v245, v41, v45
    v_cvt_pk_bf16_f32 v246, v49, v53
    v_cvt_pk_bf16_f32 v247, v57, v61
    buffer_store_dwordx4 v[244:247], v249, s[12:15], s39 offen sc1
    s_add_u32 s39, s39, 2736128
    v_cvt_pk_bf16_f32 v240, v34, v38
    v_cvt_pk_bf16_f32 v241, v42, v46
    v_cvt_pk_bf16_f32 v242, v50, v54
    v_cvt_pk_bf16_f32 v243, v58, v62
    buffer_store_dwordx4 v[240:243], v249, s[12:15], s39 offen sc1
    s_add_u32 s39, s39, 2736128
    v_cvt_pk_bf16_f32 v244, v35, v39
    v_cvt_pk_bf16_f32 v245, v43, v47
    v_cvt_pk_bf16_f32 v246, v51, v55
    v_cvt_pk_bf16_f32 v247, v59, v63
    buffer_store_dwordx4 v[244:247], v249, s[12:15], s39 offen sc1
K12_H2:
    s_mov_b64 exec, 1
    v_mov_b32 v255, 155664
    v_mov_b32 v64, 1
    ds_add_u32 v255, v64
    s_mov_b64 exec, -1
    s_waitcnt vmcnt(0)
    s_mov_b32 s41, 0
    s_mov_b32 s34, -1
    s_cmp_ge_u32 s41, 8
    s_cbranch_scc1 K12_SG0
    s_lshl_b32 s36, s41, 2
    s_add_u32 s37, s36, 155680
    s_mov_b64 exec, 1
    v_mov_b32 v255, s37
    v_mov_b32 v240, 1
    ds_add_rtn_u32 v240, v255, v240
    s_waitcnt lgkmcnt(0)
    v_readfirstlane_b32 s37, v240
    s_nop 3
    s_cmp_eq_u32 s37, 3
    s_cbranch_scc0 K12_SH0
    v_mov_b32 v255, 1
    v_mov_b32 v240, s36
    buffer_atomic_add v255, v240, s[60:63], 0 offen sc0 sc1
    s_mov_b32 s34, s41
K12_SH0:
    s_mov_b64 exec, -1
K12_SG0:
    s_waitcnt vmcnt(0)
    s_cmp_ge_u32 s34, 8
    s_cbranch_scc1 K12_PB1
    v_readfirstlane_b32 s37, v255
    s_nop 3
    s_cmp_eq_u32 s37, 255
    s_cbranch_scc0 K12_PB1
    s_lshl_b32 s36, s34, 4
    s_add_u32 s36, s36, 128
    s_mov_b64 exec, 1
    v_mov_b32 v255, 1
    v_mov_b32 v240, s36
    buffer_store_dword v255, v240, s[60:63], 0 offen sc1
    s_mov_b64 exec, -1
K12_PB1:
    s_branch K12_CONS
K12_PROD:
    s_setprio 1
    s_cmp_eq_u32 s43, 0
    s_cbranch_scc1 K12_WENTRY
K12_XW:
    s_cmp_eq_u32 s27, 0
    s_cbranch_scc1 K12_XP_N
    v_perm_b32 v64, v4, v0, s28
    v_perm_b32 v68, v4, v0, s29
    v_perm_b32 v65, v12, v8, s28
    v_perm_b32 v69, v12, v8, s29
    v_perm_b32 v66, v20, v16, s28
    v_perm_b32 v70, v20, v16, s29
    v_perm_b32 v67, v28, v24, s28
    v_perm_b32 v71, v28, v24, s29
    v_perm_b32 v72, v5, v1, s28
    v_perm_b32 v76, v5, v1, s29
    v_perm_b32 v73, v13, v9, s28
    v_perm_b32 v77, v13, v9, s29
    v_perm_b32 v74, v21, v17, s28
    v_perm_b32 v78, v21, v17, s29
    v_perm_b32 v75, v29, v25, s28
    v_perm_b32 v79, v29, v25, s29
    v_perm_b32 v80, v6, v2, s28
    v_perm_b32 v84, v6, v2, s29
    v_perm_b32 v81, v14, v10, s28
    v_perm_b32 v85, v14, v10, s29
    v_perm_b32 v82, v22, v18, s28
    v_perm_b32 v86, v22, v18, s29
    v_perm_b32 v83, v30, v26, s28
    v_perm_b32 v87, v30, v26, s29
    v_perm_b32 v88, v7, v3, s28
    v_perm_b32 v92, v7, v3, s29
    v_perm_b32 v89, v15, v11, s28
    v_perm_b32 v93, v15, v11, s29
    v_perm_b32 v90, v23, v19, s28
    v_perm_b32 v94, v23, v19, s29
    v_perm_b32 v91, v31, v27, s28
    v_perm_b32 v95, v31, v27, s29
    v_perm_b32 v0, v36, v32, s28
    v_perm_b32 v4, v36, v32, s29
    v_perm_b32 v1, v44, v40, s28
    v_perm_b32 v5, v44, v40, s29
    v_perm_b32 v2, v52, v48, s28
    v_perm_b32 v6, v52, v48, s29
    v_perm_b32 v3, v60, v56, s28
    v_perm_b32 v7, v60, v56, s29
    v_perm_b32 v8, v37, v33, s28
    v_perm_b32 v12, v37, v33, s29
    v_perm_b32 v9, v45, v41, s28
    v_perm_b32 v13, v45, v41, s29
    v_perm_b32 v10, v53, v49, s28
    v_perm_b32 v14, v53, v49, s29
    v_perm_b32 v11, v61, v57, s28
    v_perm_b32 v15, v61, v57, s29
    v_perm_b32 v16, v38, v34, s28
    v_perm_b32 v20, v38, v34, s29
    v_perm_b32 v17, v46, v42, s28
    v_perm_b32 v21, v46, v42, s29
    v_perm_b32 v18, v54, v50, s28
    v_perm_b32 v22, v54, v50, s29
    v_perm_b32 v19, v62, v58, s28
    v_perm_b32 v23, v62, v58, s29
    v_perm_b32 v24, v39, v35, s28
    v_perm_b32 v28, v39, v35, s29
    v_perm_b32 v25, v47, v43, s28
    v_perm_b32 v29, v47, v43, s29
    v_perm_b32 v26, v55, v51, s28
    v_perm_b32 v30, v55, v51, s29
    v_perm_b32 v27, v63, v59, s28
    v_perm_b32 v31, v63, v59, s29
K12_XP_N:
    s_add_u32 s42, s40, 1
    s_lshl_b32 s36, s42, 7
    s_add_u32 s36, s36, s22
    s_lshr_b32 s37, s36, 9
    s_lshl_b32 s37, s37, 19
    s_and_b32 s36, s36, 511
    s_lshl_b32 s36, s36, 10
    s_add_u32 s36, s36, s37
    s_add_u32 s36, s36, s33
    buffer_load_dwordx4 v[96:99], v250, s[8:11], s36 offen
    s_add_u32 s36, s36, 0x100000
    buffer_load_dwordx4 v[100:103], v250, s[8:11], s36 offen
    s_add_u32 s36, s36, 0x100000
    buffer_load_dwordx4 v[104:107], v250, s[8:11], s36 offen
    s_add_u32 s36, s36, 0x100000
    buffer_load_dwordx4 v[108:111], v250, s[8:11], s36 offen
    s_add_u32 s36, s36, 0x100000
    buffer_load_dwordx4 v[112:115], v250, s[8:11], s36 offen
    s_add_u32 s36, s36, 0x100000
    buffer_load_dwordx4 v[116:119], v250, s[8:11], s36 offen
    s_add_u32 s36, s36, 0x100000
    buffer_load_dwordx4 v[120:123], v250, s[8:11], s36 offen
    s_add_u32 s36, s36, 0x100000
    buffer_load_dwordx4 v[124:127], v250, s[8:11], s36 offen
    s_waitcnt vmcnt(8)
    s_mov_b32 s34, -1
    s_cmp_ge_u32 s41, 8
    s_cbranch_scc1 K12_SG2
    s_lshl_b32 s36, s41, 2
    s_add_u32 s37, s36, 155680
    s_mov_b64 exec, 1
    v_mov_b32 v255, s37
    v_mov_b32 v240, 1
    ds_add_rtn_u32 v240, v255, v240
    s_waitcnt lgkmcnt(0)
    v_readfirstlane_b32 s37, v240
    s_nop 3
    s_cmp_eq_u32 s37, 3
    s_cbranch_scc0 K12_SH2
    v_mov_b32 v255, 1
    v_mov_b32 v240, s36
    buffer_atomic_add v255, v240, s[60:63], 0 offen sc0 sc1
    s_mov_b32 s34, s41
K12_SH2:
    s_mov_b64 exec, -1
K12_SG2:
    s_cmp_ge_u32 s34, 8
    s_cbranch_scc1 K12_EP3
    s_waitcnt vmcnt(0)
    s_cmp_ge_u32 s34, 8
    s_cbranch_scc1 K12_PB4
    v_readfirstlane_b32 s37, v255
    s_nop 3
    s_cmp_eq_u32 s37, 255
    s_cbranch_scc0 K12_PB4
    s_lshl_b32 s36, s34, 4
    s_add_u32 s36, s36, 128
    s_mov_b64 exec, 1
    v_mov_b32 v255, 1
    v_mov_b32 v240, s36
    buffer_store_dword v255, v240, s[60:63], 0 offen sc1
    s_mov_b64 exec, -1
K12_PB4:
    s_mov_b32 s34, -1
K12_EP3:
    s_cmp_eq_u32 s27, 0
    s_cbranch_scc1 K12_XP_E
    s_lshl_b32 s36, s40, 2
    s_sub_i32 s36, s36, 17
    s_max_i32 s36, s36, 1
    s_mov_b32 s38, 155648
    s_cmp_eq_u32 s40, 99
    s_cselect_b32 s36, 4, s36
    s_cselect_b32 s38, 155664, s38
    s_cbranch_scc1 K12_GS0
    s_cmp_lt_u32 s40, 3
    s_cbranch_scc1 K12_GT0
K12_GS0:
    s_mov_b32 s37, 32768
K12_GL0:
    v_mov_b32 v240, s38
    ds_read_b32 v240, v240
    s_waitcnt lgkmcnt(0)
    v_cmp_gt_u32 vcc, s36, v240
    s_sub_u32 s37, s37, 1
    s_cmp_eq_u32 s37, 0
    s_cbranch_scc1 K12_GT0
    s_cbranch_vccz K12_GT0
    s_sleep 2
    s_branch K12_GL0
K12_GT0:
    s_mul_i32 s39, s40, 85504
    s_add_u32 s39, s39, s31
    s_lshl_b32 s36, s30, 7
    s_add_u32 s39, s39, s36
    v_bfe_u32 v249, v254, 4, 2
    v_bfe_u32 v240, v254, 8, 1
    v_lshl_add_u32 v249, v240, 2, v249
    s_lshr_b32 s36, s30, 1
    s_and_b32 s36, s36, 7
    v_xor_b32 v249, s36, v249
    v_lshl_add_u32 v249, v249, 4, v252
    v_mfma_f32_16x16x32_bf16 v[32:35], v[160:163], v[64:67], 0
    v_mfma_f32_16x16x32_bf16 v[36:39], v[160:163], v[68:71], 0
    v_mfma_f32_16x16x32_bf16 v[40:43], v[160:163], v[72:75], 0
    v_mfma_f32_16x16x32_bf16 v[44:47], v[160:163], v[76:79], 0
    v_mfma_f32_16x16x32_bf16 v[48:51], v[160:163], v[80:83], 0
    v_mfma_f32_16x16x32_bf16 v[52:55], v[160:163], v[84:87], 0
    v_mfma_f32_16x16x32_bf16 v[56:59], v[160:163], v[88:91], 0
    v_mfma_f32_16x16x32_bf16 v[60:63], v[160:163], v[92:95], 0
    v_mfma_f32_16x16x32_bf16 v[32:35], v[192:195], v[64:67], v[32:35]
    v_mfma_f32_16x16x32_bf16 v[36:39], v[192:195], v[68:71], v[36:39]
    v_mfma_f32_16x16x32_bf16 v[40:43], v[192:195], v[72:75], v[40:43]
    v_mfma_f32_16x16x32_bf16 v[44:47], v[192:195], v[76:79], v[44:47]
    v_mfma_f32_16x16x32_bf16 v[48:51], v[192:195], v[80:83], v[48:51]
    v_mfma_f32_16x16x32_bf16 v[52:55], v[192:195], v[84:87], v[52:55]
    v_mfma_f32_16x16x32_bf16 v[56:59], v[192:195], v[88:91], v[56:59]
    v_mfma_f32_16x16x32_bf16 v[60:63], v[192:195], v[92:95], v[60:63]
    v_mfma_f32_16x16x32_bf16 v[32:35], v[164:167], v[0:3], v[32:35]
    v_mfma_f32_16x16x32_bf16 v[36:39], v[164:167], v[4:7], v[36:39]
    v_mfma_f32_16x16x32_bf16 v[40:43], v[164:167], v[8:11], v[40:43]
    v_mfma_f32_16x16x32_bf16 v[44:47], v[164:167], v[12:15], v[44:47]
    v_mfma_f32_16x16x32_bf16 v[48:51], v[164:167], v[16:19], v[48:51]
    v_mfma_f32_16x16x32_bf16 v[52:55], v[164:167], v[20:23], v[52:55]
    v_mfma_f32_16x16x32_bf16 v[56:59], v[164:167], v[24:27], v[56:59]
    v_mfma_f32_16x16x32_bf16 v[60:63], v[164:167], v[28:31], v[60:63]
    v_mfma_f32_16x16x32_bf16 v[32:35], v[196:199], v[0:3], v[32:35]
    v_mfma_f32_16x16x32_bf16 v[36:39], v[196:199], v[4:7], v[36:39]
    v_mfma_f32_16x16x32_bf16 v[40:43], v[196:199], v[8:11], v[40:43]
    v_mfma_f32_16x16x32_bf16 v[44:47], v[196:199], v[12:15], v[44:47]
    v_mfma_f32_16x16x32_bf16 v[48:51], v[196:199], v[16:19], v[48:51]
    v_mfma_f32_16x16x32_bf16 v[52:55], v[196:199], v[20:23], v[52:55]
    v_mfma_f32_16x16x32_bf16 v[56:59], v[196:199], v[24:27], v[56:59]
    v_mfma_f32_16x16x32_bf16 v[60:63], v[196:199], v[28:31], v[60:63]
    s_nop 7
    v_cvt_pk_bf16_f32 v240, v32, v36
    v_cvt_pk_bf16_f32 v241, v40, v44
    v_cvt_pk_bf16_f32 v242, v48, v52
    v_cvt_pk_bf16_f32 v243, v56, v60
    buffer_store_dwordx4 v[240:243], v249, s[12:15], s39 offen sc1
    s_add_u32 s39, s39, 2736128
    v_cvt_pk_bf16_f32 v244, v33, v37
    v_cvt_pk_bf16_f32 v245, v41, v45
    v_cvt_pk_bf16_f32 v246, v49, v53
    v_cvt_pk_bf16_f32 v247, v57, v61
    buffer_store_dwordx4 v[244:247], v249, s[12:15], s39 offen sc1
    s_add_u32 s39, s39, 2736128
    v_cvt_pk_bf16_f32 v240, v34, v38
    v_cvt_pk_bf16_f32 v241, v42, v46
    v_cvt_pk_bf16_f32 v242, v50, v54
    v_cvt_pk_bf16_f32 v243, v58, v62
    buffer_store_dwordx4 v[240:243], v249, s[12:15], s39 offen sc1
    s_add_u32 s39, s39, 2736128
    v_cvt_pk_bf16_f32 v244, v35, v39
    v_cvt_pk_bf16_f32 v245, v43, v47
    v_cvt_pk_bf16_f32 v246, v51, v55
    v_cvt_pk_bf16_f32 v247, v59, v63
    buffer_store_dwordx4 v[244:247], v249, s[12:15], s39 offen sc1
    s_add_u32 s39, s39, 2736128
    v_mfma_f32_16x16x32_bf16 v[32:35], v[168:171], v[64:67], 0
    v_mfma_f32_16x16x32_bf16 v[36:39], v[168:171], v[68:71], 0
    v_mfma_f32_16x16x32_bf16 v[40:43], v[168:171], v[72:75], 0
    v_mfma_f32_16x16x32_bf16 v[44:47], v[168:171], v[76:79], 0
    v_mfma_f32_16x16x32_bf16 v[48:51], v[168:171], v[80:83], 0
    v_mfma_f32_16x16x32_bf16 v[52:55], v[168:171], v[84:87], 0
    v_mfma_f32_16x16x32_bf16 v[56:59], v[168:171], v[88:91], 0
    v_mfma_f32_16x16x32_bf16 v[60:63], v[168:171], v[92:95], 0
    v_mfma_f32_16x16x32_bf16 v[32:35], v[200:203], v[64:67], v[32:35]
    v_mfma_f32_16x16x32_bf16 v[36:39], v[200:203], v[68:71], v[36:39]
    v_mfma_f32_16x16x32_bf16 v[40:43], v[200:203], v[72:75], v[40:43]
    v_mfma_f32_16x16x32_bf16 v[44:47], v[200:203], v[76:79], v[44:47]
    v_mfma_f32_16x16x32_bf16 v[48:51], v[200:203], v[80:83], v[48:51]
    v_mfma_f32_16x16x32_bf16 v[52:55], v[200:203], v[84:87], v[52:55]
    v_mfma_f32_16x16x32_bf16 v[56:59], v[200:203], v[88:91], v[56:59]
    v_mfma_f32_16x16x32_bf16 v[60:63], v[200:203], v[92:95], v[60:63]
    v_mfma_f32_16x16x32_bf16 v[32:35], v[172:175], v[0:3], v[32:35]
    v_mfma_f32_16x16x32_bf16 v[36:39], v[172:175], v[4:7], v[36:39]
    v_mfma_f32_16x16x32_bf16 v[40:43], v[172:175], v[8:11], v[40:43]
    v_mfma_f32_16x16x32_bf16 v[44:47], v[172:175], v[12:15], v[44:47]
    v_mfma_f32_16x16x32_bf16 v[48:51], v[172:175], v[16:19], v[48:51]
    v_mfma_f32_16x16x32_bf16 v[52:55], v[172:175], v[20:23], v[52:55]
    v_mfma_f32_16x16x32_bf16 v[56:59], v[172:175], v[24:27], v[56:59]
    v_mfma_f32_16x16x32_bf16 v[60:63], v[172:175], v[28:31], v[60:63]
    v_mfma_f32_16x16x32_bf16 v[32:35], v[204:207], v[0:3], v[32:35]
    v_mfma_f32_16x16x32_bf16 v[36:39], v[204:207], v[4:7], v[36:39]
    v_mfma_f32_16x16x32_bf16 v[40:43], v[204:207], v[8:11], v[40:43]
    v_mfma_f32_16x16x32_bf16 v[44:47], v[204:207], v[12:15], v[44:47]
    v_mfma_f32_16x16x32_bf16 v[48:51], v[204:207], v[16:19], v[48:51]
    v_mfma_f32_16x16x32_bf16 v[52:55], v[204:207], v[20:23], v[52:55]
    v_mfma_f32_16x16x32_bf16 v[56:59], v[204:207], v[24:27], v[56:59]
    v_mfma_f32_16x16x32_bf16 v[60:63], v[204:207], v[28:31], v[60:63]
    s_nop 7
    v_cvt_pk_bf16_f32 v240, v32, v36
    v_cvt_pk_bf16_f32 v241, v40, v44
    v_cvt_pk_bf16_f32 v242, v48, v52
    v_cvt_pk_bf16_f32 v243, v56, v60
    buffer_store_dwordx4 v[240:243], v249, s[12:15], s39 offen sc1
    s_add_u32 s39, s39, 2736128
    v_cvt_pk_bf16_f32 v244, v33, v37
    v_cvt_pk_bf16_f32 v245, v41, v45
    v_cvt_pk_bf16_f32 v246, v49, v53
    v_cvt_pk_bf16_f32 v247, v57, v61
    buffer_store_dwordx4 v[244:247], v249, s[12:15], s39 offen sc1
    s_add_u32 s39, s39, 2736128
    v_cvt_pk_bf16_f32 v240, v34, v38
    v_cvt_pk_bf16_f32 v241, v42, v46
    v_cvt_pk_bf16_f32 v242, v50, v54
    v_cvt_pk_bf16_f32 v243, v58, v62
    buffer_store_dwordx4 v[240:243], v249, s[12:15], s39 offen sc1
    s_add_u32 s39, s39, 2736128
    v_cvt_pk_bf16_f32 v244, v35, v39
    v_cvt_pk_bf16_f32 v245, v43, v47
    v_cvt_pk_bf16_f32 v246, v51, v55
    v_cvt_pk_bf16_f32 v247, v59, v63
    buffer_store_dwordx4 v[244:247], v249, s[12:15], s39 offen sc1
    s_add_u32 s39, s39, 2736128
    v_mfma_f32_16x16x32_bf16 v[32:35], v[176:179], v[64:67], 0
    v_mfma_f32_16x16x32_bf16 v[36:39], v[176:179], v[68:71], 0
    v_mfma_f32_16x16x32_bf16 v[40:43], v[176:179], v[72:75], 0
    v_mfma_f32_16x16x32_bf16 v[44:47], v[176:179], v[76:79], 0
    v_mfma_f32_16x16x32_bf16 v[48:51], v[176:179], v[80:83], 0
    v_mfma_f32_16x16x32_bf16 v[52:55], v[176:179], v[84:87], 0
    v_mfma_f32_16x16x32_bf16 v[56:59], v[176:179], v[88:91], 0
    v_mfma_f32_16x16x32_bf16 v[60:63], v[176:179], v[92:95], 0
    v_mfma_f32_16x16x32_bf16 v[32:35], v[208:211], v[64:67], v[32:35]
    v_mfma_f32_16x16x32_bf16 v[36:39], v[208:211], v[68:71], v[36:39]
    v_mfma_f32_16x16x32_bf16 v[40:43], v[208:211], v[72:75], v[40:43]
    v_mfma_f32_16x16x32_bf16 v[44:47], v[208:211], v[76:79], v[44:47]
    v_mfma_f32_16x16x32_bf16 v[48:51], v[208:211], v[80:83], v[48:51]
    v_mfma_f32_16x16x32_bf16 v[52:55], v[208:211], v[84:87], v[52:55]
    v_mfma_f32_16x16x32_bf16 v[56:59], v[208:211], v[88:91], v[56:59]
    v_mfma_f32_16x16x32_bf16 v[60:63], v[208:211], v[92:95], v[60:63]
    v_mfma_f32_16x16x32_bf16 v[32:35], v[180:183], v[0:3], v[32:35]
    v_mfma_f32_16x16x32_bf16 v[36:39], v[180:183], v[4:7], v[36:39]
    v_mfma_f32_16x16x32_bf16 v[40:43], v[180:183], v[8:11], v[40:43]
    v_mfma_f32_16x16x32_bf16 v[44:47], v[180:183], v[12:15], v[44:47]
    v_mfma_f32_16x16x32_bf16 v[48:51], v[180:183], v[16:19], v[48:51]
    v_mfma_f32_16x16x32_bf16 v[52:55], v[180:183], v[20:23], v[52:55]
    v_mfma_f32_16x16x32_bf16 v[56:59], v[180:183], v[24:27], v[56:59]
    v_mfma_f32_16x16x32_bf16 v[60:63], v[180:183], v[28:31], v[60:63]
    v_mfma_f32_16x16x32_bf16 v[32:35], v[212:215], v[0:3], v[32:35]
    v_mfma_f32_16x16x32_bf16 v[36:39], v[212:215], v[4:7], v[36:39]
    v_mfma_f32_16x16x32_bf16 v[40:43], v[212:215], v[8:11], v[40:43]
    v_mfma_f32_16x16x32_bf16 v[44:47], v[212:215], v[12:15], v[44:47]
    v_mfma_f32_16x16x32_bf16 v[48:51], v[212:215], v[16:19], v[48:51]
    v_mfma_f32_16x16x32_bf16 v[52:55], v[212:215], v[20:23], v[52:55]
    v_mfma_f32_16x16x32_bf16 v[56:59], v[212:215], v[24:27], v[56:59]
    v_mfma_f32_16x16x32_bf16 v[60:63], v[212:215], v[28:31], v[60:63]
    s_nop 7
    v_cvt_pk_bf16_f32 v240, v32, v36
    v_cvt_pk_bf16_f32 v241, v40, v44
    v_cvt_pk_bf16_f32 v242, v48, v52
    v_cvt_pk_bf16_f32 v243, v56, v60
    buffer_store_dwordx4 v[240:243], v249, s[12:15], s39 offen sc1
    s_add_u32 s39, s39, 2736128
    v_cvt_pk_bf16_f32 v244, v33, v37
    v_cvt_pk_bf16_f32 v245, v41, v45
    v_cvt_pk_bf16_f32 v246, v49, v53
    v_cvt_pk_bf16_f32 v247, v57, v61
    buffer_store_dwordx4 v[244:247], v249, s[12:15], s39 offen sc1
    s_add_u32 s39, s39, 2736128
    v_cvt_pk_bf16_f32 v240, v34, v38
    v_cvt_pk_bf16_f32 v241, v42, v46
    v_cvt_pk_bf16_f32 v242, v50, v54
    v_cvt_pk_bf16_f32 v243, v58, v62
    buffer_store_dwordx4 v[240:243], v249, s[12:15], s39 offen sc1
    s_add_u32 s39, s39, 2736128
    v_cvt_pk_bf16_f32 v244, v35, v39
    v_cvt_pk_bf16_f32 v245, v43, v47
    v_cvt_pk_bf16_f32 v246, v51, v55
    v_cvt_pk_bf16_f32 v247, v59, v63
    buffer_store_dwordx4 v[244:247], v249, s[12:15], s39 offen sc1
    s_add_u32 s39, s39, 2736128
    v_mfma_f32_16x16x32_bf16 v[32:35], v[184:187], v[64:67], 0
    v_mfma_f32_16x16x32_bf16 v[36:39], v[184:187], v[68:71], 0
    v_mfma_f32_16x16x32_bf16 v[40:43], v[184:187], v[72:75], 0
    v_mfma_f32_16x16x32_bf16 v[44:47], v[184:187], v[76:79], 0
    v_mfma_f32_16x16x32_bf16 v[48:51], v[184:187], v[80:83], 0
    v_mfma_f32_16x16x32_bf16 v[52:55], v[184:187], v[84:87], 0
    v_mfma_f32_16x16x32_bf16 v[56:59], v[184:187], v[88:91], 0
    v_mfma_f32_16x16x32_bf16 v[60:63], v[184:187], v[92:95], 0
    v_mfma_f32_16x16x32_bf16 v[32:35], v[216:219], v[64:67], v[32:35]
    v_mfma_f32_16x16x32_bf16 v[36:39], v[216:219], v[68:71], v[36:39]
    v_mfma_f32_16x16x32_bf16 v[40:43], v[216:219], v[72:75], v[40:43]
    v_mfma_f32_16x16x32_bf16 v[44:47], v[216:219], v[76:79], v[44:47]
    v_mfma_f32_16x16x32_bf16 v[48:51], v[216:219], v[80:83], v[48:51]
    v_mfma_f32_16x16x32_bf16 v[52:55], v[216:219], v[84:87], v[52:55]
    v_mfma_f32_16x16x32_bf16 v[56:59], v[216:219], v[88:91], v[56:59]
    v_mfma_f32_16x16x32_bf16 v[60:63], v[216:219], v[92:95], v[60:63]
    v_mfma_f32_16x16x32_bf16 v[32:35], v[188:191], v[0:3], v[32:35]
    v_mfma_f32_16x16x32_bf16 v[36:39], v[188:191], v[4:7], v[36:39]
    v_mfma_f32_16x16x32_bf16 v[40:43], v[188:191], v[8:11], v[40:43]
    v_mfma_f32_16x16x32_bf16 v[44:47], v[188:191], v[12:15], v[44:47]
    v_mfma_f32_16x16x32_bf16 v[48:51], v[188:191], v[16:19], v[48:51]
    v_mfma_f32_16x16x32_bf16 v[52:55], v[188:191], v[20:23], v[52:55]
    v_mfma_f32_16x16x32_bf16 v[56:59], v[188:191], v[24:27], v[56:59]
    v_mfma_f32_16x16x32_bf16 v[60:63], v[188:191], v[28:31], v[60:63]
    v_mfma_f32_16x16x32_bf16 v[32:35], v[220:223], v[0:3], v[32:35]
    v_mfma_f32_16x16x32_bf16 v[36:39], v[220:223], v[4:7], v[36:39]
    v_mfma_f32_16x16x32_bf16 v[40:43], v[220:223], v[8:11], v[40:43]
    v_mfma_f32_16x16x32_bf16 v[44:47], v[220:223], v[12:15], v[44:47]
    v_mfma_f32_16x16x32_bf16 v[48:51], v[220:223], v[16:19], v[48:51]
    v_mfma_f32_16x16x32_bf16 v[52:55], v[220:223], v[20:23], v[52:55]
    v_mfma_f32_16x16x32_bf16 v[56:59], v[220:223], v[24:27], v[56:59]
    v_mfma_f32_16x16x32_bf16 v[60:63], v[220:223], v[28:31], v[60:63]
    s_nop 7
    v_cvt_pk_bf16_f32 v240, v32, v36
    v_cvt_pk_bf16_f32 v241, v40, v44
    v_cvt_pk_bf16_f32 v242, v48, v52
    v_cvt_pk_bf16_f32 v243, v56, v60
    buffer_store_dwordx4 v[240:243], v249, s[12:15], s39 offen sc1
    s_add_u32 s39, s39, 2736128
    v_cvt_pk_bf16_f32 v244, v33, v37
    v_cvt_pk_bf16_f32 v245, v41, v45
    v_cvt_pk_bf16_f32 v246, v49, v53
    v_cvt_pk_bf16_f32 v247, v57, v61
    buffer_store_dwordx4 v[244:247], v249, s[12:15], s39 offen sc1
    s_add_u32 s39, s39, 2736128
    v_cvt_pk_bf16_f32 v240, v34, v38
    v_cvt_pk_bf16_f32 v241, v42, v46
    v_cvt_pk_bf16_f32 v242, v50, v54
    v_cvt_pk_bf16_f32 v243, v58, v62
    buffer_store_dwordx4 v[240:243], v249, s[12:15], s39 offen sc1
    s_add_u32 s39, s39, 2736128
    v_cvt_pk_bf16_f32 v244, v35, v39
    v_cvt_pk_bf16_f32 v245, v43, v47
    v_cvt_pk_bf16_f32 v246, v51, v55
    v_cvt_pk_bf16_f32 v247, v59, v63
    buffer_store_dwordx4 v[244:247], v249, s[12:15], s39 offen sc1
    s_mov_b32 s41, s40
    s_add_u32 s40, s40, 1
    s_cmp_eq_u32 s41, 3
    s_cbranch_scc0 K12_ES5
    s_waitcnt vmcnt(0)
    s_mov_b32 s34, -1
    s_cmp_ge_u32 s41, 8
    s_cbranch_scc1 K12_SG6
    s_lshl_b32 s36, s41, 2
    s_add_u32 s37, s36, 155680
    s_mov_b64 exec, 1
    v_mov_b32 v255, s37
    v_mov_b32 v240, 1
    ds_add_rtn_u32 v240, v255, v240
    s_waitcnt lgkmcnt(0)
    v_readfirstlane_b32 s37, v240
    s_nop 3
    s_cmp_eq_u32 s37, 3
    s_cbranch_scc0 K12_SH6
    v_mov_b32 v255, 1
    v_mov_b32 v240, s36
    buffer_atomic_add v255, v240, s[60:63], 0 offen sc0 sc1
    s_mov_b32 s34, s41
K12_SH6:
    s_mov_b64 exec, -1
K12_SG6:
    s_waitcnt vmcnt(0)
    s_cmp_ge_u32 s34, 8
    s_cbranch_scc1 K12_PB7
    v_readfirstlane_b32 s37, v255
    s_nop 3
    s_cmp_eq_u32 s37, 255
    s_cbranch_scc0 K12_PB7
    s_lshl_b32 s36, s34, 4
    s_add_u32 s36, s36, 128
    s_mov_b64 exec, 1
    v_mov_b32 v255, 1
    v_mov_b32 v240, s36
    buffer_store_dword v255, v240, s[60:63], 0 offen sc1
    s_mov_b64 exec, -1
K12_PB7:
    s_mov_b32 s34, -1
    s_mov_b32 s41, -1
K12_ES5:
    s_waitcnt vmcnt(16)
    s_branch K12_XP_F
K12_XP_E:
    s_mov_b32 s41, s40
    s_add_u32 s40, s40, 1
    s_cmp_eq_u32 s41, 3
    s_cbranch_scc0 K12_ES8
    s_waitcnt vmcnt(0)
    s_mov_b32 s34, -1
    s_cmp_ge_u32 s41, 8
    s_cbranch_scc1 K12_SG9
    s_lshl_b32 s36, s41, 2
    s_add_u32 s37, s36, 155680
    s_mov_b64 exec, 1
    v_mov_b32 v255, s37
    v_mov_b32 v240, 1
    ds_add_rtn_u32 v240, v255, v240
    s_waitcnt lgkmcnt(0)
    v_readfirstlane_b32 s37, v240
    s_nop 3
    s_cmp_eq_u32 s37, 3
    s_cbranch_scc0 K12_SH9
    v_mov_b32 v255, 1
    v_mov_b32 v240, s36
    buffer_atomic_add v255, v240, s[60:63], 0 offen sc0 sc1
    s_mov_b32 s34, s41
K12_SH9:
    s_mov_b64 exec, -1
K12_SG9:
    s_waitcnt vmcnt(0)
    s_cmp_ge_u32 s34, 8
    s_cbranch_scc1 K12_PB10
    v_readfirstlane_b32 s37, v255
    s_nop 3
    s_cmp_eq_u32 s37, 255
    s_cbranch_scc0 K12_PB10
    s_lshl_b32 s36, s34, 4
    s_add_u32 s36, s36, 128
    s_mov_b64 exec, 1
    v_mov_b32 v255, 1
    v_mov_b32 v240, s36
    buffer_store_dword v255, v240, s[60:63], 0 offen sc1
    s_mov_b64 exec, -1
K12_PB10:
    s_mov_b32 s34, -1
    s_mov_b32 s41, -1
K12_ES8:
    s_waitcnt vmcnt(0)
K12_XP_F:
    s_cmp_ge_u32 s34, 8
    s_cbranch_scc1 K12_PB11
    v_readfirstlane_b32 s37, v255
    s_nop 3
    s_cmp_eq_u32 s37, 255
    s_cbranch_scc0 K12_PB11
    s_lshl_b32 s36, s34, 4
    s_add_u32 s36, s36, 128
    s_mov_b64 exec, 1
    v_mov_b32 v255, 1
    v_mov_b32 v240, s36
    buffer_store_dword v255, v240, s[60:63], 0 offen sc1
    s_mov_b64 exec, -1
K12_PB11:
    s_cmp_ge_u32 s40, 8
    s_cbranch_scc1 K12_PFIN
K12_WENTRY:
    v_perm_b32 v64, v100, v96, s28
    v_perm_b32 v68, v100, v96, s29
    v_perm_b32 v65, v108, v104, s28
    v_perm_b32 v69, v108, v104, s29
    v_perm_b32 v66, v116, v112, s28
    v_perm_b32 v70, v116, v112, s29
    v_perm_b32 v67, v124, v120, s28
    v_perm_b32 v71, v124, v120, s29
    v_perm_b32 v72, v101, v97, s28
    v_perm_b32 v76, v101, v97, s29
    v_perm_b32 v73, v109, v105, s28
    v_perm_b32 v77, v109, v105, s29
    v_perm_b32 v74, v117, v113, s28
    v_perm_b32 v78, v117, v113, s29
    v_perm_b32 v75, v125, v121, s28
    v_perm_b32 v79, v125, v121, s29
    v_perm_b32 v80, v102, v98, s28
    v_perm_b32 v84, v102, v98, s29
    v_perm_b32 v81, v110, v106, s28
    v_perm_b32 v85, v110, v106, s29
    v_perm_b32 v82, v118, v114, s28
    v_perm_b32 v86, v118, v114, s29
    v_perm_b32 v83, v126, v122, s28
    v_perm_b32 v87, v126, v122, s29
    v_perm_b32 v88, v103, v99, s28
    v_perm_b32 v92, v103, v99, s29
    v_perm_b32 v89, v111, v107, s28
    v_perm_b32 v93, v111, v107, s29
    v_perm_b32 v90, v119, v115, s28
    v_perm_b32 v94, v119, v115, s29
    v_perm_b32 v91, v127, v123, s28
    v_perm_b32 v95, v127, v123, s29
    s_add_u32 s42, s40, 1
    s_mul_i32 s36, s42, 85
    s_add_u32 s36, s36, s2
    s_and_b32 s36, s36, 255
    s_mul_hi_u32 s37, s36, 0x55555556
    s_mul_i32 s38, s37, 3
    s_cmp_eq_u32 s38, s36
    s_cselect_b32 s27, 1, 0
    s_cmp_lt_u32 s37, 78
    s_cselect_b32 s27, s27, 0
    s_add_u32 s37, s37, 89
    s_cmp_eq_u32 s21, 0
    s_cselect_b32 s30, s24, s37
    s_cselect_b32 s27, 1, s27
    s_cmp_eq_u32 s27, 0
    s_cbranch_scc1 K12_WP_N
    s_lshl_b32 s36, s42, 8
    s_mul_i32 s37, s30, 98304
    s_add_u32 s36, s36, s37
    buffer_load_dwordx4 v[0:3], v248, s[4:7], s36 offen
    buffer_load_dwordx4 v[4:7], v248, s[4:7], s36 offen offset:2048
    s_add_u32 s36, s36, 4096
    buffer_load_dwordx4 v[8:11], v248, s[4:7], s36 offen
    buffer_load_dwordx4 v[12:15], v248, s[4:7], s36 offen offset:2048
    s_add_u32 s36, s36, 4096
    buffer_load_dwordx4 v[16:19], v248, s[4:7], s36 offen
    buffer_load_dwordx4 v[20:23], v248, s[4:7], s36 offen offset:2048
    s_add_u32 s36, s36, 4096
    buffer_load_dwordx4 v[24:27], v248, s[4:7], s36 offen
    buffer_load_dwordx4 v[28:31], v248, s[4:7], s36 offen offset:2048
    s_add_u32 s36, s36, 53248
    buffer_load_dwordx4 v[32:35], v248, s[4:7], s36 offen
    buffer_load_dwordx4 v[36:39], v248, s[4:7], s36 offen offset:2048
    s_add_u32 s36, s36, 4096
    buffer_load_dwordx4 v[40:43], v248, s[4:7], s36 offen
    buffer_load_dwordx4 v[44:47], v248, s[4:7], s36 offen offset:2048
    s_add_u32 s36, s36, 4096
    buffer_load_dwordx4 v[48:51], v248, s[4:7], s36 offen
    buffer_load_dwordx4 v[52:55], v248, s[4:7], s36 offen offset:2048
    s_add_u32 s36, s36, 4096
    buffer_load_dwordx4 v[56:59], v248, s[4:7], s36 offen
    buffer_load_dwordx4 v[60:63], v248, s[4:7], s36 offen offset:2048
    s_waitcnt vmcnt(16)
    s_branch K12_WP_M
K12_WP_N:
    s_waitcnt vmcnt(0)
K12_WP_M:
    s_mov_b32 s34, -1
    s_cmp_ge_u32 s41, 8
    s_cbranch_scc1 K12_SG12
    s_lshl_b32 s36, s41, 2
    s_add_u32 s37, s36, 155680
    s_mov_b64 exec, 1
    v_mov_b32 v255, s37
    v_mov_b32 v240, 1
    ds_add_rtn_u32 v240, v255, v240
    s_waitcnt lgkmcnt(0)
    v_readfirstlane_b32 s37, v240
    s_nop 3
    s_cmp_eq_u32 s37, 3
    s_cbranch_scc0 K12_SH12
    v_mov_b32 v255, 1
    v_mov_b32 v240, s36
    buffer_atomic_add v255, v240, s[60:63], 0 offen sc0 sc1
    s_mov_b32 s34, s41
K12_SH12:
    s_mov_b64 exec, -1
K12_SG12:
    s_cmp_ge_u32 s34, 8
    s_cbranch_scc1 K12_EP13
    s_waitcnt vmcnt(0)
    s_cmp_ge_u32 s34, 8
    s_cbranch_scc1 K12_PB14
    v_readfirstlane_b32 s37, v255
    s_nop 3
    s_cmp_eq_u32 s37, 255
    s_cbranch_scc0 K12_PB14
    s_lshl_b32 s36, s34, 4
    s_add_u32 s36, s36, 128
    s_mov_b64 exec, 1
    v_mov_b32 v255, 1
    v_mov_b32 v240, s36
    buffer_store_dword v255, v240, s[60:63], 0 offen sc1
    s_mov_b64 exec, -1
K12_PB14:
    s_mov_b32 s34, -1
K12_EP13:
    s_lshl_b32 s36, s40, 2
    s_sub_i32 s36, s36, 17
    s_max_i32 s36, s36, 1
    s_mov_b32 s38, 155648
    s_cmp_eq_u32 s40, 99
    s_cselect_b32 s36, 4, s36
    s_cselect_b32 s38, 155664, s38
    s_cbranch_scc1 K12_GS1
    s_cmp_lt_u32 s40, 3
    s_cbranch_scc1 K12_GT1
K12_GS1:
    s_mov_b32 s37, 32768
K12_GL1:
    v_mov_b32 v240, s38
    ds_read_b32 v240, v240
    s_waitcnt lgkmcnt(0)
    v_cmp_gt_u32 vcc, s36, v240
    s_sub_u32 s37, s37, 1
    s_cmp_eq_u32 s37, 0
    s_cbranch_scc1 K12_GT1
    s_cbranch_vccz K12_GT1
    s_sleep 2
    s_branch K12_GL1
K12_GT1:
    s_lshl_b32 s36, s40, 7
    s_add_u32 s36, s36, s22
    s_and_b32 s37, s36, 3
    s_lshr_b32 s38, s36, 1
    s_and_b32 s38, s38, 4
    s_or_b32 s37, s37, s38
    v_bfe_u32 v253, v254, 5, 3
    v_xor_b32 v253, s37, v253
    v_lshl_add_u32 v253, v253, 5, v251
    s_lshl_b32 s36, s36, 9
    s_add_u32 s39, s36, s32
    v_mfma_f32_16x16x32_bf16 v[128:131], v[224:227], v[64:67], 0
    v_mfma_f32_16x16x32_bf16 v[132:135], v[224:227], v[68:71], 0
    v_mfma_f32_16x16x32_bf16 v[136:139], v[224:227], v[72:75], 0
    v_mfma_f32_16x16x32_bf16 v[140:143], v[224:227], v[76:79], 0
    v_mfma_f32_16x16x32_bf16 v[144:147], v[224:227], v[80:83], 0
    v_mfma_f32_16x16x32_bf16 v[148:151], v[224:227], v[84:87], 0
    v_mfma_f32_16x16x32_bf16 v[152:155], v[224:227], v[88:91], 0
    v_mfma_f32_16x16x32_bf16 v[156:159], v[224:227], v[92:95], 0
    s_nop 7
    v_cvt_pk_bf16_f32 v240, v128, v132
    v_cvt_pk_bf16_f32 v241, v136, v140
    v_cvt_pk_bf16_f32 v242, v144, v148
    v_cvt_pk_bf16_f32 v243, v152, v156
    buffer_store_dwordx4 v[240:243], v253, s[16:19], s39 offen sc1
    s_add_u32 s39, s39, 4194304
    v_cvt_pk_bf16_f32 v244, v129, v133
    v_cvt_pk_bf16_f32 v245, v137, v141
    v_cvt_pk_bf16_f32 v246, v145, v149
    v_cvt_pk_bf16_f32 v247, v153, v157
    buffer_store_dwordx4 v[244:247], v253, s[16:19], s39 offen sc1
    s_add_u32 s39, s39, 4194304
    v_cvt_pk_bf16_f32 v240, v130, v134
    v_cvt_pk_bf16_f32 v241, v138, v142
    v_cvt_pk_bf16_f32 v242, v146, v150
    v_cvt_pk_bf16_f32 v243, v154, v158
    buffer_store_dwordx4 v[240:243], v253, s[16:19], s39 offen sc1
    s_add_u32 s39, s39, 4194304
    v_cvt_pk_bf16_f32 v244, v131, v135
    v_cvt_pk_bf16_f32 v245, v139, v143
    v_cvt_pk_bf16_f32 v246, v147, v151
    v_cvt_pk_bf16_f32 v247, v155, v159
    buffer_store_dwordx4 v[244:247], v253, s[16:19], s39 offen sc1
    s_add_u32 s39, s39, 4194304
    v_mfma_f32_16x16x32_bf16 v[128:131], v[228:231], v[64:67], 0
    v_mfma_f32_16x16x32_bf16 v[132:135], v[228:231], v[68:71], 0
    v_mfma_f32_16x16x32_bf16 v[136:139], v[228:231], v[72:75], 0
    v_mfma_f32_16x16x32_bf16 v[140:143], v[228:231], v[76:79], 0
    v_mfma_f32_16x16x32_bf16 v[144:147], v[228:231], v[80:83], 0
    v_mfma_f32_16x16x32_bf16 v[148:151], v[228:231], v[84:87], 0
    v_mfma_f32_16x16x32_bf16 v[152:155], v[228:231], v[88:91], 0
    v_mfma_f32_16x16x32_bf16 v[156:159], v[228:231], v[92:95], 0
    s_nop 7
    v_cvt_pk_bf16_f32 v240, v128, v132
    v_cvt_pk_bf16_f32 v241, v136, v140
    v_cvt_pk_bf16_f32 v242, v144, v148
    v_cvt_pk_bf16_f32 v243, v152, v156
    buffer_store_dwordx4 v[240:243], v253, s[16:19], s39 offen sc1
    s_add_u32 s39, s39, 4194304
    v_cvt_pk_bf16_f32 v244, v129, v133
    v_cvt_pk_bf16_f32 v245, v137, v141
    v_cvt_pk_bf16_f32 v246, v145, v149
    v_cvt_pk_bf16_f32 v247, v153, v157
    buffer_store_dwordx4 v[244:247], v253, s[16:19], s39 offen sc1
    s_add_u32 s39, s39, 4194304
    v_cvt_pk_bf16_f32 v240, v130, v134
    v_cvt_pk_bf16_f32 v241, v138, v142
    v_cvt_pk_bf16_f32 v242, v146, v150
    v_cvt_pk_bf16_f32 v243, v154, v158
    buffer_store_dwordx4 v[240:243], v253, s[16:19], s39 offen sc1
    s_add_u32 s39, s39, 4194304
    v_cvt_pk_bf16_f32 v244, v131, v135
    v_cvt_pk_bf16_f32 v245, v139, v143
    v_cvt_pk_bf16_f32 v246, v147, v151
    v_cvt_pk_bf16_f32 v247, v155, v159
    buffer_store_dwordx4 v[244:247], v253, s[16:19], s39 offen sc1
    s_add_u32 s39, s39, 4194304
    v_mfma_f32_16x16x32_bf16 v[128:131], v[232:235], v[64:67], 0
    v_mfma_f32_16x16x32_bf16 v[132:135], v[232:235], v[68:71], 0
    v_mfma_f32_16x16x32_bf16 v[136:139], v[232:235], v[72:75], 0
    v_mfma_f32_16x16x32_bf16 v[140:143], v[232:235], v[76:79], 0
    v_mfma_f32_16x16x32_bf16 v[144:147], v[232:235], v[80:83], 0
    v_mfma_f32_16x16x32_bf16 v[148:151], v[232:235], v[84:87], 0
    v_mfma_f32_16x16x32_bf16 v[152:155], v[232:235], v[88:91], 0
    v_mfma_f32_16x16x32_bf16 v[156:159], v[232:235], v[92:95], 0
    s_nop 7
    v_cvt_pk_bf16_f32 v240, v128, v132
    v_cvt_pk_bf16_f32 v241, v136, v140
    v_cvt_pk_bf16_f32 v242, v144, v148
    v_cvt_pk_bf16_f32 v243, v152, v156
    buffer_store_dwordx4 v[240:243], v253, s[16:19], s39 offen sc1
    s_add_u32 s39, s39, 4194304
    v_cvt_pk_bf16_f32 v244, v129, v133
    v_cvt_pk_bf16_f32 v245, v137, v141
    v_cvt_pk_bf16_f32 v246, v145, v149
    v_cvt_pk_bf16_f32 v247, v153, v157
    buffer_store_dwordx4 v[244:247], v253, s[16:19], s39 offen sc1
    s_add_u32 s39, s39, 4194304
    v_cvt_pk_bf16_f32 v240, v130, v134
    v_cvt_pk_bf16_f32 v241, v138, v142
    v_cvt_pk_bf16_f32 v242, v146, v150
    v_cvt_pk_bf16_f32 v243, v154, v158
    buffer_store_dwordx4 v[240:243], v253, s[16:19], s39 offen sc1
    s_add_u32 s39, s39, 4194304
    v_cvt_pk_bf16_f32 v244, v131, v135
    v_cvt_pk_bf16_f32 v245, v139, v143
    v_cvt_pk_bf16_f32 v246, v147, v151
    v_cvt_pk_bf16_f32 v247, v155, v159
    buffer_store_dwordx4 v[244:247], v253, s[16:19], s39 offen sc1
    s_add_u32 s39, s39, 4194304
    v_mfma_f32_16x16x32_bf16 v[128:131], v[236:239], v[64:67], 0
    v_mfma_f32_16x16x32_bf16 v[132:135], v[236:239], v[68:71], 0
    v_mfma_f32_16x16x32_bf16 v[136:139], v[236:239], v[72:75], 0
    v_mfma_f32_16x16x32_bf16 v[140:143], v[236:239], v[76:79], 0
    v_mfma_f32_16x16x32_bf16 v[144:147], v[236:239], v[80:83], 0
    v_mfma_f32_16x16x32_bf16 v[148:151], v[236:239], v[84:87], 0
    v_mfma_f32_16x16x32_bf16 v[152:155], v[236:239], v[88:91], 0
    v_mfma_f32_16x16x32_bf16 v[156:159], v[236:239], v[92:95], 0
    s_nop 7
    v_cvt_pk_bf16_f32 v240, v128, v132
    v_cvt_pk_bf16_f32 v241, v136, v140
    v_cvt_pk_bf16_f32 v242, v144, v148
    v_cvt_pk_bf16_f32 v243, v152, v156
    buffer_store_dwordx4 v[240:243], v253, s[16:19], s39 offen sc1
    s_add_u32 s39, s39, 4194304
    v_cvt_pk_bf16_f32 v244, v129, v133
    v_cvt_pk_bf16_f32 v245, v137, v141
    v_cvt_pk_bf16_f32 v246, v145, v149
    v_cvt_pk_bf16_f32 v247, v153, v157
    buffer_store_dwordx4 v[244:247], v253, s[16:19], s39 offen sc1
    s_add_u32 s39, s39, 4194304
    v_cvt_pk_bf16_f32 v240, v130, v134
    v_cvt_pk_bf16_f32 v241, v138, v142
    v_cvt_pk_bf16_f32 v242, v146, v150
    v_cvt_pk_bf16_f32 v243, v154, v158
    buffer_store_dwordx4 v[240:243], v253, s[16:19], s39 offen sc1
    s_add_u32 s39, s39, 4194304
    v_cvt_pk_bf16_f32 v244, v131, v135
    v_cvt_pk_bf16_f32 v245, v139, v143
    v_cvt_pk_bf16_f32 v246, v147, v151
    v_cvt_pk_bf16_f32 v247, v155, v159
    buffer_store_dwordx4 v[244:247], v253, s[16:19], s39 offen sc1
    s_mov_b32 s41, s40
    s_add_u32 s40, s40, 1
    s_cmp_eq_u32 s41, 3
    s_cbranch_scc0 K12_ES15
    s_waitcnt vmcnt(0)
    s_mov_b32 s34, -1
    s_cmp_ge_u32 s41, 8
    s_cbranch_scc1 K12_SG16
    s_lshl_b32 s36, s41, 2
    s_add_u32 s37, s36, 155680
    s_mov_b64 exec, 1
    v_mov_b32 v255, s37
    v_mov_b32 v240, 1
    ds_add_rtn_u32 v240, v255, v240
    s_waitcnt lgkmcnt(0)
    v_readfirstlane_b32 s37, v240
    s_nop 3
    s_cmp_eq_u32 s37, 3
    s_cbranch_scc0 K12_SH16
    v_mov_b32 v255, 1
    v_mov_b32 v240, s36
    buffer_atomic_add v255, v240, s[60:63], 0 offen sc0 sc1
    s_mov_b32 s34, s41
K12_SH16:
    s_mov_b64 exec, -1
K12_SG16:
    s_waitcnt vmcnt(0)
    s_cmp_ge_u32 s34, 8
    s_cbranch_scc1 K12_PB17
    v_readfirstlane_b32 s37, v255
    s_nop 3
    s_cmp_eq_u32 s37, 255
    s_cbranch_scc0 K12_PB17
    s_lshl_b32 s36, s34, 4
    s_add_u32 s36, s36, 128
    s_mov_b64 exec, 1
    v_mov_b32 v255, 1
    v_mov_b32 v240, s36
    buffer_store_dword v255, v240, s[60:63], 0 offen sc1
    s_mov_b64 exec, -1
K12_PB17:
    s_mov_b32 s34, -1
    s_mov_b32 s41, -1
K12_ES15:
    s_waitcnt vmcnt(16)
    s_cmp_ge_u32 s34, 8
    s_cbranch_scc1 K12_PB18
    v_readfirstlane_b32 s37, v255
    s_nop 3
    s_cmp_eq_u32 s37, 255
    s_cbranch_scc0 K12_PB18
    s_lshl_b32 s36, s34, 4
    s_add_u32 s36, s36, 128
    s_mov_b64 exec, 1
    v_mov_b32 v255, 1
    v_mov_b32 v240, s36
    buffer_store_dword v255, v240, s[60:63], 0 offen sc1
    s_mov_b64 exec, -1
K12_PB18:
    s_cmp_lt_u32 s40, 8
    s_cbranch_scc1 K12_XW
K12_PFIN:
    s_waitcnt vmcnt(0)
    s_mov_b32 s34, -1
    s_cmp_ge_u32 s41, 8
    s_cbranch_scc1 K12_SG19
    s_lshl_b32 s36, s41, 2
    s_add_u32 s37, s36, 155680
    s_mov_b64 exec, 1
    v_mov_b32 v255, s37
    v_mov_b32 v240, 1
    ds_add_rtn_u32 v240, v255, v240
    s_waitcnt lgkmcnt(0)
    v_readfirstlane_b32 s37, v240
    s_nop 3
    s_cmp_eq_u32 s37, 3
    s_cbranch_scc0 K12_SH19
    v_mov_b32 v255, 1
    v_mov_b32 v240, s36
    buffer_atomic_add v255, v240, s[60:63], 0 offen sc0 sc1
    s_mov_b32 s34, s41
K12_SH19:
    s_mov_b64 exec, -1
K12_SG19:
    s_waitcnt vmcnt(0)
    s_cmp_ge_u32 s34, 8
    s_cbranch_scc1 K12_PB20
    v_readfirstlane_b32 s37, v255
    s_nop 3
    s_cmp_eq_u32 s37, 255
    s_cbranch_scc0 K12_PB20
    s_lshl_b32 s36, s34, 4
    s_add_u32 s36, s36, 128
    s_mov_b64 exec, 1
    v_mov_b32 v255, 1
    v_mov_b32 v240, s36
    buffer_store_dword v255, v240, s[60:63], 0 offen sc1
    s_mov_b64 exec, -1
K12_PB20:
    s_endpgm
K12_CONS:
    s_and_b32 s6, s2, 7
    s_lshl_b32 s6, s6, 2
    s_lshr_b32 s7, s2, 6
    s_add_u32 s6, s6, s7
    s_lshr_b32 s7, s2, 3
    s_and_b32 s7, s7, 7
    s_lshr_b32 s20, s7, 2
    s_and_b32 s21, s7, 3
    s_lshl_b32 s22, s6, 1
    s_add_u32 s22, s22, s20
    s_lshl_b32 s23, s6, 2
    s_add_u32 s23, s23, s21
    s_mul_i32 s24, s22, 684032
    s_mul_i32 s25, s23, 524288
    s_add_u32 s25, s25, 50331648
    s_mul_i32 s26, s22, 342016
    s_add_u32 s26, s26, 118489088
    s_add_u32 s8, s58, s24
    s_addc_u32 s9, s59, 0
    s_and_b32 s9, s9, 0xffff
    s_mov_b32 s10, 684032
    s_mov_b32 s11, 0x00020000
    s_add_u32 s12, s58, s25
    s_addc_u32 s13, s59, 0
    s_and_b32 s13, s13, 0xffff
    s_mov_b32 s14, 524288
    s_mov_b32 s15, 0x00020000
    s_add_u32 s16, s58, s26
    s_addc_u32 s17, s59, 0
    s_and_b32 s17, s17, 0xffff
    s_mov_b32 s18, 342016
    s_mov_b32 s19, 0x00020000
    s_add_u32 s4, s56, 128
    s_addc_u32 s5, s57, 0
    s_and_b32 s5, s5, 0xffff
    s_cmp_eq_u32 s3, 0
    s_cselect_b32 s6, 128, 0
    s_mov_b32 s7, 0x00020000
    s_mov_b32 s46, 155712
    s_cselect_b32 s46, s46, 155776
    s_mov_b32 s47, 155712
    s_cselect_b32 s47, s47, 155744
    s_cselect_b32 s45, 4, 0
    s_mov_b32 s50, s45
    v_and_b32 v8, 15, v2
    v_lshrrev_b32 v9, 4, v2
    v_lshlrev_b32 v1, 4, v2
    s_mul_i32 s30, s3, 5120
    s_mov_b32 s36, s30
    s_lshl_b32 s31, s3, 12
    s_add_u32 s37, s31, 22528
    s_lshl_b32 s33, s3, 8
    s_add_u32 s33, s33, 20480
    s_mov_b32 s38, s33
    s_mov_b32 s44, 0xffff
    s_cmp_eq_u32 s3, 3
    s_cselect_b32 s44, 0xff, s44
    s_mov_b32 s45, 0
    v_lshrrev_b32 v10, 1, v8
    v_xor_b32 v10, v10, v9
    v_lshlrev_b32 v10, 4, v10
    v_lshl_add_u32 v2, v8, 7, v10
    v_xor_b32 v3, 64, v2
    v_lshrrev_b32 v10, 2, v8
    v_lshl_add_u32 v11, v9, 3, v10
    v_lshlrev_b32 v11, 9, v11
    v_and_b32 v12, 1, v9
    v_lshl_or_b32 v10, v12, 2, v10
    s_lshl_b32 s28, s3, 1
    v_xor_b32 v10, s28, v10
    v_lshl_add_u32 v11, v10, 5, v11
    v_and_b32 v10, 3, v8
    v_lshl_add_u32 v11, v10, 3, v11
    v_add_u32 v4, 22528, v11
    v_and_b32 v10, 3, v8
    v_lshlrev_b32 v10, 2, v10
    v_add_u32 v5, 155648, v10
    s_lshl_b32 s28, s3, 2
    s_add_u32 s28, s28, 155648
    v_mov_b32 v7, s28
    s_mov_b32 s35, 0x80008000
    s_mov_b32 s62, 0
    s_mov_b32 s63, 0
    s_mov_b32 s39, 0
    s_add_u32 m0, s39, s36
    s_nop 0
    buffer_load_dwordx4 v1, s[8:11], s30 offen sc1 lds
    buffer_load_dwordx4 v1, s[8:11], s30 offen offset:1024 sc1 lds
    buffer_load_dwordx4 v1, s[8:11], s30 offen offset:2048 sc1 lds
    buffer_load_dwordx4 v1, s[8:11], s30 offen offset:3072 sc1 lds
    s_add_u32 m0, m0, 4096
    s_add_u32 s34, s30, 4096
    buffer_load_dwordx4 v1, s[8:11], s34 offen sc1 lds
    s_add_u32 m0, s39, s37
    s_add_u32 s30, s30, 21376
    buffer_load_dwordx4 v1, s[12:15], s31 offen sc1 lds
    buffer_load_dwordx4 v1, s[12:15], s31 offen offset:1024 sc1 lds
    buffer_load_dwordx4 v1, s[12:15], s31 offen offset:2048 sc1 lds
    buffer_load_dwordx4 v1, s[12:15], s31 offen offset:3072 sc1 lds
    s_add_u32 m0, s39, s38
    s_mov_b64 exec, s[44:45]
    buffer_load_dwordx4 v1, s[8:11], s33 offen sc1 lds
    s_mov_b64 exec, -1
    s_add_u32 s31, s31, 16384
    s_add_u32 s33, s33, 21376
    s_add_u32 s39, s39, 38912
    s_add_u32 m0, s39, s36
    s_nop 0
    buffer_load_dwordx4 v1, s[8:11], s30 offen sc1 lds
    buffer_load_dwordx4 v1, s[8:11], s30 offen offset:1024 sc1 lds
    buffer_load_dwordx4 v1, s[8:11], s30 offen offset:2048 sc1 lds
    buffer_load_dwordx4 v1, s[8:11], s30 offen offset:3072 sc1 lds
    s_add_u32 m0, m0, 4096
    s_add_u32 s34, s30, 4096
    buffer_load_dwordx4 v1, s[8:11], s34 offen sc1 lds
    s_add_u32 m0, s39, s37
    s_add_u32 s30, s30, 21376
    buffer_load_dwordx4 v1, s[12:15], s31 offen sc1 lds
    buffer_load_dwordx4 v1, s[12:15], s31 offen offset:1024 sc1 lds
    buffer_load_dwordx4 v1, s[12:15], s31 offen offset:2048 sc1 lds
    buffer_load_dwordx4 v1, s[12:15], s31 offen offset:3072 sc1 lds
    s_add_u32 m0, s39, s38
    s_mov_b64 exec, s[44:45]
    buffer_load_dwordx4 v1, s[8:11], s33 offen sc1 lds
    s_mov_b64 exec, -1
    s_add_u32 s31, s31, 16384
    s_add_u32 s33, s33, 21376
    s_add_u32 s39, s39, 38912
    s_add_u32 m0, s39, s36
    s_nop 0
    buffer_load_dwordx4 v1, s[8:11], s30 offen sc1 lds
    buffer_load_dwordx4 v1, s[8:11], s30 offen offset:1024 sc1 lds
    buffer_load_dwordx4 v1, s[8:11], s30 offen offset:2048 sc1 lds
    buffer_load_dwordx4 v1, s[8:11], s30 offen offset:3072 sc1 lds
    s_add_u32 m0, m0, 4096
    s_add_u32 s34, s30, 4096
    buffer_load_dwordx4 v1, s[8:11], s34 offen sc1 lds
    s_add_u32 m0, s39, s37
    s_add_u32 s30, s30, 21376
    buffer_load_dwordx4 v1, s[12:15], s31 offen sc1 lds
    buffer_load_dwordx4 v1, s[12:15], s31 offen offset:1024 sc1 lds
    buffer_load_dwordx4 v1, s[12:15], s31 offen offset:2048 sc1 lds
    buffer_load_dwordx4 v1, s[12:15], s31 offen offset:3072 sc1 lds
    s_add_u32 m0, s39, s38
    s_mov_b64 exec, s[44:45]
    buffer_load_dwordx4 v1, s[8:11], s33 offen sc1 lds
    s_mov_b64 exec, -1
    s_add_u32 s31, s31, 16384
    s_add_u32 s33, s33, 21376
    s_add_u32 s39, s39, 38912
    s_mov_b32 m0, s46
    s_mov_b64 exec, 0xff
    buffer_load_dword v1, s[4:7], 0 offen sc1 lds
    s_mov_b64 exec, -1
    v_lshrrev_b32 v9, 4, v1
    v_and_b32 v8, 15, v9
    v_lshrrev_b32 v9, 4, v9
    v_and_b32 v10, 3, v8
    v_lshlrev_b32 v10, 2, v10
    v_lshrrev_b32 v12, 3, v8
    v_lshl_add_u32 v10, v12, 1, v10
    s_lshl_b32 s28, s3, 4
    s_add_u32 s28, s28, 1
    v_add_u32 v10, s28, v10
    v_bfe_u32 v11, v8, 2, 1
    v_and_b32 v13, 1, v9
    v_lshlrev_b32 v13, 3, v13
    v_mul_u32_u24 v14, 96, v11
    v_mad_u32_u24 v15, v10, v13, v14
    v_mad_u32_u24 v16, v10, 0, v15
    v_mad_u32_u24 v17, v10, 1, v15
    v_mad_u32_u24 v18, v10, 2, v15
    v_mad_u32_u24 v19, v10, 3, v15
    v_mad_u32_u24 v20, v10, 4, v15
    v_mad_u32_u24 v21, v10, 5, v15
    v_mad_u32_u24 v22, v10, 6, v15
    v_mad_u32_u24 v23, v10, 7, v15
    v_and_b32 v16, 127, v16
    v_and_b32 v17, 127, v17
    v_and_b32 v18, 127, v18
    v_and_b32 v19, 127, v19
    v_and_b32 v20, 127, v20
    v_and_b32 v21, 127, v21
    v_and_b32 v22, 127, v22
    v_and_b32 v23, 127, v23
    v_cvt_f32_u32 v16, v16
    v_cvt_f32_u32 v17, v17
    v_cvt_f32_u32 v18, v18
    v_cvt_f32_u32 v19, v19
    v_cvt_f32_u32 v20, v20
    v_cvt_f32_u32 v21, v21
    v_cvt_f32_u32 v22, v22
    v_cvt_f32_u32 v23, v23
    v_mul_f32 v16, 0x3c000000, v16
    v_mul_f32 v17, 0x3c000000, v17
    v_mul_f32 v18, 0x3c000000, v18
    v_mul_f32 v19, 0x3c000000, v19
    v_mul_f32 v20, 0x3c000000, v20
    v_mul_f32 v21, 0x3c000000, v21
    v_mul_f32 v22, 0x3c000000, v22
    v_mul_f32 v23, 0x3c000000, v23
    v_cos_f32 v16, v16
    v_cos_f32 v17, v17
    v_cos_f32 v18, v18
    v_cos_f32 v19, v19
    v_cos_f32 v20, v20
    v_cos_f32 v21, v21
    v_cos_f32 v22, v22
    v_cos_f32 v23, v23
    s_nop 0
    v_cvt_pk_bf16_f32 v24, v16, v17
    v_cvt_pk_bf16_f32 v25, v18, v19
    v_cvt_pk_bf16_f32 v26, v20, v21
    v_cvt_pk_bf16_f32 v27, v22, v23
    v_lshlrev_b32 v32, 16, v24
    v_and_b32 v33, 0xffff0000, v24
    v_sub_f32 v16, v16, v32
    v_sub_f32 v17, v17, v33
    v_lshlrev_b32 v32, 16, v25
    v_and_b32 v33, 0xffff0000, v25
    v_sub_f32 v18, v18, v32
    v_sub_f32 v19, v19, v33
    v_lshlrev_b32 v32, 16, v26
    v_and_b32 v33, 0xffff0000, v26
    v_sub_f32 v20, v20, v32
    v_sub_f32 v21, v21, v33
    v_lshlrev_b32 v32, 16, v27
    v_and_b32 v33, 0xffff0000, v27
    v_sub_f32 v22, v22, v32
    v_sub_f32 v23, v23, v33
    v_cvt_pk_bf16_f32 v28, v16, v17
    v_cvt_pk_bf16_f32 v29, v18, v19
    v_cvt_pk_bf16_f32 v30, v20, v21
    v_cvt_pk_bf16_f32 v31, v22, v23
    v_cmp_lt_u32 vcc, 1, v9
    s_lshl_b32 s28, s3, 10
    s_add_u32 s28, s28, 133120
    v_add_u32 v14, s28, v1
    v_cndmask_b32 v24, v24, v28, vcc
    v_cndmask_b32 v25, v25, v29, vcc
    v_cndmask_b32 v26, v26, v30, vcc
    v_cndmask_b32 v27, v27, v31, vcc
    ds_write_b128 v14, v[24:27]
    v_mov_b32 v12, 0
    v_mov_b32 v13, 0
    v_mov_b32 v14, 0
    v_mov_b32 v15, 0
    s_mul_i32 s28, s3, 38912
    s_add_u32 s28, s28, 21376
    v_add_u32 v16, s28, v1
    ds_write_b128 v16, v[12:15]
    s_mov_b64 exec, 0xff
    ds_write_b128 v16, v[12:15] offset:1024
    s_mov_b64 exec, -1
    s_lshl_b32 s28, s3, 2
    s_add_u32 s28, s28, 155648
    v_mov_b32 v16, s28
    ds_write_b32 v16, v12
    s_lshl_b32 s28, s3, 3
    s_add_u32 s28, s28, 155680
    v_mov_b32 v16, s28
    ds_write_b64 v16, v[12:13]
    s_lshl_b32 s28, s3, 3
    s_add_u32 s28, s28, 155712
    v_mov_b32 v16, s28
    ds_write_b64 v16, v[12:13]
    v_mov_b32 v16, 155664
    ds_write_b32 v16, v12
    v_mov_b32 v16, 155744
    v_mov_b32 v17, 1
    ds_write_b32 v16, v17
    s_waitcnt lgkmcnt(0)
    s_barrier
    v_mov_b32 v80, 0
    v_mov_b32 v81, 0
    v_mov_b32 v82, 0
    v_mov_b32 v83, 0
    v_mov_b32 v84, 0
    v_mov_b32 v85, 0
    v_mov_b32 v86, 0
    v_mov_b32 v87, 0
    v_mov_b32 v88, 0
    v_mov_b32 v89, 0
    v_mov_b32 v90, 0
    v_mov_b32 v91, 0
    v_mov_b32 v92, 0
    v_mov_b32 v93, 0
    v_mov_b32 v94, 0
    v_mov_b32 v95, 0
    v_mov_b32 v96, 0
    v_mov_b32 v97, 0
    v_mov_b32 v98, 0
    v_mov_b32 v99, 0
    v_mov_b32 v100, 0
    v_mov_b32 v101, 0
    v_mov_b32 v102, 0
    v_mov_b32 v103, 0
    v_mov_b32 v104, 0
    v_mov_b32 v105, 0
    v_mov_b32 v106, 0
    v_mov_b32 v107, 0
    v_mov_b32 v108, 0
    v_mov_b32 v109, 0
    v_mov_b32 v110, 0
    v_mov_b32 v111, 0
    v_mov_b32 v112, 0
    v_mov_b32 v113, 0
    v_mov_b32 v114, 0
    v_mov_b32 v115, 0
    v_mov_b32 v116, 0
    v_mov_b32 v117, 0
    v_mov_b32 v118, 0
    v_mov_b32 v119, 0
    v_mov_b32 v120, 0
    v_mov_b32 v121, 0
    v_mov_b32 v122, 0
    v_mov_b32 v123, 0
    v_mov_b32 v124, 0
    v_mov_b32 v125, 0
    v_mov_b32 v126, 0
    v_mov_b32 v127, 0
    v_mov_b32 v128, 0
    v_mov_b32 v129, 0
    v_mov_b32 v130, 0
    v_mov_b32 v131, 0
    v_mov_b32 v132, 0
    v_mov_b32 v133, 0
    v_mov_b32 v134, 0
    v_mov_b32 v135, 0
    v_mov_b32 v136, 0
    v_mov_b32 v137, 0
    v_mov_b32 v138, 0
    v_mov_b32 v139, 0
    v_mov_b32 v140, 0
    v_mov_b32 v141, 0
    v_mov_b32 v142, 0
    v_mov_b32 v143, 0
    v_mov_b32 v144, 0
    v_mov_b32 v145, 0
    v_mov_b32 v146, 0
    v_mov_b32 v147, 0
    v_mov_b32 v148, 0
    v_mov_b32 v149, 0
    v_mov_b32 v150, 0
    v_mov_b32 v151, 0
    v_mov_b32 v152, 0
    v_mov_b32 v153, 0
    v_mov_b32 v154, 0
    v_mov_b32 v155, 0
    v_mov_b32 v156, 0
    v_mov_b32 v157, 0
    v_mov_b32 v158, 0
    v_mov_b32 v159, 0
    v_mov_b32 v160, 0
    v_mov_b32 v161, 0
    v_mov_b32 v162, 0
    v_mov_b32 v163, 0
    v_mov_b32 v164, 0
    v_mov_b32 v165, 0
    v_mov_b32 v166, 0
    v_mov_b32 v167, 0
    v_mov_b32 v168, 0
    v_mov_b32 v169, 0
    v_mov_b32 v170, 0
    v_mov_b32 v171, 0
    v_mov_b32 v172, 0
    v_mov_b32 v173, 0
    v_mov_b32 v174, 0
    v_mov_b32 v175, 0
    v_mov_b32 v176, 0
    v_mov_b32 v177, 0
    v_mov_b32 v178, 0
    v_mov_b32 v179, 0
    v_mov_b32 v180, 0
    v_mov_b32 v181, 0
    v_mov_b32 v182, 0
    v_mov_b32 v183, 0
    v_mov_b32 v184, 0
    v_mov_b32 v185, 0
    v_mov_b32 v186, 0
    v_mov_b32 v187, 0
    v_mov_b32 v188, 0
    v_mov_b32 v189, 0
    v_mov_b32 v190, 0
    v_mov_b32 v191, 0
    v_mov_b32 v192, 0
    v_mov_b32 v193, 0
    v_mov_b32 v194, 0
    v_mov_b32 v195, 0
    v_mov_b32 v196, 0
    v_mov_b32 v197, 0
    v_mov_b32 v198, 0
    v_mov_b32 v199, 0
    v_mov_b32 v200, 0
    v_mov_b32 v201, 0
    v_mov_b32 v202, 0
    v_mov_b32 v203, 0
    v_mov_b32 v204, 0
    v_mov_b32 v205, 0
    v_mov_b32 v206, 0
    v_mov_b32 v207, 0
    v_mov_b32 v208, 0
    v_mov_b32 v209, 0
    v_mov_b32 v210, 0
    v_mov_b32 v211, 0
    v_mov_b32 v212, 0
    v_mov_b32 v213, 0
    v_mov_b32 v214, 0
    v_mov_b32 v215, 0
    v_mov_b32 v216, 0
    v_mov_b32 v217, 0
    v_mov_b32 v218, 0
    v_mov_b32 v219, 0
    v_mov_b32 v220, 0
    v_mov_b32 v221, 0
    v_mov_b32 v222, 0
    v_mov_b32 v223, 0
    v_mov_b32 v224, 0
    v_mov_b32 v225, 0
    v_mov_b32 v226, 0
    v_mov_b32 v227, 0
    v_mov_b32 v228, 0
    v_mov_b32 v229, 0
    v_mov_b32 v230, 0
    v_mov_b32 v231, 0
    v_mov_b32 v232, 0
    v_mov_b32 v233, 0
    v_mov_b32 v234, 0
    v_mov_b32 v235, 0
    v_mov_b32 v236, 0
    v_mov_b32 v237, 0
    v_mov_b32 v238, 0
    v_mov_b32 v239, 0
    v_mov_b32 v240, 0
    v_mov_b32 v241, 0
    v_mov_b32 v242, 0
    v_mov_b32 v243, 0
    v_mov_b32 v244, 0
    v_mov_b32 v245, 0
    v_mov_b32 v246, 0
    v_mov_b32 v247, 0
    v_mov_b32 v248, 0
    v_mov_b32 v249, 0
    v_mov_b32 v250, 0
    v_mov_b32 v251, 0
    v_mov_b32 v252, 0
    v_mov_b32 v253, 0
    v_mov_b32 v254, 0
    v_mov_b32 v255, 0
    s_barrier
    s_mov_b32 s40, 2
    v_mov_b32 v0, s40
    s_waitcnt vmcnt(21)
    ds_write_b32 v7, v0
    s_branch K12_S0
K12_Q0:
    ds_read_b64_tr_b16 v[40:41], v4 offset:0
    ds_read_b64_tr_b16 v[42:43], v4 offset:2048
    ds_read_b64_tr_b16 v[44:45], v4 offset:256
    ds_read_b64_tr_b16 v[46:47], v4 offset:2304
    v_xor_b32 v4, 32, v4
    ds_read_b64_tr_b16 v[48:49], v4 offset:0
    ds_read_b64_tr_b16 v[50:51], v4 offset:2048
    ds_read_b64_tr_b16 v[52:53], v4 offset:256
    ds_read_b64_tr_b16 v[54:55], v4 offset:2304
    v_xor_b32 v4, 32, v4
    ds_read_b128 v[8:11], v2 offset:0
    ds_read_b128 v[12:15], v3 offset:0
    ds_read_b128 v[16:19], v2 offset:2048
    ds_read_b128 v[20:23], v3 offset:2048
    ds_read_b128 v[32:35], v2 offset:6144
    ds_read_b128 v[36:39], v3 offset:6144
    s_waitcnt lgkmcnt(6)
    v_xor_b32 v72, s35, v44
    v_xor_b32 v73, s35, v45
    v_xor_b32 v74, s35, v46
    v_xor_b32 v75, s35, v47
    v_xor_b32 v76, s35, v52
    v_xor_b32 v77, s35, v53
    v_xor_b32 v78, s35, v54
    v_xor_b32 v79, s35, v55
    s_mov_b32 s41, 0
    s_mov_b32 s42, 38912
    s_mov_b32 s39, 0
    s_mov_b32 s29, 116736
K12_LOOP:
    s_waitcnt lgkmcnt(4)
    v_mfma_f32_16x16x32_bf16 v[80:83], v[8:11], v[40:43], v[80:83]
    ds_read_b128 v[24:27], v2 offset:4096
    v_mfma_f32_16x16x32_bf16 v[84:87], v[8:11], v[44:47], v[84:87]
    ds_read_b128 v[28:31], v3 offset:4096
    v_mfma_f32_16x16x32_bf16 v[88:91], v[8:11], v[48:51], v[88:91]
    s_add_u32 s49, s39, 2
    s_lshr_b32 s49, s49, 1
    v_mfma_f32_16x16x32_bf16 v[92:95], v[8:11], v[52:55], v[92:95]
    s_mul_i32 s48, s49, s50
    s_add_u32 s48, s48, s47
    v_mfma_f32_16x16x32_bf16 v[80:83], v[12:15], v[72:75], v[80:83]
    s_add_u32 m0, s29, s36
    s_nop 0
    buffer_load_dwordx4 v1, s[8:11], s30 offen sc1 lds
    v_mfma_f32_16x16x32_bf16 v[84:87], v[12:15], v[40:43], v[84:87]
    s_cmp_lt_u32 s49, 8
    s_cselect_b32 s48, s48, 155744
    v_mfma_f32_16x16x32_bf16 v[88:91], v[12:15], v[76:79], v[88:91]
    s_cmp_ge_u32 s49, 3
    s_cselect_b32 s48, s48, 155744
    v_mfma_f32_16x16x32_bf16 v[92:95], v[12:15], v[48:51], v[92:95]
    s_waitcnt lgkmcnt(4)
    v_mfma_f32_16x16x32_bf16 v[96:99], v[16:19], v[40:43], v[96:99]
    ds_read_b128 v[8:11], v2 offset:8192
    v_mfma_f32_16x16x32_bf16 v[100:103], v[16:19], v[44:47], v[100:103]
    ds_read_b128 v[12:15], v3 offset:8192
    v_mfma_f32_16x16x32_bf16 v[104:107], v[16:19], v[48:51], v[104:107]
    buffer_load_dwordx4 v1, s[8:11], s30 offen offset:1024 sc1 lds
    v_mfma_f32_16x16x32_bf16 v[108:111], v[16:19], v[52:55], v[108:111]
    v_mfma_f32_16x16x32_bf16 v[96:99], v[20:23], v[72:75], v[96:99]
    v_mfma_f32_16x16x32_bf16 v[100:103], v[20:23], v[40:43], v[100:103]
    v_mfma_f32_16x16x32_bf16 v[104:107], v[20:23], v[76:79], v[104:107]
    buffer_load_dwordx4 v1, s[8:11], s30 offen offset:2048 sc1 lds
    v_mfma_f32_16x16x32_bf16 v[108:111], v[20:23], v[48:51], v[108:111]
    s_waitcnt lgkmcnt(2)
    v_mfma_f32_16x16x32_bf16 v[112:115], v[24:27], v[40:43], v[112:115]
    ds_read_b128 v[16:19], v2 offset:10240
    v_mfma_f32_16x16x32_bf16 v[116:119], v[24:27], v[44:47], v[116:119]
    ds_read_b128 v[20:23], v3 offset:10240
    v_mfma_f32_16x16x32_bf16 v[120:123], v[24:27], v[48:51], v[120:123]
    v_mfma_f32_16x16x32_bf16 v[124:127], v[24:27], v[52:55], v[124:127]
    v_mfma_f32_16x16x32_bf16 v[112:115], v[28:31], v[72:75], v[112:115]
    buffer_load_dwordx4 v1, s[8:11], s30 offen offset:3072 sc1 lds
    v_mfma_f32_16x16x32_bf16 v[116:119], v[28:31], v[40:43], v[116:119]
    v_mfma_f32_16x16x32_bf16 v[120:123], v[28:31], v[76:79], v[120:123]
    v_mfma_f32_16x16x32_bf16 v[124:127], v[28:31], v[48:51], v[124:127]
    v_mfma_f32_16x16x32_bf16 v[128:131], v[32:35], v[40:43], v[128:131]
    ds_read_b128 v[24:27], v2 offset:12288
    v_mfma_f32_16x16x32_bf16 v[132:135], v[32:35], v[44:47], v[132:135]
    ds_read_b128 v[28:31], v3 offset:12288
    v_mfma_f32_16x16x32_bf16 v[136:139], v[32:35], v[48:51], v[136:139]
    s_add_u32 m0, m0, 4096
    s_add_u32 s34, s30, 4096
    buffer_load_dwordx4 v1, s[8:11], s34 offen sc1 lds
    v_mfma_f32_16x16x32_bf16 v[140:143], v[32:35], v[52:55], v[140:143]
    v_mfma_f32_16x16x32_bf16 v[128:131], v[36:39], v[72:75], v[128:131]
    v_mfma_f32_16x16x32_bf16 v[132:135], v[36:39], v[40:43], v[132:135]
    v_mfma_f32_16x16x32_bf16 v[136:139], v[36:39], v[76:79], v[136:139]
    s_add_u32 m0, s29, s37
    s_add_u32 s30, s30, 21376
    buffer_load_dwordx4 v1, s[12:15], s31 offen sc1 lds
    v_mfma_f32_16x16x32_bf16 v[140:143], v[36:39], v[48:51], v[140:143]
    s_waitcnt lgkmcnt(4)
    v_mfma_f32_16x16x32_bf16 v[144:147], v[8:11], v[40:43], v[144:147]
    ds_read_b128 v[32:35], v2 offset:14336
    v_mfma_f32_16x16x32_bf16 v[148:151], v[8:11], v[44:47], v[148:151]
    ds_read_b128 v[36:39], v3 offset:14336
    v_mfma_f32_16x16x32_bf16 v[152:155], v[8:11], v[48:51], v[152:155]
    v_mfma_f32_16x16x32_bf16 v[156:159], v[8:11], v[52:55], v[156:159]
    v_mfma_f32_16x16x32_bf16 v[144:147], v[12:15], v[72:75], v[144:147]
    buffer_load_dwordx4 v1, s[12:15], s31 offen offset:1024 sc1 lds
    v_mfma_f32_16x16x32_bf16 v[148:151], v[12:15], v[40:43], v[148:151]
    v_mfma_f32_16x16x32_bf16 v[152:155], v[12:15], v[76:79], v[152:155]
    v_mfma_f32_16x16x32_bf16 v[156:159], v[12:15], v[48:51], v[156:159]
    s_waitcnt lgkmcnt(4)
    v_mfma_f32_16x16x32_bf16 v[160:163], v[16:19], v[40:43], v[160:163]
    ds_read_b128 v[8:11], v2 offset:16384
    v_mfma_f32_16x16x32_bf16 v[164:167], v[16:19], v[44:47], v[164:167]
    ds_read_b128 v[12:15], v3 offset:16384
    v_mfma_f32_16x16x32_bf16 v[168:171], v[16:19], v[48:51], v[168:171]
    buffer_load_dwordx4 v1, s[12:15], s31 offen offset:2048 sc1 lds
    v_mfma_f32_16x16x32_bf16 v[172:175], v[16:19], v[52:55], v[172:175]
    v_mfma_f32_16x16x32_bf16 v[160:163], v[20:23], v[72:75], v[160:163]
    v_mfma_f32_16x16x32_bf16 v[164:167], v[20:23], v[40:43], v[164:167]
    v_mfma_f32_16x16x32_bf16 v[168:171], v[20:23], v[76:79], v[168:171]
    buffer_load_dwordx4 v1, s[12:15], s31 offen offset:3072 sc1 lds
    v_mfma_f32_16x16x32_bf16 v[172:175], v[20:23], v[48:51], v[172:175]
    s_waitcnt lgkmcnt(4)
    v_mfma_f32_16x16x32_bf16 v[176:179], v[24:27], v[40:43], v[176:179]
    ds_read_b128 v[16:19], v2 offset:18432
    v_mfma_f32_16x16x32_bf16 v[180:183], v[24:27], v[44:47], v[180:183]
    ds_read_b128 v[20:23], v3 offset:18432
    v_mov_b32 v0, s48
    v_mfma_f32_16x16x32_bf16 v[184:187], v[24:27], v[48:51], v[184:187]
    ds_read_b32 v0, v0
    v_mfma_f32_16x16x32_bf16 v[188:191], v[24:27], v[52:55], v[188:191]
    v_mfma_f32_16x16x32_bf16 v[176:179], v[28:31], v[72:75], v[176:179]
    s_add_u32 m0, s29, s38
    s_mov_b64 exec, s[44:45]
    buffer_load_dwordx4 v1, s[8:11], s33 offen sc1 lds
    s_mov_b64 exec, -1
    s_add_u32 s31, s31, 16384
    s_add_u32 s33, s33, 21376
    v_mfma_f32_16x16x32_bf16 v[180:183], v[28:31], v[40:43], v[180:183]
    v_mfma_f32_16x16x32_bf16 v[184:187], v[28:31], v[76:79], v[184:187]
    v_mfma_f32_16x16x32_bf16 v[188:191], v[28:31], v[48:51], v[188:191]
    s_waitcnt lgkmcnt(0)
    v_cmp_eq_u32 vcc, 0, v0
    s_waitcnt lgkmcnt(5)
    v_mfma_f32_16x16x32_bf16 v[192:195], v[32:35], v[40:43], v[192:195]
    ds_read_b128 v[24:27], v2 offset:20480
    v_mfma_f32_16x16x32_bf16 v[196:199], v[32:35], v[44:47], v[196:199]
    ds_read_b128 v[28:31], v3 offset:20480
    s_cbranch_vccnz K12_F1
K12_G1:
    v_mfma_f32_16x16x32_bf16 v[200:203], v[32:35], v[48:51], v[200:203]
    s_sub_u32 s43, s42, s41
    s_add_u32 s40, s40, 1
    v_add_u32 v2, s43, v2
    v_mfma_f32_16x16x32_bf16 v[204:207], v[32:35], v[52:55], v[204:207]
    v_add_u32 v3, s43, v3
    v_add_u32 v4, s43, v4
    v_mov_b32 v0, s40
    v_mfma_f32_16x16x32_bf16 v[192:195], v[36:39], v[72:75], v[192:195]
    s_waitcnt vmcnt(21)
    ds_write_b32 v7, v0
    v_mfma_f32_16x16x32_bf16 v[196:199], v[36:39], v[40:43], v[196:199]
    v_mfma_f32_16x16x32_bf16 v[200:203], v[36:39], v[76:79], v[200:203]
    v_mfma_f32_16x16x32_bf16 v[204:207], v[36:39], v[48:51], v[204:207]
    ds_read_b32 v56, v5
    s_waitcnt lgkmcnt(7)
    v_mfma_f32_16x16x32_bf16 v[208:211], v[8:11], v[40:43], v[208:211]
    v_mfma_f32_16x16x32_bf16 v[212:215], v[8:11], v[44:47], v[212:215]
    v_mfma_f32_16x16x32_bf16 v[216:219], v[8:11], v[48:51], v[216:219]
    v_mfma_f32_16x16x32_bf16 v[220:223], v[8:11], v[52:55], v[220:223]
    s_waitcnt lgkmcnt(0)
    v_cmp_gt_u32 vcc, s40, v56
    v_mfma_f32_16x16x32_bf16 v[208:211], v[12:15], v[72:75], v[208:211]
    v_mfma_f32_16x16x32_bf16 v[212:215], v[12:15], v[40:43], v[212:215]
    s_cbranch_vccnz K12_S2
K12_Q2:
    v_mfma_f32_16x16x32_bf16 v[216:219], v[12:15], v[76:79], v[216:219]
    ds_read_b64_tr_b16 v[56:57], v4 offset:0
    v_mfma_f32_16x16x32_bf16 v[220:223], v[12:15], v[48:51], v[220:223]
    ds_read_b64_tr_b16 v[58:59], v4 offset:2048
    v_mfma_f32_16x16x32_bf16 v[224:227], v[16:19], v[40:43], v[224:227]
    ds_read_b64_tr_b16 v[60:61], v4 offset:256
    v_mfma_f32_16x16x32_bf16 v[228:231], v[16:19], v[44:47], v[228:231]
    ds_read_b64_tr_b16 v[62:63], v4 offset:2304
    v_mfma_f32_16x16x32_bf16 v[232:235], v[16:19], v[48:51], v[232:235]
    v_xor_b32 v4, 32, v4
    v_mfma_f32_16x16x32_bf16 v[236:239], v[16:19], v[52:55], v[236:239]
    ds_read_b64_tr_b16 v[64:65], v4 offset:0
    v_mfma_f32_16x16x32_bf16 v[224:227], v[20:23], v[72:75], v[224:227]
    ds_read_b64_tr_b16 v[66:67], v4 offset:2048
    v_mfma_f32_16x16x32_bf16 v[228:231], v[20:23], v[40:43], v[228:231]
    ds_read_b64_tr_b16 v[68:69], v4 offset:256
    ds_read_b64_tr_b16 v[70:71], v4 offset:2304
    v_xor_b32 v4, 32, v4
    v_mfma_f32_16x16x32_bf16 v[232:235], v[20:23], v[76:79], v[232:235]
    ds_read_b128 v[8:11], v2 offset:0
    v_mfma_f32_16x16x32_bf16 v[236:239], v[20:23], v[48:51], v[236:239]
    ds_read_b128 v[12:15], v3 offset:0
    v_mfma_f32_16x16x32_bf16 v[240:243], v[24:27], v[40:43], v[240:243]
    ds_read_b128 v[16:19], v2 offset:2048
    v_mfma_f32_16x16x32_bf16 v[244:247], v[24:27], v[44:47], v[244:247]
    ds_read_b128 v[20:23], v3 offset:2048
    v_mfma_f32_16x16x32_bf16 v[248:251], v[24:27], v[48:51], v[248:251]
    ds_read_b128 v[32:35], v2 offset:6144
    v_mfma_f32_16x16x32_bf16 v[252:255], v[24:27], v[52:55], v[252:255]
    ds_read_b128 v[36:39], v3 offset:6144
    s_mov_b32 s29, s41
    s_mov_b32 s41, s42
    s_add_u32 s42, s42, 38912
    v_mfma_f32_16x16x32_bf16 v[240:243], v[28:31], v[72:75], v[240:243]
    s_waitcnt lgkmcnt(6)
    v_xor_b32 v72, s35, v60
    v_xor_b32 v73, s35, v61
    v_mfma_f32_16x16x32_bf16 v[244:247], v[28:31], v[40:43], v[244:247]
    v_xor_b32 v74, s35, v62
    v_xor_b32 v75, s35, v63
    s_cmp_eq_u32 s42, 155648
    s_cselect_b32 s42, 0, s42
    v_mfma_f32_16x16x32_bf16 v[248:251], v[28:31], v[76:79], v[248:251]
    v_xor_b32 v76, s35, v68
    v_xor_b32 v77, s35, v69
    v_mfma_f32_16x16x32_bf16 v[252:255], v[28:31], v[48:51], v[252:255]
    v_xor_b32 v78, s35, v70
    v_xor_b32 v79, s35, v71
    s_waitcnt lgkmcnt(4)
    v_mfma_f32_16x16x32_bf16 v[80:83], v[8:11], v[56:59], v[80:83]
    ds_read_b128 v[24:27], v2 offset:4096
    v_mfma_f32_16x16x32_bf16 v[84:87], v[8:11], v[60:63], v[84:87]
    ds_read_b128 v[28:31], v3 offset:4096
    v_mfma_f32_16x16x32_bf16 v[88:91], v[8:11], v[64:67], v[88:91]
    v_mfma_f32_16x16x32_bf16 v[92:95], v[8:11], v[68:71], v[92:95]
    v_mfma_f32_16x16x32_bf16 v[80:83], v[12:15], v[72:75], v[80:83]
    s_add_u32 m0, s29, s36
    s_nop 0
    buffer_load_dwordx4 v1, s[8:11], s30 offen sc1 lds
    v_mfma_f32_16x16x32_bf16 v[84:87], v[12:15], v[56:59], v[84:87]
    v_mfma_f32_16x16x32_bf16 v[88:91], v[12:15], v[76:79], v[88:91]
    v_mfma_f32_16x16x32_bf16 v[92:95], v[12:15], v[64:67], v[92:95]
    s_waitcnt lgkmcnt(4)
    v_mfma_f32_16x16x32_bf16 v[96:99], v[16:19], v[56:59], v[96:99]
    ds_read_b128 v[8:11], v2 offset:8192
    v_mfma_f32_16x16x32_bf16 v[100:103], v[16:19], v[60:63], v[100:103]
    ds_read_b128 v[12:15], v3 offset:8192
    v_mfma_f32_16x16x32_bf16 v[104:107], v[16:19], v[64:67], v[104:107]
    buffer_load_dwordx4 v1, s[8:11], s30 offen offset:1024 sc1 lds
    v_mfma_f32_16x16x32_bf16 v[108:111], v[16:19], v[68:71], v[108:111]
    v_mfma_f32_16x16x32_bf16 v[96:99], v[20:23], v[72:75], v[96:99]
    v_mfma_f32_16x16x32_bf16 v[100:103], v[20:23], v[56:59], v[100:103]
    v_mfma_f32_16x16x32_bf16 v[104:107], v[20:23], v[76:79], v[104:107]
    buffer_load_dwordx4 v1, s[8:11], s30 offen offset:2048 sc1 lds
    v_mfma_f32_16x16x32_bf16 v[108:111], v[20:23], v[64:67], v[108:111]
    s_waitcnt lgkmcnt(2)
    v_mfma_f32_16x16x32_bf16 v[112:115], v[24:27], v[56:59], v[112:115]
    ds_read_b128 v[16:19], v2 offset:10240
    v_mfma_f32_16x16x32_bf16 v[116:119], v[24:27], v[60:63], v[116:119]
    ds_read_b128 v[20:23], v3 offset:10240
    v_mfma_f32_16x16x32_bf16 v[120:123], v[24:27], v[64:67], v[120:123]
    v_mfma_f32_16x16x32_bf16 v[124:127], v[24:27], v[68:71], v[124:127]
    v_mfma_f32_16x16x32_bf16 v[112:115], v[28:31], v[72:75], v[112:115]
    buffer_load_dwordx4 v1, s[8:11], s30 offen offset:3072 sc1 lds
    v_mfma_f32_16x16x32_bf16 v[116:119], v[28:31], v[56:59], v[116:119]
    v_mfma_f32_16x16x32_bf16 v[120:123], v[28:31], v[76:79], v[120:123]
    v_mfma_f32_16x16x32_bf16 v[124:127], v[28:31], v[64:67], v[124:127]
    v_mfma_f32_16x16x32_bf16 v[128:131], v[32:35], v[56:59], v[128:131]
    ds_read_b128 v[24:27], v2 offset:12288
    v_mfma_f32_16x16x32_bf16 v[132:135], v[32:35], v[60:63], v[132:135]
    ds_read_b128 v[28:31], v3 offset:12288
    v_mfma_f32_16x16x32_bf16 v[136:139], v[32:35], v[64:67], v[136:139]
    s_add_u32 m0, m0, 4096
    s_add_u32 s34, s30, 4096
    buffer_load_dwordx4 v1, s[8:11], s34 offen sc1 lds
    v_mfma_f32_16x16x32_bf16 v[140:143], v[32:35], v[68:71], v[140:143]
    v_mfma_f32_16x16x32_bf16 v[128:131], v[36:39], v[72:75], v[128:131]
    v_mfma_f32_16x16x32_bf16 v[132:135], v[36:39], v[56:59], v[132:135]
    v_mfma_f32_16x16x32_bf16 v[136:139], v[36:39], v[76:79], v[136:139]
    s_add_u32 m0, s29, s37
    s_add_u32 s30, s30, 21376
    buffer_load_dwordx4 v1, s[12:15], s31 offen sc1 lds
    v_mfma_f32_16x16x32_bf16 v[140:143], v[36:39], v[64:67], v[140:143]
    s_waitcnt lgkmcnt(4)
    v_mfma_f32_16x16x32_bf16 v[144:147], v[8:11], v[56:59], v[144:147]
    ds_read_b128 v[32:35], v2 offset:14336
    v_mfma_f32_16x16x32_bf16 v[148:151], v[8:11], v[60:63], v[148:151]
    ds_read_b128 v[36:39], v3 offset:14336
    v_mfma_f32_16x16x32_bf16 v[152:155], v[8:11], v[64:67], v[152:155]
    v_mfma_f32_16x16x32_bf16 v[156:159], v[8:11], v[68:71], v[156:159]
    v_mfma_f32_16x16x32_bf16 v[144:147], v[12:15], v[72:75], v[144:147]
    buffer_load_dwordx4 v1, s[12:15], s31 offen offset:1024 sc1 lds
    v_mfma_f32_16x16x32_bf16 v[148:151], v[12:15], v[56:59], v[148:151]
    v_mfma_f32_16x16x32_bf16 v[152:155], v[12:15], v[76:79], v[152:155]
    v_mfma_f32_16x16x32_bf16 v[156:159], v[12:15], v[64:67], v[156:159]
    s_waitcnt lgkmcnt(4)
    v_mfma_f32_16x16x32_bf16 v[160:163], v[16:19], v[56:59], v[160:163]
    ds_read_b128 v[8:11], v2 offset:16384
    v_mfma_f32_16x16x32_bf16 v[164:167], v[16:19], v[60:63], v[164:167]
    ds_read_b128 v[12:15], v3 offset:16384
    v_mfma_f32_16x16x32_bf16 v[168:171], v[16:19], v[64:67], v[168:171]
    buffer_load_dwordx4 v1, s[12:15], s31 offen offset:2048 sc1 lds
    v_mfma_f32_16x16x32_bf16 v[172:175], v[16:19], v[68:71], v[172:175]
    v_mfma_f32_16x16x32_bf16 v[160:163], v[20:23], v[72:75], v[160:163]
    v_mfma_f32_16x16x32_bf16 v[164:167], v[20:23], v[56:59], v[164:167]
    v_mfma_f32_16x16x32_bf16 v[168:171], v[20:23], v[76:79], v[168:171]
    buffer_load_dwordx4 v1, s[12:15], s31 offen offset:3072 sc1 lds
    v_mfma_f32_16x16x32_bf16 v[172:175], v[20:23], v[64:67], v[172:175]
    s_waitcnt lgkmcnt(4)
    v_mfma_f32_16x16x32_bf16 v[176:179], v[24:27], v[56:59], v[176:179]
    ds_read_b128 v[16:19], v2 offset:18432
    v_mfma_f32_16x16x32_bf16 v[180:183], v[24:27], v[60:63], v[180:183]
    ds_read_b128 v[20:23], v3 offset:18432
    v_mfma_f32_16x16x32_bf16 v[184:187], v[24:27], v[64:67], v[184:187]
    v_mfma_f32_16x16x32_bf16 v[188:191], v[24:27], v[68:71], v[188:191]
    v_mfma_f32_16x16x32_bf16 v[176:179], v[28:31], v[72:75], v[176:179]
    s_add_u32 m0, s29, s38
    s_mov_b64 exec, s[44:45]
    buffer_load_dwordx4 v1, s[8:11], s33 offen sc1 lds
    s_mov_b64 exec, -1
    s_add_u32 s31, s31, 16384
    s_add_u32 s33, s33, 21376
    v_mfma_f32_16x16x32_bf16 v[180:183], v[28:31], v[56:59], v[180:183]
    v_mfma_f32_16x16x32_bf16 v[184:187], v[28:31], v[76:79], v[184:187]
    s_mov_b32 m0, s46
    s_mov_b64 exec, 0xff
    buffer_load_dword v1, s[4:7], 0 offen sc1 lds
    s_mov_b64 exec, -1
    v_mfma_f32_16x16x32_bf16 v[188:191], v[28:31], v[64:67], v[188:191]
    s_waitcnt lgkmcnt(4)
    v_mfma_f32_16x16x32_bf16 v[192:195], v[32:35], v[56:59], v[192:195]
    ds_read_b128 v[24:27], v2 offset:20480
    v_mfma_f32_16x16x32_bf16 v[196:199], v[32:35], v[60:63], v[196:199]
    ds_read_b128 v[28:31], v3 offset:20480
    v_mfma_f32_16x16x32_bf16 v[200:203], v[32:35], v[64:67], v[200:203]
    s_sub_u32 s43, s42, s41
    s_add_u32 s40, s40, 1
    v_add_u32 v2, s43, v2
    v_mfma_f32_16x16x32_bf16 v[204:207], v[32:35], v[68:71], v[204:207]
    v_add_u32 v3, s43, v3
    v_add_u32 v4, s43, v4
    v_mov_b32 v0, s40
    v_mfma_f32_16x16x32_bf16 v[192:195], v[36:39], v[72:75], v[192:195]
    s_waitcnt vmcnt(21)
    ds_write_b32 v7, v0
    v_mfma_f32_16x16x32_bf16 v[196:199], v[36:39], v[56:59], v[196:199]
    v_mfma_f32_16x16x32_bf16 v[200:203], v[36:39], v[76:79], v[200:203]
    v_mfma_f32_16x16x32_bf16 v[204:207], v[36:39], v[64:67], v[204:207]
    ds_read_b32 v40, v5
    s_waitcnt lgkmcnt(6)
    v_mfma_f32_16x16x32_bf16 v[208:211], v[8:11], v[56:59], v[208:211]
    v_mfma_f32_16x16x32_bf16 v[212:215], v[8:11], v[60:63], v[212:215]
    v_mfma_f32_16x16x32_bf16 v[216:219], v[8:11], v[64:67], v[216:219]
    v_mfma_f32_16x16x32_bf16 v[220:223], v[8:11], v[68:71], v[220:223]
    s_waitcnt lgkmcnt(0)
    v_cmp_gt_u32 vcc, s40, v40
    v_mfma_f32_16x16x32_bf16 v[208:211], v[12:15], v[72:75], v[208:211]
    v_mfma_f32_16x16x32_bf16 v[212:215], v[12:15], v[56:59], v[212:215]
    s_cbranch_vccnz K12_S3
K12_Q3:
    v_mfma_f32_16x16x32_bf16 v[216:219], v[12:15], v[76:79], v[216:219]
    ds_read_b64_tr_b16 v[40:41], v4 offset:0
    v_mfma_f32_16x16x32_bf16 v[220:223], v[12:15], v[64:67], v[220:223]
    ds_read_b64_tr_b16 v[42:43], v4 offset:2048
    v_mfma_f32_16x16x32_bf16 v[224:227], v[16:19], v[56:59], v[224:227]
    ds_read_b64_tr_b16 v[44:45], v4 offset:256
    v_mfma_f32_16x16x32_bf16 v[228:231], v[16:19], v[60:63], v[228:231]
    ds_read_b64_tr_b16 v[46:47], v4 offset:2304
    v_mfma_f32_16x16x32_bf16 v[232:235], v[16:19], v[64:67], v[232:235]
    v_xor_b32 v4, 32, v4
    v_mfma_f32_16x16x32_bf16 v[236:239], v[16:19], v[68:71], v[236:239]
    ds_read_b64_tr_b16 v[48:49], v4 offset:0
    v_mfma_f32_16x16x32_bf16 v[224:227], v[20:23], v[72:75], v[224:227]
    ds_read_b64_tr_b16 v[50:51], v4 offset:2048
    v_mfma_f32_16x16x32_bf16 v[228:231], v[20:23], v[56:59], v[228:231]
    ds_read_b64_tr_b16 v[52:53], v4 offset:256
    ds_read_b64_tr_b16 v[54:55], v4 offset:2304
    v_xor_b32 v4, 32, v4
    v_mfma_f32_16x16x32_bf16 v[232:235], v[20:23], v[76:79], v[232:235]
    ds_read_b128 v[8:11], v2 offset:0
    v_mfma_f32_16x16x32_bf16 v[236:239], v[20:23], v[64:67], v[236:239]
    ds_read_b128 v[12:15], v3 offset:0
    v_mfma_f32_16x16x32_bf16 v[240:243], v[24:27], v[56:59], v[240:243]
    ds_read_b128 v[16:19], v2 offset:2048
    v_mfma_f32_16x16x32_bf16 v[244:247], v[24:27], v[60:63], v[244:247]
    ds_read_b128 v[20:23], v3 offset:2048
    v_mfma_f32_16x16x32_bf16 v[248:251], v[24:27], v[64:67], v[248:251]
    ds_read_b128 v[32:35], v2 offset:6144
    v_mfma_f32_16x16x32_bf16 v[252:255], v[24:27], v[68:71], v[252:255]
    ds_read_b128 v[36:39], v3 offset:6144
    s_mov_b32 s29, s41
    s_mov_b32 s41, s42
    s_add_u32 s42, s42, 38912
    v_mfma_f32_16x16x32_bf16 v[240:243], v[28:31], v[72:75], v[240:243]
    s_waitcnt lgkmcnt(6)
    v_xor_b32 v72, s35, v44
    v_xor_b32 v73, s35, v45
    v_mfma_f32_16x16x32_bf16 v[244:247], v[28:31], v[56:59], v[244:247]
    v_xor_b32 v74, s35, v46
    v_xor_b32 v75, s35, v47
    s_cmp_eq_u32 s42, 155648
    s_cselect_b32 s42, 0, s42
    v_mfma_f32_16x16x32_bf16 v[248:251], v[28:31], v[76:79], v[248:251]
    v_xor_b32 v76, s35, v52
    v_xor_b32 v77, s35, v53
    v_mfma_f32_16x16x32_bf16 v[252:255], v[28:31], v[64:67], v[252:255]
    v_xor_b32 v78, s35, v54
    v_xor_b32 v79, s35, v55
    s_add_u32 s39, s39, 1
    s_cmp_lt_u32 s39, 16
    s_cbranch_scc1 K12_LOOP
    v_lshrrev_b32 v8, 4, v1
    v_and_b32 v9, 15, v8
    v_lshrrev_b32 v8, 4, v8
    s_lshl_b32 s28, s21, 7
    s_lshl_b32 s29, s3, 5
    s_add_u32 s28, s28, s29
    v_add_u32 v9, s28, v9
    v_lshlrev_b32 v9, 2, v9
    v_lshl_add_u32 v6, v8, 13, v9
    s_nop 2
    s_mov_b32 s38, 0
    v_cvt_pk_bf16_f32 v8, v80, v84
    buffer_store_dword v8, v6, s[16:19], s38 offen offset:0
    v_cvt_pk_bf16_f32 v9, v88, v92
    buffer_store_dword v9, v6, s[16:19], s38 offen offset:64
    v_cvt_pk_bf16_f32 v10, v81, v85
    buffer_store_dword v10, v6, s[16:19], s38 offen offset:2048
    v_cvt_pk_bf16_f32 v11, v89, v93
    buffer_store_dword v11, v6, s[16:19], s38 offen offset:2112
    s_mov_b32 s38, 4096
    v_cvt_pk_bf16_f32 v12, v82, v86
    buffer_store_dword v12, v6, s[16:19], s38 offen offset:0
    v_cvt_pk_bf16_f32 v13, v90, v94
    buffer_store_dword v13, v6, s[16:19], s38 offen offset:64
    v_cvt_pk_bf16_f32 v14, v83, v87
    buffer_store_dword v14, v6, s[16:19], s38 offen offset:2048
    v_cvt_pk_bf16_f32 v15, v91, v95
    buffer_store_dword v15, v6, s[16:19], s38 offen offset:2112
    s_mov_b32 s38, 32768
    v_cvt_pk_bf16_f32 v8, v96, v100
    buffer_store_dword v8, v6, s[16:19], s38 offen offset:0
    v_cvt_pk_bf16_f32 v9, v104, v108
    buffer_store_dword v9, v6, s[16:19], s38 offen offset:64
    v_cvt_pk_bf16_f32 v10, v97, v101
    buffer_store_dword v10, v6, s[16:19], s38 offen offset:2048
    v_cvt_pk_bf16_f32 v11, v105, v109
    buffer_store_dword v11, v6, s[16:19], s38 offen offset:2112
    s_mov_b32 s38, 36864
    v_cvt_pk_bf16_f32 v12, v98, v102
    buffer_store_dword v12, v6, s[16:19], s38 offen offset:0
    v_cvt_pk_bf16_f32 v13, v106, v110
    buffer_store_dword v13, v6, s[16:19], s38 offen offset:64
    v_cvt_pk_bf16_f32 v14, v99, v103
    buffer_store_dword v14, v6, s[16:19], s38 offen offset:2048
    v_cvt_pk_bf16_f32 v15, v107, v111
    buffer_store_dword v15, v6, s[16:19], s38 offen offset:2112
    s_mov_b32 s38, 65536
    v_cvt_pk_bf16_f32 v8, v112, v116
    buffer_store_dword v8, v6, s[16:19], s38 offen offset:0
    v_cvt_pk_bf16_f32 v9, v120, v124
    buffer_store_dword v9, v6, s[16:19], s38 offen offset:64
    v_cvt_pk_bf16_f32 v10, v113, v117
    buffer_store_dword v10, v6, s[16:19], s38 offen offset:2048
    v_cvt_pk_bf16_f32 v11, v121, v125
    buffer_store_dword v11, v6, s[16:19], s38 offen offset:2112
    s_mov_b32 s38, 69632
    v_cvt_pk_bf16_f32 v12, v114, v118
    buffer_store_dword v12, v6, s[16:19], s38 offen offset:0
    v_cvt_pk_bf16_f32 v13, v122, v126
    buffer_store_dword v13, v6, s[16:19], s38 offen offset:64
    v_cvt_pk_bf16_f32 v14, v115, v119
    buffer_store_dword v14, v6, s[16:19], s38 offen offset:2048
    v_cvt_pk_bf16_f32 v15, v123, v127
    buffer_store_dword v15, v6, s[16:19], s38 offen offset:2112
    s_mov_b32 s38, 98304
    v_cvt_pk_bf16_f32 v8, v128, v132
    buffer_store_dword v8, v6, s[16:19], s38 offen offset:0
    v_cvt_pk_bf16_f32 v9, v136, v140
    buffer_store_dword v9, v6, s[16:19], s38 offen offset:64
    v_cvt_pk_bf16_f32 v10, v129, v133
    buffer_store_dword v10, v6, s[16:19], s38 offen offset:2048
    v_cvt_pk_bf16_f32 v11, v137, v141
    buffer_store_dword v11, v6, s[16:19], s38 offen offset:2112
    s_mov_b32 s38, 102400
    v_cvt_pk_bf16_f32 v12, v130, v134
    buffer_store_dword v12, v6, s[16:19], s38 offen offset:0
    v_cvt_pk_bf16_f32 v13, v138, v142
    buffer_store_dword v13, v6, s[16:19], s38 offen offset:64
    v_cvt_pk_bf16_f32 v14, v131, v135
    buffer_store_dword v14, v6, s[16:19], s38 offen offset:2048
    v_cvt_pk_bf16_f32 v15, v139, v143
    buffer_store_dword v15, v6, s[16:19], s38 offen offset:2112
    s_mov_b32 s38, 131072
    v_cvt_pk_bf16_f32 v8, v144, v148
    buffer_store_dword v8, v6, s[16:19], s38 offen offset:0
    v_cvt_pk_bf16_f32 v9, v152, v156
    buffer_store_dword v9, v6, s[16:19], s38 offen offset:64
    v_cvt_pk_bf16_f32 v10, v145, v149
    buffer_store_dword v10, v6, s[16:19], s38 offen offset:2048
    v_cvt_pk_bf16_f32 v11, v153, v157
    buffer_store_dword v11, v6, s[16:19], s38 offen offset:2112
    s_mov_b32 s38, 135168
    v_cvt_pk_bf16_f32 v12, v146, v150
    buffer_store_dword v12, v6, s[16:19], s38 offen offset:0
    v_cvt_pk_bf16_f32 v13, v154, v158
    buffer_store_dword v13, v6, s[16:19], s38 offen offset:64
    v_cvt_pk_bf16_f32 v14, v147, v151
    buffer_store_dword v14, v6, s[16:19], s38 offen offset:2048
    v_cvt_pk_bf16_f32 v15, v155, v159
    buffer_store_dword v15, v6, s[16:19], s38 offen offset:2112
    s_mov_b32 s38, 163840
    v_cvt_pk_bf16_f32 v8, v160, v164
    buffer_store_dword v8, v6, s[16:19], s38 offen offset:0
    v_cvt_pk_bf16_f32 v9, v168, v172
    buffer_store_dword v9, v6, s[16:19], s38 offen offset:64
    v_cvt_pk_bf16_f32 v10, v161, v165
    buffer_store_dword v10, v6, s[16:19], s38 offen offset:2048
    v_cvt_pk_bf16_f32 v11, v169, v173
    buffer_store_dword v11, v6, s[16:19], s38 offen offset:2112
    s_mov_b32 s38, 167936
    v_cvt_pk_bf16_f32 v12, v162, v166
    buffer_store_dword v12, v6, s[16:19], s38 offen offset:0
    v_cvt_pk_bf16_f32 v13, v170, v174
    buffer_store_dword v13, v6, s[16:19], s38 offen offset:64
    v_cvt_pk_bf16_f32 v14, v163, v167
    buffer_store_dword v14, v6, s[16:19], s38 offen offset:2048
    v_cvt_pk_bf16_f32 v15, v171, v175
    buffer_store_dword v15, v6, s[16:19], s38 offen offset:2112
    s_mov_b32 s38, 196608
    v_cvt_pk_bf16_f32 v8, v176, v180
    buffer_store_dword v8, v6, s[16:19], s38 offen offset:0
    v_cvt_pk_bf16_f32 v9, v184, v188
    buffer_store_dword v9, v6, s[16:19], s38 offen offset:64
    v_cvt_pk_bf16_f32 v10, v177, v181
    buffer_store_dword v10, v6, s[16:19], s38 offen offset:2048
    v_cvt_pk_bf16_f32 v11, v185, v189
    buffer_store_dword v11, v6, s[16:19], s38 offen offset:2112
    s_mov_b32 s38, 200704
    v_cvt_pk_bf16_f32 v12, v178, v182
    buffer_store_dword v12, v6, s[16:19], s38 offen offset:0
    v_cvt_pk_bf16_f32 v13, v186, v190
    buffer_store_dword v13, v6, s[16:19], s38 offen offset:64
    v_cvt_pk_bf16_f32 v14, v179, v183
    buffer_store_dword v14, v6, s[16:19], s38 offen offset:2048
    v_cvt_pk_bf16_f32 v15, v187, v191
    buffer_store_dword v15, v6, s[16:19], s38 offen offset:2112
    s_mov_b32 s38, 229376
    v_cvt_pk_bf16_f32 v8, v192, v196
    buffer_store_dword v8, v6, s[16:19], s38 offen offset:0
    v_cvt_pk_bf16_f32 v9, v200, v204
    buffer_store_dword v9, v6, s[16:19], s38 offen offset:64
    v_cvt_pk_bf16_f32 v10, v193, v197
    buffer_store_dword v10, v6, s[16:19], s38 offen offset:2048
    v_cvt_pk_bf16_f32 v11, v201, v205
    buffer_store_dword v11, v6, s[16:19], s38 offen offset:2112
    s_mov_b32 s38, 233472
    v_cvt_pk_bf16_f32 v12, v194, v198
    buffer_store_dword v12, v6, s[16:19], s38 offen offset:0
    v_cvt_pk_bf16_f32 v13, v202, v206
    buffer_store_dword v13, v6, s[16:19], s38 offen offset:64
    v_cvt_pk_bf16_f32 v14, v195, v199
    buffer_store_dword v14, v6, s[16:19], s38 offen offset:2048
    v_cvt_pk_bf16_f32 v15, v203, v207
    buffer_store_dword v15, v6, s[16:19], s38 offen offset:2112
    s_mov_b32 s38, 262144
    v_cvt_pk_bf16_f32 v8, v208, v212
    buffer_store_dword v8, v6, s[16:19], s38 offen offset:0
    v_cvt_pk_bf16_f32 v9, v216, v220
    buffer_store_dword v9, v6, s[16:19], s38 offen offset:64
    v_cvt_pk_bf16_f32 v10, v209, v213
    buffer_store_dword v10, v6, s[16:19], s38 offen offset:2048
    v_cvt_pk_bf16_f32 v11, v217, v221
    buffer_store_dword v11, v6, s[16:19], s38 offen offset:2112
    s_mov_b32 s38, 266240
    v_cvt_pk_bf16_f32 v12, v210, v214
    buffer_store_dword v12, v6, s[16:19], s38 offen offset:0
    v_cvt_pk_bf16_f32 v13, v218, v222
    buffer_store_dword v13, v6, s[16:19], s38 offen offset:64
    v_cvt_pk_bf16_f32 v14, v211, v215
    buffer_store_dword v14, v6, s[16:19], s38 offen offset:2048
    v_cvt_pk_bf16_f32 v15, v219, v223
    buffer_store_dword v15, v6, s[16:19], s38 offen offset:2112
    s_mov_b32 s38, 294912
    v_cvt_pk_bf16_f32 v8, v224, v228
    buffer_store_dword v8, v6, s[16:19], s38 offen offset:0
    v_cvt_pk_bf16_f32 v9, v232, v236
    buffer_store_dword v9, v6, s[16:19], s38 offen offset:64
    v_cvt_pk_bf16_f32 v10, v225, v229
    buffer_store_dword v10, v6, s[16:19], s38 offen offset:2048
    v_cvt_pk_bf16_f32 v11, v233, v237
    buffer_store_dword v11, v6, s[16:19], s38 offen offset:2112
    s_mov_b32 s38, 299008
    v_cvt_pk_bf16_f32 v12, v226, v230
    buffer_store_dword v12, v6, s[16:19], s38 offen offset:0
    v_cvt_pk_bf16_f32 v13, v234, v238
    buffer_store_dword v13, v6, s[16:19], s38 offen offset:64
    v_cvt_pk_bf16_f32 v14, v227, v231
    buffer_store_dword v14, v6, s[16:19], s38 offen offset:2048
    v_cvt_pk_bf16_f32 v15, v235, v239
    buffer_store_dword v15, v6, s[16:19], s38 offen offset:2112
    s_mov_b32 s38, 327680
    v_cvt_pk_bf16_f32 v8, v240, v244
    buffer_store_dword v8, v6, s[16:19], s38 offen offset:0
    v_cvt_pk_bf16_f32 v9, v248, v252
    buffer_store_dword v9, v6, s[16:19], s38 offen offset:64
    v_cvt_pk_bf16_f32 v10, v241, v245
    buffer_store_dword v10, v6, s[16:19], s38 offen offset:2048
    v_cvt_pk_bf16_f32 v11, v249, v253
    buffer_store_dword v11, v6, s[16:19], s38 offen offset:2112
    s_mov_b32 s38, 331776
    v_cvt_pk_bf16_f32 v12, v242, v246
    buffer_store_dword v12, v6, s[16:19], s38 offen offset:0
    v_cvt_pk_bf16_f32 v13, v250, v254
    buffer_store_dword v13, v6, s[16:19], s38 offen offset:64
    v_cvt_pk_bf16_f32 v14, v243, v247
    buffer_store_dword v14, v6, s[16:19], s38 offen offset:2048
    v_cvt_pk_bf16_f32 v15, v251, v255
    buffer_store_dword v15, v6, s[16:19], s38 offen offset:2112
    s_endpgm
K12_S0:
    s_mov_b32 s61, 4096
    s_add_u32 s62, s62, 1
K12_S0_L:
    ds_read_b32 v56, v5
    s_waitcnt lgkmcnt(0)
    v_cmp_gt_u32 vcc, s40, v56
    s_sub_u32 s61, s61, 1
    s_cmp_eq_u32 s61, 0
    s_cbranch_scc1 K12_Q0
    s_cbranch_vccz K12_Q0
    s_branch K12_S0_L
K12_F1:
    s_mov_b32 s61, 4096
    s_add_u32 s63, s63, 1
K12_F1_L:
    s_mov_b32 m0, s46
    s_mov_b64 exec, 0xff
    buffer_load_dword v1, s[4:7], 0 offen sc1 lds
    s_mov_b64 exec, -1
    s_waitcnt vmcnt(0)
    v_mov_b32 v0, s48
    ds_read_b32 v0, v0
    s_waitcnt lgkmcnt(0)
    v_cmp_eq_u32 vcc, 0, v0
    s_sub_u32 s61, s61, 1
    s_cmp_eq_u32 s61, 0
    s_cbranch_scc1 K12_F1_X
    s_cbranch_vccz K12_F1_X
    s_sleep 2
    s_branch K12_F1_L
K12_F1_X:
    s_branch K12_G1
K12_S2:
    s_mov_b32 s61, 4096
    s_add_u32 s62, s62, 1
K12_S2_L:
    ds_read_b32 v56, v5
    s_waitcnt lgkmcnt(0)
    v_cmp_gt_u32 vcc, s40, v56
    s_sub_u32 s61, s61, 1
    s_cmp_eq_u32 s61, 0
    s_cbranch_scc1 K12_Q2
    s_cbranch_vccz K12_Q2
    s_branch K12_S2_L
K12_S3:
    s_mov_b32 s61, 4096
    s_add_u32 s62, s62, 1
K12_S3_L:
    ds_read_b32 v40, v5
    s_waitcnt lgkmcnt(0)
    v_cmp_gt_u32 vcc, s40, v40
    s_sub_u32 s61, s61, 1
    s_cmp_eq_u32 s61, 0
    s_cbranch_scc1 K12_Q3
    s_cbranch_vccz K12_Q3
    s_branch K12_S3_L
K12_END:
    s_endpgm
.p2align 8
.type k3_stats_kernel,@function
k3_stats_kernel:
    s_cmp_ge_u32 s2, 256
    s_cbranch_scc1 K3_END
    s_load_dwordx2 s[4:5], s[0:1], 48
    v_lshrrev_b32 v1, 6, v0
    v_and_b32 v2, 63, v0
    v_readfirstlane_b32 s3, v1
    s_and_b32 s6, s2, 15
    s_lshr_b32 s7, s2, 4
    s_lshr_b32 s20, s6, 3
    s_and_b32 s21, s6, 7
    s_mul_i32 s22, s7, 11
    s_mul_i32 s23, s7, 10
    s_add_u32 s23, s23, 7
    s_cmp_lt_u32 s7, 7
    s_cselect_b32 s22, s22, s23
    s_cselect_b32 s23, 11, 10
    s_add_u32 s22, s22, s3
    v_and_b32 v3, 15, v2
    v_lshrrev_b32 v4, 4, v2
    v_lshlrev_b32 v5, 4, v2
    s_mov_b32 s24, 2736128
    v_mul_lo_u32 v6, v4, s24
    v_lshl_add_u32 v6, v3, 4, v6
    s_mul_i32 s25, s20, 167
    s_add_u32 s25, s25, s22
    s_lshl_b32 s25, s25, 11
    s_lshl_b32 s24, s21, 8
    s_add_u32 s25, s25, s24
    s_waitcnt lgkmcnt(0)
    s_add_u32 s8, s4, 118489088
    s_addc_u32 s9, s5, 0
    s_and_b32 s9, s9, 0xffff
    s_mov_b32 s10, 21889024
    s_mov_b32 s11, 0x00020000
    s_add_u32 s12, s4, 143654912
    s_addc_u32 s13, s5, 0
    s_and_b32 s13, s13, 0xffff
    s_mov_b32 s14, 131072
    s_mov_b32 s15, 0x00020000
    s_cmp_lt_u32 s3, s23
    s_cbranch_scc0 K3_NOLOAD
    buffer_load_dwordx4 v[16:19], v6, s[8:11], s25 offen
    s_add_u32 s25, s25, 684032
    buffer_load_dwordx4 v[20:23], v6, s[8:11], s25 offen
    s_add_u32 s25, s25, 684032
    buffer_load_dwordx4 v[24:27], v6, s[8:11], s25 offen
    s_add_u32 s25, s25, 684032
    buffer_load_dwordx4 v[28:31], v6, s[8:11], s25 offen
    s_add_u32 s25, s25, 8892416
    buffer_load_dwordx4 v[32:35], v6, s[8:11], s25 offen
    s_add_u32 s25, s25, 684032
    buffer_load_dwordx4 v[36:39], v6, s[8:11], s25 offen
    s_add_u32 s25, s25, 684032
    buffer_load_dwordx4 v[40:43], v6, s[8:11], s25 offen
    s_add_u32 s25, s25, 684032
    buffer_load_dwordx4 v[44:47], v6, s[8:11], s25 offen
K3_NOLOAD:
    s_cmp_ge_u32 s3, 6
    s_cbranch_scc1 K3_TABDONE
    s_sub_u32 s27, s3, 0
    s_lshr_b32 s28, s27, 1
    s_and_b32 s29, s27, 1
    s_lshl_b32 s30, s28, 4
    v_add_u32 v8, s30, v3
    s_lshl_b32 s30, s29, 5
    s_add_u32 s30, s30, 1
    v_lshlrev_b32 v9, 3, v4
    v_add_u32 v9, s30, v9
    v_mul_u32_u24 v9, v8, v9
    v_lshlrev_b32 v8, 1, v8
    v_mad_u32_u24 v48, v8, 0, v9
    v_mad_u32_u24 v49, v8, 0, v9
    v_add_u32 v49, 32, v49
    v_mad_u32_u24 v50, v8, 1, v9
    v_mad_u32_u24 v51, v8, 1, v9
    v_add_u32 v51, 32, v51
    v_mad_u32_u24 v52, v8, 2, v9
    v_mad_u32_u24 v53, v8, 2, v9
    v_add_u32 v53, 32, v53
    v_mad_u32_u24 v54, v8, 3, v9
    v_mad_u32_u24 v55, v8, 3, v9
    v_add_u32 v55, 32, v55
    v_and_b32 v48, 127, v48
    v_and_b32 v49, 127, v49
    v_and_b32 v50, 127, v50
    v_and_b32 v51, 127, v51
    v_and_b32 v52, 127, v52
    v_and_b32 v53, 127, v53
    v_and_b32 v54, 127, v54
    v_and_b32 v55, 127, v55
    v_cvt_f32_u32 v48, v48
    v_cvt_f32_u32 v49, v49
    v_cvt_f32_u32 v50, v50
    v_cvt_f32_u32 v51, v51
    v_cvt_f32_u32 v52, v52
    v_cvt_f32_u32 v53, v53
    v_cvt_f32_u32 v54, v54
    v_cvt_f32_u32 v55, v55
    v_mul_f32 v48, 0x3c000000, v48
    v_mul_f32 v49, 0x3c000000, v49
    v_mul_f32 v50, 0x3c000000, v50
    v_mul_f32 v51, 0x3c000000, v51
    v_mul_f32 v52, 0x3c000000, v52
    v_mul_f32 v53, 0x3c000000, v53
    v_mul_f32 v54, 0x3c000000, v54
    v_mul_f32 v55, 0x3c000000, v55
    v_cos_f32 v48, v48
    v_cos_f32 v49, v49
    v_cos_f32 v50, v50
    v_cos_f32 v51, v51
    v_cos_f32 v52, v52
    v_cos_f32 v53, v53
    v_cos_f32 v54, v54
    v_cos_f32 v55, v55
    s_nop 0
    v_mul_f32 v48, 0x3d000000, v48
    v_mul_f32 v49, 0x3d000000, v49
    v_mul_f32 v50, 0x3d000000, v50
    v_mul_f32 v51, 0x3d000000, v51
    v_mul_f32 v52, 0x3d000000, v52
    v_mul_f32 v53, 0x3d000000, v53
    v_mul_f32 v54, 0x3d000000, v54
    v_mul_f32 v55, 0x3d000000, v55
    v_cvt_pk_bf16_f32 v56, v48, v49
    v_cvt_pk_bf16_f32 v57, v50, v51
    v_cvt_pk_bf16_f32 v58, v52, v53
    v_cvt_pk_bf16_f32 v59, v54, v55
    v_lshlrev_b32 v64, 16, v56
    v_and_b32 v65, 0xffff0000, v56
    v_sub_f32 v48, v48, v64
    v_sub_f32 v49, v49, v65
    v_lshlrev_b32 v64, 16, v57
    v_and_b32 v65, 0xffff0000, v57
    v_sub_f32 v50, v50, v64
    v_sub_f32 v51, v51, v65
    v_lshlrev_b32 v64, 16, v58
    v_and_b32 v65, 0xffff0000, v58
    v_sub_f32 v52, v52, v64
    v_sub_f32 v53, v53, v65
    v_lshlrev_b32 v64, 16, v59
    v_and_b32 v65, 0xffff0000, v59
    v_sub_f32 v54, v54, v64
    v_sub_f32 v55, v55, v65
    v_cvt_pk_bf16_f32 v60, v48, v49
    v_cvt_pk_bf16_f32 v61, v50, v51
    v_cvt_pk_bf16_f32 v62, v52, v53
    v_cvt_pk_bf16_f32 v63, v54, v55
    s_lshl_b32 s30, s27, 11
    v_add_u32 v10, s30, v5
    ds_write_b128 v10, v[56:59]
    ds_write_b128 v10, v[60:63] offset:1024
K3_TABDONE:
    s_waitcnt lgkmcnt(0)
    s_barrier
    s_cmp_lt_u32 s3, s23
    s_cbranch_scc0 K3_IDLE
    ds_read_b128 v[48:51], v5 offset:0
    ds_read_b128 v[52:55], v5 offset:1024
    ds_read_b128 v[56:59], v5 offset:2048
    ds_read_b128 v[60:63], v5 offset:3072
    ds_read_b128 v[64:67], v5 offset:4096
    ds_read_b128 v[68:71], v5 offset:5120
    ds_read_b128 v[72:75], v5 offset:6144
    ds_read_b128 v[76:79], v5 offset:7168
    ds_read_b128 v[80:83], v5 offset:8192
    ds_read_b128 v[84:87], v5 offset:9216
    ds_read_b128 v[88:91], v5 offset:10240
    ds_read_b128 v[92:95], v5 offset:11264
    s_waitcnt vmcnt(0)
    v_swap_b32 v17, v20
    v_swap_b32 v18, v24
    v_swap_b32 v19, v28
    v_swap_b32 v22, v25
    v_swap_b32 v23, v29
    v_swap_b32 v27, v30
    v_swap_b32 v33, v36
    v_swap_b32 v34, v40
    v_swap_b32 v35, v44
    v_swap_b32 v38, v41
    v_swap_b32 v39, v45
    v_swap_b32 v43, v46
    s_waitcnt lgkmcnt(0)
    s_mul_i32 s24, s22, 48
    s_sub_u32 s24, 7985, s24
    s_cmp_ge_u32 s24, 48
    s_cbranch_scc1 K3_FULL
    v_add_u32 v7, 0, v3
    v_cmp_gt_u32 vcc, s24, v7
    s_nop 1
    v_cndmask_b32 v48, 0, v48, vcc
    v_cndmask_b32 v49, 0, v49, vcc
    v_cndmask_b32 v50, 0, v50, vcc
    v_cndmask_b32 v51, 0, v51, vcc
    v_cndmask_b32 v52, 0, v52, vcc
    v_cndmask_b32 v53, 0, v53, vcc
    v_cndmask_b32 v54, 0, v54, vcc
    v_cndmask_b32 v55, 0, v55, vcc
    v_cndmask_b32 v56, 0, v56, vcc
    v_cndmask_b32 v57, 0, v57, vcc
    v_cndmask_b32 v58, 0, v58, vcc
    v_cndmask_b32 v59, 0, v59, vcc
    v_cndmask_b32 v60, 0, v60, vcc
    v_cndmask_b32 v61, 0, v61, vcc
    v_cndmask_b32 v62, 0, v62, vcc
    v_cndmask_b32 v63, 0, v63, vcc
    v_add_u32 v7, 16, v3
    v_cmp_gt_u32 vcc, s24, v7
    s_nop 1
    v_cndmask_b32 v64, 0, v64, vcc
    v_cndmask_b32 v65, 0, v65, vcc
    v_cndmask_b32 v66, 0, v66, vcc
    v_cndmask_b32 v67, 0, v67, vcc
    v_cndmask_b32 v68, 0, v68, vcc
    v_cndmask_b32 v69, 0, v69, vcc
    v_cndmask_b32 v70, 0, v70, vcc
    v_cndmask_b32 v71, 0, v71, vcc
    v_cndmask_b32 v72, 0, v72, vcc
    v_cndmask_b32 v73, 0, v73, vcc
    v_cndmask_b32 v74, 0, v74, vcc
    v_cndmask_b32 v75, 0, v75, vcc
    v_cndmask_b32 v76, 0, v76, vcc
    v_cndmask_b32 v77, 0, v77, vcc
    v_cndmask_b32 v78, 0, v78, vcc
    v_cndmask_b32 v79, 0, v79, vcc
    v_add_u32 v7, 32, v3
    v_cmp_gt_u32 vcc, s24, v7
    s_nop 1
    v_cndmask_b32 v80, 0, v80, vcc
    v_cndmask_b32 v81, 0, v81, vcc
    v_cndmask_b32 v82, 0, v82, vcc
    v_cndmask_b32 v83, 0, v83, vcc
    v_cndmask_b32 v84, 0, v84, vcc
    v_cndmask_b32 v85, 0, v85, vcc
    v_cndmask_b32 v86, 0, v86, vcc
    v_cndmask_b32 v87, 0, v87, vcc
    v_cndmask_b32 v88, 0, v88, vcc
    v_cndmask_b32 v89, 0, v89, vcc
    v_cndmask_b32 v90, 0, v90, vcc
    v_cndmask_b32 v91, 0, v91, vcc
    v_cndmask_b32 v92, 0, v92, vcc
    v_cndmask_b32 v93, 0, v93, vcc
    v_cndmask_b32 v94, 0, v94, vcc
    v_cndmask_b32 v95, 0, v95, vcc
K3_FULL:
    s_nop 1
    v_mfma_f32_16x16x32_bf16 v[96:99], v[48:51], v[16:19], 0
    v_mfma_f32_16x16x32_bf16 v[100:103], v[48:51], v[20:23], 0
    v_mfma_f32_16x16x32_bf16 v[104:107], v[48:51], v[24:27], 0
    v_mfma_f32_16x16x32_bf16 v[108:111], v[48:51], v[28:31], 0
    v_mfma_f32_16x16x32_bf16 v[96:99], v[52:55], v[16:19], v[96:99]
    v_mfma_f32_16x16x32_bf16 v[100:103], v[52:55], v[20:23], v[100:103]
    v_mfma_f32_16x16x32_bf16 v[104:107], v[52:55], v[24:27], v[104:107]
    v_mfma_f32_16x16x32_bf16 v[108:111], v[52:55], v[28:31], v[108:111]
    v_mfma_f32_16x16x32_bf16 v[96:99], v[56:59], v[32:35], v[96:99]
    v_mfma_f32_16x16x32_bf16 v[100:103], v[56:59], v[36:39], v[100:103]
    v_mfma_f32_16x16x32_bf16 v[104:107], v[56:59], v[40:43], v[104:107]
    v_mfma_f32_16x16x32_bf16 v[108:111], v[56:59], v[44:47], v[108:111]
    v_mfma_f32_16x16x32_bf16 v[96:99], v[60:63], v[32:35], v[96:99]
    v_mfma_f32_16x16x32_bf16 v[100:103], v[60:63], v[36:39], v[100:103]
    v_mfma_f32_16x16x32_bf16 v[104:107], v[60:63], v[40:43], v[104:107]
    v_mfma_f32_16x16x32_bf16 v[108:111], v[60:63], v[44:47], v[108:111]
    v_mfma_f32_16x16x32_bf16 v[112:115], v[64:67], v[16:19], 0
    v_mfma_f32_16x16x32_bf16 v[116:119], v[64:67], v[20:23], 0
    v_mfma_f32_16x16x32_bf16 v[120:123], v[64:67], v[24:27], 0
    v_mfma_f32_16x16x32_bf16 v[124:127], v[64:67], v[28:31], 0
    v_mfma_f32_16x16x32_bf16 v[112:115], v[68:71], v[16:19], v[112:115]
    v_mfma_f32_16x16x32_bf16 v[116:119], v[68:71], v[20:23], v[116:119]
    v_mfma_f32_16x16x32_bf16 v[120:123], v[68:71], v[24:27], v[120:123]
    v_mfma_f32_16x16x32_bf16 v[124:127], v[68:71], v[28:31], v[124:127]
    v_mfma_f32_16x16x32_bf16 v[112:115], v[72:75], v[32:35], v[112:115]
    v_mfma_f32_16x16x32_bf16 v[116:119], v[72:75], v[36:39], v[116:119]
    v_mfma_f32_16x16x32_bf16 v[120:123], v[72:75], v[40:43], v[120:123]
    v_mfma_f32_16x16x32_bf16 v[124:127], v[72:75], v[44:47], v[124:127]
    v_mfma_f32_16x16x32_bf16 v[112:115], v[76:79], v[32:35], v[112:115]
    v_mfma_f32_16x16x32_bf16 v[116:119], v[76:79], v[36:39], v[116:119]
    v_mfma_f32_16x16x32_bf16 v[120:123], v[76:79], v[40:43], v[120:123]
    v_mfma_f32_16x16x32_bf16 v[124:127], v[76:79], v[44:47], v[124:127]
    v_mfma_f32_16x16x32_bf16 v[128:131], v[80:83], v[16:19], 0
    v_mfma_f32_16x16x32_bf16 v[132:135], v[80:83], v[20:23], 0
    v_mfma_f32_16x16x32_bf16 v[136:139], v[80:83], v[24:27], 0
    v_mfma_f32_16x16x32_bf16 v[140:143], v[80:83], v[28:31], 0
    v_mfma_f32_16x16x32_bf16 v[128:131], v[84:87], v[16:19], v[128:131]
    v_mfma_f32_16x16x32_bf16 v[132:135], v[84:87], v[20:23], v[132:135]
    v_mfma_f32_16x16x32_bf16 v[136:139], v[84:87], v[24:27], v[136:139]
    v_mfma_f32_16x16x32_bf16 v[140:143], v[84:87], v[28:31], v[140:143]
    v_mfma_f32_16x16x32_bf16 v[128:131], v[88:91], v[32:35], v[128:131]
    v_mfma_f32_16x16x32_bf16 v[132:135], v[88:91], v[36:39], v[132:135]
    v_mfma_f32_16x16x32_bf16 v[136:139], v[88:91], v[40:43], v[136:139]
    v_mfma_f32_16x16x32_bf16 v[140:143], v[88:91], v[44:47], v[140:143]
    v_mfma_f32_16x16x32_bf16 v[128:131], v[92:95], v[32:35], v[128:131]
    v_mfma_f32_16x16x32_bf16 v[132:135], v[92:95], v[36:39], v[132:135]
    v_mfma_f32_16x16x32_bf16 v[136:139], v[92:95], v[40:43], v[136:139]
    v_mfma_f32_16x16x32_bf16 v[140:143], v[92:95], v[44:47], v[140:143]
    s_nop 7
    v_mov_b32 v16, v96
    v_mul_f32 v20, v96, v96
    v_mov_b32 v17, v100
    v_mul_f32 v21, v100, v100
    v_mov_b32 v18, v104
    v_mul_f32 v22, v104, v104
    v_mov_b32 v19, v108
    v_mul_f32 v23, v108, v108
    v_add_f32 v16, v16, v97
    v_fmac_f32 v20, v97, v97
    v_add_f32 v17, v17, v101
    v_fmac_f32 v21, v101, v101
    v_add_f32 v18, v18, v105
    v_fmac_f32 v22, v105, v105
    v_add_f32 v19, v19, v109
    v_fmac_f32 v23, v109, v109
    v_add_f32 v16, v16, v98
    v_fmac_f32 v20, v98, v98
    v_add_f32 v17, v17, v102
    v_fmac_f32 v21, v102, v102
    v_add_f32 v18, v18, v106
    v_fmac_f32 v22, v106, v106
    v_add_f32 v19, v19, v110
    v_fmac_f32 v23, v110, v110
    v_add_f32 v16, v16, v99
    v_fmac_f32 v20, v99, v99
    v_add_f32 v17, v17, v103
    v_fmac_f32 v21, v103, v103
    v_add_f32 v18, v18, v107
    v_fmac_f32 v22, v107, v107
    v_add_f32 v19, v19, v111
    v_fmac_f32 v23, v111, v111
    v_add_f32 v16, v16, v112
    v_fmac_f32 v20, v112, v112
    v_add_f32 v17, v17, v116
    v_fmac_f32 v21, v116, v116
    v_add_f32 v18, v18, v120
    v_fmac_f32 v22, v120, v120
    v_add_f32 v19, v19, v124
    v_fmac_f32 v23, v124, v124
    v_add_f32 v16, v16, v113
    v_fmac_f32 v20, v113, v113
    v_add_f32 v17, v17, v117
    v_fmac_f32 v21, v117, v117
    v_add_f32 v18, v18, v121
    v_fmac_f32 v22, v121, v121
    v_add_f32 v19, v19, v125
    v_fmac_f32 v23, v125, v125
    v_add_f32 v16, v16, v114
    v_fmac_f32 v20, v114, v114
    v_add_f32 v17, v17, v118
    v_fmac_f32 v21, v118, v118
    v_add_f32 v18, v18, v122
    v_fmac_f32 v22, v122, v122
    v_add_f32 v19, v19, v126
    v_fmac_f32 v23, v126, v126
    v_add_f32 v16, v16, v115
    v_fmac_f32 v20, v115, v115
    v_add_f32 v17, v17, v119
    v_fmac_f32 v21, v119, v119
    v_add_f32 v18, v18, v123
    v_fmac_f32 v22, v123, v123
    v_add_f32 v19, v19, v127
    v_fmac_f32 v23, v127, v127
    v_add_f32 v16, v16, v128
    v_fmac_f32 v20, v128, v128
    v_add_f32 v17, v17, v132
    v_fmac_f32 v21, v132, v132
    v_add_f32 v18, v18, v136
    v_fmac_f32 v22, v136, v136
    v_add_f32 v19, v19, v140
    v_fmac_f32 v23, v140, v140
    v_add_f32 v16, v16, v129
    v_fmac_f32 v20, v129, v129
    v_add_f32 v17, v17, v133
    v_fmac_f32 v21, v133, v133
    v_add_f32 v18, v18, v137
    v_fmac_f32 v22, v137, v137
    v_add_f32 v19, v19, v141
    v_fmac_f32 v23, v141, v141
    v_add_f32 v16, v16, v130
    v_fmac_f32 v20, v130, v130
    v_add_f32 v17, v17, v134
    v_fmac_f32 v21, v134, v134
    v_add_f32 v18, v18, v138
    v_fmac_f32 v22, v138, v138
    v_add_f32 v19, v19, v142
    v_fmac_f32 v23, v142, v142
    v_add_f32 v16, v16, v131
    v_fmac_f32 v20, v131, v131
    v_add_f32 v17, v17, v135
    v_fmac_f32 v21, v135, v135
    v_add_f32 v18, v18, v139
    v_fmac_f32 v22, v139, v139
    v_add_f32 v19, v19, v143
    v_fmac_f32 v23, v143, v143
    v_mov_b32 v24, v16
    v_mov_b32 v25, v17
    v_mov_b32 v26, v18
    v_mov_b32 v27, v19
    v_mov_b32 v28, v20
    v_mov_b32 v29, v21
    v_mov_b32 v30, v22
    v_mov_b32 v31, v23
    s_nop 0
    v_permlane32_swap_b32 v16, v24
    v_permlane32_swap_b32 v17, v25
    v_permlane32_swap_b32 v18, v26
    v_permlane32_swap_b32 v19, v27
    v_permlane32_swap_b32 v20, v28
    v_permlane32_swap_b32 v21, v29
    v_permlane32_swap_b32 v22, v30
    v_permlane32_swap_b32 v23, v31
    v_add_f32 v16, v16, v24
    v_add_f32 v17, v17, v25
    v_add_f32 v18, v18, v26
    v_add_f32 v19, v19, v27
    v_add_f32 v20, v20, v28
    v_add_f32 v21, v21, v29
    v_add_f32 v22, v22, v30
    v_add_f32 v23, v23, v31
    v_mov_b32 v24, v16
    v_mov_b32 v25, v17
    v_mov_b32 v26, v18
    v_mov_b32 v27, v19
    v_mov_b32 v28, v20
    v_mov_b32 v29, v21
    v_mov_b32 v30, v22
    v_mov_b32 v31, v23
    s_nop 0
    v_permlane16_swap_b32 v16, v24
    v_permlane16_swap_b32 v17, v25
    v_permlane16_swap_b32 v18, v26
    v_permlane16_swap_b32 v19, v27
    v_permlane16_swap_b32 v20, v28
    v_permlane16_swap_b32 v21, v29
    v_permlane16_swap_b32 v22, v30
    v_permlane16_swap_b32 v23, v31
    v_add_f32 v16, v16, v24
    v_add_f32 v17, v17, v25
    v_add_f32 v18, v18, v26
    v_add_f32 v19, v19, v27
    v_add_f32 v20, v20, v28
    v_add_f32 v21, v21, v29
    v_add_f32 v22, v22, v30
    v_add_f32 v23, v23, v31
    s_branch K3_WR
K3_IDLE:
    v_mov_b32 v16, 0
    v_mov_b32 v17, 0
    v_mov_b32 v18, 0
    v_mov_b32 v19, 0
    v_mov_b32 v20, 0
    v_mov_b32 v21, 0
    v_mov_b32 v22, 0
    v_mov_b32 v23, 0
K3_WR:
    s_lshl_b32 s24, s3, 9
    v_lshlrev_b32 v7, 4, v3
    v_add_u32 v7, s24, v7
    ds_write_b128 v7, v[16:19] offset:12288
    ds_write_b128 v7, v[20:23] offset:12544
    s_waitcnt lgkmcnt(0)
    s_barrier
    s_cmp_ge_u32 s3, 2
    s_cbranch_scc1 K3_END
    v_lshlrev_b32 v7, 2, v0
    ds_read_b32 v32, v7 offset:12288
    ds_read_b32 v33, v7 offset:12800
    ds_read_b32 v34, v7 offset:13312
    ds_read_b32 v35, v7 offset:13824
    ds_read_b32 v36, v7 offset:14336
    ds_read_b32 v37, v7 offset:14848
    ds_read_b32 v38, v7 offset:15360
    ds_read_b32 v39, v7 offset:15872
    ds_read_b32 v40, v7 offset:16384
    ds_read_b32 v41, v7 offset:16896
    ds_read_b32 v42, v7 offset:17408
    ds_read_b32 v43, v7 offset:17920
    s_waitcnt lgkmcnt(0)
    v_add_f32 v32, v32, v33
    v_add_f32 v32, v32, v34
    v_add_f32 v32, v32, v35
    v_add_f32 v32, v32, v36
    v_add_f32 v32, v32, v37
    v_add_f32 v32, v32, v38
    v_add_f32 v32, v32, v39
    v_add_f32 v32, v32, v40
    v_add_f32 v32, v32, v41
    v_add_f32 v32, v32, v42
    v_add_f32 v32, v32, v43
    s_lshl_b32 s24, s6, 4
    s_add_u32 s24, s24, s7
    s_lshl_b32 s24, s24, 9
    buffer_store_dword v32, v7, s[12:15], s24 offen
K3_END:
    s_endpgm
.p2align 8
.type k4_out_kernel,@function
k4_out_kernel:
    s_cmp_ge_u32 s2, 256
    s_cbranch_scc1 K4_END
    s_load_dwordx2 s[4:5], s[0:1], 48
    s_load_dwordx4 s[40:43], s[0:1], 16
    s_load_dwordx2 s[44:45], s[0:1], 32
    v_lshrrev_b32 v1, 6, v0
    v_and_b32 v2, 63, v0
    v_readfirstlane_b32 s3, v1
    s_and_b32 s6, s2, 15
    s_lshr_b32 s7, s2, 4
    s_lshr_b32 s20, s6, 3
    s_and_b32 s21, s6, 7
    s_mul_i32 s22, s7, 11
    s_mul_i32 s23, s7, 10
    s_add_u32 s23, s23, 7
    s_cmp_lt_u32 s7, 7
    s_cselect_b32 s22, s22, s23
    s_cselect_b32 s23, 11, 10
    s_add_u32 s22, s22, s3
    v_and_b32 v3, 15, v2
    v_lshrrev_b32 v4, 4, v2
    v_lshlrev_b32 v5, 4, v2
    s_mov_b32 s24, 2736128
    v_mul_lo_u32 v6, v4, s24
    v_lshl_add_u32 v6, v3, 4, v6
    s_mul_i32 s25, s20, 167
    s_add_u32 s25, s25, s22
    s_lshl_b32 s25, s25, 11
    s_lshl_b32 s24, s21, 8
    s_add_u32 s25, s25, s24
    s_waitcnt lgkmcnt(0)
    s_add_u32 s8, s4, 118489088
    s_addc_u32 s9, s5, 0
    s_and_b32 s9, s9, 0xffff
    s_mov_b32 s10, 21889024
    s_mov_b32 s11, 0x00020000
    s_add_u32 s12, s4, 143654912
    s_addc_u32 s13, s5, 0
    s_and_b32 s13, s13, 0xffff
    s_mov_b32 s14, 131072
    s_mov_b32 s15, 0x00020000
    s_cmp_lt_u32 s3, s23
    s_cbranch_scc0 K4_NOLOAD
    buffer_load_dwordx4 v[16:19], v6, s[8:11], s25 offen
    s_add_u32 s25, s25, 684032
    buffer_load_dwordx4 v[20:23], v6, s[8:11], s25 offen
    s_add_u32 s25, s25, 684032
    buffer_load_dwordx4 v[24:27], v6, s[8:11], s25 offen
    s_add_u32 s25, s25, 684032
    buffer_load_dwordx4 v[28:31], v6, s[8:11], s25 offen
    s_add_u32 s25, s25, 8892416
    buffer_load_dwordx4 v[32:35], v6, s[8:11], s25 offen
    s_add_u32 s25, s25, 684032
    buffer_load_dwordx4 v[36:39], v6, s[8:11], s25 offen
    s_add_u32 s25, s25, 684032
    buffer_load_dwordx4 v[40:43], v6, s[8:11], s25 offen
    s_add_u32 s25, s25, 684032
    buffer_load_dwordx4 v[44:47], v6, s[8:11], s25 offen
K4_NOLOAD:
    s_cmp_lg_u32 s3, 0
    s_cbranch_scc1 K4_TAB
    s_mov_b32 s16, s40
    s_mov_b32 s17, s41
    s_and_b32 s17, s17, 0xffff
    s_mov_b32 s18, 1024
    s_mov_b32 s19, 0x00020000
    s_mov_b32 s28, s42
    s_mov_b32 s29, s43
    s_and_b32 s29, s29, 0xffff
    s_mov_b32 s30, 1024
    s_mov_b32 s31, 0x00020000
    v_lshlrev_b32 v7, 2, v2
    s_lshl_b32 s24, s6, 13
    buffer_load_dword v96, v7, s[12:15], s24 offen offset:0
    buffer_load_dword v112, v7, s[12:15], s24 offen offset:256
    buffer_load_dword v97, v7, s[12:15], s24 offen offset:512
    buffer_load_dword v113, v7, s[12:15], s24 offen offset:768
    buffer_load_dword v98, v7, s[12:15], s24 offen offset:1024
    buffer_load_dword v114, v7, s[12:15], s24 offen offset:1280
    buffer_load_dword v99, v7, s[12:15], s24 offen offset:1536
    buffer_load_dword v115, v7, s[12:15], s24 offen offset:1792
    buffer_load_dword v100, v7, s[12:15], s24 offen offset:2048
    buffer_load_dword v116, v7, s[12:15], s24 offen offset:2304
    buffer_load_dword v101, v7, s[12:15], s24 offen offset:2560
    buffer_load_dword v117, v7, s[12:15], s24 offen offset:2816
    buffer_load_dword v102, v7, s[12:15], s24 offen offset:3072
    buffer_load_dword v118, v7, s[12:15], s24 offen offset:3328
    buffer_load_dword v103, v7, s[12:15], s24 offen offset:3584
    buffer_load_dword v119, v7, s[12:15], s24 offen offset:3840
    s_add_u32 s24, s24, 4096
    buffer_load_dword v104, v7, s[12:15], s24 offen offset:0
    buffer_load_dword v120, v7, s[12:15], s24 offen offset:256
    buffer_load_dword v105, v7, s[12:15], s24 offen offset:512
    buffer_load_dword v121, v7, s[12:15], s24 offen offset:768
    buffer_load_dword v106, v7, s[12:15], s24 offen offset:1024
    buffer_load_dword v122, v7, s[12:15], s24 offen offset:1280
    buffer_load_dword v107, v7, s[12:15], s24 offen offset:1536
    buffer_load_dword v123, v7, s[12:15], s24 offen offset:1792
    buffer_load_dword v108, v7, s[12:15], s24 offen offset:2048
    buffer_load_dword v124, v7, s[12:15], s24 offen offset:2304
    buffer_load_dword v109, v7, s[12:15], s24 offen offset:2560
    buffer_load_dword v125, v7, s[12:15], s24 offen offset:2816
    buffer_load_dword v110, v7, s[12:15], s24 offen offset:3072
    buffer_load_dword v126, v7, s[12:15], s24 offen offset:3328
    buffer_load_dword v111, v7, s[12:15], s24 offen offset:3584
    buffer_load_dword v127, v7, s[12:15], s24 offen offset:3840
    s_lshl_b32 s24, s21, 7
    v_lshlrev_b32 v8, 1, v2
    buffer_load_ushort v9, v8, s[16:19], s24 offen
    buffer_load_ushort v10, v8, s[28:31], s24 offen
    s_waitcnt vmcnt(0)
    v_add_f32 v96, v96, v104
    v_add_f32 v112, v112, v120
    v_add_f32 v97, v97, v105
    v_add_f32 v113, v113, v121
    v_add_f32 v98, v98, v106
    v_add_f32 v114, v114, v122
    v_add_f32 v99, v99, v107
    v_add_f32 v115, v115, v123
    v_add_f32 v100, v100, v108
    v_add_f32 v116, v116, v124
    v_add_f32 v101, v101, v109
    v_add_f32 v117, v117, v125
    v_add_f32 v102, v102, v110
    v_add_f32 v118, v118, v126
    v_add_f32 v103, v103, v111
    v_add_f32 v119, v119, v127
    v_add_f32 v96, v96, v100
    v_add_f32 v112, v112, v116
    v_add_f32 v97, v97, v101
    v_add_f32 v113, v113, v117
    v_add_f32 v98, v98, v102
    v_add_f32 v114, v114, v118
    v_add_f32 v99, v99, v103
    v_add_f32 v115, v115, v119
    v_add_f32 v96, v96, v98
    v_add_f32 v112, v112, v114
    v_add_f32 v97, v97, v99
    v_add_f32 v113, v113, v115
    v_add_f32 v96, v96, v97
    v_add_f32 v112, v112, v113
    v_mul_f32 v11, 0x39035177, v96
    v_mul_f32 v12, 0x39035177, v112
    v_fma_f32 v12, -v11, v11, v12
    v_max_f32 v12, 0, v12
    v_add_f32 v12, 0x3727c5ac, v12
    v_sqrt_f32 v12, v12
    v_lshlrev_b32 v9, 16, v9
    v_rcp_f32 v12, v12
    v_lshlrev_b32 v10, 16, v10
    v_mul_f32 v9, v9, v12
    v_fma_f32 v10, -v11, v9, v10
    ds_write_b32 v7, v9 offset:12288
    ds_write_b32 v7, v10 offset:12544
    s_branch K4_TABDONE
K4_TAB:
    s_cmp_ge_u32 s3, 7
    s_cbranch_scc1 K4_TABDONE
    s_sub_u32 s27, s3, 1
    s_lshr_b32 s28, s27, 1
    s_and_b32 s29, s27, 1
    s_lshl_b32 s30, s28, 4
    v_add_u32 v8, s30, v3
    s_lshl_b32 s30, s29, 5
    s_add_u32 s30, s30, 1
    v_lshlrev_b32 v9, 3, v4
    v_add_u32 v9, s30, v9
    v_mul_u32_u24 v9, v8, v9
    v_lshlrev_b32 v8, 1, v8
    v_mad_u32_u24 v48, v8, 0, v9
    v_mad_u32_u24 v49, v8, 0, v9
    v_add_u32 v49, 32, v49
    v_mad_u32_u24 v50, v8, 1, v9
    v_mad_u32_u24 v51, v8, 1, v9
    v_add_u32 v51, 32, v51
    v_mad_u32_u24 v52, v8, 2, v9
    v_mad_u32_u24 v53, v8, 2, v9
    v_add_u32 v53, 32, v53
    v_mad_u32_u24 v54, v8, 3, v9
    v_mad_u32_u24 v55, v8, 3, v9
    v_add_u32 v55, 32, v55
    v_and_b32 v48, 127, v48
    v_and_b32 v49, 127, v49
    v_and_b32 v50, 127, v50
    v_and_b32 v51, 127, v51
    v_and_b32 v52, 127, v52
    v_and_b32 v53, 127, v53
    v_and_b32 v54, 127, v54
    v_and_b32 v55, 127, v55
    v_cvt_f32_u32 v48, v48
    v_cvt_f32_u32 v49, v49
    v_cvt_f32_u32 v50, v50
    v_cvt_f32_u32 v51, v51
    v_cvt_f32_u32 v52, v52
    v_cvt_f32_u32 v53, v53
    v_cvt_f32_u32 v54, v54
    v_cvt_f32_u32 v55, v55
    v_mul_f32 v48, 0x3c000000, v48
    v_mul_f32 v49, 0x3c000000, v49
    v_mul_f32 v50, 0x3c000000, v50
    v_mul_f32 v51, 0x3c000000, v51
    v_mul_f32 v52, 0x3c000000, v52
    v_mul_f32 v53, 0x3c000000, v53
    v_mul_f32 v54, 0x3c000000, v54
    v_mul_f32 v55, 0x3c000000, v55
    v_cos_f32 v48, v48
    v_cos_f32 v49, v49
    v_cos_f32 v50, v50
    v_cos_f32 v51, v51
    v_cos_f32 v52, v52
    v_cos_f32 v53, v53
    v_cos_f32 v54, v54
    v_cos_f32 v55, v55
    s_nop 0
    v_mul_f32 v48, 0x3d000000, v48
    v_mul_f32 v49, 0x3d000000, v49
    v_mul_f32 v50, 0x3d000000, v50
    v_mul_f32 v51, 0x3d000000, v51
    v_mul_f32 v52, 0x3d000000, v52
    v_mul_f32 v53, 0x3d000000, v53
    v_mul_f32 v54, 0x3d000000, v54
    v_mul_f32 v55, 0x3d000000, v55
    v_cvt_pk_bf16_f32 v56, v48, v49
    v_cvt_pk_bf16_f32 v57, v50, v51
    v_cvt_pk_bf16_f32 v58, v52, v53
    v_cvt_pk_bf16_f32 v59, v54, v55
    v_lshlrev_b32 v64, 16, v56
    v_and_b32 v65, 0xffff0000, v56
    v_sub_f32 v48, v48, v64
    v_sub_f32 v49, v49, v65
    v_lshlrev_b32 v64, 16, v57
    v_and_b32 v65, 0xffff0000, v57
    v_sub_f32 v50, v50, v64
    v_sub_f32 v51, v51, v65
    v_lshlrev_b32 v64, 16, v58
    v_and_b32 v65, 0xffff0000, v58
    v_sub_f32 v52, v52, v64
    v_sub_f32 v53, v53, v65
    v_lshlrev_b32 v64, 16, v59
    v_and_b32 v65, 0xffff0000, v59
    v_sub_f32 v54, v54, v64
    v_sub_f32 v55, v55, v65
    v_cvt_pk_bf16_f32 v60, v48, v49
    v_cvt_pk_bf16_f32 v61, v50, v51
    v_cvt_pk_bf16_f32 v62, v52, v53
    v_cvt_pk_bf16_f32 v63, v54, v55
    s_lshl_b32 s30, s27, 11
    v_add_u32 v10, s30, v5
    ds_write_b128 v10, v[56:59]
    ds_write_b128 v10, v[60:63] offset:1024
K4_TABDONE:
    s_waitcnt lgkmcnt(0)
    s_barrier
    s_cmp_lt_u32 s3, s23
    s_cbranch_scc0 K4_END
    ds_read_b128 v[48:51], v5 offset:0
    ds_read_b128 v[52:55], v5 offset:1024
    ds_read_b128 v[56:59], v5 offset:2048
    ds_read_b128 v[60:63], v5 offset:3072
    ds_read_b128 v[64:67], v5 offset:4096
    ds_read_b128 v[68:71], v5 offset:5120
    ds_read_b128 v[72:75], v5 offset:6144
    ds_read_b128 v[76:79], v5 offset:7168
    ds_read_b128 v[80:83], v5 offset:8192
    ds_read_b128 v[84:87], v5 offset:9216
    ds_read_b128 v[88:91], v5 offset:10240
    ds_read_b128 v[92:95], v5 offset:11264
    v_lshlrev_b32 v7, 4, v3
    ds_read_b128 v[144:147], v7 offset:12288
    ds_read_b128 v[148:151], v7 offset:12544
    s_waitcnt vmcnt(0)
    v_swap_b32 v17, v20
    v_swap_b32 v18, v24
    v_swap_b32 v19, v28
    v_swap_b32 v22, v25
    v_swap_b32 v23, v29
    v_swap_b32 v27, v30
    v_swap_b32 v33, v36
    v_swap_b32 v34, v40
    v_swap_b32 v35, v44
    v_swap_b32 v38, v41
    v_swap_b32 v39, v45
    v_swap_b32 v43, v46
    s_waitcnt lgkmcnt(0)
    s_nop 1
    v_mfma_f32_16x16x32_bf16 v[96:99], v[48:51], v[16:19], 0
    v_mfma_f32_16x16x32_bf16 v[100:103], v[48:51], v[20:23], 0
    v_mfma_f32_16x16x32_bf16 v[104:107], v[48:51], v[24:27], 0
    v_mfma_f32_16x16x32_bf16 v[108:111], v[48:51], v[28:31], 0
    v_mfma_f32_16x16x32_bf16 v[96:99], v[52:55], v[16:19], v[96:99]
    v_mfma_f32_16x16x32_bf16 v[100:103], v[52:55], v[20:23], v[100:103]
    v_mfma_f32_16x16x32_bf16 v[104:107], v[52:55], v[24:27], v[104:107]
    v_mfma_f32_16x16x32_bf16 v[108:111], v[52:55], v[28:31], v[108:111]
    v_mfma_f32_16x16x32_bf16 v[96:99], v[56:59], v[32:35], v[96:99]
    v_mfma_f32_16x16x32_bf16 v[100:103], v[56:59], v[36:39], v[100:103]
    v_mfma_f32_16x16x32_bf16 v[104:107], v[56:59], v[40:43], v[104:107]
    v_mfma_f32_16x16x32_bf16 v[108:111], v[56:59], v[44:47], v[108:111]
    v_mfma_f32_16x16x32_bf16 v[96:99], v[60:63], v[32:35], v[96:99]
    v_mfma_f32_16x16x32_bf16 v[100:103], v[60:63], v[36:39], v[100:103]
    v_mfma_f32_16x16x32_bf16 v[104:107], v[60:63], v[40:43], v[104:107]
    v_mfma_f32_16x16x32_bf16 v[108:111], v[60:63], v[44:47], v[108:111]
    v_mfma_f32_16x16x32_bf16 v[112:115], v[64:67], v[16:19], 0
    v_mfma_f32_16x16x32_bf16 v[116:119], v[64:67], v[20:23], 0
    v_mfma_f32_16x16x32_bf16 v[120:123], v[64:67], v[24:27], 0
    v_mfma_f32_16x16x32_bf16 v[124:127], v[64:67], v[28:31], 0
    v_mfma_f32_16x16x32_bf16 v[112:115], v[68:71], v[16:19], v[112:115]
    v_mfma_f32_16x16x32_bf16 v[116:119], v[68:71], v[20:23], v[116:119]
    v_mfma_f32_16x16x32_bf16 v[120:123], v[68:71], v[24:27], v[120:123]
    v_mfma_f32_16x16x32_bf16 v[124:127], v[68:71], v[28:31], v[124:127]
    v_mfma_f32_16x16x32_bf16 v[112:115], v[72:75], v[32:35], v[112:115]
    v_mfma_f32_16x16x32_bf16 v[116:119], v[72:75], v[36:39], v[116:119]
    v_mfma_f32_16x16x32_bf16 v[120:123], v[72:75], v[40:43], v[120:123]
    v_mfma_f32_16x16x32_bf16 v[124:127], v[72:75], v[44:47], v[124:127]
    v_mfma_f32_16x16x32_bf16 v[112:115], v[76:79], v[32:35], v[112:115]
    v_mfma_f32_16x16x32_bf16 v[116:119], v[76:79], v[36:39], v[116:119]
    v_mfma_f32_16x16x32_bf16 v[120:123], v[76:79], v[40:43], v[120:123]
    v_mfma_f32_16x16x32_bf16 v[124:127], v[76:79], v[44:47], v[124:127]
    v_mfma_f32_16x16x32_bf16 v[128:131], v[80:83], v[16:19], 0
    v_mfma_f32_16x16x32_bf16 v[132:135], v[80:83], v[20:23], 0
    v_mfma_f32_16x16x32_bf16 v[136:139], v[80:83], v[24:27], 0
    v_mfma_f32_16x16x32_bf16 v[140:143], v[80:83], v[28:31], 0
    v_mfma_f32_16x16x32_bf16 v[128:131], v[84:87], v[16:19], v[128:131]
    v_mfma_f32_16x16x32_bf16 v[132:135], v[84:87], v[20:23], v[132:135]
    v_mfma_f32_16x16x32_bf16 v[136:139], v[84:87], v[24:27], v[136:139]
    v_mfma_f32_16x16x32_bf16 v[140:143], v[84:87], v[28:31], v[140:143]
    v_mfma_f32_16x16x32_bf16 v[128:131], v[88:91], v[32:35], v[128:131]
    v_mfma_f32_16x16x32_bf16 v[132:135], v[88:91], v[36:39], v[132:135]
    v_mfma_f32_16x16x32_bf16 v[136:139], v[88:91], v[40:43], v[136:139]
    v_mfma_f32_16x16x32_bf16 v[140:143], v[88:91], v[44:47], v[140:143]
    v_mfma_f32_16x16x32_bf16 v[128:131], v[92:95], v[32:35], v[128:131]
    v_mfma_f32_16x16x32_bf16 v[132:135], v[92:95], v[36:39], v[132:135]
    v_mfma_f32_16x16x32_bf16 v[136:139], v[92:95], v[40:43], v[136:139]
    v_mfma_f32_16x16x32_bf16 v[140:143], v[92:95], v[44:47], v[140:143]
    s_mul_i32 s24, s20, 8176640
    s_add_u32 s16, s44, s24
    s_addc_u32 s17, s45, 0
    s_and_b32 s17, s17, 0xffff
    s_mov_b32 s18, 8176640
    s_mov_b32 s19, 0x00020000
    v_lshlrev_b32 v7, 12, v4
    v_lshl_add_u32 v7, v3, 3, v7
    s_lshl_b32 s24, s21, 7
    v_add_u32 v7, s24, v7
    s_mul_i32 s25, s22, 49152
    s_mov_b32 s30, 0xc0135761
    s_mov_b32 s31, 0xbdd2d3e8
    v_mov_b32 v15, s30
    s_nop 3
    v_fma_f32 v16, v96, v144, v148
    v_fma_f32 v17, v100, v145, v149
    v_fma_f32 v18, v104, v146, v150
    v_fma_f32 v19, v108, v147, v151
    v_fma_f32 v20, v97, v144, v148
    v_fma_f32 v21, v101, v145, v149
    v_fma_f32 v22, v105, v146, v150
    v_fma_f32 v23, v109, v147, v151
    v_mul_f32 v24, v16, v16
    v_mul_f32 v25, v17, v17
    v_mul_f32 v26, v18, v18
    v_mul_f32 v27, v19, v19
    v_mul_f32 v28, v20, v20
    v_mul_f32 v29, v21, v21
    v_mul_f32 v30, v22, v22
    v_mul_f32 v31, v23, v23
    v_fma_f32 v24, v24, s31, v15
    v_fma_f32 v25, v25, s31, v15
    v_fma_f32 v26, v26, s31, v15
    v_fma_f32 v27, v27, s31, v15
    v_fma_f32 v28, v28, s31, v15
    v_fma_f32 v29, v29, s31, v15
    v_fma_f32 v30, v30, s31, v15
    v_fma_f32 v31, v31, s31, v15
    v_mul_f32 v24, v24, v16
    v_mul_f32 v25, v25, v17
    v_mul_f32 v26, v26, v18
    v_mul_f32 v27, v27, v19
    v_mul_f32 v28, v28, v20
    v_mul_f32 v29, v29, v21
    v_mul_f32 v30, v30, v22
    v_mul_f32 v31, v31, v23
    v_exp_f32 v24, v24
    v_exp_f32 v25, v25
    v_exp_f32 v26, v26
    v_exp_f32 v27, v27
    v_exp_f32 v28, v28
    v_exp_f32 v29, v29
    v_exp_f32 v30, v30
    v_exp_f32 v31, v31
    v_add_f32 v24, 1.0, v24
    v_add_f32 v25, 1.0, v25
    v_add_f32 v26, 1.0, v26
    v_add_f32 v27, 1.0, v27
    v_add_f32 v28, 1.0, v28
    v_add_f32 v29, 1.0, v29
    v_add_f32 v30, 1.0, v30
    v_add_f32 v31, 1.0, v31
    v_rcp_f32 v24, v24
    v_rcp_f32 v25, v25
    v_rcp_f32 v26, v26
    v_rcp_f32 v27, v27
    v_rcp_f32 v28, v28
    v_rcp_f32 v29, v29
    v_rcp_f32 v30, v30
    v_rcp_f32 v31, v31
    v_mul_f32 v16, v16, v24
    v_mul_f32 v17, v17, v25
    v_mul_f32 v18, v18, v26
    v_mul_f32 v19, v19, v27
    v_mul_f32 v20, v20, v28
    v_mul_f32 v21, v21, v29
    v_mul_f32 v22, v22, v30
    v_mul_f32 v23, v23, v31
    v_cvt_pk_bf16_f32 v32, v16, v17
    v_cvt_pk_bf16_f32 v33, v18, v19
    buffer_store_dwordx2 v[32:33], v7, s[16:19], s25 offen offset:0
    v_cvt_pk_bf16_f32 v34, v20, v21
    v_cvt_pk_bf16_f32 v35, v22, v23
    buffer_store_dwordx2 v[34:35], v7, s[16:19], s25 offen offset:1024
    s_add_u32 s25, s25, 2048
    v_fma_f32 v36, v98, v144, v148
    v_fma_f32 v37, v102, v145, v149
    v_fma_f32 v38, v106, v146, v150
    v_fma_f32 v39, v110, v147, v151
    v_fma_f32 v40, v99, v144, v148
    v_fma_f32 v41, v103, v145, v149
    v_fma_f32 v42, v107, v146, v150
    v_fma_f32 v43, v111, v147, v151
    v_mul_f32 v44, v36, v36
    v_mul_f32 v45, v37, v37
    v_mul_f32 v46, v38, v38
    v_mul_f32 v47, v39, v39
    v_mul_f32 v48, v40, v40
    v_mul_f32 v49, v41, v41
    v_mul_f32 v50, v42, v42
    v_mul_f32 v51, v43, v43
    v_fma_f32 v44, v44, s31, v15
    v_fma_f32 v45, v45, s31, v15
    v_fma_f32 v46, v46, s31, v15
    v_fma_f32 v47, v47, s31, v15
    v_fma_f32 v48, v48, s31, v15
    v_fma_f32 v49, v49, s31, v15
    v_fma_f32 v50, v50, s31, v15
    v_fma_f32 v51, v51, s31, v15
    v_mul_f32 v44, v44, v36
    v_mul_f32 v45, v45, v37
    v_mul_f32 v46, v46, v38
    v_mul_f32 v47, v47, v39
    v_mul_f32 v48, v48, v40
    v_mul_f32 v49, v49, v41
    v_mul_f32 v50, v50, v42
    v_mul_f32 v51, v51, v43
    v_exp_f32 v44, v44
    v_exp_f32 v45, v45
    v_exp_f32 v46, v46
    v_exp_f32 v47, v47
    v_exp_f32 v48, v48
    v_exp_f32 v49, v49
    v_exp_f32 v50, v50
    v_exp_f32 v51, v51
    v_add_f32 v44, 1.0, v44
    v_add_f32 v45, 1.0, v45
    v_add_f32 v46, 1.0, v46
    v_add_f32 v47, 1.0, v47
    v_add_f32 v48, 1.0, v48
    v_add_f32 v49, 1.0, v49
    v_add_f32 v50, 1.0, v50
    v_add_f32 v51, 1.0, v51
    v_rcp_f32 v44, v44
    v_rcp_f32 v45, v45
    v_rcp_f32 v46, v46
    v_rcp_f32 v47, v47
    v_rcp_f32 v48, v48
    v_rcp_f32 v49, v49
    v_rcp_f32 v50, v50
    v_rcp_f32 v51, v51
    v_mul_f32 v36, v36, v44
    v_mul_f32 v37, v37, v45
    v_mul_f32 v38, v38, v46
    v_mul_f32 v39, v39, v47
    v_mul_f32 v40, v40, v48
    v_mul_f32 v41, v41, v49
    v_mul_f32 v42, v42, v50
    v_mul_f32 v43, v43, v51
    v_cvt_pk_bf16_f32 v52, v36, v37
    v_cvt_pk_bf16_f32 v53, v38, v39
    buffer_store_dwordx2 v[52:53], v7, s[16:19], s25 offen offset:0
    v_cvt_pk_bf16_f32 v54, v40, v41
    v_cvt_pk_bf16_f32 v55, v42, v43
    buffer_store_dwordx2 v[54:55], v7, s[16:19], s25 offen offset:1024
    s_add_u32 s25, s25, 2048
    s_add_u32 s25, s25, 12288
    v_fma_f32 v16, v112, v144, v148
    v_fma_f32 v17, v116, v145, v149
    v_fma_f32 v18, v120, v146, v150
    v_fma_f32 v19, v124, v147, v151
    v_fma_f32 v20, v113, v144, v148
    v_fma_f32 v21, v117, v145, v149
    v_fma_f32 v22, v121, v146, v150
    v_fma_f32 v23, v125, v147, v151
    v_mul_f32 v24, v16, v16
    v_mul_f32 v25, v17, v17
    v_mul_f32 v26, v18, v18
    v_mul_f32 v27, v19, v19
    v_mul_f32 v28, v20, v20
    v_mul_f32 v29, v21, v21
    v_mul_f32 v30, v22, v22
    v_mul_f32 v31, v23, v23
    v_fma_f32 v24, v24, s31, v15
    v_fma_f32 v25, v25, s31, v15
    v_fma_f32 v26, v26, s31, v15
    v_fma_f32 v27, v27, s31, v15
    v_fma_f32 v28, v28, s31, v15
    v_fma_f32 v29, v29, s31, v15
    v_fma_f32 v30, v30, s31, v15
    v_fma_f32 v31, v31, s31, v15
    v_mul_f32 v24, v24, v16
    v_mul_f32 v25, v25, v17
    v_mul_f32 v26, v26, v18
    v_mul_f32 v27, v27, v19
    v_mul_f32 v28, v28, v20
    v_mul_f32 v29, v29, v21
    v_mul_f32 v30, v30, v22
    v_mul_f32 v31, v31, v23
    v_exp_f32 v24, v24
    v_exp_f32 v25, v25
    v_exp_f32 v26, v26
    v_exp_f32 v27, v27
    v_exp_f32 v28, v28
    v_exp_f32 v29, v29
    v_exp_f32 v30, v30
    v_exp_f32 v31, v31
    v_add_f32 v24, 1.0, v24
    v_add_f32 v25, 1.0, v25
    v_add_f32 v26, 1.0, v26
    v_add_f32 v27, 1.0, v27
    v_add_f32 v28, 1.0, v28
    v_add_f32 v29, 1.0, v29
    v_add_f32 v30, 1.0, v30
    v_add_f32 v31, 1.0, v31
    v_rcp_f32 v24, v24
    v_rcp_f32 v25, v25
    v_rcp_f32 v26, v26
    v_rcp_f32 v27, v27
    v_rcp_f32 v28, v28
    v_rcp_f32 v29, v29
    v_rcp_f32 v30, v30
    v_rcp_f32 v31, v31
    v_mul_f32 v16, v16, v24
    v_mul_f32 v17, v17, v25
    v_mul_f32 v18, v18, v26
    v_mul_f32 v19, v19, v27
    v_mul_f32 v20, v20, v28
    v_mul_f32 v21, v21, v29
    v_mul_f32 v22, v22, v30
    v_mul_f32 v23, v23, v31
    v_cvt_pk_bf16_f32 v32, v16, v17
    v_cvt_pk_bf16_f32 v33, v18, v19
    buffer_store_dwordx2 v[32:33], v7, s[16:19], s25 offen offset:0
    v_cvt_pk_bf16_f32 v34, v20, v21
    v_cvt_pk_bf16_f32 v35, v22, v23
    buffer_store_dwordx2 v[34:35], v7, s[16:19], s25 offen offset:1024
    s_add_u32 s25, s25, 2048
    v_fma_f32 v36, v114, v144, v148
    v_fma_f32 v37, v118, v145, v149
    v_fma_f32 v38, v122, v146, v150
    v_fma_f32 v39, v126, v147, v151
    v_fma_f32 v40, v115, v144, v148
    v_fma_f32 v41, v119, v145, v149
    v_fma_f32 v42, v123, v146, v150
    v_fma_f32 v43, v127, v147, v151
    v_mul_f32 v44, v36, v36
    v_mul_f32 v45, v37, v37
    v_mul_f32 v46, v38, v38
    v_mul_f32 v47, v39, v39
    v_mul_f32 v48, v40, v40
    v_mul_f32 v49, v41, v41
    v_mul_f32 v50, v42, v42
    v_mul_f32 v51, v43, v43
    v_fma_f32 v44, v44, s31, v15
    v_fma_f32 v45, v45, s31, v15
    v_fma_f32 v46, v46, s31, v15
    v_fma_f32 v47, v47, s31, v15
    v_fma_f32 v48, v48, s31, v15
    v_fma_f32 v49, v49, s31, v15
    v_fma_f32 v50, v50, s31, v15
    v_fma_f32 v51, v51, s31, v15
    v_mul_f32 v44, v44, v36
    v_mul_f32 v45, v45, v37
    v_mul_f32 v46, v46, v38
    v_mul_f32 v47, v47, v39
    v_mul_f32 v48, v48, v40
    v_mul_f32 v49, v49, v41
    v_mul_f32 v50, v50, v42
    v_mul_f32 v51, v51, v43
    v_exp_f32 v44, v44
    v_exp_f32 v45, v45
    v_exp_f32 v46, v46
    v_exp_f32 v47, v47
    v_exp_f32 v48, v48
    v_exp_f32 v49, v49
    v_exp_f32 v50, v50
    v_exp_f32 v51, v51
    v_add_f32 v44, 1.0, v44
    v_add_f32 v45, 1.0, v45
    v_add_f32 v46, 1.0, v46
    v_add_f32 v47, 1.0, v47
    v_add_f32 v48, 1.0, v48
    v_add_f32 v49, 1.0, v49
    v_add_f32 v50, 1.0, v50
    v_add_f32 v51, 1.0, v51
    v_rcp_f32 v44, v44
    v_rcp_f32 v45, v45
    v_rcp_f32 v46, v46
    v_rcp_f32 v47, v47
    v_rcp_f32 v48, v48
    v_rcp_f32 v49, v49
    v_rcp_f32 v50, v50
    v_rcp_f32 v51, v51
    v_mul_f32 v36, v36, v44
    v_mul_f32 v37, v37, v45
    v_mul_f32 v38, v38, v46
    v_mul_f32 v39, v39, v47
    v_mul_f32 v40, v40, v48
    v_mul_f32 v41, v41, v49
    v_mul_f32 v42, v42, v50
    v_mul_f32 v43, v43, v51
    v_cvt_pk_bf16_f32 v52, v36, v37
    v_cvt_pk_bf16_f32 v53, v38, v39
    buffer_store_dwordx2 v[52:53], v7, s[16:19], s25 offen offset:0
    v_cvt_pk_bf16_f32 v54, v40, v41
    v_cvt_pk_bf16_f32 v55, v42, v43
    buffer_store_dwordx2 v[54:55], v7, s[16:19], s25 offen offset:1024
    s_add_u32 s25, s25, 2048
    s_add_u32 s25, s25, 12288
    v_fma_f32 v16, v128, v144, v148
    v_fma_f32 v17, v132, v145, v149
    v_fma_f32 v18, v136, v146, v150
    v_fma_f32 v19, v140, v147, v151
    v_fma_f32 v20, v129, v144, v148
    v_fma_f32 v21, v133, v145, v149
    v_fma_f32 v22, v137, v146, v150
    v_fma_f32 v23, v141, v147, v151
    v_mul_f32 v24, v16, v16
    v_mul_f32 v25, v17, v17
    v_mul_f32 v26, v18, v18
    v_mul_f32 v27, v19, v19
    v_mul_f32 v28, v20, v20
    v_mul_f32 v29, v21, v21
    v_mul_f32 v30, v22, v22
    v_mul_f32 v31, v23, v23
    v_fma_f32 v24, v24, s31, v15
    v_fma_f32 v25, v25, s31, v15
    v_fma_f32 v26, v26, s31, v15
    v_fma_f32 v27, v27, s31, v15
    v_fma_f32 v28, v28, s31, v15
    v_fma_f32 v29, v29, s31, v15
    v_fma_f32 v30, v30, s31, v15
    v_fma_f32 v31, v31, s31, v15
    v_mul_f32 v24, v24, v16
    v_mul_f32 v25, v25, v17
    v_mul_f32 v26, v26, v18
    v_mul_f32 v27, v27, v19
    v_mul_f32 v28, v28, v20
    v_mul_f32 v29, v29, v21
    v_mul_f32 v30, v30, v22
    v_mul_f32 v31, v31, v23
    v_exp_f32 v24, v24
    v_exp_f32 v25, v25
    v_exp_f32 v26, v26
    v_exp_f32 v27, v27
    v_exp_f32 v28, v28
    v_exp_f32 v29, v29
    v_exp_f32 v30, v30
    v_exp_f32 v31, v31
    v_add_f32 v24, 1.0, v24
    v_add_f32 v25, 1.0, v25
    v_add_f32 v26, 1.0, v26
    v_add_f32 v27, 1.0, v27
    v_add_f32 v28, 1.0, v28
    v_add_f32 v29, 1.0, v29
    v_add_f32 v30, 1.0, v30
    v_add_f32 v31, 1.0, v31
    v_rcp_f32 v24, v24
    v_rcp_f32 v25, v25
    v_rcp_f32 v26, v26
    v_rcp_f32 v27, v27
    v_rcp_f32 v28, v28
    v_rcp_f32 v29, v29
    v_rcp_f32 v30, v30
    v_rcp_f32 v31, v31
    v_mul_f32 v16, v16, v24
    v_mul_f32 v17, v17, v25
    v_mul_f32 v18, v18, v26
    v_mul_f32 v19, v19, v27
    v_mul_f32 v20, v20, v28
    v_mul_f32 v21, v21, v29
    v_mul_f32 v22, v22, v30
    v_mul_f32 v23, v23, v31
    v_cvt_pk_bf16_f32 v32, v16, v17
    v_cvt_pk_bf16_f32 v33, v18, v19
    buffer_store_dwordx2 v[32:33], v7, s[16:19], s25 offen offset:0
    v_cvt_pk_bf16_f32 v34, v20, v21
    v_cvt_pk_bf16_f32 v35, v22, v23
    buffer_store_dwordx2 v[34:35], v7, s[16:19], s25 offen offset:1024
    s_add_u32 s25, s25, 2048
    v_fma_f32 v36, v130, v144, v148
    v_fma_f32 v37, v134, v145, v149
    v_fma_f32 v38, v138, v146, v150
    v_fma_f32 v39, v142, v147, v151
    v_fma_f32 v40, v131, v144, v148
    v_fma_f32 v41, v135, v145, v149
    v_fma_f32 v42, v139, v146, v150
    v_fma_f32 v43, v143, v147, v151
    v_mul_f32 v44, v36, v36
    v_mul_f32 v45, v37, v37
    v_mul_f32 v46, v38, v38
    v_mul_f32 v47, v39, v39
    v_mul_f32 v48, v40, v40
    v_mul_f32 v49, v41, v41
    v_mul_f32 v50, v42, v42
    v_mul_f32 v51, v43, v43
    v_fma_f32 v44, v44, s31, v15
    v_fma_f32 v45, v45, s31, v15
    v_fma_f32 v46, v46, s31, v15
    v_fma_f32 v47, v47, s31, v15
    v_fma_f32 v48, v48, s31, v15
    v_fma_f32 v49, v49, s31, v15
    v_fma_f32 v50, v50, s31, v15
    v_fma_f32 v51, v51, s31, v15
    v_mul_f32 v44, v44, v36
    v_mul_f32 v45, v45, v37
    v_mul_f32 v46, v46, v38
    v_mul_f32 v47, v47, v39
    v_mul_f32 v48, v48, v40
    v_mul_f32 v49, v49, v41
    v_mul_f32 v50, v50, v42
    v_mul_f32 v51, v51, v43
    v_exp_f32 v44, v44
    v_exp_f32 v45, v45
    v_exp_f32 v46, v46
    v_exp_f32 v47, v47
    v_exp_f32 v48, v48
    v_exp_f32 v49, v49
    v_exp_f32 v50, v50
    v_exp_f32 v51, v51
    v_add_f32 v44, 1.0, v44
    v_add_f32 v45, 1.0, v45
    v_add_f32 v46, 1.0, v46
    v_add_f32 v47, 1.0, v47
    v_add_f32 v48, 1.0, v48
    v_add_f32 v49, 1.0, v49
    v_add_f32 v50, 1.0, v50
    v_add_f32 v51, 1.0, v51
    v_rcp_f32 v44, v44
    v_rcp_f32 v45, v45
    v_rcp_f32 v46, v46
    v_rcp_f32 v47, v47
    v_rcp_f32 v48, v48
    v_rcp_f32 v49, v49
    v_rcp_f32 v50, v50
    v_rcp_f32 v51, v51
    v_mul_f32 v36, v36, v44
    v_mul_f32 v37, v37, v45
    v_mul_f32 v38, v38, v46
    v_mul_f32 v39, v39, v47
    v_mul_f32 v40, v40, v48
    v_mul_f32 v41, v41, v49
    v_mul_f32 v42, v42, v50
    v_mul_f32 v43, v43, v51
    v_cvt_pk_bf16_f32 v52, v36, v37
    v_cvt_pk_bf16_f32 v53, v38, v39
    buffer_store_dwordx2 v[52:53], v7, s[16:19], s25 offen offset:0
    v_cvt_pk_bf16_f32 v54, v40, v41
    v_cvt_pk_bf16_f32 v55, v42, v43
    buffer_store_dwordx2 v[54:55], v7, s[16:19], s25 offen offset:1024
    s_add_u32 s25, s25, 2048
    s_add_u32 s25, s25, 12288
K4_END:
    s_endpgm
TEXT_END:
.section .rodata,"a"
.p2align 6
.amdhsa_kernel k1_xform_kernel
  .amdhsa_next_free_vgpr 128
  .amdhsa_next_free_sgpr 96
  .amdhsa_accum_offset 128
  .amdhsa_group_segment_fixed_size 0
  .amdhsa_kernarg_size 56
  .amdhsa_user_sgpr_count 2
  .amdhsa_user_sgpr_kernarg_segment_ptr 1
  .amdhsa_system_sgpr_workgroup_id_x 1
.end_amdhsa_kernel
.p2align 6
.amdhsa_kernel k12_fused_kernel
  .amdhsa_next_free_vgpr 256
  .amdhsa_next_free_sgpr 96
  .amdhsa_accum_offset 256
  .amdhsa_group_segment_fixed_size 0
  .amdhsa_kernarg_size 56
  .amdhsa_user_sgpr_count 2
  .amdhsa_user_sgpr_kernarg_segment_ptr 1
  .amdhsa_system_sgpr_workgroup_id_x 1
.end_amdhsa_kernel
.p2align 6
.amdhsa_kernel k3_stats_kernel
  .amdhsa_next_free_vgpr 168
  .amdhsa_next_free_sgpr 96
  .amdhsa_accum_offset 168
  .amdhsa_group_segment_fixed_size 0
  .amdhsa_kernarg_size 56
  .amdhsa_user_sgpr_count 2
  .amdhsa_user_sgpr_kernarg_segment_ptr 1
  .amdhsa_system_sgpr_workgroup_id_x 1
.end_amdhsa_kernel
.p2align 6
.amdhsa_kernel k4_out_kernel
  .amdhsa_next_free_vgpr 168
  .amdhsa_next_free_sgpr 96
  .amdhsa_accum_offset 168
  .amdhsa_group_segment_fixed_size 0
  .amdhsa_kernarg_size 56
  .amdhsa_user_sgpr_count 2
  .amdhsa_user_sgpr_kernarg_segment_ptr 1
  .amdhsa_system_sgpr_workgroup_id_x 1
.end_amdhsa_kernel
```

```asm
; @launch kernel=k1_xform_kernel grid=(636,1,1) block=(256,1,1) lds=16384
; @launch kernel=k12_fused_kernel grid=(256,1,1) block=(512,1,1) lds=155840
; @launch kernel=k34_out_kernel grid=(256,1,1) block=(768,1,1) lds=18944
.amdgcn_target "amdgcn-amd-amdhsa--gfx950"
.text
.globl k1_xform_kernel
.globl k12_fused_kernel
.globl k34_out_kernel
.p2align 8
.type k1_xform_kernel,@function
k1_xform_kernel:
    s_cmp_ge_u32 s2, 636
    s_cbranch_scc1 K1_END
    s_load_dwordx4 s[4:7], s[0:1], 0
    s_load_dwordx2 s[8:9], s[0:1], 48
    v_lshrrev_b32 v120, 6, v0
    v_and_b32 v121, 63, v0
    v_readfirstlane_b32 s3, v120
    v_and_b32 v122, 15, v121
    v_lshrrev_b32 v123, 4, v121
    s_mov_b32 s28, 0x05040100
    s_mov_b32 s29, 0x07060302
    v_and_b32 v124, 3, v122
    v_lshlrev_b32 v124, 2, v124
    v_lshrrev_b32 v125, 3, v122
    v_lshl_add_u32 v124, v125, 1, v124
    s_lshl_b32 s10, s3, 4
    s_add_u32 s10, s10, 1
    v_add_u32 v124, s10, v124
    v_bfe_u32 v125, v122, 2, 1
    v_lshlrev_b32 v121, 4, v121
    s_waitcnt lgkmcnt(0)
    s_or_b32 s10, s2, s3
    s_cmp_eq_u32 s10, 0
    s_cbranch_scc0 K1_NOCLR
    s_add_u32 s12, s8, 153092096
    s_addc_u32 s13, s9, 0
    s_and_b32 s13, s13, 0xffff
    s_mov_b32 s14, 32768
    s_mov_b32 s15, 0x00020000
    v_lshrrev_b32 v118, 4, v121
    v_lshlrev_b32 v119, 10, v118
    v_mov_b32 v117, 0
    s_mov_b64 exec, 0xffff
    buffer_store_dword v117, v119, s[12:15], 0 offen
    v_lshlrev_b32 v119, 4, v118
    v_add_u32 v119, 16384, v119
    buffer_store_dword v117, v119, s[12:15], 0 offen
    s_mov_b64 exec, -1
K1_NOCLR:
    s_cmp_lt_u32 s2, 32
    s_cbranch_scc0 K1_NOFILL
    s_add_u32 s12, s8, 153616384
    s_addc_u32 s13, s9, 0
    s_and_b32 s13, s13, 0xffff
    s_mov_b32 s14, 131072
    s_mov_b32 s15, 0x00020000
    s_lshl_b32 s10, s2, 2
    s_add_u32 s10, s10, s3
    s_lshl_b32 s10, s10, 10
    v_mov_b32 v112, -1
    v_mov_b32 v113, -1
    v_mov_b32 v114, -1
    v_mov_b32 v115, -1
    buffer_store_dwordx4 v[112:115], v121, s[12:15], s10 offen
K1_NOFILL:
    s_add_u32 s10, s2, 384
    s_sub_u32 s11, s2, 252
    s_cmp_lt_u32 s2, 252
    s_cselect_b32 s2, s10, s11
    s_cmp_lt_u32 s2, 384
    s_cbranch_scc1 K1_W
    s_sub_u32 s11, s2, 384
    s_mul_hi_u32 s13, s11, 1431655766
    s_mul_i32 s12, s13, 3
    s_sub_u32 s12, s11, s12
    s_mov_b32 s11, s13
    s_cmp_ge_u32 s11, 42
    s_cselect_b32 s13, 1, 0
    s_mul_i32 s14, s13, 42
    s_sub_u32 s11, s11, s14
    s_lshl_b32 s11, s11, 2
    s_add_u32 s11, s11, s3
    s_mul_i32 s14, s13, 16384000
    s_add_u32 s16, s4, s14
    s_addc_u32 s17, s5, 0
    s_and_b32 s17, s17, 0xffff
    s_mov_b32 s18, 16384000
    s_mov_b32 s19, 0x00020000
    s_mov_b32 s20, s8
    s_mov_b32 s21, s9
    s_and_b32 s21, s21, 0xffff
    s_mov_b32 s22, 43778048
    s_mov_b32 s23, 0x00020000
    v_lshlrev_b32 v126, 14, v123
    v_lshl_add_u32 v126, v122, 4, v126
    s_mul_i32 s15, s11, 98304
    s_lshl_b32 s24, s12, 8
    s_add_u32 s15, s15, s24
    buffer_load_dwordx4 v[0:3], v126, s[16:19], s15 offen
    buffer_load_dwordx4 v[4:7], v126, s[16:19], s15 offen offset:2048
    s_add_u32 s15, s15, 4096
    buffer_load_dwordx4 v[8:11], v126, s[16:19], s15 offen
    buffer_load_dwordx4 v[12:15], v126, s[16:19], s15 offen offset:2048
    s_add_u32 s15, s15, 4096
    buffer_load_dwordx4 v[16:19], v126, s[16:19], s15 offen
    buffer_load_dwordx4 v[20:23], v126, s[16:19], s15 offen offset:2048
    s_add_u32 s15, s15, 4096
    buffer_load_dwordx4 v[24:27], v126, s[16:19], s15 offen
    buffer_load_dwordx4 v[28:31], v126, s[16:19], s15 offen offset:2048
    s_add_u32 s15, s15, 53248
    buffer_load_dwordx4 v[32:35], v126, s[16:19], s15 offen
    buffer_load_dwordx4 v[36:39], v126, s[16:19], s15 offen offset:2048
    s_add_u32 s15, s15, 4096
    buffer_load_dwordx4 v[40:43], v126, s[16:19], s15 offen
    buffer_load_dwordx4 v[44:47], v126, s[16:19], s15 offen offset:2048
    s_add_u32 s15, s15, 4096
    buffer_load_dwordx4 v[48:51], v126, s[16:19], s15 offen
    buffer_load_dwordx4 v[52:55], v126, s[16:19], s15 offen offset:2048
    s_add_u32 s15, s15, 4096
    buffer_load_dwordx4 v[56:59], v126, s[16:19], s15 offen
    buffer_load_dwordx4 v[60:63], v126, s[16:19], s15 offen offset:2048
    v_lshlrev_b32 v127, 3, v123
    v_lshlrev_b32 v112, 5, v125
    v_mad_u32_u24 v113, v124, v127, v112
    v_mad_u32_u24 v64, v124, 0, v113
    v_mad_u32_u24 v65, v124, 1, v113
    v_mad_u32_u24 v66, v124, 2, v113
    v_mad_u32_u24 v67, v124, 3, v113
    v_mad_u32_u24 v68, v124, 4, v113
    v_mad_u32_u24 v69, v124, 5, v113
    v_mad_u32_u24 v70, v124, 6, v113
    v_mad_u32_u24 v71, v124, 7, v113
    v_and_b32 v64, 127, v64
    v_and_b32 v65, 127, v65
    v_and_b32 v66, 127, v66
    v_and_b32 v67, 127, v67
    v_and_b32 v68, 127, v68
    v_and_b32 v69, 127, v69
    v_and_b32 v70, 127, v70
    v_and_b32 v71, 127, v71
    v_cvt_f32_u32 v64, v64
    v_cvt_f32_u32 v65, v65
    v_cvt_f32_u32 v66, v66
    v_cvt_f32_u32 v67, v67
    v_cvt_f32_u32 v68, v68
    v_cvt_f32_u32 v69, v69
    v_cvt_f32_u32 v70, v70
    v_cvt_f32_u32 v71, v71
    v_mul_f32 v64, 0x3c000000, v64
    v_mul_f32 v65, 0x3c000000, v65
    v_mul_f32 v66, 0x3c000000, v66
    v_mul_f32 v67, 0x3c000000, v67
    v_mul_f32 v68, 0x3c000000, v68
    v_mul_f32 v69, 0x3c000000, v69
    v_mul_f32 v70, 0x3c000000, v70
    v_mul_f32 v71, 0x3c000000, v71
    v_cos_f32 v64, v64
    v_cos_f32 v65, v65
    v_cos_f32 v66, v66
    v_cos_f32 v67, v67
    v_cos_f32 v68, v68
    v_cos_f32 v69, v69
    v_cos_f32 v70, v70
    v_cos_f32 v71, v71
    s_nop 0
    v_cvt_pk_bf16_f32 v72, v64, v65
    v_cvt_pk_bf16_f32 v73, v66, v67
    v_cvt_pk_bf16_f32 v74, v68, v69
    v_cvt_pk_bf16_f32 v75, v70, v71
    v_lshlrev_b32 v80, 16, v72
    v_and_b32 v81, 0xffff0000, v72
    v_sub_f32 v64, v64, v80
    v_sub_f32 v65, v65, v81
    v_lshlrev_b32 v80, 16, v73
    v_and_b32 v81, 0xffff0000, v73
    v_sub_f32 v66, v66, v80
    v_sub_f32 v67, v67, v81
    v_lshlrev_b32 v80, 16, v74
    v_and_b32 v81, 0xffff0000, v74
    v_sub_f32 v68, v68, v80
    v_sub_f32 v69, v69, v81
    v_lshlrev_b32 v80, 16, v75
    v_and_b32 v81, 0xffff0000, v75
    v_sub_f32 v70, v70, v80
    v_sub_f32 v71, v71, v81
    v_cvt_pk_bf16_f32 v76, v64, v65
    v_cvt_pk_bf16_f32 v77, v66, v67
    v_cvt_pk_bf16_f32 v78, v68, v69
    v_cvt_pk_bf16_f32 v79, v70, v71
    s_lshl_b32 s24, s3, 12
    v_add_u32 v114, s24, v121
    ds_write_b128 v114, v[72:75] offset:0
    ds_write_b128 v114, v[76:79] offset:1024
    v_add_u32 v127, 32, v127
    v_lshlrev_b32 v112, 5, v125
    v_mad_u32_u24 v113, v124, v127, v112
    v_mad_u32_u24 v64, v124, 0, v113
    v_mad_u32_u24 v65, v124, 1, v113
    v_mad_u32_u24 v66, v124, 2, v113
    v_mad_u32_u24 v67, v124, 3, v113
    v_mad_u32_u24 v68, v124, 4, v113
    v_mad_u32_u24 v69, v124, 5, v113
    v_mad_u32_u24 v70, v124, 6, v113
    v_mad_u32_u24 v71, v124, 7, v113
    v_and_b32 v64, 127, v64
    v_and_b32 v65, 127, v65
    v_and_b32 v66, 127, v66
    v_and_b32 v67, 127, v67
    v_and_b32 v68, 127, v68
    v_and_b32 v69, 127, v69
    v_and_b32 v70, 127, v70
    v_and_b32 v71, 127, v71
    v_cvt_f32_u32 v64, v64
    v_cvt_f32_u32 v65, v65
    v_cvt_f32_u32 v66, v66
    v_cvt_f32_u32 v67, v67
    v_cvt_f32_u32 v68, v68
    v_cvt_f32_u32 v69, v69
    v_cvt_f32_u32 v70, v70
    v_cvt_f32_u32 v71, v71
    v_mul_f32 v64, 0x3c000000, v64
    v_mul_f32 v65, 0x3c000000, v65
    v_mul_f32 v66, 0x3c000000, v66
    v_mul_f32 v67, 0x3c000000, v67
    v_mul_f32 v68, 0x3c000000, v68
    v_mul_f32 v69, 0x3c000000, v69
    v_mul_f32 v70, 0x3c000000, v70
    v_mul_f32 v71, 0x3c000000, v71
    v_cos_f32 v64, v64
    v_cos_f32 v65, v65
    v_cos_f32 v66, v66
    v_cos_f32 v67, v67
    v_cos_f32 v68, v68
    v_cos_f32 v69, v69
    v_cos_f32 v70, v70
    v_cos_f32 v71, v71
    s_nop 0
    v_cvt_pk_bf16_f32 v72, v64, v65
    v_cvt_pk_bf16_f32 v73, v66, v67
    v_cvt_pk_bf16_f32 v74, v68, v69
    v_cvt_pk_bf16_f32 v75, v70, v71
    v_lshlrev_b32 v80, 16, v72
    v_and_b32 v81, 0xffff0000, v72
    v_sub_f32 v64, v64, v80
    v_sub_f32 v65, v65, v81
    v_lshlrev_b32 v80, 16, v73
    v_and_b32 v81, 0xffff0000, v73
    v_sub_f32 v66, v66, v80
    v_sub_f32 v67, v67, v81
    v_lshlrev_b32 v80, 16, v74
    v_and_b32 v81, 0xffff0000, v74
    v_sub_f32 v68, v68, v80
    v_sub_f32 v69, v69, v81
    v_lshlrev_b32 v80, 16, v75
    v_and_b32 v81, 0xffff0000, v75
    v_sub_f32 v70, v70, v80
    v_sub_f32 v71, v71, v81
    v_cvt_pk_bf16_f32 v76, v64, v65
    v_cvt_pk_bf16_f32 v77, v66, v67
    v_cvt_pk_bf16_f32 v78, v68, v69
    v_cvt_pk_bf16_f32 v79, v70, v71
    s_lshl_b32 s24, s3, 12
    v_add_u32 v114, s24, v121
    ds_write_b128 v114, v[72:75] offset:2048
    ds_write_b128 v114, v[76:79] offset:3072
    v_lshrrev_b32 v112, 1, v123
    s_mov_b32 s24, 1368064
    v_mul_lo_u32 v112, v112, s24
    v_lshrrev_b32 v113, 2, v122
    s_mov_b32 s24, 21376
    v_mul_lo_u32 v113, v113, s24
    v_add_u32 v112, v112, v113
    v_and_b32 v113, 3, v122
    v_and_b32 v114, 1, v123
    v_lshl_add_u32 v113, v114, 2, v113
    s_lshr_b32 s24, s11, 1
    s_and_b32 s24, s24, 7
    v_xor_b32 v113, s24, v113
    v_lshl_add_u32 v120, v113, 4, v112
    s_mul_i32 s25, s13, 684032
    s_mul_i32 s24, s12, 85504
    s_add_u32 s25, s25, s24
    s_lshl_b32 s24, s11, 7
    s_add_u32 s25, s25, s24
    s_waitcnt lgkmcnt(0)
    s_barrier
    s_cmp_ge_u32 s11, 167
    s_cbranch_scc1 K1_END
    s_waitcnt vmcnt(8)
    v_perm_b32 v64, v4, v0, s28
    v_perm_b32 v68, v4, v0, s29
    v_perm_b32 v65, v12, v8, s28
    v_perm_b32 v69, v12, v8, s29
    v_perm_b32 v66, v20, v16, s28
    v_perm_b32 v70, v20, v16, s29
    v_perm_b32 v67, v28, v24, s28
    v_perm_b32 v71, v28, v24, s29
    v_perm_b32 v72, v5, v1, s28
    v_perm_b32 v76, v5, v1, s29
    v_perm_b32 v73, v13, v9, s28
    v_perm_b32 v77, v13, v9, s29
    v_perm_b32 v74, v21, v17, s28
    v_perm_b32 v78, v21, v17, s29
    v_perm_b32 v75, v29, v25, s28
    v_perm_b32 v79, v29, v25, s29
    v_perm_b32 v80, v6, v2, s28
    v_perm_b32 v84, v6, v2, s29
    v_perm_b32 v81, v14, v10, s28
    v_perm_b32 v85, v14, v10, s29
    v_perm_b32 v82, v22, v18, s28
    v_perm_b32 v86, v22, v18, s29
    v_perm_b32 v83, v30, v26, s28
    v_perm_b32 v87, v30, v26, s29
    v_perm_b32 v88, v7, v3, s28
    v_perm_b32 v92, v7, v3, s29
    v_perm_b32 v89, v15, v11, s28
    v_perm_b32 v93, v15, v11, s29
    v_perm_b32 v90, v23, v19, s28
    v_perm_b32 v94, v23, v19, s29
    v_perm_b32 v91, v31, v27, s28
    v_perm_b32 v95, v31, v27, s29
    s_waitcnt vmcnt(0)
    v_perm_b32 v0, v36, v32, s28
    v_perm_b32 v4, v36, v32, s29
    v_perm_b32 v1, v44, v40, s28
    v_perm_b32 v5, v44, v40, s29
    v_perm_b32 v2, v52, v48, s28
    v_perm_b32 v6, v52, v48, s29
    v_perm_b32 v3, v60, v56, s28
    v_perm_b32 v7, v60, v56, s29
    v_perm_b32 v8, v37, v33, s28
    v_perm_b32 v12, v37, v33, s29
    v_perm_b32 v9, v45, v41, s28
    v_perm_b32 v13, v45, v41, s29
    v_perm_b32 v10, v53, v49, s28
    v_perm_b32 v14, v53, v49, s29
    v_perm_b32 v11, v61, v57, s28
    v_perm_b32 v15, v61, v57, s29
    v_perm_b32 v16, v38, v34, s28
    v_perm_b32 v20, v38, v34, s29
    v_perm_b32 v17, v46, v42, s28
    v_perm_b32 v21, v46, v42, s29
    v_perm_b32 v18, v54, v50, s28
    v_perm_b32 v22, v54, v50, s29
    v_perm_b32 v19, v62, v58, s28
    v_perm_b32 v23, v62, v58, s29
    v_perm_b32 v24, v39, v35, s28
    v_perm_b32 v28, v39, v35, s29
    v_perm_b32 v25, v47, v43, s28
    v_perm_b32 v29, v47, v43, s29
    v_perm_b32 v26, v55, v51, s28
    v_perm_b32 v30, v55, v51, s29
    v_perm_b32 v27, v63, v59, s28
    v_perm_b32 v31, v63, v59, s29
    ds_read_b128 v[96:99], v121 offset:0
    ds_read_b128 v[100:103], v121 offset:1024
    ds_read_b128 v[104:107], v121 offset:2048
    ds_read_b128 v[108:111], v121 offset:3072
    s_waitcnt lgkmcnt(3)
    v_mfma_f32_16x16x32_bf16 v[32:35], v[96:99], v[64:67], 0
    v_mfma_f32_16x16x32_bf16 v[36:39], v[96:99], v[68:71], 0
    v_mfma_f32_16x16x32_bf16 v[40:43], v[96:99], v[72:75], 0
    v_mfma_f32_16x16x32_bf16 v[44:47], v[96:99], v[76:79], 0
    v_mfma_f32_16x16x32_bf16 v[48:51], v[96:99], v[80:83], 0
    v_mfma_f32_16x16x32_bf16 v[52:55], v[96:99], v[84:87], 0
    v_mfma_f32_16x16x32_bf16 v[56:59], v[96:99], v[88:91], 0
    v_mfma_f32_16x16x32_bf16 v[60:63], v[96:99], v[92:95], 0
    s_waitcnt lgkmcnt(2)
    v_mfma_f32_16x16x32_bf16 v[32:35], v[100:103], v[64:67], v[32:35]
    v_mfma_f32_16x16x32_bf16 v[36:39], v[100:103], v[68:71], v[36:39]
    v_mfma_f32_16x16x32_bf16 v[40:43], v[100:103], v[72:75], v[40:43]
    v_mfma_f32_16x16x32_bf16 v[44:47], v[100:103], v[76:79], v[44:47]
    v_mfma_f32_16x16x32_bf16 v[48:51], v[100:103], v[80:83], v[48:51]
    v_mfma_f32_16x16x32_bf16 v[52:55], v[100:103], v[84:87], v[52:55]
    v_mfma_f32_16x16x32_bf16 v[56:59], v[100:103], v[88:91], v[56:59]
    v_mfma_f32_16x16x32_bf16 v[60:63], v[100:103], v[92:95], v[60:63]
    s_waitcnt lgkmcnt(1)
    v_mfma_f32_16x16x32_bf16 v[32:35], v[104:107], v[0:3], v[32:35]
    v_mfma_f32_16x16x32_bf16 v[36:39], v[104:107], v[4:7], v[36:39]
    v_mfma_f32_16x16x32_bf16 v[40:43], v[104:107], v[8:11], v[40:43]
    v_mfma_f32_16x16x32_bf16 v[44:47], v[104:107], v[12:15], v[44:47]
    v_mfma_f32_16x16x32_bf16 v[48:51], v[104:107], v[16:19], v[48:51]
    v_mfma_f32_16x16x32_bf16 v[52:55], v[104:107], v[20:23], v[52:55]
    v_mfma_f32_16x16x32_bf16 v[56:59], v[104:107], v[24:27], v[56:59]
    v_mfma_f32_16x16x32_bf16 v[60:63], v[104:107], v[28:31], v[60:63]
    s_waitcnt lgkmcnt(0)
    v_mfma_f32_16x16x32_bf16 v[32:35], v[108:111], v[0:3], v[32:35]
    v_mfma_f32_16x16x32_bf16 v[36:39], v[108:111], v[4:7], v[36:39]
    v_mfma_f32_16x16x32_bf16 v[40:43], v[108:111], v[8:11], v[40:43]
    v_mfma_f32_16x16x32_bf16 v[44:47], v[108:111], v[12:15], v[44:47]
    v_mfma_f32_16x16x32_bf16 v[48:51], v[108:111], v[16:19], v[48:51]
    v_mfma_f32_16x16x32_bf16 v[52:55], v[108:111], v[20:23], v[52:55]
    v_mfma_f32_16x16x32_bf16 v[56:59], v[108:111], v[24:27], v[56:59]
    v_mfma_f32_16x16x32_bf16 v[60:63], v[108:111], v[28:31], v[60:63]
    s_nop 7
    v_cvt_pk_bf16_f32 v112, v32, v36
    v_cvt_pk_bf16_f32 v113, v40, v44
    v_cvt_pk_bf16_f32 v114, v48, v52
    v_cvt_pk_bf16_f32 v115, v56, v60
    buffer_store_dwordx4 v[112:115], v120, s[20:23], s25 offen
    s_add_u32 s25, s25, 2736128
    v_cvt_pk_bf16_f32 v116, v33, v37
    v_cvt_pk_bf16_f32 v117, v41, v45
    v_cvt_pk_bf16_f32 v118, v49, v53
    v_cvt_pk_bf16_f32 v119, v57, v61
    buffer_store_dwordx4 v[116:119], v120, s[20:23], s25 offen
    s_add_u32 s25, s25, 2736128
    v_cvt_pk_bf16_f32 v112, v34, v38
    v_cvt_pk_bf16_f32 v113, v42, v46
    v_cvt_pk_bf16_f32 v114, v50, v54
    v_cvt_pk_bf16_f32 v115, v58, v62
    buffer_store_dwordx4 v[112:115], v120, s[20:23], s25 offen
    s_add_u32 s25, s25, 2736128
    v_cvt_pk_bf16_f32 v116, v35, v39
    v_cvt_pk_bf16_f32 v117, v43, v47
    v_cvt_pk_bf16_f32 v118, v51, v55
    v_cvt_pk_bf16_f32 v119, v59, v63
    buffer_store_dwordx4 v[116:119], v120, s[20:23], s25 offen
    s_add_u32 s25, s25, 2736128
    ds_read_b128 v[96:99], v121 offset:4096
    ds_read_b128 v[100:103], v121 offset:5120
    ds_read_b128 v[104:107], v121 offset:6144
    ds_read_b128 v[108:111], v121 offset:7168
    s_waitcnt lgkmcnt(3)
    v_mfma_f32_16x16x32_bf16 v[32:35], v[96:99], v[64:67], 0
    v_mfma_f32_16x16x32_bf16 v[36:39], v[96:99], v[68:71], 0
    v_mfma_f32_16x16x32_bf16 v[40:43], v[96:99], v[72:75], 0
    v_mfma_f32_16x16x32_bf16 v[44:47], v[96:99], v[76:79], 0
    v_mfma_f32_16x16x32_bf16 v[48:51], v[96:99], v[80:83], 0
    v_mfma_f32_16x16x32_bf16 v[52:55], v[96:99], v[84:87], 0
    v_mfma_f32_16x16x32_bf16 v[56:59], v[96:99], v[88:91], 0
    v_mfma_f32_16x16x32_bf16 v[60:63], v[96:99], v[92:95], 0
    s_waitcnt lgkmcnt(2)
    v_mfma_f32_16x16x32_bf16 v[32:35], v[100:103], v[64:67], v[32:35]
    v_mfma_f32_16x16x32_bf16 v[36:39], v[100:103], v[68:71], v[36:39]
    v_mfma_f32_16x16x32_bf16 v[40:43], v[100:103], v[72:75], v[40:43]
    v_mfma_f32_16x16x32_bf16 v[44:47], v[100:103], v[76:79], v[44:47]
    v_mfma_f32_16x16x32_bf16 v[48:51], v[100:103], v[80:83], v[48:51]
    v_mfma_f32_16x16x32_bf16 v[52:55], v[100:103], v[84:87], v[52:55]
    v_mfma_f32_16x16x32_bf16 v[56:59], v[100:103], v[88:91], v[56:59]
    v_mfma_f32_16x16x32_bf16 v[60:63], v[100:103], v[92:95], v[60:63]
    s_waitcnt lgkmcnt(1)
    v_mfma_f32_16x16x32_bf16 v[32:35], v[104:107], v[0:3], v[32:35]
    v_mfma_f32_16x16x32_bf16 v[36:39], v[104:107], v[4:7], v[36:39]
    v_mfma_f32_16x16x32_bf16 v[40:43], v[104:107], v[8:11], v[40:43]
    v_mfma_f32_16x16x32_bf16 v[44:47], v[104:107], v[12:15], v[44:47]
    v_mfma_f32_16x16x32_bf16 v[48:51], v[104:107], v[16:19], v[48:51]
    v_mfma_f32_16x16x32_bf16 v[52:55], v[104:107], v[20:23], v[52:55]
    v_mfma_f32_16x16x32_bf16 v[56:59], v[104:107], v[24:27], v[56:59]
    v_mfma_f32_16x16x32_bf16 v[60:63], v[104:107], v[28:31], v[60:63]
    s_waitcnt lgkmcnt(0)
    v_mfma_f32_16x16x32_bf16 v[32:35], v[108:111], v[0:3], v[32:35]
    v_mfma_f32_16x16x32_bf16 v[36:39], v[108:111], v[4:7], v[36:39]
    v_mfma_f32_16x16x32_bf16 v[40:43], v[108:111], v[8:11], v[40:43]
    v_mfma_f32_16x16x32_bf16 v[44:47], v[108:111], v[12:15], v[44:47]
    v_mfma_f32_16x16x32_bf16 v[48:51], v[108:111], v[16:19], v[48:51]
    v_mfma_f32_16x16x32_bf16 v[52:55], v[108:111], v[20:23], v[52:55]
    v_mfma_f32_16x16x32_bf16 v[56:59], v[108:111], v[24:27], v[56:59]
    v_mfma_f32_16x16x32_bf16 v[60:63], v[108:111], v[28:31], v[60:63]
    s_nop 7
    v_cvt_pk_bf16_f32 v112, v32, v36
    v_cvt_pk_bf16_f32 v113, v40, v44
    v_cvt_pk_bf16_f32 v114, v48, v52
    v_cvt_pk_bf16_f32 v115, v56, v60
    buffer_store_dwordx4 v[112:115], v120, s[20:23], s25 offen
    s_add_u32 s25, s25, 2736128
    v_cvt_pk_bf16_f32 v116, v33, v37
    v_cvt_pk_bf16_f32 v117, v41, v45
    v_cvt_pk_bf16_f32 v118, v49, v53
    v_cvt_pk_bf16_f32 v119, v57, v61
    buffer_store_dwordx4 v[116:119], v120, s[20:23], s25 offen
    s_add_u32 s25, s25, 2736128
    v_cvt_pk_bf16_f32 v112, v34, v38
    v_cvt_pk_bf16_f32 v113, v42, v46
    v_cvt_pk_bf16_f32 v114, v50, v54
    v_cvt_pk_bf16_f32 v115, v58, v62
    buffer_store_dwordx4 v[112:115], v120, s[20:23], s25 offen
    s_add_u32 s25, s25, 2736128
    v_cvt_pk_bf16_f32 v116, v35, v39
    v_cvt_pk_bf16_f32 v117, v43, v47
    v_cvt_pk_bf16_f32 v118, v51, v55
    v_cvt_pk_bf16_f32 v119, v59, v63
    buffer_store_dwordx4 v[116:119], v120, s[20:23], s25 offen
    s_add_u32 s25, s25, 2736128
    ds_read_b128 v[96:99], v121 offset:8192
    ds_read_b128 v[100:103], v121 offset:9216
    ds_read_b128 v[104:107], v121 offset:10240
    ds_read_b128 v[108:111], v121 offset:11264
    s_waitcnt lgkmcnt(3)
    v_mfma_f32_16x16x32_bf16 v[32:35], v[96:99], v[64:67], 0
    v_mfma_f32_16x16x32_bf16 v[36:39], v[96:99], v[68:71], 0
    v_mfma_f32_16x16x32_bf16 v[40:43], v[96:99], v[72:75], 0
    v_mfma_f32_16x16x32_bf16 v[44:47], v[96:99], v[76:79], 0
    v_mfma_f32_16x16x32_bf16 v[48:51], v[96:99], v[80:83], 0
    v_mfma_f32_16x16x32_bf16 v[52:55], v[96:99], v[84:87], 0
    v_mfma_f32_16x16x32_bf16 v[56:59], v[96:99], v[88:91], 0
    v_mfma_f32_16x16x32_bf16 v[60:63], v[96:99], v[92:95], 0
    s_waitcnt lgkmcnt(2)
    v_mfma_f32_16x16x32_bf16 v[32:35], v[100:103], v[64:67], v[32:35]
    v_mfma_f32_16x16x32_bf16 v[36:39], v[100:103], v[68:71], v[36:39]
    v_mfma_f32_16x16x32_bf16 v[40:43], v[100:103], v[72:75], v[40:43]
    v_mfma_f32_16x16x32_bf16 v[44:47], v[100:103], v[76:79], v[44:47]
    v_mfma_f32_16x16x32_bf16 v[48:51], v[100:103], v[80:83], v[48:51]
    v_mfma_f32_16x16x32_bf16 v[52:55], v[100:103], v[84:87], v[52:55]
    v_mfma_f32_16x16x32_bf16 v[56:59], v[100:103], v[88:91], v[56:59]
    v_mfma_f32_16x16x32_bf16 v[60:63], v[100:103], v[92:95], v[60:63]
    s_waitcnt lgkmcnt(1)
    v_mfma_f32_16x16x32_bf16 v[32:35], v[104:107], v[0:3], v[32:35]
    v_mfma_f32_16x16x32_bf16 v[36:39], v[104:107], v[4:7], v[36:39]
    v_mfma_f32_16x16x32_bf16 v[40:43], v[104:107], v[8:11], v[40:43]
    v_mfma_f32_16x16x32_bf16 v[44:47], v[104:107], v[12:15], v[44:47]
    v_mfma_f32_16x16x32_bf16 v[48:51], v[104:107], v[16:19], v[48:51]
    v_mfma_f32_16x16x32_bf16 v[52:55], v[104:107], v[20:23], v[52:55]
    v_mfma_f32_16x16x32_bf16 v[56:59], v[104:107], v[24:27], v[56:59]
    v_mfma_f32_16x16x32_bf16 v[60:63], v[104:107], v[28:31], v[60:63]
    s_waitcnt lgkmcnt(0)
    v_mfma_f32_16x16x32_bf16 v[32:35], v[108:111], v[0:3], v[32:35]
    v_mfma_f32_16x16x32_bf16 v[36:39], v[108:111], v[4:7], v[36:39]
    v_mfma_f32_16x16x32_bf16 v[40:43], v[108:111], v[8:11], v[40:43]
    v_mfma_f32_16x16x32_bf16 v[44:47], v[108:111], v[12:15], v[44:47]
    v_mfma_f32_16x16x32_bf16 v[48:51], v[108:111], v[16:19], v[48:51]
    v_mfma_f32_16x16x32_bf16 v[52:55], v[108:111], v[20:23], v[52:55]
    v_mfma_f32_16x16x32_bf16 v[56:59], v[108:111], v[24:27], v[56:59]
    v_mfma_f32_16x16x32_bf16 v[60:63], v[108:111], v[28:31], v[60:63]
    s_nop 7
    v_cvt_pk_bf16_f32 v112, v32, v36
    v_cvt_pk_bf16_f32 v113, v40, v44
    v_cvt_pk_bf16_f32 v114, v48, v52
    v_cvt_pk_bf16_f32 v115, v56, v60
    buffer_store_dwordx4 v[112:115], v120, s[20:23], s25 offen
    s_add_u32 s25, s25, 2736128
    v_cvt_pk_bf16_f32 v116, v33, v37
    v_cvt_pk_bf16_f32 v117, v41, v45
    v_cvt_pk_bf16_f32 v118, v49, v53
    v_cvt_pk_bf16_f32 v119, v57, v61
    buffer_store_dwordx4 v[116:119], v120, s[20:23], s25 offen
    s_add_u32 s25, s25, 2736128
    v_cvt_pk_bf16_f32 v112, v34, v38
    v_cvt_pk_bf16_f32 v113, v42, v46
    v_cvt_pk_bf16_f32 v114, v50, v54
    v_cvt_pk_bf16_f32 v115, v58, v62
    buffer_store_dwordx4 v[112:115], v120, s[20:23], s25 offen
    s_add_u32 s25, s25, 2736128
    v_cvt_pk_bf16_f32 v116, v35, v39
    v_cvt_pk_bf16_f32 v117, v43, v47
    v_cvt_pk_bf16_f32 v118, v51, v55
    v_cvt_pk_bf16_f32 v119, v59, v63
    buffer_store_dwordx4 v[116:119], v120, s[20:23], s25 offen
    s_add_u32 s25, s25, 2736128
    ds_read_b128 v[96:99], v121 offset:12288
    ds_read_b128 v[100:103], v121 offset:13312
    ds_read_b128 v[104:107], v121 offset:14336
    ds_read_b128 v[108:111], v121 offset:15360
    s_waitcnt lgkmcnt(3)
    v_mfma_f32_16x16x32_bf16 v[32:35], v[96:99], v[64:67], 0
    v_mfma_f32_16x16x32_bf16 v[36:39], v[96:99], v[68:71], 0
    v_mfma_f32_16x16x32_bf16 v[40:43], v[96:99], v[72:75], 0
    v_mfma_f32_16x16x32_bf16 v[44:47], v[96:99], v[76:79], 0
    v_mfma_f32_16x16x32_bf16 v[48:51], v[96:99], v[80:83], 0
    v_mfma_f32_16x16x32_bf16 v[52:55], v[96:99], v[84:87], 0
    v_mfma_f32_16x16x32_bf16 v[56:59], v[96:99], v[88:91], 0
    v_mfma_f32_16x16x32_bf16 v[60:63], v[96:99], v[92:95], 0
    s_waitcnt lgkmcnt(2)
    v_mfma_f32_16x16x32_bf16 v[32:35], v[100:103], v[64:67], v[32:35]
    v_mfma_f32_16x16x32_bf16 v[36:39], v[100:103], v[68:71], v[36:39]
    v_mfma_f32_16x16x32_bf16 v[40:43], v[100:103], v[72:75], v[40:43]
    v_mfma_f32_16x16x32_bf16 v[44:47], v[100:103], v[76:79], v[44:47]
    v_mfma_f32_16x16x32_bf16 v[48:51], v[100:103], v[80:83], v[48:51]
    v_mfma_f32_16x16x32_bf16 v[52:55], v[100:103], v[84:87], v[52:55]
    v_mfma_f32_16x16x32_bf16 v[56:59], v[100:103], v[88:91], v[56:59]
    v_mfma_f32_16x16x32_bf16 v[60:63], v[100:103], v[92:95], v[60:63]
    s_waitcnt lgkmcnt(1)
    v_mfma_f32_16x16x32_bf16 v[32:35], v[104:107], v[0:3], v[32:35]
    v_mfma_f32_16x16x32_bf16 v[36:39], v[104:107], v[4:7], v[36:39]
    v_mfma_f32_16x16x32_bf16 v[40:43], v[104:107], v[8:11], v[40:43]
    v_mfma_f32_16x16x32_bf16 v[44:47], v[104:107], v[12:15], v[44:47]
    v_mfma_f32_16x16x32_bf16 v[48:51], v[104:107], v[16:19], v[48:51]
    v_mfma_f32_16x16x32_bf16 v[52:55], v[104:107], v[20:23], v[52:55]
    v_mfma_f32_16x16x32_bf16 v[56:59], v[104:107], v[24:27], v[56:59]
    v_mfma_f32_16x16x32_bf16 v[60:63], v[104:107], v[28:31], v[60:63]
    s_waitcnt lgkmcnt(0)
    v_mfma_f32_16x16x32_bf16 v[32:35], v[108:111], v[0:3], v[32:35]
    v_mfma_f32_16x16x32_bf16 v[36:39], v[108:111], v[4:7], v[36:39]
    v_mfma_f32_16x16x32_bf16 v[40:43], v[108:111], v[8:11], v[40:43]
    v_mfma_f32_16x16x32_bf16 v[44:47], v[108:111], v[12:15], v[44:47]
    v_mfma_f32_16x16x32_bf16 v[48:51], v[108:111], v[16:19], v[48:51]
    v_mfma_f32_16x16x32_bf16 v[52:55], v[108:111], v[20:23], v[52:55]
    v_mfma_f32_16x16x32_bf16 v[56:59], v[108:111], v[24:27], v[56:59]
    v_mfma_f32_16x16x32_bf16 v[60:63], v[108:111], v[28:31], v[60:63]
    s_nop 7
    v_cvt_pk_bf16_f32 v112, v32, v36
    v_cvt_pk_bf16_f32 v113, v40, v44
    v_cvt_pk_bf16_f32 v114, v48, v52
    v_cvt_pk_bf16_f32 v115, v56, v60
    buffer_store_dwordx4 v[112:115], v120, s[20:23], s25 offen
    s_add_u32 s25, s25, 2736128
    v_cvt_pk_bf16_f32 v116, v33, v37
    v_cvt_pk_bf16_f32 v117, v41, v45
    v_cvt_pk_bf16_f32 v118, v49, v53
    v_cvt_pk_bf16_f32 v119, v57, v61
    buffer_store_dwordx4 v[116:119], v120, s[20:23], s25 offen
    s_add_u32 s25, s25, 2736128
    v_cvt_pk_bf16_f32 v112, v34, v38
    v_cvt_pk_bf16_f32 v113, v42, v46
    v_cvt_pk_bf16_f32 v114, v50, v54
    v_cvt_pk_bf16_f32 v115, v58, v62
    buffer_store_dwordx4 v[112:115], v120, s[20:23], s25 offen
    s_add_u32 s25, s25, 2736128
    v_cvt_pk_bf16_f32 v116, v35, v39
    v_cvt_pk_bf16_f32 v117, v43, v47
    v_cvt_pk_bf16_f32 v118, v51, v55
    v_cvt_pk_bf16_f32 v119, v59, v63
    buffer_store_dwordx4 v[116:119], v120, s[20:23], s25 offen
    s_endpgm
K1_W:
    s_mov_b32 s16, s6
    s_mov_b32 s17, s7
    s_and_b32 s17, s17, 0xffff
    s_mov_b32 s18, 16252928
    s_mov_b32 s19, 0x00020000
    s_add_u32 s20, s8, 50331648
    s_addc_u32 s21, s9, 0
    s_and_b32 s21, s21, 0xffff
    s_mov_b32 s22, 67108864
    s_mov_b32 s23, 0x00020000
    s_mul_i32 s11, s2, 1
    s_lshr_b32 s12, s11, 9
    s_and_b32 s13, s11, 511
    s_lshl_b32 s14, s12, 19
    s_lshl_b32 s15, s13, 10
    s_add_u32 s14, s14, s15
    s_lshl_b32 s15, s3, 8
    s_add_u32 s14, s14, s15
    v_and_b32 v126, 1, v123
    v_lshlrev_b32 v126, 23, v126
    v_lshl_add_u32 v126, v122, 4, v126
    s_mov_b32 s15, s14
    buffer_load_dwordx4 v[0:3], v126, s[16:19], s15 offen
    s_add_u32 s15, s15, 0x100000
    buffer_load_dwordx4 v[4:7], v126, s[16:19], s15 offen
    s_add_u32 s15, s15, 0x100000
    buffer_load_dwordx4 v[8:11], v126, s[16:19], s15 offen
    s_add_u32 s15, s15, 0x100000
    buffer_load_dwordx4 v[12:15], v126, s[16:19], s15 offen
    s_add_u32 s15, s15, 0x100000
    buffer_load_dwordx4 v[16:19], v126, s[16:19], s15 offen
    s_add_u32 s15, s15, 0x100000
    buffer_load_dwordx4 v[20:23], v126, s[16:19], s15 offen
    s_add_u32 s15, s15, 0x100000
    buffer_load_dwordx4 v[24:27], v126, s[16:19], s15 offen
    s_add_u32 s15, s15, 0x100000
    buffer_load_dwordx4 v[28:31], v126, s[16:19], s15 offen
    v_and_b32 v127, 1, v123
    v_lshlrev_b32 v127, 3, v127
    v_mul_u32_u24 v112, 96, v125
    v_mad_u32_u24 v113, v124, v127, v112
    v_mad_u32_u24 v64, v124, 0, v113
    v_mad_u32_u24 v65, v124, 1, v113
    v_mad_u32_u24 v66, v124, 2, v113
    v_mad_u32_u24 v67, v124, 3, v113
    v_mad_u32_u24 v68, v124, 4, v113
    v_mad_u32_u24 v69, v124, 5, v113
    v_mad_u32_u24 v70, v124, 6, v113
    v_mad_u32_u24 v71, v124, 7, v113
    v_and_b32 v64, 127, v64
    v_and_b32 v65, 127, v65
    v_and_b32 v66, 127, v66
    v_and_b32 v67, 127, v67
    v_and_b32 v68, 127, v68
    v_and_b32 v69, 127, v69
    v_and_b32 v70, 127, v70
    v_and_b32 v71, 127, v71
    v_cvt_f32_u32 v64, v64
    v_cvt_f32_u32 v65, v65
    v_cvt_f32_u32 v66, v66
    v_cvt_f32_u32 v67, v67
    v_cvt_f32_u32 v68, v68
    v_cvt_f32_u32 v69, v69
    v_cvt_f32_u32 v70, v70
    v_cvt_f32_u32 v71, v71
    v_mul_f32 v64, 0x3c000000, v64
    v_mul_f32 v65, 0x3c000000, v65
    v_mul_f32 v66, 0x3c000000, v66
    v_mul_f32 v67, 0x3c000000, v67
    v_mul_f32 v68, 0x3c000000, v68
    v_mul_f32 v69, 0x3c000000, v69
    v_mul_f32 v70, 0x3c000000, v70
    v_mul_f32 v71, 0x3c000000, v71
    v_cos_f32 v64, v64
    v_cos_f32 v65, v65
    v_cos_f32 v66, v66
    v_cos_f32 v67, v67
    v_cos_f32 v68, v68
    v_cos_f32 v69, v69
    v_cos_f32 v70, v70
    v_cos_f32 v71, v71
    s_nop 0
    v_cvt_pk_bf16_f32 v72, v64, v65
    v_cvt_pk_bf16_f32 v73, v66, v67
    v_cvt_pk_bf16_f32 v74, v68, v69
    v_cvt_pk_bf16_f32 v75, v70, v71
    v_lshlrev_b32 v80, 16, v72
    v_and_b32 v81, 0xffff0000, v72
    v_sub_f32 v64, v64, v80
    v_sub_f32 v65, v65, v81
    v_lshlrev_b32 v80, 16, v73
    v_and_b32 v81, 0xffff0000, v73
    v_sub_f32 v66, v66, v80
    v_sub_f32 v67, v67, v81
    v_lshlrev_b32 v80, 16, v74
    v_and_b32 v81, 0xffff0000, v74
    v_sub_f32 v68, v68, v80
    v_sub_f32 v69, v69, v81
    v_lshlrev_b32 v80, 16, v75
    v_and_b32 v81, 0xffff0000, v75
    v_sub_f32 v70, v70, v80
    v_sub_f32 v71, v71, v81
    v_cvt_pk_bf16_f32 v76, v64, v65
    v_cvt_pk_bf16_f32 v77, v66, v67
    v_cvt_pk_bf16_f32 v78, v68, v69
    v_cvt_pk_bf16_f32 v79, v70, v71
    v_cmp_lt_u32 vcc, 1, v123
    s_lshl_b32 s24, s3, 10
    v_add_u32 v114, s24, v121
    v_cndmask_b32 v72, v72, v76, vcc
    v_cndmask_b32 v73, v73, v77, vcc
    v_cndmask_b32 v74, v74, v78, vcc
    v_cndmask_b32 v75, v75, v79, vcc
    ds_write_b128 v114, v[72:75]
    v_lshrrev_b32 v112, 1, v123
    s_mov_b32 s24, 2097152
    v_mul_lo_u32 v112, v112, s24
    v_and_b32 v113, 1, v123
    v_lshl_add_u32 v112, v113, 8, v112
    v_and_b32 v113, 1, v122
    v_lshl_add_u32 v124, v113, 4, v112
    v_lshrrev_b32 v125, 1, v122
    s_mul_i32 s26, s3, 524288
    s_lshl_b32 s24, s11, 9
    s_add_u32 s26, s26, s24
    s_waitcnt lgkmcnt(0)
    s_barrier
    ds_read_b128 v[96:99], v121 offset:0
    ds_read_b128 v[100:103], v121 offset:1024
    ds_read_b128 v[104:107], v121 offset:2048
    ds_read_b128 v[108:111], v121 offset:3072
    s_mov_b32 s27, 0
    s_waitcnt vmcnt(0) lgkmcnt(0)
K1_W_LOOP:
    s_add_u32 s24, s11, s27
    s_and_b32 s30, s24, 3
    s_lshr_b32 s24, s24, 1
    s_and_b32 s24, s24, 4
    s_or_b32 s30, s30, s24
    v_xor_b32 v112, s30, v125
    v_lshl_add_u32 v120, v112, 5, v124
    s_lshl_b32 s25, s27, 9
    s_add_u32 s25, s25, s26
    v_perm_b32 v32, v4, v0, s28
    v_perm_b32 v36, v4, v0, s29
    v_perm_b32 v33, v12, v8, s28
    v_perm_b32 v37, v12, v8, s29
    v_perm_b32 v34, v20, v16, s28
    v_perm_b32 v38, v20, v16, s29
    v_perm_b32 v35, v28, v24, s28
    v_perm_b32 v39, v28, v24, s29
    v_perm_b32 v40, v5, v1, s28
    v_perm_b32 v44, v5, v1, s29
    v_perm_b32 v41, v13, v9, s28
    v_perm_b32 v45, v13, v9, s29
    v_perm_b32 v42, v21, v17, s28
    v_perm_b32 v46, v21, v17, s29
    v_perm_b32 v43, v29, v25, s28
    v_perm_b32 v47, v29, v25, s29
    v_perm_b32 v48, v6, v2, s28
    v_perm_b32 v52, v6, v2, s29
    v_perm_b32 v49, v14, v10, s28
    v_perm_b32 v53, v14, v10, s29
    v_perm_b32 v50, v22, v18, s28
    v_perm_b32 v54, v22, v18, s29
    v_perm_b32 v51, v30, v26, s28
    v_perm_b32 v55, v30, v26, s29
    v_perm_b32 v56, v7, v3, s28
    v_perm_b32 v60, v7, v3, s29
    v_perm_b32 v57, v15, v11, s28
    v_perm_b32 v61, v15, v11, s29
    v_perm_b32 v58, v23, v19, s28
    v_perm_b32 v62, v23, v19, s29
    v_perm_b32 v59, v31, v27, s28
    v_perm_b32 v63, v31, v27, s29
    s_add_u32 s27, s27, 1
    s_add_u32 s14, s14, 1024
    s_cmp_ge_u32 s27, 1
    s_cbranch_scc1 K1_W_NOLOAD
    s_mov_b32 s15, s14
    buffer_load_dwordx4 v[0:3], v126, s[16:19], s15 offen
    s_add_u32 s15, s15, 0x100000
    buffer_load_dwordx4 v[4:7], v126, s[16:19], s15 offen
    s_add_u32 s15, s15, 0x100000
    buffer_load_dwordx4 v[8:11], v126, s[16:19], s15 offen
    s_add_u32 s15, s15, 0x100000
    buffer_load_dwordx4 v[12:15], v126, s[16:19], s15 offen
    s_add_u32 s15, s15, 0x100000
    buffer_load_dwordx4 v[16:19], v126, s[16:19], s15 offen
    s_add_u32 s15, s15, 0x100000
    buffer_load_dwordx4 v[20:23], v126, s[16:19], s15 offen
    s_add_u32 s15, s15, 0x100000
    buffer_load_dwordx4 v[24:27], v126, s[16:19], s15 offen
    s_add_u32 s15, s15, 0x100000
    buffer_load_dwordx4 v[28:31], v126, s[16:19], s15 offen
K1_W_NOLOAD:
    v_mfma_f32_16x16x32_bf16 v[64:67], v[96:99], v[32:35], 0
    v_mfma_f32_16x16x32_bf16 v[68:71], v[96:99], v[36:39], 0
    v_mfma_f32_16x16x32_bf16 v[72:75], v[96:99], v[40:43], 0
    v_mfma_f32_16x16x32_bf16 v[76:79], v[96:99], v[44:47], 0
    v_mfma_f32_16x16x32_bf16 v[80:83], v[96:99], v[48:51], 0
    v_mfma_f32_16x16x32_bf16 v[84:87], v[96:99], v[52:55], 0
    v_mfma_f32_16x16x32_bf16 v[88:91], v[96:99], v[56:59], 0
    v_mfma_f32_16x16x32_bf16 v[92:95], v[96:99], v[60:63], 0
    s_nop 7
    v_cvt_pk_bf16_f32 v112, v64, v68
    v_cvt_pk_bf16_f32 v113, v72, v76
    v_cvt_pk_bf16_f32 v114, v80, v84
    v_cvt_pk_bf16_f32 v115, v88, v92
    buffer_store_dwordx4 v[112:115], v120, s[20:23], s25 offen
    s_add_u32 s25, s25, 4194304
    v_cvt_pk_bf16_f32 v116, v65, v69
    v_cvt_pk_bf16_f32 v117, v73, v77
    v_cvt_pk_bf16_f32 v118, v81, v85
    v_cvt_pk_bf16_f32 v119, v89, v93
    buffer_store_dwordx4 v[116:119], v120, s[20:23], s25 offen
    s_add_u32 s25, s25, 4194304
    v_cvt_pk_bf16_f32 v112, v66, v70
    v_cvt_pk_bf16_f32 v113, v74, v78
    v_cvt_pk_bf16_f32 v114, v82, v86
    v_cvt_pk_bf16_f32 v115, v90, v94
    buffer_store_dwordx4 v[112:115], v120, s[20:23], s25 offen
    s_add_u32 s25, s25, 4194304
    v_cvt_pk_bf16_f32 v116, v67, v71
    v_cvt_pk_bf16_f32 v117, v75, v79
    v_cvt_pk_bf16_f32 v118, v83, v87
    v_cvt_pk_bf16_f32 v119, v91, v95
    buffer_store_dwordx4 v[116:119], v120, s[20:23], s25 offen
    s_add_u32 s25, s25, 4194304
    v_mfma_f32_16x16x32_bf16 v[64:67], v[100:103], v[32:35], 0
    v_mfma_f32_16x16x32_bf16 v[68:71], v[100:103], v[36:39], 0
    v_mfma_f32_16x16x32_bf16 v[72:75], v[100:103], v[40:43], 0
    v_mfma_f32_16x16x32_bf16 v[76:79], v[100:103], v[44:47], 0
    v_mfma_f32_16x16x32_bf16 v[80:83], v[100:103], v[48:51], 0
    v_mfma_f32_16x16x32_bf16 v[84:87], v[100:103], v[52:55], 0
    v_mfma_f32_16x16x32_bf16 v[88:91], v[100:103], v[56:59], 0
    v_mfma_f32_16x16x32_bf16 v[92:95], v[100:103], v[60:63], 0
    s_nop 7
    v_cvt_pk_bf16_f32 v112, v64, v68
    v_cvt_pk_bf16_f32 v113, v72, v76
    v_cvt_pk_bf16_f32 v114, v80, v84
    v_cvt_pk_bf16_f32 v115, v88, v92
    buffer_store_dwordx4 v[112:115], v120, s[20:23], s25 offen
    s_add_u32 s25, s25, 4194304
    v_cvt_pk_bf16_f32 v116, v65, v69
    v_cvt_pk_bf16_f32 v117, v73, v77
    v_cvt_pk_bf16_f32 v118, v81, v85
    v_cvt_pk_bf16_f32 v119, v89, v93
    buffer_store_dwordx4 v[116:119], v120, s[20:23], s25 offen
    s_add_u32 s25, s25, 4194304
    v_cvt_pk_bf16_f32 v112, v66, v70
    v_cvt_pk_bf16_f32 v113, v74, v78
    v_cvt_pk_bf16_f32 v114, v82, v86
    v_cvt_pk_bf16_f32 v115, v90, v94
    buffer_store_dwordx4 v[112:115], v120, s[20:23], s25 offen
    s_add_u32 s25, s25, 4194304
    v_cvt_pk_bf16_f32 v116, v67, v71
    v_cvt_pk_bf16_f32 v117, v75, v79
    v_cvt_pk_bf16_f32 v118, v83, v87
    v_cvt_pk_bf16_f32 v119, v91, v95
    buffer_store_dwordx4 v[116:119], v120, s[20:23], s25 offen
    s_add_u32 s25, s25, 4194304
    v_mfma_f32_16x16x32_bf16 v[64:67], v[104:107], v[32:35], 0
    v_mfma_f32_16x16x32_bf16 v[68:71], v[104:107], v[36:39], 0
    v_mfma_f32_16x16x32_bf16 v[72:75], v[104:107], v[40:43], 0
    v_mfma_f32_16x16x32_bf16 v[76:79], v[104:107], v[44:47], 0
    v_mfma_f32_16x16x32_bf16 v[80:83], v[104:107], v[48:51], 0
    v_mfma_f32_16x16x32_bf16 v[84:87], v[104:107], v[52:55], 0
    v_mfma_f32_16x16x32_bf16 v[88:91], v[104:107], v[56:59], 0
    v_mfma_f32_16x16x32_bf16 v[92:95], v[104:107], v[60:63], 0
    s_nop 7
    v_cvt_pk_bf16_f32 v112, v64, v68
    v_cvt_pk_bf16_f32 v113, v72, v76
    v_cvt_pk_bf16_f32 v114, v80, v84
    v_cvt_pk_bf16_f32 v115, v88, v92
    buffer_store_dwordx4 v[112:115], v120, s[20:23], s25 offen
    s_add_u32 s25, s25, 4194304
    v_cvt_pk_bf16_f32 v116, v65, v69
    v_cvt_pk_bf16_f32 v117, v73, v77
    v_cvt_pk_bf16_f32 v118, v81, v85
    v_cvt_pk_bf16_f32 v119, v89, v93
    buffer_store_dwordx4 v[116:119], v120, s[20:23], s25 offen
    s_add_u32 s25, s25, 4194304
    v_cvt_pk_bf16_f32 v112, v66, v70
    v_cvt_pk_bf16_f32 v113, v74, v78
    v_cvt_pk_bf16_f32 v114, v82, v86
    v_cvt_pk_bf16_f32 v115, v90, v94
    buffer_store_dwordx4 v[112:115], v120, s[20:23], s25 offen
    s_add_u32 s25, s25, 4194304
    v_cvt_pk_bf16_f32 v116, v67, v71
    v_cvt_pk_bf16_f32 v117, v75, v79
    v_cvt_pk_bf16_f32 v118, v83, v87
    v_cvt_pk_bf16_f32 v119, v91, v95
    buffer_store_dwordx4 v[116:119], v120, s[20:23], s25 offen
    s_add_u32 s25, s25, 4194304
    v_mfma_f32_16x16x32_bf16 v[64:67], v[108:111], v[32:35], 0
    v_mfma_f32_16x16x32_bf16 v[68:71], v[108:111], v[36:39], 0
    v_mfma_f32_16x16x32_bf16 v[72:75], v[108:111], v[40:43], 0
    v_mfma_f32_16x16x32_bf16 v[76:79], v[108:111], v[44:47], 0
    v_mfma_f32_16x16x32_bf16 v[80:83], v[108:111], v[48:51], 0
    v_mfma_f32_16x16x32_bf16 v[84:87], v[108:111], v[52:55], 0
    v_mfma_f32_16x16x32_bf16 v[88:91], v[108:111], v[56:59], 0
    v_mfma_f32_16x16x32_bf16 v[92:95], v[108:111], v[60:63], 0
    s_nop 7
    v_cvt_pk_bf16_f32 v112, v64, v68
    v_cvt_pk_bf16_f32 v113, v72, v76
    v_cvt_pk_bf16_f32 v114, v80, v84
    v_cvt_pk_bf16_f32 v115, v88, v92
    buffer_store_dwordx4 v[112:115], v120, s[20:23], s25 offen
    s_add_u32 s25, s25, 4194304
    v_cvt_pk_bf16_f32 v116, v65, v69
    v_cvt_pk_bf16_f32 v117, v73, v77
    v_cvt_pk_bf16_f32 v118, v81, v85
    v_cvt_pk_bf16_f32 v119, v89, v93
    buffer_store_dwordx4 v[116:119], v120, s[20:23], s25 offen
    s_add_u32 s25, s25, 4194304
    v_cvt_pk_bf16_f32 v112, v66, v70
    v_cvt_pk_bf16_f32 v113, v74, v78
    v_cvt_pk_bf16_f32 v114, v82, v86
    v_cvt_pk_bf16_f32 v115, v90, v94
    buffer_store_dwordx4 v[112:115], v120, s[20:23], s25 offen
    s_add_u32 s25, s25, 4194304
    v_cvt_pk_bf16_f32 v116, v67, v71
    v_cvt_pk_bf16_f32 v117, v75, v79
    v_cvt_pk_bf16_f32 v118, v83, v87
    v_cvt_pk_bf16_f32 v119, v91, v95
    buffer_store_dwordx4 v[116:119], v120, s[20:23], s25 offen
    s_waitcnt vmcnt(16)
    s_cmp_lt_u32 s27, 1
    s_cbranch_scc1 K1_W_LOOP
K1_END:
    s_endpgm
.p2align 8
.type k12_fused_kernel,@function
k12_fused_kernel:
    s_cmp_ge_u32 s2, 256
    s_cbranch_scc1 K12_END
    s_load_dwordx4 s[52:55], s[0:1], 0
    s_load_dwordx4 s[56:59], s[0:1], 40
    s_getpc_b64 s[90:91]
CPF_K12:
    s_sub_u32 s90, s90, CPF_K12-k12_fused_kernel
    s_subb_u32 s91, s91, 0
    v_lshlrev_b32 v8, 7, v0
    v_mov_b32 v11, s91
    v_min_u32 v9, TEXT_END-k12_fused_kernel-4, v8
    v_add_co_u32 v10, vcc, s90, v9
    v_addc_co_u32 v11, vcc, 0, v11, vcc
    global_load_dword v63, v[10:11], off
    v_lshrrev_b32 v1, 6, v0
    v_and_b32 v2, 63, v0
    v_readfirstlane_b32 s3, v1
    s_waitcnt lgkmcnt(0)
    s_cmp_lt_u32 s3, 4
    s_cbranch_scc1 K12_CONS
    v_and_b32 v64, 15, v2
    v_lshrrev_b32 v65, 4, v2
    v_lshlrev_b32 v254, 4, v2
    s_and_b32 s44, s3, 3
    s_and_b32 s20, s44, 1
    s_lshr_b32 s21, s44, 1
    s_lshl_b32 s22, s2, 1
    s_add_u32 s22, s22, s21
    s_and_b32 s23, s22, 3
    s_lshr_b32 s22, s22, 2
    s_and_b32 s24, s2, 7
    s_lshl_b32 s24, s24, 5
    s_lshr_b32 s25, s2, 3
    s_add_u32 s24, s24, s25
    s_cmp_ge_u32 s24, 167
    s_cselect_b32 s25, 1, 0
    s_mul_i32 s26, s25, 167
    s_sub_u32 s24, s24, s26
    s_cmp_eq_u32 s21, 0
    s_cselect_b32 s25, s25, 1
    s_mul_i32 s26, s25, 16384000
    s_add_u32 s4, s52, s26
    s_addc_u32 s5, s53, 0
    s_and_b32 s5, s5, 0xffff
    s_mov_b32 s6, 16384000
    s_mov_b32 s7, 0x00020000
    s_mov_b32 s8, s54
    s_mov_b32 s9, s55
    s_and_b32 s9, s9, 0xffff
    s_mov_b32 s10, 16252928
    s_mov_b32 s11, 0x00020000
    s_mov_b32 s12, s58
    s_mov_b32 s13, s59
    s_and_b32 s13, s13, 0xffff
    s_mov_b32 s14, 43778048
    s_mov_b32 s15, 0x00020000
    s_add_u32 s16, s58, 50331648
    s_addc_u32 s17, s59, 0
    s_and_b32 s17, s17, 0xffff
    s_mov_b32 s18, 67108864
    s_mov_b32 s19, 0x00020000
    s_add_u32 s60, s58, 153092096
    s_addc_u32 s61, s59, 0
    s_and_b32 s61, s61, 0xffff
    s_mov_b32 s62, 32768
    s_mov_b32 s63, 0x00020000
    s_mov_b32 s28, 0x05040100
    s_mov_b32 s29, 0x07060302
    v_lshlrev_b32 v248, 14, v65
    v_lshl_add_u32 v248, v64, 4, v248
    v_and_b32 v250, 1, v65
    v_lshlrev_b32 v250, 23, v250
    v_lshl_add_u32 v250, v64, 4, v250
    v_lshrrev_b32 v66, 1, v65
    s_mov_b32 s26, 1368064
    v_mul_lo_u32 v66, v66, s26
    v_lshrrev_b32 v67, 2, v64
    s_mov_b32 s26, 21376
    v_mul_lo_u32 v67, v67, s26
    v_add_u32 v66, v66, v67
    v_mov_b32 v252, v66
    v_lshrrev_b32 v66, 1, v65
    s_mov_b32 s26, 2097152
    v_mul_lo_u32 v66, v66, s26
    v_and_b32 v67, 1, v65
    v_lshl_add_u32 v66, v67, 8, v66
    v_and_b32 v67, 1, v64
    v_lshl_add_u32 v251, v67, 4, v66
    s_mul_i32 s31, s25, 684032
    s_mul_i32 s32, s23, 524288
    s_lshl_b32 s33, s23, 8
    s_mov_b32 s40, 3
    s_xor_b32 s43, s40, s20
    s_and_b32 s43, s43, 1
    s_mul_i32 s36, s40, 85
    s_add_u32 s36, s36, s2
    s_and_b32 s36, s36, 255
    s_mul_hi_u32 s37, s36, 0x55555556
    s_mul_i32 s38, s37, 3
    s_cmp_eq_u32 s38, s36
    s_cselect_b32 s27, 1, 0
    s_cmp_lt_u32 s37, 78
    s_cselect_b32 s27, s27, 0
    s_add_u32 s37, s37, 89
    s_cmp_eq_u32 s21, 0
    s_cselect_b32 s30, s24, s37
    s_cselect_b32 s27, 1, s27
    s_cmp_eq_u32 s43, 0
    s_cbranch_scc0 K12_PL1
    s_lshl_b32 s36, s40, 7
    s_add_u32 s36, s36, s22
    s_lshr_b32 s37, s36, 9
    s_lshl_b32 s37, s37, 19
    s_and_b32 s36, s36, 511
    s_lshl_b32 s36, s36, 10
    s_add_u32 s36, s36, s37
    s_add_u32 s36, s36, s33
    buffer_load_dwordx4 v[96:99], v250, s[8:11], s36 offen
    s_add_u32 s36, s36, 0x100000
    buffer_load_dwordx4 v[100:103], v250, s[8:11], s36 offen
    s_add_u32 s36, s36, 0x100000
    buffer_load_dwordx4 v[104:107], v250, s[8:11], s36 offen
    s_add_u32 s36, s36, 0x100000
    buffer_load_dwordx4 v[108:111], v250, s[8:11], s36 offen
    s_add_u32 s36, s36, 0x100000
    buffer_load_dwordx4 v[112:115], v250, s[8:11], s36 offen
    s_add_u32 s36, s36, 0x100000
    buffer_load_dwordx4 v[116:119], v250, s[8:11], s36 offen
    s_add_u32 s36, s36, 0x100000
    buffer_load_dwordx4 v[120:123], v250, s[8:11], s36 offen
    s_add_u32 s36, s36, 0x100000
    buffer_load_dwordx4 v[124:127], v250, s[8:11], s36 offen
    s_branch K12_PL2
K12_PL1:
    s_cmp_eq_u32 s27, 0
    s_cbranch_scc1 K12_PL2
    s_lshl_b32 s36, s40, 8
    s_mul_i32 s37, s30, 98304
    s_add_u32 s36, s36, s37
    buffer_load_dwordx4 v[0:3], v248, s[4:7], s36 offen
    buffer_load_dwordx4 v[4:7], v248, s[4:7], s36 offen offset:2048
    s_add_u32 s36, s36, 4096
    buffer_load_dwordx4 v[8:11], v248, s[4:7], s36 offen
    buffer_load_dwordx4 v[12:15], v248, s[4:7], s36 offen offset:2048
    s_add_u32 s36, s36, 4096
    buffer_load_dwordx4 v[16:19], v248, s[4:7], s36 offen
    buffer_load_dwordx4 v[20:23], v248, s[4:7], s36 offen offset:2048
    s_add_u32 s36, s36, 4096
    buffer_load_dwordx4 v[24:27], v248, s[4:7], s36 offen
    buffer_load_dwordx4 v[28:31], v248, s[4:7], s36 offen offset:2048
    s_add_u32 s36, s36, 53248
    buffer_load_dwordx4 v[32:35], v248, s[4:7], s36 offen
    buffer_load_dwordx4 v[36:39], v248, s[4:7], s36 offen offset:2048
    s_add_u32 s36, s36, 4096
    buffer_load_dwordx4 v[40:43], v248, s[4:7], s36 offen
    buffer_load_dwordx4 v[44:47], v248, s[4:7], s36 offen offset:2048
    s_add_u32 s36, s36, 4096
    buffer_load_dwordx4 v[48:51], v248, s[4:7], s36 offen
    buffer_load_dwordx4 v[52:55], v248, s[4:7], s36 offen offset:2048
    s_add_u32 s36, s36, 4096
    buffer_load_dwordx4 v[56:59], v248, s[4:7], s36 offen
    buffer_load_dwordx4 v[60:63], v248, s[4:7], s36 offen offset:2048
K12_PL2:
    v_and_b32 v128, 3, v64
    v_lshlrev_b32 v128, 2, v128
    v_lshrrev_b32 v130, 3, v64
    v_lshl_add_u32 v128, v130, 1, v128
    s_lshl_b32 s36, s44, 4
    s_add_u32 s36, s36, 1
    v_add_u32 v128, s36, v128
    v_bfe_u32 v129, v64, 2, 1
    v_lshlrev_b32 v131, 3, v65
    v_lshlrev_b32 v132, 5, v129
    v_mad_u32_u24 v133, v128, v131, v132
    v_mad_u32_u24 v136, v128, 0, v133
    v_mad_u32_u24 v137, v128, 1, v133
    v_mad_u32_u24 v138, v128, 2, v133
    v_mad_u32_u24 v139, v128, 3, v133
    v_mad_u32_u24 v140, v128, 4, v133
    v_mad_u32_u24 v141, v128, 5, v133
    v_mad_u32_u24 v142, v128, 6, v133
    v_mad_u32_u24 v143, v128, 7, v133
    v_and_b32 v136, 127, v136
    v_and_b32 v137, 127, v137
    v_and_b32 v138, 127, v138
    v_and_b32 v139, 127, v139
    v_and_b32 v140, 127, v140
    v_and_b32 v141, 127, v141
    v_and_b32 v142, 127, v142
    v_and_b32 v143, 127, v143
    v_cvt_f32_u32 v136, v136
    v_cvt_f32_u32 v137, v137
    v_cvt_f32_u32 v138, v138
    v_cvt_f32_u32 v139, v139
    v_cvt_f32_u32 v140, v140
    v_cvt_f32_u32 v141, v141
    v_cvt_f32_u32 v142, v142
    v_cvt_f32_u32 v143, v143
    v_mul_f32 v136, 0x3c000000, v136
    v_mul_f32 v137, 0x3c000000, v137
    v_mul_f32 v138, 0x3c000000, v138
    v_mul_f32 v139, 0x3c000000, v139
    v_mul_f32 v140, 0x3c000000, v140
    v_mul_f32 v141, 0x3c000000, v141
    v_mul_f32 v142, 0x3c000000, v142
    v_mul_f32 v143, 0x3c000000, v143
    v_cos_f32 v136, v136
    v_cos_f32 v137, v137
    v_cos_f32 v138, v138
    v_cos_f32 v139, v139
    v_cos_f32 v140, v140
    v_cos_f32 v141, v141
    v_cos_f32 v142, v142
    v_cos_f32 v143, v143
    s_nop 0
    v_cvt_pk_bf16_f32 v144, v136, v137
    v_cvt_pk_bf16_f32 v145, v138, v139
    v_cvt_pk_bf16_f32 v146, v140, v141
    v_cvt_pk_bf16_f32 v147, v142, v143
    v_lshlrev_b32 v152, 16, v144
    v_and_b32 v153, 0xffff0000, v144
    v_sub_f32 v136, v136, v152
    v_sub_f32 v137, v137, v153
    v_lshlrev_b32 v152, 16, v145
    v_and_b32 v153, 0xffff0000, v145
    v_sub_f32 v138, v138, v152
    v_sub_f32 v139, v139, v153
    v_lshlrev_b32 v152, 16, v146
    v_and_b32 v153, 0xffff0000, v146
    v_sub_f32 v140, v140, v152
    v_sub_f32 v141, v141, v153
    v_lshlrev_b32 v152, 16, v147
    v_and_b32 v153, 0xffff0000, v147
    v_sub_f32 v142, v142, v152
    v_sub_f32 v143, v143, v153
    v_cvt_pk_bf16_f32 v148, v136, v137
    v_cvt_pk_bf16_f32 v149, v138, v139
    v_cvt_pk_bf16_f32 v150, v140, v141
    v_cvt_pk_bf16_f32 v151, v142, v143
    s_lshl_b32 s37, s44, 12
    s_add_u32 s37, s37, 116736
    v_add_u32 v132, s37, v254
    ds_write_b128 v132, v[144:147]
    ds_write_b128 v132, v[148:151] offset:1024
    v_add_u32 v131, 32, v131
    v_lshlrev_b32 v132, 5, v129
    v_mad_u32_u24 v133, v128, v131, v132
    v_mad_u32_u24 v136, v128, 0, v133
    v_mad_u32_u24 v137, v128, 1, v133
    v_mad_u32_u24 v138, v128, 2, v133
    v_mad_u32_u24 v139, v128, 3, v133
    v_mad_u32_u24 v140, v128, 4, v133
    v_mad_u32_u24 v141, v128, 5, v133
    v_mad_u32_u24 v142, v128, 6, v133
    v_mad_u32_u24 v143, v128, 7, v133
    v_and_b32 v136, 127, v136
    v_and_b32 v137, 127, v137
    v_and_b32 v138, 127, v138
    v_and_b32 v139, 127, v139
    v_and_b32 v140, 127, v140
    v_and_b32 v141, 127, v141
    v_and_b32 v142, 127, v142
    v_and_b32 v143, 127, v143
    v_cvt_f32_u32 v136, v136
    v_cvt_f32_u32 v137, v137
    v_cvt_f32_u32 v138, v138
    v_cvt_f32_u32 v139, v139
    v_cvt_f32_u32 v140, v140
    v_cvt_f32_u32 v141, v141
    v_cvt_f32_u32 v142, v142
    v_cvt_f32_u32 v143, v143
    v_mul_f32 v136, 0x3c000000, v136
    v_mul_f32 v137, 0x3c000000, v137
    v_mul_f32 v138, 0x3c000000, v138
    v_mul_f32 v139, 0x3c000000, v139
    v_mul_f32 v140, 0x3c000000, v140
    v_mul_f32 v141, 0x3c000000, v141
    v_mul_f32 v142, 0x3c000000, v142
    v_mul_f32 v143, 0x3c000000, v143
    v_cos_f32 v136, v136
    v_cos_f32 v137, v137
    v_cos_f32 v138, v138
    v_cos_f32 v139, v139
    v_cos_f32 v140, v140
    v_cos_f32 v141, v141
    v_cos_f32 v142, v142
    v_cos_f32 v143, v143
    s_nop 0
    v_cvt_pk_bf16_f32 v144, v136, v137
    v_cvt_pk_bf16_f32 v145, v138, v139
    v_cvt_pk_bf16_f32 v146, v140, v141
    v_cvt_pk_bf16_f32 v147, v142, v143
    v_lshlrev_b32 v152, 16, v144
    v_and_b32 v153, 0xffff0000, v144
    v_sub_f32 v136, v136, v152
    v_sub_f32 v137, v137, v153
    v_lshlrev_b32 v152, 16, v145
    v_and_b32 v153, 0xffff0000, v145
    v_sub_f32 v138, v138, v152
    v_sub_f32 v139, v139, v153
    v_lshlrev_b32 v152, 16, v146
    v_and_b32 v153, 0xffff0000, v146
    v_sub_f32 v140, v140, v152
    v_sub_f32 v141, v141, v153
    v_lshlrev_b32 v152, 16, v147
    v_and_b32 v153, 0xffff0000, v147
    v_sub_f32 v142, v142, v152
    v_sub_f32 v143, v143, v153
    v_cvt_pk_bf16_f32 v148, v136, v137
    v_cvt_pk_bf16_f32 v149, v138, v139
    v_cvt_pk_bf16_f32 v150, v140, v141
    v_cvt_pk_bf16_f32 v151, v142, v143
    s_lshl_b32 s37, s44, 12
    s_add_u32 s37, s37, 118784
    v_add_u32 v132, s37, v254
    ds_write_b128 v132, v[144:147]
    ds_write_b128 v132, v[148:151] offset:1024
K12_TB:
    s_waitcnt lgkmcnt(0)
    s_barrier
    v_add_u32 v255, 116736, v254
    ds_read_b128 v[160:163], v255 offset:0
    ds_read_b128 v[192:195], v255 offset:1024
    ds_read_b128 v[164:167], v255 offset:2048
    ds_read_b128 v[196:199], v255 offset:3072
    ds_read_b128 v[168:171], v255 offset:4096
    ds_read_b128 v[200:203], v255 offset:5120
    ds_read_b128 v[172:175], v255 offset:6144
    ds_read_b128 v[204:207], v255 offset:7168
    s_waitcnt lgkmcnt(0)
    ds_read_b128 v[176:179], v255 offset:8192
    ds_read_b128 v[208:211], v255 offset:9216
    ds_read_b128 v[180:183], v255 offset:10240
    ds_read_b128 v[212:215], v255 offset:11264
    ds_read_b128 v[184:187], v255 offset:12288
    ds_read_b128 v[216:219], v255 offset:13312
    ds_read_b128 v[188:191], v255 offset:14336
    ds_read_b128 v[220:223], v255 offset:15360
    ds_read_b128 v[224:227], v255 offset:16384
    ds_read_b128 v[228:231], v255 offset:17408
    ds_read_b128 v[232:235], v255 offset:18432
    ds_read_b128 v[236:239], v255 offset:19456
    s_waitcnt lgkmcnt(0)
    s_barrier
    s_waitcnt vmcnt(0) lgkmcnt(0)
    s_mov_b32 s41, -1
    s_mov_b32 s34, -1
    s_branch K12_PROD
    s_cmp_lt_u32 s3, 4
    s_cbranch_scc0 K12_PROD
    s_cmp_eq_u32 s43, 0
    s_cbranch_scc0 K12_H1
    v_perm_b32 v64, v100, v96, s28
    v_perm_b32 v68, v100, v96, s29
    v_perm_b32 v65, v108, v104, s28
    v_perm_b32 v69, v108, v104, s29
    v_perm_b32 v66, v116, v112, s28
    v_perm_b32 v70, v116, v112, s29
    v_perm_b32 v67, v124, v120, s28
    v_perm_b32 v71, v124, v120, s29
    v_perm_b32 v72, v101, v97, s28
    v_perm_b32 v76, v101, v97, s29
    v_perm_b32 v73, v109, v105, s28
    v_perm_b32 v77, v109, v105, s29
    v_perm_b32 v74, v117, v113, s28
    v_perm_b32 v78, v117, v113, s29
    v_perm_b32 v75, v125, v121, s28
    v_perm_b32 v79, v125, v121, s29
    v_perm_b32 v80, v102, v98, s28
    v_perm_b32 v84, v102, v98, s29
    v_perm_b32 v81, v110, v106, s28
    v_perm_b32 v85, v110, v106, s29
    v_perm_b32 v82, v118, v114, s28
    v_perm_b32 v86, v118, v114, s29
    v_perm_b32 v83, v126, v122, s28
    v_perm_b32 v87, v126, v122, s29
    v_perm_b32 v88, v103, v99, s28
    v_perm_b32 v92, v103, v99, s29
    v_perm_b32 v89, v111, v107, s28
    v_perm_b32 v93, v111, v107, s29
    v_perm_b32 v90, v119, v115, s28
    v_perm_b32 v94, v119, v115, s29
    v_perm_b32 v91, v127, v123, s28
    v_perm_b32 v95, v127, v123, s29
    s_lshl_b32 s36, s40, 7
    s_add_u32 s36, s36, s22
    s_and_b32 s37, s36, 3
    s_lshr_b32 s38, s36, 1
    s_and_b32 s38, s38, 4
    s_or_b32 s37, s37, s38
    v_bfe_u32 v253, v254, 5, 3
    v_xor_b32 v253, s37, v253
    v_lshl_add_u32 v253, v253, 5, v251
    s_lshl_b32 s36, s36, 9
    s_add_u32 s39, s36, s32
    v_mfma_f32_16x16x32_bf16 v[128:131], v[224:227], v[64:67], 0
    v_mfma_f32_16x16x32_bf16 v[132:135], v[224:227], v[68:71], 0
    v_mfma_f32_16x16x32_bf16 v[136:139], v[224:227], v[72:75], 0
    v_mfma_f32_16x16x32_bf16 v[140:143], v[224:227], v[76:79], 0
    v_mfma_f32_16x16x32_bf16 v[144:147], v[224:227], v[80:83], 0
    v_mfma_f32_16x16x32_bf16 v[148:151], v[224:227], v[84:87], 0
    v_mfma_f32_16x16x32_bf16 v[152:155], v[224:227], v[88:91], 0
    v_mfma_f32_16x16x32_bf16 v[156:159], v[224:227], v[92:95], 0
    s_nop 7
    v_cvt_pk_bf16_f32 v240, v128, v132
    v_cvt_pk_bf16_f32 v241, v136, v140
    v_cvt_pk_bf16_f32 v242, v144, v148
    v_cvt_pk_bf16_f32 v243, v152, v156
    buffer_store_dwordx4 v[240:243], v253, s[16:19], s39 offen sc1
    s_add_u32 s39, s39, 4194304
    v_cvt_pk_bf16_f32 v244, v129, v133
    v_cvt_pk_bf16_f32 v245, v137, v141
    v_cvt_pk_bf16_f32 v246, v145, v149
    v_cvt_pk_bf16_f32 v247, v153, v157
    buffer_store_dwordx4 v[244:247], v253, s[16:19], s39 offen sc1
    s_add_u32 s39, s39, 4194304
    v_cvt_pk_bf16_f32 v240, v130, v134
    v_cvt_pk_bf16_f32 v241, v138, v142
    v_cvt_pk_bf16_f32 v242, v146, v150
    v_cvt_pk_bf16_f32 v243, v154, v158
    buffer_store_dwordx4 v[240:243], v253, s[16:19], s39 offen sc1
    s_add_u32 s39, s39, 4194304
    v_cvt_pk_bf16_f32 v244, v131, v135
    v_cvt_pk_bf16_f32 v245, v139, v143
    v_cvt_pk_bf16_f32 v246, v147, v151
    v_cvt_pk_bf16_f32 v247, v155, v159
    buffer_store_dwordx4 v[244:247], v253, s[16:19], s39 offen sc1
    s_add_u32 s39, s39, 4194304
    v_mfma_f32_16x16x32_bf16 v[128:131], v[228:231], v[64:67], 0
    v_mfma_f32_16x16x32_bf16 v[132:135], v[228:231], v[68:71], 0
    v_mfma_f32_16x16x32_bf16 v[136:139], v[228:231], v[72:75], 0
    v_mfma_f32_16x16x32_bf16 v[140:143], v[228:231], v[76:79], 0
    v_mfma_f32_16x16x32_bf16 v[144:147], v[228:231], v[80:83], 0
    v_mfma_f32_16x16x32_bf16 v[148:151], v[228:231], v[84:87], 0
    v_mfma_f32_16x16x32_bf16 v[152:155], v[228:231], v[88:91], 0
    v_mfma_f32_16x16x32_bf16 v[156:159], v[228:231], v[92:95], 0
    s_nop 7
    v_cvt_pk_bf16_f32 v240, v128, v132
    v_cvt_pk_bf16_f32 v241, v136, v140
    v_cvt_pk_bf16_f32 v242, v144, v148
    v_cvt_pk_bf16_f32 v243, v152, v156
    buffer_store_dwordx4 v[240:243], v253, s[16:19], s39 offen sc1
    s_add_u32 s39, s39, 4194304
    v_cvt_pk_bf16_f32 v244, v129, v133
    v_cvt_pk_bf16_f32 v245, v137, v141
    v_cvt_pk_bf16_f32 v246, v145, v149
    v_cvt_pk_bf16_f32 v247, v153, v157
    buffer_store_dwordx4 v[244:247], v253, s[16:19], s39 offen sc1
    s_add_u32 s39, s39, 4194304
    v_cvt_pk_bf16_f32 v240, v130, v134
    v_cvt_pk_bf16_f32 v241, v138, v142
    v_cvt_pk_bf16_f32 v242, v146, v150
    v_cvt_pk_bf16_f32 v243, v154, v158
    buffer_store_dwordx4 v[240:243], v253, s[16:19], s39 offen sc1
    s_add_u32 s39, s39, 4194304
    v_cvt_pk_bf16_f32 v244, v131, v135
    v_cvt_pk_bf16_f32 v245, v139, v143
    v_cvt_pk_bf16_f32 v246, v147, v151
    v_cvt_pk_bf16_f32 v247, v155, v159
    buffer_store_dwordx4 v[244:247], v253, s[16:19], s39 offen sc1
    s_add_u32 s39, s39, 4194304
    v_mfma_f32_16x16x32_bf16 v[128:131], v[232:235], v[64:67], 0
    v_mfma_f32_16x16x32_bf16 v[132:135], v[232:235], v[68:71], 0
    v_mfma_f32_16x16x32_bf16 v[136:139], v[232:235], v[72:75], 0
    v_mfma_f32_16x16x32_bf16 v[140:143], v[232:235], v[76:79], 0
    v_mfma_f32_16x16x32_bf16 v[144:147], v[232:235], v[80:83], 0
    v_mfma_f32_16x16x32_bf16 v[148:151], v[232:235], v[84:87], 0
    v_mfma_f32_16x16x32_bf16 v[152:155], v[232:235], v[88:91], 0
    v_mfma_f32_16x16x32_bf16 v[156:159], v[232:235], v[92:95], 0
    s_nop 7
    v_cvt_pk_bf16_f32 v240, v128, v132
    v_cvt_pk_bf16_f32 v241, v136, v140
    v_cvt_pk_bf16_f32 v242, v144, v148
    v_cvt_pk_bf16_f32 v243, v152, v156
    buffer_store_dwordx4 v[240:243], v253, s[16:19], s39 offen sc1
    s_add_u32 s39, s39, 4194304
    v_cvt_pk_bf16_f32 v244, v129, v133
    v_cvt_pk_bf16_f32 v245, v137, v141
    v_cvt_pk_bf16_f32 v246, v145, v149
    v_cvt_pk_bf16_f32 v247, v153, v157
    buffer_store_dwordx4 v[244:247], v253, s[16:19], s39 offen sc1
    s_add_u32 s39, s39, 4194304
    v_cvt_pk_bf16_f32 v240, v130, v134
    v_cvt_pk_bf16_f32 v241, v138, v142
    v_cvt_pk_bf16_f32 v242, v146, v150
    v_cvt_pk_bf16_f32 v243, v154, v158
    buffer_store_dwordx4 v[240:243], v253, s[16:19], s39 offen sc1
    s_add_u32 s39, s39, 4194304
    v_cvt_pk_bf16_f32 v244, v131, v135
    v_cvt_pk_bf16_f32 v245, v139, v143
    v_cvt_pk_bf16_f32 v246, v147, v151
    v_cvt_pk_bf16_f32 v247, v155, v159
    buffer_store_dwordx4 v[244:247], v253, s[16:19], s39 offen sc1
    s_add_u32 s39, s39, 4194304
    v_mfma_f32_16x16x32_bf16 v[128:131], v[236:239], v[64:67], 0
    v_mfma_f32_16x16x32_bf16 v[132:135], v[236:239], v[68:71], 0
    v_mfma_f32_16x16x32_bf16 v[136:139], v[236:239], v[72:75], 0
    v_mfma_f32_16x16x32_bf16 v[140:143], v[236:239], v[76:79], 0
    v_mfma_f32_16x16x32_bf16 v[144:147], v[236:239], v[80:83], 0
    v_mfma_f32_16x16x32_bf16 v[148:151], v[236:239], v[84:87], 0
    v_mfma_f32_16x16x32_bf16 v[152:155], v[236:239], v[88:91], 0
    v_mfma_f32_16x16x32_bf16 v[156:159], v[236:239], v[92:95], 0
    s_nop 7
    v_cvt_pk_bf16_f32 v240, v128, v132
    v_cvt_pk_bf16_f32 v241, v136, v140
    v_cvt_pk_bf16_f32 v242, v144, v148
    v_cvt_pk_bf16_f32 v243, v152, v156
    buffer_store_dwordx4 v[240:243], v253, s[16:19], s39 offen sc1
    s_add_u32 s39, s39, 4194304
    v_cvt_pk_bf16_f32 v244, v129, v133
    v_cvt_pk_bf16_f32 v245, v137, v141
    v_cvt_pk_bf16_f32 v246, v145, v149
    v_cvt_pk_bf16_f32 v247, v153, v157
    buffer_store_dwordx4 v[244:247], v253, s[16:19], s39 offen sc1
    s_add_u32 s39, s39, 4194304
    v_cvt_pk_bf16_f32 v240, v130, v134
    v_cvt_pk_bf16_f32 v241, v138, v142
    v_cvt_pk_bf16_f32 v242, v146, v150
    v_cvt_pk_bf16_f32 v243, v154, v158
    buffer_store_dwordx4 v[240:243], v253, s[16:19], s39 offen sc1
    s_add_u32 s39, s39, 4194304
    v_cvt_pk_bf16_f32 v244, v131, v135
    v_cvt_pk_bf16_f32 v245, v139, v143
    v_cvt_pk_bf16_f32 v246, v147, v151
    v_cvt_pk_bf16_f32 v247, v155, v159
    buffer_store_dwordx4 v[244:247], v253, s[16:19], s39 offen sc1
    s_branch K12_H2
K12_H1:
    s_cmp_eq_u32 s27, 0
    s_cbranch_scc1 K12_H2
    v_perm_b32 v64, v4, v0, s28
    v_perm_b32 v68, v4, v0, s29
    v_perm_b32 v65, v12, v8, s28
    v_perm_b32 v69, v12, v8, s29
    v_perm_b32 v66, v20, v16, s28
    v_perm_b32 v70, v20, v16, s29
    v_perm_b32 v67, v28, v24, s28
    v_perm_b32 v71, v28, v24, s29
    v_perm_b32 v72, v5, v1, s28
    v_perm_b32 v76, v5, v1, s29
    v_perm_b32 v73, v13, v9, s28
    v_perm_b32 v77, v13, v9, s29
    v_perm_b32 v74, v21, v17, s28
    v_perm_b32 v78, v21, v17, s29
    v_perm_b32 v75, v29, v25, s28
    v_perm_b32 v79, v29, v25, s29
    v_perm_b32 v80, v6, v2, s28
    v_perm_b32 v84, v6, v2, s29
    v_perm_b32 v81, v14, v10, s28
    v_perm_b32 v85, v14, v10, s29
    v_perm_b32 v82, v22, v18, s28
    v_perm_b32 v86, v22, v18, s29
    v_perm_b32 v83, v30, v26, s28
    v_perm_b32 v87, v30, v26, s29
    v_perm_b32 v88, v7, v3, s28
    v_perm_b32 v92, v7, v3, s29
    v_perm_b32 v89, v15, v11, s28
    v_perm_b32 v93, v15, v11, s29
    v_perm_b32 v90, v23, v19, s28
    v_perm_b32 v94, v23, v19, s29
    v_perm_b32 v91, v31, v27, s28
    v_perm_b32 v95, v31, v27, s29
    v_perm_b32 v0, v36, v32, s28
    v_perm_b32 v4, v36, v32, s29
    v_perm_b32 v1, v44, v40, s28
    v_perm_b32 v5, v44, v40, s29
    v_perm_b32 v2, v52, v48, s28
    v_perm_b32 v6, v52, v48, s29
    v_perm_b32 v3, v60, v56, s28
    v_perm_b32 v7, v60, v56, s29
    v_perm_b32 v8, v37, v33, s28
    v_perm_b32 v12, v37, v33, s29
    v_perm_b32 v9, v45, v41, s28
    v_perm_b32 v13, v45, v41, s29
    v_perm_b32 v10, v53, v49, s28
    v_perm_b32 v14, v53, v49, s29
    v_perm_b32 v11, v61, v57, s28
    v_perm_b32 v15, v61, v57, s29
    v_perm_b32 v16, v38, v34, s28
    v_perm_b32 v20, v38, v34, s29
    v_perm_b32 v17, v46, v42, s28
    v_perm_b32 v21, v46, v42, s29
    v_perm_b32 v18, v54, v50, s28
    v_perm_b32 v22, v54, v50, s29
    v_perm_b32 v19, v62, v58, s28
    v_perm_b32 v23, v62, v58, s29
    v_perm_b32 v24, v39, v35, s28
    v_perm_b32 v28, v39, v35, s29
    v_perm_b32 v25, v47, v43, s28
    v_perm_b32 v29, v47, v43, s29
    v_perm_b32 v26, v55, v51, s28
    v_perm_b32 v30, v55, v51, s29
    v_perm_b32 v27, v63, v59, s28
    v_perm_b32 v31, v63, v59, s29
    s_mul_i32 s39, s40, 85504
    s_add_u32 s39, s39, s31
    s_lshl_b32 s36, s30, 7
    s_add_u32 s39, s39, s36
    v_bfe_u32 v249, v254, 4, 2
    v_bfe_u32 v240, v254, 8, 1
    v_lshl_add_u32 v249, v240, 2, v249
    s_lshr_b32 s36, s30, 1
    s_and_b32 s36, s36, 7
    v_xor_b32 v249, s36, v249
    v_lshl_add_u32 v249, v249, 4, v252
    v_mfma_f32_16x16x32_bf16 v[32:35], v[160:163], v[64:67], 0
    v_mfma_f32_16x16x32_bf16 v[36:39], v[160:163], v[68:71], 0
    v_mfma_f32_16x16x32_bf16 v[40:43], v[160:163], v[72:75], 0
    v_mfma_f32_16x16x32_bf16 v[44:47], v[160:163], v[76:79], 0
    v_mfma_f32_16x16x32_bf16 v[48:51], v[160:163], v[80:83], 0
    v_mfma_f32_16x16x32_bf16 v[52:55], v[160:163], v[84:87], 0
    v_mfma_f32_16x16x32_bf16 v[56:59], v[160:163], v[88:91], 0
    v_mfma_f32_16x16x32_bf16 v[60:63], v[160:163], v[92:95], 0
    v_mfma_f32_16x16x32_bf16 v[32:35], v[192:195], v[64:67], v[32:35]
    v_mfma_f32_16x16x32_bf16 v[36:39], v[192:195], v[68:71], v[36:39]
    v_mfma_f32_16x16x32_bf16 v[40:43], v[192:195], v[72:75], v[40:43]
    v_mfma_f32_16x16x32_bf16 v[44:47], v[192:195], v[76:79], v[44:47]
    v_mfma_f32_16x16x32_bf16 v[48:51], v[192:195], v[80:83], v[48:51]
    v_mfma_f32_16x16x32_bf16 v[52:55], v[192:195], v[84:87], v[52:55]
    v_mfma_f32_16x16x32_bf16 v[56:59], v[192:195], v[88:91], v[56:59]
    v_mfma_f32_16x16x32_bf16 v[60:63], v[192:195], v[92:95], v[60:63]
    v_mfma_f32_16x16x32_bf16 v[32:35], v[164:167], v[0:3], v[32:35]
    v_mfma_f32_16x16x32_bf16 v[36:39], v[164:167], v[4:7], v[36:39]
    v_mfma_f32_16x16x32_bf16 v[40:43], v[164:167], v[8:11], v[40:43]
    v_mfma_f32_16x16x32_bf16 v[44:47], v[164:167], v[12:15], v[44:47]
    v_mfma_f32_16x16x32_bf16 v[48:51], v[164:167], v[16:19], v[48:51]
    v_mfma_f32_16x16x32_bf16 v[52:55], v[164:167], v[20:23], v[52:55]
    v_mfma_f32_16x16x32_bf16 v[56:59], v[164:167], v[24:27], v[56:59]
    v_mfma_f32_16x16x32_bf16 v[60:63], v[164:167], v[28:31], v[60:63]
    v_mfma_f32_16x16x32_bf16 v[32:35], v[196:199], v[0:3], v[32:35]
    v_mfma_f32_16x16x32_bf16 v[36:39], v[196:199], v[4:7], v[36:39]
    v_mfma_f32_16x16x32_bf16 v[40:43], v[196:199], v[8:11], v[40:43]
    v_mfma_f32_16x16x32_bf16 v[44:47], v[196:199], v[12:15], v[44:47]
    v_mfma_f32_16x16x32_bf16 v[48:51], v[196:199], v[16:19], v[48:51]
    v_mfma_f32_16x16x32_bf16 v[52:55], v[196:199], v[20:23], v[52:55]
    v_mfma_f32_16x16x32_bf16 v[56:59], v[196:199], v[24:27], v[56:59]
    v_mfma_f32_16x16x32_bf16 v[60:63], v[196:199], v[28:31], v[60:63]
    s_nop 7
    v_cvt_pk_bf16_f32 v240, v32, v36
    v_cvt_pk_bf16_f32 v241, v40, v44
    v_cvt_pk_bf16_f32 v242, v48, v52
    v_cvt_pk_bf16_f32 v243, v56, v60
    buffer_store_dwordx4 v[240:243], v249, s[12:15], s39 offen sc1
    s_add_u32 s39, s39, 2736128
    v_cvt_pk_bf16_f32 v244, v33, v37
    v_cvt_pk_bf16_f32 v245, v41, v45
    v_cvt_pk_bf16_f32 v246, v49, v53
    v_cvt_pk_bf16_f32 v247, v57, v61
    buffer_store_dwordx4 v[244:247], v249, s[12:15], s39 offen sc1
    s_add_u32 s39, s39, 2736128
    v_cvt_pk_bf16_f32 v240, v34, v38
    v_cvt_pk_bf16_f32 v241, v42, v46
    v_cvt_pk_bf16_f32 v242, v50, v54
    v_cvt_pk_bf16_f32 v243, v58, v62
    buffer_store_dwordx4 v[240:243], v249, s[12:15], s39 offen sc1
    s_add_u32 s39, s39, 2736128
    v_cvt_pk_bf16_f32 v244, v35, v39
    v_cvt_pk_bf16_f32 v245, v43, v47
    v_cvt_pk_bf16_f32 v246, v51, v55
    v_cvt_pk_bf16_f32 v247, v59, v63
    buffer_store_dwordx4 v[244:247], v249, s[12:15], s39 offen sc1
    s_add_u32 s39, s39, 2736128
    v_mfma_f32_16x16x32_bf16 v[32:35], v[168:171], v[64:67], 0
    v_mfma_f32_16x16x32_bf16 v[36:39], v[168:171], v[68:71], 0
    v_mfma_f32_16x16x32_bf16 v[40:43], v[168:171], v[72:75], 0
    v_mfma_f32_16x16x32_bf16 v[44:47], v[168:171], v[76:79], 0
    v_mfma_f32_16x16x32_bf16 v[48:51], v[168:171], v[80:83], 0
    v_mfma_f32_16x16x32_bf16 v[52:55], v[168:171], v[84:87], 0
    v_mfma_f32_16x16x32_bf16 v[56:59], v[168:171], v[88:91], 0
    v_mfma_f32_16x16x32_bf16 v[60:63], v[168:171], v[92:95], 0
    v_mfma_f32_16x16x32_bf16 v[32:35], v[200:203], v[64:67], v[32:35]
    v_mfma_f32_16x16x32_bf16 v[36:39], v[200:203], v[68:71], v[36:39]
    v_mfma_f32_16x16x32_bf16 v[40:43], v[200:203], v[72:75], v[40:43]
    v_mfma_f32_16x16x32_bf16 v[44:47], v[200:203], v[76:79], v[44:47]
    v_mfma_f32_16x16x32_bf16 v[48:51], v[200:203], v[80:83], v[48:51]
    v_mfma_f32_16x16x32_bf16 v[52:55], v[200:203], v[84:87], v[52:55]
    v_mfma_f32_16x16x32_bf16 v[56:59], v[200:203], v[88:91], v[56:59]
    v_mfma_f32_16x16x32_bf16 v[60:63], v[200:203], v[92:95], v[60:63]
    v_mfma_f32_16x16x32_bf16 v[32:35], v[172:175], v[0:3], v[32:35]
    v_mfma_f32_16x16x32_bf16 v[36:39], v[172:175], v[4:7], v[36:39]
    v_mfma_f32_16x16x32_bf16 v[40:43], v[172:175], v[8:11], v[40:43]
    v_mfma_f32_16x16x32_bf16 v[44:47], v[172:175], v[12:15], v[44:47]
    v_mfma_f32_16x16x32_bf16 v[48:51], v[172:175], v[16:19], v[48:51]
    v_mfma_f32_16x16x32_bf16 v[52:55], v[172:175], v[20:23], v[52:55]
    v_mfma_f32_16x16x32_bf16 v[56:59], v[172:175], v[24:27], v[56:59]
    v_mfma_f32_16x16x32_bf16 v[60:63], v[172:175], v[28:31], v[60:63]
    v_mfma_f32_16x16x32_bf16 v[32:35], v[204:207], v[0:3], v[32:35]
    v_mfma_f32_16x16x32_bf16 v[36:39], v[204:207], v[4:7], v[36:39]
    v_mfma_f32_16x16x32_bf16 v[40:43], v[204:207], v[8:11], v[40:43]
    v_mfma_f32_16x16x32_bf16 v[44:47], v[204:207], v[12:15], v[44:47]
    v_mfma_f32_16x16x32_bf16 v[48:51], v[204:207], v[16:19], v[48:51]
    v_mfma_f32_16x16x32_bf16 v[52:55], v[204:207], v[20:23], v[52:55]
    v_mfma_f32_16x16x32_bf16 v[56:59], v[204:207], v[24:27], v[56:59]
    v_mfma_f32_16x16x32_bf16 v[60:63], v[204:207], v[28:31], v[60:63]
    s_nop 7
    v_cvt_pk_bf16_f32 v240, v32, v36
    v_cvt_pk_bf16_f32 v241, v40, v44
    v_cvt_pk_bf16_f32 v242, v48, v52
    v_cvt_pk_bf16_f32 v243, v56, v60
    buffer_store_dwordx4 v[240:243], v249, s[12:15], s39 offen sc1
    s_add_u32 s39, s39, 2736128
    v_cvt_pk_bf16_f32 v244, v33, v37
    v_cvt_pk_bf16_f32 v245, v41, v45
    v_cvt_pk_bf16_f32 v246, v49, v53
    v_cvt_pk_bf16_f32 v247, v57, v61
    buffer_store_dwordx4 v[244:247], v249, s[12:15], s39 offen sc1
    s_add_u32 s39, s39, 2736128
    v_cvt_pk_bf16_f32 v240, v34, v38
    v_cvt_pk_bf16_f32 v241, v42, v46
    v_cvt_pk_bf16_f32 v242, v50, v54
    v_cvt_pk_bf16_f32 v243, v58, v62
    buffer_store_dwordx4 v[240:243], v249, s[12:15], s39 offen sc1
    s_add_u32 s39, s39, 2736128
    v_cvt_pk_bf16_f32 v244, v35, v39
    v_cvt_pk_bf16_f32 v245, v43, v47
    v_cvt_pk_bf16_f32 v246, v51, v55
    v_cvt_pk_bf16_f32 v247, v59, v63
    buffer_store_dwordx4 v[244:247], v249, s[12:15], s39 offen sc1
    s_add_u32 s39, s39, 2736128
    v_mfma_f32_16x16x32_bf16 v[32:35], v[176:179], v[64:67], 0
    v_mfma_f32_16x16x32_bf16 v[36:39], v[176:179], v[68:71], 0
    v_mfma_f32_16x16x32_bf16 v[40:43], v[176:179], v[72:75], 0
    v_mfma_f32_16x16x32_bf16 v[44:47], v[176:179], v[76:79], 0
    v_mfma_f32_16x16x32_bf16 v[48:51], v[176:179], v[80:83], 0
    v_mfma_f32_16x16x32_bf16 v[52:55], v[176:179], v[84:87], 0
    v_mfma_f32_16x16x32_bf16 v[56:59], v[176:179], v[88:91], 0
    v_mfma_f32_16x16x32_bf16 v[60:63], v[176:179], v[92:95], 0
    v_mfma_f32_16x16x32_bf16 v[32:35], v[208:211], v[64:67], v[32:35]
    v_mfma_f32_16x16x32_bf16 v[36:39], v[208:211], v[68:71], v[36:39]
    v_mfma_f32_16x16x32_bf16 v[40:43], v[208:211], v[72:75], v[40:43]
    v_mfma_f32_16x16x32_bf16 v[44:47], v[208:211], v[76:79], v[44:47]
    v_mfma_f32_16x16x32_bf16 v[48:51], v[208:211], v[80:83], v[48:51]
    v_mfma_f32_16x16x32_bf16 v[52:55], v[208:211], v[84:87], v[52:55]
    v_mfma_f32_16x16x32_bf16 v[56:59], v[208:211], v[88:91], v[56:59]
    v_mfma_f32_16x16x32_bf16 v[60:63], v[208:211], v[92:95], v[60:63]
    v_mfma_f32_16x16x32_bf16 v[32:35], v[180:183], v[0:3], v[32:35]
    v_mfma_f32_16x16x32_bf16 v[36:39], v[180:183], v[4:7], v[36:39]
    v_mfma_f32_16x16x32_bf16 v[40:43], v[180:183], v[8:11], v[40:43]
    v_mfma_f32_16x16x32_bf16 v[44:47], v[180:183], v[12:15], v[44:47]
    v_mfma_f32_16x16x32_bf16 v[48:51], v[180:183], v[16:19], v[48:51]
    v_mfma_f32_16x16x32_bf16 v[52:55], v[180:183], v[20:23], v[52:55]
    v_mfma_f32_16x16x32_bf16 v[56:59], v[180:183], v[24:27], v[56:59]
    v_mfma_f32_16x16x32_bf16 v[60:63], v[180:183], v[28:31], v[60:63]
    v_mfma_f32_16x16x32_bf16 v[32:35], v[212:215], v[0:3], v[32:35]
    v_mfma_f32_16x16x32_bf16 v[36:39], v[212:215], v[4:7], v[36:39]
    v_mfma_f32_16x16x32_bf16 v[40:43], v[212:215], v[8:11], v[40:43]
    v_mfma_f32_16x16x32_bf16 v[44:47], v[212:215], v[12:15], v[44:47]
    v_mfma_f32_16x16x32_bf16 v[48:51], v[212:215], v[16:19], v[48:51]
    v_mfma_f32_16x16x32_bf16 v[52:55], v[212:215], v[20:23], v[52:55]
    v_mfma_f32_16x16x32_bf16 v[56:59], v[212:215], v[24:27], v[56:59]
    v_mfma_f32_16x16x32_bf16 v[60:63], v[212:215], v[28:31], v[60:63]
    s_nop 7
    v_cvt_pk_bf16_f32 v240, v32, v36
    v_cvt_pk_bf16_f32 v241, v40, v44
    v_cvt_pk_bf16_f32 v242, v48, v52
    v_cvt_pk_bf16_f32 v243, v56, v60
    buffer_store_dwordx4 v[240:243], v249, s[12:15], s39 offen sc1
    s_add_u32 s39, s39, 2736128
    v_cvt_pk_bf16_f32 v244, v33, v37
    v_cvt_pk_bf16_f32 v245, v41, v45
    v_cvt_pk_bf16_f32 v246, v49, v53
    v_cvt_pk_bf16_f32 v247, v57, v61
    buffer_store_dwordx4 v[244:247], v249, s[12:15], s39 offen sc1
    s_add_u32 s39, s39, 2736128
    v_cvt_pk_bf16_f32 v240, v34, v38
    v_cvt_pk_bf16_f32 v241, v42, v46
    v_cvt_pk_bf16_f32 v242, v50, v54
    v_cvt_pk_bf16_f32 v243, v58, v62
    buffer_store_dwordx4 v[240:243], v249, s[12:15], s39 offen sc1
    s_add_u32 s39, s39, 2736128
    v_cvt_pk_bf16_f32 v244, v35, v39
    v_cvt_pk_bf16_f32 v245, v43, v47
    v_cvt_pk_bf16_f32 v246, v51, v55
    v_cvt_pk_bf16_f32 v247, v59, v63
    buffer_store_dwordx4 v[244:247], v249, s[12:15], s39 offen sc1
    s_add_u32 s39, s39, 2736128
    v_mfma_f32_16x16x32_bf16 v[32:35], v[184:187], v[64:67], 0
    v_mfma_f32_16x16x32_bf16 v[36:39], v[184:187], v[68:71], 0
    v_mfma_f32_16x16x32_bf16 v[40:43], v[184:187], v[72:75], 0
    v_mfma_f32_16x16x32_bf16 v[44:47], v[184:187], v[76:79], 0
    v_mfma_f32_16x16x32_bf16 v[48:51], v[184:187], v[80:83], 0
    v_mfma_f32_16x16x32_bf16 v[52:55], v[184:187], v[84:87], 0
    v_mfma_f32_16x16x32_bf16 v[56:59], v[184:187], v[88:91], 0
    v_mfma_f32_16x16x32_bf16 v[60:63], v[184:187], v[92:95], 0
    v_mfma_f32_16x16x32_bf16 v[32:35], v[216:219], v[64:67], v[32:35]
    v_mfma_f32_16x16x32_bf16 v[36:39], v[216:219], v[68:71], v[36:39]
    v_mfma_f32_16x16x32_bf16 v[40:43], v[216:219], v[72:75], v[40:43]
    v_mfma_f32_16x16x32_bf16 v[44:47], v[216:219], v[76:79], v[44:47]
    v_mfma_f32_16x16x32_bf16 v[48:51], v[216:219], v[80:83], v[48:51]
    v_mfma_f32_16x16x32_bf16 v[52:55], v[216:219], v[84:87], v[52:55]
    v_mfma_f32_16x16x32_bf16 v[56:59], v[216:219], v[88:91], v[56:59]
    v_mfma_f32_16x16x32_bf16 v[60:63], v[216:219], v[92:95], v[60:63]
    v_mfma_f32_16x16x32_bf16 v[32:35], v[188:191], v[0:3], v[32:35]
    v_mfma_f32_16x16x32_bf16 v[36:39], v[188:191], v[4:7], v[36:39]
    v_mfma_f32_16x16x32_bf16 v[40:43], v[188:191], v[8:11], v[40:43]
    v_mfma_f32_16x16x32_bf16 v[44:47], v[188:191], v[12:15], v[44:47]
    v_mfma_f32_16x16x32_bf16 v[48:51], v[188:191], v[16:19], v[48:51]
    v_mfma_f32_16x16x32_bf16 v[52:55], v[188:191], v[20:23], v[52:55]
    v_mfma_f32_16x16x32_bf16 v[56:59], v[188:191], v[24:27], v[56:59]
    v_mfma_f32_16x16x32_bf16 v[60:63], v[188:191], v[28:31], v[60:63]
    v_mfma_f32_16x16x32_bf16 v[32:35], v[220:223], v[0:3], v[32:35]
    v_mfma_f32_16x16x32_bf16 v[36:39], v[220:223], v[4:7], v[36:39]
    v_mfma_f32_16x16x32_bf16 v[40:43], v[220:223], v[8:11], v[40:43]
    v_mfma_f32_16x16x32_bf16 v[44:47], v[220:223], v[12:15], v[44:47]
    v_mfma_f32_16x16x32_bf16 v[48:51], v[220:223], v[16:19], v[48:51]
    v_mfma_f32_16x16x32_bf16 v[52:55], v[220:223], v[20:23], v[52:55]
    v_mfma_f32_16x16x32_bf16 v[56:59], v[220:223], v[24:27], v[56:59]
    v_mfma_f32_16x16x32_bf16 v[60:63], v[220:223], v[28:31], v[60:63]
    s_nop 7
    v_cvt_pk_bf16_f32 v240, v32, v36
    v_cvt_pk_bf16_f32 v241, v40, v44
    v_cvt_pk_bf16_f32 v242, v48, v52
    v_cvt_pk_bf16_f32 v243, v56, v60
    buffer_store_dwordx4 v[240:243], v249, s[12:15], s39 offen sc1
    s_add_u32 s39, s39, 2736128
    v_cvt_pk_bf16_f32 v244, v33, v37
    v_cvt_pk_bf16_f32 v245, v41, v45
    v_cvt_pk_bf16_f32 v246, v49, v53
    v_cvt_pk_bf16_f32 v247, v57, v61
    buffer_store_dwordx4 v[244:247], v249, s[12:15], s39 offen sc1
    s_add_u32 s39, s39, 2736128
    v_cvt_pk_bf16_f32 v240, v34, v38
    v_cvt_pk_bf16_f32 v241, v42, v46
    v_cvt_pk_bf16_f32 v242, v50, v54
    v_cvt_pk_bf16_f32 v243, v58, v62
    buffer_store_dwordx4 v[240:243], v249, s[12:15], s39 offen sc1
    s_add_u32 s39, s39, 2736128
    v_cvt_pk_bf16_f32 v244, v35, v39
    v_cvt_pk_bf16_f32 v245, v43, v47
    v_cvt_pk_bf16_f32 v246, v51, v55
    v_cvt_pk_bf16_f32 v247, v59, v63
    buffer_store_dwordx4 v[244:247], v249, s[12:15], s39 offen sc1
K12_H2:
    s_mov_b64 exec, 1
    v_mov_b32 v255, 155664
    v_mov_b32 v64, 1
    ds_add_u32 v255, v64
    s_mov_b64 exec, -1
    s_waitcnt vmcnt(0)
    s_mov_b32 s41, 0
    s_mov_b32 s34, -1
    s_cmp_ge_u32 s41, 8
    s_cbranch_scc1 K12_SG0
    s_lshl_b32 s36, s41, 2
    s_add_u32 s37, s36, 155680
    s_mov_b64 exec, 1
    v_mov_b32 v255, s37
    v_mov_b32 v240, 1
    ds_add_rtn_u32 v240, v255, v240
    s_waitcnt lgkmcnt(0)
    v_readfirstlane_b32 s37, v240
    s_nop 3
    s_cmp_eq_u32 s37, 3
    s_cbranch_scc0 K12_SH0
    s_lshl_b32 s36, s36, 8
    v_mov_b32 v255, 1
    v_mov_b32 v240, s36
    buffer_atomic_add v255, v240, s[60:63], 0 offen sc0 sc1
    s_mov_b32 s34, s41
K12_SH0:
    s_mov_b64 exec, -1
K12_SG0:
    s_waitcnt vmcnt(0)
    s_cmp_ge_u32 s34, 8
    s_cbranch_scc1 K12_PB1
    v_readfirstlane_b32 s37, v255
    s_nop 3
    s_cmp_eq_u32 s37, 255
    s_cbranch_scc0 K12_PB1
    s_lshl_b32 s36, s34, 4
    s_add_u32 s36, s36, 16384
    s_mov_b64 exec, 1
    v_mov_b32 v255, 1
    v_mov_b32 v240, s36
    buffer_store_dword v255, v240, s[60:63], 0 offen sc1
    s_mov_b64 exec, -1
K12_PB1:
    s_branch K12_CONS
K12_PROD:
    s_setprio 1
    s_cmp_eq_u32 s43, 0
    s_cbranch_scc1 K12_WENTRY
K12_XW:
    s_cmp_eq_u32 s27, 0
    s_cbranch_scc1 K12_XP_N
    v_perm_b32 v64, v4, v0, s28
    v_perm_b32 v68, v4, v0, s29
    v_perm_b32 v65, v12, v8, s28
    v_perm_b32 v69, v12, v8, s29
    v_perm_b32 v66, v20, v16, s28
    v_perm_b32 v70, v20, v16, s29
    v_perm_b32 v67, v28, v24, s28
    v_perm_b32 v71, v28, v24, s29
    v_perm_b32 v72, v5, v1, s28
    v_perm_b32 v76, v5, v1, s29
    v_perm_b32 v73, v13, v9, s28
    v_perm_b32 v77, v13, v9, s29
    v_perm_b32 v74, v21, v17, s28
    v_perm_b32 v78, v21, v17, s29
    v_perm_b32 v75, v29, v25, s28
    v_perm_b32 v79, v29, v25, s29
    v_perm_b32 v80, v6, v2, s28
    v_perm_b32 v84, v6, v2, s29
    v_perm_b32 v81, v14, v10, s28
    v_perm_b32 v85, v14, v10, s29
    v_perm_b32 v82, v22, v18, s28
    v_perm_b32 v86, v22, v18, s29
    v_perm_b32 v83, v30, v26, s28
    v_perm_b32 v87, v30, v26, s29
    v_perm_b32 v88, v7, v3, s28
    v_perm_b32 v92, v7, v3, s29
    v_perm_b32 v89, v15, v11, s28
    v_perm_b32 v93, v15, v11, s29
    v_perm_b32 v90, v23, v19, s28
    v_perm_b32 v94, v23, v19, s29
    v_perm_b32 v91, v31, v27, s28
    v_perm_b32 v95, v31, v27, s29
    v_perm_b32 v0, v36, v32, s28
    v_perm_b32 v4, v36, v32, s29
    v_perm_b32 v1, v44, v40, s28
    v_perm_b32 v5, v44, v40, s29
    v_perm_b32 v2, v52, v48, s28
    v_perm_b32 v6, v52, v48, s29
    v_perm_b32 v3, v60, v56, s28
    v_perm_b32 v7, v60, v56, s29
    v_perm_b32 v8, v37, v33, s28
    v_perm_b32 v12, v37, v33, s29
    v_perm_b32 v9, v45, v41, s28
    v_perm_b32 v13, v45, v41, s29
    v_perm_b32 v10, v53, v49, s28
    v_perm_b32 v14, v53, v49, s29
    v_perm_b32 v11, v61, v57, s28
    v_perm_b32 v15, v61, v57, s29
    v_perm_b32 v16, v38, v34, s28
    v_perm_b32 v20, v38, v34, s29
    v_perm_b32 v17, v46, v42, s28
    v_perm_b32 v21, v46, v42, s29
    v_perm_b32 v18, v54, v50, s28
    v_perm_b32 v22, v54, v50, s29
    v_perm_b32 v19, v62, v58, s28
    v_perm_b32 v23, v62, v58, s29
    v_perm_b32 v24, v39, v35, s28
    v_perm_b32 v28, v39, v35, s29
    v_perm_b32 v25, v47, v43, s28
    v_perm_b32 v29, v47, v43, s29
    v_perm_b32 v26, v55, v51, s28
    v_perm_b32 v30, v55, v51, s29
    v_perm_b32 v27, v63, v59, s28
    v_perm_b32 v31, v63, v59, s29
K12_XP_N:
    s_add_u32 s42, s40, 1
    s_lshl_b32 s36, s42, 7
    s_add_u32 s36, s36, s22
    s_lshr_b32 s37, s36, 9
    s_lshl_b32 s37, s37, 19
    s_and_b32 s36, s36, 511
    s_lshl_b32 s36, s36, 10
    s_add_u32 s36, s36, s37
    s_add_u32 s36, s36, s33
    buffer_load_dwordx4 v[96:99], v250, s[8:11], s36 offen
    s_add_u32 s36, s36, 0x100000
    buffer_load_dwordx4 v[100:103], v250, s[8:11], s36 offen
    s_add_u32 s36, s36, 0x100000
    buffer_load_dwordx4 v[104:107], v250, s[8:11], s36 offen
    s_add_u32 s36, s36, 0x100000
    buffer_load_dwordx4 v[108:111], v250, s[8:11], s36 offen
    s_add_u32 s36, s36, 0x100000
    buffer_load_dwordx4 v[112:115], v250, s[8:11], s36 offen
    s_add_u32 s36, s36, 0x100000
    buffer_load_dwordx4 v[116:119], v250, s[8:11], s36 offen
    s_add_u32 s36, s36, 0x100000
    buffer_load_dwordx4 v[120:123], v250, s[8:11], s36 offen
    s_add_u32 s36, s36, 0x100000
    buffer_load_dwordx4 v[124:127], v250, s[8:11], s36 offen
    s_waitcnt vmcnt(8)
    s_mov_b32 s34, -1
    s_cmp_ge_u32 s41, 8
    s_cbranch_scc1 K12_SG2
    s_lshl_b32 s36, s41, 2
    s_add_u32 s37, s36, 155680
    s_mov_b64 exec, 1
    v_mov_b32 v255, s37
    v_mov_b32 v240, 1
    ds_add_rtn_u32 v240, v255, v240
    s_waitcnt lgkmcnt(0)
    v_readfirstlane_b32 s37, v240
    s_nop 3
    s_cmp_eq_u32 s37, 3
    s_cbranch_scc0 K12_SH2
    s_lshl_b32 s36, s36, 8
    v_mov_b32 v255, 1
    v_mov_b32 v240, s36
    buffer_atomic_add v255, v240, s[60:63], 0 offen sc0 sc1
    s_mov_b32 s34, s41
K12_SH2:
    s_mov_b64 exec, -1
K12_SG2:
    s_cmp_ge_u32 s34, 8
    s_cbranch_scc1 K12_EP3
    s_waitcnt vmcnt(0)
    s_cmp_ge_u32 s34, 8
    s_cbranch_scc1 K12_PB4
    v_readfirstlane_b32 s37, v255
    s_nop 3
    s_cmp_eq_u32 s37, 255
    s_cbranch_scc0 K12_PB4
    s_lshl_b32 s36, s34, 4
    s_add_u32 s36, s36, 16384
    s_mov_b64 exec, 1
    v_mov_b32 v255, 1
    v_mov_b32 v240, s36
    buffer_store_dword v255, v240, s[60:63], 0 offen sc1
    s_mov_b64 exec, -1
K12_PB4:
    s_mov_b32 s34, -1
K12_EP3:
    s_cmp_eq_u32 s27, 0
    s_cbranch_scc1 K12_XP_E
    s_lshl_b32 s36, s40, 3
    s_sub_i32 s36, s36, 28
    s_max_i32 s36, s36, 1
    s_mov_b32 s38, 155648
    s_cmp_eq_u32 s40, 99
    s_cselect_b32 s36, 4, s36
    s_cselect_b32 s38, 155664, s38
    s_cbranch_scc1 K12_GS0
    s_cmp_lt_u32 s40, 3
    s_cbranch_scc1 K12_GT0
K12_GS0:
    s_mov_b32 s37, 32768
K12_GL0:
    v_mov_b32 v240, s38
    ds_read_b32 v240, v240
    s_waitcnt lgkmcnt(0)
    v_cmp_gt_u32 vcc, s36, v240
    s_sub_u32 s37, s37, 1
    s_cmp_eq_u32 s37, 0
    s_cbranch_scc1 K12_GT0
    s_cbranch_vccz K12_GT0
    s_sleep 2
    s_branch K12_GL0
K12_GT0:
    s_mul_i32 s39, s40, 85504
    s_add_u32 s39, s39, s31
    s_lshl_b32 s36, s30, 7
    s_add_u32 s39, s39, s36
    v_bfe_u32 v249, v254, 4, 2
    v_bfe_u32 v240, v254, 8, 1
    v_lshl_add_u32 v249, v240, 2, v249
    s_lshr_b32 s36, s30, 1
    s_and_b32 s36, s36, 7
    v_xor_b32 v249, s36, v249
    v_lshl_add_u32 v249, v249, 4, v252
    v_mfma_f32_16x16x32_bf16 v[32:35], v[160:163], v[64:67], 0
    v_mfma_f32_16x16x32_bf16 v[36:39], v[160:163], v[68:71], 0
    v_mfma_f32_16x16x32_bf16 v[40:43], v[160:163], v[72:75], 0
    v_mfma_f32_16x16x32_bf16 v[44:47], v[160:163], v[76:79], 0
    v_mfma_f32_16x16x32_bf16 v[48:51], v[160:163], v[80:83], 0
    v_mfma_f32_16x16x32_bf16 v[52:55], v[160:163], v[84:87], 0
    v_mfma_f32_16x16x32_bf16 v[56:59], v[160:163], v[88:91], 0
    v_mfma_f32_16x16x32_bf16 v[60:63], v[160:163], v[92:95], 0
    v_mfma_f32_16x16x32_bf16 v[32:35], v[192:195], v[64:67], v[32:35]
    v_mfma_f32_16x16x32_bf16 v[36:39], v[192:195], v[68:71], v[36:39]
    v_mfma_f32_16x16x32_bf16 v[40:43], v[192:195], v[72:75], v[40:43]
    v_mfma_f32_16x16x32_bf16 v[44:47], v[192:195], v[76:79], v[44:47]
    v_mfma_f32_16x16x32_bf16 v[48:51], v[192:195], v[80:83], v[48:51]
    v_mfma_f32_16x16x32_bf16 v[52:55], v[192:195], v[84:87], v[52:55]
    v_mfma_f32_16x16x32_bf16 v[56:59], v[192:195], v[88:91], v[56:59]
    v_mfma_f32_16x16x32_bf16 v[60:63], v[192:195], v[92:95], v[60:63]
    v_mfma_f32_16x16x32_bf16 v[32:35], v[164:167], v[0:3], v[32:35]
    v_mfma_f32_16x16x32_bf16 v[36:39], v[164:167], v[4:7], v[36:39]
    v_mfma_f32_16x16x32_bf16 v[40:43], v[164:167], v[8:11], v[40:43]
    v_mfma_f32_16x16x32_bf16 v[44:47], v[164:167], v[12:15], v[44:47]
    v_mfma_f32_16x16x32_bf16 v[48:51], v[164:167], v[16:19], v[48:51]
    v_mfma_f32_16x16x32_bf16 v[52:55], v[164:167], v[20:23], v[52:55]
    v_mfma_f32_16x16x32_bf16 v[56:59], v[164:167], v[24:27], v[56:59]
    v_mfma_f32_16x16x32_bf16 v[60:63], v[164:167], v[28:31], v[60:63]
    v_mfma_f32_16x16x32_bf16 v[32:35], v[196:199], v[0:3], v[32:35]
    v_mfma_f32_16x16x32_bf16 v[36:39], v[196:199], v[4:7], v[36:39]
    v_mfma_f32_16x16x32_bf16 v[40:43], v[196:199], v[8:11], v[40:43]
    v_mfma_f32_16x16x32_bf16 v[44:47], v[196:199], v[12:15], v[44:47]
    v_mfma_f32_16x16x32_bf16 v[48:51], v[196:199], v[16:19], v[48:51]
    v_mfma_f32_16x16x32_bf16 v[52:55], v[196:199], v[20:23], v[52:55]
    v_mfma_f32_16x16x32_bf16 v[56:59], v[196:199], v[24:27], v[56:59]
    v_mfma_f32_16x16x32_bf16 v[60:63], v[196:199], v[28:31], v[60:63]
    s_nop 7
    v_cvt_pk_bf16_f32 v240, v32, v36
    v_cvt_pk_bf16_f32 v241, v40, v44
    v_cvt_pk_bf16_f32 v242, v48, v52
    v_cvt_pk_bf16_f32 v243, v56, v60
    buffer_store_dwordx4 v[240:243], v249, s[12:15], s39 offen sc1
    s_add_u32 s39, s39, 2736128
    v_cvt_pk_bf16_f32 v244, v33, v37
    v_cvt_pk_bf16_f32 v245, v41, v45
    v_cvt_pk_bf16_f32 v246, v49, v53
    v_cvt_pk_bf16_f32 v247, v57, v61
    buffer_store_dwordx4 v[244:247], v249, s[12:15], s39 offen sc1
    s_add_u32 s39, s39, 2736128
    v_cvt_pk_bf16_f32 v240, v34, v38
    v_cvt_pk_bf16_f32 v241, v42, v46
    v_cvt_pk_bf16_f32 v242, v50, v54
    v_cvt_pk_bf16_f32 v243, v58, v62
    buffer_store_dwordx4 v[240:243], v249, s[12:15], s39 offen sc1
    s_add_u32 s39, s39, 2736128
    v_cvt_pk_bf16_f32 v244, v35, v39
    v_cvt_pk_bf16_f32 v245, v43, v47
    v_cvt_pk_bf16_f32 v246, v51, v55
    v_cvt_pk_bf16_f32 v247, v59, v63
    buffer_store_dwordx4 v[244:247], v249, s[12:15], s39 offen sc1
    s_add_u32 s39, s39, 2736128
    v_mfma_f32_16x16x32_bf16 v[32:35], v[168:171], v[64:67], 0
    v_mfma_f32_16x16x32_bf16 v[36:39], v[168:171], v[68:71], 0
    v_mfma_f32_16x16x32_bf16 v[40:43], v[168:171], v[72:75], 0
    v_mfma_f32_16x16x32_bf16 v[44:47], v[168:171], v[76:79], 0
    v_mfma_f32_16x16x32_bf16 v[48:51], v[168:171], v[80:83], 0
    v_mfma_f32_16x16x32_bf16 v[52:55], v[168:171], v[84:87], 0
    v_mfma_f32_16x16x32_bf16 v[56:59], v[168:171], v[88:91], 0
    v_mfma_f32_16x16x32_bf16 v[60:63], v[168:171], v[92:95], 0
    v_mfma_f32_16x16x32_bf16 v[32:35], v[200:203], v[64:67], v[32:35]
    v_mfma_f32_16x16x32_bf16 v[36:39], v[200:203], v[68:71], v[36:39]
    v_mfma_f32_16x16x32_bf16 v[40:43], v[200:203], v[72:75], v[40:43]
    v_mfma_f32_16x16x32_bf16 v[44:47], v[200:203], v[76:79], v[44:47]
    v_mfma_f32_16x16x32_bf16 v[48:51], v[200:203], v[80:83], v[48:51]
    v_mfma_f32_16x16x32_bf16 v[52:55], v[200:203], v[84:87], v[52:55]
    v_mfma_f32_16x16x32_bf16 v[56:59], v[200:203], v[88:91], v[56:59]
    v_mfma_f32_16x16x32_bf16 v[60:63], v[200:203], v[92:95], v[60:63]
    v_mfma_f32_16x16x32_bf16 v[32:35], v[172:175], v[0:3], v[32:35]
    v_mfma_f32_16x16x32_bf16 v[36:39], v[172:175], v[4:7], v[36:39]
    v_mfma_f32_16x16x32_bf16 v[40:43], v[172:175], v[8:11], v[40:43]
    v_mfma_f32_16x16x32_bf16 v[44:47], v[172:175], v[12:15], v[44:47]
    v_mfma_f32_16x16x32_bf16 v[48:51], v[172:175], v[16:19], v[48:51]
    v_mfma_f32_16x16x32_bf16 v[52:55], v[172:175], v[20:23], v[52:55]
    v_mfma_f32_16x16x32_bf16 v[56:59], v[172:175], v[24:27], v[56:59]
    v_mfma_f32_16x16x32_bf16 v[60:63], v[172:175], v[28:31], v[60:63]
    v_mfma_f32_16x16x32_bf16 v[32:35], v[204:207], v[0:3], v[32:35]
    v_mfma_f32_16x16x32_bf16 v[36:39], v[204:207], v[4:7], v[36:39]
    v_mfma_f32_16x16x32_bf16 v[40:43], v[204:207], v[8:11], v[40:43]
    v_mfma_f32_16x16x32_bf16 v[44:47], v[204:207], v[12:15], v[44:47]
    v_mfma_f32_16x16x32_bf16 v[48:51], v[204:207], v[16:19], v[48:51]
    v_mfma_f32_16x16x32_bf16 v[52:55], v[204:207], v[20:23], v[52:55]
    v_mfma_f32_16x16x32_bf16 v[56:59], v[204:207], v[24:27], v[56:59]
    v_mfma_f32_16x16x32_bf16 v[60:63], v[204:207], v[28:31], v[60:63]
    s_nop 7
    v_cvt_pk_bf16_f32 v240, v32, v36
    v_cvt_pk_bf16_f32 v241, v40, v44
    v_cvt_pk_bf16_f32 v242, v48, v52
    v_cvt_pk_bf16_f32 v243, v56, v60
    buffer_store_dwordx4 v[240:243], v249, s[12:15], s39 offen sc1
    s_add_u32 s39, s39, 2736128
    v_cvt_pk_bf16_f32 v244, v33, v37
    v_cvt_pk_bf16_f32 v245, v41, v45
    v_cvt_pk_bf16_f32 v246, v49, v53
    v_cvt_pk_bf16_f32 v247, v57, v61
    buffer_store_dwordx4 v[244:247], v249, s[12:15], s39 offen sc1
    s_add_u32 s39, s39, 2736128
    v_cvt_pk_bf16_f32 v240, v34, v38
    v_cvt_pk_bf16_f32 v241, v42, v46
    v_cvt_pk_bf16_f32 v242, v50, v54
    v_cvt_pk_bf16_f32 v243, v58, v62
    buffer_store_dwordx4 v[240:243], v249, s[12:15], s39 offen sc1
    s_add_u32 s39, s39, 2736128
    v_cvt_pk_bf16_f32 v244, v35, v39
    v_cvt_pk_bf16_f32 v245, v43, v47
    v_cvt_pk_bf16_f32 v246, v51, v55
    v_cvt_pk_bf16_f32 v247, v59, v63
    buffer_store_dwordx4 v[244:247], v249, s[12:15], s39 offen sc1
    s_add_u32 s39, s39, 2736128
    v_mfma_f32_16x16x32_bf16 v[32:35], v[176:179], v[64:67], 0
    v_mfma_f32_16x16x32_bf16 v[36:39], v[176:179], v[68:71], 0
    v_mfma_f32_16x16x32_bf16 v[40:43], v[176:179], v[72:75], 0
    v_mfma_f32_16x16x32_bf16 v[44:47], v[176:179], v[76:79], 0
    v_mfma_f32_16x16x32_bf16 v[48:51], v[176:179], v[80:83], 0
    v_mfma_f32_16x16x32_bf16 v[52:55], v[176:179], v[84:87], 0
    v_mfma_f32_16x16x32_bf16 v[56:59], v[176:179], v[88:91], 0
    v_mfma_f32_16x16x32_bf16 v[60:63], v[176:179], v[92:95], 0
    v_mfma_f32_16x16x32_bf16 v[32:35], v[208:211], v[64:67], v[32:35]
    v_mfma_f32_16x16x32_bf16 v[36:39], v[208:211], v[68:71], v[36:39]
    v_mfma_f32_16x16x32_bf16 v[40:43], v[208:211], v[72:75], v[40:43]
    v_mfma_f32_16x16x32_bf16 v[44:47], v[208:211], v[76:79], v[44:47]
    v_mfma_f32_16x16x32_bf16 v[48:51], v[208:211], v[80:83], v[48:51]
    v_mfma_f32_16x16x32_bf16 v[52:55], v[208:211], v[84:87], v[52:55]
    v_mfma_f32_16x16x32_bf16 v[56:59], v[208:211], v[88:91], v[56:59]
    v_mfma_f32_16x16x32_bf16 v[60:63], v[208:211], v[92:95], v[60:63]
    v_mfma_f32_16x16x32_bf16 v[32:35], v[180:183], v[0:3], v[32:35]
    v_mfma_f32_16x16x32_bf16 v[36:39], v[180:183], v[4:7], v[36:39]
    v_mfma_f32_16x16x32_bf16 v[40:43], v[180:183], v[8:11], v[40:43]
    v_mfma_f32_16x16x32_bf16 v[44:47], v[180:183], v[12:15], v[44:47]
    v_mfma_f32_16x16x32_bf16 v[48:51], v[180:183], v[16:19], v[48:51]
    v_mfma_f32_16x16x32_bf16 v[52:55], v[180:183], v[20:23], v[52:55]
    v_mfma_f32_16x16x32_bf16 v[56:59], v[180:183], v[24:27], v[56:59]
    v_mfma_f32_16x16x32_bf16 v[60:63], v[180:183], v[28:31], v[60:63]
    v_mfma_f32_16x16x32_bf16 v[32:35], v[212:215], v[0:3], v[32:35]
    v_mfma_f32_16x16x32_bf16 v[36:39], v[212:215], v[4:7], v[36:39]
    v_mfma_f32_16x16x32_bf16 v[40:43], v[212:215], v[8:11], v[40:43]
    v_mfma_f32_16x16x32_bf16 v[44:47], v[212:215], v[12:15], v[44:47]
    v_mfma_f32_16x16x32_bf16 v[48:51], v[212:215], v[16:19], v[48:51]
    v_mfma_f32_16x16x32_bf16 v[52:55], v[212:215], v[20:23], v[52:55]
    v_mfma_f32_16x16x32_bf16 v[56:59], v[212:215], v[24:27], v[56:59]
    v_mfma_f32_16x16x32_bf16 v[60:63], v[212:215], v[28:31], v[60:63]
    s_nop 7
    v_cvt_pk_bf16_f32 v240, v32, v36
    v_cvt_pk_bf16_f32 v241, v40, v44
    v_cvt_pk_bf16_f32 v242, v48, v52
    v_cvt_pk_bf16_f32 v243, v56, v60
    buffer_store_dwordx4 v[240:243], v249, s[12:15], s39 offen sc1
    s_add_u32 s39, s39, 2736128
    v_cvt_pk_bf16_f32 v244, v33, v37
    v_cvt_pk_bf16_f32 v245, v41, v45
    v_cvt_pk_bf16_f32 v246, v49, v53
    v_cvt_pk_bf16_f32 v247, v57, v61
    buffer_store_dwordx4 v[244:247], v249, s[12:15], s39 offen sc1
    s_add_u32 s39, s39, 2736128
    v_cvt_pk_bf16_f32 v240, v34, v38
    v_cvt_pk_bf16_f32 v241, v42, v46
    v_cvt_pk_bf16_f32 v242, v50, v54
    v_cvt_pk_bf16_f32 v243, v58, v62
    buffer_store_dwordx4 v[240:243], v249, s[12:15], s39 offen sc1
    s_add_u32 s39, s39, 2736128
    v_cvt_pk_bf16_f32 v244, v35, v39
    v_cvt_pk_bf16_f32 v245, v43, v47
    v_cvt_pk_bf16_f32 v246, v51, v55
    v_cvt_pk_bf16_f32 v247, v59, v63
    buffer_store_dwordx4 v[244:247], v249, s[12:15], s39 offen sc1
    s_add_u32 s39, s39, 2736128
    v_mfma_f32_16x16x32_bf16 v[32:35], v[184:187], v[64:67], 0
    v_mfma_f32_16x16x32_bf16 v[36:39], v[184:187], v[68:71], 0
    v_mfma_f32_16x16x32_bf16 v[40:43], v[184:187], v[72:75], 0
    v_mfma_f32_16x16x32_bf16 v[44:47], v[184:187], v[76:79], 0
    v_mfma_f32_16x16x32_bf16 v[48:51], v[184:187], v[80:83], 0
    v_mfma_f32_16x16x32_bf16 v[52:55], v[184:187], v[84:87], 0
    v_mfma_f32_16x16x32_bf16 v[56:59], v[184:187], v[88:91], 0
    v_mfma_f32_16x16x32_bf16 v[60:63], v[184:187], v[92:95], 0
    v_mfma_f32_16x16x32_bf16 v[32:35], v[216:219], v[64:67], v[32:35]
    v_mfma_f32_16x16x32_bf16 v[36:39], v[216:219], v[68:71], v[36:39]
    v_mfma_f32_16x16x32_bf16 v[40:43], v[216:219], v[72:75], v[40:43]
    v_mfma_f32_16x16x32_bf16 v[44:47], v[216:219], v[76:79], v[44:47]
    v_mfma_f32_16x16x32_bf16 v[48:51], v[216:219], v[80:83], v[48:51]
    v_mfma_f32_16x16x32_bf16 v[52:55], v[216:219], v[84:87], v[52:55]
    v_mfma_f32_16x16x32_bf16 v[56:59], v[216:219], v[88:91], v[56:59]
    v_mfma_f32_16x16x32_bf16 v[60:63], v[216:219], v[92:95], v[60:63]
    v_mfma_f32_16x16x32_bf16 v[32:35], v[188:191], v[0:3], v[32:35]
    v_mfma_f32_16x16x32_bf16 v[36:39], v[188:191], v[4:7], v[36:39]
    v_mfma_f32_16x16x32_bf16 v[40:43], v[188:191], v[8:11], v[40:43]
    v_mfma_f32_16x16x32_bf16 v[44:47], v[188:191], v[12:15], v[44:47]
    v_mfma_f32_16x16x32_bf16 v[48:51], v[188:191], v[16:19], v[48:51]
    v_mfma_f32_16x16x32_bf16 v[52:55], v[188:191], v[20:23], v[52:55]
    v_mfma_f32_16x16x32_bf16 v[56:59], v[188:191], v[24:27], v[56:59]
    v_mfma_f32_16x16x32_bf16 v[60:63], v[188:191], v[28:31], v[60:63]
    v_mfma_f32_16x16x32_bf16 v[32:35], v[220:223], v[0:3], v[32:35]
    v_mfma_f32_16x16x32_bf16 v[36:39], v[220:223], v[4:7], v[36:39]
    v_mfma_f32_16x16x32_bf16 v[40:43], v[220:223], v[8:11], v[40:43]
    v_mfma_f32_16x16x32_bf16 v[44:47], v[220:223], v[12:15], v[44:47]
    v_mfma_f32_16x16x32_bf16 v[48:51], v[220:223], v[16:19], v[48:51]
    v_mfma_f32_16x16x32_bf16 v[52:55], v[220:223], v[20:23], v[52:55]
    v_mfma_f32_16x16x32_bf16 v[56:59], v[220:223], v[24:27], v[56:59]
    v_mfma_f32_16x16x32_bf16 v[60:63], v[220:223], v[28:31], v[60:63]
    s_nop 7
    v_cvt_pk_bf16_f32 v240, v32, v36
    v_cvt_pk_bf16_f32 v241, v40, v44
    v_cvt_pk_bf16_f32 v242, v48, v52
    v_cvt_pk_bf16_f32 v243, v56, v60
    buffer_store_dwordx4 v[240:243], v249, s[12:15], s39 offen sc1
    s_add_u32 s39, s39, 2736128
    v_cvt_pk_bf16_f32 v244, v33, v37
    v_cvt_pk_bf16_f32 v245, v41, v45
    v_cvt_pk_bf16_f32 v246, v49, v53
    v_cvt_pk_bf16_f32 v247, v57, v61
    buffer_store_dwordx4 v[244:247], v249, s[12:15], s39 offen sc1
    s_add_u32 s39, s39, 2736128
    v_cvt_pk_bf16_f32 v240, v34, v38
    v_cvt_pk_bf16_f32 v241, v42, v46
    v_cvt_pk_bf16_f32 v242, v50, v54
    v_cvt_pk_bf16_f32 v243, v58, v62
    buffer_store_dwordx4 v[240:243], v249, s[12:15], s39 offen sc1
    s_add_u32 s39, s39, 2736128
    v_cvt_pk_bf16_f32 v244, v35, v39
    v_cvt_pk_bf16_f32 v245, v43, v47
    v_cvt_pk_bf16_f32 v246, v51, v55
    v_cvt_pk_bf16_f32 v247, v59, v63
    buffer_store_dwordx4 v[244:247], v249, s[12:15], s39 offen sc1
    s_mov_b32 s41, s40
    s_add_u32 s40, s40, 1
    s_cmp_eq_u32 s41, 3
    s_cbranch_scc0 K12_ES5
    s_waitcnt vmcnt(0)
    s_mov_b32 s34, -1
    s_cmp_ge_u32 s41, 8
    s_cbranch_scc1 K12_SG6
    s_lshl_b32 s36, s41, 2
    s_add_u32 s37, s36, 155680
    s_mov_b64 exec, 1
    v_mov_b32 v255, s37
    v_mov_b32 v240, 1
    ds_add_rtn_u32 v240, v255, v240
    s_waitcnt lgkmcnt(0)
    v_readfirstlane_b32 s37, v240
    s_nop 3
    s_cmp_eq_u32 s37, 3
    s_cbranch_scc0 K12_SH6
    s_lshl_b32 s36, s36, 8
    v_mov_b32 v255, 1
    v_mov_b32 v240, s36
    buffer_atomic_add v255, v240, s[60:63], 0 offen sc0 sc1
    s_mov_b32 s34, s41
K12_SH6:
    s_mov_b64 exec, -1
K12_SG6:
    s_waitcnt vmcnt(0)
    s_cmp_ge_u32 s34, 8
    s_cbranch_scc1 K12_PB7
    v_readfirstlane_b32 s37, v255
    s_nop 3
    s_cmp_eq_u32 s37, 255
    s_cbranch_scc0 K12_PB7
    s_lshl_b32 s36, s34, 4
    s_add_u32 s36, s36, 16384
    s_mov_b64 exec, 1
    v_mov_b32 v255, 1
    v_mov_b32 v240, s36
    buffer_store_dword v255, v240, s[60:63], 0 offen sc1
    s_mov_b64 exec, -1
K12_PB7:
    s_mov_b32 s34, -1
    s_mov_b32 s41, -1
K12_ES5:
    s_waitcnt vmcnt(16)
    s_branch K12_XP_F
K12_XP_E:
    s_mov_b32 s41, s40
    s_add_u32 s40, s40, 1
    s_cmp_eq_u32 s41, 3
    s_cbranch_scc0 K12_ES8
    s_waitcnt vmcnt(0)
    s_mov_b32 s34, -1
    s_cmp_ge_u32 s41, 8
    s_cbranch_scc1 K12_SG9
    s_lshl_b32 s36, s41, 2
    s_add_u32 s37, s36, 155680
    s_mov_b64 exec, 1
    v_mov_b32 v255, s37
    v_mov_b32 v240, 1
    ds_add_rtn_u32 v240, v255, v240
    s_waitcnt lgkmcnt(0)
    v_readfirstlane_b32 s37, v240
    s_nop 3
    s_cmp_eq_u32 s37, 3
    s_cbranch_scc0 K12_SH9
    s_lshl_b32 s36, s36, 8
    v_mov_b32 v255, 1
    v_mov_b32 v240, s36
    buffer_atomic_add v255, v240, s[60:63], 0 offen sc0 sc1
    s_mov_b32 s34, s41
K12_SH9:
    s_mov_b64 exec, -1
K12_SG9:
    s_waitcnt vmcnt(0)
    s_cmp_ge_u32 s34, 8
    s_cbranch_scc1 K12_PB10
    v_readfirstlane_b32 s37, v255
    s_nop 3
    s_cmp_eq_u32 s37, 255
    s_cbranch_scc0 K12_PB10
    s_lshl_b32 s36, s34, 4
    s_add_u32 s36, s36, 16384
    s_mov_b64 exec, 1
    v_mov_b32 v255, 1
    v_mov_b32 v240, s36
    buffer_store_dword v255, v240, s[60:63], 0 offen sc1
    s_mov_b64 exec, -1
K12_PB10:
    s_mov_b32 s34, -1
    s_mov_b32 s41, -1
K12_ES8:
    s_waitcnt vmcnt(0)
K12_XP_F:
    s_cmp_ge_u32 s34, 8
    s_cbranch_scc1 K12_PB11
    v_readfirstlane_b32 s37, v255
    s_nop 3
    s_cmp_eq_u32 s37, 255
    s_cbranch_scc0 K12_PB11
    s_lshl_b32 s36, s34, 4
    s_add_u32 s36, s36, 16384
    s_mov_b64 exec, 1
    v_mov_b32 v255, 1
    v_mov_b32 v240, s36
    buffer_store_dword v255, v240, s[60:63], 0 offen sc1
    s_mov_b64 exec, -1
K12_PB11:
    s_cmp_ge_u32 s40, 8
    s_cbranch_scc1 K12_PFIN
K12_WENTRY:
    v_perm_b32 v64, v100, v96, s28
    v_perm_b32 v68, v100, v96, s29
    v_perm_b32 v65, v108, v104, s28
    v_perm_b32 v69, v108, v104, s29
    v_perm_b32 v66, v116, v112, s28
    v_perm_b32 v70, v116, v112, s29
    v_perm_b32 v67, v124, v120, s28
    v_perm_b32 v71, v124, v120, s29
    v_perm_b32 v72, v101, v97, s28
    v_perm_b32 v76, v101, v97, s29
    v_perm_b32 v73, v109, v105, s28
    v_perm_b32 v77, v109, v105, s29
    v_perm_b32 v74, v117, v113, s28
    v_perm_b32 v78, v117, v113, s29
    v_perm_b32 v75, v125, v121, s28
    v_perm_b32 v79, v125, v121, s29
    v_perm_b32 v80, v102, v98, s28
    v_perm_b32 v84, v102, v98, s29
    v_perm_b32 v81, v110, v106, s28
    v_perm_b32 v85, v110, v106, s29
    v_perm_b32 v82, v118, v114, s28
    v_perm_b32 v86, v118, v114, s29
    v_perm_b32 v83, v126, v122, s28
    v_perm_b32 v87, v126, v122, s29
    v_perm_b32 v88, v103, v99, s28
    v_perm_b32 v92, v103, v99, s29
    v_perm_b32 v89, v111, v107, s28
    v_perm_b32 v93, v111, v107, s29
    v_perm_b32 v90, v119, v115, s28
    v_perm_b32 v94, v119, v115, s29
    v_perm_b32 v91, v127, v123, s28
    v_perm_b32 v95, v127, v123, s29
    s_add_u32 s42, s40, 1
    s_mul_i32 s36, s42, 85
    s_add_u32 s36, s36, s2
    s_and_b32 s36, s36, 255
    s_mul_hi_u32 s37, s36, 0x55555556
    s_mul_i32 s38, s37, 3
    s_cmp_eq_u32 s38, s36
    s_cselect_b32 s27, 1, 0
    s_cmp_lt_u32 s37, 78
    s_cselect_b32 s27, s27, 0
    s_add_u32 s37, s37, 89
    s_cmp_eq_u32 s21, 0
    s_cselect_b32 s30, s24, s37
    s_cselect_b32 s27, 1, s27
    s_cmp_eq_u32 s27, 0
    s_cbranch_scc1 K12_WP_N
    s_lshl_b32 s36, s42, 8
    s_mul_i32 s37, s30, 98304
    s_add_u32 s36, s36, s37
    buffer_load_dwordx4 v[0:3], v248, s[4:7], s36 offen
    buffer_load_dwordx4 v[4:7], v248, s[4:7], s36 offen offset:2048
    s_add_u32 s36, s36, 4096
    buffer_load_dwordx4 v[8:11], v248, s[4:7], s36 offen
    buffer_load_dwordx4 v[12:15], v248, s[4:7], s36 offen offset:2048
    s_add_u32 s36, s36, 4096
    buffer_load_dwordx4 v[16:19], v248, s[4:7], s36 offen
    buffer_load_dwordx4 v[20:23], v248, s[4:7], s36 offen offset:2048
    s_add_u32 s36, s36, 4096
    buffer_load_dwordx4 v[24:27], v248, s[4:7], s36 offen
    buffer_load_dwordx4 v[28:31], v248, s[4:7], s36 offen offset:2048
    s_add_u32 s36, s36, 53248
    buffer_load_dwordx4 v[32:35], v248, s[4:7], s36 offen
    buffer_load_dwordx4 v[36:39], v248, s[4:7], s36 offen offset:2048
    s_add_u32 s36, s36, 4096
    buffer_load_dwordx4 v[40:43], v248, s[4:7], s36 offen
    buffer_load_dwordx4 v[44:47], v248, s[4:7], s36 offen offset:2048
    s_add_u32 s36, s36, 4096
    buffer_load_dwordx4 v[48:51], v248, s[4:7], s36 offen
    buffer_load_dwordx4 v[52:55], v248, s[4:7], s36 offen offset:2048
    s_add_u32 s36, s36, 4096
    buffer_load_dwordx4 v[56:59], v248, s[4:7], s36 offen
    buffer_load_dwordx4 v[60:63], v248, s[4:7], s36 offen offset:2048
    s_waitcnt vmcnt(16)
    s_branch K12_WP_M
K12_WP_N:
    s_waitcnt vmcnt(0)
K12_WP_M:
    s_mov_b32 s34, -1
    s_cmp_ge_u32 s41, 8
    s_cbranch_scc1 K12_SG12
    s_lshl_b32 s36, s41, 2
    s_add_u32 s37, s36, 155680
    s_mov_b64 exec, 1
    v_mov_b32 v255, s37
    v_mov_b32 v240, 1
    ds_add_rtn_u32 v240, v255, v240
    s_waitcnt lgkmcnt(0)
    v_readfirstlane_b32 s37, v240
    s_nop 3
    s_cmp_eq_u32 s37, 3
    s_cbranch_scc0 K12_SH12
    s_lshl_b32 s36, s36, 8
    v_mov_b32 v255, 1
    v_mov_b32 v240, s36
    buffer_atomic_add v255, v240, s[60:63], 0 offen sc0 sc1
    s_mov_b32 s34, s41
K12_SH12:
    s_mov_b64 exec, -1
K12_SG12:
    s_cmp_ge_u32 s34, 8
    s_cbranch_scc1 K12_EP13
    s_waitcnt vmcnt(0)
    s_cmp_ge_u32 s34, 8
    s_cbranch_scc1 K12_PB14
    v_readfirstlane_b32 s37, v255
    s_nop 3
    s_cmp_eq_u32 s37, 255
    s_cbranch_scc0 K12_PB14
    s_lshl_b32 s36, s34, 4
    s_add_u32 s36, s36, 16384
    s_mov_b64 exec, 1
    v_mov_b32 v255, 1
    v_mov_b32 v240, s36
    buffer_store_dword v255, v240, s[60:63], 0 offen sc1
    s_mov_b64 exec, -1
K12_PB14:
    s_mov_b32 s34, -1
K12_EP13:
    s_lshl_b32 s36, s40, 3
    s_sub_i32 s36, s36, 28
    s_max_i32 s36, s36, 1
    s_mov_b32 s38, 155648
    s_cmp_eq_u32 s40, 99
    s_cselect_b32 s36, 4, s36
    s_cselect_b32 s38, 155664, s38
    s_cbranch_scc1 K12_GS1
    s_cmp_lt_u32 s40, 3
    s_cbranch_scc1 K12_GT1
K12_GS1:
    s_mov_b32 s37, 32768
K12_GL1:
    v_mov_b32 v240, s38
    ds_read_b32 v240, v240
    s_waitcnt lgkmcnt(0)
    v_cmp_gt_u32 vcc, s36, v240
    s_sub_u32 s37, s37, 1
    s_cmp_eq_u32 s37, 0
    s_cbranch_scc1 K12_GT1
    s_cbranch_vccz K12_GT1
    s_sleep 2
    s_branch K12_GL1
K12_GT1:
    s_lshl_b32 s36, s40, 7
    s_add_u32 s36, s36, s22
    s_and_b32 s37, s36, 3
    s_lshr_b32 s38, s36, 1
    s_and_b32 s38, s38, 4
    s_or_b32 s37, s37, s38
    v_bfe_u32 v253, v254, 5, 3
    v_xor_b32 v253, s37, v253
    v_lshl_add_u32 v253, v253, 5, v251
    s_lshl_b32 s36, s36, 9
    s_add_u32 s39, s36, s32
    v_mfma_f32_16x16x32_bf16 v[128:131], v[224:227], v[64:67], 0
    v_mfma_f32_16x16x32_bf16 v[132:135], v[224:227], v[68:71], 0
    v_mfma_f32_16x16x32_bf16 v[136:139], v[224:227], v[72:75], 0
    v_mfma_f32_16x16x32_bf16 v[140:143], v[224:227], v[76:79], 0
    v_mfma_f32_16x16x32_bf16 v[144:147], v[224:227], v[80:83], 0
    v_mfma_f32_16x16x32_bf16 v[148:151], v[224:227], v[84:87], 0
    v_mfma_f32_16x16x32_bf16 v[152:155], v[224:227], v[88:91], 0
    v_mfma_f32_16x16x32_bf16 v[156:159], v[224:227], v[92:95], 0
    s_nop 7
    v_cvt_pk_bf16_f32 v240, v128, v132
    v_cvt_pk_bf16_f32 v241, v136, v140
    v_cvt_pk_bf16_f32 v242, v144, v148
    v_cvt_pk_bf16_f32 v243, v152, v156
    buffer_store_dwordx4 v[240:243], v253, s[16:19], s39 offen sc1
    s_add_u32 s39, s39, 4194304
    v_cvt_pk_bf16_f32 v244, v129, v133
    v_cvt_pk_bf16_f32 v245, v137, v141
    v_cvt_pk_bf16_f32 v246, v145, v149
    v_cvt_pk_bf16_f32 v247, v153, v157
    buffer_store_dwordx4 v[244:247], v253, s[16:19], s39 offen sc1
    s_add_u32 s39, s39, 4194304
    v_cvt_pk_bf16_f32 v240, v130, v134
    v_cvt_pk_bf16_f32 v241, v138, v142
    v_cvt_pk_bf16_f32 v242, v146, v150
    v_cvt_pk_bf16_f32 v243, v154, v158
    buffer_store_dwordx4 v[240:243], v253, s[16:19], s39 offen sc1
    s_add_u32 s39, s39, 4194304
    v_cvt_pk_bf16_f32 v244, v131, v135
    v_cvt_pk_bf16_f32 v245, v139, v143
    v_cvt_pk_bf16_f32 v246, v147, v151
    v_cvt_pk_bf16_f32 v247, v155, v159
    buffer_store_dwordx4 v[244:247], v253, s[16:19], s39 offen sc1
    s_add_u32 s39, s39, 4194304
    v_mfma_f32_16x16x32_bf16 v[128:131], v[228:231], v[64:67], 0
    v_mfma_f32_16x16x32_bf16 v[132:135], v[228:231], v[68:71], 0
    v_mfma_f32_16x16x32_bf16 v[136:139], v[228:231], v[72:75], 0
    v_mfma_f32_16x16x32_bf16 v[140:143], v[228:231], v[76:79], 0
    v_mfma_f32_16x16x32_bf16 v[144:147], v[228:231], v[80:83], 0
    v_mfma_f32_16x16x32_bf16 v[148:151], v[228:231], v[84:87], 0
    v_mfma_f32_16x16x32_bf16 v[152:155], v[228:231], v[88:91], 0
    v_mfma_f32_16x16x32_bf16 v[156:159], v[228:231], v[92:95], 0
    s_nop 7
    v_cvt_pk_bf16_f32 v240, v128, v132
    v_cvt_pk_bf16_f32 v241, v136, v140
    v_cvt_pk_bf16_f32 v242, v144, v148
    v_cvt_pk_bf16_f32 v243, v152, v156
    buffer_store_dwordx4 v[240:243], v253, s[16:19], s39 offen sc1
    s_add_u32 s39, s39, 4194304
    v_cvt_pk_bf16_f32 v244, v129, v133
    v_cvt_pk_bf16_f32 v245, v137, v141
    v_cvt_pk_bf16_f32 v246, v145, v149
    v_cvt_pk_bf16_f32 v247, v153, v157
    buffer_store_dwordx4 v[244:247], v253, s[16:19], s39 offen sc1
    s_add_u32 s39, s39, 4194304
    v_cvt_pk_bf16_f32 v240, v130, v134
    v_cvt_pk_bf16_f32 v241, v138, v142
    v_cvt_pk_bf16_f32 v242, v146, v150
    v_cvt_pk_bf16_f32 v243, v154, v158
    buffer_store_dwordx4 v[240:243], v253, s[16:19], s39 offen sc1
    s_add_u32 s39, s39, 4194304
    v_cvt_pk_bf16_f32 v244, v131, v135
    v_cvt_pk_bf16_f32 v245, v139, v143
    v_cvt_pk_bf16_f32 v246, v147, v151
    v_cvt_pk_bf16_f32 v247, v155, v159
    buffer_store_dwordx4 v[244:247], v253, s[16:19], s39 offen sc1
    s_add_u32 s39, s39, 4194304
    v_mfma_f32_16x16x32_bf16 v[128:131], v[232:235], v[64:67], 0
    v_mfma_f32_16x16x32_bf16 v[132:135], v[232:235], v[68:71], 0
    v_mfma_f32_16x16x32_bf16 v[136:139], v[232:235], v[72:75], 0
    v_mfma_f32_16x16x32_bf16 v[140:143], v[232:235], v[76:79], 0
    v_mfma_f32_16x16x32_bf16 v[144:147], v[232:235], v[80:83], 0
    v_mfma_f32_16x16x32_bf16 v[148:151], v[232:235], v[84:87], 0
    v_mfma_f32_16x16x32_bf16 v[152:155], v[232:235], v[88:91], 0
    v_mfma_f32_16x16x32_bf16 v[156:159], v[232:235], v[92:95], 0
    s_nop 7
    v_cvt_pk_bf16_f32 v240, v128, v132
    v_cvt_pk_bf16_f32 v241, v136, v140
    v_cvt_pk_bf16_f32 v242, v144, v148
    v_cvt_pk_bf16_f32 v243, v152, v156
    buffer_store_dwordx4 v[240:243], v253, s[16:19], s39 offen sc1
    s_add_u32 s39, s39, 4194304
    v_cvt_pk_bf16_f32 v244, v129, v133
    v_cvt_pk_bf16_f32 v245, v137, v141
    v_cvt_pk_bf16_f32 v246, v145, v149
    v_cvt_pk_bf16_f32 v247, v153, v157
    buffer_store_dwordx4 v[244:247], v253, s[16:19], s39 offen sc1
    s_add_u32 s39, s39, 4194304
    v_cvt_pk_bf16_f32 v240, v130, v134
    v_cvt_pk_bf16_f32 v241, v138, v142
    v_cvt_pk_bf16_f32 v242, v146, v150
    v_cvt_pk_bf16_f32 v243, v154, v158
    buffer_store_dwordx4 v[240:243], v253, s[16:19], s39 offen sc1
    s_add_u32 s39, s39, 4194304
    v_cvt_pk_bf16_f32 v244, v131, v135
    v_cvt_pk_bf16_f32 v245, v139, v143
    v_cvt_pk_bf16_f32 v246, v147, v151
    v_cvt_pk_bf16_f32 v247, v155, v159
    buffer_store_dwordx4 v[244:247], v253, s[16:19], s39 offen sc1
    s_add_u32 s39, s39, 4194304
    v_mfma_f32_16x16x32_bf16 v[128:131], v[236:239], v[64:67], 0
    v_mfma_f32_16x16x32_bf16 v[132:135], v[236:239], v[68:71], 0
    v_mfma_f32_16x16x32_bf16 v[136:139], v[236:239], v[72:75], 0
    v_mfma_f32_16x16x32_bf16 v[140:143], v[236:239], v[76:79], 0
    v_mfma_f32_16x16x32_bf16 v[144:147], v[236:239], v[80:83], 0
    v_mfma_f32_16x16x32_bf16 v[148:151], v[236:239], v[84:87], 0
    v_mfma_f32_16x16x32_bf16 v[152:155], v[236:239], v[88:91], 0
    v_mfma_f32_16x16x32_bf16 v[156:159], v[236:239], v[92:95], 0
    s_nop 7
    v_cvt_pk_bf16_f32 v240, v128, v132
    v_cvt_pk_bf16_f32 v241, v136, v140
    v_cvt_pk_bf16_f32 v242, v144, v148
    v_cvt_pk_bf16_f32 v243, v152, v156
    buffer_store_dwordx4 v[240:243], v253, s[16:19], s39 offen sc1
    s_add_u32 s39, s39, 4194304
    v_cvt_pk_bf16_f32 v244, v129, v133
    v_cvt_pk_bf16_f32 v245, v137, v141
    v_cvt_pk_bf16_f32 v246, v145, v149
    v_cvt_pk_bf16_f32 v247, v153, v157
    buffer_store_dwordx4 v[244:247], v253, s[16:19], s39 offen sc1
    s_add_u32 s39, s39, 4194304
    v_cvt_pk_bf16_f32 v240, v130, v134
    v_cvt_pk_bf16_f32 v241, v138, v142
    v_cvt_pk_bf16_f32 v242, v146, v150
    v_cvt_pk_bf16_f32 v243, v154, v158
    buffer_store_dwordx4 v[240:243], v253, s[16:19], s39 offen sc1
    s_add_u32 s39, s39, 4194304
    v_cvt_pk_bf16_f32 v244, v131, v135
    v_cvt_pk_bf16_f32 v245, v139, v143
    v_cvt_pk_bf16_f32 v246, v147, v151
    v_cvt_pk_bf16_f32 v247, v155, v159
    buffer_store_dwordx4 v[244:247], v253, s[16:19], s39 offen sc1
    s_mov_b32 s41, s40
    s_add_u32 s40, s40, 1
    s_cmp_eq_u32 s41, 3
    s_cbranch_scc0 K12_ES15
    s_waitcnt vmcnt(0)
    s_mov_b32 s34, -1
    s_cmp_ge_u32 s41, 8
    s_cbranch_scc1 K12_SG16
    s_lshl_b32 s36, s41, 2
    s_add_u32 s37, s36, 155680
    s_mov_b64 exec, 1
    v_mov_b32 v255, s37
    v_mov_b32 v240, 1
    ds_add_rtn_u32 v240, v255, v240
    s_waitcnt lgkmcnt(0)
    v_readfirstlane_b32 s37, v240
    s_nop 3
    s_cmp_eq_u32 s37, 3
    s_cbranch_scc0 K12_SH16
    s_lshl_b32 s36, s36, 8
    v_mov_b32 v255, 1
    v_mov_b32 v240, s36
    buffer_atomic_add v255, v240, s[60:63], 0 offen sc0 sc1
    s_mov_b32 s34, s41
K12_SH16:
    s_mov_b64 exec, -1
K12_SG16:
    s_waitcnt vmcnt(0)
    s_cmp_ge_u32 s34, 8
    s_cbranch_scc1 K12_PB17
    v_readfirstlane_b32 s37, v255
    s_nop 3
    s_cmp_eq_u32 s37, 255
    s_cbranch_scc0 K12_PB17
    s_lshl_b32 s36, s34, 4
    s_add_u32 s36, s36, 16384
    s_mov_b64 exec, 1
    v_mov_b32 v255, 1
    v_mov_b32 v240, s36
    buffer_store_dword v255, v240, s[60:63], 0 offen sc1
    s_mov_b64 exec, -1
K12_PB17:
    s_mov_b32 s34, -1
    s_mov_b32 s41, -1
K12_ES15:
    s_waitcnt vmcnt(16)
    s_cmp_ge_u32 s34, 8
    s_cbranch_scc1 K12_PB18
    v_readfirstlane_b32 s37, v255
    s_nop 3
    s_cmp_eq_u32 s37, 255
    s_cbranch_scc0 K12_PB18
    s_lshl_b32 s36, s34, 4
    s_add_u32 s36, s36, 16384
    s_mov_b64 exec, 1
    v_mov_b32 v255, 1
    v_mov_b32 v240, s36
    buffer_store_dword v255, v240, s[60:63], 0 offen sc1
    s_mov_b64 exec, -1
K12_PB18:
    s_cmp_lt_u32 s40, 8
    s_cbranch_scc1 K12_XW
K12_PFIN:
    s_waitcnt vmcnt(0)
    s_mov_b32 s34, -1
    s_cmp_ge_u32 s41, 8
    s_cbranch_scc1 K12_SG19
    s_lshl_b32 s36, s41, 2
    s_add_u32 s37, s36, 155680
    s_mov_b64 exec, 1
    v_mov_b32 v255, s37
    v_mov_b32 v240, 1
    ds_add_rtn_u32 v240, v255, v240
    s_waitcnt lgkmcnt(0)
    v_readfirstlane_b32 s37, v240
    s_nop 3
    s_cmp_eq_u32 s37, 3
    s_cbranch_scc0 K12_SH19
    s_lshl_b32 s36, s36, 8
    v_mov_b32 v255, 1
    v_mov_b32 v240, s36
    buffer_atomic_add v255, v240, s[60:63], 0 offen sc0 sc1
    s_mov_b32 s34, s41
K12_SH19:
    s_mov_b64 exec, -1
K12_SG19:
    s_waitcnt vmcnt(0)
    s_cmp_ge_u32 s34, 8
    s_cbranch_scc1 K12_PB20
    v_readfirstlane_b32 s37, v255
    s_nop 3
    s_cmp_eq_u32 s37, 255
    s_cbranch_scc0 K12_PB20
    s_lshl_b32 s36, s34, 4
    s_add_u32 s36, s36, 16384
    s_mov_b64 exec, 1
    v_mov_b32 v255, 1
    v_mov_b32 v240, s36
    buffer_store_dword v255, v240, s[60:63], 0 offen sc1
    s_mov_b64 exec, -1
K12_PB20:
    s_endpgm
K12_CONS:
    s_and_b32 s6, s2, 7
    s_lshl_b32 s6, s6, 2
    s_lshr_b32 s7, s2, 6
    s_add_u32 s6, s6, s7
    s_lshr_b32 s7, s2, 3
    s_and_b32 s7, s7, 7
    s_lshr_b32 s20, s7, 2
    s_and_b32 s21, s7, 3
    s_lshl_b32 s22, s6, 1
    s_add_u32 s22, s22, s20
    s_lshl_b32 s23, s6, 2
    s_add_u32 s23, s23, s21
    s_mul_i32 s24, s22, 684032
    s_mul_i32 s25, s23, 524288
    s_add_u32 s25, s25, 50331648
    s_mul_i32 s26, s22, 342016
    s_add_u32 s26, s26, 118489088
    s_add_u32 s8, s58, s24
    s_addc_u32 s9, s59, 0
    s_and_b32 s9, s9, 0xffff
    s_mov_b32 s10, 684032
    s_mov_b32 s11, 0x00020000
    s_add_u32 s12, s58, s25
    s_addc_u32 s13, s59, 0
    s_and_b32 s13, s13, 0xffff
    s_mov_b32 s14, 524288
    s_mov_b32 s15, 0x00020000
    s_add_u32 s16, s58, s26
    s_addc_u32 s17, s59, 0
    s_and_b32 s17, s17, 0xffff
    s_mov_b32 s18, 342016
    s_mov_b32 s19, 0x00020000
    s_add_u32 s4, s58, 153108480
    s_addc_u32 s5, s59, 0
    s_and_b32 s5, s5, 0xffff
    s_cmp_eq_u32 s3, 0
    s_cselect_b32 s6, 128, 0
    s_mov_b32 s7, 0x00020000
    s_mov_b32 s46, 155712
    s_cselect_b32 s46, s46, 155776
    s_mov_b32 s47, 155712
    s_cselect_b32 s47, s47, 155744
    s_cselect_b32 s45, 4, 0
    s_mov_b32 s50, s45
    v_and_b32 v8, 15, v2
    v_lshrrev_b32 v9, 4, v2
    v_lshlrev_b32 v1, 4, v2
    s_mul_i32 s30, s3, 5120
    s_mov_b32 s36, s30
    s_lshl_b32 s31, s3, 12
    s_add_u32 s37, s31, 22528
    s_lshl_b32 s33, s3, 8
    s_add_u32 s33, s33, 20480
    s_mov_b32 s38, s33
    s_mov_b32 s44, 0xffff
    s_cmp_eq_u32 s3, 3
    s_cselect_b32 s44, 0xff, s44
    s_mov_b32 s45, 0
    v_lshrrev_b32 v10, 1, v8
    v_xor_b32 v10, v10, v9
    v_lshlrev_b32 v10, 4, v10
    v_lshl_add_u32 v2, v8, 7, v10
    v_xor_b32 v3, 64, v2
    v_lshrrev_b32 v10, 2, v8
    v_lshl_add_u32 v11, v9, 3, v10
    v_lshlrev_b32 v11, 9, v11
    v_and_b32 v12, 1, v9
    v_lshl_or_b32 v10, v12, 2, v10
    s_lshl_b32 s28, s3, 1
    v_xor_b32 v10, s28, v10
    v_lshl_add_u32 v11, v10, 5, v11
    v_and_b32 v10, 3, v8
    v_lshl_add_u32 v11, v10, 3, v11
    v_add_u32 v4, 22528, v11
    v_and_b32 v10, 3, v8
    v_lshlrev_b32 v10, 2, v10
    v_add_u32 v5, 155648, v10
    s_lshl_b32 s28, s3, 2
    s_add_u32 s28, s28, 155648
    v_mov_b32 v7, s28
    s_mov_b32 s35, 0x80008000
    s_mov_b32 s62, 0
    s_mov_b32 s63, 0
    s_mov_b32 s39, 0
    s_add_u32 m0, s39, s36
    s_nop 0
    buffer_load_dwordx4 v1, s[8:11], s30 offen sc1 lds
    buffer_load_dwordx4 v1, s[8:11], s30 offen offset:1024 sc1 lds
    buffer_load_dwordx4 v1, s[8:11], s30 offen offset:2048 sc1 lds
    buffer_load_dwordx4 v1, s[8:11], s30 offen offset:3072 sc1 lds
    s_add_u32 m0, m0, 4096
    s_add_u32 s34, s30, 4096
    buffer_load_dwordx4 v1, s[8:11], s34 offen sc1 lds
    s_add_u32 m0, s39, s37
    s_add_u32 s30, s30, 21376
    buffer_load_dwordx4 v1, s[12:15], s31 offen sc1 lds
    buffer_load_dwordx4 v1, s[12:15], s31 offen offset:1024 sc1 lds
    buffer_load_dwordx4 v1, s[12:15], s31 offen offset:2048 sc1 lds
    buffer_load_dwordx4 v1, s[12:15], s31 offen offset:3072 sc1 lds
    s_add_u32 m0, s39, s38
    s_mov_b64 exec, s[44:45]
    buffer_load_dwordx4 v1, s[8:11], s33 offen sc1 lds
    s_mov_b64 exec, -1
    s_add_u32 s31, s31, 16384
    s_add_u32 s33, s33, 21376
    s_add_u32 s39, s39, 38912
    s_add_u32 m0, s39, s36
    s_nop 0
    buffer_load_dwordx4 v1, s[8:11], s30 offen sc1 lds
    buffer_load_dwordx4 v1, s[8:11], s30 offen offset:1024 sc1 lds
    buffer_load_dwordx4 v1, s[8:11], s30 offen offset:2048 sc1 lds
    buffer_load_dwordx4 v1, s[8:11], s30 offen offset:3072 sc1 lds
    s_add_u32 m0, m0, 4096
    s_add_u32 s34, s30, 4096
    buffer_load_dwordx4 v1, s[8:11], s34 offen sc1 lds
    s_add_u32 m0, s39, s37
    s_add_u32 s30, s30, 21376
    buffer_load_dwordx4 v1, s[12:15], s31 offen sc1 lds
    buffer_load_dwordx4 v1, s[12:15], s31 offen offset:1024 sc1 lds
    buffer_load_dwordx4 v1, s[12:15], s31 offen offset:2048 sc1 lds
    buffer_load_dwordx4 v1, s[12:15], s31 offen offset:3072 sc1 lds
    s_add_u32 m0, s39, s38
    s_mov_b64 exec, s[44:45]
    buffer_load_dwordx4 v1, s[8:11], s33 offen sc1 lds
    s_mov_b64 exec, -1
    s_add_u32 s31, s31, 16384
    s_add_u32 s33, s33, 21376
    s_add_u32 s39, s39, 38912
    s_add_u32 m0, s39, s36
    s_nop 0
    buffer_load_dwordx4 v1, s[8:11], s30 offen sc1 lds
    buffer_load_dwordx4 v1, s[8:11], s30 offen offset:1024 sc1 lds
    buffer_load_dwordx4 v1, s[8:11], s30 offen offset:2048 sc1 lds
    buffer_load_dwordx4 v1, s[8:11], s30 offen offset:3072 sc1 lds
    s_add_u32 m0, m0, 4096
    s_add_u32 s34, s30, 4096
    buffer_load_dwordx4 v1, s[8:11], s34 offen sc1 lds
    s_add_u32 m0, s39, s37
    s_add_u32 s30, s30, 21376
    buffer_load_dwordx4 v1, s[12:15], s31 offen sc1 lds
    buffer_load_dwordx4 v1, s[12:15], s31 offen offset:1024 sc1 lds
    buffer_load_dwordx4 v1, s[12:15], s31 offen offset:2048 sc1 lds
    buffer_load_dwordx4 v1, s[12:15], s31 offen offset:3072 sc1 lds
    s_add_u32 m0, s39, s38
    s_mov_b64 exec, s[44:45]
    buffer_load_dwordx4 v1, s[8:11], s33 offen sc1 lds
    s_mov_b64 exec, -1
    s_add_u32 s31, s31, 16384
    s_add_u32 s33, s33, 21376
    s_add_u32 s39, s39, 38912
    s_mov_b32 m0, s46
    s_mov_b64 exec, 0xff
    buffer_load_dword v1, s[4:7], 0 offen sc1 lds
    s_mov_b64 exec, -1
    v_lshrrev_b32 v9, 4, v1
    v_and_b32 v8, 15, v9
    v_lshrrev_b32 v9, 4, v9
    v_and_b32 v10, 3, v8
    v_lshlrev_b32 v10, 2, v10
    v_lshrrev_b32 v12, 3, v8
    v_lshl_add_u32 v10, v12, 1, v10
    s_lshl_b32 s28, s3, 4
    s_add_u32 s28, s28, 1
    v_add_u32 v10, s28, v10
    v_bfe_u32 v11, v8, 2, 1
    v_and_b32 v13, 1, v9
    v_lshlrev_b32 v13, 3, v13
    v_mul_u32_u24 v14, 96, v11
    v_mad_u32_u24 v15, v10, v13, v14
    v_mad_u32_u24 v16, v10, 0, v15
    v_mad_u32_u24 v17, v10, 1, v15
    v_mad_u32_u24 v18, v10, 2, v15
    v_mad_u32_u24 v19, v10, 3, v15
    v_mad_u32_u24 v20, v10, 4, v15
    v_mad_u32_u24 v21, v10, 5, v15
    v_mad_u32_u24 v22, v10, 6, v15
    v_mad_u32_u24 v23, v10, 7, v15
    v_and_b32 v16, 127, v16
    v_and_b32 v17, 127, v17
    v_and_b32 v18, 127, v18
    v_and_b32 v19, 127, v19
    v_and_b32 v20, 127, v20
    v_and_b32 v21, 127, v21
    v_and_b32 v22, 127, v22
    v_and_b32 v23, 127, v23
    v_cvt_f32_u32 v16, v16
    v_cvt_f32_u32 v17, v17
    v_cvt_f32_u32 v18, v18
    v_cvt_f32_u32 v19, v19
    v_cvt_f32_u32 v20, v20
    v_cvt_f32_u32 v21, v21
    v_cvt_f32_u32 v22, v22
    v_cvt_f32_u32 v23, v23
    v_mul_f32 v16, 0x3c000000, v16
    v_mul_f32 v17, 0x3c000000, v17
    v_mul_f32 v18, 0x3c000000, v18
    v_mul_f32 v19, 0x3c000000, v19
    v_mul_f32 v20, 0x3c000000, v20
    v_mul_f32 v21, 0x3c000000, v21
    v_mul_f32 v22, 0x3c000000, v22
    v_mul_f32 v23, 0x3c000000, v23
    v_cos_f32 v16, v16
    v_cos_f32 v17, v17
    v_cos_f32 v18, v18
    v_cos_f32 v19, v19
    v_cos_f32 v20, v20
    v_cos_f32 v21, v21
    v_cos_f32 v22, v22
    v_cos_f32 v23, v23
    s_nop 0
    v_cvt_pk_bf16_f32 v24, v16, v17
    v_cvt_pk_bf16_f32 v25, v18, v19
    v_cvt_pk_bf16_f32 v26, v20, v21
    v_cvt_pk_bf16_f32 v27, v22, v23
    v_lshlrev_b32 v32, 16, v24
    v_and_b32 v33, 0xffff0000, v24
    v_sub_f32 v16, v16, v32
    v_sub_f32 v17, v17, v33
    v_lshlrev_b32 v32, 16, v25
    v_and_b32 v33, 0xffff0000, v25
    v_sub_f32 v18, v18, v32
    v_sub_f32 v19, v19, v33
    v_lshlrev_b32 v32, 16, v26
    v_and_b32 v33, 0xffff0000, v26
    v_sub_f32 v20, v20, v32
    v_sub_f32 v21, v21, v33
    v_lshlrev_b32 v32, 16, v27
    v_and_b32 v33, 0xffff0000, v27
    v_sub_f32 v22, v22, v32
    v_sub_f32 v23, v23, v33
    v_cvt_pk_bf16_f32 v28, v16, v17
    v_cvt_pk_bf16_f32 v29, v18, v19
    v_cvt_pk_bf16_f32 v30, v20, v21
    v_cvt_pk_bf16_f32 v31, v22, v23
    v_cmp_lt_u32 vcc, 1, v9
    s_lshl_b32 s28, s3, 10
    s_add_u32 s28, s28, 133120
    v_add_u32 v14, s28, v1
    v_cndmask_b32 v24, v24, v28, vcc
    v_cndmask_b32 v25, v25, v29, vcc
    v_cndmask_b32 v26, v26, v30, vcc
    v_cndmask_b32 v27, v27, v31, vcc
    ds_write_b128 v14, v[24:27]
    v_mov_b32 v12, 0
    v_mov_b32 v13, 0
    v_mov_b32 v14, 0
    v_mov_b32 v15, 0
    s_mul_i32 s28, s3, 38912
    s_add_u32 s28, s28, 21376
    v_add_u32 v16, s28, v1
    ds_write_b128 v16, v[12:15]
    s_mov_b64 exec, 0xff
    ds_write_b128 v16, v[12:15] offset:1024
    s_mov_b64 exec, -1
    s_lshl_b32 s28, s3, 2
    s_add_u32 s28, s28, 155648
    v_mov_b32 v16, s28
    ds_write_b32 v16, v12
    s_lshl_b32 s28, s3, 3
    s_add_u32 s28, s28, 155680
    v_mov_b32 v16, s28
    ds_write_b64 v16, v[12:13]
    s_lshl_b32 s28, s3, 3
    s_add_u32 s28, s28, 155712
    v_mov_b32 v16, s28
    ds_write_b64 v16, v[12:13]
    v_mov_b32 v16, 155664
    ds_write_b32 v16, v12
    v_mov_b32 v16, 155744
    v_mov_b32 v17, 1
    ds_write_b32 v16, v17
    s_waitcnt lgkmcnt(0)
    s_barrier
    v_mov_b32 v80, 0
    v_mov_b32 v81, 0
    v_mov_b32 v82, 0
    v_mov_b32 v83, 0
    v_mov_b32 v84, 0
    v_mov_b32 v85, 0
    v_mov_b32 v86, 0
    v_mov_b32 v87, 0
    v_mov_b32 v88, 0
    v_mov_b32 v89, 0
    v_mov_b32 v90, 0
    v_mov_b32 v91, 0
    v_mov_b32 v92, 0
    v_mov_b32 v93, 0
    v_mov_b32 v94, 0
    v_mov_b32 v95, 0
    v_mov_b32 v96, 0
    v_mov_b32 v97, 0
    v_mov_b32 v98, 0
    v_mov_b32 v99, 0
    v_mov_b32 v100, 0
    v_mov_b32 v101, 0
    v_mov_b32 v102, 0
    v_mov_b32 v103, 0
    v_mov_b32 v104, 0
    v_mov_b32 v105, 0
    v_mov_b32 v106, 0
    v_mov_b32 v107, 0
    v_mov_b32 v108, 0
    v_mov_b32 v109, 0
    v_mov_b32 v110, 0
    v_mov_b32 v111, 0
    v_mov_b32 v112, 0
    v_mov_b32 v113, 0
    v_mov_b32 v114, 0
    v_mov_b32 v115, 0
    v_mov_b32 v116, 0
    v_mov_b32 v117, 0
    v_mov_b32 v118, 0
    v_mov_b32 v119, 0
    v_mov_b32 v120, 0
    v_mov_b32 v121, 0
    v_mov_b32 v122, 0
    v_mov_b32 v123, 0
    v_mov_b32 v124, 0
    v_mov_b32 v125, 0
    v_mov_b32 v126, 0
    v_mov_b32 v127, 0
    v_mov_b32 v128, 0
    v_mov_b32 v129, 0
    v_mov_b32 v130, 0
    v_mov_b32 v131, 0
    v_mov_b32 v132, 0
    v_mov_b32 v133, 0
    v_mov_b32 v134, 0
    v_mov_b32 v135, 0
    v_mov_b32 v136, 0
    v_mov_b32 v137, 0
    v_mov_b32 v138, 0
    v_mov_b32 v139, 0
    v_mov_b32 v140, 0
    v_mov_b32 v141, 0
    v_mov_b32 v142, 0
    v_mov_b32 v143, 0
    v_mov_b32 v144, 0
    v_mov_b32 v145, 0
    v_mov_b32 v146, 0
    v_mov_b32 v147, 0
    v_mov_b32 v148, 0
    v_mov_b32 v149, 0
    v_mov_b32 v150, 0
    v_mov_b32 v151, 0
    v_mov_b32 v152, 0
    v_mov_b32 v153, 0
    v_mov_b32 v154, 0
    v_mov_b32 v155, 0
    v_mov_b32 v156, 0
    v_mov_b32 v157, 0
    v_mov_b32 v158, 0
    v_mov_b32 v159, 0
    v_mov_b32 v160, 0
    v_mov_b32 v161, 0
    v_mov_b32 v162, 0
    v_mov_b32 v163, 0
    v_mov_b32 v164, 0
    v_mov_b32 v165, 0
    v_mov_b32 v166, 0
    v_mov_b32 v167, 0
    v_mov_b32 v168, 0
    v_mov_b32 v169, 0
    v_mov_b32 v170, 0
    v_mov_b32 v171, 0
    v_mov_b32 v172, 0
    v_mov_b32 v173, 0
    v_mov_b32 v174, 0
    v_mov_b32 v175, 0
    v_mov_b32 v176, 0
    v_mov_b32 v177, 0
    v_mov_b32 v178, 0
    v_mov_b32 v179, 0
    v_mov_b32 v180, 0
    v_mov_b32 v181, 0
    v_mov_b32 v182, 0
    v_mov_b32 v183, 0
    v_mov_b32 v184, 0
    v_mov_b32 v185, 0
    v_mov_b32 v186, 0
    v_mov_b32 v187, 0
    v_mov_b32 v188, 0
    v_mov_b32 v189, 0
    v_mov_b32 v190, 0
    v_mov_b32 v191, 0
    v_mov_b32 v192, 0
    v_mov_b32 v193, 0
    v_mov_b32 v194, 0
    v_mov_b32 v195, 0
    v_mov_b32 v196, 0
    v_mov_b32 v197, 0
    v_mov_b32 v198, 0
    v_mov_b32 v199, 0
    v_mov_b32 v200, 0
    v_mov_b32 v201, 0
    v_mov_b32 v202, 0
    v_mov_b32 v203, 0
    v_mov_b32 v204, 0
    v_mov_b32 v205, 0
    v_mov_b32 v206, 0
    v_mov_b32 v207, 0
    v_mov_b32 v208, 0
    v_mov_b32 v209, 0
    v_mov_b32 v210, 0
    v_mov_b32 v211, 0
    v_mov_b32 v212, 0
    v_mov_b32 v213, 0
    v_mov_b32 v214, 0
    v_mov_b32 v215, 0
    v_mov_b32 v216, 0
    v_mov_b32 v217, 0
    v_mov_b32 v218, 0
    v_mov_b32 v219, 0
    v_mov_b32 v220, 0
    v_mov_b32 v221, 0
    v_mov_b32 v222, 0
    v_mov_b32 v223, 0
    v_mov_b32 v224, 0
    v_mov_b32 v225, 0
    v_mov_b32 v226, 0
    v_mov_b32 v227, 0
    v_mov_b32 v228, 0
    v_mov_b32 v229, 0
    v_mov_b32 v230, 0
    v_mov_b32 v231, 0
    v_mov_b32 v232, 0
    v_mov_b32 v233, 0
    v_mov_b32 v234, 0
    v_mov_b32 v235, 0
    v_mov_b32 v236, 0
    v_mov_b32 v237, 0
    v_mov_b32 v238, 0
    v_mov_b32 v239, 0
    v_mov_b32 v240, 0
    v_mov_b32 v241, 0
    v_mov_b32 v242, 0
    v_mov_b32 v243, 0
    v_mov_b32 v244, 0
    v_mov_b32 v245, 0
    v_mov_b32 v246, 0
    v_mov_b32 v247, 0
    v_mov_b32 v248, 0
    v_mov_b32 v249, 0
    v_mov_b32 v250, 0
    v_mov_b32 v251, 0
    v_mov_b32 v252, 0
    v_mov_b32 v253, 0
    v_mov_b32 v254, 0
    v_mov_b32 v255, 0
    s_barrier
    s_mov_b32 s40, 2
    v_mov_b32 v0, s40
    s_waitcnt vmcnt(21)
    ds_write_b32 v7, v0
    s_branch K12_S0
K12_Q0:
    ds_read_b64_tr_b16 v[40:41], v4 offset:0
    ds_read_b64_tr_b16 v[42:43], v4 offset:2048
    ds_read_b64_tr_b16 v[44:45], v4 offset:256
    ds_read_b64_tr_b16 v[46:47], v4 offset:2304
    v_xor_b32 v4, 32, v4
    ds_read_b64_tr_b16 v[48:49], v4 offset:0
    ds_read_b64_tr_b16 v[50:51], v4 offset:2048
    ds_read_b64_tr_b16 v[52:53], v4 offset:256
    ds_read_b64_tr_b16 v[54:55], v4 offset:2304
    v_xor_b32 v4, 32, v4
    ds_read_b128 v[8:11], v2 offset:0
    ds_read_b128 v[12:15], v3 offset:0
    ds_read_b128 v[16:19], v2 offset:2048
    ds_read_b128 v[20:23], v3 offset:2048
    ds_read_b128 v[32:35], v2 offset:6144
    ds_read_b128 v[36:39], v3 offset:6144
    ds_read_b32 v60, v5
    s_waitcnt lgkmcnt(7)
    v_xor_b32 v72, s35, v44
    v_xor_b32 v73, s35, v45
    v_xor_b32 v74, s35, v46
    v_xor_b32 v75, s35, v47
    v_xor_b32 v76, s35, v52
    v_xor_b32 v77, s35, v53
    v_xor_b32 v78, s35, v54
    v_xor_b32 v79, s35, v55
    s_mov_b32 s41, 0
    s_mov_b32 s42, 38912
    s_mov_b32 s39, 0
    s_mov_b32 s29, 116736
K12_LOOP:
    s_waitcnt lgkmcnt(5)
    v_mfma_f32_16x16x32_bf16 v[80:83], v[8:11], v[40:43], v[80:83]
    ds_read_b128 v[24:27], v2 offset:4096
    v_mfma_f32_16x16x32_bf16 v[84:87], v[8:11], v[44:47], v[84:87]
    ds_read_b128 v[28:31], v3 offset:4096
    v_mfma_f32_16x16x32_bf16 v[88:91], v[8:11], v[48:51], v[88:91]
    s_waitcnt lgkmcnt(2)
    v_cmp_gt_u32 vcc, s40, v60
    s_add_u32 s49, s39, 2
    s_lshr_b32 s49, s49, 1
    v_mfma_f32_16x16x32_bf16 v[92:95], v[8:11], v[52:55], v[92:95]
    s_cbranch_vccnz K12_S1
K12_Q1:
    s_mul_i32 s48, s49, s50
    s_add_u32 s48, s48, s47
    v_mfma_f32_16x16x32_bf16 v[80:83], v[12:15], v[72:75], v[80:83]
    s_add_u32 m0, s29, s36
    s_nop 0
    buffer_load_dwordx4 v1, s[8:11], s30 offen sc1 lds
    v_mfma_f32_16x16x32_bf16 v[84:87], v[12:15], v[40:43], v[84:87]
    s_cmp_lt_u32 s49, 8
    s_cselect_b32 s48, s48, 155744
    v_mfma_f32_16x16x32_bf16 v[88:91], v[12:15], v[76:79], v[88:91]
    s_cmp_ge_u32 s49, 3
    s_cselect_b32 s48, s48, 155744
    v_mfma_f32_16x16x32_bf16 v[92:95], v[12:15], v[48:51], v[92:95]
    v_mfma_f32_16x16x32_bf16 v[96:99], v[16:19], v[40:43], v[96:99]
    ds_read_b128 v[8:11], v2 offset:8192
    v_mfma_f32_16x16x32_bf16 v[100:103], v[16:19], v[44:47], v[100:103]
    ds_read_b128 v[12:15], v3 offset:8192
    v_mfma_f32_16x16x32_bf16 v[104:107], v[16:19], v[48:51], v[104:107]
    buffer_load_dwordx4 v1, s[8:11], s30 offen offset:1024 sc1 lds
    v_mfma_f32_16x16x32_bf16 v[108:111], v[16:19], v[52:55], v[108:111]
    v_mfma_f32_16x16x32_bf16 v[96:99], v[20:23], v[72:75], v[96:99]
    v_mfma_f32_16x16x32_bf16 v[100:103], v[20:23], v[40:43], v[100:103]
    v_mfma_f32_16x16x32_bf16 v[104:107], v[20:23], v[76:79], v[104:107]
    buffer_load_dwordx4 v1, s[8:11], s30 offen offset:2048 sc1 lds
    v_mfma_f32_16x16x32_bf16 v[108:111], v[20:23], v[48:51], v[108:111]
    s_waitcnt lgkmcnt(2)
    v_mfma_f32_16x16x32_bf16 v[112:115], v[24:27], v[40:43], v[112:115]
    ds_read_b128 v[16:19], v2 offset:10240
    v_mfma_f32_16x16x32_bf16 v[116:119], v[24:27], v[44:47], v[116:119]
    ds_read_b128 v[20:23], v3 offset:10240
    v_mfma_f32_16x16x32_bf16 v[120:123], v[24:27], v[48:51], v[120:123]
    v_mfma_f32_16x16x32_bf16 v[124:127], v[24:27], v[52:55], v[124:127]
    v_mfma_f32_16x16x32_bf16 v[112:115], v[28:31], v[72:75], v[112:115]
    buffer_load_dwordx4 v1, s[8:11], s30 offen offset:3072 sc1 lds
    v_mfma_f32_16x16x32_bf16 v[116:119], v[28:31], v[40:43], v[116:119]
    v_mfma_f32_16x16x32_bf16 v[120:123], v[28:31], v[76:79], v[120:123]
    v_mfma_f32_16x16x32_bf16 v[124:127], v[28:31], v[48:51], v[124:127]
    v_mfma_f32_16x16x32_bf16 v[128:131], v[32:35], v[40:43], v[128:131]
    ds_read_b128 v[24:27], v2 offset:12288
    v_mfma_f32_16x16x32_bf16 v[132:135], v[32:35], v[44:47], v[132:135]
    ds_read_b128 v[28:31], v3 offset:12288
    v_mfma_f32_16x16x32_bf16 v[136:139], v[32:35], v[48:51], v[136:139]
    s_add_u32 m0, m0, 4096
    s_add_u32 s34, s30, 4096
    buffer_load_dwordx4 v1, s[8:11], s34 offen sc1 lds
    v_mfma_f32_16x16x32_bf16 v[140:143], v[32:35], v[52:55], v[140:143]
    v_mfma_f32_16x16x32_bf16 v[128:131], v[36:39], v[72:75], v[128:131]
    v_mfma_f32_16x16x32_bf16 v[132:135], v[36:39], v[40:43], v[132:135]
    v_mfma_f32_16x16x32_bf16 v[136:139], v[36:39], v[76:79], v[136:139]
    s_add_u32 m0, s29, s37
    s_add_u32 s30, s30, 21376
    buffer_load_dwordx4 v1, s[12:15], s31 offen sc1 lds
    v_mfma_f32_16x16x32_bf16 v[140:143], v[36:39], v[48:51], v[140:143]
    s_waitcnt lgkmcnt(4)
    v_mfma_f32_16x16x32_bf16 v[144:147], v[8:11], v[40:43], v[144:147]
    ds_read_b128 v[32:35], v2 offset:14336
    v_mfma_f32_16x16x32_bf16 v[148:151], v[8:11], v[44:47], v[148:151]
    ds_read_b128 v[36:39], v3 offset:14336
    v_mfma_f32_16x16x32_bf16 v[152:155], v[8:11], v[48:51], v[152:155]
    v_mfma_f32_16x16x32_bf16 v[156:159], v[8:11], v[52:55], v[156:159]
    v_mfma_f32_16x16x32_bf16 v[144:147], v[12:15], v[72:75], v[144:147]
    buffer_load_dwordx4 v1, s[12:15], s31 offen offset:1024 sc1 lds
    v_mfma_f32_16x16x32_bf16 v[148:151], v[12:15], v[40:43], v[148:151]
    v_mfma_f32_16x16x32_bf16 v[152:155], v[12:15], v[76:79], v[152:155]
    v_mfma_f32_16x16x32_bf16 v[156:159], v[12:15], v[48:51], v[156:159]
    s_waitcnt lgkmcnt(4)
    v_mfma_f32_16x16x32_bf16 v[160:163], v[16:19], v[40:43], v[160:163]
    ds_read_b128 v[8:11], v2 offset:16384
    v_mfma_f32_16x16x32_bf16 v[164:167], v[16:19], v[44:47], v[164:167]
    ds_read_b128 v[12:15], v3 offset:16384
    v_mfma_f32_16x16x32_bf16 v[168:171], v[16:19], v[48:51], v[168:171]
    buffer_load_dwordx4 v1, s[12:15], s31 offen offset:2048 sc1 lds
    v_mfma_f32_16x16x32_bf16 v[172:175], v[16:19], v[52:55], v[172:175]
    s_add_u32 s40, s40, 1
    s_mov_b32 s51, s40
    v_mov_b32 v0, s40
    v_mfma_f32_16x16x32_bf16 v[160:163], v[20:23], v[72:75], v[160:163]
    s_waitcnt vmcnt(19)
    ds_write_b32 v7, v0
    v_mfma_f32_16x16x32_bf16 v[164:167], v[20:23], v[40:43], v[164:167]
    v_mfma_f32_16x16x32_bf16 v[168:171], v[20:23], v[76:79], v[168:171]
    buffer_load_dwordx4 v1, s[12:15], s31 offen offset:3072 sc1 lds
    v_mfma_f32_16x16x32_bf16 v[172:175], v[20:23], v[48:51], v[172:175]
    s_waitcnt lgkmcnt(5)
    v_mfma_f32_16x16x32_bf16 v[176:179], v[24:27], v[40:43], v[176:179]
    ds_read_b128 v[16:19], v2 offset:18432
    v_mfma_f32_16x16x32_bf16 v[180:183], v[24:27], v[44:47], v[180:183]
    ds_read_b128 v[20:23], v3 offset:18432
    v_mov_b32 v0, s48
    v_mfma_f32_16x16x32_bf16 v[184:187], v[24:27], v[48:51], v[184:187]
    ds_read_b32 v0, v0
    v_mfma_f32_16x16x32_bf16 v[188:191], v[24:27], v[52:55], v[188:191]
    v_mfma_f32_16x16x32_bf16 v[176:179], v[28:31], v[72:75], v[176:179]
    s_add_u32 m0, s29, s38
    s_mov_b64 exec, s[44:45]
    buffer_load_dwordx4 v1, s[8:11], s33 offen sc1 lds
    s_mov_b64 exec, -1
    s_add_u32 s31, s31, 16384
    s_add_u32 s33, s33, 21376
    v_mfma_f32_16x16x32_bf16 v[180:183], v[28:31], v[40:43], v[180:183]
    v_mfma_f32_16x16x32_bf16 v[184:187], v[28:31], v[76:79], v[184:187]
    v_mfma_f32_16x16x32_bf16 v[188:191], v[28:31], v[48:51], v[188:191]
    s_waitcnt lgkmcnt(0)
    v_cmp_eq_u32 vcc, 0, v0
    v_mfma_f32_16x16x32_bf16 v[192:195], v[32:35], v[40:43], v[192:195]
    ds_read_b128 v[24:27], v2 offset:20480
    v_mfma_f32_16x16x32_bf16 v[196:199], v[32:35], v[44:47], v[196:199]
    ds_read_b128 v[28:31], v3 offset:20480
    s_cbranch_vccnz K12_F2
K12_G2:
    v_mfma_f32_16x16x32_bf16 v[200:203], v[32:35], v[48:51], v[200:203]
    s_sub_u32 s43, s42, s41
    s_add_u32 s40, s40, 1
    v_add_u32 v2, s43, v2
    v_mfma_f32_16x16x32_bf16 v[204:207], v[32:35], v[52:55], v[204:207]
    v_add_u32 v3, s43, v3
    v_add_u32 v4, s43, v4
    v_mov_b32 v0, s40
    v_mfma_f32_16x16x32_bf16 v[192:195], v[36:39], v[72:75], v[192:195]
    ds_write_b32 v7, v0
    v_mfma_f32_16x16x32_bf16 v[196:199], v[36:39], v[40:43], v[196:199]
    v_mfma_f32_16x16x32_bf16 v[200:203], v[36:39], v[76:79], v[200:203]
    v_mfma_f32_16x16x32_bf16 v[204:207], v[36:39], v[48:51], v[204:207]
    ds_read_b32 v56, v5
    v_mfma_f32_16x16x32_bf16 v[208:211], v[8:11], v[40:43], v[208:211]
    v_mfma_f32_16x16x32_bf16 v[212:215], v[8:11], v[44:47], v[212:215]
    v_mfma_f32_16x16x32_bf16 v[216:219], v[8:11], v[48:51], v[216:219]
    v_mfma_f32_16x16x32_bf16 v[220:223], v[8:11], v[52:55], v[220:223]
    s_waitcnt lgkmcnt(0)
    v_cmp_gt_u32 vcc, s51, v56
    v_mfma_f32_16x16x32_bf16 v[208:211], v[12:15], v[72:75], v[208:211]
    v_mfma_f32_16x16x32_bf16 v[212:215], v[12:15], v[40:43], v[212:215]
    s_cbranch_vccnz K12_S3
K12_Q3:
    v_mfma_f32_16x16x32_bf16 v[216:219], v[12:15], v[76:79], v[216:219]
    ds_read_b64_tr_b16 v[56:57], v4 offset:0
    v_mfma_f32_16x16x32_bf16 v[220:223], v[12:15], v[48:51], v[220:223]
    ds_read_b64_tr_b16 v[58:59], v4 offset:2048
    v_mfma_f32_16x16x32_bf16 v[224:227], v[16:19], v[40:43], v[224:227]
    ds_read_b64_tr_b16 v[60:61], v4 offset:256
    v_mfma_f32_16x16x32_bf16 v[228:231], v[16:19], v[44:47], v[228:231]
    ds_read_b64_tr_b16 v[62:63], v4 offset:2304
    v_mfma_f32_16x16x32_bf16 v[232:235], v[16:19], v[48:51], v[232:235]
    v_xor_b32 v4, 32, v4
    v_mfma_f32_16x16x32_bf16 v[236:239], v[16:19], v[52:55], v[236:239]
    ds_read_b64_tr_b16 v[64:65], v4 offset:0
    v_mfma_f32_16x16x32_bf16 v[224:227], v[20:23], v[72:75], v[224:227]
    ds_read_b64_tr_b16 v[66:67], v4 offset:2048
    v_mfma_f32_16x16x32_bf16 v[228:231], v[20:23], v[40:43], v[228:231]
    ds_read_b64_tr_b16 v[68:69], v4 offset:256
    ds_read_b64_tr_b16 v[70:71], v4 offset:2304
    v_xor_b32 v4, 32, v4
    v_mfma_f32_16x16x32_bf16 v[232:235], v[20:23], v[76:79], v[232:235]
    ds_read_b128 v[8:11], v2 offset:0
    v_mfma_f32_16x16x32_bf16 v[236:239], v[20:23], v[48:51], v[236:239]
    ds_read_b128 v[12:15], v3 offset:0
    v_mfma_f32_16x16x32_bf16 v[240:243], v[24:27], v[40:43], v[240:243]
    ds_read_b128 v[16:19], v2 offset:2048
    v_mfma_f32_16x16x32_bf16 v[244:247], v[24:27], v[44:47], v[244:247]
    ds_read_b128 v[20:23], v3 offset:2048
    v_mfma_f32_16x16x32_bf16 v[248:251], v[24:27], v[48:51], v[248:251]
    ds_read_b128 v[32:35], v2 offset:6144
    v_mfma_f32_16x16x32_bf16 v[252:255], v[24:27], v[52:55], v[252:255]
    ds_read_b128 v[36:39], v3 offset:6144
    ds_read_b32 v44, v5
    s_mov_b32 s29, s41
    s_mov_b32 s41, s42
    s_add_u32 s42, s42, 38912
    v_mfma_f32_16x16x32_bf16 v[240:243], v[28:31], v[72:75], v[240:243]
    s_waitcnt lgkmcnt(7)
    v_xor_b32 v72, s35, v60
    v_xor_b32 v73, s35, v61
    v_mfma_f32_16x16x32_bf16 v[244:247], v[28:31], v[40:43], v[244:247]
    v_xor_b32 v74, s35, v62
    v_xor_b32 v75, s35, v63
    s_cmp_eq_u32 s42, 155648
    s_cselect_b32 s42, 0, s42
    v_mfma_f32_16x16x32_bf16 v[248:251], v[28:31], v[76:79], v[248:251]
    v_xor_b32 v76, s35, v68
    v_xor_b32 v77, s35, v69
    v_mfma_f32_16x16x32_bf16 v[252:255], v[28:31], v[48:51], v[252:255]
    v_xor_b32 v78, s35, v70
    v_xor_b32 v79, s35, v71
    s_waitcnt lgkmcnt(5)
    v_mfma_f32_16x16x32_bf16 v[80:83], v[8:11], v[56:59], v[80:83]
    ds_read_b128 v[24:27], v2 offset:4096
    v_mfma_f32_16x16x32_bf16 v[84:87], v[8:11], v[60:63], v[84:87]
    ds_read_b128 v[28:31], v3 offset:4096
    v_mfma_f32_16x16x32_bf16 v[88:91], v[8:11], v[64:67], v[88:91]
    s_waitcnt lgkmcnt(2)
    v_cmp_gt_u32 vcc, s40, v44
    v_mfma_f32_16x16x32_bf16 v[92:95], v[8:11], v[68:71], v[92:95]
    s_cbranch_vccnz K12_S4
K12_Q4:
    v_mfma_f32_16x16x32_bf16 v[80:83], v[12:15], v[72:75], v[80:83]
    s_add_u32 m0, s29, s36
    s_nop 0
    buffer_load_dwordx4 v1, s[8:11], s30 offen sc1 lds
    v_mfma_f32_16x16x32_bf16 v[84:87], v[12:15], v[56:59], v[84:87]
    v_mfma_f32_16x16x32_bf16 v[88:91], v[12:15], v[76:79], v[88:91]
    v_mfma_f32_16x16x32_bf16 v[92:95], v[12:15], v[64:67], v[92:95]
    v_mfma_f32_16x16x32_bf16 v[96:99], v[16:19], v[56:59], v[96:99]
    ds_read_b128 v[8:11], v2 offset:8192
    v_mfma_f32_16x16x32_bf16 v[100:103], v[16:19], v[60:63], v[100:103]
    ds_read_b128 v[12:15], v3 offset:8192
    v_mfma_f32_16x16x32_bf16 v[104:107], v[16:19], v[64:67], v[104:107]
    buffer_load_dwordx4 v1, s[8:11], s30 offen offset:1024 sc1 lds
    v_mfma_f32_16x16x32_bf16 v[108:111], v[16:19], v[68:71], v[108:111]
    v_mfma_f32_16x16x32_bf16 v[96:99], v[20:23], v[72:75], v[96:99]
    v_mfma_f32_16x16x32_bf16 v[100:103], v[20:23], v[56:59], v[100:103]
    v_mfma_f32_16x16x32_bf16 v[104:107], v[20:23], v[76:79], v[104:107]
    buffer_load_dwordx4 v1, s[8:11], s30 offen offset:2048 sc1 lds
    v_mfma_f32_16x16x32_bf16 v[108:111], v[20:23], v[64:67], v[108:111]
    s_waitcnt lgkmcnt(2)
    v_mfma_f32_16x16x32_bf16 v[112:115], v[24:27], v[56:59], v[112:115]
    ds_read_b128 v[16:19], v2 offset:10240
    v_mfma_f32_16x16x32_bf16 v[116:119], v[24:27], v[60:63], v[116:119]
    ds_read_b128 v[20:23], v3 offset:10240
    v_mfma_f32_16x16x32_bf16 v[120:123], v[24:27], v[64:67], v[120:123]
    v_mfma_f32_16x16x32_bf16 v[124:127], v[24:27], v[68:71], v[124:127]
    v_mfma_f32_16x16x32_bf16 v[112:115], v[28:31], v[72:75], v[112:115]
    buffer_load_dwordx4 v1, s[8:11], s30 offen offset:3072 sc1 lds
    v_mfma_f32_16x16x32_bf16 v[116:119], v[28:31], v[56:59], v[116:119]
    v_mfma_f32_16x16x32_bf16 v[120:123], v[28:31], v[76:79], v[120:123]
    v_mfma_f32_16x16x32_bf16 v[124:127], v[28:31], v[64:67], v[124:127]
    v_mfma_f32_16x16x32_bf16 v[128:131], v[32:35], v[56:59], v[128:131]
    ds_read_b128 v[24:27], v2 offset:12288
    v_mfma_f32_16x16x32_bf16 v[132:135], v[32:35], v[60:63], v[132:135]
    ds_read_b128 v[28:31], v3 offset:12288
    v_mfma_f32_16x16x32_bf16 v[136:139], v[32:35], v[64:67], v[136:139]
    s_add_u32 m0, m0, 4096
    s_add_u32 s34, s30, 4096
    buffer_load_dwordx4 v1, s[8:11], s34 offen sc1 lds
    v_mfma_f32_16x16x32_bf16 v[140:143], v[32:35], v[68:71], v[140:143]
    v_mfma_f32_16x16x32_bf16 v[128:131], v[36:39], v[72:75], v[128:131]
    v_mfma_f32_16x16x32_bf16 v[132:135], v[36:39], v[56:59], v[132:135]
    v_mfma_f32_16x16x32_bf16 v[136:139], v[36:39], v[76:79], v[136:139]
    s_add_u32 m0, s29, s37
    s_add_u32 s30, s30, 21376
    buffer_load_dwordx4 v1, s[12:15], s31 offen sc1 lds
    v_mfma_f32_16x16x32_bf16 v[140:143], v[36:39], v[64:67], v[140:143]
    s_waitcnt lgkmcnt(4)
    v_mfma_f32_16x16x32_bf16 v[144:147], v[8:11], v[56:59], v[144:147]
    ds_read_b128 v[32:35], v2 offset:14336
    v_mfma_f32_16x16x32_bf16 v[148:151], v[8:11], v[60:63], v[148:151]
    ds_read_b128 v[36:39], v3 offset:14336
    v_mfma_f32_16x16x32_bf16 v[152:155], v[8:11], v[64:67], v[152:155]
    v_mfma_f32_16x16x32_bf16 v[156:159], v[8:11], v[68:71], v[156:159]
    v_mfma_f32_16x16x32_bf16 v[144:147], v[12:15], v[72:75], v[144:147]
    buffer_load_dwordx4 v1, s[12:15], s31 offen offset:1024 sc1 lds
    v_mfma_f32_16x16x32_bf16 v[148:151], v[12:15], v[56:59], v[148:151]
    v_mfma_f32_16x16x32_bf16 v[152:155], v[12:15], v[76:79], v[152:155]
    v_mfma_f32_16x16x32_bf16 v[156:159], v[12:15], v[64:67], v[156:159]
    s_waitcnt lgkmcnt(4)
    v_mfma_f32_16x16x32_bf16 v[160:163], v[16:19], v[56:59], v[160:163]
    ds_read_b128 v[8:11], v2 offset:16384
    v_mfma_f32_16x16x32_bf16 v[164:167], v[16:19], v[60:63], v[164:167]
    ds_read_b128 v[12:15], v3 offset:16384
    v_mfma_f32_16x16x32_bf16 v[168:171], v[16:19], v[64:67], v[168:171]
    buffer_load_dwordx4 v1, s[12:15], s31 offen offset:2048 sc1 lds
    v_mfma_f32_16x16x32_bf16 v[172:175], v[16:19], v[68:71], v[172:175]
    s_add_u32 s40, s40, 1
    s_mov_b32 s51, s40
    v_mov_b32 v0, s40
    v_mfma_f32_16x16x32_bf16 v[160:163], v[20:23], v[72:75], v[160:163]
    s_waitcnt vmcnt(19)
    ds_write_b32 v7, v0
    v_mfma_f32_16x16x32_bf16 v[164:167], v[20:23], v[56:59], v[164:167]
    v_mfma_f32_16x16x32_bf16 v[168:171], v[20:23], v[76:79], v[168:171]
    buffer_load_dwordx4 v1, s[12:15], s31 offen offset:3072 sc1 lds
    v_mfma_f32_16x16x32_bf16 v[172:175], v[20:23], v[64:67], v[172:175]
    s_waitcnt lgkmcnt(5)
    v_mfma_f32_16x16x32_bf16 v[176:179], v[24:27], v[56:59], v[176:179]
    ds_read_b128 v[16:19], v2 offset:18432
    v_mfma_f32_16x16x32_bf16 v[180:183], v[24:27], v[60:63], v[180:183]
    ds_read_b128 v[20:23], v3 offset:18432
    v_mfma_f32_16x16x32_bf16 v[184:187], v[24:27], v[64:67], v[184:187]
    v_mfma_f32_16x16x32_bf16 v[188:191], v[24:27], v[68:71], v[188:191]
    v_mfma_f32_16x16x32_bf16 v[176:179], v[28:31], v[72:75], v[176:179]
    s_add_u32 m0, s29, s38
    s_mov_b64 exec, s[44:45]
    buffer_load_dwordx4 v1, s[8:11], s33 offen sc1 lds
    s_mov_b64 exec, -1
    s_add_u32 s31, s31, 16384
    s_add_u32 s33, s33, 21376
    v_mfma_f32_16x16x32_bf16 v[180:183], v[28:31], v[56:59], v[180:183]
    v_mfma_f32_16x16x32_bf16 v[184:187], v[28:31], v[76:79], v[184:187]
    s_mov_b32 m0, s46
    s_mov_b64 exec, 0xff
    buffer_load_dword v1, s[4:7], 0 offen sc1 lds
    s_mov_b64 exec, -1
    v_mfma_f32_16x16x32_bf16 v[188:191], v[28:31], v[64:67], v[188:191]
    s_waitcnt lgkmcnt(5)
    v_mfma_f32_16x16x32_bf16 v[192:195], v[32:35], v[56:59], v[192:195]
    ds_read_b128 v[24:27], v2 offset:20480
    v_mfma_f32_16x16x32_bf16 v[196:199], v[32:35], v[60:63], v[196:199]
    ds_read_b128 v[28:31], v3 offset:20480
    v_mfma_f32_16x16x32_bf16 v[200:203], v[32:35], v[64:67], v[200:203]
    s_sub_u32 s43, s42, s41
    s_add_u32 s40, s40, 1
    v_add_u32 v2, s43, v2
    v_mfma_f32_16x16x32_bf16 v[204:207], v[32:35], v[68:71], v[204:207]
    v_add_u32 v3, s43, v3
    v_add_u32 v4, s43, v4
    v_mov_b32 v0, s40
    v_mfma_f32_16x16x32_bf16 v[192:195], v[36:39], v[72:75], v[192:195]
    ds_write_b32 v7, v0
    v_mfma_f32_16x16x32_bf16 v[196:199], v[36:39], v[56:59], v[196:199]
    v_mfma_f32_16x16x32_bf16 v[200:203], v[36:39], v[76:79], v[200:203]
    v_mfma_f32_16x16x32_bf16 v[204:207], v[36:39], v[64:67], v[204:207]
    ds_read_b32 v40, v5
    s_waitcnt lgkmcnt(7)
    v_mfma_f32_16x16x32_bf16 v[208:211], v[8:11], v[56:59], v[208:211]
    v_mfma_f32_16x16x32_bf16 v[212:215], v[8:11], v[60:63], v[212:215]
    v_mfma_f32_16x16x32_bf16 v[216:219], v[8:11], v[64:67], v[216:219]
    v_mfma_f32_16x16x32_bf16 v[220:223], v[8:11], v[68:71], v[220:223]
    s_waitcnt lgkmcnt(0)
    v_cmp_gt_u32 vcc, s51, v40
    v_mfma_f32_16x16x32_bf16 v[208:211], v[12:15], v[72:75], v[208:211]
    v_mfma_f32_16x16x32_bf16 v[212:215], v[12:15], v[56:59], v[212:215]
    s_cbranch_vccnz K12_S5
K12_Q5:
    v_mfma_f32_16x16x32_bf16 v[216:219], v[12:15], v[76:79], v[216:219]
    ds_read_b64_tr_b16 v[40:41], v4 offset:0
    v_mfma_f32_16x16x32_bf16 v[220:223], v[12:15], v[64:67], v[220:223]
    ds_read_b64_tr_b16 v[42:43], v4 offset:2048
    v_mfma_f32_16x16x32_bf16 v[224:227], v[16:19], v[56:59], v[224:227]
    ds_read_b64_tr_b16 v[44:45], v4 offset:256
    v_mfma_f32_16x16x32_bf16 v[228:231], v[16:19], v[60:63], v[228:231]
    ds_read_b64_tr_b16 v[46:47], v4 offset:2304
    v_mfma_f32_16x16x32_bf16 v[232:235], v[16:19], v[64:67], v[232:235]
    v_xor_b32 v4, 32, v4
    v_mfma_f32_16x16x32_bf16 v[236:239], v[16:19], v[68:71], v[236:239]
    ds_read_b64_tr_b16 v[48:49], v4 offset:0
    v_mfma_f32_16x16x32_bf16 v[224:227], v[20:23], v[72:75], v[224:227]
    ds_read_b64_tr_b16 v[50:51], v4 offset:2048
    v_mfma_f32_16x16x32_bf16 v[228:231], v[20:23], v[56:59], v[228:231]
    ds_read_b64_tr_b16 v[52:53], v4 offset:256
    ds_read_b64_tr_b16 v[54:55], v4 offset:2304
    v_xor_b32 v4, 32, v4
    v_mfma_f32_16x16x32_bf16 v[232:235], v[20:23], v[76:79], v[232:235]
    ds_read_b128 v[8:11], v2 offset:0
    v_mfma_f32_16x16x32_bf16 v[236:239], v[20:23], v[64:67], v[236:239]
    ds_read_b128 v[12:15], v3 offset:0
    v_mfma_f32_16x16x32_bf16 v[240:243], v[24:27], v[56:59], v[240:243]
    ds_read_b128 v[16:19], v2 offset:2048
    v_mfma_f32_16x16x32_bf16 v[244:247], v[24:27], v[60:63], v[244:247]
    ds_read_b128 v[20:23], v3 offset:2048
    v_mfma_f32_16x16x32_bf16 v[248:251], v[24:27], v[64:67], v[248:251]
    ds_read_b128 v[32:35], v2 offset:6144
    v_mfma_f32_16x16x32_bf16 v[252:255], v[24:27], v[68:71], v[252:255]
    ds_read_b128 v[36:39], v3 offset:6144
    ds_read_b32 v60, v5
    s_mov_b32 s29, s41
    s_mov_b32 s41, s42
    s_add_u32 s42, s42, 38912
    v_mfma_f32_16x16x32_bf16 v[240:243], v[28:31], v[72:75], v[240:243]
    s_waitcnt lgkmcnt(7)
    v_xor_b32 v72, s35, v44
    v_xor_b32 v73, s35, v45
    v_mfma_f32_16x16x32_bf16 v[244:247], v[28:31], v[56:59], v[244:247]
    v_xor_b32 v74, s35, v46
    v_xor_b32 v75, s35, v47
    s_cmp_eq_u32 s42, 155648
    s_cselect_b32 s42, 0, s42
    v_mfma_f32_16x16x32_bf16 v[248:251], v[28:31], v[76:79], v[248:251]
    v_xor_b32 v76, s35, v52
    v_xor_b32 v77, s35, v53
    v_mfma_f32_16x16x32_bf16 v[252:255], v[28:31], v[64:67], v[252:255]
    v_xor_b32 v78, s35, v54
    v_xor_b32 v79, s35, v55
    s_add_u32 s39, s39, 1
    s_cmp_lt_u32 s39, 16
    s_cbranch_scc1 K12_LOOP
    v_lshrrev_b32 v8, 4, v1
    v_and_b32 v9, 15, v8
    v_lshrrev_b32 v8, 4, v8
    s_lshl_b32 s28, s21, 7
    s_lshl_b32 s29, s3, 5
    s_add_u32 s28, s28, s29
    v_add_u32 v9, s28, v9
    v_lshlrev_b32 v9, 2, v9
    v_lshl_add_u32 v6, v8, 13, v9
    s_nop 2
    s_mov_b32 s38, 0
    v_cvt_pk_bf16_f32 v8, v80, v84
    buffer_store_dword v8, v6, s[16:19], s38 offen offset:0
    v_cvt_pk_bf16_f32 v9, v88, v92
    buffer_store_dword v9, v6, s[16:19], s38 offen offset:64
    v_cvt_pk_bf16_f32 v10, v81, v85
    buffer_store_dword v10, v6, s[16:19], s38 offen offset:2048
    v_cvt_pk_bf16_f32 v11, v89, v93
    buffer_store_dword v11, v6, s[16:19], s38 offen offset:2112
    s_mov_b32 s38, 4096
    v_cvt_pk_bf16_f32 v12, v82, v86
    buffer_store_dword v12, v6, s[16:19], s38 offen offset:0
    v_cvt_pk_bf16_f32 v13, v90, v94
    buffer_store_dword v13, v6, s[16:19], s38 offen offset:64
    v_cvt_pk_bf16_f32 v14, v83, v87
    buffer_store_dword v14, v6, s[16:19], s38 offen offset:2048
    v_cvt_pk_bf16_f32 v15, v91, v95
    buffer_store_dword v15, v6, s[16:19], s38 offen offset:2112
    s_mov_b32 s38, 32768
    v_cvt_pk_bf16_f32 v8, v96, v100
    buffer_store_dword v8, v6, s[16:19], s38 offen offset:0
    v_cvt_pk_bf16_f32 v9, v104, v108
    buffer_store_dword v9, v6, s[16:19], s38 offen offset:64
    v_cvt_pk_bf16_f32 v10, v97, v101
    buffer_store_dword v10, v6, s[16:19], s38 offen offset:2048
    v_cvt_pk_bf16_f32 v11, v105, v109
    buffer_store_dword v11, v6, s[16:19], s38 offen offset:2112
    s_mov_b32 s38, 36864
    v_cvt_pk_bf16_f32 v12, v98, v102
    buffer_store_dword v12, v6, s[16:19], s38 offen offset:0
    v_cvt_pk_bf16_f32 v13, v106, v110
    buffer_store_dword v13, v6, s[16:19], s38 offen offset:64
    v_cvt_pk_bf16_f32 v14, v99, v103
    buffer_store_dword v14, v6, s[16:19], s38 offen offset:2048
    v_cvt_pk_bf16_f32 v15, v107, v111
    buffer_store_dword v15, v6, s[16:19], s38 offen offset:2112
    s_mov_b32 s38, 65536
    v_cvt_pk_bf16_f32 v8, v112, v116
    buffer_store_dword v8, v6, s[16:19], s38 offen offset:0
    v_cvt_pk_bf16_f32 v9, v120, v124
    buffer_store_dword v9, v6, s[16:19], s38 offen offset:64
    v_cvt_pk_bf16_f32 v10, v113, v117
    buffer_store_dword v10, v6, s[16:19], s38 offen offset:2048
    v_cvt_pk_bf16_f32 v11, v121, v125
    buffer_store_dword v11, v6, s[16:19], s38 offen offset:2112
    s_mov_b32 s38, 69632
    v_cvt_pk_bf16_f32 v12, v114, v118
    buffer_store_dword v12, v6, s[16:19], s38 offen offset:0
    v_cvt_pk_bf16_f32 v13, v122, v126
    buffer_store_dword v13, v6, s[16:19], s38 offen offset:64
    v_cvt_pk_bf16_f32 v14, v115, v119
    buffer_store_dword v14, v6, s[16:19], s38 offen offset:2048
    v_cvt_pk_bf16_f32 v15, v123, v127
    buffer_store_dword v15, v6, s[16:19], s38 offen offset:2112
    s_mov_b32 s38, 98304
    v_cvt_pk_bf16_f32 v8, v128, v132
    buffer_store_dword v8, v6, s[16:19], s38 offen offset:0
    v_cvt_pk_bf16_f32 v9, v136, v140
    buffer_store_dword v9, v6, s[16:19], s38 offen offset:64
    v_cvt_pk_bf16_f32 v10, v129, v133
    buffer_store_dword v10, v6, s[16:19], s38 offen offset:2048
    v_cvt_pk_bf16_f32 v11, v137, v141
    buffer_store_dword v11, v6, s[16:19], s38 offen offset:2112
    s_mov_b32 s38, 102400
    v_cvt_pk_bf16_f32 v12, v130, v134
    buffer_store_dword v12, v6, s[16:19], s38 offen offset:0
    v_cvt_pk_bf16_f32 v13, v138, v142
    buffer_store_dword v13, v6, s[16:19], s38 offen offset:64
    v_cvt_pk_bf16_f32 v14, v131, v135
    buffer_store_dword v14, v6, s[16:19], s38 offen offset:2048
    v_cvt_pk_bf16_f32 v15, v139, v143
    buffer_store_dword v15, v6, s[16:19], s38 offen offset:2112
    s_mov_b32 s38, 131072
    v_cvt_pk_bf16_f32 v8, v144, v148
    buffer_store_dword v8, v6, s[16:19], s38 offen offset:0
    v_cvt_pk_bf16_f32 v9, v152, v156
    buffer_store_dword v9, v6, s[16:19], s38 offen offset:64
    v_cvt_pk_bf16_f32 v10, v145, v149
    buffer_store_dword v10, v6, s[16:19], s38 offen offset:2048
    v_cvt_pk_bf16_f32 v11, v153, v157
    buffer_store_dword v11, v6, s[16:19], s38 offen offset:2112
    s_mov_b32 s38, 135168
    v_cvt_pk_bf16_f32 v12, v146, v150
    buffer_store_dword v12, v6, s[16:19], s38 offen offset:0
    v_cvt_pk_bf16_f32 v13, v154, v158
    buffer_store_dword v13, v6, s[16:19], s38 offen offset:64
    v_cvt_pk_bf16_f32 v14, v147, v151
    buffer_store_dword v14, v6, s[16:19], s38 offen offset:2048
    v_cvt_pk_bf16_f32 v15, v155, v159
    buffer_store_dword v15, v6, s[16:19], s38 offen offset:2112
    s_mov_b32 s38, 163840
    v_cvt_pk_bf16_f32 v8, v160, v164
    buffer_store_dword v8, v6, s[16:19], s38 offen offset:0
    v_cvt_pk_bf16_f32 v9, v168, v172
    buffer_store_dword v9, v6, s[16:19], s38 offen offset:64
    v_cvt_pk_bf16_f32 v10, v161, v165
    buffer_store_dword v10, v6, s[16:19], s38 offen offset:2048
    v_cvt_pk_bf16_f32 v11, v169, v173
    buffer_store_dword v11, v6, s[16:19], s38 offen offset:2112
    s_mov_b32 s38, 167936
    v_cvt_pk_bf16_f32 v12, v162, v166
    buffer_store_dword v12, v6, s[16:19], s38 offen offset:0
    v_cvt_pk_bf16_f32 v13, v170, v174
    buffer_store_dword v13, v6, s[16:19], s38 offen offset:64
    v_cvt_pk_bf16_f32 v14, v163, v167
    buffer_store_dword v14, v6, s[16:19], s38 offen offset:2048
    v_cvt_pk_bf16_f32 v15, v171, v175
    buffer_store_dword v15, v6, s[16:19], s38 offen offset:2112
    s_mov_b32 s38, 196608
    v_cvt_pk_bf16_f32 v8, v176, v180
    buffer_store_dword v8, v6, s[16:19], s38 offen offset:0
    v_cvt_pk_bf16_f32 v9, v184, v188
    buffer_store_dword v9, v6, s[16:19], s38 offen offset:64
    v_cvt_pk_bf16_f32 v10, v177, v181
    buffer_store_dword v10, v6, s[16:19], s38 offen offset:2048
    v_cvt_pk_bf16_f32 v11, v185, v189
    buffer_store_dword v11, v6, s[16:19], s38 offen offset:2112
    s_mov_b32 s38, 200704
    v_cvt_pk_bf16_f32 v12, v178, v182
    buffer_store_dword v12, v6, s[16:19], s38 offen offset:0
    v_cvt_pk_bf16_f32 v13, v186, v190
    buffer_store_dword v13, v6, s[16:19], s38 offen offset:64
    v_cvt_pk_bf16_f32 v14, v179, v183
    buffer_store_dword v14, v6, s[16:19], s38 offen offset:2048
    v_cvt_pk_bf16_f32 v15, v187, v191
    buffer_store_dword v15, v6, s[16:19], s38 offen offset:2112
    s_mov_b32 s38, 229376
    v_cvt_pk_bf16_f32 v8, v192, v196
    buffer_store_dword v8, v6, s[16:19], s38 offen offset:0
    v_cvt_pk_bf16_f32 v9, v200, v204
    buffer_store_dword v9, v6, s[16:19], s38 offen offset:64
    v_cvt_pk_bf16_f32 v10, v193, v197
    buffer_store_dword v10, v6, s[16:19], s38 offen offset:2048
    v_cvt_pk_bf16_f32 v11, v201, v205
    buffer_store_dword v11, v6, s[16:19], s38 offen offset:2112
    s_mov_b32 s38, 233472
    v_cvt_pk_bf16_f32 v12, v194, v198
    buffer_store_dword v12, v6, s[16:19], s38 offen offset:0
    v_cvt_pk_bf16_f32 v13, v202, v206
    buffer_store_dword v13, v6, s[16:19], s38 offen offset:64
    v_cvt_pk_bf16_f32 v14, v195, v199
    buffer_store_dword v14, v6, s[16:19], s38 offen offset:2048
    v_cvt_pk_bf16_f32 v15, v203, v207
    buffer_store_dword v15, v6, s[16:19], s38 offen offset:2112
    s_mov_b32 s38, 262144
    v_cvt_pk_bf16_f32 v8, v208, v212
    buffer_store_dword v8, v6, s[16:19], s38 offen offset:0
    v_cvt_pk_bf16_f32 v9, v216, v220
    buffer_store_dword v9, v6, s[16:19], s38 offen offset:64
    v_cvt_pk_bf16_f32 v10, v209, v213
    buffer_store_dword v10, v6, s[16:19], s38 offen offset:2048
    v_cvt_pk_bf16_f32 v11, v217, v221
    buffer_store_dword v11, v6, s[16:19], s38 offen offset:2112
    s_mov_b32 s38, 266240
    v_cvt_pk_bf16_f32 v12, v210, v214
    buffer_store_dword v12, v6, s[16:19], s38 offen offset:0
    v_cvt_pk_bf16_f32 v13, v218, v222
    buffer_store_dword v13, v6, s[16:19], s38 offen offset:64
    v_cvt_pk_bf16_f32 v14, v211, v215
    buffer_store_dword v14, v6, s[16:19], s38 offen offset:2048
    v_cvt_pk_bf16_f32 v15, v219, v223
    buffer_store_dword v15, v6, s[16:19], s38 offen offset:2112
    s_mov_b32 s38, 294912
    v_cvt_pk_bf16_f32 v8, v224, v228
    buffer_store_dword v8, v6, s[16:19], s38 offen offset:0
    v_cvt_pk_bf16_f32 v9, v232, v236
    buffer_store_dword v9, v6, s[16:19], s38 offen offset:64
    v_cvt_pk_bf16_f32 v10, v225, v229
    buffer_store_dword v10, v6, s[16:19], s38 offen offset:2048
    v_cvt_pk_bf16_f32 v11, v233, v237
    buffer_store_dword v11, v6, s[16:19], s38 offen offset:2112
    s_mov_b32 s38, 299008
    v_cvt_pk_bf16_f32 v12, v226, v230
    buffer_store_dword v12, v6, s[16:19], s38 offen offset:0
    v_cvt_pk_bf16_f32 v13, v234, v238
    buffer_store_dword v13, v6, s[16:19], s38 offen offset:64
    v_cvt_pk_bf16_f32 v14, v227, v231
    buffer_store_dword v14, v6, s[16:19], s38 offen offset:2048
    v_cvt_pk_bf16_f32 v15, v235, v239
    buffer_store_dword v15, v6, s[16:19], s38 offen offset:2112
    s_mov_b32 s38, 327680
    v_cvt_pk_bf16_f32 v8, v240, v244
    buffer_store_dword v8, v6, s[16:19], s38 offen offset:0
    v_cvt_pk_bf16_f32 v9, v248, v252
    buffer_store_dword v9, v6, s[16:19], s38 offen offset:64
    v_cvt_pk_bf16_f32 v10, v241, v245
    buffer_store_dword v10, v6, s[16:19], s38 offen offset:2048
    v_cvt_pk_bf16_f32 v11, v249, v253
    buffer_store_dword v11, v6, s[16:19], s38 offen offset:2112
    s_mov_b32 s38, 331776
    v_cvt_pk_bf16_f32 v12, v242, v246
    buffer_store_dword v12, v6, s[16:19], s38 offen offset:0
    v_cvt_pk_bf16_f32 v13, v250, v254
    buffer_store_dword v13, v6, s[16:19], s38 offen offset:64
    v_cvt_pk_bf16_f32 v14, v243, v247
    buffer_store_dword v14, v6, s[16:19], s38 offen offset:2048
    v_cvt_pk_bf16_f32 v15, v251, v255
    buffer_store_dword v15, v6, s[16:19], s38 offen offset:2112
    s_endpgm
K12_S0:
    s_mov_b32 s61, 4096
    s_add_u32 s62, s62, 1
K12_S0_L:
    ds_read_b32 v56, v5
    s_waitcnt lgkmcnt(0)
    v_cmp_gt_u32 vcc, s40, v56
    s_sub_u32 s61, s61, 1
    s_cmp_eq_u32 s61, 0
    s_cbranch_scc1 K12_Q0
    s_cbranch_vccz K12_Q0
    s_branch K12_S0_L
K12_S1:
    s_mov_b32 s61, 4096
    s_add_u32 s62, s62, 1
K12_S1_L:
    ds_read_b32 v60, v5
    s_waitcnt lgkmcnt(0)
    v_cmp_gt_u32 vcc, s40, v60
    s_sub_u32 s61, s61, 1
    s_cmp_eq_u32 s61, 0
    s_cbranch_scc1 K12_Q1
    s_cbranch_vccz K12_Q1
    s_branch K12_S1_L
K12_F2:
    s_mov_b32 s61, 4096
    s_add_u32 s63, s63, 1
K12_F2_L:
    s_mov_b32 m0, s46
    s_mov_b64 exec, 0xff
    buffer_load_dword v1, s[4:7], 0 offen sc1 lds
    s_mov_b64 exec, -1
    s_waitcnt vmcnt(0)
    v_mov_b32 v0, s48
    ds_read_b32 v0, v0
    s_waitcnt lgkmcnt(0)
    v_cmp_eq_u32 vcc, 0, v0
    s_sub_u32 s61, s61, 1
    s_cmp_eq_u32 s61, 0
    s_cbranch_scc1 K12_F2_X
    s_cbranch_vccz K12_F2_X
    s_sleep 2
    s_branch K12_F2_L
K12_F2_X:
    s_branch K12_G2
K12_S3:
    s_mov_b32 s61, 4096
    s_add_u32 s62, s62, 1
K12_S3_L:
    ds_read_b32 v56, v5
    s_waitcnt lgkmcnt(0)
    v_cmp_gt_u32 vcc, s51, v56
    s_sub_u32 s61, s61, 1
    s_cmp_eq_u32 s61, 0
    s_cbranch_scc1 K12_Q3
    s_cbranch_vccz K12_Q3
    s_branch K12_S3_L
K12_S4:
    s_mov_b32 s61, 4096
    s_add_u32 s62, s62, 1
K12_S4_L:
    ds_read_b32 v44, v5
    s_waitcnt lgkmcnt(0)
    v_cmp_gt_u32 vcc, s40, v44
    s_sub_u32 s61, s61, 1
    s_cmp_eq_u32 s61, 0
    s_cbranch_scc1 K12_Q4
    s_cbranch_vccz K12_Q4
    s_branch K12_S4_L
K12_S5:
    s_mov_b32 s61, 4096
    s_add_u32 s62, s62, 1
K12_S5_L:
    ds_read_b32 v40, v5
    s_waitcnt lgkmcnt(0)
    v_cmp_gt_u32 vcc, s51, v40
    s_sub_u32 s61, s61, 1
    s_cmp_eq_u32 s61, 0
    s_cbranch_scc1 K12_Q5
    s_cbranch_vccz K12_Q5
    s_branch K12_S5_L
K12_END:
    s_endpgm
.p2align 8
.type k34_out_kernel,@function
k34_out_kernel:
    s_cmp_ge_u32 s2, 256
    s_cbranch_scc1 K34_END
    s_load_dwordx2 s[4:5], s[0:1], 48
    s_load_dwordx4 s[40:43], s[0:1], 16
    s_load_dwordx2 s[44:45], s[0:1], 32
    v_lshrrev_b32 v1, 6, v0
    v_and_b32 v2, 63, v0
    v_readfirstlane_b32 s3, v1
    s_and_b32 s6, s2, 15
    s_lshr_b32 s7, s2, 4
    s_lshr_b32 s20, s6, 3
    s_and_b32 s21, s6, 7
    s_mul_i32 s22, s7, 11
    s_mul_i32 s23, s7, 10
    s_add_u32 s23, s23, 7
    s_cmp_lt_u32 s7, 7
    s_cselect_b32 s22, s22, s23
    s_cselect_b32 s23, 11, 10
    s_add_u32 s22, s22, s3
    v_and_b32 v3, 15, v2
    v_lshrrev_b32 v4, 4, v2
    v_lshlrev_b32 v5, 4, v2
    s_mov_b32 s24, 2736128
    v_mul_lo_u32 v6, v4, s24
    v_lshl_add_u32 v6, v3, 4, v6
    s_mul_i32 s25, s20, 167
    s_add_u32 s25, s25, s22
    s_lshl_b32 s25, s25, 11
    s_lshl_b32 s24, s21, 8
    s_add_u32 s25, s25, s24
    s_waitcnt lgkmcnt(0)
    s_add_u32 s8, s4, 118489088
    s_addc_u32 s9, s5, 0
    s_and_b32 s9, s9, 0xffff
    s_mov_b32 s10, 21889024
    s_mov_b32 s11, 0x00020000
    s_add_u32 s12, s4, 153616384
    s_addc_u32 s13, s5, 0
    s_and_b32 s13, s13, 0xffff
    s_mov_b32 s14, 131072
    s_mov_b32 s15, 0x00020000
    s_cmp_lt_u32 s3, s23
    s_cbranch_scc0 K34_NOLOAD
    buffer_load_dwordx4 v[16:19], v6, s[8:11], s25 offen
    s_add_u32 s25, s25, 684032
    buffer_load_dwordx4 v[20:23], v6, s[8:11], s25 offen
    s_add_u32 s25, s25, 684032
    buffer_load_dwordx4 v[24:27], v6, s[8:11], s25 offen
    s_add_u32 s25, s25, 684032
    buffer_load_dwordx4 v[28:31], v6, s[8:11], s25 offen
    s_add_u32 s25, s25, 8892416
    buffer_load_dwordx4 v[32:35], v6, s[8:11], s25 offen
    s_add_u32 s25, s25, 684032
    buffer_load_dwordx4 v[36:39], v6, s[8:11], s25 offen
    s_add_u32 s25, s25, 684032
    buffer_load_dwordx4 v[40:43], v6, s[8:11], s25 offen
    s_add_u32 s25, s25, 684032
    buffer_load_dwordx4 v[44:47], v6, s[8:11], s25 offen
K34_NOLOAD:
    s_cmp_lg_u32 s3, 0
    s_cbranch_scc1 K34_TAB
    s_mov_b32 s16, s40
    s_mov_b32 s17, s41
    s_and_b32 s17, s17, 0xffff
    s_mov_b32 s18, 1024
    s_mov_b32 s19, 0x00020000
    s_mov_b32 s28, s42
    s_mov_b32 s29, s43
    s_and_b32 s29, s29, 0xffff
    s_mov_b32 s30, 1024
    s_mov_b32 s31, 0x00020000
    s_lshl_b32 s24, s21, 7
    v_lshlrev_b32 v8, 1, v2
    buffer_load_ushort v152, v8, s[16:19], s24 offen
    buffer_load_ushort v153, v8, s[28:31], s24 offen
    s_branch K34_TABDONE
K34_TAB:
    s_cmp_ge_u32 s3, 7
    s_cbranch_scc1 K34_TABDONE
    s_sub_u32 s27, s3, 1
    s_lshr_b32 s28, s27, 1
    s_and_b32 s29, s27, 1
    s_lshl_b32 s30, s28, 4
    v_add_u32 v8, s30, v3
    s_lshl_b32 s30, s29, 5
    s_add_u32 s30, s30, 1
    v_lshlrev_b32 v9, 3, v4
    v_add_u32 v9, s30, v9
    v_mul_u32_u24 v9, v8, v9
    v_lshlrev_b32 v8, 1, v8
    v_mad_u32_u24 v48, v8, 0, v9
    v_mad_u32_u24 v49, v8, 0, v9
    v_add_u32 v49, 32, v49
    v_mad_u32_u24 v50, v8, 1, v9
    v_mad_u32_u24 v51, v8, 1, v9
    v_add_u32 v51, 32, v51
    v_mad_u32_u24 v52, v8, 2, v9
    v_mad_u32_u24 v53, v8, 2, v9
    v_add_u32 v53, 32, v53
    v_mad_u32_u24 v54, v8, 3, v9
    v_mad_u32_u24 v55, v8, 3, v9
    v_add_u32 v55, 32, v55
    v_and_b32 v48, 127, v48
    v_and_b32 v49, 127, v49
    v_and_b32 v50, 127, v50
    v_and_b32 v51, 127, v51
    v_and_b32 v52, 127, v52
    v_and_b32 v53, 127, v53
    v_and_b32 v54, 127, v54
    v_and_b32 v55, 127, v55
    v_cvt_f32_u32 v48, v48
    v_cvt_f32_u32 v49, v49
    v_cvt_f32_u32 v50, v50
    v_cvt_f32_u32 v51, v51
    v_cvt_f32_u32 v52, v52
    v_cvt_f32_u32 v53, v53
    v_cvt_f32_u32 v54, v54
    v_cvt_f32_u32 v55, v55
    v_mul_f32 v48, 0x3c000000, v48
    v_mul_f32 v49, 0x3c000000, v49
    v_mul_f32 v50, 0x3c000000, v50
    v_mul_f32 v51, 0x3c000000, v51
    v_mul_f32 v52, 0x3c000000, v52
    v_mul_f32 v53, 0x3c000000, v53
    v_mul_f32 v54, 0x3c000000, v54
    v_mul_f32 v55, 0x3c000000, v55
    v_cos_f32 v48, v48
    v_cos_f32 v49, v49
    v_cos_f32 v50, v50
    v_cos_f32 v51, v51
    v_cos_f32 v52, v52
    v_cos_f32 v53, v53
    v_cos_f32 v54, v54
    v_cos_f32 v55, v55
    s_nop 0
    v_mul_f32 v48, 0x3d000000, v48
    v_mul_f32 v49, 0x3d000000, v49
    v_mul_f32 v50, 0x3d000000, v50
    v_mul_f32 v51, 0x3d000000, v51
    v_mul_f32 v52, 0x3d000000, v52
    v_mul_f32 v53, 0x3d000000, v53
    v_mul_f32 v54, 0x3d000000, v54
    v_mul_f32 v55, 0x3d000000, v55
    v_cvt_pk_bf16_f32 v56, v48, v49
    v_cvt_pk_bf16_f32 v57, v50, v51
    v_cvt_pk_bf16_f32 v58, v52, v53
    v_cvt_pk_bf16_f32 v59, v54, v55
    v_lshlrev_b32 v64, 16, v56
    v_and_b32 v65, 0xffff0000, v56
    v_sub_f32 v48, v48, v64
    v_sub_f32 v49, v49, v65
    v_lshlrev_b32 v64, 16, v57
    v_and_b32 v65, 0xffff0000, v57
    v_sub_f32 v50, v50, v64
    v_sub_f32 v51, v51, v65
    v_lshlrev_b32 v64, 16, v58
    v_and_b32 v65, 0xffff0000, v58
    v_sub_f32 v52, v52, v64
    v_sub_f32 v53, v53, v65
    v_lshlrev_b32 v64, 16, v59
    v_and_b32 v65, 0xffff0000, v59
    v_sub_f32 v54, v54, v64
    v_sub_f32 v55, v55, v65
    v_cvt_pk_bf16_f32 v60, v48, v49
    v_cvt_pk_bf16_f32 v61, v50, v51
    v_cvt_pk_bf16_f32 v62, v52, v53
    v_cvt_pk_bf16_f32 v63, v54, v55
    s_lshl_b32 s30, s27, 11
    v_add_u32 v10, s30, v5
    ds_write_b128 v10, v[56:59]
    ds_write_b128 v10, v[60:63] offset:1024
K34_TABDONE:
    s_waitcnt lgkmcnt(0)
    s_barrier
    s_cmp_lt_u32 s3, s23
    s_cbranch_scc0 K34_IDLE
    ds_read_b128 v[48:51], v5 offset:0
    ds_read_b128 v[52:55], v5 offset:1024
    ds_read_b128 v[56:59], v5 offset:2048
    ds_read_b128 v[60:63], v5 offset:3072
    ds_read_b128 v[64:67], v5 offset:4096
    ds_read_b128 v[68:71], v5 offset:5120
    ds_read_b128 v[72:75], v5 offset:6144
    ds_read_b128 v[76:79], v5 offset:7168
    ds_read_b128 v[80:83], v5 offset:8192
    ds_read_b128 v[84:87], v5 offset:9216
    ds_read_b128 v[88:91], v5 offset:10240
    ds_read_b128 v[92:95], v5 offset:11264
    s_waitcnt vmcnt(0)
    v_swap_b32 v17, v20
    v_swap_b32 v18, v24
    v_swap_b32 v19, v28
    v_swap_b32 v22, v25
    v_swap_b32 v23, v29
    v_swap_b32 v27, v30
    v_swap_b32 v33, v36
    v_swap_b32 v34, v40
    v_swap_b32 v35, v44
    v_swap_b32 v38, v41
    v_swap_b32 v39, v45
    v_swap_b32 v43, v46
    s_waitcnt lgkmcnt(0)
    s_mul_i32 s24, s22, 48
    s_sub_u32 s24, 7985, s24
    s_cmp_ge_u32 s24, 48
    s_cbranch_scc1 K34_FULL
    v_add_u32 v7, 0, v3
    v_cmp_gt_u32 vcc, s24, v7
    s_nop 1
    v_cndmask_b32 v48, 0, v48, vcc
    v_cndmask_b32 v49, 0, v49, vcc
    v_cndmask_b32 v50, 0, v50, vcc
    v_cndmask_b32 v51, 0, v51, vcc
    v_cndmask_b32 v52, 0, v52, vcc
    v_cndmask_b32 v53, 0, v53, vcc
    v_cndmask_b32 v54, 0, v54, vcc
    v_cndmask_b32 v55, 0, v55, vcc
    v_cndmask_b32 v56, 0, v56, vcc
    v_cndmask_b32 v57, 0, v57, vcc
    v_cndmask_b32 v58, 0, v58, vcc
    v_cndmask_b32 v59, 0, v59, vcc
    v_cndmask_b32 v60, 0, v60, vcc
    v_cndmask_b32 v61, 0, v61, vcc
    v_cndmask_b32 v62, 0, v62, vcc
    v_cndmask_b32 v63, 0, v63, vcc
    v_add_u32 v7, 16, v3
    v_cmp_gt_u32 vcc, s24, v7
    s_nop 1
    v_cndmask_b32 v64, 0, v64, vcc
    v_cndmask_b32 v65, 0, v65, vcc
    v_cndmask_b32 v66, 0, v66, vcc
    v_cndmask_b32 v67, 0, v67, vcc
    v_cndmask_b32 v68, 0, v68, vcc
    v_cndmask_b32 v69, 0, v69, vcc
    v_cndmask_b32 v70, 0, v70, vcc
    v_cndmask_b32 v71, 0, v71, vcc
    v_cndmask_b32 v72, 0, v72, vcc
    v_cndmask_b32 v73, 0, v73, vcc
    v_cndmask_b32 v74, 0, v74, vcc
    v_cndmask_b32 v75, 0, v75, vcc
    v_cndmask_b32 v76, 0, v76, vcc
    v_cndmask_b32 v77, 0, v77, vcc
    v_cndmask_b32 v78, 0, v78, vcc
    v_cndmask_b32 v79, 0, v79, vcc
    v_add_u32 v7, 32, v3
    v_cmp_gt_u32 vcc, s24, v7
    s_nop 1
    v_cndmask_b32 v80, 0, v80, vcc
    v_cndmask_b32 v81, 0, v81, vcc
    v_cndmask_b32 v82, 0, v82, vcc
    v_cndmask_b32 v83, 0, v83, vcc
    v_cndmask_b32 v84, 0, v84, vcc
    v_cndmask_b32 v85, 0, v85, vcc
    v_cndmask_b32 v86, 0, v86, vcc
    v_cndmask_b32 v87, 0, v87, vcc
    v_cndmask_b32 v88, 0, v88, vcc
    v_cndmask_b32 v89, 0, v89, vcc
    v_cndmask_b32 v90, 0, v90, vcc
    v_cndmask_b32 v91, 0, v91, vcc
    v_cndmask_b32 v92, 0, v92, vcc
    v_cndmask_b32 v93, 0, v93, vcc
    v_cndmask_b32 v94, 0, v94, vcc
    v_cndmask_b32 v95, 0, v95, vcc
K34_FULL:
    s_nop 1
    v_mfma_f32_16x16x32_bf16 v[96:99], v[48:51], v[16:19], 0
    v_mfma_f32_16x16x32_bf16 v[100:103], v[48:51], v[20:23], 0
    v_mfma_f32_16x16x32_bf16 v[104:107], v[48:51], v[24:27], 0
    v_mfma_f32_16x16x32_bf16 v[108:111], v[48:51], v[28:31], 0
    v_mfma_f32_16x16x32_bf16 v[96:99], v[52:55], v[16:19], v[96:99]
    v_mfma_f32_16x16x32_bf16 v[100:103], v[52:55], v[20:23], v[100:103]
    v_mfma_f32_16x16x32_bf16 v[104:107], v[52:55], v[24:27], v[104:107]
    v_mfma_f32_16x16x32_bf16 v[108:111], v[52:55], v[28:31], v[108:111]
    v_mfma_f32_16x16x32_bf16 v[96:99], v[56:59], v[32:35], v[96:99]
    v_mfma_f32_16x16x32_bf16 v[100:103], v[56:59], v[36:39], v[100:103]
    v_mfma_f32_16x16x32_bf16 v[104:107], v[56:59], v[40:43], v[104:107]
    v_mfma_f32_16x16x32_bf16 v[108:111], v[56:59], v[44:47], v[108:111]
    v_mfma_f32_16x16x32_bf16 v[96:99], v[60:63], v[32:35], v[96:99]
    v_mfma_f32_16x16x32_bf16 v[100:103], v[60:63], v[36:39], v[100:103]
    v_mfma_f32_16x16x32_bf16 v[104:107], v[60:63], v[40:43], v[104:107]
    v_mfma_f32_16x16x32_bf16 v[108:111], v[60:63], v[44:47], v[108:111]
    v_mfma_f32_16x16x32_bf16 v[112:115], v[64:67], v[16:19], 0
    v_mfma_f32_16x16x32_bf16 v[116:119], v[64:67], v[20:23], 0
    v_mfma_f32_16x16x32_bf16 v[120:123], v[64:67], v[24:27], 0
    v_mfma_f32_16x16x32_bf16 v[124:127], v[64:67], v[28:31], 0
    v_mfma_f32_16x16x32_bf16 v[112:115], v[68:71], v[16:19], v[112:115]
    v_mfma_f32_16x16x32_bf16 v[116:119], v[68:71], v[20:23], v[116:119]
    v_mfma_f32_16x16x32_bf16 v[120:123], v[68:71], v[24:27], v[120:123]
    v_mfma_f32_16x16x32_bf16 v[124:127], v[68:71], v[28:31], v[124:127]
    v_mfma_f32_16x16x32_bf16 v[112:115], v[72:75], v[32:35], v[112:115]
    v_mfma_f32_16x16x32_bf16 v[116:119], v[72:75], v[36:39], v[116:119]
    v_mfma_f32_16x16x32_bf16 v[120:123], v[72:75], v[40:43], v[120:123]
    v_mfma_f32_16x16x32_bf16 v[124:127], v[72:75], v[44:47], v[124:127]
    v_mfma_f32_16x16x32_bf16 v[112:115], v[76:79], v[32:35], v[112:115]
    v_mfma_f32_16x16x32_bf16 v[116:119], v[76:79], v[36:39], v[116:119]
    v_mfma_f32_16x16x32_bf16 v[120:123], v[76:79], v[40:43], v[120:123]
    v_mfma_f32_16x16x32_bf16 v[124:127], v[76:79], v[44:47], v[124:127]
    v_mfma_f32_16x16x32_bf16 v[128:131], v[80:83], v[16:19], 0
    v_mfma_f32_16x16x32_bf16 v[132:135], v[80:83], v[20:23], 0
    v_mfma_f32_16x16x32_bf16 v[136:139], v[80:83], v[24:27], 0
    v_mfma_f32_16x16x32_bf16 v[140:143], v[80:83], v[28:31], 0
    v_mfma_f32_16x16x32_bf16 v[128:131], v[84:87], v[16:19], v[128:131]
    v_mfma_f32_16x16x32_bf16 v[132:135], v[84:87], v[20:23], v[132:135]
    v_mfma_f32_16x16x32_bf16 v[136:139], v[84:87], v[24:27], v[136:139]
    v_mfma_f32_16x16x32_bf16 v[140:143], v[84:87], v[28:31], v[140:143]
    v_mfma_f32_16x16x32_bf16 v[128:131], v[88:91], v[32:35], v[128:131]
    v_mfma_f32_16x16x32_bf16 v[132:135], v[88:91], v[36:39], v[132:135]
    v_mfma_f32_16x16x32_bf16 v[136:139], v[88:91], v[40:43], v[136:139]
    v_mfma_f32_16x16x32_bf16 v[140:143], v[88:91], v[44:47], v[140:143]
    v_mfma_f32_16x16x32_bf16 v[128:131], v[92:95], v[32:35], v[128:131]
    v_mfma_f32_16x16x32_bf16 v[132:135], v[92:95], v[36:39], v[132:135]
    v_mfma_f32_16x16x32_bf16 v[136:139], v[92:95], v[40:43], v[136:139]
    v_mfma_f32_16x16x32_bf16 v[140:143], v[92:95], v[44:47], v[140:143]
    s_nop 7
    v_mov_b32 v16, v96
    v_mul_f32 v20, v96, v96
    v_mov_b32 v17, v100
    v_mul_f32 v21, v100, v100
    v_mov_b32 v18, v104
    v_mul_f32 v22, v104, v104
    v_mov_b32 v19, v108
    v_mul_f32 v23, v108, v108
    v_add_f32 v16, v16, v97
    v_fmac_f32 v20, v97, v97
    v_add_f32 v17, v17, v101
    v_fmac_f32 v21, v101, v101
    v_add_f32 v18, v18, v105
    v_fmac_f32 v22, v105, v105
    v_add_f32 v19, v19, v109
    v_fmac_f32 v23, v109, v109
    v_add_f32 v16, v16, v98
    v_fmac_f32 v20, v98, v98
    v_add_f32 v17, v17, v102
    v_fmac_f32 v21, v102, v102
    v_add_f32 v18, v18, v106
    v_fmac_f32 v22, v106, v106
    v_add_f32 v19, v19, v110
    v_fmac_f32 v23, v110, v110
    v_add_f32 v16, v16, v99
    v_fmac_f32 v20, v99, v99
    v_add_f32 v17, v17, v103
    v_fmac_f32 v21, v103, v103
    v_add_f32 v18, v18, v107
    v_fmac_f32 v22, v107, v107
    v_add_f32 v19, v19, v111
    v_fmac_f32 v23, v111, v111
    v_add_f32 v16, v16, v112
    v_fmac_f32 v20, v112, v112
    v_add_f32 v17, v17, v116
    v_fmac_f32 v21, v116, v116
    v_add_f32 v18, v18, v120
    v_fmac_f32 v22, v120, v120
    v_add_f32 v19, v19, v124
    v_fmac_f32 v23, v124, v124
    v_add_f32 v16, v16, v113
    v_fmac_f32 v20, v113, v113
    v_add_f32 v17, v17, v117
    v_fmac_f32 v21, v117, v117
    v_add_f32 v18, v18, v121
    v_fmac_f32 v22, v121, v121
    v_add_f32 v19, v19, v125
    v_fmac_f32 v23, v125, v125
    v_add_f32 v16, v16, v114
    v_fmac_f32 v20, v114, v114
    v_add_f32 v17, v17, v118
    v_fmac_f32 v21, v118, v118
    v_add_f32 v18, v18, v122
    v_fmac_f32 v22, v122, v122
    v_add_f32 v19, v19, v126
    v_fmac_f32 v23, v126, v126
    v_add_f32 v16, v16, v115
    v_fmac_f32 v20, v115, v115
    v_add_f32 v17, v17, v119
    v_fmac_f32 v21, v119, v119
    v_add_f32 v18, v18, v123
    v_fmac_f32 v22, v123, v123
    v_add_f32 v19, v19, v127
    v_fmac_f32 v23, v127, v127
    v_add_f32 v16, v16, v128
    v_fmac_f32 v20, v128, v128
    v_add_f32 v17, v17, v132
    v_fmac_f32 v21, v132, v132
    v_add_f32 v18, v18, v136
    v_fmac_f32 v22, v136, v136
    v_add_f32 v19, v19, v140
    v_fmac_f32 v23, v140, v140
    v_add_f32 v16, v16, v129
    v_fmac_f32 v20, v129, v129
    v_add_f32 v17, v17, v133
    v_fmac_f32 v21, v133, v133
    v_add_f32 v18, v18, v137
    v_fmac_f32 v22, v137, v137
    v_add_f32 v19, v19, v141
    v_fmac_f32 v23, v141, v141
    v_add_f32 v16, v16, v130
    v_fmac_f32 v20, v130, v130
    v_add_f32 v17, v17, v134
    v_fmac_f32 v21, v134, v134
    v_add_f32 v18, v18, v138
    v_fmac_f32 v22, v138, v138
    v_add_f32 v19, v19, v142
    v_fmac_f32 v23, v142, v142
    v_add_f32 v16, v16, v131
    v_fmac_f32 v20, v131, v131
    v_add_f32 v17, v17, v135
    v_fmac_f32 v21, v135, v135
    v_add_f32 v18, v18, v139
    v_fmac_f32 v22, v139, v139
    v_add_f32 v19, v19, v143
    v_fmac_f32 v23, v143, v143
    v_mov_b32 v24, v16
    v_mov_b32 v25, v17
    v_mov_b32 v26, v18
    v_mov_b32 v27, v19
    v_mov_b32 v28, v20
    v_mov_b32 v29, v21
    v_mov_b32 v30, v22
    v_mov_b32 v31, v23
    s_nop 0
    v_permlane32_swap_b32 v16, v24
    v_permlane32_swap_b32 v17, v25
    v_permlane32_swap_b32 v18, v26
    v_permlane32_swap_b32 v19, v27
    v_permlane32_swap_b32 v20, v28
    v_permlane32_swap_b32 v21, v29
    v_permlane32_swap_b32 v22, v30
    v_permlane32_swap_b32 v23, v31
    v_add_f32 v16, v16, v24
    v_add_f32 v17, v17, v25
    v_add_f32 v18, v18, v26
    v_add_f32 v19, v19, v27
    v_add_f32 v20, v20, v28
    v_add_f32 v21, v21, v29
    v_add_f32 v22, v22, v30
    v_add_f32 v23, v23, v31
    v_mov_b32 v24, v16
    v_mov_b32 v25, v17
    v_mov_b32 v26, v18
    v_mov_b32 v27, v19
    v_mov_b32 v28, v20
    v_mov_b32 v29, v21
    v_mov_b32 v30, v22
    v_mov_b32 v31, v23
    s_nop 0
    v_permlane16_swap_b32 v16, v24
    v_permlane16_swap_b32 v17, v25
    v_permlane16_swap_b32 v18, v26
    v_permlane16_swap_b32 v19, v27
    v_permlane16_swap_b32 v20, v28
    v_permlane16_swap_b32 v21, v29
    v_permlane16_swap_b32 v22, v30
    v_permlane16_swap_b32 v23, v31
    v_add_f32 v16, v16, v24
    v_add_f32 v17, v17, v25
    v_add_f32 v18, v18, v26
    v_add_f32 v19, v19, v27
    v_add_f32 v20, v20, v28
    v_add_f32 v21, v21, v29
    v_add_f32 v22, v22, v30
    v_add_f32 v23, v23, v31
    s_branch K34_WR
K34_IDLE:
    v_mov_b32 v16, 0
    v_mov_b32 v17, 0
    v_mov_b32 v18, 0
    v_mov_b32 v19, 0
    v_mov_b32 v20, 0
    v_mov_b32 v21, 0
    v_mov_b32 v22, 0
    v_mov_b32 v23, 0
K34_WR:
    s_lshl_b32 s24, s3, 9
    v_lshlrev_b32 v7, 4, v3
    v_add_u32 v7, s24, v7
    ds_write_b128 v7, v[16:19] offset:12288
    ds_write_b128 v7, v[20:23] offset:12544
    s_waitcnt lgkmcnt(0)
    s_barrier
    s_cmp_lg_u32 s3, 0
    s_cbranch_scc1 K34_WAIT
    v_lshlrev_b32 v7, 2, v2
    ds_read_b32 v16, v7 offset:12288
    ds_read_b32 v17, v7 offset:12800
    ds_read_b32 v18, v7 offset:13312
    ds_read_b32 v19, v7 offset:13824
    ds_read_b32 v20, v7 offset:14336
    ds_read_b32 v21, v7 offset:14848
    ds_read_b32 v22, v7 offset:15360
    ds_read_b32 v23, v7 offset:15872
    ds_read_b32 v24, v7 offset:16384
    ds_read_b32 v25, v7 offset:16896
    ds_read_b32 v26, v7 offset:17408
    ds_read_b32 v27, v7 offset:17920
    s_waitcnt lgkmcnt(0)
    ds_read_b32 v32, v7 offset:12544
    ds_read_b32 v33, v7 offset:13056
    ds_read_b32 v34, v7 offset:13568
    ds_read_b32 v35, v7 offset:14080
    ds_read_b32 v36, v7 offset:14592
    ds_read_b32 v37, v7 offset:15104
    ds_read_b32 v38, v7 offset:15616
    ds_read_b32 v39, v7 offset:16128
    ds_read_b32 v40, v7 offset:16640
    ds_read_b32 v41, v7 offset:17152
    ds_read_b32 v42, v7 offset:17664
    ds_read_b32 v43, v7 offset:18176
    v_add_f32 v16, v16, v17
    v_add_f32 v16, v16, v18
    v_add_f32 v16, v16, v19
    v_add_f32 v16, v16, v20
    v_add_f32 v16, v16, v21
    v_add_f32 v16, v16, v22
    v_add_f32 v16, v16, v23
    v_add_f32 v16, v16, v24
    v_add_f32 v16, v16, v25
    v_add_f32 v16, v16, v26
    v_add_f32 v16, v16, v27
    s_waitcnt lgkmcnt(0)
    v_add_f32 v32, v32, v33
    v_add_f32 v32, v32, v34
    v_add_f32 v32, v32, v35
    v_add_f32 v32, v32, v36
    v_add_f32 v32, v32, v37
    v_add_f32 v32, v32, v38
    v_add_f32 v32, v32, v39
    v_add_f32 v32, v32, v40
    v_add_f32 v32, v32, v41
    v_add_f32 v32, v32, v42
    v_add_f32 v32, v32, v43
    s_lshl_b32 s24, s6, 4
    s_add_u32 s24, s24, s7
    s_lshl_b32 s24, s24, 9
    buffer_store_dword v16, v7, s[12:15], s24 offen sc1
    buffer_store_dword v32, v7, s[12:15], s24 offen offset:256 sc1
    s_mov_b32 s26, 20000
K34_POLL:
    s_lshl_b32 s24, s6, 13
    buffer_load_dword v16, v7, s[12:15], s24 offen offset:0 sc1
    buffer_load_dword v32, v7, s[12:15], s24 offen offset:256 sc1
    buffer_load_dword v17, v7, s[12:15], s24 offen offset:512 sc1
    buffer_load_dword v33, v7, s[12:15], s24 offen offset:768 sc1
    buffer_load_dword v18, v7, s[12:15], s24 offen offset:1024 sc1
    buffer_load_dword v34, v7, s[12:15], s24 offen offset:1280 sc1
    buffer_load_dword v19, v7, s[12:15], s24 offen offset:1536 sc1
    buffer_load_dword v35, v7, s[12:15], s24 offen offset:1792 sc1
    buffer_load_dword v20, v7, s[12:15], s24 offen offset:2048 sc1
    buffer_load_dword v36, v7, s[12:15], s24 offen offset:2304 sc1
    buffer_load_dword v21, v7, s[12:15], s24 offen offset:2560 sc1
    buffer_load_dword v37, v7, s[12:15], s24 offen offset:2816 sc1
    buffer_load_dword v22, v7, s[12:15], s24 offen offset:3072 sc1
    buffer_load_dword v38, v7, s[12:15], s24 offen offset:3328 sc1
    buffer_load_dword v23, v7, s[12:15], s24 offen offset:3584 sc1
    buffer_load_dword v39, v7, s[12:15], s24 offen offset:3840 sc1
    s_add_u32 s24, s24, 4096
    buffer_load_dword v24, v7, s[12:15], s24 offen offset:0 sc1
    buffer_load_dword v40, v7, s[12:15], s24 offen offset:256 sc1
    buffer_load_dword v25, v7, s[12:15], s24 offen offset:512 sc1
    buffer_load_dword v41, v7, s[12:15], s24 offen offset:768 sc1
    buffer_load_dword v26, v7, s[12:15], s24 offen offset:1024 sc1
    buffer_load_dword v42, v7, s[12:15], s24 offen offset:1280 sc1
    buffer_load_dword v27, v7, s[12:15], s24 offen offset:1536 sc1
    buffer_load_dword v43, v7, s[12:15], s24 offen offset:1792 sc1
    buffer_load_dword v28, v7, s[12:15], s24 offen offset:2048 sc1
    buffer_load_dword v44, v7, s[12:15], s24 offen offset:2304 sc1
    buffer_load_dword v29, v7, s[12:15], s24 offen offset:2560 sc1
    buffer_load_dword v45, v7, s[12:15], s24 offen offset:2816 sc1
    buffer_load_dword v30, v7, s[12:15], s24 offen offset:3072 sc1
    buffer_load_dword v46, v7, s[12:15], s24 offen offset:3328 sc1
    buffer_load_dword v31, v7, s[12:15], s24 offen offset:3584 sc1
    buffer_load_dword v47, v7, s[12:15], s24 offen offset:3840 sc1
    s_waitcnt vmcnt(0)
    v_max3_u32 v48, v16, v17, v18
    v_max3_u32 v48, v48, v19, v20
    v_max3_u32 v48, v48, v21, v22
    v_max3_u32 v48, v48, v23, v24
    v_max3_u32 v48, v48, v25, v26
    v_max3_u32 v48, v48, v27, v28
    v_max3_u32 v48, v48, v29, v30
    v_max3_u32 v48, v48, v31, v32
    v_max3_u32 v48, v48, v33, v34
    v_max3_u32 v48, v48, v35, v36
    v_max3_u32 v48, v48, v37, v38
    v_max3_u32 v48, v48, v39, v40
    v_max3_u32 v48, v48, v41, v42
    v_max3_u32 v48, v48, v43, v44
    v_max3_u32 v48, v48, v45, v46
    v_max_u32 v48, v48, v47
    v_cmp_eq_u32 vcc, -1, v48
    s_sub_u32 s26, s26, 1
    s_cmp_eq_u32 s26, 0
    s_cbranch_scc1 K34_GOT
    s_cbranch_vccz K34_GOT
    s_sleep 1
    s_branch K34_POLL
K34_GOT:
    v_add_f32 v16, v16, v24
    v_add_f32 v32, v32, v40
    v_add_f32 v17, v17, v25
    v_add_f32 v33, v33, v41
    v_add_f32 v18, v18, v26
    v_add_f32 v34, v34, v42
    v_add_f32 v19, v19, v27
    v_add_f32 v35, v35, v43
    v_add_f32 v20, v20, v28
    v_add_f32 v36, v36, v44
    v_add_f32 v21, v21, v29
    v_add_f32 v37, v37, v45
    v_add_f32 v22, v22, v30
    v_add_f32 v38, v38, v46
    v_add_f32 v23, v23, v31
    v_add_f32 v39, v39, v47
    v_add_f32 v16, v16, v20
    v_add_f32 v32, v32, v36
    v_add_f32 v17, v17, v21
    v_add_f32 v33, v33, v37
    v_add_f32 v18, v18, v22
    v_add_f32 v34, v34, v38
    v_add_f32 v19, v19, v23
    v_add_f32 v35, v35, v39
    v_add_f32 v16, v16, v18
    v_add_f32 v32, v32, v34
    v_add_f32 v17, v17, v19
    v_add_f32 v33, v33, v35
    v_add_f32 v16, v16, v17
    v_add_f32 v32, v32, v33
    v_mul_f32 v11, 0x39035177, v16
    v_mul_f32 v12, 0x39035177, v32
    v_fma_f32 v12, -v11, v11, v12
    v_max_f32 v12, 0, v12
    v_add_f32 v12, 0x3727c5ac, v12
    v_sqrt_f32 v12, v12
    v_lshlrev_b32 v9, 16, v152
    v_rcp_f32 v12, v12
    v_lshlrev_b32 v10, 16, v153
    v_mul_f32 v9, v9, v12
    v_fma_f32 v10, -v11, v9, v10
    ds_write_b32 v7, v9 offset:18432
    ds_write_b32 v7, v10 offset:18688
    s_waitcnt lgkmcnt(0)
K34_WAIT:
    s_barrier
    s_cmp_lt_u32 s3, s23
    s_cbranch_scc0 K34_END
    v_lshlrev_b32 v7, 4, v3
    ds_read_b128 v[144:147], v7 offset:18432
    ds_read_b128 v[148:151], v7 offset:18688
    s_mul_i32 s24, s20, 8176640
    s_add_u32 s16, s44, s24
    s_addc_u32 s17, s45, 0
    s_and_b32 s17, s17, 0xffff
    s_mov_b32 s18, 8176640
    s_mov_b32 s19, 0x00020000
    v_lshlrev_b32 v7, 12, v4
    v_lshl_add_u32 v7, v3, 3, v7
    s_lshl_b32 s24, s21, 7
    v_add_u32 v7, s24, v7
    s_mul_i32 s25, s22, 49152
    s_mov_b32 s30, 0xc0135761
    s_mov_b32 s31, 0xbdd2d3e8
    v_mov_b32 v15, s30
    s_waitcnt lgkmcnt(0)
    v_fma_f32 v16, v96, v144, v148
    v_fma_f32 v17, v100, v145, v149
    v_fma_f32 v18, v104, v146, v150
    v_fma_f32 v19, v108, v147, v151
    v_fma_f32 v20, v97, v144, v148
    v_fma_f32 v21, v101, v145, v149
    v_fma_f32 v22, v105, v146, v150
    v_fma_f32 v23, v109, v147, v151
    v_mul_f32 v24, v16, v16
    v_mul_f32 v25, v17, v17
    v_mul_f32 v26, v18, v18
    v_mul_f32 v27, v19, v19
    v_mul_f32 v28, v20, v20
    v_mul_f32 v29, v21, v21
    v_mul_f32 v30, v22, v22
    v_mul_f32 v31, v23, v23
    v_fma_f32 v24, v24, s31, v15
    v_fma_f32 v25, v25, s31, v15
    v_fma_f32 v26, v26, s31, v15
    v_fma_f32 v27, v27, s31, v15
    v_fma_f32 v28, v28, s31, v15
    v_fma_f32 v29, v29, s31, v15
    v_fma_f32 v30, v30, s31, v15
    v_fma_f32 v31, v31, s31, v15
    v_mul_f32 v24, v24, v16
    v_mul_f32 v25, v25, v17
    v_mul_f32 v26, v26, v18
    v_mul_f32 v27, v27, v19
    v_mul_f32 v28, v28, v20
    v_mul_f32 v29, v29, v21
    v_mul_f32 v30, v30, v22
    v_mul_f32 v31, v31, v23
    v_exp_f32 v24, v24
    v_exp_f32 v25, v25
    v_exp_f32 v26, v26
    v_exp_f32 v27, v27
    v_exp_f32 v28, v28
    v_exp_f32 v29, v29
    v_exp_f32 v30, v30
    v_exp_f32 v31, v31
    v_add_f32 v24, 1.0, v24
    v_add_f32 v25, 1.0, v25
    v_add_f32 v26, 1.0, v26
    v_add_f32 v27, 1.0, v27
    v_add_f32 v28, 1.0, v28
    v_add_f32 v29, 1.0, v29
    v_add_f32 v30, 1.0, v30
    v_add_f32 v31, 1.0, v31
    v_rcp_f32 v24, v24
    v_rcp_f32 v25, v25
    v_rcp_f32 v26, v26
    v_rcp_f32 v27, v27
    v_rcp_f32 v28, v28
    v_rcp_f32 v29, v29
    v_rcp_f32 v30, v30
    v_rcp_f32 v31, v31
    v_mul_f32 v16, v16, v24
    v_mul_f32 v17, v17, v25
    v_mul_f32 v18, v18, v26
    v_mul_f32 v19, v19, v27
    v_mul_f32 v20, v20, v28
    v_mul_f32 v21, v21, v29
    v_mul_f32 v22, v22, v30
    v_mul_f32 v23, v23, v31
    v_cvt_pk_bf16_f32 v32, v16, v17
    v_cvt_pk_bf16_f32 v33, v18, v19
    buffer_store_dwordx2 v[32:33], v7, s[16:19], s25 offen offset:0
    v_cvt_pk_bf16_f32 v34, v20, v21
    v_cvt_pk_bf16_f32 v35, v22, v23
    buffer_store_dwordx2 v[34:35], v7, s[16:19], s25 offen offset:1024
    s_add_u32 s25, s25, 2048
    v_fma_f32 v36, v98, v144, v148
    v_fma_f32 v37, v102, v145, v149
    v_fma_f32 v38, v106, v146, v150
    v_fma_f32 v39, v110, v147, v151
    v_fma_f32 v40, v99, v144, v148
    v_fma_f32 v41, v103, v145, v149
    v_fma_f32 v42, v107, v146, v150
    v_fma_f32 v43, v111, v147, v151
    v_mul_f32 v44, v36, v36
    v_mul_f32 v45, v37, v37
    v_mul_f32 v46, v38, v38
    v_mul_f32 v47, v39, v39
    v_mul_f32 v48, v40, v40
    v_mul_f32 v49, v41, v41
    v_mul_f32 v50, v42, v42
    v_mul_f32 v51, v43, v43
    v_fma_f32 v44, v44, s31, v15
    v_fma_f32 v45, v45, s31, v15
    v_fma_f32 v46, v46, s31, v15
    v_fma_f32 v47, v47, s31, v15
    v_fma_f32 v48, v48, s31, v15
    v_fma_f32 v49, v49, s31, v15
    v_fma_f32 v50, v50, s31, v15
    v_fma_f32 v51, v51, s31, v15
    v_mul_f32 v44, v44, v36
    v_mul_f32 v45, v45, v37
    v_mul_f32 v46, v46, v38
    v_mul_f32 v47, v47, v39
    v_mul_f32 v48, v48, v40
    v_mul_f32 v49, v49, v41
    v_mul_f32 v50, v50, v42
    v_mul_f32 v51, v51, v43
    v_exp_f32 v44, v44
    v_exp_f32 v45, v45
    v_exp_f32 v46, v46
    v_exp_f32 v47, v47
    v_exp_f32 v48, v48
    v_exp_f32 v49, v49
    v_exp_f32 v50, v50
    v_exp_f32 v51, v51
    v_add_f32 v44, 1.0, v44
    v_add_f32 v45, 1.0, v45
    v_add_f32 v46, 1.0, v46
    v_add_f32 v47, 1.0, v47
    v_add_f32 v48, 1.0, v48
    v_add_f32 v49, 1.0, v49
    v_add_f32 v50, 1.0, v50
    v_add_f32 v51, 1.0, v51
    v_rcp_f32 v44, v44
    v_rcp_f32 v45, v45
    v_rcp_f32 v46, v46
    v_rcp_f32 v47, v47
    v_rcp_f32 v48, v48
    v_rcp_f32 v49, v49
    v_rcp_f32 v50, v50
    v_rcp_f32 v51, v51
    v_mul_f32 v36, v36, v44
    v_mul_f32 v37, v37, v45
    v_mul_f32 v38, v38, v46
    v_mul_f32 v39, v39, v47
    v_mul_f32 v40, v40, v48
    v_mul_f32 v41, v41, v49
    v_mul_f32 v42, v42, v50
    v_mul_f32 v43, v43, v51
    v_cvt_pk_bf16_f32 v52, v36, v37
    v_cvt_pk_bf16_f32 v53, v38, v39
    buffer_store_dwordx2 v[52:53], v7, s[16:19], s25 offen offset:0
    v_cvt_pk_bf16_f32 v54, v40, v41
    v_cvt_pk_bf16_f32 v55, v42, v43
    buffer_store_dwordx2 v[54:55], v7, s[16:19], s25 offen offset:1024
    s_add_u32 s25, s25, 2048
    s_add_u32 s25, s25, 12288
    v_fma_f32 v16, v112, v144, v148
    v_fma_f32 v17, v116, v145, v149
    v_fma_f32 v18, v120, v146, v150
    v_fma_f32 v19, v124, v147, v151
    v_fma_f32 v20, v113, v144, v148
    v_fma_f32 v21, v117, v145, v149
    v_fma_f32 v22, v121, v146, v150
    v_fma_f32 v23, v125, v147, v151
    v_mul_f32 v24, v16, v16
    v_mul_f32 v25, v17, v17
    v_mul_f32 v26, v18, v18
    v_mul_f32 v27, v19, v19
    v_mul_f32 v28, v20, v20
    v_mul_f32 v29, v21, v21
    v_mul_f32 v30, v22, v22
    v_mul_f32 v31, v23, v23
    v_fma_f32 v24, v24, s31, v15
    v_fma_f32 v25, v25, s31, v15
    v_fma_f32 v26, v26, s31, v15
    v_fma_f32 v27, v27, s31, v15
    v_fma_f32 v28, v28, s31, v15
    v_fma_f32 v29, v29, s31, v15
    v_fma_f32 v30, v30, s31, v15
    v_fma_f32 v31, v31, s31, v15
    v_mul_f32 v24, v24, v16
    v_mul_f32 v25, v25, v17
    v_mul_f32 v26, v26, v18
    v_mul_f32 v27, v27, v19
    v_mul_f32 v28, v28, v20
    v_mul_f32 v29, v29, v21
    v_mul_f32 v30, v30, v22
    v_mul_f32 v31, v31, v23
    v_exp_f32 v24, v24
    v_exp_f32 v25, v25
    v_exp_f32 v26, v26
    v_exp_f32 v27, v27
    v_exp_f32 v28, v28
    v_exp_f32 v29, v29
    v_exp_f32 v30, v30
    v_exp_f32 v31, v31
    v_add_f32 v24, 1.0, v24
    v_add_f32 v25, 1.0, v25
    v_add_f32 v26, 1.0, v26
    v_add_f32 v27, 1.0, v27
    v_add_f32 v28, 1.0, v28
    v_add_f32 v29, 1.0, v29
    v_add_f32 v30, 1.0, v30
    v_add_f32 v31, 1.0, v31
    v_rcp_f32 v24, v24
    v_rcp_f32 v25, v25
    v_rcp_f32 v26, v26
    v_rcp_f32 v27, v27
    v_rcp_f32 v28, v28
    v_rcp_f32 v29, v29
    v_rcp_f32 v30, v30
    v_rcp_f32 v31, v31
    v_mul_f32 v16, v16, v24
    v_mul_f32 v17, v17, v25
    v_mul_f32 v18, v18, v26
    v_mul_f32 v19, v19, v27
    v_mul_f32 v20, v20, v28
    v_mul_f32 v21, v21, v29
    v_mul_f32 v22, v22, v30
    v_mul_f32 v23, v23, v31
    v_cvt_pk_bf16_f32 v32, v16, v17
    v_cvt_pk_bf16_f32 v33, v18, v19
    buffer_store_dwordx2 v[32:33], v7, s[16:19], s25 offen offset:0
    v_cvt_pk_bf16_f32 v34, v20, v21
    v_cvt_pk_bf16_f32 v35, v22, v23
    buffer_store_dwordx2 v[34:35], v7, s[16:19], s25 offen offset:1024
    s_add_u32 s25, s25, 2048
    v_fma_f32 v36, v114, v144, v148
    v_fma_f32 v37, v118, v145, v149
    v_fma_f32 v38, v122, v146, v150
    v_fma_f32 v39, v126, v147, v151
    v_fma_f32 v40, v115, v144, v148
    v_fma_f32 v41, v119, v145, v149
    v_fma_f32 v42, v123, v146, v150
    v_fma_f32 v43, v127, v147, v151
    v_mul_f32 v44, v36, v36
    v_mul_f32 v45, v37, v37
    v_mul_f32 v46, v38, v38
    v_mul_f32 v47, v39, v39
    v_mul_f32 v48, v40, v40
    v_mul_f32 v49, v41, v41
    v_mul_f32 v50, v42, v42
    v_mul_f32 v51, v43, v43
    v_fma_f32 v44, v44, s31, v15
    v_fma_f32 v45, v45, s31, v15
    v_fma_f32 v46, v46, s31, v15
    v_fma_f32 v47, v47, s31, v15
    v_fma_f32 v48, v48, s31, v15
    v_fma_f32 v49, v49, s31, v15
    v_fma_f32 v50, v50, s31, v15
    v_fma_f32 v51, v51, s31, v15
    v_mul_f32 v44, v44, v36
    v_mul_f32 v45, v45, v37
    v_mul_f32 v46, v46, v38
    v_mul_f32 v47, v47, v39
    v_mul_f32 v48, v48, v40
    v_mul_f32 v49, v49, v41
    v_mul_f32 v50, v50, v42
    v_mul_f32 v51, v51, v43
    v_exp_f32 v44, v44
    v_exp_f32 v45, v45
    v_exp_f32 v46, v46
    v_exp_f32 v47, v47
    v_exp_f32 v48, v48
    v_exp_f32 v49, v49
    v_exp_f32 v50, v50
    v_exp_f32 v51, v51
    v_add_f32 v44, 1.0, v44
    v_add_f32 v45, 1.0, v45
    v_add_f32 v46, 1.0, v46
    v_add_f32 v47, 1.0, v47
    v_add_f32 v48, 1.0, v48
    v_add_f32 v49, 1.0, v49
    v_add_f32 v50, 1.0, v50
    v_add_f32 v51, 1.0, v51
    v_rcp_f32 v44, v44
    v_rcp_f32 v45, v45
    v_rcp_f32 v46, v46
    v_rcp_f32 v47, v47
    v_rcp_f32 v48, v48
    v_rcp_f32 v49, v49
    v_rcp_f32 v50, v50
    v_rcp_f32 v51, v51
    v_mul_f32 v36, v36, v44
    v_mul_f32 v37, v37, v45
    v_mul_f32 v38, v38, v46
    v_mul_f32 v39, v39, v47
    v_mul_f32 v40, v40, v48
    v_mul_f32 v41, v41, v49
    v_mul_f32 v42, v42, v50
    v_mul_f32 v43, v43, v51
    v_cvt_pk_bf16_f32 v52, v36, v37
    v_cvt_pk_bf16_f32 v53, v38, v39
    buffer_store_dwordx2 v[52:53], v7, s[16:19], s25 offen offset:0
    v_cvt_pk_bf16_f32 v54, v40, v41
    v_cvt_pk_bf16_f32 v55, v42, v43
    buffer_store_dwordx2 v[54:55], v7, s[16:19], s25 offen offset:1024
    s_add_u32 s25, s25, 2048
    s_add_u32 s25, s25, 12288
    v_fma_f32 v16, v128, v144, v148
    v_fma_f32 v17, v132, v145, v149
    v_fma_f32 v18, v136, v146, v150
    v_fma_f32 v19, v140, v147, v151
    v_fma_f32 v20, v129, v144, v148
    v_fma_f32 v21, v133, v145, v149
    v_fma_f32 v22, v137, v146, v150
    v_fma_f32 v23, v141, v147, v151
    v_mul_f32 v24, v16, v16
    v_mul_f32 v25, v17, v17
    v_mul_f32 v26, v18, v18
    v_mul_f32 v27, v19, v19
    v_mul_f32 v28, v20, v20
    v_mul_f32 v29, v21, v21
    v_mul_f32 v30, v22, v22
    v_mul_f32 v31, v23, v23
    v_fma_f32 v24, v24, s31, v15
    v_fma_f32 v25, v25, s31, v15
    v_fma_f32 v26, v26, s31, v15
    v_fma_f32 v27, v27, s31, v15
    v_fma_f32 v28, v28, s31, v15
    v_fma_f32 v29, v29, s31, v15
    v_fma_f32 v30, v30, s31, v15
    v_fma_f32 v31, v31, s31, v15
    v_mul_f32 v24, v24, v16
    v_mul_f32 v25, v25, v17
    v_mul_f32 v26, v26, v18
    v_mul_f32 v27, v27, v19
    v_mul_f32 v28, v28, v20
    v_mul_f32 v29, v29, v21
    v_mul_f32 v30, v30, v22
    v_mul_f32 v31, v31, v23
    v_exp_f32 v24, v24
    v_exp_f32 v25, v25
    v_exp_f32 v26, v26
    v_exp_f32 v27, v27
    v_exp_f32 v28, v28
    v_exp_f32 v29, v29
    v_exp_f32 v30, v30
    v_exp_f32 v31, v31
    v_add_f32 v24, 1.0, v24
    v_add_f32 v25, 1.0, v25
    v_add_f32 v26, 1.0, v26
    v_add_f32 v27, 1.0, v27
    v_add_f32 v28, 1.0, v28
    v_add_f32 v29, 1.0, v29
    v_add_f32 v30, 1.0, v30
    v_add_f32 v31, 1.0, v31
    v_rcp_f32 v24, v24
    v_rcp_f32 v25, v25
    v_rcp_f32 v26, v26
    v_rcp_f32 v27, v27
    v_rcp_f32 v28, v28
    v_rcp_f32 v29, v29
    v_rcp_f32 v30, v30
    v_rcp_f32 v31, v31
    v_mul_f32 v16, v16, v24
    v_mul_f32 v17, v17, v25
    v_mul_f32 v18, v18, v26
    v_mul_f32 v19, v19, v27
    v_mul_f32 v20, v20, v28
    v_mul_f32 v21, v21, v29
    v_mul_f32 v22, v22, v30
    v_mul_f32 v23, v23, v31
    v_cvt_pk_bf16_f32 v32, v16, v17
    v_cvt_pk_bf16_f32 v33, v18, v19
    buffer_store_dwordx2 v[32:33], v7, s[16:19], s25 offen offset:0
    v_cvt_pk_bf16_f32 v34, v20, v21
    v_cvt_pk_bf16_f32 v35, v22, v23
    buffer_store_dwordx2 v[34:35], v7, s[16:19], s25 offen offset:1024
    s_add_u32 s25, s25, 2048
    v_fma_f32 v36, v130, v144, v148
    v_fma_f32 v37, v134, v145, v149
    v_fma_f32 v38, v138, v146, v150
    v_fma_f32 v39, v142, v147, v151
    v_fma_f32 v40, v131, v144, v148
    v_fma_f32 v41, v135, v145, v149
    v_fma_f32 v42, v139, v146, v150
    v_fma_f32 v43, v143, v147, v151
    v_mul_f32 v44, v36, v36
    v_mul_f32 v45, v37, v37
    v_mul_f32 v46, v38, v38
    v_mul_f32 v47, v39, v39
    v_mul_f32 v48, v40, v40
    v_mul_f32 v49, v41, v41
    v_mul_f32 v50, v42, v42
    v_mul_f32 v51, v43, v43
    v_fma_f32 v44, v44, s31, v15
    v_fma_f32 v45, v45, s31, v15
    v_fma_f32 v46, v46, s31, v15
    v_fma_f32 v47, v47, s31, v15
    v_fma_f32 v48, v48, s31, v15
    v_fma_f32 v49, v49, s31, v15
    v_fma_f32 v50, v50, s31, v15
    v_fma_f32 v51, v51, s31, v15
    v_mul_f32 v44, v44, v36
    v_mul_f32 v45, v45, v37
    v_mul_f32 v46, v46, v38
    v_mul_f32 v47, v47, v39
    v_mul_f32 v48, v48, v40
    v_mul_f32 v49, v49, v41
    v_mul_f32 v50, v50, v42
    v_mul_f32 v51, v51, v43
    v_exp_f32 v44, v44
    v_exp_f32 v45, v45
    v_exp_f32 v46, v46
    v_exp_f32 v47, v47
    v_exp_f32 v48, v48
    v_exp_f32 v49, v49
    v_exp_f32 v50, v50
    v_exp_f32 v51, v51
    v_add_f32 v44, 1.0, v44
    v_add_f32 v45, 1.0, v45
    v_add_f32 v46, 1.0, v46
    v_add_f32 v47, 1.0, v47
    v_add_f32 v48, 1.0, v48
    v_add_f32 v49, 1.0, v49
    v_add_f32 v50, 1.0, v50
    v_add_f32 v51, 1.0, v51
    v_rcp_f32 v44, v44
    v_rcp_f32 v45, v45
    v_rcp_f32 v46, v46
    v_rcp_f32 v47, v47
    v_rcp_f32 v48, v48
    v_rcp_f32 v49, v49
    v_rcp_f32 v50, v50
    v_rcp_f32 v51, v51
    v_mul_f32 v36, v36, v44
    v_mul_f32 v37, v37, v45
    v_mul_f32 v38, v38, v46
    v_mul_f32 v39, v39, v47
    v_mul_f32 v40, v40, v48
    v_mul_f32 v41, v41, v49
    v_mul_f32 v42, v42, v50
    v_mul_f32 v43, v43, v51
    v_cvt_pk_bf16_f32 v52, v36, v37
    v_cvt_pk_bf16_f32 v53, v38, v39
    buffer_store_dwordx2 v[52:53], v7, s[16:19], s25 offen offset:0
    v_cvt_pk_bf16_f32 v54, v40, v41
    v_cvt_pk_bf16_f32 v55, v42, v43
    buffer_store_dwordx2 v[54:55], v7, s[16:19], s25 offen offset:1024
    s_add_u32 s25, s25, 2048
    s_add_u32 s25, s25, 12288
K34_END:
    s_endpgm
TEXT_END:
.section .rodata,"a"
.p2align 6
.amdhsa_kernel k1_xform_kernel
  .amdhsa_next_free_vgpr 128
  .amdhsa_next_free_sgpr 96
  .amdhsa_accum_offset 128
  .amdhsa_group_segment_fixed_size 0
  .amdhsa_kernarg_size 56
  .amdhsa_user_sgpr_count 2
  .amdhsa_user_sgpr_kernarg_segment_ptr 1
  .amdhsa_system_sgpr_workgroup_id_x 1
.end_amdhsa_kernel
.p2align 6
.amdhsa_kernel k12_fused_kernel
  .amdhsa_next_free_vgpr 256
  .amdhsa_next_free_sgpr 96
  .amdhsa_accum_offset 256
  .amdhsa_group_segment_fixed_size 0
  .amdhsa_kernarg_size 56
  .amdhsa_user_sgpr_count 2
  .amdhsa_user_sgpr_kernarg_segment_ptr 1
  .amdhsa_system_sgpr_workgroup_id_x 1
.end_amdhsa_kernel
.p2align 6
.amdhsa_kernel k34_out_kernel
  .amdhsa_next_free_vgpr 168
  .amdhsa_next_free_sgpr 96
  .amdhsa_accum_offset 168
  .amdhsa_group_segment_fixed_size 0
  .amdhsa_kernarg_size 56
  .amdhsa_user_sgpr_count 2
  .amdhsa_user_sgpr_kernarg_segment_ptr 1
  .amdhsa_system_sgpr_workgroup_id_x 1
.end_amdhsa_kernel
```

```asm
; @launch kernel=k1_xform_kernel grid=(636,1,1) block=(256,1,1) lds=16384
; @launch kernel=k12_fused_kernel grid=(256,1,1) block=(512,1,1) lds=155840
; @launch kernel=k34_out_kernel grid=(256,1,1) block=(768,1,1) lds=18944
.amdgcn_target "amdgcn-amd-amdhsa--gfx950"
.text
.globl k1_xform_kernel
.globl k12_fused_kernel
.globl k34_out_kernel
.p2align 8
.type k1_xform_kernel,@function
k1_xform_kernel:
    s_cmp_ge_u32 s2, 636
    s_cbranch_scc1 K1_END
    s_load_dwordx4 s[4:7], s[0:1], 0
    s_load_dwordx2 s[8:9], s[0:1], 48
    v_lshrrev_b32 v120, 6, v0
    v_and_b32 v121, 63, v0
    v_readfirstlane_b32 s3, v120
    v_and_b32 v122, 15, v121
    v_lshrrev_b32 v123, 4, v121
    s_mov_b32 s28, 0x05040100
    s_mov_b32 s29, 0x07060302
    v_and_b32 v124, 3, v122
    v_lshlrev_b32 v124, 2, v124
    v_lshrrev_b32 v125, 3, v122
    v_lshl_add_u32 v124, v125, 1, v124
    s_lshl_b32 s10, s3, 4
    s_add_u32 s10, s10, 1
    v_add_u32 v124, s10, v124
    v_bfe_u32 v125, v122, 2, 1
    v_lshlrev_b32 v121, 4, v121
    s_waitcnt lgkmcnt(0)
    s_or_b32 s10, s2, s3
    s_cmp_eq_u32 s10, 0
    s_cbranch_scc0 K1_NOCLR
    s_add_u32 s12, s8, 153092096
    s_addc_u32 s13, s9, 0
    s_and_b32 s13, s13, 0xffff
    s_mov_b32 s14, 32768
    s_mov_b32 s15, 0x00020000
    v_lshrrev_b32 v118, 4, v121
    v_lshlrev_b32 v119, 10, v118
    v_mov_b32 v117, 0
    s_mov_b64 exec, 0xffff
    buffer_store_dword v117, v119, s[12:15], 0 offen
    v_lshlrev_b32 v119, 4, v118
    v_add_u32 v119, 16384, v119
    buffer_store_dword v117, v119, s[12:15], 0 offen
    s_mov_b64 exec, -1
K1_NOCLR:
    s_cmp_lt_u32 s2, 32
    s_cbranch_scc0 K1_NOFILL
    s_add_u32 s12, s8, 153616384
    s_addc_u32 s13, s9, 0
    s_and_b32 s13, s13, 0xffff
    s_mov_b32 s14, 131072
    s_mov_b32 s15, 0x00020000
    s_lshl_b32 s10, s2, 2
    s_add_u32 s10, s10, s3
    s_lshl_b32 s10, s10, 10
    v_mov_b32 v112, -1
    v_mov_b32 v113, -1
    v_mov_b32 v114, -1
    v_mov_b32 v115, -1
    buffer_store_dwordx4 v[112:115], v121, s[12:15], s10 offen
K1_NOFILL:
    s_add_u32 s10, s2, 384
    s_sub_u32 s11, s2, 252
    s_cmp_lt_u32 s2, 252
    s_cselect_b32 s2, s10, s11
    s_cmp_lt_u32 s2, 384
    s_cbranch_scc1 K1_W
    s_sub_u32 s11, s2, 384
    s_mul_hi_u32 s13, s11, 1431655766
    s_mul_i32 s12, s13, 3
    s_sub_u32 s12, s11, s12
    s_mov_b32 s11, s13
    s_cmp_ge_u32 s11, 42
    s_cselect_b32 s13, 1, 0
    s_mul_i32 s14, s13, 42
    s_sub_u32 s11, s11, s14
    s_lshl_b32 s11, s11, 2
    s_add_u32 s11, s11, s3
    s_mul_i32 s14, s13, 16384000
    s_add_u32 s16, s4, s14
    s_addc_u32 s17, s5, 0
    s_and_b32 s17, s17, 0xffff
    s_mov_b32 s18, 16384000
    s_mov_b32 s19, 0x00020000
    s_mov_b32 s20, s8
    s_mov_b32 s21, s9
    s_and_b32 s21, s21, 0xffff
    s_mov_b32 s22, 43778048
    s_mov_b32 s23, 0x00020000
    v_lshlrev_b32 v126, 14, v123
    v_lshl_add_u32 v126, v122, 4, v126
    s_mul_i32 s15, s11, 98304
    s_lshl_b32 s24, s12, 8
    s_add_u32 s15, s15, s24
    buffer_load_dwordx4 v[0:3], v126, s[16:19], s15 offen
    buffer_load_dwordx4 v[4:7], v126, s[16:19], s15 offen offset:2048
    s_add_u32 s15, s15, 4096
    buffer_load_dwordx4 v[8:11], v126, s[16:19], s15 offen
    buffer_load_dwordx4 v[12:15], v126, s[16:19], s15 offen offset:2048
    s_add_u32 s15, s15, 4096
    buffer_load_dwordx4 v[16:19], v126, s[16:19], s15 offen
    buffer_load_dwordx4 v[20:23], v126, s[16:19], s15 offen offset:2048
    s_add_u32 s15, s15, 4096
    buffer_load_dwordx4 v[24:27], v126, s[16:19], s15 offen
    buffer_load_dwordx4 v[28:31], v126, s[16:19], s15 offen offset:2048
    s_add_u32 s15, s15, 53248
    buffer_load_dwordx4 v[32:35], v126, s[16:19], s15 offen
    buffer_load_dwordx4 v[36:39], v126, s[16:19], s15 offen offset:2048
    s_add_u32 s15, s15, 4096
    buffer_load_dwordx4 v[40:43], v126, s[16:19], s15 offen
    buffer_load_dwordx4 v[44:47], v126, s[16:19], s15 offen offset:2048
    s_add_u32 s15, s15, 4096
    buffer_load_dwordx4 v[48:51], v126, s[16:19], s15 offen
    buffer_load_dwordx4 v[52:55], v126, s[16:19], s15 offen offset:2048
    s_add_u32 s15, s15, 4096
    buffer_load_dwordx4 v[56:59], v126, s[16:19], s15 offen
    buffer_load_dwordx4 v[60:63], v126, s[16:19], s15 offen offset:2048
    v_lshlrev_b32 v127, 3, v123
    v_lshlrev_b32 v112, 5, v125
    v_mad_u32_u24 v113, v124, v127, v112
    v_mad_u32_u24 v64, v124, 0, v113
    v_mad_u32_u24 v65, v124, 1, v113
    v_mad_u32_u24 v66, v124, 2, v113
    v_mad_u32_u24 v67, v124, 3, v113
    v_mad_u32_u24 v68, v124, 4, v113
    v_mad_u32_u24 v69, v124, 5, v113
    v_mad_u32_u24 v70, v124, 6, v113
    v_mad_u32_u24 v71, v124, 7, v113
    v_and_b32 v64, 127, v64
    v_and_b32 v65, 127, v65
    v_and_b32 v66, 127, v66
    v_and_b32 v67, 127, v67
    v_and_b32 v68, 127, v68
    v_and_b32 v69, 127, v69
    v_and_b32 v70, 127, v70
    v_and_b32 v71, 127, v71
    v_cvt_f32_u32 v64, v64
    v_cvt_f32_u32 v65, v65
    v_cvt_f32_u32 v66, v66
    v_cvt_f32_u32 v67, v67
    v_cvt_f32_u32 v68, v68
    v_cvt_f32_u32 v69, v69
    v_cvt_f32_u32 v70, v70
    v_cvt_f32_u32 v71, v71
    v_mul_f32 v64, 0x3c000000, v64
    v_mul_f32 v65, 0x3c000000, v65
    v_mul_f32 v66, 0x3c000000, v66
    v_mul_f32 v67, 0x3c000000, v67
    v_mul_f32 v68, 0x3c000000, v68
    v_mul_f32 v69, 0x3c000000, v69
    v_mul_f32 v70, 0x3c000000, v70
    v_mul_f32 v71, 0x3c000000, v71
    v_cos_f32 v64, v64
    v_cos_f32 v65, v65
    v_cos_f32 v66, v66
    v_cos_f32 v67, v67
    v_cos_f32 v68, v68
    v_cos_f32 v69, v69
    v_cos_f32 v70, v70
    v_cos_f32 v71, v71
    s_nop 0
    v_cvt_pk_bf16_f32 v72, v64, v65
    v_cvt_pk_bf16_f32 v73, v66, v67
    v_cvt_pk_bf16_f32 v74, v68, v69
    v_cvt_pk_bf16_f32 v75, v70, v71
    v_lshlrev_b32 v80, 16, v72
    v_and_b32 v81, 0xffff0000, v72
    v_sub_f32 v64, v64, v80
    v_sub_f32 v65, v65, v81
    v_lshlrev_b32 v80, 16, v73
    v_and_b32 v81, 0xffff0000, v73
    v_sub_f32 v66, v66, v80
    v_sub_f32 v67, v67, v81
    v_lshlrev_b32 v80, 16, v74
    v_and_b32 v81, 0xffff0000, v74
    v_sub_f32 v68, v68, v80
    v_sub_f32 v69, v69, v81
    v_lshlrev_b32 v80, 16, v75
    v_and_b32 v81, 0xffff0000, v75
    v_sub_f32 v70, v70, v80
    v_sub_f32 v71, v71, v81
    v_cvt_pk_bf16_f32 v76, v64, v65
    v_cvt_pk_bf16_f32 v77, v66, v67
    v_cvt_pk_bf16_f32 v78, v68, v69
    v_cvt_pk_bf16_f32 v79, v70, v71
    s_lshl_b32 s24, s3, 12
    v_add_u32 v114, s24, v121
    ds_write_b128 v114, v[72:75] offset:0
    ds_write_b128 v114, v[76:79] offset:1024
    v_add_u32 v127, 32, v127
    v_lshlrev_b32 v112, 5, v125
    v_mad_u32_u24 v113, v124, v127, v112
    v_mad_u32_u24 v64, v124, 0, v113
    v_mad_u32_u24 v65, v124, 1, v113
    v_mad_u32_u24 v66, v124, 2, v113
    v_mad_u32_u24 v67, v124, 3, v113
    v_mad_u32_u24 v68, v124, 4, v113
    v_mad_u32_u24 v69, v124, 5, v113
    v_mad_u32_u24 v70, v124, 6, v113
    v_mad_u32_u24 v71, v124, 7, v113
    v_and_b32 v64, 127, v64
    v_and_b32 v65, 127, v65
    v_and_b32 v66, 127, v66
    v_and_b32 v67, 127, v67
    v_and_b32 v68, 127, v68
    v_and_b32 v69, 127, v69
    v_and_b32 v70, 127, v70
    v_and_b32 v71, 127, v71
    v_cvt_f32_u32 v64, v64
    v_cvt_f32_u32 v65, v65
    v_cvt_f32_u32 v66, v66
    v_cvt_f32_u32 v67, v67
    v_cvt_f32_u32 v68, v68
    v_cvt_f32_u32 v69, v69
    v_cvt_f32_u32 v70, v70
    v_cvt_f32_u32 v71, v71
    v_mul_f32 v64, 0x3c000000, v64
    v_mul_f32 v65, 0x3c000000, v65
    v_mul_f32 v66, 0x3c000000, v66
    v_mul_f32 v67, 0x3c000000, v67
    v_mul_f32 v68, 0x3c000000, v68
    v_mul_f32 v69, 0x3c000000, v69
    v_mul_f32 v70, 0x3c000000, v70
    v_mul_f32 v71, 0x3c000000, v71
    v_cos_f32 v64, v64
    v_cos_f32 v65, v65
    v_cos_f32 v66, v66
    v_cos_f32 v67, v67
    v_cos_f32 v68, v68
    v_cos_f32 v69, v69
    v_cos_f32 v70, v70
    v_cos_f32 v71, v71
    s_nop 0
    v_cvt_pk_bf16_f32 v72, v64, v65
    v_cvt_pk_bf16_f32 v73, v66, v67
    v_cvt_pk_bf16_f32 v74, v68, v69
    v_cvt_pk_bf16_f32 v75, v70, v71
    v_lshlrev_b32 v80, 16, v72
    v_and_b32 v81, 0xffff0000, v72
    v_sub_f32 v64, v64, v80
    v_sub_f32 v65, v65, v81
    v_lshlrev_b32 v80, 16, v73
    v_and_b32 v81, 0xffff0000, v73
    v_sub_f32 v66, v66, v80
    v_sub_f32 v67, v67, v81
    v_lshlrev_b32 v80, 16, v74
    v_and_b32 v81, 0xffff0000, v74
    v_sub_f32 v68, v68, v80
    v_sub_f32 v69, v69, v81
    v_lshlrev_b32 v80, 16, v75
    v_and_b32 v81, 0xffff0000, v75
    v_sub_f32 v70, v70, v80
    v_sub_f32 v71, v71, v81
    v_cvt_pk_bf16_f32 v76, v64, v65
    v_cvt_pk_bf16_f32 v77, v66, v67
    v_cvt_pk_bf16_f32 v78, v68, v69
    v_cvt_pk_bf16_f32 v79, v70, v71
    s_lshl_b32 s24, s3, 12
    v_add_u32 v114, s24, v121
    ds_write_b128 v114, v[72:75] offset:2048
    ds_write_b128 v114, v[76:79] offset:3072
    v_lshrrev_b32 v112, 1, v123
    s_mov_b32 s24, 1368064
    v_mul_lo_u32 v112, v112, s24
    v_lshrrev_b32 v113, 2, v122
    s_mov_b32 s24, 21376
    v_mul_lo_u32 v113, v113, s24
    v_add_u32 v112, v112, v113
    v_and_b32 v113, 3, v122
    v_and_b32 v114, 1, v123
    v_lshl_add_u32 v113, v114, 2, v113
    s_lshr_b32 s24, s11, 1
    s_and_b32 s24, s24, 7
    v_xor_b32 v113, s24, v113
    v_lshl_add_u32 v120, v113, 4, v112
    s_mul_i32 s25, s13, 684032
    s_mul_i32 s24, s12, 85504
    s_add_u32 s25, s25, s24
    s_lshl_b32 s24, s11, 7
    s_add_u32 s25, s25, s24
    s_waitcnt lgkmcnt(0)
    s_barrier
    s_cmp_ge_u32 s11, 167
    s_cbranch_scc1 K1_END
    s_waitcnt vmcnt(8)
    v_perm_b32 v64, v4, v0, s28
    v_perm_b32 v68, v4, v0, s29
    v_perm_b32 v65, v12, v8, s28
    v_perm_b32 v69, v12, v8, s29
    v_perm_b32 v66, v20, v16, s28
    v_perm_b32 v70, v20, v16, s29
    v_perm_b32 v67, v28, v24, s28
    v_perm_b32 v71, v28, v24, s29
    v_perm_b32 v72, v5, v1, s28
    v_perm_b32 v76, v5, v1, s29
    v_perm_b32 v73, v13, v9, s28
    v_perm_b32 v77, v13, v9, s29
    v_perm_b32 v74, v21, v17, s28
    v_perm_b32 v78, v21, v17, s29
    v_perm_b32 v75, v29, v25, s28
    v_perm_b32 v79, v29, v25, s29
    v_perm_b32 v80, v6, v2, s28
    v_perm_b32 v84, v6, v2, s29
    v_perm_b32 v81, v14, v10, s28
    v_perm_b32 v85, v14, v10, s29
    v_perm_b32 v82, v22, v18, s28
    v_perm_b32 v86, v22, v18, s29
    v_perm_b32 v83, v30, v26, s28
    v_perm_b32 v87, v30, v26, s29
    v_perm_b32 v88, v7, v3, s28
    v_perm_b32 v92, v7, v3, s29
    v_perm_b32 v89, v15, v11, s28
    v_perm_b32 v93, v15, v11, s29
    v_perm_b32 v90, v23, v19, s28
    v_perm_b32 v94, v23, v19, s29
    v_perm_b32 v91, v31, v27, s28
    v_perm_b32 v95, v31, v27, s29
    s_waitcnt vmcnt(0)
    v_perm_b32 v0, v36, v32, s28
    v_perm_b32 v4, v36, v32, s29
    v_perm_b32 v1, v44, v40, s28
    v_perm_b32 v5, v44, v40, s29
    v_perm_b32 v2, v52, v48, s28
    v_perm_b32 v6, v52, v48, s29
    v_perm_b32 v3, v60, v56, s28
    v_perm_b32 v7, v60, v56, s29
    v_perm_b32 v8, v37, v33, s28
    v_perm_b32 v12, v37, v33, s29
    v_perm_b32 v9, v45, v41, s28
    v_perm_b32 v13, v45, v41, s29
    v_perm_b32 v10, v53, v49, s28
    v_perm_b32 v14, v53, v49, s29
    v_perm_b32 v11, v61, v57, s28
    v_perm_b32 v15, v61, v57, s29
    v_perm_b32 v16, v38, v34, s28
    v_perm_b32 v20, v38, v34, s29
    v_perm_b32 v17, v46, v42, s28
    v_perm_b32 v21, v46, v42, s29
    v_perm_b32 v18, v54, v50, s28
    v_perm_b32 v22, v54, v50, s29
    v_perm_b32 v19, v62, v58, s28
    v_perm_b32 v23, v62, v58, s29
    v_perm_b32 v24, v39, v35, s28
    v_perm_b32 v28, v39, v35, s29
    v_perm_b32 v25, v47, v43, s28
    v_perm_b32 v29, v47, v43, s29
    v_perm_b32 v26, v55, v51, s28
    v_perm_b32 v30, v55, v51, s29
    v_perm_b32 v27, v63, v59, s28
    v_perm_b32 v31, v63, v59, s29
    ds_read_b128 v[96:99], v121 offset:0
    ds_read_b128 v[100:103], v121 offset:1024
    ds_read_b128 v[104:107], v121 offset:2048
    ds_read_b128 v[108:111], v121 offset:3072
    s_waitcnt lgkmcnt(3)
    v_mfma_f32_16x16x32_bf16 v[32:35], v[96:99], v[64:67], 0
    v_mfma_f32_16x16x32_bf16 v[36:39], v[96:99], v[68:71], 0
    v_mfma_f32_16x16x32_bf16 v[40:43], v[96:99], v[72:75], 0
    v_mfma_f32_16x16x32_bf16 v[44:47], v[96:99], v[76:79], 0
    v_mfma_f32_16x16x32_bf16 v[48:51], v[96:99], v[80:83], 0
    v_mfma_f32_16x16x32_bf16 v[52:55], v[96:99], v[84:87], 0
    v_mfma_f32_16x16x32_bf16 v[56:59], v[96:99], v[88:91], 0
    v_mfma_f32_16x16x32_bf16 v[60:63], v[96:99], v[92:95], 0
    s_waitcnt lgkmcnt(2)
    v_mfma_f32_16x16x32_bf16 v[32:35], v[100:103], v[64:67], v[32:35]
    v_mfma_f32_16x16x32_bf16 v[36:39], v[100:103], v[68:71], v[36:39]
    v_mfma_f32_16x16x32_bf16 v[40:43], v[100:103], v[72:75], v[40:43]
    v_mfma_f32_16x16x32_bf16 v[44:47], v[100:103], v[76:79], v[44:47]
    v_mfma_f32_16x16x32_bf16 v[48:51], v[100:103], v[80:83], v[48:51]
    v_mfma_f32_16x16x32_bf16 v[52:55], v[100:103], v[84:87], v[52:55]
    v_mfma_f32_16x16x32_bf16 v[56:59], v[100:103], v[88:91], v[56:59]
    v_mfma_f32_16x16x32_bf16 v[60:63], v[100:103], v[92:95], v[60:63]
    s_waitcnt lgkmcnt(1)
    v_mfma_f32_16x16x32_bf16 v[32:35], v[104:107], v[0:3], v[32:35]
    v_mfma_f32_16x16x32_bf16 v[36:39], v[104:107], v[4:7], v[36:39]
    v_mfma_f32_16x16x32_bf16 v[40:43], v[104:107], v[8:11], v[40:43]
    v_mfma_f32_16x16x32_bf16 v[44:47], v[104:107], v[12:15], v[44:47]
    v_mfma_f32_16x16x32_bf16 v[48:51], v[104:107], v[16:19], v[48:51]
    v_mfma_f32_16x16x32_bf16 v[52:55], v[104:107], v[20:23], v[52:55]
    v_mfma_f32_16x16x32_bf16 v[56:59], v[104:107], v[24:27], v[56:59]
    v_mfma_f32_16x16x32_bf16 v[60:63], v[104:107], v[28:31], v[60:63]
    s_waitcnt lgkmcnt(0)
    v_mfma_f32_16x16x32_bf16 v[32:35], v[108:111], v[0:3], v[32:35]
    v_mfma_f32_16x16x32_bf16 v[36:39], v[108:111], v[4:7], v[36:39]
    v_mfma_f32_16x16x32_bf16 v[40:43], v[108:111], v[8:11], v[40:43]
    v_mfma_f32_16x16x32_bf16 v[44:47], v[108:111], v[12:15], v[44:47]
    v_mfma_f32_16x16x32_bf16 v[48:51], v[108:111], v[16:19], v[48:51]
    v_mfma_f32_16x16x32_bf16 v[52:55], v[108:111], v[20:23], v[52:55]
    v_mfma_f32_16x16x32_bf16 v[56:59], v[108:111], v[24:27], v[56:59]
    v_mfma_f32_16x16x32_bf16 v[60:63], v[108:111], v[28:31], v[60:63]
    s_nop 7
    v_cvt_pk_bf16_f32 v112, v32, v36
    v_cvt_pk_bf16_f32 v113, v40, v44
    v_cvt_pk_bf16_f32 v114, v48, v52
    v_cvt_pk_bf16_f32 v115, v56, v60
    buffer_store_dwordx4 v[112:115], v120, s[20:23], s25 offen
    s_add_u32 s25, s25, 2736128
    v_cvt_pk_bf16_f32 v116, v33, v37
    v_cvt_pk_bf16_f32 v117, v41, v45
    v_cvt_pk_bf16_f32 v118, v49, v53
    v_cvt_pk_bf16_f32 v119, v57, v61
    buffer_store_dwordx4 v[116:119], v120, s[20:23], s25 offen
    s_add_u32 s25, s25, 2736128
    v_cvt_pk_bf16_f32 v112, v34, v38
    v_cvt_pk_bf16_f32 v113, v42, v46
    v_cvt_pk_bf16_f32 v114, v50, v54
    v_cvt_pk_bf16_f32 v115, v58, v62
    buffer_store_dwordx4 v[112:115], v120, s[20:23], s25 offen
    s_add_u32 s25, s25, 2736128
    v_cvt_pk_bf16_f32 v116, v35, v39
    v_cvt_pk_bf16_f32 v117, v43, v47
    v_cvt_pk_bf16_f32 v118, v51, v55
    v_cvt_pk_bf16_f32 v119, v59, v63
    buffer_store_dwordx4 v[116:119], v120, s[20:23], s25 offen
    s_add_u32 s25, s25, 2736128
    ds_read_b128 v[96:99], v121 offset:4096
    ds_read_b128 v[100:103], v121 offset:5120
    ds_read_b128 v[104:107], v121 offset:6144
    ds_read_b128 v[108:111], v121 offset:7168
    s_waitcnt lgkmcnt(3)
    v_mfma_f32_16x16x32_bf16 v[32:35], v[96:99], v[64:67], 0
    v_mfma_f32_16x16x32_bf16 v[36:39], v[96:99], v[68:71], 0
    v_mfma_f32_16x16x32_bf16 v[40:43], v[96:99], v[72:75], 0
    v_mfma_f32_16x16x32_bf16 v[44:47], v[96:99], v[76:79], 0
    v_mfma_f32_16x16x32_bf16 v[48:51], v[96:99], v[80:83], 0
    v_mfma_f32_16x16x32_bf16 v[52:55], v[96:99], v[84:87], 0
    v_mfma_f32_16x16x32_bf16 v[56:59], v[96:99], v[88:91], 0
    v_mfma_f32_16x16x32_bf16 v[60:63], v[96:99], v[92:95], 0
    s_waitcnt lgkmcnt(2)
    v_mfma_f32_16x16x32_bf16 v[32:35], v[100:103], v[64:67], v[32:35]
    v_mfma_f32_16x16x32_bf16 v[36:39], v[100:103], v[68:71], v[36:39]
    v_mfma_f32_16x16x32_bf16 v[40:43], v[100:103], v[72:75], v[40:43]
    v_mfma_f32_16x16x32_bf16 v[44:47], v[100:103], v[76:79], v[44:47]
    v_mfma_f32_16x16x32_bf16 v[48:51], v[100:103], v[80:83], v[48:51]
    v_mfma_f32_16x16x32_bf16 v[52:55], v[100:103], v[84:87], v[52:55]
    v_mfma_f32_16x16x32_bf16 v[56:59], v[100:103], v[88:91], v[56:59]
    v_mfma_f32_16x16x32_bf16 v[60:63], v[100:103], v[92:95], v[60:63]
    s_waitcnt lgkmcnt(1)
    v_mfma_f32_16x16x32_bf16 v[32:35], v[104:107], v[0:3], v[32:35]
    v_mfma_f32_16x16x32_bf16 v[36:39], v[104:107], v[4:7], v[36:39]
    v_mfma_f32_16x16x32_bf16 v[40:43], v[104:107], v[8:11], v[40:43]
    v_mfma_f32_16x16x32_bf16 v[44:47], v[104:107], v[12:15], v[44:47]
    v_mfma_f32_16x16x32_bf16 v[48:51], v[104:107], v[16:19], v[48:51]
    v_mfma_f32_16x16x32_bf16 v[52:55], v[104:107], v[20:23], v[52:55]
    v_mfma_f32_16x16x32_bf16 v[56:59], v[104:107], v[24:27], v[56:59]
    v_mfma_f32_16x16x32_bf16 v[60:63], v[104:107], v[28:31], v[60:63]
    s_waitcnt lgkmcnt(0)
    v_mfma_f32_16x16x32_bf16 v[32:35], v[108:111], v[0:3], v[32:35]
    v_mfma_f32_16x16x32_bf16 v[36:39], v[108:111], v[4:7], v[36:39]
    v_mfma_f32_16x16x32_bf16 v[40:43], v[108:111], v[8:11], v[40:43]
    v_mfma_f32_16x16x32_bf16 v[44:47], v[108:111], v[12:15], v[44:47]
    v_mfma_f32_16x16x32_bf16 v[48:51], v[108:111], v[16:19], v[48:51]
    v_mfma_f32_16x16x32_bf16 v[52:55], v[108:111], v[20:23], v[52:55]
    v_mfma_f32_16x16x32_bf16 v[56:59], v[108:111], v[24:27], v[56:59]
    v_mfma_f32_16x16x32_bf16 v[60:63], v[108:111], v[28:31], v[60:63]
    s_nop 7
    v_cvt_pk_bf16_f32 v112, v32, v36
    v_cvt_pk_bf16_f32 v113, v40, v44
    v_cvt_pk_bf16_f32 v114, v48, v52
    v_cvt_pk_bf16_f32 v115, v56, v60
    buffer_store_dwordx4 v[112:115], v120, s[20:23], s25 offen
    s_add_u32 s25, s25, 2736128
    v_cvt_pk_bf16_f32 v116, v33, v37
    v_cvt_pk_bf16_f32 v117, v41, v45
    v_cvt_pk_bf16_f32 v118, v49, v53
    v_cvt_pk_bf16_f32 v119, v57, v61
    buffer_store_dwordx4 v[116:119], v120, s[20:23], s25 offen
    s_add_u32 s25, s25, 2736128
    v_cvt_pk_bf16_f32 v112, v34, v38
    v_cvt_pk_bf16_f32 v113, v42, v46
    v_cvt_pk_bf16_f32 v114, v50, v54
    v_cvt_pk_bf16_f32 v115, v58, v62
    buffer_store_dwordx4 v[112:115], v120, s[20:23], s25 offen
    s_add_u32 s25, s25, 2736128
    v_cvt_pk_bf16_f32 v116, v35, v39
    v_cvt_pk_bf16_f32 v117, v43, v47
    v_cvt_pk_bf16_f32 v118, v51, v55
    v_cvt_pk_bf16_f32 v119, v59, v63
    buffer_store_dwordx4 v[116:119], v120, s[20:23], s25 offen
    s_add_u32 s25, s25, 2736128
    ds_read_b128 v[96:99], v121 offset:8192
    ds_read_b128 v[100:103], v121 offset:9216
    ds_read_b128 v[104:107], v121 offset:10240
    ds_read_b128 v[108:111], v121 offset:11264
    s_waitcnt lgkmcnt(3)
    v_mfma_f32_16x16x32_bf16 v[32:35], v[96:99], v[64:67], 0
    v_mfma_f32_16x16x32_bf16 v[36:39], v[96:99], v[68:71], 0
    v_mfma_f32_16x16x32_bf16 v[40:43], v[96:99], v[72:75], 0
    v_mfma_f32_16x16x32_bf16 v[44:47], v[96:99], v[76:79], 0
    v_mfma_f32_16x16x32_bf16 v[48:51], v[96:99], v[80:83], 0
    v_mfma_f32_16x16x32_bf16 v[52:55], v[96:99], v[84:87], 0
    v_mfma_f32_16x16x32_bf16 v[56:59], v[96:99], v[88:91], 0
    v_mfma_f32_16x16x32_bf16 v[60:63], v[96:99], v[92:95], 0
    s_waitcnt lgkmcnt(2)
    v_mfma_f32_16x16x32_bf16 v[32:35], v[100:103], v[64:67], v[32:35]
    v_mfma_f32_16x16x32_bf16 v[36:39], v[100:103], v[68:71], v[36:39]
    v_mfma_f32_16x16x32_bf16 v[40:43], v[100:103], v[72:75], v[40:43]
    v_mfma_f32_16x16x32_bf16 v[44:47], v[100:103], v[76:79], v[44:47]
    v_mfma_f32_16x16x32_bf16 v[48:51], v[100:103], v[80:83], v[48:51]
    v_mfma_f32_16x16x32_bf16 v[52:55], v[100:103], v[84:87], v[52:55]
    v_mfma_f32_16x16x32_bf16 v[56:59], v[100:103], v[88:91], v[56:59]
    v_mfma_f32_16x16x32_bf16 v[60:63], v[100:103], v[92:95], v[60:63]
    s_waitcnt lgkmcnt(1)
    v_mfma_f32_16x16x32_bf16 v[32:35], v[104:107], v[0:3], v[32:35]
    v_mfma_f32_16x16x32_bf16 v[36:39], v[104:107], v[4:7], v[36:39]
    v_mfma_f32_16x16x32_bf16 v[40:43], v[104:107], v[8:11], v[40:43]
    v_mfma_f32_16x16x32_bf16 v[44:47], v[104:107], v[12:15], v[44:47]
    v_mfma_f32_16x16x32_bf16 v[48:51], v[104:107], v[16:19], v[48:51]
    v_mfma_f32_16x16x32_bf16 v[52:55], v[104:107], v[20:23], v[52:55]
    v_mfma_f32_16x16x32_bf16 v[56:59], v[104:107], v[24:27], v[56:59]
    v_mfma_f32_16x16x32_bf16 v[60:63], v[104:107], v[28:31], v[60:63]
    s_waitcnt lgkmcnt(0)
    v_mfma_f32_16x16x32_bf16 v[32:35], v[108:111], v[0:3], v[32:35]
    v_mfma_f32_16x16x32_bf16 v[36:39], v[108:111], v[4:7], v[36:39]
    v_mfma_f32_16x16x32_bf16 v[40:43], v[108:111], v[8:11], v[40:43]
    v_mfma_f32_16x16x32_bf16 v[44:47], v[108:111], v[12:15], v[44:47]
    v_mfma_f32_16x16x32_bf16 v[48:51], v[108:111], v[16:19], v[48:51]
    v_mfma_f32_16x16x32_bf16 v[52:55], v[108:111], v[20:23], v[52:55]
    v_mfma_f32_16x16x32_bf16 v[56:59], v[108:111], v[24:27], v[56:59]
    v_mfma_f32_16x16x32_bf16 v[60:63], v[108:111], v[28:31], v[60:63]
    s_nop 7
    v_cvt_pk_bf16_f32 v112, v32, v36
    v_cvt_pk_bf16_f32 v113, v40, v44
    v_cvt_pk_bf16_f32 v114, v48, v52
    v_cvt_pk_bf16_f32 v115, v56, v60
    buffer_store_dwordx4 v[112:115], v120, s[20:23], s25 offen
    s_add_u32 s25, s25, 2736128
    v_cvt_pk_bf16_f32 v116, v33, v37
    v_cvt_pk_bf16_f32 v117, v41, v45
    v_cvt_pk_bf16_f32 v118, v49, v53
    v_cvt_pk_bf16_f32 v119, v57, v61
    buffer_store_dwordx4 v[116:119], v120, s[20:23], s25 offen
    s_add_u32 s25, s25, 2736128
    v_cvt_pk_bf16_f32 v112, v34, v38
    v_cvt_pk_bf16_f32 v113, v42, v46
    v_cvt_pk_bf16_f32 v114, v50, v54
    v_cvt_pk_bf16_f32 v115, v58, v62
    buffer_store_dwordx4 v[112:115], v120, s[20:23], s25 offen
    s_add_u32 s25, s25, 2736128
    v_cvt_pk_bf16_f32 v116, v35, v39
    v_cvt_pk_bf16_f32 v117, v43, v47
    v_cvt_pk_bf16_f32 v118, v51, v55
    v_cvt_pk_bf16_f32 v119, v59, v63
    buffer_store_dwordx4 v[116:119], v120, s[20:23], s25 offen
    s_add_u32 s25, s25, 2736128
    ds_read_b128 v[96:99], v121 offset:12288
    ds_read_b128 v[100:103], v121 offset:13312
    ds_read_b128 v[104:107], v121 offset:14336
    ds_read_b128 v[108:111], v121 offset:15360
    s_waitcnt lgkmcnt(3)
    v_mfma_f32_16x16x32_bf16 v[32:35], v[96:99], v[64:67], 0
    v_mfma_f32_16x16x32_bf16 v[36:39], v[96:99], v[68:71], 0
    v_mfma_f32_16x16x32_bf16 v[40:43], v[96:99], v[72:75], 0
    v_mfma_f32_16x16x32_bf16 v[44:47], v[96:99], v[76:79], 0
    v_mfma_f32_16x16x32_bf16 v[48:51], v[96:99], v[80:83], 0
    v_mfma_f32_16x16x32_bf16 v[52:55], v[96:99], v[84:87], 0
    v_mfma_f32_16x16x32_bf16 v[56:59], v[96:99], v[88:91], 0
    v_mfma_f32_16x16x32_bf16 v[60:63], v[96:99], v[92:95], 0
    s_waitcnt lgkmcnt(2)
    v_mfma_f32_16x16x32_bf16 v[32:35], v[100:103], v[64:67], v[32:35]
    v_mfma_f32_16x16x32_bf16 v[36:39], v[100:103], v[68:71], v[36:39]
    v_mfma_f32_16x16x32_bf16 v[40:43], v[100:103], v[72:75], v[40:43]
    v_mfma_f32_16x16x32_bf16 v[44:47], v[100:103], v[76:79], v[44:47]
    v_mfma_f32_16x16x32_bf16 v[48:51], v[100:103], v[80:83], v[48:51]
    v_mfma_f32_16x16x32_bf16 v[52:55], v[100:103], v[84:87], v[52:55]
    v_mfma_f32_16x16x32_bf16 v[56:59], v[100:103], v[88:91], v[56:59]
    v_mfma_f32_16x16x32_bf16 v[60:63], v[100:103], v[92:95], v[60:63]
    s_waitcnt lgkmcnt(1)
    v_mfma_f32_16x16x32_bf16 v[32:35], v[104:107], v[0:3], v[32:35]
    v_mfma_f32_16x16x32_bf16 v[36:39], v[104:107], v[4:7], v[36:39]
    v_mfma_f32_16x16x32_bf16 v[40:43], v[104:107], v[8:11], v[40:43]
    v_mfma_f32_16x16x32_bf16 v[44:47], v[104:107], v[12:15], v[44:47]
    v_mfma_f32_16x16x32_bf16 v[48:51], v[104:107], v[16:19], v[48:51]
    v_mfma_f32_16x16x32_bf16 v[52:55], v[104:107], v[20:23], v[52:55]
    v_mfma_f32_16x16x32_bf16 v[56:59], v[104:107], v[24:27], v[56:59]
    v_mfma_f32_16x16x32_bf16 v[60:63], v[104:107], v[28:31], v[60:63]
    s_waitcnt lgkmcnt(0)
    v_mfma_f32_16x16x32_bf16 v[32:35], v[108:111], v[0:3], v[32:35]
    v_mfma_f32_16x16x32_bf16 v[36:39], v[108:111], v[4:7], v[36:39]
    v_mfma_f32_16x16x32_bf16 v[40:43], v[108:111], v[8:11], v[40:43]
    v_mfma_f32_16x16x32_bf16 v[44:47], v[108:111], v[12:15], v[44:47]
    v_mfma_f32_16x16x32_bf16 v[48:51], v[108:111], v[16:19], v[48:51]
    v_mfma_f32_16x16x32_bf16 v[52:55], v[108:111], v[20:23], v[52:55]
    v_mfma_f32_16x16x32_bf16 v[56:59], v[108:111], v[24:27], v[56:59]
    v_mfma_f32_16x16x32_bf16 v[60:63], v[108:111], v[28:31], v[60:63]
    s_nop 7
    v_cvt_pk_bf16_f32 v112, v32, v36
    v_cvt_pk_bf16_f32 v113, v40, v44
    v_cvt_pk_bf16_f32 v114, v48, v52
    v_cvt_pk_bf16_f32 v115, v56, v60
    buffer_store_dwordx4 v[112:115], v120, s[20:23], s25 offen
    s_add_u32 s25, s25, 2736128
    v_cvt_pk_bf16_f32 v116, v33, v37
    v_cvt_pk_bf16_f32 v117, v41, v45
    v_cvt_pk_bf16_f32 v118, v49, v53
    v_cvt_pk_bf16_f32 v119, v57, v61
    buffer_store_dwordx4 v[116:119], v120, s[20:23], s25 offen
    s_add_u32 s25, s25, 2736128
    v_cvt_pk_bf16_f32 v112, v34, v38
    v_cvt_pk_bf16_f32 v113, v42, v46
    v_cvt_pk_bf16_f32 v114, v50, v54
    v_cvt_pk_bf16_f32 v115, v58, v62
    buffer_store_dwordx4 v[112:115], v120, s[20:23], s25 offen
    s_add_u32 s25, s25, 2736128
    v_cvt_pk_bf16_f32 v116, v35, v39
    v_cvt_pk_bf16_f32 v117, v43, v47
    v_cvt_pk_bf16_f32 v118, v51, v55
    v_cvt_pk_bf16_f32 v119, v59, v63
    buffer_store_dwordx4 v[116:119], v120, s[20:23], s25 offen
    s_endpgm
K1_W:
    s_mov_b32 s16, s6
    s_mov_b32 s17, s7
    s_and_b32 s17, s17, 0xffff
    s_mov_b32 s18, 16252928
    s_mov_b32 s19, 0x00020000
    s_add_u32 s20, s8, 50331648
    s_addc_u32 s21, s9, 0
    s_and_b32 s21, s21, 0xffff
    s_mov_b32 s22, 67108864
    s_mov_b32 s23, 0x00020000
    s_mul_i32 s11, s2, 1
    s_lshr_b32 s12, s11, 9
    s_and_b32 s13, s11, 511
    s_lshl_b32 s14, s12, 19
    s_lshl_b32 s15, s13, 10
    s_add_u32 s14, s14, s15
    s_lshl_b32 s15, s3, 8
    s_add_u32 s14, s14, s15
    v_and_b32 v126, 1, v123
    v_lshlrev_b32 v126, 23, v126
    v_lshl_add_u32 v126, v122, 4, v126
    s_mov_b32 s15, s14
    buffer_load_dwordx4 v[0:3], v126, s[16:19], s15 offen
    s_add_u32 s15, s15, 0x100000
    buffer_load_dwordx4 v[4:7], v126, s[16:19], s15 offen
    s_add_u32 s15, s15, 0x100000
    buffer_load_dwordx4 v[8:11], v126, s[16:19], s15 offen
    s_add_u32 s15, s15, 0x100000
    buffer_load_dwordx4 v[12:15], v126, s[16:19], s15 offen
    s_add_u32 s15, s15, 0x100000
    buffer_load_dwordx4 v[16:19], v126, s[16:19], s15 offen
    s_add_u32 s15, s15, 0x100000
    buffer_load_dwordx4 v[20:23], v126, s[16:19], s15 offen
    s_add_u32 s15, s15, 0x100000
    buffer_load_dwordx4 v[24:27], v126, s[16:19], s15 offen
    s_add_u32 s15, s15, 0x100000
    buffer_load_dwordx4 v[28:31], v126, s[16:19], s15 offen
    v_and_b32 v127, 1, v123
    v_lshlrev_b32 v127, 3, v127
    v_mul_u32_u24 v112, 96, v125
    v_mad_u32_u24 v113, v124, v127, v112
    v_mad_u32_u24 v64, v124, 0, v113
    v_mad_u32_u24 v65, v124, 1, v113
    v_mad_u32_u24 v66, v124, 2, v113
    v_mad_u32_u24 v67, v124, 3, v113
    v_mad_u32_u24 v68, v124, 4, v113
    v_mad_u32_u24 v69, v124, 5, v113
    v_mad_u32_u24 v70, v124, 6, v113
    v_mad_u32_u24 v71, v124, 7, v113
    v_and_b32 v64, 127, v64
    v_and_b32 v65, 127, v65
    v_and_b32 v66, 127, v66
    v_and_b32 v67, 127, v67
    v_and_b32 v68, 127, v68
    v_and_b32 v69, 127, v69
    v_and_b32 v70, 127, v70
    v_and_b32 v71, 127, v71
    v_cvt_f32_u32 v64, v64
    v_cvt_f32_u32 v65, v65
    v_cvt_f32_u32 v66, v66
    v_cvt_f32_u32 v67, v67
    v_cvt_f32_u32 v68, v68
    v_cvt_f32_u32 v69, v69
    v_cvt_f32_u32 v70, v70
    v_cvt_f32_u32 v71, v71
    v_mul_f32 v64, 0x3c000000, v64
    v_mul_f32 v65, 0x3c000000, v65
    v_mul_f32 v66, 0x3c000000, v66
    v_mul_f32 v67, 0x3c000000, v67
    v_mul_f32 v68, 0x3c000000, v68
    v_mul_f32 v69, 0x3c000000, v69
    v_mul_f32 v70, 0x3c000000, v70
    v_mul_f32 v71, 0x3c000000, v71
    v_cos_f32 v64, v64
    v_cos_f32 v65, v65
    v_cos_f32 v66, v66
    v_cos_f32 v67, v67
    v_cos_f32 v68, v68
    v_cos_f32 v69, v69
    v_cos_f32 v70, v70
    v_cos_f32 v71, v71
    s_nop 0
    v_cvt_pk_bf16_f32 v72, v64, v65
    v_cvt_pk_bf16_f32 v73, v66, v67
    v_cvt_pk_bf16_f32 v74, v68, v69
    v_cvt_pk_bf16_f32 v75, v70, v71
    v_lshlrev_b32 v80, 16, v72
    v_and_b32 v81, 0xffff0000, v72
    v_sub_f32 v64, v64, v80
    v_sub_f32 v65, v65, v81
    v_lshlrev_b32 v80, 16, v73
    v_and_b32 v81, 0xffff0000, v73
    v_sub_f32 v66, v66, v80
    v_sub_f32 v67, v67, v81
    v_lshlrev_b32 v80, 16, v74
    v_and_b32 v81, 0xffff0000, v74
    v_sub_f32 v68, v68, v80
    v_sub_f32 v69, v69, v81
    v_lshlrev_b32 v80, 16, v75
    v_and_b32 v81, 0xffff0000, v75
    v_sub_f32 v70, v70, v80
    v_sub_f32 v71, v71, v81
    v_cvt_pk_bf16_f32 v76, v64, v65
    v_cvt_pk_bf16_f32 v77, v66, v67
    v_cvt_pk_bf16_f32 v78, v68, v69
    v_cvt_pk_bf16_f32 v79, v70, v71
    v_cmp_lt_u32 vcc, 1, v123
    s_lshl_b32 s24, s3, 10
    v_add_u32 v114, s24, v121
    v_cndmask_b32 v72, v72, v76, vcc
    v_cndmask_b32 v73, v73, v77, vcc
    v_cndmask_b32 v74, v74, v78, vcc
    v_cndmask_b32 v75, v75, v79, vcc
    ds_write_b128 v114, v[72:75]
    v_lshrrev_b32 v112, 1, v123
    s_mov_b32 s24, 2097152
    v_mul_lo_u32 v112, v112, s24
    v_and_b32 v113, 1, v123
    v_lshl_add_u32 v112, v113, 8, v112
    v_and_b32 v113, 1, v122
    v_lshl_add_u32 v124, v113, 4, v112
    v_lshrrev_b32 v125, 1, v122
    s_mul_i32 s26, s3, 524288
    s_lshl_b32 s24, s11, 9
    s_add_u32 s26, s26, s24
    s_waitcnt lgkmcnt(0)
    s_barrier
    ds_read_b128 v[96:99], v121 offset:0
    ds_read_b128 v[100:103], v121 offset:1024
    ds_read_b128 v[104:107], v121 offset:2048
    ds_read_b128 v[108:111], v121 offset:3072
    s_mov_b32 s27, 0
    s_waitcnt vmcnt(0) lgkmcnt(0)
K1_W_LOOP:
    s_add_u32 s24, s11, s27
    s_and_b32 s30, s24, 3
    s_lshr_b32 s24, s24, 1
    s_and_b32 s24, s24, 4
    s_or_b32 s30, s30, s24
    v_xor_b32 v112, s30, v125
    v_lshl_add_u32 v120, v112, 5, v124
    s_lshl_b32 s25, s27, 9
    s_add_u32 s25, s25, s26
    v_perm_b32 v32, v4, v0, s28
    v_perm_b32 v36, v4, v0, s29
    v_perm_b32 v33, v12, v8, s28
    v_perm_b32 v37, v12, v8, s29
    v_perm_b32 v34, v20, v16, s28
    v_perm_b32 v38, v20, v16, s29
    v_perm_b32 v35, v28, v24, s28
    v_perm_b32 v39, v28, v24, s29
    v_perm_b32 v40, v5, v1, s28
    v_perm_b32 v44, v5, v1, s29
    v_perm_b32 v41, v13, v9, s28
    v_perm_b32 v45, v13, v9, s29
    v_perm_b32 v42, v21, v17, s28
    v_perm_b32 v46, v21, v17, s29
    v_perm_b32 v43, v29, v25, s28
    v_perm_b32 v47, v29, v25, s29
    v_perm_b32 v48, v6, v2, s28
    v_perm_b32 v52, v6, v2, s29
    v_perm_b32 v49, v14, v10, s28
    v_perm_b32 v53, v14, v10, s29
    v_perm_b32 v50, v22, v18, s28
    v_perm_b32 v54, v22, v18, s29
    v_perm_b32 v51, v30, v26, s28
    v_perm_b32 v55, v30, v26, s29
    v_perm_b32 v56, v7, v3, s28
    v_perm_b32 v60, v7, v3, s29
    v_perm_b32 v57, v15, v11, s28
    v_perm_b32 v61, v15, v11, s29
    v_perm_b32 v58, v23, v19, s28
    v_perm_b32 v62, v23, v19, s29
    v_perm_b32 v59, v31, v27, s28
    v_perm_b32 v63, v31, v27, s29
    s_add_u32 s27, s27, 1
    s_add_u32 s14, s14, 1024
    s_cmp_ge_u32 s27, 1
    s_cbranch_scc1 K1_W_NOLOAD
    s_mov_b32 s15, s14
    buffer_load_dwordx4 v[0:3], v126, s[16:19], s15 offen
    s_add_u32 s15, s15, 0x100000
    buffer_load_dwordx4 v[4:7], v126, s[16:19], s15 offen
    s_add_u32 s15, s15, 0x100000
    buffer_load_dwordx4 v[8:11], v126, s[16:19], s15 offen
    s_add_u32 s15, s15, 0x100000
    buffer_load_dwordx4 v[12:15], v126, s[16:19], s15 offen
    s_add_u32 s15, s15, 0x100000
    buffer_load_dwordx4 v[16:19], v126, s[16:19], s15 offen
    s_add_u32 s15, s15, 0x100000
    buffer_load_dwordx4 v[20:23], v126, s[16:19], s15 offen
    s_add_u32 s15, s15, 0x100000
    buffer_load_dwordx4 v[24:27], v126, s[16:19], s15 offen
    s_add_u32 s15, s15, 0x100000
    buffer_load_dwordx4 v[28:31], v126, s[16:19], s15 offen
K1_W_NOLOAD:
    v_mfma_f32_16x16x32_bf16 v[64:67], v[96:99], v[32:35], 0
    v_mfma_f32_16x16x32_bf16 v[68:71], v[96:99], v[36:39], 0
    v_mfma_f32_16x16x32_bf16 v[72:75], v[96:99], v[40:43], 0
    v_mfma_f32_16x16x32_bf16 v[76:79], v[96:99], v[44:47], 0
    v_mfma_f32_16x16x32_bf16 v[80:83], v[96:99], v[48:51], 0
    v_mfma_f32_16x16x32_bf16 v[84:87], v[96:99], v[52:55], 0
    v_mfma_f32_16x16x32_bf16 v[88:91], v[96:99], v[56:59], 0
    v_mfma_f32_16x16x32_bf16 v[92:95], v[96:99], v[60:63], 0
    s_nop 7
    v_cvt_pk_bf16_f32 v112, v64, v68
    v_cvt_pk_bf16_f32 v113, v72, v76
    v_cvt_pk_bf16_f32 v114, v80, v84
    v_cvt_pk_bf16_f32 v115, v88, v92
    buffer_store_dwordx4 v[112:115], v120, s[20:23], s25 offen
    s_add_u32 s25, s25, 4194304
    v_cvt_pk_bf16_f32 v116, v65, v69
    v_cvt_pk_bf16_f32 v117, v73, v77
    v_cvt_pk_bf16_f32 v118, v81, v85
    v_cvt_pk_bf16_f32 v119, v89, v93
    buffer_store_dwordx4 v[116:119], v120, s[20:23], s25 offen
    s_add_u32 s25, s25, 4194304
    v_cvt_pk_bf16_f32 v112, v66, v70
    v_cvt_pk_bf16_f32 v113, v74, v78
    v_cvt_pk_bf16_f32 v114, v82, v86
    v_cvt_pk_bf16_f32 v115, v90, v94
    buffer_store_dwordx4 v[112:115], v120, s[20:23], s25 offen
    s_add_u32 s25, s25, 4194304
    v_cvt_pk_bf16_f32 v116, v67, v71
    v_cvt_pk_bf16_f32 v117, v75, v79
    v_cvt_pk_bf16_f32 v118, v83, v87
    v_cvt_pk_bf16_f32 v119, v91, v95
    buffer_store_dwordx4 v[116:119], v120, s[20:23], s25 offen
    s_add_u32 s25, s25, 4194304
    v_mfma_f32_16x16x32_bf16 v[64:67], v[100:103], v[32:35], 0
    v_mfma_f32_16x16x32_bf16 v[68:71], v[100:103], v[36:39], 0
    v_mfma_f32_16x16x32_bf16 v[72:75], v[100:103], v[40:43], 0
    v_mfma_f32_16x16x32_bf16 v[76:79], v[100:103], v[44:47], 0
    v_mfma_f32_16x16x32_bf16 v[80:83], v[100:103], v[48:51], 0
    v_mfma_f32_16x16x32_bf16 v[84:87], v[100:103], v[52:55], 0
    v_mfma_f32_16x16x32_bf16 v[88:91], v[100:103], v[56:59], 0
    v_mfma_f32_16x16x32_bf16 v[92:95], v[100:103], v[60:63], 0
    s_nop 7
    v_cvt_pk_bf16_f32 v112, v64, v68
    v_cvt_pk_bf16_f32 v113, v72, v76
    v_cvt_pk_bf16_f32 v114, v80, v84
    v_cvt_pk_bf16_f32 v115, v88, v92
    buffer_store_dwordx4 v[112:115], v120, s[20:23], s25 offen
    s_add_u32 s25, s25, 4194304
    v_cvt_pk_bf16_f32 v116, v65, v69
    v_cvt_pk_bf16_f32 v117, v73, v77
    v_cvt_pk_bf16_f32 v118, v81, v85
    v_cvt_pk_bf16_f32 v119, v89, v93
    buffer_store_dwordx4 v[116:119], v120, s[20:23], s25 offen
    s_add_u32 s25, s25, 4194304
    v_cvt_pk_bf16_f32 v112, v66, v70
    v_cvt_pk_bf16_f32 v113, v74, v78
    v_cvt_pk_bf16_f32 v114, v82, v86
    v_cvt_pk_bf16_f32 v115, v90, v94
    buffer_store_dwordx4 v[112:115], v120, s[20:23], s25 offen
    s_add_u32 s25, s25, 4194304
    v_cvt_pk_bf16_f32 v116, v67, v71
    v_cvt_pk_bf16_f32 v117, v75, v79
    v_cvt_pk_bf16_f32 v118, v83, v87
    v_cvt_pk_bf16_f32 v119, v91, v95
    buffer_store_dwordx4 v[116:119], v120, s[20:23], s25 offen
    s_add_u32 s25, s25, 4194304
    v_mfma_f32_16x16x32_bf16 v[64:67], v[104:107], v[32:35], 0
    v_mfma_f32_16x16x32_bf16 v[68:71], v[104:107], v[36:39], 0
    v_mfma_f32_16x16x32_bf16 v[72:75], v[104:107], v[40:43], 0
    v_mfma_f32_16x16x32_bf16 v[76:79], v[104:107], v[44:47], 0
    v_mfma_f32_16x16x32_bf16 v[80:83], v[104:107], v[48:51], 0
    v_mfma_f32_16x16x32_bf16 v[84:87], v[104:107], v[52:55], 0
    v_mfma_f32_16x16x32_bf16 v[88:91], v[104:107], v[56:59], 0
    v_mfma_f32_16x16x32_bf16 v[92:95], v[104:107], v[60:63], 0
    s_nop 7
    v_cvt_pk_bf16_f32 v112, v64, v68
    v_cvt_pk_bf16_f32 v113, v72, v76
    v_cvt_pk_bf16_f32 v114, v80, v84
    v_cvt_pk_bf16_f32 v115, v88, v92
    buffer_store_dwordx4 v[112:115], v120, s[20:23], s25 offen
    s_add_u32 s25, s25, 4194304
    v_cvt_pk_bf16_f32 v116, v65, v69
    v_cvt_pk_bf16_f32 v117, v73, v77
    v_cvt_pk_bf16_f32 v118, v81, v85
    v_cvt_pk_bf16_f32 v119, v89, v93
    buffer_store_dwordx4 v[116:119], v120, s[20:23], s25 offen
    s_add_u32 s25, s25, 4194304
    v_cvt_pk_bf16_f32 v112, v66, v70
    v_cvt_pk_bf16_f32 v113, v74, v78
    v_cvt_pk_bf16_f32 v114, v82, v86
    v_cvt_pk_bf16_f32 v115, v90, v94
    buffer_store_dwordx4 v[112:115], v120, s[20:23], s25 offen
    s_add_u32 s25, s25, 4194304
    v_cvt_pk_bf16_f32 v116, v67, v71
    v_cvt_pk_bf16_f32 v117, v75, v79
    v_cvt_pk_bf16_f32 v118, v83, v87
    v_cvt_pk_bf16_f32 v119, v91, v95
    buffer_store_dwordx4 v[116:119], v120, s[20:23], s25 offen
    s_add_u32 s25, s25, 4194304
    v_mfma_f32_16x16x32_bf16 v[64:67], v[108:111], v[32:35], 0
    v_mfma_f32_16x16x32_bf16 v[68:71], v[108:111], v[36:39], 0
    v_mfma_f32_16x16x32_bf16 v[72:75], v[108:111], v[40:43], 0
    v_mfma_f32_16x16x32_bf16 v[76:79], v[108:111], v[44:47], 0
    v_mfma_f32_16x16x32_bf16 v[80:83], v[108:111], v[48:51], 0
    v_mfma_f32_16x16x32_bf16 v[84:87], v[108:111], v[52:55], 0
    v_mfma_f32_16x16x32_bf16 v[88:91], v[108:111], v[56:59], 0
    v_mfma_f32_16x16x32_bf16 v[92:95], v[108:111], v[60:63], 0
    s_nop 7
    v_cvt_pk_bf16_f32 v112, v64, v68
    v_cvt_pk_bf16_f32 v113, v72, v76
    v_cvt_pk_bf16_f32 v114, v80, v84
    v_cvt_pk_bf16_f32 v115, v88, v92
    buffer_store_dwordx4 v[112:115], v120, s[20:23], s25 offen
    s_add_u32 s25, s25, 4194304
    v_cvt_pk_bf16_f32 v116, v65, v69
    v_cvt_pk_bf16_f32 v117, v73, v77
    v_cvt_pk_bf16_f32 v118, v81, v85
    v_cvt_pk_bf16_f32 v119, v89, v93
    buffer_store_dwordx4 v[116:119], v120, s[20:23], s25 offen
    s_add_u32 s25, s25, 4194304
    v_cvt_pk_bf16_f32 v112, v66, v70
    v_cvt_pk_bf16_f32 v113, v74, v78
    v_cvt_pk_bf16_f32 v114, v82, v86
    v_cvt_pk_bf16_f32 v115, v90, v94
    buffer_store_dwordx4 v[112:115], v120, s[20:23], s25 offen
    s_add_u32 s25, s25, 4194304
    v_cvt_pk_bf16_f32 v116, v67, v71
    v_cvt_pk_bf16_f32 v117, v75, v79
    v_cvt_pk_bf16_f32 v118, v83, v87
    v_cvt_pk_bf16_f32 v119, v91, v95
    buffer_store_dwordx4 v[116:119], v120, s[20:23], s25 offen
    s_waitcnt vmcnt(16)
    s_cmp_lt_u32 s27, 1
    s_cbranch_scc1 K1_W_LOOP
K1_END:
    s_endpgm
.p2align 8
.type k12_fused_kernel,@function
k12_fused_kernel:
    s_cmp_ge_u32 s2, 256
    s_cbranch_scc1 K12_END
    s_load_dwordx4 s[52:55], s[0:1], 0
    s_load_dwordx4 s[56:59], s[0:1], 40
    s_getpc_b64 s[90:91]
CPF_K12:
    s_sub_u32 s90, s90, CPF_K12-k12_fused_kernel
    s_subb_u32 s91, s91, 0
    v_lshlrev_b32 v8, 7, v0
    v_mov_b32 v11, s91
    v_min_u32 v9, TEXT_END-k12_fused_kernel-4, v8
    v_add_co_u32 v10, vcc, s90, v9
    v_addc_co_u32 v11, vcc, 0, v11, vcc
    global_load_dword v63, v[10:11], off
    v_lshrrev_b32 v1, 6, v0
    v_and_b32 v2, 63, v0
    v_readfirstlane_b32 s3, v1
    s_waitcnt lgkmcnt(0)
    s_cmp_lt_u32 s3, 4
    s_cbranch_scc1 K12_CONS
    v_and_b32 v64, 15, v2
    v_lshrrev_b32 v65, 4, v2
    v_lshlrev_b32 v254, 4, v2
    s_and_b32 s44, s3, 3
    s_and_b32 s20, s44, 1
    s_lshr_b32 s21, s44, 1
    s_lshl_b32 s22, s2, 1
    s_add_u32 s22, s22, s21
    s_and_b32 s23, s22, 3
    s_lshr_b32 s22, s22, 2
    s_and_b32 s24, s2, 7
    s_lshl_b32 s24, s24, 5
    s_lshr_b32 s25, s2, 3
    s_add_u32 s24, s24, s25
    s_cmp_ge_u32 s24, 167
    s_cselect_b32 s25, 1, 0
    s_mul_i32 s26, s25, 167
    s_sub_u32 s24, s24, s26
    s_cmp_eq_u32 s21, 0
    s_cselect_b32 s25, s25, 1
    s_mul_i32 s26, s25, 16384000
    s_add_u32 s4, s52, s26
    s_addc_u32 s5, s53, 0
    s_and_b32 s5, s5, 0xffff
    s_mov_b32 s6, 16384000
    s_mov_b32 s7, 0x00020000
    s_mov_b32 s8, s54
    s_mov_b32 s9, s55
    s_and_b32 s9, s9, 0xffff
    s_mov_b32 s10, 16252928
    s_mov_b32 s11, 0x00020000
    s_mov_b32 s12, s58
    s_mov_b32 s13, s59
    s_and_b32 s13, s13, 0xffff
    s_mov_b32 s14, 43778048
    s_mov_b32 s15, 0x00020000
    s_add_u32 s16, s58, 50331648
    s_addc_u32 s17, s59, 0
    s_and_b32 s17, s17, 0xffff
    s_mov_b32 s18, 67108864
    s_mov_b32 s19, 0x00020000
    s_add_u32 s60, s58, 153092096
    s_addc_u32 s61, s59, 0
    s_and_b32 s61, s61, 0xffff
    s_mov_b32 s62, 32768
    s_mov_b32 s63, 0x00020000
    s_mov_b32 s28, 0x05040100
    s_mov_b32 s29, 0x07060302
    v_lshlrev_b32 v248, 14, v65
    v_lshl_add_u32 v248, v64, 4, v248
    v_and_b32 v250, 1, v65
    v_lshlrev_b32 v250, 23, v250
    v_lshl_add_u32 v250, v64, 4, v250
    v_lshrrev_b32 v66, 1, v65
    s_mov_b32 s26, 1368064
    v_mul_lo_u32 v66, v66, s26
    v_lshrrev_b32 v67, 2, v64
    s_mov_b32 s26, 21376
    v_mul_lo_u32 v67, v67, s26
    v_add_u32 v66, v66, v67
    v_mov_b32 v252, v66
    v_lshrrev_b32 v66, 1, v65
    s_mov_b32 s26, 2097152
    v_mul_lo_u32 v66, v66, s26
    v_and_b32 v67, 1, v65
    v_lshl_add_u32 v66, v67, 8, v66
    v_and_b32 v67, 1, v64
    v_lshl_add_u32 v251, v67, 4, v66
    s_mul_i32 s31, s25, 684032
    s_mul_i32 s32, s23, 524288
    s_lshl_b32 s33, s23, 8
    s_mov_b32 s40, 3
    s_xor_b32 s43, s40, s20
    s_and_b32 s43, s43, 1
    s_mul_i32 s36, s40, 85
    s_add_u32 s36, s36, s2
    s_and_b32 s36, s36, 255
    s_mul_hi_u32 s37, s36, 0x55555556
    s_mul_i32 s38, s37, 3
    s_cmp_eq_u32 s38, s36
    s_cselect_b32 s27, 1, 0
    s_cmp_lt_u32 s37, 78
    s_cselect_b32 s27, s27, 0
    s_add_u32 s37, s37, 89
    s_cmp_eq_u32 s21, 0
    s_cselect_b32 s30, s24, s37
    s_cselect_b32 s27, 1, s27
    s_cmp_eq_u32 s43, 0
    s_cbranch_scc0 K12_PL1
    s_lshl_b32 s36, s40, 7
    s_add_u32 s36, s36, s22
    s_lshr_b32 s37, s36, 9
    s_lshl_b32 s37, s37, 19
    s_and_b32 s36, s36, 511
    s_lshl_b32 s36, s36, 10
    s_add_u32 s36, s36, s37
    s_add_u32 s36, s36, s33
    buffer_load_dwordx4 v[96:99], v250, s[8:11], s36 offen
    s_add_u32 s36, s36, 0x100000
    buffer_load_dwordx4 v[100:103], v250, s[8:11], s36 offen
    s_add_u32 s36, s36, 0x100000
    buffer_load_dwordx4 v[104:107], v250, s[8:11], s36 offen
    s_add_u32 s36, s36, 0x100000
    buffer_load_dwordx4 v[108:111], v250, s[8:11], s36 offen
    s_add_u32 s36, s36, 0x100000
    buffer_load_dwordx4 v[112:115], v250, s[8:11], s36 offen
    s_add_u32 s36, s36, 0x100000
    buffer_load_dwordx4 v[116:119], v250, s[8:11], s36 offen
    s_add_u32 s36, s36, 0x100000
    buffer_load_dwordx4 v[120:123], v250, s[8:11], s36 offen
    s_add_u32 s36, s36, 0x100000
    buffer_load_dwordx4 v[124:127], v250, s[8:11], s36 offen
    s_branch K12_PL2
K12_PL1:
    s_cmp_eq_u32 s27, 0
    s_cbranch_scc1 K12_PL2
    s_lshl_b32 s36, s40, 8
    s_mul_i32 s37, s30, 98304
    s_add_u32 s36, s36, s37
    buffer_load_dwordx4 v[0:3], v248, s[4:7], s36 offen
    buffer_load_dwordx4 v[4:7], v248, s[4:7], s36 offen offset:2048
    s_add_u32 s36, s36, 4096
    buffer_load_dwordx4 v[8:11], v248, s[4:7], s36 offen
    buffer_load_dwordx4 v[12:15], v248, s[4:7], s36 offen offset:2048
    s_add_u32 s36, s36, 4096
    buffer_load_dwordx4 v[16:19], v248, s[4:7], s36 offen
    buffer_load_dwordx4 v[20:23], v248, s[4:7], s36 offen offset:2048
    s_add_u32 s36, s36, 4096
    buffer_load_dwordx4 v[24:27], v248, s[4:7], s36 offen
    buffer_load_dwordx4 v[28:31], v248, s[4:7], s36 offen offset:2048
    s_add_u32 s36, s36, 53248
    buffer_load_dwordx4 v[32:35], v248, s[4:7], s36 offen
    buffer_load_dwordx4 v[36:39], v248, s[4:7], s36 offen offset:2048
    s_add_u32 s36, s36, 4096
    buffer_load_dwordx4 v[40:43], v248, s[4:7], s36 offen
    buffer_load_dwordx4 v[44:47], v248, s[4:7], s36 offen offset:2048
    s_add_u32 s36, s36, 4096
    buffer_load_dwordx4 v[48:51], v248, s[4:7], s36 offen
    buffer_load_dwordx4 v[52:55], v248, s[4:7], s36 offen offset:2048
    s_add_u32 s36, s36, 4096
    buffer_load_dwordx4 v[56:59], v248, s[4:7], s36 offen
    buffer_load_dwordx4 v[60:63], v248, s[4:7], s36 offen offset:2048
K12_PL2:
    v_lshrrev_b32 v128, 4, v254
    v_lshlrev_b32 v129, 11, v128
    v_lshrrev_b32 v130, 1, v128
    v_lshlrev_b32 v130, 20, v130
    v_and_b32 v131, 1, v128
    v_lshl_add_u32 v130, v131, 7, v130
    s_mov_b32 s45, s27
    s_mov_b32 s46, s30
    s_add_u32 s47, s40, 1
K12_TCH:
    s_xor_b32 s48, s47, s20
    s_and_b32 s48, s48, 1
    s_cmp_eq_u32 s48, 0
    s_cbranch_scc1 K12_TCHW
    s_mul_i32 s36, s47, 85
    s_add_u32 s36, s36, s2
    s_and_b32 s36, s36, 255
    s_mul_hi_u32 s37, s36, 0x55555556
    s_mul_i32 s38, s37, 3
    s_cmp_eq_u32 s38, s36
    s_cselect_b32 s27, 1, 0
    s_cmp_lt_u32 s37, 78
    s_cselect_b32 s27, s27, 0
    s_add_u32 s37, s37, 89
    s_cmp_eq_u32 s21, 0
    s_cselect_b32 s30, s24, s37
    s_cselect_b32 s27, 1, s27
    s_cmp_eq_u32 s27, 0
    s_cbranch_scc1 K12_TCHN
    s_lshl_b32 s36, s47, 8
    s_mul_i32 s37, s30, 98304
    s_add_u32 s36, s36, s37
    buffer_load_dword v244, v129, s[4:7], s36 offen
    buffer_load_dword v245, v129, s[4:7], s36 offen offset:128
    s_branch K12_TCHN
K12_TCHW:
    s_lshl_b32 s36, s47, 7
    s_add_u32 s36, s36, s22
    s_lshr_b32 s37, s36, 9
    s_lshl_b32 s37, s37, 19
    s_and_b32 s36, s36, 511
    s_lshl_b32 s36, s36, 10
    s_add_u32 s36, s36, s37
    s_add_u32 s36, s36, s33
    s_mov_b64 exec, 0xffffffff
    buffer_load_dword v246, v130, s[8:11], s36 offen
    s_mov_b64 exec, -1
K12_TCHN:
    s_add_u32 s47, s47, 1
    s_cmp_lt_u32 s47, 8
    s_cbranch_scc1 K12_TCH
    s_mov_b32 s27, s45
    s_mov_b32 s30, s46
    v_and_b32 v128, 3, v64
    v_lshlrev_b32 v128, 2, v128
    v_lshrrev_b32 v130, 3, v64
    v_lshl_add_u32 v128, v130, 1, v128
    s_lshl_b32 s36, s44, 4
    s_add_u32 s36, s36, 1
    v_add_u32 v128, s36, v128
    v_bfe_u32 v129, v64, 2, 1
    v_lshlrev_b32 v131, 3, v65
    v_lshlrev_b32 v132, 5, v129
    v_mad_u32_u24 v133, v128, v131, v132
    v_mad_u32_u24 v136, v128, 0, v133
    v_mad_u32_u24 v137, v128, 1, v133
    v_mad_u32_u24 v138, v128, 2, v133
    v_mad_u32_u24 v139, v128, 3, v133
    v_mad_u32_u24 v140, v128, 4, v133
    v_mad_u32_u24 v141, v128, 5, v133
    v_mad_u32_u24 v142, v128, 6, v133
    v_mad_u32_u24 v143, v128, 7, v133
    v_and_b32 v136, 127, v136
    v_and_b32 v137, 127, v137
    v_and_b32 v138, 127, v138
    v_and_b32 v139, 127, v139
    v_and_b32 v140, 127, v140
    v_and_b32 v141, 127, v141
    v_and_b32 v142, 127, v142
    v_and_b32 v143, 127, v143
    v_cvt_f32_u32 v136, v136
    v_cvt_f32_u32 v137, v137
    v_cvt_f32_u32 v138, v138
    v_cvt_f32_u32 v139, v139
    v_cvt_f32_u32 v140, v140
    v_cvt_f32_u32 v141, v141
    v_cvt_f32_u32 v142, v142
    v_cvt_f32_u32 v143, v143
    v_mul_f32 v136, 0x3c000000, v136
    v_mul_f32 v137, 0x3c000000, v137
    v_mul_f32 v138, 0x3c000000, v138
    v_mul_f32 v139, 0x3c000000, v139
    v_mul_f32 v140, 0x3c000000, v140
    v_mul_f32 v141, 0x3c000000, v141
    v_mul_f32 v142, 0x3c000000, v142
    v_mul_f32 v143, 0x3c000000, v143
    v_cos_f32 v136, v136
    v_cos_f32 v137, v137
    v_cos_f32 v138, v138
    v_cos_f32 v139, v139
    v_cos_f32 v140, v140
    v_cos_f32 v141, v141
    v_cos_f32 v142, v142
    v_cos_f32 v143, v143
    s_nop 0
    v_cvt_pk_bf16_f32 v144, v136, v137
    v_cvt_pk_bf16_f32 v145, v138, v139
    v_cvt_pk_bf16_f32 v146, v140, v141
    v_cvt_pk_bf16_f32 v147, v142, v143
    v_lshlrev_b32 v152, 16, v144
    v_and_b32 v153, 0xffff0000, v144
    v_sub_f32 v136, v136, v152
    v_sub_f32 v137, v137, v153
    v_lshlrev_b32 v152, 16, v145
    v_and_b32 v153, 0xffff0000, v145
    v_sub_f32 v138, v138, v152
    v_sub_f32 v139, v139, v153
    v_lshlrev_b32 v152, 16, v146
    v_and_b32 v153, 0xffff0000, v146
    v_sub_f32 v140, v140, v152
    v_sub_f32 v141, v141, v153
    v_lshlrev_b32 v152, 16, v147
    v_and_b32 v153, 0xffff0000, v147
    v_sub_f32 v142, v142, v152
    v_sub_f32 v143, v143, v153
    v_cvt_pk_bf16_f32 v148, v136, v137
    v_cvt_pk_bf16_f32 v149, v138, v139
    v_cvt_pk_bf16_f32 v150, v140, v141
    v_cvt_pk_bf16_f32 v151, v142, v143
    s_lshl_b32 s37, s44, 12
    s_add_u32 s37, s37, 116736
    v_add_u32 v132, s37, v254
    ds_write_b128 v132, v[144:147]
    ds_write_b128 v132, v[148:151] offset:1024
    v_add_u32 v131, 32, v131
    v_lshlrev_b32 v132, 5, v129
    v_mad_u32_u24 v133, v128, v131, v132
    v_mad_u32_u24 v136, v128, 0, v133
    v_mad_u32_u24 v137, v128, 1, v133
    v_mad_u32_u24 v138, v128, 2, v133
    v_mad_u32_u24 v139, v128, 3, v133
    v_mad_u32_u24 v140, v128, 4, v133
    v_mad_u32_u24 v141, v128, 5, v133
    v_mad_u32_u24 v142, v128, 6, v133
    v_mad_u32_u24 v143, v128, 7, v133
    v_and_b32 v136, 127, v136
    v_and_b32 v137, 127, v137
    v_and_b32 v138, 127, v138
    v_and_b32 v139, 127, v139
    v_and_b32 v140, 127, v140
    v_and_b32 v141, 127, v141
    v_and_b32 v142, 127, v142
    v_and_b32 v143, 127, v143
    v_cvt_f32_u32 v136, v136
    v_cvt_f32_u32 v137, v137
    v_cvt_f32_u32 v138, v138
    v_cvt_f32_u32 v139, v139
    v_cvt_f32_u32 v140, v140
    v_cvt_f32_u32 v141, v141
    v_cvt_f32_u32 v142, v142
    v_cvt_f32_u32 v143, v143
    v_mul_f32 v136, 0x3c000000, v136
    v_mul_f32 v137, 0x3c000000, v137
    v_mul_f32 v138, 0x3c000000, v138
    v_mul_f32 v139, 0x3c000000, v139
    v_mul_f32 v140, 0x3c000000, v140
    v_mul_f32 v141, 0x3c000000, v141
    v_mul_f32 v142, 0x3c000000, v142
    v_mul_f32 v143, 0x3c000000, v143
    v_cos_f32 v136, v136
    v_cos_f32 v137, v137
    v_cos_f32 v138, v138
    v_cos_f32 v139, v139
    v_cos_f32 v140, v140
    v_cos_f32 v141, v141
    v_cos_f32 v142, v142
    v_cos_f32 v143, v143
    s_nop 0
    v_cvt_pk_bf16_f32 v144, v136, v137
    v_cvt_pk_bf16_f32 v145, v138, v139
    v_cvt_pk_bf16_f32 v146, v140, v141
    v_cvt_pk_bf16_f32 v147, v142, v143
    v_lshlrev_b32 v152, 16, v144
    v_and_b32 v153, 0xffff0000, v144
    v_sub_f32 v136, v136, v152
    v_sub_f32 v137, v137, v153
    v_lshlrev_b32 v152, 16, v145
    v_and_b32 v153, 0xffff0000, v145
    v_sub_f32 v138, v138, v152
    v_sub_f32 v139, v139, v153
    v_lshlrev_b32 v152, 16, v146
    v_and_b32 v153, 0xffff0000, v146
    v_sub_f32 v140, v140, v152
    v_sub_f32 v141, v141, v153
    v_lshlrev_b32 v152, 16, v147
    v_and_b32 v153, 0xffff0000, v147
    v_sub_f32 v142, v142, v152
    v_sub_f32 v143, v143, v153
    v_cvt_pk_bf16_f32 v148, v136, v137
    v_cvt_pk_bf16_f32 v149, v138, v139
    v_cvt_pk_bf16_f32 v150, v140, v141
    v_cvt_pk_bf16_f32 v151, v142, v143
    s_lshl_b32 s37, s44, 12
    s_add_u32 s37, s37, 118784
    v_add_u32 v132, s37, v254
    ds_write_b128 v132, v[144:147]
    ds_write_b128 v132, v[148:151] offset:1024
K12_TB:
    s_waitcnt lgkmcnt(0)
    s_barrier
    v_add_u32 v255, 116736, v254
    ds_read_b128 v[160:163], v255 offset:0
    ds_read_b128 v[192:195], v255 offset:1024
    ds_read_b128 v[164:167], v255 offset:2048
    ds_read_b128 v[196:199], v255 offset:3072
    ds_read_b128 v[168:171], v255 offset:4096
    ds_read_b128 v[200:203], v255 offset:5120
    ds_read_b128 v[172:175], v255 offset:6144
    ds_read_b128 v[204:207], v255 offset:7168
    s_waitcnt lgkmcnt(0)
    ds_read_b128 v[176:179], v255 offset:8192
    ds_read_b128 v[208:211], v255 offset:9216
    ds_read_b128 v[180:183], v255 offset:10240
    ds_read_b128 v[212:215], v255 offset:11264
    ds_read_b128 v[184:187], v255 offset:12288
    ds_read_b128 v[216:219], v255 offset:13312
    ds_read_b128 v[188:191], v255 offset:14336
    ds_read_b128 v[220:223], v255 offset:15360
    ds_read_b128 v[224:227], v255 offset:16384
    ds_read_b128 v[228:231], v255 offset:17408
    ds_read_b128 v[232:235], v255 offset:18432
    ds_read_b128 v[236:239], v255 offset:19456
    s_waitcnt lgkmcnt(0)
    s_barrier
    s_waitcnt vmcnt(0) lgkmcnt(0)
    s_mov_b32 s41, -1
    s_mov_b32 s34, -1
    s_branch K12_PROD
    s_cmp_lt_u32 s3, 4
    s_cbranch_scc0 K12_PROD
    s_cmp_eq_u32 s43, 0
    s_cbranch_scc0 K12_H1
    v_perm_b32 v64, v100, v96, s28
    v_perm_b32 v68, v100, v96, s29
    v_perm_b32 v65, v108, v104, s28
    v_perm_b32 v69, v108, v104, s29
    v_perm_b32 v66, v116, v112, s28
    v_perm_b32 v70, v116, v112, s29
    v_perm_b32 v67, v124, v120, s28
    v_perm_b32 v71, v124, v120, s29
    v_perm_b32 v72, v101, v97, s28
    v_perm_b32 v76, v101, v97, s29
    v_perm_b32 v73, v109, v105, s28
    v_perm_b32 v77, v109, v105, s29
    v_perm_b32 v74, v117, v113, s28
    v_perm_b32 v78, v117, v113, s29
    v_perm_b32 v75, v125, v121, s28
    v_perm_b32 v79, v125, v121, s29
    v_perm_b32 v80, v102, v98, s28
    v_perm_b32 v84, v102, v98, s29
    v_perm_b32 v81, v110, v106, s28
    v_perm_b32 v85, v110, v106, s29
    v_perm_b32 v82, v118, v114, s28
    v_perm_b32 v86, v118, v114, s29
    v_perm_b32 v83, v126, v122, s28
    v_perm_b32 v87, v126, v122, s29
    v_perm_b32 v88, v103, v99, s28
    v_perm_b32 v92, v103, v99, s29
    v_perm_b32 v89, v111, v107, s28
    v_perm_b32 v93, v111, v107, s29
    v_perm_b32 v90, v119, v115, s28
    v_perm_b32 v94, v119, v115, s29
    v_perm_b32 v91, v127, v123, s28
    v_perm_b32 v95, v127, v123, s29
    s_lshl_b32 s36, s40, 7
    s_add_u32 s36, s36, s22
    s_and_b32 s37, s36, 3
    s_lshr_b32 s38, s36, 1
    s_and_b32 s38, s38, 4
    s_or_b32 s37, s37, s38
    v_bfe_u32 v253, v254, 5, 3
    v_xor_b32 v253, s37, v253
    v_lshl_add_u32 v253, v253, 5, v251
    s_lshl_b32 s36, s36, 9
    s_add_u32 s39, s36, s32
    v_mfma_f32_16x16x32_bf16 v[128:131], v[224:227], v[64:67], 0
    v_mfma_f32_16x16x32_bf16 v[132:135], v[224:227], v[68:71], 0
    v_mfma_f32_16x16x32_bf16 v[136:139], v[224:227], v[72:75], 0
    v_mfma_f32_16x16x32_bf16 v[140:143], v[224:227], v[76:79], 0
    v_mfma_f32_16x16x32_bf16 v[144:147], v[224:227], v[80:83], 0
    v_mfma_f32_16x16x32_bf16 v[148:151], v[224:227], v[84:87], 0
    v_mfma_f32_16x16x32_bf16 v[152:155], v[224:227], v[88:91], 0
    v_mfma_f32_16x16x32_bf16 v[156:159], v[224:227], v[92:95], 0
    s_nop 7
    v_cvt_pk_bf16_f32 v240, v128, v132
    v_cvt_pk_bf16_f32 v241, v136, v140
    v_cvt_pk_bf16_f32 v242, v144, v148
    v_cvt_pk_bf16_f32 v243, v152, v156
    buffer_store_dwordx4 v[240:243], v253, s[16:19], s39 offen sc1
    s_add_u32 s39, s39, 4194304
    v_cvt_pk_bf16_f32 v244, v129, v133
    v_cvt_pk_bf16_f32 v245, v137, v141
    v_cvt_pk_bf16_f32 v246, v145, v149
    v_cvt_pk_bf16_f32 v247, v153, v157
    buffer_store_dwordx4 v[244:247], v253, s[16:19], s39 offen sc1
    s_add_u32 s39, s39, 4194304
    v_cvt_pk_bf16_f32 v240, v130, v134
    v_cvt_pk_bf16_f32 v241, v138, v142
    v_cvt_pk_bf16_f32 v242, v146, v150
    v_cvt_pk_bf16_f32 v243, v154, v158
    buffer_store_dwordx4 v[240:243], v253, s[16:19], s39 offen sc1
    s_add_u32 s39, s39, 4194304
    v_cvt_pk_bf16_f32 v244, v131, v135
    v_cvt_pk_bf16_f32 v245, v139, v143
    v_cvt_pk_bf16_f32 v246, v147, v151
    v_cvt_pk_bf16_f32 v247, v155, v159
    buffer_store_dwordx4 v[244:247], v253, s[16:19], s39 offen sc1
    s_add_u32 s39, s39, 4194304
    v_mfma_f32_16x16x32_bf16 v[128:131], v[228:231], v[64:67], 0
    v_mfma_f32_16x16x32_bf16 v[132:135], v[228:231], v[68:71], 0
    v_mfma_f32_16x16x32_bf16 v[136:139], v[228:231], v[72:75], 0
    v_mfma_f32_16x16x32_bf16 v[140:143], v[228:231], v[76:79], 0
    v_mfma_f32_16x16x32_bf16 v[144:147], v[228:231], v[80:83], 0
    v_mfma_f32_16x16x32_bf16 v[148:151], v[228:231], v[84:87], 0
    v_mfma_f32_16x16x32_bf16 v[152:155], v[228:231], v[88:91], 0
    v_mfma_f32_16x16x32_bf16 v[156:159], v[228:231], v[92:95], 0
    s_nop 7
    v_cvt_pk_bf16_f32 v240, v128, v132
    v_cvt_pk_bf16_f32 v241, v136, v140
    v_cvt_pk_bf16_f32 v242, v144, v148
    v_cvt_pk_bf16_f32 v243, v152, v156
    buffer_store_dwordx4 v[240:243], v253, s[16:19], s39 offen sc1
    s_add_u32 s39, s39, 4194304
    v_cvt_pk_bf16_f32 v244, v129, v133
    v_cvt_pk_bf16_f32 v245, v137, v141
    v_cvt_pk_bf16_f32 v246, v145, v149
    v_cvt_pk_bf16_f32 v247, v153, v157
    buffer_store_dwordx4 v[244:247], v253, s[16:19], s39 offen sc1
    s_add_u32 s39, s39, 4194304
    v_cvt_pk_bf16_f32 v240, v130, v134
    v_cvt_pk_bf16_f32 v241, v138, v142
    v_cvt_pk_bf16_f32 v242, v146, v150
    v_cvt_pk_bf16_f32 v243, v154, v158
    buffer_store_dwordx4 v[240:243], v253, s[16:19], s39 offen sc1
    s_add_u32 s39, s39, 4194304
    v_cvt_pk_bf16_f32 v244, v131, v135
    v_cvt_pk_bf16_f32 v245, v139, v143
    v_cvt_pk_bf16_f32 v246, v147, v151
    v_cvt_pk_bf16_f32 v247, v155, v159
    buffer_store_dwordx4 v[244:247], v253, s[16:19], s39 offen sc1
    s_add_u32 s39, s39, 4194304
    v_mfma_f32_16x16x32_bf16 v[128:131], v[232:235], v[64:67], 0
    v_mfma_f32_16x16x32_bf16 v[132:135], v[232:235], v[68:71], 0
    v_mfma_f32_16x16x32_bf16 v[136:139], v[232:235], v[72:75], 0
    v_mfma_f32_16x16x32_bf16 v[140:143], v[232:235], v[76:79], 0
    v_mfma_f32_16x16x32_bf16 v[144:147], v[232:235], v[80:83], 0
    v_mfma_f32_16x16x32_bf16 v[148:151], v[232:235], v[84:87], 0
    v_mfma_f32_16x16x32_bf16 v[152:155], v[232:235], v[88:91], 0
    v_mfma_f32_16x16x32_bf16 v[156:159], v[232:235], v[92:95], 0
    s_nop 7
    v_cvt_pk_bf16_f32 v240, v128, v132
    v_cvt_pk_bf16_f32 v241, v136, v140
    v_cvt_pk_bf16_f32 v242, v144, v148
    v_cvt_pk_bf16_f32 v243, v152, v156
    buffer_store_dwordx4 v[240:243], v253, s[16:19], s39 offen sc1
    s_add_u32 s39, s39, 4194304
    v_cvt_pk_bf16_f32 v244, v129, v133
    v_cvt_pk_bf16_f32 v245, v137, v141
    v_cvt_pk_bf16_f32 v246, v145, v149
    v_cvt_pk_bf16_f32 v247, v153, v157
    buffer_store_dwordx4 v[244:247], v253, s[16:19], s39 offen sc1
    s_add_u32 s39, s39, 4194304
    v_cvt_pk_bf16_f32 v240, v130, v134
    v_cvt_pk_bf16_f32 v241, v138, v142
    v_cvt_pk_bf16_f32 v242, v146, v150
    v_cvt_pk_bf16_f32 v243, v154, v158
    buffer_store_dwordx4 v[240:243], v253, s[16:19], s39 offen sc1
    s_add_u32 s39, s39, 4194304
    v_cvt_pk_bf16_f32 v244, v131, v135
    v_cvt_pk_bf16_f32 v245, v139, v143
    v_cvt_pk_bf16_f32 v246, v147, v151
    v_cvt_pk_bf16_f32 v247, v155, v159
    buffer_store_dwordx4 v[244:247], v253, s[16:19], s39 offen sc1
    s_add_u32 s39, s39, 4194304
    v_mfma_f32_16x16x32_bf16 v[128:131], v[236:239], v[64:67], 0
    v_mfma_f32_16x16x32_bf16 v[132:135], v[236:239], v[68:71], 0
    v_mfma_f32_16x16x32_bf16 v[136:139], v[236:239], v[72:75], 0
    v_mfma_f32_16x16x32_bf16 v[140:143], v[236:239], v[76:79], 0
    v_mfma_f32_16x16x32_bf16 v[144:147], v[236:239], v[80:83], 0
    v_mfma_f32_16x16x32_bf16 v[148:151], v[236:239], v[84:87], 0
    v_mfma_f32_16x16x32_bf16 v[152:155], v[236:239], v[88:91], 0
    v_mfma_f32_16x16x32_bf16 v[156:159], v[236:239], v[92:95], 0
    s_nop 7
    v_cvt_pk_bf16_f32 v240, v128, v132
    v_cvt_pk_bf16_f32 v241, v136, v140
    v_cvt_pk_bf16_f32 v242, v144, v148
    v_cvt_pk_bf16_f32 v243, v152, v156
    buffer_store_dwordx4 v[240:243], v253, s[16:19], s39 offen sc1
    s_add_u32 s39, s39, 4194304
    v_cvt_pk_bf16_f32 v244, v129, v133
    v_cvt_pk_bf16_f32 v245, v137, v141
    v_cvt_pk_bf16_f32 v246, v145, v149
    v_cvt_pk_bf16_f32 v247, v153, v157
    buffer_store_dwordx4 v[244:247], v253, s[16:19], s39 offen sc1
    s_add_u32 s39, s39, 4194304
    v_cvt_pk_bf16_f32 v240, v130, v134
    v_cvt_pk_bf16_f32 v241, v138, v142
    v_cvt_pk_bf16_f32 v242, v146, v150
    v_cvt_pk_bf16_f32 v243, v154, v158
    buffer_store_dwordx4 v[240:243], v253, s[16:19], s39 offen sc1
    s_add_u32 s39, s39, 4194304
    v_cvt_pk_bf16_f32 v244, v131, v135
    v_cvt_pk_bf16_f32 v245, v139, v143
    v_cvt_pk_bf16_f32 v246, v147, v151
    v_cvt_pk_bf16_f32 v247, v155, v159
    buffer_store_dwordx4 v[244:247], v253, s[16:19], s39 offen sc1
    s_branch K12_H2
K12_H1:
    s_cmp_eq_u32 s27, 0
    s_cbranch_scc1 K12_H2
    v_perm_b32 v64, v4, v0, s28
    v_perm_b32 v68, v4, v0, s29
    v_perm_b32 v65, v12, v8, s28
    v_perm_b32 v69, v12, v8, s29
    v_perm_b32 v66, v20, v16, s28
    v_perm_b32 v70, v20, v16, s29
    v_perm_b32 v67, v28, v24, s28
    v_perm_b32 v71, v28, v24, s29
    v_perm_b32 v72, v5, v1, s28
    v_perm_b32 v76, v5, v1, s29
    v_perm_b32 v73, v13, v9, s28
    v_perm_b32 v77, v13, v9, s29
    v_perm_b32 v74, v21, v17, s28
    v_perm_b32 v78, v21, v17, s29
    v_perm_b32 v75, v29, v25, s28
    v_perm_b32 v79, v29, v25, s29
    v_perm_b32 v80, v6, v2, s28
    v_perm_b32 v84, v6, v2, s29
    v_perm_b32 v81, v14, v10, s28
    v_perm_b32 v85, v14, v10, s29
    v_perm_b32 v82, v22, v18, s28
    v_perm_b32 v86, v22, v18, s29
    v_perm_b32 v83, v30, v26, s28
    v_perm_b32 v87, v30, v26, s29
    v_perm_b32 v88, v7, v3, s28
    v_perm_b32 v92, v7, v3, s29
    v_perm_b32 v89, v15, v11, s28
    v_perm_b32 v93, v15, v11, s29
    v_perm_b32 v90, v23, v19, s28
    v_perm_b32 v94, v23, v19, s29
    v_perm_b32 v91, v31, v27, s28
    v_perm_b32 v95, v31, v27, s29
    v_perm_b32 v0, v36, v32, s28
    v_perm_b32 v4, v36, v32, s29
    v_perm_b32 v1, v44, v40, s28
    v_perm_b32 v5, v44, v40, s29
    v_perm_b32 v2, v52, v48, s28
    v_perm_b32 v6, v52, v48, s29
    v_perm_b32 v3, v60, v56, s28
    v_perm_b32 v7, v60, v56, s29
    v_perm_b32 v8, v37, v33, s28
    v_perm_b32 v12, v37, v33, s29
    v_perm_b32 v9, v45, v41, s28
    v_perm_b32 v13, v45, v41, s29
    v_perm_b32 v10, v53, v49, s28
    v_perm_b32 v14, v53, v49, s29
    v_perm_b32 v11, v61, v57, s28
    v_perm_b32 v15, v61, v57, s29
    v_perm_b32 v16, v38, v34, s28
    v_perm_b32 v20, v38, v34, s29
    v_perm_b32 v17, v46, v42, s28
    v_perm_b32 v21, v46, v42, s29
    v_perm_b32 v18, v54, v50, s28
    v_perm_b32 v22, v54, v50, s29
    v_perm_b32 v19, v62, v58, s28
    v_perm_b32 v23, v62, v58, s29
    v_perm_b32 v24, v39, v35, s28
    v_perm_b32 v28, v39, v35, s29
    v_perm_b32 v25, v47, v43, s28
    v_perm_b32 v29, v47, v43, s29
    v_perm_b32 v26, v55, v51, s28
    v_perm_b32 v30, v55, v51, s29
    v_perm_b32 v27, v63, v59, s28
    v_perm_b32 v31, v63, v59, s29
    s_mul_i32 s39, s40, 85504
    s_add_u32 s39, s39, s31
    s_lshl_b32 s36, s30, 7
    s_add_u32 s39, s39, s36
    v_bfe_u32 v249, v254, 4, 2
    v_bfe_u32 v240, v254, 8, 1
    v_lshl_add_u32 v249, v240, 2, v249
    s_lshr_b32 s36, s30, 1
    s_and_b32 s36, s36, 7
    v_xor_b32 v249, s36, v249
    v_lshl_add_u32 v249, v249, 4, v252
    v_mfma_f32_16x16x32_bf16 v[32:35], v[160:163], v[64:67], 0
    v_mfma_f32_16x16x32_bf16 v[36:39], v[160:163], v[68:71], 0
    v_mfma_f32_16x16x32_bf16 v[40:43], v[160:163], v[72:75], 0
    v_mfma_f32_16x16x32_bf16 v[44:47], v[160:163], v[76:79], 0
    v_mfma_f32_16x16x32_bf16 v[48:51], v[160:163], v[80:83], 0
    v_mfma_f32_16x16x32_bf16 v[52:55], v[160:163], v[84:87], 0
    v_mfma_f32_16x16x32_bf16 v[56:59], v[160:163], v[88:91], 0
    v_mfma_f32_16x16x32_bf16 v[60:63], v[160:163], v[92:95], 0
    v_mfma_f32_16x16x32_bf16 v[32:35], v[164:167], v[0:3], v[32:35]
    v_mfma_f32_16x16x32_bf16 v[36:39], v[164:167], v[4:7], v[36:39]
    v_mfma_f32_16x16x32_bf16 v[40:43], v[164:167], v[8:11], v[40:43]
    v_mfma_f32_16x16x32_bf16 v[44:47], v[164:167], v[12:15], v[44:47]
    v_mfma_f32_16x16x32_bf16 v[48:51], v[164:167], v[16:19], v[48:51]
    v_mfma_f32_16x16x32_bf16 v[52:55], v[164:167], v[20:23], v[52:55]
    v_mfma_f32_16x16x32_bf16 v[56:59], v[164:167], v[24:27], v[56:59]
    v_mfma_f32_16x16x32_bf16 v[60:63], v[164:167], v[28:31], v[60:63]
    s_nop 7
    v_cvt_pk_bf16_f32 v240, v32, v36
    v_cvt_pk_bf16_f32 v241, v40, v44
    v_cvt_pk_bf16_f32 v242, v48, v52
    v_cvt_pk_bf16_f32 v243, v56, v60
    buffer_store_dwordx4 v[240:243], v249, s[12:15], s39 offen sc1
    s_add_u32 s39, s39, 2736128
    v_cvt_pk_bf16_f32 v244, v33, v37
    v_cvt_pk_bf16_f32 v245, v41, v45
    v_cvt_pk_bf16_f32 v246, v49, v53
    v_cvt_pk_bf16_f32 v247, v57, v61
    buffer_store_dwordx4 v[244:247], v249, s[12:15], s39 offen sc1
    s_add_u32 s39, s39, 2736128
    v_cvt_pk_bf16_f32 v240, v34, v38
    v_cvt_pk_bf16_f32 v241, v42, v46
    v_cvt_pk_bf16_f32 v242, v50, v54
    v_cvt_pk_bf16_f32 v243, v58, v62
    buffer_store_dwordx4 v[240:243], v249, s[12:15], s39 offen sc1
    s_add_u32 s39, s39, 2736128
    v_cvt_pk_bf16_f32 v244, v35, v39
    v_cvt_pk_bf16_f32 v245, v43, v47
    v_cvt_pk_bf16_f32 v246, v51, v55
    v_cvt_pk_bf16_f32 v247, v59, v63
    buffer_store_dwordx4 v[244:247], v249, s[12:15], s39 offen sc1
    s_add_u32 s39, s39, 2736128
    v_mfma_f32_16x16x32_bf16 v[32:35], v[168:171], v[64:67], 0
    v_mfma_f32_16x16x32_bf16 v[36:39], v[168:171], v[68:71], 0
    v_mfma_f32_16x16x32_bf16 v[40:43], v[168:171], v[72:75], 0
    v_mfma_f32_16x16x32_bf16 v[44:47], v[168:171], v[76:79], 0
    v_mfma_f32_16x16x32_bf16 v[48:51], v[168:171], v[80:83], 0
    v_mfma_f32_16x16x32_bf16 v[52:55], v[168:171], v[84:87], 0
    v_mfma_f32_16x16x32_bf16 v[56:59], v[168:171], v[88:91], 0
    v_mfma_f32_16x16x32_bf16 v[60:63], v[168:171], v[92:95], 0
    v_mfma_f32_16x16x32_bf16 v[32:35], v[172:175], v[0:3], v[32:35]
    v_mfma_f32_16x16x32_bf16 v[36:39], v[172:175], v[4:7], v[36:39]
    v_mfma_f32_16x16x32_bf16 v[40:43], v[172:175], v[8:11], v[40:43]
    v_mfma_f32_16x16x32_bf16 v[44:47], v[172:175], v[12:15], v[44:47]
    v_mfma_f32_16x16x32_bf16 v[48:51], v[172:175], v[16:19], v[48:51]
    v_mfma_f32_16x16x32_bf16 v[52:55], v[172:175], v[20:23], v[52:55]
    v_mfma_f32_16x16x32_bf16 v[56:59], v[172:175], v[24:27], v[56:59]
    v_mfma_f32_16x16x32_bf16 v[60:63], v[172:175], v[28:31], v[60:63]
    s_nop 7
    v_cvt_pk_bf16_f32 v240, v32, v36
    v_cvt_pk_bf16_f32 v241, v40, v44
    v_cvt_pk_bf16_f32 v242, v48, v52
    v_cvt_pk_bf16_f32 v243, v56, v60
    buffer_store_dwordx4 v[240:243], v249, s[12:15], s39 offen sc1
    s_add_u32 s39, s39, 2736128
    v_cvt_pk_bf16_f32 v244, v33, v37
    v_cvt_pk_bf16_f32 v245, v41, v45
    v_cvt_pk_bf16_f32 v246, v49, v53
    v_cvt_pk_bf16_f32 v247, v57, v61
    buffer_store_dwordx4 v[244:247], v249, s[12:15], s39 offen sc1
    s_add_u32 s39, s39, 2736128
    v_cvt_pk_bf16_f32 v240, v34, v38
    v_cvt_pk_bf16_f32 v241, v42, v46
    v_cvt_pk_bf16_f32 v242, v50, v54
    v_cvt_pk_bf16_f32 v243, v58, v62
    buffer_store_dwordx4 v[240:243], v249, s[12:15], s39 offen sc1
    s_add_u32 s39, s39, 2736128
    v_cvt_pk_bf16_f32 v244, v35, v39
    v_cvt_pk_bf16_f32 v245, v43, v47
    v_cvt_pk_bf16_f32 v246, v51, v55
    v_cvt_pk_bf16_f32 v247, v59, v63
    buffer_store_dwordx4 v[244:247], v249, s[12:15], s39 offen sc1
    s_add_u32 s39, s39, 2736128
    v_mfma_f32_16x16x32_bf16 v[32:35], v[176:179], v[64:67], 0
    v_mfma_f32_16x16x32_bf16 v[36:39], v[176:179], v[68:71], 0
    v_mfma_f32_16x16x32_bf16 v[40:43], v[176:179], v[72:75], 0
    v_mfma_f32_16x16x32_bf16 v[44:47], v[176:179], v[76:79], 0
    v_mfma_f32_16x16x32_bf16 v[48:51], v[176:179], v[80:83], 0
    v_mfma_f32_16x16x32_bf16 v[52:55], v[176:179], v[84:87], 0
    v_mfma_f32_16x16x32_bf16 v[56:59], v[176:179], v[88:91], 0
    v_mfma_f32_16x16x32_bf16 v[60:63], v[176:179], v[92:95], 0
    v_mfma_f32_16x16x32_bf16 v[32:35], v[180:183], v[0:3], v[32:35]
    v_mfma_f32_16x16x32_bf16 v[36:39], v[180:183], v[4:7], v[36:39]
    v_mfma_f32_16x16x32_bf16 v[40:43], v[180:183], v[8:11], v[40:43]
    v_mfma_f32_16x16x32_bf16 v[44:47], v[180:183], v[12:15], v[44:47]
    v_mfma_f32_16x16x32_bf16 v[48:51], v[180:183], v[16:19], v[48:51]
    v_mfma_f32_16x16x32_bf16 v[52:55], v[180:183], v[20:23], v[52:55]
    v_mfma_f32_16x16x32_bf16 v[56:59], v[180:183], v[24:27], v[56:59]
    v_mfma_f32_16x16x32_bf16 v[60:63], v[180:183], v[28:31], v[60:63]
    s_nop 7
    v_cvt_pk_bf16_f32 v240, v32, v36
    v_cvt_pk_bf16_f32 v241, v40, v44
    v_cvt_pk_bf16_f32 v242, v48, v52
    v_cvt_pk_bf16_f32 v243, v56, v60
    buffer_store_dwordx4 v[240:243], v249, s[12:15], s39 offen sc1
    s_add_u32 s39, s39, 2736128
    v_cvt_pk_bf16_f32 v244, v33, v37
    v_cvt_pk_bf16_f32 v245, v41, v45
    v_cvt_pk_bf16_f32 v246, v49, v53
    v_cvt_pk_bf16_f32 v247, v57, v61
    buffer_store_dwordx4 v[244:247], v249, s[12:15], s39 offen sc1
    s_add_u32 s39, s39, 2736128
    v_cvt_pk_bf16_f32 v240, v34, v38
    v_cvt_pk_bf16_f32 v241, v42, v46
    v_cvt_pk_bf16_f32 v242, v50, v54
    v_cvt_pk_bf16_f32 v243, v58, v62
    buffer_store_dwordx4 v[240:243], v249, s[12:15], s39 offen sc1
    s_add_u32 s39, s39, 2736128
    v_cvt_pk_bf16_f32 v244, v35, v39
    v_cvt_pk_bf16_f32 v245, v43, v47
    v_cvt_pk_bf16_f32 v246, v51, v55
    v_cvt_pk_bf16_f32 v247, v59, v63
    buffer_store_dwordx4 v[244:247], v249, s[12:15], s39 offen sc1
    s_add_u32 s39, s39, 2736128
    v_mfma_f32_16x16x32_bf16 v[32:35], v[184:187], v[64:67], 0
    v_mfma_f32_16x16x32_bf16 v[36:39], v[184:187], v[68:71], 0
    v_mfma_f32_16x16x32_bf16 v[40:43], v[184:187], v[72:75], 0
    v_mfma_f32_16x16x32_bf16 v[44:47], v[184:187], v[76:79], 0
    v_mfma_f32_16x16x32_bf16 v[48:51], v[184:187], v[80:83], 0
    v_mfma_f32_16x16x32_bf16 v[52:55], v[184:187], v[84:87], 0
    v_mfma_f32_16x16x32_bf16 v[56:59], v[184:187], v[88:91], 0
    v_mfma_f32_16x16x32_bf16 v[60:63], v[184:187], v[92:95], 0
    v_mfma_f32_16x16x32_bf16 v[32:35], v[188:191], v[0:3], v[32:35]
    v_mfma_f32_16x16x32_bf16 v[36:39], v[188:191], v[4:7], v[36:39]
    v_mfma_f32_16x16x32_bf16 v[40:43], v[188:191], v[8:11], v[40:43]
    v_mfma_f32_16x16x32_bf16 v[44:47], v[188:191], v[12:15], v[44:47]
    v_mfma_f32_16x16x32_bf16 v[48:51], v[188:191], v[16:19], v[48:51]
    v_mfma_f32_16x16x32_bf16 v[52:55], v[188:191], v[20:23], v[52:55]
    v_mfma_f32_16x16x32_bf16 v[56:59], v[188:191], v[24:27], v[56:59]
    v_mfma_f32_16x16x32_bf16 v[60:63], v[188:191], v[28:31], v[60:63]
    s_nop 7
    v_cvt_pk_bf16_f32 v240, v32, v36
    v_cvt_pk_bf16_f32 v241, v40, v44
    v_cvt_pk_bf16_f32 v242, v48, v52
    v_cvt_pk_bf16_f32 v243, v56, v60
    buffer_store_dwordx4 v[240:243], v249, s[12:15], s39 offen sc1
    s_add_u32 s39, s39, 2736128
    v_cvt_pk_bf16_f32 v244, v33, v37
    v_cvt_pk_bf16_f32 v245, v41, v45
    v_cvt_pk_bf16_f32 v246, v49, v53
    v_cvt_pk_bf16_f32 v247, v57, v61
    buffer_store_dwordx4 v[244:247], v249, s[12:15], s39 offen sc1
    s_add_u32 s39, s39, 2736128
    v_cvt_pk_bf16_f32 v240, v34, v38
    v_cvt_pk_bf16_f32 v241, v42, v46
    v_cvt_pk_bf16_f32 v242, v50, v54
    v_cvt_pk_bf16_f32 v243, v58, v62
    buffer_store_dwordx4 v[240:243], v249, s[12:15], s39 offen sc1
    s_add_u32 s39, s39, 2736128
    v_cvt_pk_bf16_f32 v244, v35, v39
    v_cvt_pk_bf16_f32 v245, v43, v47
    v_cvt_pk_bf16_f32 v246, v51, v55
    v_cvt_pk_bf16_f32 v247, v59, v63
    buffer_store_dwordx4 v[244:247], v249, s[12:15], s39 offen sc1
K12_H2:
    s_mov_b64 exec, 1
    v_mov_b32 v255, 155664
    v_mov_b32 v64, 1
    ds_add_u32 v255, v64
    s_mov_b64 exec, -1
    s_waitcnt vmcnt(0)
    s_mov_b32 s41, 0
    s_mov_b32 s34, -1
    s_cmp_ge_u32 s41, 8
    s_cbranch_scc1 K12_SG0
    s_lshl_b32 s36, s41, 2
    s_add_u32 s37, s36, 155680
    s_mov_b64 exec, 1
    v_mov_b32 v255, s37
    v_mov_b32 v240, 1
    ds_add_rtn_u32 v240, v255, v240
    s_waitcnt lgkmcnt(0)
    v_readfirstlane_b32 s37, v240
    s_nop 3
    s_cmp_eq_u32 s37, 3
    s_cbranch_scc0 K12_SH0
    s_lshl_b32 s36, s36, 8
    v_mov_b32 v255, 1
    v_mov_b32 v240, s36
    buffer_atomic_add v255, v240, s[60:63], 0 offen sc0 sc1
    s_mov_b32 s34, s41
K12_SH0:
    s_mov_b64 exec, -1
K12_SG0:
    s_waitcnt vmcnt(0)
    s_cmp_ge_u32 s34, 8
    s_cbranch_scc1 K12_PB1
    v_readfirstlane_b32 s37, v255
    s_nop 3
    s_cmp_eq_u32 s37, 255
    s_cbranch_scc0 K12_PB1
    s_lshl_b32 s36, s34, 4
    s_add_u32 s36, s36, 16384
    s_mov_b64 exec, 1
    v_mov_b32 v255, 1
    v_mov_b32 v240, s36
    buffer_store_dword v255, v240, s[60:63], 0 offen sc1
    s_mov_b64 exec, -1
K12_PB1:
    s_branch K12_CONS
K12_PROD:
    s_setprio 1
    s_cmp_eq_u32 s43, 0
    s_cbranch_scc1 K12_WENTRY
K12_XW:
    s_waitcnt vmcnt(0)
    s_mov_b32 s34, -1
    s_cmp_ge_u32 s41, 8
    s_cbranch_scc1 K12_SG2
    s_lshl_b32 s36, s41, 2
    s_add_u32 s37, s36, 155680
    s_mov_b64 exec, 1
    v_mov_b32 v255, s37
    v_mov_b32 v240, 1
    ds_add_rtn_u32 v240, v255, v240
    s_waitcnt lgkmcnt(0)
    v_readfirstlane_b32 s37, v240
    s_nop 3
    s_cmp_eq_u32 s37, 3
    s_cbranch_scc0 K12_SH2
    s_lshl_b32 s36, s36, 8
    v_mov_b32 v255, 1
    v_mov_b32 v240, s36
    buffer_atomic_add v255, v240, s[60:63], 0 offen sc0 sc1
    s_mov_b32 s34, s41
K12_SH2:
    s_mov_b64 exec, -1
K12_SG2:
    s_cmp_ge_u32 s34, 8
    s_cbranch_scc1 K12_EP3
    s_waitcnt vmcnt(0)
    s_cmp_ge_u32 s34, 8
    s_cbranch_scc1 K12_PB4
    v_readfirstlane_b32 s37, v255
    s_nop 3
    s_cmp_eq_u32 s37, 255
    s_cbranch_scc0 K12_PB4
    s_lshl_b32 s36, s34, 4
    s_add_u32 s36, s36, 16384
    s_mov_b64 exec, 1
    v_mov_b32 v255, 1
    v_mov_b32 v240, s36
    buffer_store_dword v255, v240, s[60:63], 0 offen sc1
    s_mov_b64 exec, -1
K12_PB4:
    s_mov_b32 s34, -1
K12_EP3:
    s_cmp_eq_u32 s27, 0
    s_cbranch_scc1 K12_XP_N
    v_perm_b32 v64, v4, v0, s28
    v_perm_b32 v68, v4, v0, s29
    v_perm_b32 v65, v12, v8, s28
    v_perm_b32 v69, v12, v8, s29
    v_perm_b32 v66, v20, v16, s28
    v_perm_b32 v70, v20, v16, s29
    v_perm_b32 v67, v28, v24, s28
    v_perm_b32 v71, v28, v24, s29
    v_perm_b32 v72, v5, v1, s28
    v_perm_b32 v76, v5, v1, s29
    v_perm_b32 v73, v13, v9, s28
    v_perm_b32 v77, v13, v9, s29
    v_perm_b32 v74, v21, v17, s28
    v_perm_b32 v78, v21, v17, s29
    v_perm_b32 v75, v29, v25, s28
    v_perm_b32 v79, v29, v25, s29
    v_perm_b32 v80, v6, v2, s28
    v_perm_b32 v84, v6, v2, s29
    v_perm_b32 v81, v14, v10, s28
    v_perm_b32 v85, v14, v10, s29
    v_perm_b32 v82, v22, v18, s28
    v_perm_b32 v86, v22, v18, s29
    v_perm_b32 v83, v30, v26, s28
    v_perm_b32 v87, v30, v26, s29
    v_perm_b32 v88, v7, v3, s28
    v_perm_b32 v92, v7, v3, s29
    v_perm_b32 v89, v15, v11, s28
    v_perm_b32 v93, v15, v11, s29
    v_perm_b32 v90, v23, v19, s28
    v_perm_b32 v94, v23, v19, s29
    v_perm_b32 v91, v31, v27, s28
    v_perm_b32 v95, v31, v27, s29
    v_perm_b32 v0, v36, v32, s28
    v_perm_b32 v4, v36, v32, s29
    v_perm_b32 v1, v44, v40, s28
    v_perm_b32 v5, v44, v40, s29
    v_perm_b32 v2, v52, v48, s28
    v_perm_b32 v6, v52, v48, s29
    v_perm_b32 v3, v60, v56, s28
    v_perm_b32 v7, v60, v56, s29
    v_perm_b32 v8, v37, v33, s28
    v_perm_b32 v12, v37, v33, s29
    v_perm_b32 v9, v45, v41, s28
    v_perm_b32 v13, v45, v41, s29
    v_perm_b32 v10, v53, v49, s28
    v_perm_b32 v14, v53, v49, s29
    v_perm_b32 v11, v61, v57, s28
    v_perm_b32 v15, v61, v57, s29
    v_perm_b32 v16, v38, v34, s28
    v_perm_b32 v20, v38, v34, s29
    v_perm_b32 v17, v46, v42, s28
    v_perm_b32 v21, v46, v42, s29
    v_perm_b32 v18, v54, v50, s28
    v_perm_b32 v22, v54, v50, s29
    v_perm_b32 v19, v62, v58, s28
    v_perm_b32 v23, v62, v58, s29
    v_perm_b32 v24, v39, v35, s28
    v_perm_b32 v28, v39, v35, s29
    v_perm_b32 v25, v47, v43, s28
    v_perm_b32 v29, v47, v43, s29
    v_perm_b32 v26, v55, v51, s28
    v_perm_b32 v30, v55, v51, s29
    v_perm_b32 v27, v63, v59, s28
    v_perm_b32 v31, v63, v59, s29
K12_XP_N:
    s_lshl_b32 s36, s40, 3
    s_sub_i32 s36, s36, 28
    s_max_i32 s36, s36, 1
    s_mov_b32 s37, 32768
K12_GL0:
    v_mov_b32 v240, 155648
    ds_read_b32 v240, v240
    s_waitcnt lgkmcnt(0)
    v_cmp_gt_u32 vcc, s36, v240
    s_sub_u32 s37, s37, 1
    s_cmp_eq_u32 s37, 0
    s_cbranch_scc1 K12_GT0
    s_cbranch_vccz K12_GT0
    s_sleep 2
    s_branch K12_GL0
K12_GT0:
    s_add_u32 s42, s40, 1
    s_lshl_b32 s36, s42, 7
    s_add_u32 s36, s36, s22
    s_lshr_b32 s37, s36, 9
    s_lshl_b32 s37, s37, 19
    s_and_b32 s36, s36, 511
    s_lshl_b32 s36, s36, 10
    s_add_u32 s36, s36, s37
    s_add_u32 s36, s36, s33
    buffer_load_dwordx4 v[96:99], v250, s[8:11], s36 offen
    s_add_u32 s36, s36, 0x100000
    buffer_load_dwordx4 v[100:103], v250, s[8:11], s36 offen
    s_add_u32 s36, s36, 0x100000
    buffer_load_dwordx4 v[104:107], v250, s[8:11], s36 offen
    s_add_u32 s36, s36, 0x100000
    buffer_load_dwordx4 v[108:111], v250, s[8:11], s36 offen
    s_add_u32 s36, s36, 0x100000
    buffer_load_dwordx4 v[112:115], v250, s[8:11], s36 offen
    s_add_u32 s36, s36, 0x100000
    buffer_load_dwordx4 v[116:119], v250, s[8:11], s36 offen
    s_add_u32 s36, s36, 0x100000
    buffer_load_dwordx4 v[120:123], v250, s[8:11], s36 offen
    s_add_u32 s36, s36, 0x100000
    buffer_load_dwordx4 v[124:127], v250, s[8:11], s36 offen
    s_cmp_eq_u32 s27, 0
    s_cbranch_scc1 K12_XP_E
    s_mul_i32 s39, s40, 85504
    s_add_u32 s39, s39, s31
    s_lshl_b32 s36, s30, 7
    s_add_u32 s39, s39, s36
    v_bfe_u32 v249, v254, 4, 2
    v_bfe_u32 v240, v254, 8, 1
    v_lshl_add_u32 v249, v240, 2, v249
    s_lshr_b32 s36, s30, 1
    s_and_b32 s36, s36, 7
    v_xor_b32 v249, s36, v249
    v_lshl_add_u32 v249, v249, 4, v252
    v_mfma_f32_16x16x32_bf16 v[32:35], v[160:163], v[64:67], 0
    v_mfma_f32_16x16x32_bf16 v[36:39], v[160:163], v[68:71], 0
    v_mfma_f32_16x16x32_bf16 v[40:43], v[160:163], v[72:75], 0
    v_mfma_f32_16x16x32_bf16 v[44:47], v[160:163], v[76:79], 0
    v_mfma_f32_16x16x32_bf16 v[48:51], v[160:163], v[80:83], 0
    v_mfma_f32_16x16x32_bf16 v[52:55], v[160:163], v[84:87], 0
    v_mfma_f32_16x16x32_bf16 v[56:59], v[160:163], v[88:91], 0
    v_mfma_f32_16x16x32_bf16 v[60:63], v[160:163], v[92:95], 0
    v_mfma_f32_16x16x32_bf16 v[32:35], v[164:167], v[0:3], v[32:35]
    v_mfma_f32_16x16x32_bf16 v[36:39], v[164:167], v[4:7], v[36:39]
    v_mfma_f32_16x16x32_bf16 v[40:43], v[164:167], v[8:11], v[40:43]
    v_mfma_f32_16x16x32_bf16 v[44:47], v[164:167], v[12:15], v[44:47]
    v_mfma_f32_16x16x32_bf16 v[48:51], v[164:167], v[16:19], v[48:51]
    v_mfma_f32_16x16x32_bf16 v[52:55], v[164:167], v[20:23], v[52:55]
    v_mfma_f32_16x16x32_bf16 v[56:59], v[164:167], v[24:27], v[56:59]
    v_mfma_f32_16x16x32_bf16 v[60:63], v[164:167], v[28:31], v[60:63]
    s_nop 7
    v_cvt_pk_bf16_f32 v240, v32, v36
    v_cvt_pk_bf16_f32 v241, v40, v44
    v_cvt_pk_bf16_f32 v242, v48, v52
    v_cvt_pk_bf16_f32 v243, v56, v60
    buffer_store_dwordx4 v[240:243], v249, s[12:15], s39 offen sc1
    s_add_u32 s39, s39, 2736128
    v_cvt_pk_bf16_f32 v244, v33, v37
    v_cvt_pk_bf16_f32 v245, v41, v45
    v_cvt_pk_bf16_f32 v246, v49, v53
    v_cvt_pk_bf16_f32 v247, v57, v61
    buffer_store_dwordx4 v[244:247], v249, s[12:15], s39 offen sc1
    s_add_u32 s39, s39, 2736128
    v_cvt_pk_bf16_f32 v240, v34, v38
    v_cvt_pk_bf16_f32 v241, v42, v46
    v_cvt_pk_bf16_f32 v242, v50, v54
    v_cvt_pk_bf16_f32 v243, v58, v62
    buffer_store_dwordx4 v[240:243], v249, s[12:15], s39 offen sc1
    s_add_u32 s39, s39, 2736128
    v_cvt_pk_bf16_f32 v244, v35, v39
    v_cvt_pk_bf16_f32 v245, v43, v47
    v_cvt_pk_bf16_f32 v246, v51, v55
    v_cvt_pk_bf16_f32 v247, v59, v63
    buffer_store_dwordx4 v[244:247], v249, s[12:15], s39 offen sc1
    s_add_u32 s39, s39, 2736128
    v_mfma_f32_16x16x32_bf16 v[32:35], v[168:171], v[64:67], 0
    v_mfma_f32_16x16x32_bf16 v[36:39], v[168:171], v[68:71], 0
    v_mfma_f32_16x16x32_bf16 v[40:43], v[168:171], v[72:75], 0
    v_mfma_f32_16x16x32_bf16 v[44:47], v[168:171], v[76:79], 0
    v_mfma_f32_16x16x32_bf16 v[48:51], v[168:171], v[80:83], 0
    v_mfma_f32_16x16x32_bf16 v[52:55], v[168:171], v[84:87], 0
    v_mfma_f32_16x16x32_bf16 v[56:59], v[168:171], v[88:91], 0
    v_mfma_f32_16x16x32_bf16 v[60:63], v[168:171], v[92:95], 0
    v_mfma_f32_16x16x32_bf16 v[32:35], v[172:175], v[0:3], v[32:35]
    v_mfma_f32_16x16x32_bf16 v[36:39], v[172:175], v[4:7], v[36:39]
    v_mfma_f32_16x16x32_bf16 v[40:43], v[172:175], v[8:11], v[40:43]
    v_mfma_f32_16x16x32_bf16 v[44:47], v[172:175], v[12:15], v[44:47]
    v_mfma_f32_16x16x32_bf16 v[48:51], v[172:175], v[16:19], v[48:51]
    v_mfma_f32_16x16x32_bf16 v[52:55], v[172:175], v[20:23], v[52:55]
    v_mfma_f32_16x16x32_bf16 v[56:59], v[172:175], v[24:27], v[56:59]
    v_mfma_f32_16x16x32_bf16 v[60:63], v[172:175], v[28:31], v[60:63]
    s_nop 7
    v_cvt_pk_bf16_f32 v240, v32, v36
    v_cvt_pk_bf16_f32 v241, v40, v44
    v_cvt_pk_bf16_f32 v242, v48, v52
    v_cvt_pk_bf16_f32 v243, v56, v60
    buffer_store_dwordx4 v[240:243], v249, s[12:15], s39 offen sc1
    s_add_u32 s39, s39, 2736128
    v_cvt_pk_bf16_f32 v244, v33, v37
    v_cvt_pk_bf16_f32 v245, v41, v45
    v_cvt_pk_bf16_f32 v246, v49, v53
    v_cvt_pk_bf16_f32 v247, v57, v61
    buffer_store_dwordx4 v[244:247], v249, s[12:15], s39 offen sc1
    s_add_u32 s39, s39, 2736128
    v_cvt_pk_bf16_f32 v240, v34, v38
    v_cvt_pk_bf16_f32 v241, v42, v46
    v_cvt_pk_bf16_f32 v242, v50, v54
    v_cvt_pk_bf16_f32 v243, v58, v62
    buffer_store_dwordx4 v[240:243], v249, s[12:15], s39 offen sc1
    s_add_u32 s39, s39, 2736128
    v_cvt_pk_bf16_f32 v244, v35, v39
    v_cvt_pk_bf16_f32 v245, v43, v47
    v_cvt_pk_bf16_f32 v246, v51, v55
    v_cvt_pk_bf16_f32 v247, v59, v63
    buffer_store_dwordx4 v[244:247], v249, s[12:15], s39 offen sc1
    s_add_u32 s39, s39, 2736128
    v_mfma_f32_16x16x32_bf16 v[32:35], v[176:179], v[64:67], 0
    v_mfma_f32_16x16x32_bf16 v[36:39], v[176:179], v[68:71], 0
    v_mfma_f32_16x16x32_bf16 v[40:43], v[176:179], v[72:75], 0
    v_mfma_f32_16x16x32_bf16 v[44:47], v[176:179], v[76:79], 0
    v_mfma_f32_16x16x32_bf16 v[48:51], v[176:179], v[80:83], 0
    v_mfma_f32_16x16x32_bf16 v[52:55], v[176:179], v[84:87], 0
    v_mfma_f32_16x16x32_bf16 v[56:59], v[176:179], v[88:91], 0
    v_mfma_f32_16x16x32_bf16 v[60:63], v[176:179], v[92:95], 0
    v_mfma_f32_16x16x32_bf16 v[32:35], v[180:183], v[0:3], v[32:35]
    v_mfma_f32_16x16x32_bf16 v[36:39], v[180:183], v[4:7], v[36:39]
    v_mfma_f32_16x16x32_bf16 v[40:43], v[180:183], v[8:11], v[40:43]
    v_mfma_f32_16x16x32_bf16 v[44:47], v[180:183], v[12:15], v[44:47]
    v_mfma_f32_16x16x32_bf16 v[48:51], v[180:183], v[16:19], v[48:51]
    v_mfma_f32_16x16x32_bf16 v[52:55], v[180:183], v[20:23], v[52:55]
    v_mfma_f32_16x16x32_bf16 v[56:59], v[180:183], v[24:27], v[56:59]
    v_mfma_f32_16x16x32_bf16 v[60:63], v[180:183], v[28:31], v[60:63]
    s_nop 7
    v_cvt_pk_bf16_f32 v240, v32, v36
    v_cvt_pk_bf16_f32 v241, v40, v44
    v_cvt_pk_bf16_f32 v242, v48, v52
    v_cvt_pk_bf16_f32 v243, v56, v60
    buffer_store_dwordx4 v[240:243], v249, s[12:15], s39 offen sc1
    s_add_u32 s39, s39, 2736128
    v_cvt_pk_bf16_f32 v244, v33, v37
    v_cvt_pk_bf16_f32 v245, v41, v45
    v_cvt_pk_bf16_f32 v246, v49, v53
    v_cvt_pk_bf16_f32 v247, v57, v61
    buffer_store_dwordx4 v[244:247], v249, s[12:15], s39 offen sc1
    s_add_u32 s39, s39, 2736128
    v_cvt_pk_bf16_f32 v240, v34, v38
    v_cvt_pk_bf16_f32 v241, v42, v46
    v_cvt_pk_bf16_f32 v242, v50, v54
    v_cvt_pk_bf16_f32 v243, v58, v62
    buffer_store_dwordx4 v[240:243], v249, s[12:15], s39 offen sc1
    s_add_u32 s39, s39, 2736128
    v_cvt_pk_bf16_f32 v244, v35, v39
    v_cvt_pk_bf16_f32 v245, v43, v47
    v_cvt_pk_bf16_f32 v246, v51, v55
    v_cvt_pk_bf16_f32 v247, v59, v63
    buffer_store_dwordx4 v[244:247], v249, s[12:15], s39 offen sc1
    s_add_u32 s39, s39, 2736128
    v_mfma_f32_16x16x32_bf16 v[32:35], v[184:187], v[64:67], 0
    v_mfma_f32_16x16x32_bf16 v[36:39], v[184:187], v[68:71], 0
    v_mfma_f32_16x16x32_bf16 v[40:43], v[184:187], v[72:75], 0
    v_mfma_f32_16x16x32_bf16 v[44:47], v[184:187], v[76:79], 0
    v_mfma_f32_16x16x32_bf16 v[48:51], v[184:187], v[80:83], 0
    v_mfma_f32_16x16x32_bf16 v[52:55], v[184:187], v[84:87], 0
    v_mfma_f32_16x16x32_bf16 v[56:59], v[184:187], v[88:91], 0
    v_mfma_f32_16x16x32_bf16 v[60:63], v[184:187], v[92:95], 0
    v_mfma_f32_16x16x32_bf16 v[32:35], v[188:191], v[0:3], v[32:35]
    v_mfma_f32_16x16x32_bf16 v[36:39], v[188:191], v[4:7], v[36:39]
    v_mfma_f32_16x16x32_bf16 v[40:43], v[188:191], v[8:11], v[40:43]
    v_mfma_f32_16x16x32_bf16 v[44:47], v[188:191], v[12:15], v[44:47]
    v_mfma_f32_16x16x32_bf16 v[48:51], v[188:191], v[16:19], v[48:51]
    v_mfma_f32_16x16x32_bf16 v[52:55], v[188:191], v[20:23], v[52:55]
    v_mfma_f32_16x16x32_bf16 v[56:59], v[188:191], v[24:27], v[56:59]
    v_mfma_f32_16x16x32_bf16 v[60:63], v[188:191], v[28:31], v[60:63]
    s_nop 7
    v_cvt_pk_bf16_f32 v240, v32, v36
    v_cvt_pk_bf16_f32 v241, v40, v44
    v_cvt_pk_bf16_f32 v242, v48, v52
    v_cvt_pk_bf16_f32 v243, v56, v60
    buffer_store_dwordx4 v[240:243], v249, s[12:15], s39 offen sc1
    s_add_u32 s39, s39, 2736128
    v_cvt_pk_bf16_f32 v244, v33, v37
    v_cvt_pk_bf16_f32 v245, v41, v45
    v_cvt_pk_bf16_f32 v246, v49, v53
    v_cvt_pk_bf16_f32 v247, v57, v61
    buffer_store_dwordx4 v[244:247], v249, s[12:15], s39 offen sc1
    s_add_u32 s39, s39, 2736128
    v_cvt_pk_bf16_f32 v240, v34, v38
    v_cvt_pk_bf16_f32 v241, v42, v46
    v_cvt_pk_bf16_f32 v242, v50, v54
    v_cvt_pk_bf16_f32 v243, v58, v62
    buffer_store_dwordx4 v[240:243], v249, s[12:15], s39 offen sc1
    s_add_u32 s39, s39, 2736128
    v_cvt_pk_bf16_f32 v244, v35, v39
    v_cvt_pk_bf16_f32 v245, v43, v47
    v_cvt_pk_bf16_f32 v246, v51, v55
    v_cvt_pk_bf16_f32 v247, v59, v63
    buffer_store_dwordx4 v[244:247], v249, s[12:15], s39 offen sc1
    s_mov_b32 s41, s40
    s_add_u32 s40, s40, 1
    s_cmp_eq_u32 s41, 3
    s_cbranch_scc0 K12_ES5
    s_waitcnt vmcnt(0)
    s_mov_b32 s34, -1
    s_cmp_ge_u32 s41, 8
    s_cbranch_scc1 K12_SG6
    s_lshl_b32 s36, s41, 2
    s_add_u32 s37, s36, 155680
    s_mov_b64 exec, 1
    v_mov_b32 v255, s37
    v_mov_b32 v240, 1
    ds_add_rtn_u32 v240, v255, v240
    s_waitcnt lgkmcnt(0)
    v_readfirstlane_b32 s37, v240
    s_nop 3
    s_cmp_eq_u32 s37, 3
    s_cbranch_scc0 K12_SH6
    s_lshl_b32 s36, s36, 8
    v_mov_b32 v255, 1
    v_mov_b32 v240, s36
    buffer_atomic_add v255, v240, s[60:63], 0 offen sc0 sc1
    s_mov_b32 s34, s41
K12_SH6:
    s_mov_b64 exec, -1
K12_SG6:
    s_waitcnt vmcnt(0)
    s_cmp_ge_u32 s34, 8
    s_cbranch_scc1 K12_PB7
    v_readfirstlane_b32 s37, v255
    s_nop 3
    s_cmp_eq_u32 s37, 255
    s_cbranch_scc0 K12_PB7
    s_lshl_b32 s36, s34, 4
    s_add_u32 s36, s36, 16384
    s_mov_b64 exec, 1
    v_mov_b32 v255, 1
    v_mov_b32 v240, s36
    buffer_store_dword v255, v240, s[60:63], 0 offen sc1
    s_mov_b64 exec, -1
K12_PB7:
    s_mov_b32 s34, -1
    s_mov_b32 s41, -1
K12_ES5:
    s_waitcnt vmcnt(16)
    s_branch K12_XP_F
K12_XP_E:
    s_mov_b32 s41, s40
    s_add_u32 s40, s40, 1
    s_cmp_eq_u32 s41, 3
    s_cbranch_scc0 K12_ES8
    s_waitcnt vmcnt(0)
    s_mov_b32 s34, -1
    s_cmp_ge_u32 s41, 8
    s_cbranch_scc1 K12_SG9
    s_lshl_b32 s36, s41, 2
    s_add_u32 s37, s36, 155680
    s_mov_b64 exec, 1
    v_mov_b32 v255, s37
    v_mov_b32 v240, 1
    ds_add_rtn_u32 v240, v255, v240
    s_waitcnt lgkmcnt(0)
    v_readfirstlane_b32 s37, v240
    s_nop 3
    s_cmp_eq_u32 s37, 3
    s_cbranch_scc0 K12_SH9
    s_lshl_b32 s36, s36, 8
    v_mov_b32 v255, 1
    v_mov_b32 v240, s36
    buffer_atomic_add v255, v240, s[60:63], 0 offen sc0 sc1
    s_mov_b32 s34, s41
K12_SH9:
    s_mov_b64 exec, -1
K12_SG9:
    s_waitcnt vmcnt(0)
    s_cmp_ge_u32 s34, 8
    s_cbranch_scc1 K12_PB10
    v_readfirstlane_b32 s37, v255
    s_nop 3
    s_cmp_eq_u32 s37, 255
    s_cbranch_scc0 K12_PB10
    s_lshl_b32 s36, s34, 4
    s_add_u32 s36, s36, 16384
    s_mov_b64 exec, 1
    v_mov_b32 v255, 1
    v_mov_b32 v240, s36
    buffer_store_dword v255, v240, s[60:63], 0 offen sc1
    s_mov_b64 exec, -1
K12_PB10:
    s_mov_b32 s34, -1
    s_mov_b32 s41, -1
K12_ES8:
    s_waitcnt vmcnt(0)
K12_XP_F:
    s_cmp_ge_u32 s34, 8
    s_cbranch_scc1 K12_PB11
    v_readfirstlane_b32 s37, v255
    s_nop 3
    s_cmp_eq_u32 s37, 255
    s_cbranch_scc0 K12_PB11
    s_lshl_b32 s36, s34, 4
    s_add_u32 s36, s36, 16384
    s_mov_b64 exec, 1
    v_mov_b32 v255, 1
    v_mov_b32 v240, s36
    buffer_store_dword v255, v240, s[60:63], 0 offen sc1
    s_mov_b64 exec, -1
K12_PB11:
    s_cmp_ge_u32 s40, 8
    s_cbranch_scc1 K12_PFIN
K12_WENTRY:
    s_waitcnt vmcnt(0)
    s_mov_b32 s34, -1
    s_cmp_ge_u32 s41, 8
    s_cbranch_scc1 K12_SG12
    s_lshl_b32 s36, s41, 2
    s_add_u32 s37, s36, 155680
    s_mov_b64 exec, 1
    v_mov_b32 v255, s37
    v_mov_b32 v240, 1
    ds_add_rtn_u32 v240, v255, v240
    s_waitcnt lgkmcnt(0)
    v_readfirstlane_b32 s37, v240
    s_nop 3
    s_cmp_eq_u32 s37, 3
    s_cbranch_scc0 K12_SH12
    s_lshl_b32 s36, s36, 8
    v_mov_b32 v255, 1
    v_mov_b32 v240, s36
    buffer_atomic_add v255, v240, s[60:63], 0 offen sc0 sc1
    s_mov_b32 s34, s41
K12_SH12:
    s_mov_b64 exec, -1
K12_SG12:
    s_cmp_ge_u32 s34, 8
    s_cbranch_scc1 K12_EP13
    s_waitcnt vmcnt(0)
    s_cmp_ge_u32 s34, 8
    s_cbranch_scc1 K12_PB14
    v_readfirstlane_b32 s37, v255
    s_nop 3
    s_cmp_eq_u32 s37, 255
    s_cbranch_scc0 K12_PB14
    s_lshl_b32 s36, s34, 4
    s_add_u32 s36, s36, 16384
    s_mov_b64 exec, 1
    v_mov_b32 v255, 1
    v_mov_b32 v240, s36
    buffer_store_dword v255, v240, s[60:63], 0 offen sc1
    s_mov_b64 exec, -1
K12_PB14:
    s_mov_b32 s34, -1
K12_EP13:
    v_perm_b32 v64, v100, v96, s28
    v_perm_b32 v68, v100, v96, s29
    v_perm_b32 v65, v108, v104, s28
    v_perm_b32 v69, v108, v104, s29
    v_perm_b32 v66, v116, v112, s28
    v_perm_b32 v70, v116, v112, s29
    v_perm_b32 v67, v124, v120, s28
    v_perm_b32 v71, v124, v120, s29
    v_perm_b32 v72, v101, v97, s28
    v_perm_b32 v76, v101, v97, s29
    v_perm_b32 v73, v109, v105, s28
    v_perm_b32 v77, v109, v105, s29
    v_perm_b32 v74, v117, v113, s28
    v_perm_b32 v78, v117, v113, s29
    v_perm_b32 v75, v125, v121, s28
    v_perm_b32 v79, v125, v121, s29
    v_perm_b32 v80, v102, v98, s28
    v_perm_b32 v84, v102, v98, s29
    v_perm_b32 v81, v110, v106, s28
    v_perm_b32 v85, v110, v106, s29
    v_perm_b32 v82, v118, v114, s28
    v_perm_b32 v86, v118, v114, s29
    v_perm_b32 v83, v126, v122, s28
    v_perm_b32 v87, v126, v122, s29
    v_perm_b32 v88, v103, v99, s28
    v_perm_b32 v92, v103, v99, s29
    v_perm_b32 v89, v111, v107, s28
    v_perm_b32 v93, v111, v107, s29
    v_perm_b32 v90, v119, v115, s28
    v_perm_b32 v94, v119, v115, s29
    v_perm_b32 v91, v127, v123, s28
    v_perm_b32 v95, v127, v123, s29
    s_lshl_b32 s36, s40, 3
    s_sub_i32 s36, s36, 28
    s_max_i32 s36, s36, 1
    s_mov_b32 s37, 32768
K12_GL1:
    v_mov_b32 v240, 155648
    ds_read_b32 v240, v240
    s_waitcnt lgkmcnt(0)
    v_cmp_gt_u32 vcc, s36, v240
    s_sub_u32 s37, s37, 1
    s_cmp_eq_u32 s37, 0
    s_cbranch_scc1 K12_GT1
    s_cbranch_vccz K12_GT1
    s_sleep 2
    s_branch K12_GL1
K12_GT1:
    s_add_u32 s42, s40, 1
    s_mul_i32 s36, s42, 85
    s_add_u32 s36, s36, s2
    s_and_b32 s36, s36, 255
    s_mul_hi_u32 s37, s36, 0x55555556
    s_mul_i32 s38, s37, 3
    s_cmp_eq_u32 s38, s36
    s_cselect_b32 s27, 1, 0
    s_cmp_lt_u32 s37, 78
    s_cselect_b32 s27, s27, 0
    s_add_u32 s37, s37, 89
    s_cmp_eq_u32 s21, 0
    s_cselect_b32 s30, s24, s37
    s_cselect_b32 s27, 1, s27
    s_cmp_eq_u32 s27, 0
    s_cbranch_scc1 K12_WP_N
    s_lshl_b32 s36, s42, 8
    s_mul_i32 s37, s30, 98304
    s_add_u32 s36, s36, s37
    buffer_load_dwordx4 v[0:3], v248, s[4:7], s36 offen
    buffer_load_dwordx4 v[4:7], v248, s[4:7], s36 offen offset:2048
    s_add_u32 s36, s36, 4096
    buffer_load_dwordx4 v[8:11], v248, s[4:7], s36 offen
    buffer_load_dwordx4 v[12:15], v248, s[4:7], s36 offen offset:2048
    s_add_u32 s36, s36, 4096
    buffer_load_dwordx4 v[16:19], v248, s[4:7], s36 offen
    buffer_load_dwordx4 v[20:23], v248, s[4:7], s36 offen offset:2048
    s_add_u32 s36, s36, 4096
    buffer_load_dwordx4 v[24:27], v248, s[4:7], s36 offen
    buffer_load_dwordx4 v[28:31], v248, s[4:7], s36 offen offset:2048
    s_add_u32 s36, s36, 53248
    buffer_load_dwordx4 v[32:35], v248, s[4:7], s36 offen
    buffer_load_dwordx4 v[36:39], v248, s[4:7], s36 offen offset:2048
    s_add_u32 s36, s36, 4096
    buffer_load_dwordx4 v[40:43], v248, s[4:7], s36 offen
    buffer_load_dwordx4 v[44:47], v248, s[4:7], s36 offen offset:2048
    s_add_u32 s36, s36, 4096
    buffer_load_dwordx4 v[48:51], v248, s[4:7], s36 offen
    buffer_load_dwordx4 v[52:55], v248, s[4:7], s36 offen offset:2048
    s_add_u32 s36, s36, 4096
    buffer_load_dwordx4 v[56:59], v248, s[4:7], s36 offen
    buffer_load_dwordx4 v[60:63], v248, s[4:7], s36 offen offset:2048
    s_branch K12_WP_M
K12_WP_N:
K12_WP_M:
    s_lshl_b32 s36, s40, 7
    s_add_u32 s36, s36, s22
    s_and_b32 s37, s36, 3
    s_lshr_b32 s38, s36, 1
    s_and_b32 s38, s38, 4
    s_or_b32 s37, s37, s38
    v_bfe_u32 v253, v254, 5, 3
    v_xor_b32 v253, s37, v253
    v_lshl_add_u32 v253, v253, 5, v251
    s_lshl_b32 s36, s36, 9
    s_add_u32 s39, s36, s32
    v_mfma_f32_16x16x32_bf16 v[128:131], v[224:227], v[64:67], 0
    v_mfma_f32_16x16x32_bf16 v[132:135], v[224:227], v[68:71], 0
    v_mfma_f32_16x16x32_bf16 v[136:139], v[224:227], v[72:75], 0
    v_mfma_f32_16x16x32_bf16 v[140:143], v[224:227], v[76:79], 0
    v_mfma_f32_16x16x32_bf16 v[144:147], v[224:227], v[80:83], 0
    v_mfma_f32_16x16x32_bf16 v[148:151], v[224:227], v[84:87], 0
    v_mfma_f32_16x16x32_bf16 v[152:155], v[224:227], v[88:91], 0
    v_mfma_f32_16x16x32_bf16 v[156:159], v[224:227], v[92:95], 0
    s_nop 7
    v_cvt_pk_bf16_f32 v240, v128, v132
    v_cvt_pk_bf16_f32 v241, v136, v140
    v_cvt_pk_bf16_f32 v242, v144, v148
    v_cvt_pk_bf16_f32 v243, v152, v156
    buffer_store_dwordx4 v[240:243], v253, s[16:19], s39 offen sc1
    s_add_u32 s39, s39, 4194304
    v_cvt_pk_bf16_f32 v244, v129, v133
    v_cvt_pk_bf16_f32 v245, v137, v141
    v_cvt_pk_bf16_f32 v246, v145, v149
    v_cvt_pk_bf16_f32 v247, v153, v157
    buffer_store_dwordx4 v[244:247], v253, s[16:19], s39 offen sc1
    s_add_u32 s39, s39, 4194304
    v_cvt_pk_bf16_f32 v240, v130, v134
    v_cvt_pk_bf16_f32 v241, v138, v142
    v_cvt_pk_bf16_f32 v242, v146, v150
    v_cvt_pk_bf16_f32 v243, v154, v158
    buffer_store_dwordx4 v[240:243], v253, s[16:19], s39 offen sc1
    s_add_u32 s39, s39, 4194304
    v_cvt_pk_bf16_f32 v244, v131, v135
    v_cvt_pk_bf16_f32 v245, v139, v143
    v_cvt_pk_bf16_f32 v246, v147, v151
    v_cvt_pk_bf16_f32 v247, v155, v159
    buffer_store_dwordx4 v[244:247], v253, s[16:19], s39 offen sc1
    s_add_u32 s39, s39, 4194304
    v_mfma_f32_16x16x32_bf16 v[128:131], v[228:231], v[64:67], 0
    v_mfma_f32_16x16x32_bf16 v[132:135], v[228:231], v[68:71], 0
    v_mfma_f32_16x16x32_bf16 v[136:139], v[228:231], v[72:75], 0
    v_mfma_f32_16x16x32_bf16 v[140:143], v[228:231], v[76:79], 0
    v_mfma_f32_16x16x32_bf16 v[144:147], v[228:231], v[80:83], 0
    v_mfma_f32_16x16x32_bf16 v[148:151], v[228:231], v[84:87], 0
    v_mfma_f32_16x16x32_bf16 v[152:155], v[228:231], v[88:91], 0
    v_mfma_f32_16x16x32_bf16 v[156:159], v[228:231], v[92:95], 0
    s_nop 7
    v_cvt_pk_bf16_f32 v240, v128, v132
    v_cvt_pk_bf16_f32 v241, v136, v140
    v_cvt_pk_bf16_f32 v242, v144, v148
    v_cvt_pk_bf16_f32 v243, v152, v156
    buffer_store_dwordx4 v[240:243], v253, s[16:19], s39 offen sc1
    s_add_u32 s39, s39, 4194304
    v_cvt_pk_bf16_f32 v244, v129, v133
    v_cvt_pk_bf16_f32 v245, v137, v141
    v_cvt_pk_bf16_f32 v246, v145, v149
    v_cvt_pk_bf16_f32 v247, v153, v157
    buffer_store_dwordx4 v[244:247], v253, s[16:19], s39 offen sc1
    s_add_u32 s39, s39, 4194304
    v_cvt_pk_bf16_f32 v240, v130, v134
    v_cvt_pk_bf16_f32 v241, v138, v142
    v_cvt_pk_bf16_f32 v242, v146, v150
    v_cvt_pk_bf16_f32 v243, v154, v158
    buffer_store_dwordx4 v[240:243], v253, s[16:19], s39 offen sc1
    s_add_u32 s39, s39, 4194304
    v_cvt_pk_bf16_f32 v244, v131, v135
    v_cvt_pk_bf16_f32 v245, v139, v143
    v_cvt_pk_bf16_f32 v246, v147, v151
    v_cvt_pk_bf16_f32 v247, v155, v159
    buffer_store_dwordx4 v[244:247], v253, s[16:19], s39 offen sc1
    s_add_u32 s39, s39, 4194304
    v_mfma_f32_16x16x32_bf16 v[128:131], v[232:235], v[64:67], 0
    v_mfma_f32_16x16x32_bf16 v[132:135], v[232:235], v[68:71], 0
    v_mfma_f32_16x16x32_bf16 v[136:139], v[232:235], v[72:75], 0
    v_mfma_f32_16x16x32_bf16 v[140:143], v[232:235], v[76:79], 0
    v_mfma_f32_16x16x32_bf16 v[144:147], v[232:235], v[80:83], 0
    v_mfma_f32_16x16x32_bf16 v[148:151], v[232:235], v[84:87], 0
    v_mfma_f32_16x16x32_bf16 v[152:155], v[232:235], v[88:91], 0
    v_mfma_f32_16x16x32_bf16 v[156:159], v[232:235], v[92:95], 0
    s_nop 7
    v_cvt_pk_bf16_f32 v240, v128, v132
    v_cvt_pk_bf16_f32 v241, v136, v140
    v_cvt_pk_bf16_f32 v242, v144, v148
    v_cvt_pk_bf16_f32 v243, v152, v156
    buffer_store_dwordx4 v[240:243], v253, s[16:19], s39 offen sc1
    s_add_u32 s39, s39, 4194304
    v_cvt_pk_bf16_f32 v244, v129, v133
    v_cvt_pk_bf16_f32 v245, v137, v141
    v_cvt_pk_bf16_f32 v246, v145, v149
    v_cvt_pk_bf16_f32 v247, v153, v157
    buffer_store_dwordx4 v[244:247], v253, s[16:19], s39 offen sc1
    s_add_u32 s39, s39, 4194304
    v_cvt_pk_bf16_f32 v240, v130, v134
    v_cvt_pk_bf16_f32 v241, v138, v142
    v_cvt_pk_bf16_f32 v242, v146, v150
    v_cvt_pk_bf16_f32 v243, v154, v158
    buffer_store_dwordx4 v[240:243], v253, s[16:19], s39 offen sc1
    s_add_u32 s39, s39, 4194304
    v_cvt_pk_bf16_f32 v244, v131, v135
    v_cvt_pk_bf16_f32 v245, v139, v143
    v_cvt_pk_bf16_f32 v246, v147, v151
    v_cvt_pk_bf16_f32 v247, v155, v159
    buffer_store_dwordx4 v[244:247], v253, s[16:19], s39 offen sc1
    s_add_u32 s39, s39, 4194304
    v_mfma_f32_16x16x32_bf16 v[128:131], v[236:239], v[64:67], 0
    v_mfma_f32_16x16x32_bf16 v[132:135], v[236:239], v[68:71], 0
    v_mfma_f32_16x16x32_bf16 v[136:139], v[236:239], v[72:75], 0
    v_mfma_f32_16x16x32_bf16 v[140:143], v[236:239], v[76:79], 0
    v_mfma_f32_16x16x32_bf16 v[144:147], v[236:239], v[80:83], 0
    v_mfma_f32_16x16x32_bf16 v[148:151], v[236:239], v[84:87], 0
    v_mfma_f32_16x16x32_bf16 v[152:155], v[236:239], v[88:91], 0
    v_mfma_f32_16x16x32_bf16 v[156:159], v[236:239], v[92:95], 0
    s_nop 7
    v_cvt_pk_bf16_f32 v240, v128, v132
    v_cvt_pk_bf16_f32 v241, v136, v140
    v_cvt_pk_bf16_f32 v242, v144, v148
    v_cvt_pk_bf16_f32 v243, v152, v156
    buffer_store_dwordx4 v[240:243], v253, s[16:19], s39 offen sc1
    s_add_u32 s39, s39, 4194304
    v_cvt_pk_bf16_f32 v244, v129, v133
    v_cvt_pk_bf16_f32 v245, v137, v141
    v_cvt_pk_bf16_f32 v246, v145, v149
    v_cvt_pk_bf16_f32 v247, v153, v157
    buffer_store_dwordx4 v[244:247], v253, s[16:19], s39 offen sc1
    s_add_u32 s39, s39, 4194304
    v_cvt_pk_bf16_f32 v240, v130, v134
    v_cvt_pk_bf16_f32 v241, v138, v142
    v_cvt_pk_bf16_f32 v242, v146, v150
    v_cvt_pk_bf16_f32 v243, v154, v158
    buffer_store_dwordx4 v[240:243], v253, s[16:19], s39 offen sc1
    s_add_u32 s39, s39, 4194304
    v_cvt_pk_bf16_f32 v244, v131, v135
    v_cvt_pk_bf16_f32 v245, v139, v143
    v_cvt_pk_bf16_f32 v246, v147, v151
    v_cvt_pk_bf16_f32 v247, v155, v159
    buffer_store_dwordx4 v[244:247], v253, s[16:19], s39 offen sc1
    s_mov_b32 s41, s40
    s_add_u32 s40, s40, 1
    s_cmp_eq_u32 s41, 3
    s_cbranch_scc0 K12_ES15
    s_waitcnt vmcnt(0)
    s_mov_b32 s34, -1
    s_cmp_ge_u32 s41, 8
    s_cbranch_scc1 K12_SG16
    s_lshl_b32 s36, s41, 2
    s_add_u32 s37, s36, 155680
    s_mov_b64 exec, 1
    v_mov_b32 v255, s37
    v_mov_b32 v240, 1
    ds_add_rtn_u32 v240, v255, v240
    s_waitcnt lgkmcnt(0)
    v_readfirstlane_b32 s37, v240
    s_nop 3
    s_cmp_eq_u32 s37, 3
    s_cbranch_scc0 K12_SH16
    s_lshl_b32 s36, s36, 8
    v_mov_b32 v255, 1
    v_mov_b32 v240, s36
    buffer_atomic_add v255, v240, s[60:63], 0 offen sc0 sc1
    s_mov_b32 s34, s41
K12_SH16:
    s_mov_b64 exec, -1
K12_SG16:
    s_waitcnt vmcnt(0)
    s_cmp_ge_u32 s34, 8
    s_cbranch_scc1 K12_PB17
    v_readfirstlane_b32 s37, v255
    s_nop 3
    s_cmp_eq_u32 s37, 255
    s_cbranch_scc0 K12_PB17
    s_lshl_b32 s36, s34, 4
    s_add_u32 s36, s36, 16384
    s_mov_b64 exec, 1
    v_mov_b32 v255, 1
    v_mov_b32 v240, s36
    buffer_store_dword v255, v240, s[60:63], 0 offen sc1
    s_mov_b64 exec, -1
K12_PB17:
    s_mov_b32 s34, -1
    s_mov_b32 s41, -1
K12_ES15:
    s_waitcnt vmcnt(16)
    s_cmp_ge_u32 s34, 8
    s_cbranch_scc1 K12_PB18
    v_readfirstlane_b32 s37, v255
    s_nop 3
    s_cmp_eq_u32 s37, 255
    s_cbranch_scc0 K12_PB18
    s_lshl_b32 s36, s34, 4
    s_add_u32 s36, s36, 16384
    s_mov_b64 exec, 1
    v_mov_b32 v255, 1
    v_mov_b32 v240, s36
    buffer_store_dword v255, v240, s[60:63], 0 offen sc1
    s_mov_b64 exec, -1
K12_PB18:
    s_cmp_lt_u32 s40, 8
    s_cbranch_scc1 K12_XW
K12_PFIN:
    s_waitcnt vmcnt(0)
    s_mov_b32 s34, -1
    s_cmp_ge_u32 s41, 8
    s_cbranch_scc1 K12_SG19
    s_lshl_b32 s36, s41, 2
    s_add_u32 s37, s36, 155680
    s_mov_b64 exec, 1
    v_mov_b32 v255, s37
    v_mov_b32 v240, 1
    ds_add_rtn_u32 v240, v255, v240
    s_waitcnt lgkmcnt(0)
    v_readfirstlane_b32 s37, v240
    s_nop 3
    s_cmp_eq_u32 s37, 3
    s_cbranch_scc0 K12_SH19
    s_lshl_b32 s36, s36, 8
    v_mov_b32 v255, 1
    v_mov_b32 v240, s36
    buffer_atomic_add v255, v240, s[60:63], 0 offen sc0 sc1
    s_mov_b32 s34, s41
K12_SH19:
    s_mov_b64 exec, -1
K12_SG19:
    s_waitcnt vmcnt(0)
    s_cmp_ge_u32 s34, 8
    s_cbranch_scc1 K12_PB20
    v_readfirstlane_b32 s37, v255
    s_nop 3
    s_cmp_eq_u32 s37, 255
    s_cbranch_scc0 K12_PB20
    s_lshl_b32 s36, s34, 4
    s_add_u32 s36, s36, 16384
    s_mov_b64 exec, 1
    v_mov_b32 v255, 1
    v_mov_b32 v240, s36
    buffer_store_dword v255, v240, s[60:63], 0 offen sc1
    s_mov_b64 exec, -1
K12_PB20:
    s_endpgm
K12_CONS:
    s_and_b32 s6, s2, 7
    s_lshl_b32 s6, s6, 2
    s_lshr_b32 s7, s2, 6
    s_add_u32 s6, s6, s7
    s_lshr_b32 s7, s2, 3
    s_and_b32 s7, s7, 7
    s_lshr_b32 s20, s7, 2
    s_and_b32 s21, s7, 3
    s_lshl_b32 s22, s6, 1
    s_add_u32 s22, s22, s20
    s_lshl_b32 s23, s6, 2
    s_add_u32 s23, s23, s21
    s_mul_i32 s24, s22, 684032
    s_mul_i32 s25, s23, 524288
    s_add_u32 s25, s25, 50331648
    s_mul_i32 s26, s22, 342016
    s_add_u32 s26, s26, 118489088
    s_add_u32 s8, s58, s24
    s_addc_u32 s9, s59, 0
    s_and_b32 s9, s9, 0xffff
    s_mov_b32 s10, 684032
    s_mov_b32 s11, 0x00020000
    s_add_u32 s12, s58, s25
    s_addc_u32 s13, s59, 0
    s_and_b32 s13, s13, 0xffff
    s_mov_b32 s14, 524288
    s_mov_b32 s15, 0x00020000
    s_add_u32 s16, s58, s26
    s_addc_u32 s17, s59, 0
    s_and_b32 s17, s17, 0xffff
    s_mov_b32 s18, 342016
    s_mov_b32 s19, 0x00020000
    s_add_u32 s4, s58, 153108480
    s_addc_u32 s5, s59, 0
    s_and_b32 s5, s5, 0xffff
    s_cmp_eq_u32 s3, 0
    s_cselect_b32 s6, 128, 0
    s_mov_b32 s7, 0x00020000
    s_mov_b32 s46, 155712
    s_cselect_b32 s46, s46, 155776
    s_mov_b32 s47, 155712
    s_cselect_b32 s47, s47, 155744
    s_cselect_b32 s45, 4, 0
    s_mov_b32 s50, s45
    v_and_b32 v8, 15, v2
    v_lshrrev_b32 v9, 4, v2
    v_lshlrev_b32 v1, 4, v2
    s_mul_i32 s30, s3, 5120
    s_mov_b32 s36, s30
    s_lshl_b32 s31, s3, 12
    s_add_u32 s37, s31, 22528
    s_lshl_b32 s33, s3, 8
    s_add_u32 s33, s33, 20480
    s_mov_b32 s38, s33
    s_mov_b32 s44, 0xffff
    s_cmp_eq_u32 s3, 3
    s_cselect_b32 s44, 0xff, s44
    s_mov_b32 s45, 0
    v_lshrrev_b32 v10, 1, v8
    v_xor_b32 v10, v10, v9
    v_lshlrev_b32 v10, 4, v10
    v_lshl_add_u32 v2, v8, 7, v10
    v_xor_b32 v3, 64, v2
    v_lshrrev_b32 v10, 2, v8
    v_lshl_add_u32 v11, v9, 3, v10
    v_lshlrev_b32 v11, 9, v11
    v_and_b32 v12, 1, v9
    v_lshl_or_b32 v10, v12, 2, v10
    s_lshl_b32 s28, s3, 1
    v_xor_b32 v10, s28, v10
    v_lshl_add_u32 v11, v10, 5, v11
    v_and_b32 v10, 3, v8
    v_lshl_add_u32 v11, v10, 3, v11
    v_add_u32 v4, 22528, v11
    v_and_b32 v10, 3, v8
    v_lshlrev_b32 v10, 2, v10
    v_add_u32 v5, 155648, v10
    s_lshl_b32 s28, s3, 2
    s_add_u32 s28, s28, 155648
    v_mov_b32 v7, s28
    s_mov_b32 s35, 0x80008000
    s_mov_b32 s62, 0
    s_mov_b32 s63, 0
    s_mov_b32 s39, 0
    s_add_u32 m0, s39, s36
    s_nop 0
    buffer_load_dwordx4 v1, s[8:11], s30 offen sc1 lds
    buffer_load_dwordx4 v1, s[8:11], s30 offen offset:1024 sc1 lds
    buffer_load_dwordx4 v1, s[8:11], s30 offen offset:2048 sc1 lds
    buffer_load_dwordx4 v1, s[8:11], s30 offen offset:3072 sc1 lds
    s_add_u32 m0, m0, 4096
    s_add_u32 s34, s30, 4096
    buffer_load_dwordx4 v1, s[8:11], s34 offen sc1 lds
    s_add_u32 m0, s39, s37
    s_add_u32 s30, s30, 21376
    buffer_load_dwordx4 v1, s[12:15], s31 offen sc1 lds
    buffer_load_dwordx4 v1, s[12:15], s31 offen offset:1024 sc1 lds
    buffer_load_dwordx4 v1, s[12:15], s31 offen offset:2048 sc1 lds
    buffer_load_dwordx4 v1, s[12:15], s31 offen offset:3072 sc1 lds
    s_add_u32 m0, s39, s38
    s_mov_b64 exec, s[44:45]
    buffer_load_dwordx4 v1, s[8:11], s33 offen sc1 lds
    s_mov_b64 exec, -1
    s_add_u32 s31, s31, 16384
    s_add_u32 s33, s33, 21376
    s_add_u32 s39, s39, 38912
    s_add_u32 m0, s39, s36
    s_nop 0
    buffer_load_dwordx4 v1, s[8:11], s30 offen sc1 lds
    buffer_load_dwordx4 v1, s[8:11], s30 offen offset:1024 sc1 lds
    buffer_load_dwordx4 v1, s[8:11], s30 offen offset:2048 sc1 lds
    buffer_load_dwordx4 v1, s[8:11], s30 offen offset:3072 sc1 lds
    s_add_u32 m0, m0, 4096
    s_add_u32 s34, s30, 4096
    buffer_load_dwordx4 v1, s[8:11], s34 offen sc1 lds
    s_add_u32 m0, s39, s37
    s_add_u32 s30, s30, 21376
    buffer_load_dwordx4 v1, s[12:15], s31 offen sc1 lds
    buffer_load_dwordx4 v1, s[12:15], s31 offen offset:1024 sc1 lds
    buffer_load_dwordx4 v1, s[12:15], s31 offen offset:2048 sc1 lds
    buffer_load_dwordx4 v1, s[12:15], s31 offen offset:3072 sc1 lds
    s_add_u32 m0, s39, s38
    s_mov_b64 exec, s[44:45]
    buffer_load_dwordx4 v1, s[8:11], s33 offen sc1 lds
    s_mov_b64 exec, -1
    s_add_u32 s31, s31, 16384
    s_add_u32 s33, s33, 21376
    s_add_u32 s39, s39, 38912
    s_add_u32 m0, s39, s36
    s_nop 0
    buffer_load_dwordx4 v1, s[8:11], s30 offen sc1 lds
    buffer_load_dwordx4 v1, s[8:11], s30 offen offset:1024 sc1 lds
    buffer_load_dwordx4 v1, s[8:11], s30 offen offset:2048 sc1 lds
    buffer_load_dwordx4 v1, s[8:11], s30 offen offset:3072 sc1 lds
    s_add_u32 m0, m0, 4096
    s_add_u32 s34, s30, 4096
    buffer_load_dwordx4 v1, s[8:11], s34 offen sc1 lds
    s_add_u32 m0, s39, s37
    s_add_u32 s30, s30, 21376
    buffer_load_dwordx4 v1, s[12:15], s31 offen sc1 lds
    buffer_load_dwordx4 v1, s[12:15], s31 offen offset:1024 sc1 lds
    buffer_load_dwordx4 v1, s[12:15], s31 offen offset:2048 sc1 lds
    buffer_load_dwordx4 v1, s[12:15], s31 offen offset:3072 sc1 lds
    s_add_u32 m0, s39, s38
    s_mov_b64 exec, s[44:45]
    buffer_load_dwordx4 v1, s[8:11], s33 offen sc1 lds
    s_mov_b64 exec, -1
    s_add_u32 s31, s31, 16384
    s_add_u32 s33, s33, 21376
    s_add_u32 s39, s39, 38912
    s_mov_b32 m0, s46
    s_mov_b64 exec, 0xff
    buffer_load_dword v1, s[4:7], 0 offen sc1 lds
    s_mov_b64 exec, -1
    v_lshrrev_b32 v9, 4, v1
    v_and_b32 v8, 15, v9
    v_lshrrev_b32 v9, 4, v9
    v_and_b32 v10, 3, v8
    v_lshlrev_b32 v10, 2, v10
    v_lshrrev_b32 v12, 3, v8
    v_lshl_add_u32 v10, v12, 1, v10
    s_lshl_b32 s28, s3, 4
    s_add_u32 s28, s28, 1
    v_add_u32 v10, s28, v10
    v_bfe_u32 v11, v8, 2, 1
    v_and_b32 v13, 1, v9
    v_lshlrev_b32 v13, 3, v13
    v_mul_u32_u24 v14, 96, v11
    v_mad_u32_u24 v15, v10, v13, v14
    v_mad_u32_u24 v16, v10, 0, v15
    v_mad_u32_u24 v17, v10, 1, v15
    v_mad_u32_u24 v18, v10, 2, v15
    v_mad_u32_u24 v19, v10, 3, v15
    v_mad_u32_u24 v20, v10, 4, v15
    v_mad_u32_u24 v21, v10, 5, v15
    v_mad_u32_u24 v22, v10, 6, v15
    v_mad_u32_u24 v23, v10, 7, v15
    v_and_b32 v16, 127, v16
    v_and_b32 v17, 127, v17
    v_and_b32 v18, 127, v18
    v_and_b32 v19, 127, v19
    v_and_b32 v20, 127, v20
    v_and_b32 v21, 127, v21
    v_and_b32 v22, 127, v22
    v_and_b32 v23, 127, v23
    v_cvt_f32_u32 v16, v16
    v_cvt_f32_u32 v17, v17
    v_cvt_f32_u32 v18, v18
    v_cvt_f32_u32 v19, v19
    v_cvt_f32_u32 v20, v20
    v_cvt_f32_u32 v21, v21
    v_cvt_f32_u32 v22, v22
    v_cvt_f32_u32 v23, v23
    v_mul_f32 v16, 0x3c000000, v16
    v_mul_f32 v17, 0x3c000000, v17
    v_mul_f32 v18, 0x3c000000, v18
    v_mul_f32 v19, 0x3c000000, v19
    v_mul_f32 v20, 0x3c000000, v20
    v_mul_f32 v21, 0x3c000000, v21
    v_mul_f32 v22, 0x3c000000, v22
    v_mul_f32 v23, 0x3c000000, v23
    v_cos_f32 v16, v16
    v_cos_f32 v17, v17
    v_cos_f32 v18, v18
    v_cos_f32 v19, v19
    v_cos_f32 v20, v20
    v_cos_f32 v21, v21
    v_cos_f32 v22, v22
    v_cos_f32 v23, v23
    s_nop 0
    v_cvt_pk_bf16_f32 v24, v16, v17
    v_cvt_pk_bf16_f32 v25, v18, v19
    v_cvt_pk_bf16_f32 v26, v20, v21
    v_cvt_pk_bf16_f32 v27, v22, v23
    v_lshlrev_b32 v32, 16, v24
    v_and_b32 v33, 0xffff0000, v24
    v_sub_f32 v16, v16, v32
    v_sub_f32 v17, v17, v33
    v_lshlrev_b32 v32, 16, v25
    v_and_b32 v33, 0xffff0000, v25
    v_sub_f32 v18, v18, v32
    v_sub_f32 v19, v19, v33
    v_lshlrev_b32 v32, 16, v26
    v_and_b32 v33, 0xffff0000, v26
    v_sub_f32 v20, v20, v32
    v_sub_f32 v21, v21, v33
    v_lshlrev_b32 v32, 16, v27
    v_and_b32 v33, 0xffff0000, v27
    v_sub_f32 v22, v22, v32
    v_sub_f32 v23, v23, v33
    v_cvt_pk_bf16_f32 v28, v16, v17
    v_cvt_pk_bf16_f32 v29, v18, v19
    v_cvt_pk_bf16_f32 v30, v20, v21
    v_cvt_pk_bf16_f32 v31, v22, v23
    v_cmp_lt_u32 vcc, 1, v9
    s_lshl_b32 s28, s3, 10
    s_add_u32 s28, s28, 133120
    v_add_u32 v14, s28, v1
    v_cndmask_b32 v24, v24, v28, vcc
    v_cndmask_b32 v25, v25, v29, vcc
    v_cndmask_b32 v26, v26, v30, vcc
    v_cndmask_b32 v27, v27, v31, vcc
    ds_write_b128 v14, v[24:27]
    v_mov_b32 v12, 0
    v_mov_b32 v13, 0
    v_mov_b32 v14, 0
    v_mov_b32 v15, 0
    s_mul_i32 s28, s3, 38912
    s_add_u32 s28, s28, 21376
    v_add_u32 v16, s28, v1
    ds_write_b128 v16, v[12:15]
    s_mov_b64 exec, 0xff
    ds_write_b128 v16, v[12:15] offset:1024
    s_mov_b64 exec, -1
    s_lshl_b32 s28, s3, 2
    s_add_u32 s28, s28, 155648
    v_mov_b32 v16, s28
    ds_write_b32 v16, v12
    s_lshl_b32 s28, s3, 3
    s_add_u32 s28, s28, 155680
    v_mov_b32 v16, s28
    ds_write_b64 v16, v[12:13]
    s_lshl_b32 s28, s3, 3
    s_add_u32 s28, s28, 155712
    v_mov_b32 v16, s28
    ds_write_b64 v16, v[12:13]
    v_mov_b32 v16, 155664
    ds_write_b32 v16, v12
    v_mov_b32 v16, 155744
    v_mov_b32 v17, 1
    ds_write_b32 v16, v17
    s_waitcnt lgkmcnt(0)
    s_barrier
    v_mov_b32 v80, 0
    v_mov_b32 v81, 0
    v_mov_b32 v82, 0
    v_mov_b32 v83, 0
    v_mov_b32 v84, 0
    v_mov_b32 v85, 0
    v_mov_b32 v86, 0
    v_mov_b32 v87, 0
    v_mov_b32 v88, 0
    v_mov_b32 v89, 0
    v_mov_b32 v90, 0
    v_mov_b32 v91, 0
    v_mov_b32 v92, 0
    v_mov_b32 v93, 0
    v_mov_b32 v94, 0
    v_mov_b32 v95, 0
    v_mov_b32 v96, 0
    v_mov_b32 v97, 0
    v_mov_b32 v98, 0
    v_mov_b32 v99, 0
    v_mov_b32 v100, 0
    v_mov_b32 v101, 0
    v_mov_b32 v102, 0
    v_mov_b32 v103, 0
    v_mov_b32 v104, 0
    v_mov_b32 v105, 0
    v_mov_b32 v106, 0
    v_mov_b32 v107, 0
    v_mov_b32 v108, 0
    v_mov_b32 v109, 0
    v_mov_b32 v110, 0
    v_mov_b32 v111, 0
    v_mov_b32 v112, 0
    v_mov_b32 v113, 0
    v_mov_b32 v114, 0
    v_mov_b32 v115, 0
    v_mov_b32 v116, 0
    v_mov_b32 v117, 0
    v_mov_b32 v118, 0
    v_mov_b32 v119, 0
    v_mov_b32 v120, 0
    v_mov_b32 v121, 0
    v_mov_b32 v122, 0
    v_mov_b32 v123, 0
    v_mov_b32 v124, 0
    v_mov_b32 v125, 0
    v_mov_b32 v126, 0
    v_mov_b32 v127, 0
    v_mov_b32 v128, 0
    v_mov_b32 v129, 0
    v_mov_b32 v130, 0
    v_mov_b32 v131, 0
    v_mov_b32 v132, 0
    v_mov_b32 v133, 0
    v_mov_b32 v134, 0
    v_mov_b32 v135, 0
    v_mov_b32 v136, 0
    v_mov_b32 v137, 0
    v_mov_b32 v138, 0
    v_mov_b32 v139, 0
    v_mov_b32 v140, 0
    v_mov_b32 v141, 0
    v_mov_b32 v142, 0
    v_mov_b32 v143, 0
    v_mov_b32 v144, 0
    v_mov_b32 v145, 0
    v_mov_b32 v146, 0
    v_mov_b32 v147, 0
    v_mov_b32 v148, 0
    v_mov_b32 v149, 0
    v_mov_b32 v150, 0
    v_mov_b32 v151, 0
    v_mov_b32 v152, 0
    v_mov_b32 v153, 0
    v_mov_b32 v154, 0
    v_mov_b32 v155, 0
    v_mov_b32 v156, 0
    v_mov_b32 v157, 0
    v_mov_b32 v158, 0
    v_mov_b32 v159, 0
    v_mov_b32 v160, 0
    v_mov_b32 v161, 0
    v_mov_b32 v162, 0
    v_mov_b32 v163, 0
    v_mov_b32 v164, 0
    v_mov_b32 v165, 0
    v_mov_b32 v166, 0
    v_mov_b32 v167, 0
    v_mov_b32 v168, 0
    v_mov_b32 v169, 0
    v_mov_b32 v170, 0
    v_mov_b32 v171, 0
    v_mov_b32 v172, 0
    v_mov_b32 v173, 0
    v_mov_b32 v174, 0
    v_mov_b32 v175, 0
    v_mov_b32 v176, 0
    v_mov_b32 v177, 0
    v_mov_b32 v178, 0
    v_mov_b32 v179, 0
    v_mov_b32 v180, 0
    v_mov_b32 v181, 0
    v_mov_b32 v182, 0
    v_mov_b32 v183, 0
    v_mov_b32 v184, 0
    v_mov_b32 v185, 0
    v_mov_b32 v186, 0
    v_mov_b32 v187, 0
    v_mov_b32 v188, 0
    v_mov_b32 v189, 0
    v_mov_b32 v190, 0
    v_mov_b32 v191, 0
    v_mov_b32 v192, 0
    v_mov_b32 v193, 0
    v_mov_b32 v194, 0
    v_mov_b32 v195, 0
    v_mov_b32 v196, 0
    v_mov_b32 v197, 0
    v_mov_b32 v198, 0
    v_mov_b32 v199, 0
    v_mov_b32 v200, 0
    v_mov_b32 v201, 0
    v_mov_b32 v202, 0
    v_mov_b32 v203, 0
    v_mov_b32 v204, 0
    v_mov_b32 v205, 0
    v_mov_b32 v206, 0
    v_mov_b32 v207, 0
    v_mov_b32 v208, 0
    v_mov_b32 v209, 0
    v_mov_b32 v210, 0
    v_mov_b32 v211, 0
    v_mov_b32 v212, 0
    v_mov_b32 v213, 0
    v_mov_b32 v214, 0
    v_mov_b32 v215, 0
    v_mov_b32 v216, 0
    v_mov_b32 v217, 0
    v_mov_b32 v218, 0
    v_mov_b32 v219, 0
    v_mov_b32 v220, 0
    v_mov_b32 v221, 0
    v_mov_b32 v222, 0
    v_mov_b32 v223, 0
    v_mov_b32 v224, 0
    v_mov_b32 v225, 0
    v_mov_b32 v226, 0
    v_mov_b32 v227, 0
    v_mov_b32 v228, 0
    v_mov_b32 v229, 0
    v_mov_b32 v230, 0
    v_mov_b32 v231, 0
    v_mov_b32 v232, 0
    v_mov_b32 v233, 0
    v_mov_b32 v234, 0
    v_mov_b32 v235, 0
    v_mov_b32 v236, 0
    v_mov_b32 v237, 0
    v_mov_b32 v238, 0
    v_mov_b32 v239, 0
    v_mov_b32 v240, 0
    v_mov_b32 v241, 0
    v_mov_b32 v242, 0
    v_mov_b32 v243, 0
    v_mov_b32 v244, 0
    v_mov_b32 v245, 0
    v_mov_b32 v246, 0
    v_mov_b32 v247, 0
    v_mov_b32 v248, 0
    v_mov_b32 v249, 0
    v_mov_b32 v250, 0
    v_mov_b32 v251, 0
    v_mov_b32 v252, 0
    v_mov_b32 v253, 0
    v_mov_b32 v254, 0
    v_mov_b32 v255, 0
    s_barrier
    s_mov_b32 s40, 2
    v_mov_b32 v0, s40
    s_waitcnt vmcnt(21)
    ds_write_b32 v7, v0
    s_branch K12_S0
K12_Q0:
    ds_read_b64_tr_b16 v[40:41], v4 offset:0
    ds_read_b64_tr_b16 v[42:43], v4 offset:2048
    ds_read_b64_tr_b16 v[44:45], v4 offset:256
    ds_read_b64_tr_b16 v[46:47], v4 offset:2304
    v_xor_b32 v4, 32, v4
    ds_read_b64_tr_b16 v[48:49], v4 offset:0
    ds_read_b64_tr_b16 v[50:51], v4 offset:2048
    ds_read_b64_tr_b16 v[52:53], v4 offset:256
    ds_read_b64_tr_b16 v[54:55], v4 offset:2304
    v_xor_b32 v4, 32, v4
    ds_read_b128 v[8:11], v2 offset:0
    ds_read_b128 v[12:15], v3 offset:0
    ds_read_b128 v[16:19], v2 offset:2048
    ds_read_b128 v[20:23], v3 offset:2048
    ds_read_b128 v[32:35], v2 offset:6144
    ds_read_b128 v[36:39], v3 offset:6144
    ds_read_b32 v60, v5
    s_waitcnt lgkmcnt(7)
    v_xor_b32 v72, s35, v44
    v_xor_b32 v73, s35, v45
    v_xor_b32 v74, s35, v46
    v_xor_b32 v75, s35, v47
    v_xor_b32 v76, s35, v52
    v_xor_b32 v77, s35, v53
    v_xor_b32 v78, s35, v54
    v_xor_b32 v79, s35, v55
    s_mov_b32 s41, 0
    s_mov_b32 s42, 38912
    s_mov_b32 s39, 0
    s_mov_b32 s29, 116736
K12_LOOP:
    s_waitcnt lgkmcnt(5)
    v_mfma_f32_16x16x32_bf16 v[80:83], v[8:11], v[40:43], v[80:83]
    ds_read_b128 v[24:27], v2 offset:4096
    v_mfma_f32_16x16x32_bf16 v[84:87], v[8:11], v[44:47], v[84:87]
    ds_read_b128 v[28:31], v3 offset:4096
    v_mfma_f32_16x16x32_bf16 v[88:91], v[8:11], v[48:51], v[88:91]
    s_waitcnt lgkmcnt(2)
    v_cmp_gt_u32 vcc, s40, v60
    s_add_u32 s49, s39, 2
    s_lshr_b32 s49, s49, 1
    v_mfma_f32_16x16x32_bf16 v[92:95], v[8:11], v[52:55], v[92:95]
    s_cbranch_vccnz K12_S1
K12_Q1:
    s_mul_i32 s48, s49, s50
    s_add_u32 s48, s48, s47
    v_mfma_f32_16x16x32_bf16 v[80:83], v[12:15], v[72:75], v[80:83]
    s_add_u32 m0, s29, s36
    s_nop 0
    buffer_load_dwordx4 v1, s[8:11], s30 offen sc1 lds
    v_mfma_f32_16x16x32_bf16 v[84:87], v[12:15], v[40:43], v[84:87]
    s_cmp_lt_u32 s49, 8
    s_cselect_b32 s48, s48, 155744
    v_mfma_f32_16x16x32_bf16 v[88:91], v[12:15], v[76:79], v[88:91]
    s_cmp_ge_u32 s49, 3
    s_cselect_b32 s48, s48, 155744
    v_mfma_f32_16x16x32_bf16 v[92:95], v[12:15], v[48:51], v[92:95]
    v_mfma_f32_16x16x32_bf16 v[96:99], v[16:19], v[40:43], v[96:99]
    ds_read_b128 v[8:11], v2 offset:8192
    v_mfma_f32_16x16x32_bf16 v[100:103], v[16:19], v[44:47], v[100:103]
    ds_read_b128 v[12:15], v3 offset:8192
    v_mfma_f32_16x16x32_bf16 v[104:107], v[16:19], v[48:51], v[104:107]
    buffer_load_dwordx4 v1, s[8:11], s30 offen offset:1024 sc1 lds
    v_mfma_f32_16x16x32_bf16 v[108:111], v[16:19], v[52:55], v[108:111]
    v_mfma_f32_16x16x32_bf16 v[96:99], v[20:23], v[72:75], v[96:99]
    v_mfma_f32_16x16x32_bf16 v[100:103], v[20:23], v[40:43], v[100:103]
    v_mfma_f32_16x16x32_bf16 v[104:107], v[20:23], v[76:79], v[104:107]
    buffer_load_dwordx4 v1, s[8:11], s30 offen offset:2048 sc1 lds
    v_mfma_f32_16x16x32_bf16 v[108:111], v[20:23], v[48:51], v[108:111]
    s_waitcnt lgkmcnt(2)
    v_mfma_f32_16x16x32_bf16 v[112:115], v[24:27], v[40:43], v[112:115]
    ds_read_b128 v[16:19], v2 offset:10240
    v_mfma_f32_16x16x32_bf16 v[116:119], v[24:27], v[44:47], v[116:119]
    ds_read_b128 v[20:23], v3 offset:10240
    v_mfma_f32_16x16x32_bf16 v[120:123], v[24:27], v[48:51], v[120:123]
    v_mfma_f32_16x16x32_bf16 v[124:127], v[24:27], v[52:55], v[124:127]
    v_mfma_f32_16x16x32_bf16 v[112:115], v[28:31], v[72:75], v[112:115]
    buffer_load_dwordx4 v1, s[8:11], s30 offen offset:3072 sc1 lds
    v_mfma_f32_16x16x32_bf16 v[116:119], v[28:31], v[40:43], v[116:119]
    v_mfma_f32_16x16x32_bf16 v[120:123], v[28:31], v[76:79], v[120:123]
    v_mfma_f32_16x16x32_bf16 v[124:127], v[28:31], v[48:51], v[124:127]
    v_mfma_f32_16x16x32_bf16 v[128:131], v[32:35], v[40:43], v[128:131]
    ds_read_b128 v[24:27], v2 offset:12288
    v_mfma_f32_16x16x32_bf16 v[132:135], v[32:35], v[44:47], v[132:135]
    ds_read_b128 v[28:31], v3 offset:12288
    v_mfma_f32_16x16x32_bf16 v[136:139], v[32:35], v[48:51], v[136:139]
    s_add_u32 m0, m0, 4096
    s_add_u32 s34, s30, 4096
    buffer_load_dwordx4 v1, s[8:11], s34 offen sc1 lds
    v_mfma_f32_16x16x32_bf16 v[140:143], v[32:35], v[52:55], v[140:143]
    v_mfma_f32_16x16x32_bf16 v[128:131], v[36:39], v[72:75], v[128:131]
    v_mfma_f32_16x16x32_bf16 v[132:135], v[36:39], v[40:43], v[132:135]
    v_mfma_f32_16x16x32_bf16 v[136:139], v[36:39], v[76:79], v[136:139]
    s_add_u32 m0, s29, s37
    s_add_u32 s30, s30, 21376
    buffer_load_dwordx4 v1, s[12:15], s31 offen sc1 lds
    v_mfma_f32_16x16x32_bf16 v[140:143], v[36:39], v[48:51], v[140:143]
    s_waitcnt lgkmcnt(4)
    v_mfma_f32_16x16x32_bf16 v[144:147], v[8:11], v[40:43], v[144:147]
    ds_read_b128 v[32:35], v2 offset:14336
    v_mfma_f32_16x16x32_bf16 v[148:151], v[8:11], v[44:47], v[148:151]
    ds_read_b128 v[36:39], v3 offset:14336
    v_mfma_f32_16x16x32_bf16 v[152:155], v[8:11], v[48:51], v[152:155]
    v_mfma_f32_16x16x32_bf16 v[156:159], v[8:11], v[52:55], v[156:159]
    v_mfma_f32_16x16x32_bf16 v[144:147], v[12:15], v[72:75], v[144:147]
    buffer_load_dwordx4 v1, s[12:15], s31 offen offset:1024 sc1 lds
    v_mfma_f32_16x16x32_bf16 v[148:151], v[12:15], v[40:43], v[148:151]
    v_mfma_f32_16x16x32_bf16 v[152:155], v[12:15], v[76:79], v[152:155]
    v_mfma_f32_16x16x32_bf16 v[156:159], v[12:15], v[48:51], v[156:159]
    s_waitcnt lgkmcnt(4)
    v_mfma_f32_16x16x32_bf16 v[160:163], v[16:19], v[40:43], v[160:163]
    ds_read_b128 v[8:11], v2 offset:16384
    v_mfma_f32_16x16x32_bf16 v[164:167], v[16:19], v[44:47], v[164:167]
    ds_read_b128 v[12:15], v3 offset:16384
    v_mfma_f32_16x16x32_bf16 v[168:171], v[16:19], v[48:51], v[168:171]
    buffer_load_dwordx4 v1, s[12:15], s31 offen offset:2048 sc1 lds
    v_mfma_f32_16x16x32_bf16 v[172:175], v[16:19], v[52:55], v[172:175]
    s_add_u32 s40, s40, 1
    s_mov_b32 s51, s40
    v_mov_b32 v0, s40
    v_mfma_f32_16x16x32_bf16 v[160:163], v[20:23], v[72:75], v[160:163]
    s_waitcnt vmcnt(19)
    ds_write_b32 v7, v0
    v_mfma_f32_16x16x32_bf16 v[164:167], v[20:23], v[40:43], v[164:167]
    v_mfma_f32_16x16x32_bf16 v[168:171], v[20:23], v[76:79], v[168:171]
    buffer_load_dwordx4 v1, s[12:15], s31 offen offset:3072 sc1 lds
    v_mfma_f32_16x16x32_bf16 v[172:175], v[20:23], v[48:51], v[172:175]
    s_waitcnt lgkmcnt(5)
    v_mfma_f32_16x16x32_bf16 v[176:179], v[24:27], v[40:43], v[176:179]
    ds_read_b128 v[16:19], v2 offset:18432
    v_mfma_f32_16x16x32_bf16 v[180:183], v[24:27], v[44:47], v[180:183]
    ds_read_b128 v[20:23], v3 offset:18432
    v_mov_b32 v0, s48
    v_mfma_f32_16x16x32_bf16 v[184:187], v[24:27], v[48:51], v[184:187]
    ds_read_b32 v0, v0
    v_mfma_f32_16x16x32_bf16 v[188:191], v[24:27], v[52:55], v[188:191]
    v_mfma_f32_16x16x32_bf16 v[176:179], v[28:31], v[72:75], v[176:179]
    s_add_u32 m0, s29, s38
    s_mov_b64 exec, s[44:45]
    buffer_load_dwordx4 v1, s[8:11], s33 offen sc1 lds
    s_mov_b64 exec, -1
    s_add_u32 s31, s31, 16384
    s_add_u32 s33, s33, 21376
    v_mfma_f32_16x16x32_bf16 v[180:183], v[28:31], v[40:43], v[180:183]
    v_mfma_f32_16x16x32_bf16 v[184:187], v[28:31], v[76:79], v[184:187]
    v_mfma_f32_16x16x32_bf16 v[188:191], v[28:31], v[48:51], v[188:191]
    s_waitcnt lgkmcnt(0)
    v_cmp_eq_u32 vcc, 0, v0
    v_mfma_f32_16x16x32_bf16 v[192:195], v[32:35], v[40:43], v[192:195]
    ds_read_b128 v[24:27], v2 offset:20480
    v_mfma_f32_16x16x32_bf16 v[196:199], v[32:35], v[44:47], v[196:199]
    ds_read_b128 v[28:31], v3 offset:20480
    s_cbranch_vccnz K12_F2
K12_G2:
    v_mfma_f32_16x16x32_bf16 v[200:203], v[32:35], v[48:51], v[200:203]
    s_sub_u32 s43, s42, s41
    s_add_u32 s40, s40, 1
    v_add_u32 v2, s43, v2
    v_mfma_f32_16x16x32_bf16 v[204:207], v[32:35], v[52:55], v[204:207]
    v_add_u32 v3, s43, v3
    v_add_u32 v4, s43, v4
    v_mov_b32 v0, s40
    v_mfma_f32_16x16x32_bf16 v[192:195], v[36:39], v[72:75], v[192:195]
    ds_write_b32 v7, v0
    v_mfma_f32_16x16x32_bf16 v[196:199], v[36:39], v[40:43], v[196:199]
    v_mfma_f32_16x16x32_bf16 v[200:203], v[36:39], v[76:79], v[200:203]
    v_mfma_f32_16x16x32_bf16 v[204:207], v[36:39], v[48:51], v[204:207]
    ds_read_b32 v56, v5
    v_mfma_f32_16x16x32_bf16 v[208:211], v[8:11], v[40:43], v[208:211]
    v_mfma_f32_16x16x32_bf16 v[212:215], v[8:11], v[44:47], v[212:215]
    v_mfma_f32_16x16x32_bf16 v[216:219], v[8:11], v[48:51], v[216:219]
    v_mfma_f32_16x16x32_bf16 v[220:223], v[8:11], v[52:55], v[220:223]
    s_waitcnt lgkmcnt(0)
    v_cmp_gt_u32 vcc, s51, v56
    v_mfma_f32_16x16x32_bf16 v[208:211], v[12:15], v[72:75], v[208:211]
    v_mfma_f32_16x16x32_bf16 v[212:215], v[12:15], v[40:43], v[212:215]
    s_cbranch_vccnz K12_S3
K12_Q3:
    v_mfma_f32_16x16x32_bf16 v[216:219], v[12:15], v[76:79], v[216:219]
    ds_read_b64_tr_b16 v[56:57], v4 offset:0
    v_mfma_f32_16x16x32_bf16 v[220:223], v[12:15], v[48:51], v[220:223]
    ds_read_b64_tr_b16 v[58:59], v4 offset:2048
    v_mfma_f32_16x16x32_bf16 v[224:227], v[16:19], v[40:43], v[224:227]
    ds_read_b64_tr_b16 v[60:61], v4 offset:256
    v_mfma_f32_16x16x32_bf16 v[228:231], v[16:19], v[44:47], v[228:231]
    ds_read_b64_tr_b16 v[62:63], v4 offset:2304
    v_mfma_f32_16x16x32_bf16 v[232:235], v[16:19], v[48:51], v[232:235]
    v_xor_b32 v4, 32, v4
    v_mfma_f32_16x16x32_bf16 v[236:239], v[16:19], v[52:55], v[236:239]
    ds_read_b64_tr_b16 v[64:65], v4 offset:0
    v_mfma_f32_16x16x32_bf16 v[224:227], v[20:23], v[72:75], v[224:227]
    ds_read_b64_tr_b16 v[66:67], v4 offset:2048
    v_mfma_f32_16x16x32_bf16 v[228:231], v[20:23], v[40:43], v[228:231]
    ds_read_b64_tr_b16 v[68:69], v4 offset:256
    ds_read_b64_tr_b16 v[70:71], v4 offset:2304
    v_xor_b32 v4, 32, v4
    v_mfma_f32_16x16x32_bf16 v[232:235], v[20:23], v[76:79], v[232:235]
    ds_read_b128 v[8:11], v2 offset:0
    v_mfma_f32_16x16x32_bf16 v[236:239], v[20:23], v[48:51], v[236:239]
    ds_read_b128 v[12:15], v3 offset:0
    v_mfma_f32_16x16x32_bf16 v[240:243], v[24:27], v[40:43], v[240:243]
    ds_read_b128 v[16:19], v2 offset:2048
    v_mfma_f32_16x16x32_bf16 v[244:247], v[24:27], v[44:47], v[244:247]
    ds_read_b128 v[20:23], v3 offset:2048
    v_mfma_f32_16x16x32_bf16 v[248:251], v[24:27], v[48:51], v[248:251]
    ds_read_b128 v[32:35], v2 offset:6144
    v_mfma_f32_16x16x32_bf16 v[252:255], v[24:27], v[52:55], v[252:255]
    ds_read_b128 v[36:39], v3 offset:6144
    ds_read_b32 v44, v5
    s_mov_b32 s29, s41
    s_mov_b32 s41, s42
    s_add_u32 s42, s42, 38912
    v_mfma_f32_16x16x32_bf16 v[240:243], v[28:31], v[72:75], v[240:243]
    s_waitcnt lgkmcnt(7)
    v_xor_b32 v72, s35, v60
    v_xor_b32 v73, s35, v61
    v_mfma_f32_16x16x32_bf16 v[244:247], v[28:31], v[40:43], v[244:247]
    v_xor_b32 v74, s35, v62
    v_xor_b32 v75, s35, v63
    s_cmp_eq_u32 s42, 155648
    s_cselect_b32 s42, 0, s42
    v_mfma_f32_16x16x32_bf16 v[248:251], v[28:31], v[76:79], v[248:251]
    v_xor_b32 v76, s35, v68
    v_xor_b32 v77, s35, v69
    v_mfma_f32_16x16x32_bf16 v[252:255], v[28:31], v[48:51], v[252:255]
    v_xor_b32 v78, s35, v70
    v_xor_b32 v79, s35, v71
    s_waitcnt lgkmcnt(5)
    v_mfma_f32_16x16x32_bf16 v[80:83], v[8:11], v[56:59], v[80:83]
    ds_read_b128 v[24:27], v2 offset:4096
    v_mfma_f32_16x16x32_bf16 v[84:87], v[8:11], v[60:63], v[84:87]
    ds_read_b128 v[28:31], v3 offset:4096
    v_mfma_f32_16x16x32_bf16 v[88:91], v[8:11], v[64:67], v[88:91]
    s_waitcnt lgkmcnt(2)
    v_cmp_gt_u32 vcc, s40, v44
    v_mfma_f32_16x16x32_bf16 v[92:95], v[8:11], v[68:71], v[92:95]
    s_cbranch_vccnz K12_S4
K12_Q4:
    v_mfma_f32_16x16x32_bf16 v[80:83], v[12:15], v[72:75], v[80:83]
    s_add_u32 m0, s29, s36
    s_nop 0
    buffer_load_dwordx4 v1, s[8:11], s30 offen sc1 lds
    v_mfma_f32_16x16x32_bf16 v[84:87], v[12:15], v[56:59], v[84:87]
    v_mfma_f32_16x16x32_bf16 v[88:91], v[12:15], v[76:79], v[88:91]
    v_mfma_f32_16x16x32_bf16 v[92:95], v[12:15], v[64:67], v[92:95]
    v_mfma_f32_16x16x32_bf16 v[96:99], v[16:19], v[56:59], v[96:99]
    ds_read_b128 v[8:11], v2 offset:8192
    v_mfma_f32_16x16x32_bf16 v[100:103], v[16:19], v[60:63], v[100:103]
    ds_read_b128 v[12:15], v3 offset:8192
    v_mfma_f32_16x16x32_bf16 v[104:107], v[16:19], v[64:67], v[104:107]
    buffer_load_dwordx4 v1, s[8:11], s30 offen offset:1024 sc1 lds
    v_mfma_f32_16x16x32_bf16 v[108:111], v[16:19], v[68:71], v[108:111]
    v_mfma_f32_16x16x32_bf16 v[96:99], v[20:23], v[72:75], v[96:99]
    v_mfma_f32_16x16x32_bf16 v[100:103], v[20:23], v[56:59], v[100:103]
    v_mfma_f32_16x16x32_bf16 v[104:107], v[20:23], v[76:79], v[104:107]
    buffer_load_dwordx4 v1, s[8:11], s30 offen offset:2048 sc1 lds
    v_mfma_f32_16x16x32_bf16 v[108:111], v[20:23], v[64:67], v[108:111]
    s_waitcnt lgkmcnt(2)
    v_mfma_f32_16x16x32_bf16 v[112:115], v[24:27], v[56:59], v[112:115]
    ds_read_b128 v[16:19], v2 offset:10240
    v_mfma_f32_16x16x32_bf16 v[116:119], v[24:27], v[60:63], v[116:119]
    ds_read_b128 v[20:23], v3 offset:10240
    v_mfma_f32_16x16x32_bf16 v[120:123], v[24:27], v[64:67], v[120:123]
    v_mfma_f32_16x16x32_bf16 v[124:127], v[24:27], v[68:71], v[124:127]
    v_mfma_f32_16x16x32_bf16 v[112:115], v[28:31], v[72:75], v[112:115]
    buffer_load_dwordx4 v1, s[8:11], s30 offen offset:3072 sc1 lds
    v_mfma_f32_16x16x32_bf16 v[116:119], v[28:31], v[56:59], v[116:119]
    v_mfma_f32_16x16x32_bf16 v[120:123], v[28:31], v[76:79], v[120:123]
    v_mfma_f32_16x16x32_bf16 v[124:127], v[28:31], v[64:67], v[124:127]
    v_mfma_f32_16x16x32_bf16 v[128:131], v[32:35], v[56:59], v[128:131]
    ds_read_b128 v[24:27], v2 offset:12288
    v_mfma_f32_16x16x32_bf16 v[132:135], v[32:35], v[60:63], v[132:135]
    ds_read_b128 v[28:31], v3 offset:12288
    v_mfma_f32_16x16x32_bf16 v[136:139], v[32:35], v[64:67], v[136:139]
    s_add_u32 m0, m0, 4096
    s_add_u32 s34, s30, 4096
    buffer_load_dwordx4 v1, s[8:11], s34 offen sc1 lds
    v_mfma_f32_16x16x32_bf16 v[140:143], v[32:35], v[68:71], v[140:143]
    v_mfma_f32_16x16x32_bf16 v[128:131], v[36:39], v[72:75], v[128:131]
    v_mfma_f32_16x16x32_bf16 v[132:135], v[36:39], v[56:59], v[132:135]
    v_mfma_f32_16x16x32_bf16 v[136:139], v[36:39], v[76:79], v[136:139]
    s_add_u32 m0, s29, s37
    s_add_u32 s30, s30, 21376
    buffer_load_dwordx4 v1, s[12:15], s31 offen sc1 lds
    v_mfma_f32_16x16x32_bf16 v[140:143], v[36:39], v[64:67], v[140:143]
    s_waitcnt lgkmcnt(4)
    v_mfma_f32_16x16x32_bf16 v[144:147], v[8:11], v[56:59], v[144:147]
    ds_read_b128 v[32:35], v2 offset:14336
    v_mfma_f32_16x16x32_bf16 v[148:151], v[8:11], v[60:63], v[148:151]
    ds_read_b128 v[36:39], v3 offset:14336
    v_mfma_f32_16x16x32_bf16 v[152:155], v[8:11], v[64:67], v[152:155]
    v_mfma_f32_16x16x32_bf16 v[156:159], v[8:11], v[68:71], v[156:159]
    v_mfma_f32_16x16x32_bf16 v[144:147], v[12:15], v[72:75], v[144:147]
    buffer_load_dwordx4 v1, s[12:15], s31 offen offset:1024 sc1 lds
    v_mfma_f32_16x16x32_bf16 v[148:151], v[12:15], v[56:59], v[148:151]
    v_mfma_f32_16x16x32_bf16 v[152:155], v[12:15], v[76:79], v[152:155]
    v_mfma_f32_16x16x32_bf16 v[156:159], v[12:15], v[64:67], v[156:159]
    s_waitcnt lgkmcnt(4)
    v_mfma_f32_16x16x32_bf16 v[160:163], v[16:19], v[56:59], v[160:163]
    ds_read_b128 v[8:11], v2 offset:16384
    v_mfma_f32_16x16x32_bf16 v[164:167], v[16:19], v[60:63], v[164:167]
    ds_read_b128 v[12:15], v3 offset:16384
    v_mfma_f32_16x16x32_bf16 v[168:171], v[16:19], v[64:67], v[168:171]
    buffer_load_dwordx4 v1, s[12:15], s31 offen offset:2048 sc1 lds
    v_mfma_f32_16x16x32_bf16 v[172:175], v[16:19], v[68:71], v[172:175]
    s_add_u32 s40, s40, 1
    s_mov_b32 s51, s40
    v_mov_b32 v0, s40
    v_mfma_f32_16x16x32_bf16 v[160:163], v[20:23], v[72:75], v[160:163]
    s_waitcnt vmcnt(19)
    ds_write_b32 v7, v0
    v_mfma_f32_16x16x32_bf16 v[164:167], v[20:23], v[56:59], v[164:167]
    v_mfma_f32_16x16x32_bf16 v[168:171], v[20:23], v[76:79], v[168:171]
    buffer_load_dwordx4 v1, s[12:15], s31 offen offset:3072 sc1 lds
    v_mfma_f32_16x16x32_bf16 v[172:175], v[20:23], v[64:67], v[172:175]
    s_waitcnt lgkmcnt(5)
    v_mfma_f32_16x16x32_bf16 v[176:179], v[24:27], v[56:59], v[176:179]
    ds_read_b128 v[16:19], v2 offset:18432
    v_mfma_f32_16x16x32_bf16 v[180:183], v[24:27], v[60:63], v[180:183]
    ds_read_b128 v[20:23], v3 offset:18432
    v_mfma_f32_16x16x32_bf16 v[184:187], v[24:27], v[64:67], v[184:187]
    v_mfma_f32_16x16x32_bf16 v[188:191], v[24:27], v[68:71], v[188:191]
    v_mfma_f32_16x16x32_bf16 v[176:179], v[28:31], v[72:75], v[176:179]
    s_add_u32 m0, s29, s38
    s_mov_b64 exec, s[44:45]
    buffer_load_dwordx4 v1, s[8:11], s33 offen sc1 lds
    s_mov_b64 exec, -1
    s_add_u32 s31, s31, 16384
    s_add_u32 s33, s33, 21376
    v_mfma_f32_16x16x32_bf16 v[180:183], v[28:31], v[56:59], v[180:183]
    v_mfma_f32_16x16x32_bf16 v[184:187], v[28:31], v[76:79], v[184:187]
    s_mov_b32 m0, s46
    s_mov_b64 exec, 0xff
    buffer_load_dword v1, s[4:7], 0 offen sc1 lds
    s_mov_b64 exec, -1
    v_mfma_f32_16x16x32_bf16 v[188:191], v[28:31], v[64:67], v[188:191]
    s_waitcnt lgkmcnt(5)
    v_mfma_f32_16x16x32_bf16 v[192:195], v[32:35], v[56:59], v[192:195]
    ds_read_b128 v[24:27], v2 offset:20480
    v_mfma_f32_16x16x32_bf16 v[196:199], v[32:35], v[60:63], v[196:199]
    ds_read_b128 v[28:31], v3 offset:20480
    v_mfma_f32_16x16x32_bf16 v[200:203], v[32:35], v[64:67], v[200:203]
    s_sub_u32 s43, s42, s41
    s_add_u32 s40, s40, 1
    v_add_u32 v2, s43, v2
    v_mfma_f32_16x16x32_bf16 v[204:207], v[32:35], v[68:71], v[204:207]
    v_add_u32 v3, s43, v3
    v_add_u32 v4, s43, v4
    v_mov_b32 v0, s40
    v_mfma_f32_16x16x32_bf16 v[192:195], v[36:39], v[72:75], v[192:195]
    ds_write_b32 v7, v0
    v_mfma_f32_16x16x32_bf16 v[196:199], v[36:39], v[56:59], v[196:199]
    v_mfma_f32_16x16x32_bf16 v[200:203], v[36:39], v[76:79], v[200:203]
    v_mfma_f32_16x16x32_bf16 v[204:207], v[36:39], v[64:67], v[204:207]
    ds_read_b32 v40, v5
    s_waitcnt lgkmcnt(7)
    v_mfma_f32_16x16x32_bf16 v[208:211], v[8:11], v[56:59], v[208:211]
    v_mfma_f32_16x16x32_bf16 v[212:215], v[8:11], v[60:63], v[212:215]
    v_mfma_f32_16x16x32_bf16 v[216:219], v[8:11], v[64:67], v[216:219]
    v_mfma_f32_16x16x32_bf16 v[220:223], v[8:11], v[68:71], v[220:223]
    s_waitcnt lgkmcnt(0)
    v_cmp_gt_u32 vcc, s51, v40
    v_mfma_f32_16x16x32_bf16 v[208:211], v[12:15], v[72:75], v[208:211]
    v_mfma_f32_16x16x32_bf16 v[212:215], v[12:15], v[56:59], v[212:215]
    s_cbranch_vccnz K12_S5
K12_Q5:
    v_mfma_f32_16x16x32_bf16 v[216:219], v[12:15], v[76:79], v[216:219]
    ds_read_b64_tr_b16 v[40:41], v4 offset:0
    v_mfma_f32_16x16x32_bf16 v[220:223], v[12:15], v[64:67], v[220:223]
    ds_read_b64_tr_b16 v[42:43], v4 offset:2048
    v_mfma_f32_16x16x32_bf16 v[224:227], v[16:19], v[56:59], v[224:227]
    ds_read_b64_tr_b16 v[44:45], v4 offset:256
    v_mfma_f32_16x16x32_bf16 v[228:231], v[16:19], v[60:63], v[228:231]
    ds_read_b64_tr_b16 v[46:47], v4 offset:2304
    v_mfma_f32_16x16x32_bf16 v[232:235], v[16:19], v[64:67], v[232:235]
    v_xor_b32 v4, 32, v4
    v_mfma_f32_16x16x32_bf16 v[236:239], v[16:19], v[68:71], v[236:239]
    ds_read_b64_tr_b16 v[48:49], v4 offset:0
    v_mfma_f32_16x16x32_bf16 v[224:227], v[20:23], v[72:75], v[224:227]
    ds_read_b64_tr_b16 v[50:51], v4 offset:2048
    v_mfma_f32_16x16x32_bf16 v[228:231], v[20:23], v[56:59], v[228:231]
    ds_read_b64_tr_b16 v[52:53], v4 offset:256
    ds_read_b64_tr_b16 v[54:55], v4 offset:2304
    v_xor_b32 v4, 32, v4
    v_mfma_f32_16x16x32_bf16 v[232:235], v[20:23], v[76:79], v[232:235]
    ds_read_b128 v[8:11], v2 offset:0
    v_mfma_f32_16x16x32_bf16 v[236:239], v[20:23], v[64:67], v[236:239]
    ds_read_b128 v[12:15], v3 offset:0
    v_mfma_f32_16x16x32_bf16 v[240:243], v[24:27], v[56:59], v[240:243]
    ds_read_b128 v[16:19], v2 offset:2048
    v_mfma_f32_16x16x32_bf16 v[244:247], v[24:27], v[60:63], v[244:247]
    ds_read_b128 v[20:23], v3 offset:2048
    v_mfma_f32_16x16x32_bf16 v[248:251], v[24:27], v[64:67], v[248:251]
    ds_read_b128 v[32:35], v2 offset:6144
    v_mfma_f32_16x16x32_bf16 v[252:255], v[24:27], v[68:71], v[252:255]
    ds_read_b128 v[36:39], v3 offset:6144
    ds_read_b32 v60, v5
    s_mov_b32 s29, s41
    s_mov_b32 s41, s42
    s_add_u32 s42, s42, 38912
    v_mfma_f32_16x16x32_bf16 v[240:243], v[28:31], v[72:75], v[240:243]
    s_waitcnt lgkmcnt(7)
    v_xor_b32 v72, s35, v44
    v_xor_b32 v73, s35, v45
    v_mfma_f32_16x16x32_bf16 v[244:247], v[28:31], v[56:59], v[244:247]
    v_xor_b32 v74, s35, v46
    v_xor_b32 v75, s35, v47
    s_cmp_eq_u32 s42, 155648
    s_cselect_b32 s42, 0, s42
    v_mfma_f32_16x16x32_bf16 v[248:251], v[28:31], v[76:79], v[248:251]
    v_xor_b32 v76, s35, v52
    v_xor_b32 v77, s35, v53
    v_mfma_f32_16x16x32_bf16 v[252:255], v[28:31], v[64:67], v[252:255]
    v_xor_b32 v78, s35, v54
    v_xor_b32 v79, s35, v55
    s_add_u32 s39, s39, 1
    s_cmp_lt_u32 s39, 15
    s_cbranch_scc1 K12_LOOP
    s_waitcnt lgkmcnt(5)
    v_mfma_f32_16x16x32_bf16 v[80:83], v[8:11], v[40:43], v[80:83]
    ds_read_b128 v[24:27], v2 offset:4096
    v_mfma_f32_16x16x32_bf16 v[84:87], v[8:11], v[44:47], v[84:87]
    ds_read_b128 v[28:31], v3 offset:4096
    v_mfma_f32_16x16x32_bf16 v[88:91], v[8:11], v[48:51], v[88:91]
    s_waitcnt lgkmcnt(2)
    v_cmp_gt_u32 vcc, s40, v60
    s_add_u32 s49, s39, 2
    s_lshr_b32 s49, s49, 1
    v_mfma_f32_16x16x32_bf16 v[92:95], v[8:11], v[52:55], v[92:95]
    s_cbranch_vccnz K12_S6
K12_Q6:
    s_mul_i32 s48, s49, s50
    s_add_u32 s48, s48, s47
    v_mfma_f32_16x16x32_bf16 v[80:83], v[12:15], v[72:75], v[80:83]
    s_add_u32 m0, s29, s36
    s_nop 0
    buffer_load_dwordx4 v1, s[8:11], s30 offen sc1 lds
    v_mfma_f32_16x16x32_bf16 v[84:87], v[12:15], v[40:43], v[84:87]
    s_cmp_lt_u32 s49, 8
    s_cselect_b32 s48, s48, 155744
    v_mfma_f32_16x16x32_bf16 v[88:91], v[12:15], v[76:79], v[88:91]
    s_cmp_ge_u32 s49, 3
    s_cselect_b32 s48, s48, 155744
    v_mfma_f32_16x16x32_bf16 v[92:95], v[12:15], v[48:51], v[92:95]
    v_mfma_f32_16x16x32_bf16 v[96:99], v[16:19], v[40:43], v[96:99]
    ds_read_b128 v[8:11], v2 offset:8192
    v_mfma_f32_16x16x32_bf16 v[100:103], v[16:19], v[44:47], v[100:103]
    ds_read_b128 v[12:15], v3 offset:8192
    v_mfma_f32_16x16x32_bf16 v[104:107], v[16:19], v[48:51], v[104:107]
    buffer_load_dwordx4 v1, s[8:11], s30 offen offset:1024 sc1 lds
    v_mfma_f32_16x16x32_bf16 v[108:111], v[16:19], v[52:55], v[108:111]
    v_mfma_f32_16x16x32_bf16 v[96:99], v[20:23], v[72:75], v[96:99]
    v_mfma_f32_16x16x32_bf16 v[100:103], v[20:23], v[40:43], v[100:103]
    v_mfma_f32_16x16x32_bf16 v[104:107], v[20:23], v[76:79], v[104:107]
    buffer_load_dwordx4 v1, s[8:11], s30 offen offset:2048 sc1 lds
    v_mfma_f32_16x16x32_bf16 v[108:111], v[20:23], v[48:51], v[108:111]
    s_waitcnt lgkmcnt(2)
    v_mfma_f32_16x16x32_bf16 v[112:115], v[24:27], v[40:43], v[112:115]
    ds_read_b128 v[16:19], v2 offset:10240
    v_mfma_f32_16x16x32_bf16 v[116:119], v[24:27], v[44:47], v[116:119]
    ds_read_b128 v[20:23], v3 offset:10240
    v_mfma_f32_16x16x32_bf16 v[120:123], v[24:27], v[48:51], v[120:123]
    v_mfma_f32_16x16x32_bf16 v[124:127], v[24:27], v[52:55], v[124:127]
    v_mfma_f32_16x16x32_bf16 v[112:115], v[28:31], v[72:75], v[112:115]
    buffer_load_dwordx4 v1, s[8:11], s30 offen offset:3072 sc1 lds
    v_mfma_f32_16x16x32_bf16 v[116:119], v[28:31], v[40:43], v[116:119]
    v_mfma_f32_16x16x32_bf16 v[120:123], v[28:31], v[76:79], v[120:123]
    v_mfma_f32_16x16x32_bf16 v[124:127], v[28:31], v[48:51], v[124:127]
    v_mfma_f32_16x16x32_bf16 v[128:131], v[32:35], v[40:43], v[128:131]
    ds_read_b128 v[24:27], v2 offset:12288
    v_mfma_f32_16x16x32_bf16 v[132:135], v[32:35], v[44:47], v[132:135]
    ds_read_b128 v[28:31], v3 offset:12288
    v_mfma_f32_16x16x32_bf16 v[136:139], v[32:35], v[48:51], v[136:139]
    s_add_u32 m0, m0, 4096
    s_add_u32 s34, s30, 4096
    buffer_load_dwordx4 v1, s[8:11], s34 offen sc1 lds
    v_mfma_f32_16x16x32_bf16 v[140:143], v[32:35], v[52:55], v[140:143]
    v_mfma_f32_16x16x32_bf16 v[128:131], v[36:39], v[72:75], v[128:131]
    v_mfma_f32_16x16x32_bf16 v[132:135], v[36:39], v[40:43], v[132:135]
    v_mfma_f32_16x16x32_bf16 v[136:139], v[36:39], v[76:79], v[136:139]
    s_add_u32 m0, s29, s37
    s_add_u32 s30, s30, 21376
    buffer_load_dwordx4 v1, s[12:15], s31 offen sc1 lds
    v_mfma_f32_16x16x32_bf16 v[140:143], v[36:39], v[48:51], v[140:143]
    s_waitcnt lgkmcnt(4)
    v_mfma_f32_16x16x32_bf16 v[144:147], v[8:11], v[40:43], v[144:147]
    ds_read_b128 v[32:35], v2 offset:14336
    v_mfma_f32_16x16x32_bf16 v[148:151], v[8:11], v[44:47], v[148:151]
    ds_read_b128 v[36:39], v3 offset:14336
    v_mfma_f32_16x16x32_bf16 v[152:155], v[8:11], v[48:51], v[152:155]
    v_mfma_f32_16x16x32_bf16 v[156:159], v[8:11], v[52:55], v[156:159]
    v_mfma_f32_16x16x32_bf16 v[144:147], v[12:15], v[72:75], v[144:147]
    buffer_load_dwordx4 v1, s[12:15], s31 offen offset:1024 sc1 lds
    v_mfma_f32_16x16x32_bf16 v[148:151], v[12:15], v[40:43], v[148:151]
    v_mfma_f32_16x16x32_bf16 v[152:155], v[12:15], v[76:79], v[152:155]
    v_mfma_f32_16x16x32_bf16 v[156:159], v[12:15], v[48:51], v[156:159]
    s_waitcnt lgkmcnt(4)
    v_mfma_f32_16x16x32_bf16 v[160:163], v[16:19], v[40:43], v[160:163]
    ds_read_b128 v[8:11], v2 offset:16384
    v_mfma_f32_16x16x32_bf16 v[164:167], v[16:19], v[44:47], v[164:167]
    ds_read_b128 v[12:15], v3 offset:16384
    v_mfma_f32_16x16x32_bf16 v[168:171], v[16:19], v[48:51], v[168:171]
    buffer_load_dwordx4 v1, s[12:15], s31 offen offset:2048 sc1 lds
    v_mfma_f32_16x16x32_bf16 v[172:175], v[16:19], v[52:55], v[172:175]
    s_add_u32 s40, s40, 1
    s_mov_b32 s51, s40
    v_mov_b32 v0, s40
    v_mfma_f32_16x16x32_bf16 v[160:163], v[20:23], v[72:75], v[160:163]
    s_waitcnt vmcnt(19)
    ds_write_b32 v7, v0
    v_mfma_f32_16x16x32_bf16 v[164:167], v[20:23], v[40:43], v[164:167]
    v_mfma_f32_16x16x32_bf16 v[168:171], v[20:23], v[76:79], v[168:171]
    buffer_load_dwordx4 v1, s[12:15], s31 offen offset:3072 sc1 lds
    v_mfma_f32_16x16x32_bf16 v[172:175], v[20:23], v[48:51], v[172:175]
    s_waitcnt lgkmcnt(5)
    v_mfma_f32_16x16x32_bf16 v[176:179], v[24:27], v[40:43], v[176:179]
    ds_read_b128 v[16:19], v2 offset:18432
    v_mfma_f32_16x16x32_bf16 v[180:183], v[24:27], v[44:47], v[180:183]
    ds_read_b128 v[20:23], v3 offset:18432
    v_mov_b32 v0, s48
    v_mfma_f32_16x16x32_bf16 v[184:187], v[24:27], v[48:51], v[184:187]
    ds_read_b32 v0, v0
    v_mfma_f32_16x16x32_bf16 v[188:191], v[24:27], v[52:55], v[188:191]
    v_mfma_f32_16x16x32_bf16 v[176:179], v[28:31], v[72:75], v[176:179]
    s_add_u32 m0, s29, s38
    s_mov_b64 exec, s[44:45]
    buffer_load_dwordx4 v1, s[8:11], s33 offen sc1 lds
    s_mov_b64 exec, -1
    s_add_u32 s31, s31, 16384
    s_add_u32 s33, s33, 21376
    v_mfma_f32_16x16x32_bf16 v[180:183], v[28:31], v[40:43], v[180:183]
    v_mfma_f32_16x16x32_bf16 v[184:187], v[28:31], v[76:79], v[184:187]
    v_mfma_f32_16x16x32_bf16 v[188:191], v[28:31], v[48:51], v[188:191]
    s_waitcnt lgkmcnt(0)
    v_cmp_eq_u32 vcc, 0, v0
    v_mfma_f32_16x16x32_bf16 v[192:195], v[32:35], v[40:43], v[192:195]
    ds_read_b128 v[24:27], v2 offset:20480
    v_mfma_f32_16x16x32_bf16 v[196:199], v[32:35], v[44:47], v[196:199]
    ds_read_b128 v[28:31], v3 offset:20480
    s_cbranch_vccnz K12_F7
K12_G7:
    v_mfma_f32_16x16x32_bf16 v[200:203], v[32:35], v[48:51], v[200:203]
    s_sub_u32 s43, s42, s41
    s_add_u32 s40, s40, 1
    v_add_u32 v2, s43, v2
    v_mfma_f32_16x16x32_bf16 v[204:207], v[32:35], v[52:55], v[204:207]
    v_add_u32 v3, s43, v3
    v_add_u32 v4, s43, v4
    v_mov_b32 v0, s40
    v_mfma_f32_16x16x32_bf16 v[192:195], v[36:39], v[72:75], v[192:195]
    ds_write_b32 v7, v0
    v_mfma_f32_16x16x32_bf16 v[196:199], v[36:39], v[40:43], v[196:199]
    v_mfma_f32_16x16x32_bf16 v[200:203], v[36:39], v[76:79], v[200:203]
    v_mfma_f32_16x16x32_bf16 v[204:207], v[36:39], v[48:51], v[204:207]
    ds_read_b32 v56, v5
    v_mfma_f32_16x16x32_bf16 v[208:211], v[8:11], v[40:43], v[208:211]
    v_mfma_f32_16x16x32_bf16 v[212:215], v[8:11], v[44:47], v[212:215]
    v_mfma_f32_16x16x32_bf16 v[216:219], v[8:11], v[48:51], v[216:219]
    v_mfma_f32_16x16x32_bf16 v[220:223], v[8:11], v[52:55], v[220:223]
    s_waitcnt lgkmcnt(0)
    v_cmp_gt_u32 vcc, s51, v56
    v_mfma_f32_16x16x32_bf16 v[208:211], v[12:15], v[72:75], v[208:211]
    v_mfma_f32_16x16x32_bf16 v[212:215], v[12:15], v[40:43], v[212:215]
    s_cbranch_vccnz K12_S8
K12_Q8:
    v_mfma_f32_16x16x32_bf16 v[216:219], v[12:15], v[76:79], v[216:219]
    ds_read_b64_tr_b16 v[56:57], v4 offset:0
    v_mfma_f32_16x16x32_bf16 v[220:223], v[12:15], v[48:51], v[220:223]
    ds_read_b64_tr_b16 v[58:59], v4 offset:2048
    v_mfma_f32_16x16x32_bf16 v[224:227], v[16:19], v[40:43], v[224:227]
    ds_read_b64_tr_b16 v[60:61], v4 offset:256
    v_mfma_f32_16x16x32_bf16 v[228:231], v[16:19], v[44:47], v[228:231]
    ds_read_b64_tr_b16 v[62:63], v4 offset:2304
    v_mfma_f32_16x16x32_bf16 v[232:235], v[16:19], v[48:51], v[232:235]
    v_xor_b32 v4, 32, v4
    v_mfma_f32_16x16x32_bf16 v[236:239], v[16:19], v[52:55], v[236:239]
    ds_read_b64_tr_b16 v[64:65], v4 offset:0
    v_mfma_f32_16x16x32_bf16 v[224:227], v[20:23], v[72:75], v[224:227]
    ds_read_b64_tr_b16 v[66:67], v4 offset:2048
    v_mfma_f32_16x16x32_bf16 v[228:231], v[20:23], v[40:43], v[228:231]
    ds_read_b64_tr_b16 v[68:69], v4 offset:256
    ds_read_b64_tr_b16 v[70:71], v4 offset:2304
    v_xor_b32 v4, 32, v4
    v_mfma_f32_16x16x32_bf16 v[232:235], v[20:23], v[76:79], v[232:235]
    ds_read_b128 v[8:11], v2 offset:0
    v_mfma_f32_16x16x32_bf16 v[236:239], v[20:23], v[48:51], v[236:239]
    ds_read_b128 v[12:15], v3 offset:0
    v_mfma_f32_16x16x32_bf16 v[240:243], v[24:27], v[40:43], v[240:243]
    ds_read_b128 v[16:19], v2 offset:2048
    v_mfma_f32_16x16x32_bf16 v[244:247], v[24:27], v[44:47], v[244:247]
    ds_read_b128 v[20:23], v3 offset:2048
    v_mfma_f32_16x16x32_bf16 v[248:251], v[24:27], v[48:51], v[248:251]
    ds_read_b128 v[32:35], v2 offset:6144
    v_mfma_f32_16x16x32_bf16 v[252:255], v[24:27], v[52:55], v[252:255]
    ds_read_b128 v[36:39], v3 offset:6144
    ds_read_b32 v44, v5
    s_mov_b32 s29, s41
    s_mov_b32 s41, s42
    s_add_u32 s42, s42, 38912
    v_mfma_f32_16x16x32_bf16 v[240:243], v[28:31], v[72:75], v[240:243]
    s_waitcnt lgkmcnt(7)
    v_xor_b32 v72, s35, v60
    v_xor_b32 v73, s35, v61
    v_mfma_f32_16x16x32_bf16 v[244:247], v[28:31], v[40:43], v[244:247]
    v_xor_b32 v74, s35, v62
    v_xor_b32 v75, s35, v63
    s_cmp_eq_u32 s42, 155648
    s_cselect_b32 s42, 0, s42
    v_mfma_f32_16x16x32_bf16 v[248:251], v[28:31], v[76:79], v[248:251]
    v_xor_b32 v76, s35, v68
    v_xor_b32 v77, s35, v69
    v_mfma_f32_16x16x32_bf16 v[252:255], v[28:31], v[48:51], v[252:255]
    v_xor_b32 v78, s35, v70
    v_xor_b32 v79, s35, v71
    s_waitcnt lgkmcnt(5)
    v_mfma_f32_16x16x32_bf16 v[80:83], v[8:11], v[56:59], v[80:83]
    ds_read_b128 v[24:27], v2 offset:4096
    v_mfma_f32_16x16x32_bf16 v[84:87], v[8:11], v[60:63], v[84:87]
    ds_read_b128 v[28:31], v3 offset:4096
    v_mfma_f32_16x16x32_bf16 v[88:91], v[8:11], v[64:67], v[88:91]
    v_lshrrev_b32 v0, 4, v1
    v_and_b32 v5, 15, v0
    v_mfma_f32_16x16x32_bf16 v[92:95], v[8:11], v[68:71], v[92:95]
    v_lshrrev_b32 v0, 4, v0
    s_lshl_b32 s28, s21, 7
    v_mfma_f32_16x16x32_bf16 v[80:83], v[12:15], v[72:75], v[80:83]
    s_lshl_b32 s29, s3, 5
    s_add_u32 s28, s28, s29
    v_mfma_f32_16x16x32_bf16 v[84:87], v[12:15], v[56:59], v[84:87]
    v_add_u32 v5, s28, v5
    v_lshlrev_b32 v5, 2, v5
    v_mfma_f32_16x16x32_bf16 v[88:91], v[12:15], v[76:79], v[88:91]
    v_lshl_add_u32 v5, v0, 13, v5
    v_mfma_f32_16x16x32_bf16 v[92:95], v[12:15], v[64:67], v[92:95]
    s_waitcnt lgkmcnt(5)
    v_mfma_f32_16x16x32_bf16 v[96:99], v[16:19], v[56:59], v[96:99]
    ds_read_b128 v[8:11], v2 offset:8192
    v_mfma_f32_16x16x32_bf16 v[100:103], v[16:19], v[60:63], v[100:103]
    ds_read_b128 v[12:15], v3 offset:8192
    v_mfma_f32_16x16x32_bf16 v[104:107], v[16:19], v[64:67], v[104:107]
    v_mfma_f32_16x16x32_bf16 v[108:111], v[16:19], v[68:71], v[108:111]
    s_mov_b32 s38, 0
    v_cvt_pk_bf16_f32 v48, v80, v84
    buffer_store_dword v48, v5, s[16:19], s38 offen offset:0
    v_cvt_pk_bf16_f32 v49, v88, v92
    buffer_store_dword v49, v5, s[16:19], s38 offen offset:64
    v_mfma_f32_16x16x32_bf16 v[96:99], v[20:23], v[72:75], v[96:99]
    v_cvt_pk_bf16_f32 v50, v81, v85
    buffer_store_dword v50, v5, s[16:19], s38 offen offset:2048
    v_mfma_f32_16x16x32_bf16 v[100:103], v[20:23], v[56:59], v[100:103]
    v_cvt_pk_bf16_f32 v51, v89, v93
    buffer_store_dword v51, v5, s[16:19], s38 offen offset:2112
    v_mfma_f32_16x16x32_bf16 v[104:107], v[20:23], v[76:79], v[104:107]
    s_mov_b32 s38, 4096
    v_cvt_pk_bf16_f32 v52, v82, v86
    buffer_store_dword v52, v5, s[16:19], s38 offen offset:0
    v_cvt_pk_bf16_f32 v53, v90, v94
    buffer_store_dword v53, v5, s[16:19], s38 offen offset:64
    v_mfma_f32_16x16x32_bf16 v[108:111], v[20:23], v[64:67], v[108:111]
    v_cvt_pk_bf16_f32 v54, v83, v87
    buffer_store_dword v54, v5, s[16:19], s38 offen offset:2048
    s_waitcnt lgkmcnt(2)
    v_mfma_f32_16x16x32_bf16 v[112:115], v[24:27], v[56:59], v[112:115]
    ds_read_b128 v[16:19], v2 offset:10240
    v_cvt_pk_bf16_f32 v55, v91, v95
    buffer_store_dword v55, v5, s[16:19], s38 offen offset:2112
    v_mfma_f32_16x16x32_bf16 v[116:119], v[24:27], v[60:63], v[116:119]
    ds_read_b128 v[20:23], v3 offset:10240
    v_mfma_f32_16x16x32_bf16 v[120:123], v[24:27], v[64:67], v[120:123]
    v_mfma_f32_16x16x32_bf16 v[124:127], v[24:27], v[68:71], v[124:127]
    s_mov_b32 s38, 32768
    v_cvt_pk_bf16_f32 v40, v96, v100
    buffer_store_dword v40, v5, s[16:19], s38 offen offset:0
    v_cvt_pk_bf16_f32 v41, v104, v108
    buffer_store_dword v41, v5, s[16:19], s38 offen offset:64
    v_mfma_f32_16x16x32_bf16 v[112:115], v[28:31], v[72:75], v[112:115]
    v_cvt_pk_bf16_f32 v42, v97, v101
    buffer_store_dword v42, v5, s[16:19], s38 offen offset:2048
    v_mfma_f32_16x16x32_bf16 v[116:119], v[28:31], v[56:59], v[116:119]
    v_cvt_pk_bf16_f32 v43, v105, v109
    buffer_store_dword v43, v5, s[16:19], s38 offen offset:2112
    v_mfma_f32_16x16x32_bf16 v[120:123], v[28:31], v[76:79], v[120:123]
    s_mov_b32 s38, 36864
    v_cvt_pk_bf16_f32 v44, v98, v102
    buffer_store_dword v44, v5, s[16:19], s38 offen offset:0
    v_cvt_pk_bf16_f32 v45, v106, v110
    buffer_store_dword v45, v5, s[16:19], s38 offen offset:64
    v_mfma_f32_16x16x32_bf16 v[124:127], v[28:31], v[64:67], v[124:127]
    v_cvt_pk_bf16_f32 v46, v99, v103
    buffer_store_dword v46, v5, s[16:19], s38 offen offset:2048
    v_mfma_f32_16x16x32_bf16 v[128:131], v[32:35], v[56:59], v[128:131]
    ds_read_b128 v[24:27], v2 offset:12288
    v_cvt_pk_bf16_f32 v47, v107, v111
    buffer_store_dword v47, v5, s[16:19], s38 offen offset:2112
    v_mfma_f32_16x16x32_bf16 v[132:135], v[32:35], v[60:63], v[132:135]
    ds_read_b128 v[28:31], v3 offset:12288
    v_mfma_f32_16x16x32_bf16 v[136:139], v[32:35], v[64:67], v[136:139]
    v_mfma_f32_16x16x32_bf16 v[140:143], v[32:35], v[68:71], v[140:143]
    s_mov_b32 s38, 65536
    v_cvt_pk_bf16_f32 v48, v112, v116
    buffer_store_dword v48, v5, s[16:19], s38 offen offset:0
    v_cvt_pk_bf16_f32 v49, v120, v124
    buffer_store_dword v49, v5, s[16:19], s38 offen offset:64
    v_mfma_f32_16x16x32_bf16 v[128:131], v[36:39], v[72:75], v[128:131]
    v_cvt_pk_bf16_f32 v50, v113, v117
    buffer_store_dword v50, v5, s[16:19], s38 offen offset:2048
    v_mfma_f32_16x16x32_bf16 v[132:135], v[36:39], v[56:59], v[132:135]
    v_cvt_pk_bf16_f32 v51, v121, v125
    buffer_store_dword v51, v5, s[16:19], s38 offen offset:2112
    v_mfma_f32_16x16x32_bf16 v[136:139], v[36:39], v[76:79], v[136:139]
    s_mov_b32 s38, 69632
    v_cvt_pk_bf16_f32 v52, v114, v118
    buffer_store_dword v52, v5, s[16:19], s38 offen offset:0
    v_cvt_pk_bf16_f32 v53, v122, v126
    buffer_store_dword v53, v5, s[16:19], s38 offen offset:64
    v_mfma_f32_16x16x32_bf16 v[140:143], v[36:39], v[64:67], v[140:143]
    v_cvt_pk_bf16_f32 v54, v115, v119
    buffer_store_dword v54, v5, s[16:19], s38 offen offset:2048
    s_waitcnt lgkmcnt(4)
    v_mfma_f32_16x16x32_bf16 v[144:147], v[8:11], v[56:59], v[144:147]
    ds_read_b128 v[32:35], v2 offset:14336
    v_cvt_pk_bf16_f32 v55, v123, v127
    buffer_store_dword v55, v5, s[16:19], s38 offen offset:2112
    v_mfma_f32_16x16x32_bf16 v[148:151], v[8:11], v[60:63], v[148:151]
    ds_read_b128 v[36:39], v3 offset:14336
    v_mfma_f32_16x16x32_bf16 v[152:155], v[8:11], v[64:67], v[152:155]
    v_mfma_f32_16x16x32_bf16 v[156:159], v[8:11], v[68:71], v[156:159]
    s_mov_b32 s38, 98304
    v_cvt_pk_bf16_f32 v40, v128, v132
    buffer_store_dword v40, v5, s[16:19], s38 offen offset:0
    v_cvt_pk_bf16_f32 v41, v136, v140
    buffer_store_dword v41, v5, s[16:19], s38 offen offset:64
    v_mfma_f32_16x16x32_bf16 v[144:147], v[12:15], v[72:75], v[144:147]
    v_cvt_pk_bf16_f32 v42, v129, v133
    buffer_store_dword v42, v5, s[16:19], s38 offen offset:2048
    v_mfma_f32_16x16x32_bf16 v[148:151], v[12:15], v[56:59], v[148:151]
    v_cvt_pk_bf16_f32 v43, v137, v141
    buffer_store_dword v43, v5, s[16:19], s38 offen offset:2112
    v_mfma_f32_16x16x32_bf16 v[152:155], v[12:15], v[76:79], v[152:155]
    s_mov_b32 s38, 102400
    v_cvt_pk_bf16_f32 v44, v130, v134
    buffer_store_dword v44, v5, s[16:19], s38 offen offset:0
    v_cvt_pk_bf16_f32 v45, v138, v142
    buffer_store_dword v45, v5, s[16:19], s38 offen offset:64
    v_mfma_f32_16x16x32_bf16 v[156:159], v[12:15], v[64:67], v[156:159]
    v_cvt_pk_bf16_f32 v46, v131, v135
    buffer_store_dword v46, v5, s[16:19], s38 offen offset:2048
    s_waitcnt lgkmcnt(4)
    v_mfma_f32_16x16x32_bf16 v[160:163], v[16:19], v[56:59], v[160:163]
    ds_read_b128 v[8:11], v2 offset:16384
    v_cvt_pk_bf16_f32 v47, v139, v143
    buffer_store_dword v47, v5, s[16:19], s38 offen offset:2112
    v_mfma_f32_16x16x32_bf16 v[164:167], v[16:19], v[60:63], v[164:167]
    ds_read_b128 v[12:15], v3 offset:16384
    v_mfma_f32_16x16x32_bf16 v[168:171], v[16:19], v[64:67], v[168:171]
    v_mfma_f32_16x16x32_bf16 v[172:175], v[16:19], v[68:71], v[172:175]
    s_mov_b32 s38, 131072
    v_cvt_pk_bf16_f32 v48, v144, v148
    buffer_store_dword v48, v5, s[16:19], s38 offen offset:0
    v_cvt_pk_bf16_f32 v49, v152, v156
    buffer_store_dword v49, v5, s[16:19], s38 offen offset:64
    v_mfma_f32_16x16x32_bf16 v[160:163], v[20:23], v[72:75], v[160:163]
    v_cvt_pk_bf16_f32 v50, v145, v149
    buffer_store_dword v50, v5, s[16:19], s38 offen offset:2048
    v_mfma_f32_16x16x32_bf16 v[164:167], v[20:23], v[56:59], v[164:167]
    v_cvt_pk_bf16_f32 v51, v153, v157
    buffer_store_dword v51, v5, s[16:19], s38 offen offset:2112
    v_mfma_f32_16x16x32_bf16 v[168:171], v[20:23], v[76:79], v[168:171]
    s_mov_b32 s38, 135168
    v_cvt_pk_bf16_f32 v52, v146, v150
    buffer_store_dword v52, v5, s[16:19], s38 offen offset:0
    v_cvt_pk_bf16_f32 v53, v154, v158
    buffer_store_dword v53, v5, s[16:19], s38 offen offset:64
    v_mfma_f32_16x16x32_bf16 v[172:175], v[20:23], v[64:67], v[172:175]
    v_cvt_pk_bf16_f32 v54, v147, v151
    buffer_store_dword v54, v5, s[16:19], s38 offen offset:2048
    s_waitcnt lgkmcnt(4)
    v_mfma_f32_16x16x32_bf16 v[176:179], v[24:27], v[56:59], v[176:179]
    ds_read_b128 v[16:19], v2 offset:18432
    v_cvt_pk_bf16_f32 v55, v155, v159
    buffer_store_dword v55, v5, s[16:19], s38 offen offset:2112
    v_mfma_f32_16x16x32_bf16 v[180:183], v[24:27], v[60:63], v[180:183]
    ds_read_b128 v[20:23], v3 offset:18432
    v_mfma_f32_16x16x32_bf16 v[184:187], v[24:27], v[64:67], v[184:187]
    v_mfma_f32_16x16x32_bf16 v[188:191], v[24:27], v[68:71], v[188:191]
    s_mov_b32 s38, 163840
    v_cvt_pk_bf16_f32 v40, v160, v164
    buffer_store_dword v40, v5, s[16:19], s38 offen offset:0
    v_cvt_pk_bf16_f32 v41, v168, v172
    buffer_store_dword v41, v5, s[16:19], s38 offen offset:64
    v_mfma_f32_16x16x32_bf16 v[176:179], v[28:31], v[72:75], v[176:179]
    v_cvt_pk_bf16_f32 v42, v161, v165
    buffer_store_dword v42, v5, s[16:19], s38 offen offset:2048
    v_mfma_f32_16x16x32_bf16 v[180:183], v[28:31], v[56:59], v[180:183]
    v_cvt_pk_bf16_f32 v43, v169, v173
    buffer_store_dword v43, v5, s[16:19], s38 offen offset:2112
    v_mfma_f32_16x16x32_bf16 v[184:187], v[28:31], v[76:79], v[184:187]
    s_mov_b32 s38, 167936
    v_cvt_pk_bf16_f32 v44, v162, v166
    buffer_store_dword v44, v5, s[16:19], s38 offen offset:0
    v_cvt_pk_bf16_f32 v45, v170, v174
    buffer_store_dword v45, v5, s[16:19], s38 offen offset:64
    v_mfma_f32_16x16x32_bf16 v[188:191], v[28:31], v[64:67], v[188:191]
    v_cvt_pk_bf16_f32 v46, v163, v167
    buffer_store_dword v46, v5, s[16:19], s38 offen offset:2048
    s_waitcnt lgkmcnt(4)
    v_mfma_f32_16x16x32_bf16 v[192:195], v[32:35], v[56:59], v[192:195]
    ds_read_b128 v[24:27], v2 offset:20480
    v_cvt_pk_bf16_f32 v47, v171, v175
    buffer_store_dword v47, v5, s[16:19], s38 offen offset:2112
    v_mfma_f32_16x16x32_bf16 v[196:199], v[32:35], v[60:63], v[196:199]
    ds_read_b128 v[28:31], v3 offset:20480
    v_mfma_f32_16x16x32_bf16 v[200:203], v[32:35], v[64:67], v[200:203]
    v_mfma_f32_16x16x32_bf16 v[204:207], v[32:35], v[68:71], v[204:207]
    s_mov_b32 s38, 196608
    v_cvt_pk_bf16_f32 v48, v176, v180
    buffer_store_dword v48, v5, s[16:19], s38 offen offset:0
    v_cvt_pk_bf16_f32 v49, v184, v188
    buffer_store_dword v49, v5, s[16:19], s38 offen offset:64
    v_mfma_f32_16x16x32_bf16 v[192:195], v[36:39], v[72:75], v[192:195]
    v_cvt_pk_bf16_f32 v50, v177, v181
    buffer_store_dword v50, v5, s[16:19], s38 offen offset:2048
    v_mfma_f32_16x16x32_bf16 v[196:199], v[36:39], v[56:59], v[196:199]
    v_cvt_pk_bf16_f32 v51, v185, v189
    buffer_store_dword v51, v5, s[16:19], s38 offen offset:2112
    v_mfma_f32_16x16x32_bf16 v[200:203], v[36:39], v[76:79], v[200:203]
    s_mov_b32 s38, 200704
    v_cvt_pk_bf16_f32 v52, v178, v182
    buffer_store_dword v52, v5, s[16:19], s38 offen offset:0
    v_cvt_pk_bf16_f32 v53, v186, v190
    buffer_store_dword v53, v5, s[16:19], s38 offen offset:64
    v_mfma_f32_16x16x32_bf16 v[204:207], v[36:39], v[64:67], v[204:207]
    v_cvt_pk_bf16_f32 v54, v179, v183
    buffer_store_dword v54, v5, s[16:19], s38 offen offset:2048
    s_waitcnt lgkmcnt(4)
    v_mfma_f32_16x16x32_bf16 v[208:211], v[8:11], v[56:59], v[208:211]
    v_cvt_pk_bf16_f32 v55, v187, v191
    buffer_store_dword v55, v5, s[16:19], s38 offen offset:2112
    v_mfma_f32_16x16x32_bf16 v[212:215], v[8:11], v[60:63], v[212:215]
    v_mfma_f32_16x16x32_bf16 v[216:219], v[8:11], v[64:67], v[216:219]
    v_mfma_f32_16x16x32_bf16 v[220:223], v[8:11], v[68:71], v[220:223]
    s_mov_b32 s38, 229376
    v_cvt_pk_bf16_f32 v40, v192, v196
    buffer_store_dword v40, v5, s[16:19], s38 offen offset:0
    v_cvt_pk_bf16_f32 v41, v200, v204
    buffer_store_dword v41, v5, s[16:19], s38 offen offset:64
    v_mfma_f32_16x16x32_bf16 v[208:211], v[12:15], v[72:75], v[208:211]
    v_cvt_pk_bf16_f32 v42, v193, v197
    buffer_store_dword v42, v5, s[16:19], s38 offen offset:2048
    v_mfma_f32_16x16x32_bf16 v[212:215], v[12:15], v[56:59], v[212:215]
    v_cvt_pk_bf16_f32 v43, v201, v205
    buffer_store_dword v43, v5, s[16:19], s38 offen offset:2112
    v_mfma_f32_16x16x32_bf16 v[216:219], v[12:15], v[76:79], v[216:219]
    s_mov_b32 s38, 233472
    v_cvt_pk_bf16_f32 v44, v194, v198
    buffer_store_dword v44, v5, s[16:19], s38 offen offset:0
    v_cvt_pk_bf16_f32 v45, v202, v206
    buffer_store_dword v45, v5, s[16:19], s38 offen offset:64
    v_mfma_f32_16x16x32_bf16 v[220:223], v[12:15], v[64:67], v[220:223]
    v_cvt_pk_bf16_f32 v46, v195, v199
    buffer_store_dword v46, v5, s[16:19], s38 offen offset:2048
    s_waitcnt lgkmcnt(2)
    v_mfma_f32_16x16x32_bf16 v[224:227], v[16:19], v[56:59], v[224:227]
    v_cvt_pk_bf16_f32 v47, v203, v207
    buffer_store_dword v47, v5, s[16:19], s38 offen offset:2112
    v_mfma_f32_16x16x32_bf16 v[228:231], v[16:19], v[60:63], v[228:231]
    v_mfma_f32_16x16x32_bf16 v[232:235], v[16:19], v[64:67], v[232:235]
    v_mfma_f32_16x16x32_bf16 v[236:239], v[16:19], v[68:71], v[236:239]
    s_mov_b32 s38, 262144
    v_cvt_pk_bf16_f32 v48, v208, v212
    buffer_store_dword v48, v5, s[16:19], s38 offen offset:0
    v_cvt_pk_bf16_f32 v49, v216, v220
    buffer_store_dword v49, v5, s[16:19], s38 offen offset:64
    v_mfma_f32_16x16x32_bf16 v[224:227], v[20:23], v[72:75], v[224:227]
    v_cvt_pk_bf16_f32 v50, v209, v213
    buffer_store_dword v50, v5, s[16:19], s38 offen offset:2048
    v_mfma_f32_16x16x32_bf16 v[228:231], v[20:23], v[56:59], v[228:231]
    v_cvt_pk_bf16_f32 v51, v217, v221
    buffer_store_dword v51, v5, s[16:19], s38 offen offset:2112
    v_mfma_f32_16x16x32_bf16 v[232:235], v[20:23], v[76:79], v[232:235]
    s_mov_b32 s38, 266240
    v_cvt_pk_bf16_f32 v52, v210, v214
    buffer_store_dword v52, v5, s[16:19], s38 offen offset:0
    v_cvt_pk_bf16_f32 v53, v218, v222
    buffer_store_dword v53, v5, s[16:19], s38 offen offset:64
    v_mfma_f32_16x16x32_bf16 v[236:239], v[20:23], v[64:67], v[236:239]
    v_cvt_pk_bf16_f32 v54, v211, v215
    buffer_store_dword v54, v5, s[16:19], s38 offen offset:2048
    s_waitcnt lgkmcnt(0)
    v_mfma_f32_16x16x32_bf16 v[240:243], v[24:27], v[56:59], v[240:243]
    v_cvt_pk_bf16_f32 v55, v219, v223
    buffer_store_dword v55, v5, s[16:19], s38 offen offset:2112
    v_mfma_f32_16x16x32_bf16 v[244:247], v[24:27], v[60:63], v[244:247]
    v_mfma_f32_16x16x32_bf16 v[248:251], v[24:27], v[64:67], v[248:251]
    v_mfma_f32_16x16x32_bf16 v[252:255], v[24:27], v[68:71], v[252:255]
    s_mov_b32 s38, 294912
    v_cvt_pk_bf16_f32 v40, v224, v228
    buffer_store_dword v40, v5, s[16:19], s38 offen offset:0
    v_cvt_pk_bf16_f32 v41, v232, v236
    buffer_store_dword v41, v5, s[16:19], s38 offen offset:64
    v_mfma_f32_16x16x32_bf16 v[240:243], v[28:31], v[72:75], v[240:243]
    v_cvt_pk_bf16_f32 v42, v225, v229
    buffer_store_dword v42, v5, s[16:19], s38 offen offset:2048
    v_mfma_f32_16x16x32_bf16 v[244:247], v[28:31], v[56:59], v[244:247]
    v_cvt_pk_bf16_f32 v43, v233, v237
    buffer_store_dword v43, v5, s[16:19], s38 offen offset:2112
    v_mfma_f32_16x16x32_bf16 v[248:251], v[28:31], v[76:79], v[248:251]
    s_mov_b32 s38, 299008
    v_cvt_pk_bf16_f32 v44, v226, v230
    buffer_store_dword v44, v5, s[16:19], s38 offen offset:0
    v_cvt_pk_bf16_f32 v45, v234, v238
    buffer_store_dword v45, v5, s[16:19], s38 offen offset:64
    v_mfma_f32_16x16x32_bf16 v[252:255], v[28:31], v[64:67], v[252:255]
    v_cvt_pk_bf16_f32 v46, v227, v231
    buffer_store_dword v46, v5, s[16:19], s38 offen offset:2048
    v_cvt_pk_bf16_f32 v47, v235, v239
    buffer_store_dword v47, v5, s[16:19], s38 offen offset:2112
    s_nop 7
    s_mov_b32 s38, 327680
    v_cvt_pk_bf16_f32 v8, v240, v244
    buffer_store_dword v8, v5, s[16:19], s38 offen offset:0
    v_cvt_pk_bf16_f32 v9, v248, v252
    buffer_store_dword v9, v5, s[16:19], s38 offen offset:64
    v_cvt_pk_bf16_f32 v10, v241, v245
    buffer_store_dword v10, v5, s[16:19], s38 offen offset:2048
    v_cvt_pk_bf16_f32 v11, v249, v253
    buffer_store_dword v11, v5, s[16:19], s38 offen offset:2112
    s_mov_b32 s38, 331776
    v_cvt_pk_bf16_f32 v12, v242, v246
    buffer_store_dword v12, v5, s[16:19], s38 offen offset:0
    v_cvt_pk_bf16_f32 v13, v250, v254
    buffer_store_dword v13, v5, s[16:19], s38 offen offset:64
    v_cvt_pk_bf16_f32 v14, v243, v247
    buffer_store_dword v14, v5, s[16:19], s38 offen offset:2048
    v_cvt_pk_bf16_f32 v15, v251, v255
    buffer_store_dword v15, v5, s[16:19], s38 offen offset:2112
    s_endpgm
K12_S0:
    s_mov_b32 s61, 4096
    s_add_u32 s62, s62, 1
K12_S0_L:
    ds_read_b32 v56, v5
    s_waitcnt lgkmcnt(0)
    v_cmp_gt_u32 vcc, s40, v56
    s_sub_u32 s61, s61, 1
    s_cmp_eq_u32 s61, 0
    s_cbranch_scc1 K12_Q0
    s_cbranch_vccz K12_Q0
    s_branch K12_S0_L
K12_S1:
    s_mov_b32 s61, 4096
    s_add_u32 s62, s62, 1
K12_S1_L:
    ds_read_b32 v60, v5
    s_waitcnt lgkmcnt(0)
    v_cmp_gt_u32 vcc, s40, v60
    s_sub_u32 s61, s61, 1
    s_cmp_eq_u32 s61, 0
    s_cbranch_scc1 K12_Q1
    s_cbranch_vccz K12_Q1
    s_branch K12_S1_L
K12_F2:
    s_mov_b32 s61, 4096
    s_add_u32 s63, s63, 1
K12_F2_L:
    s_mov_b32 m0, s46
    s_mov_b64 exec, 0xff
    buffer_load_dword v1, s[4:7], 0 offen sc1 lds
    s_mov_b64 exec, -1
    s_waitcnt vmcnt(0)
    v_mov_b32 v0, s48
    ds_read_b32 v0, v0
    s_waitcnt lgkmcnt(0)
    v_cmp_eq_u32 vcc, 0, v0
    s_sub_u32 s61, s61, 1
    s_cmp_eq_u32 s61, 0
    s_cbranch_scc1 K12_F2_X
    s_cbranch_vccz K12_F2_X
    s_sleep 2
    s_branch K12_F2_L
K12_F2_X:
    s_branch K12_G2
K12_S3:
    s_mov_b32 s61, 4096
    s_add_u32 s62, s62, 1
K12_S3_L:
    ds_read_b32 v56, v5
    s_waitcnt lgkmcnt(0)
    v_cmp_gt_u32 vcc, s51, v56
    s_sub_u32 s61, s61, 1
    s_cmp_eq_u32 s61, 0
    s_cbranch_scc1 K12_Q3
    s_cbranch_vccz K12_Q3
    s_branch K12_S3_L
K12_S4:
    s_mov_b32 s61, 4096
    s_add_u32 s62, s62, 1
K12_S4_L:
    ds_read_b32 v44, v5
    s_waitcnt lgkmcnt(0)
    v_cmp_gt_u32 vcc, s40, v44
    s_sub_u32 s61, s61, 1
    s_cmp_eq_u32 s61, 0
    s_cbranch_scc1 K12_Q4
    s_cbranch_vccz K12_Q4
    s_branch K12_S4_L
K12_S5:
    s_mov_b32 s61, 4096
    s_add_u32 s62, s62, 1
K12_S5_L:
    ds_read_b32 v40, v5
    s_waitcnt lgkmcnt(0)
    v_cmp_gt_u32 vcc, s51, v40
    s_sub_u32 s61, s61, 1
    s_cmp_eq_u32 s61, 0
    s_cbranch_scc1 K12_Q5
    s_cbranch_vccz K12_Q5
    s_branch K12_S5_L
K12_S6:
    s_mov_b32 s61, 4096
    s_add_u32 s62, s62, 1
K12_S6_L:
    ds_read_b32 v60, v5
    s_waitcnt lgkmcnt(0)
    v_cmp_gt_u32 vcc, s40, v60
    s_sub_u32 s61, s61, 1
    s_cmp_eq_u32 s61, 0
    s_cbranch_scc1 K12_Q6
    s_cbranch_vccz K12_Q6
    s_branch K12_S6_L
K12_F7:
    s_mov_b32 s61, 4096
    s_add_u32 s63, s63, 1
K12_F7_L:
    s_mov_b32 m0, s46
    s_mov_b64 exec, 0xff
    buffer_load_dword v1, s[4:7], 0 offen sc1 lds
    s_mov_b64 exec, -1
    s_waitcnt vmcnt(0)
    v_mov_b32 v0, s48
    ds_read_b32 v0, v0
    s_waitcnt lgkmcnt(0)
    v_cmp_eq_u32 vcc, 0, v0
    s_sub_u32 s61, s61, 1
    s_cmp_eq_u32 s61, 0
    s_cbranch_scc1 K12_F7_X
    s_cbranch_vccz K12_F7_X
    s_sleep 2
    s_branch K12_F7_L
K12_F7_X:
    s_branch K12_G7
K12_S8:
    s_mov_b32 s61, 4096
    s_add_u32 s62, s62, 1
K12_S8_L:
    ds_read_b32 v56, v5
    s_waitcnt lgkmcnt(0)
    v_cmp_gt_u32 vcc, s51, v56
    s_sub_u32 s61, s61, 1
    s_cmp_eq_u32 s61, 0
    s_cbranch_scc1 K12_Q8
    s_cbranch_vccz K12_Q8
    s_branch K12_S8_L
K12_END:
    s_endpgm
.p2align 8
.type k34_out_kernel,@function
k34_out_kernel:
    s_cmp_ge_u32 s2, 256
    s_cbranch_scc1 K34_END
    s_load_dwordx2 s[4:5], s[0:1], 48
    s_load_dwordx4 s[40:43], s[0:1], 16
    s_load_dwordx2 s[44:45], s[0:1], 32
    v_lshrrev_b32 v1, 6, v0
    v_and_b32 v2, 63, v0
    v_readfirstlane_b32 s3, v1
    s_and_b32 s6, s2, 15
    s_lshr_b32 s7, s2, 4
    s_lshr_b32 s20, s6, 3
    s_and_b32 s21, s6, 7
    s_mul_i32 s22, s7, 11
    s_mul_i32 s23, s7, 10
    s_add_u32 s23, s23, 7
    s_cmp_lt_u32 s7, 7
    s_cselect_b32 s22, s22, s23
    s_cselect_b32 s23, 11, 10
    s_add_u32 s22, s22, s3
    v_and_b32 v3, 15, v2
    v_lshrrev_b32 v4, 4, v2
    v_lshlrev_b32 v5, 4, v2
    s_mov_b32 s24, 2736128
    v_mul_lo_u32 v6, v4, s24
    v_lshl_add_u32 v6, v3, 4, v6
    s_mul_i32 s25, s20, 167
    s_add_u32 s25, s25, s22
    s_lshl_b32 s25, s25, 11
    s_lshl_b32 s24, s21, 8
    s_add_u32 s25, s25, s24
    s_waitcnt lgkmcnt(0)
    s_add_u32 s8, s4, 118489088
    s_addc_u32 s9, s5, 0
    s_and_b32 s9, s9, 0xffff
    s_mov_b32 s10, 21889024
    s_mov_b32 s11, 0x00020000
    s_add_u32 s12, s4, 153616384
    s_addc_u32 s13, s5, 0
    s_and_b32 s13, s13, 0xffff
    s_mov_b32 s14, 131072
    s_mov_b32 s15, 0x00020000
    s_cmp_lt_u32 s3, s23
    s_cbranch_scc0 K34_NOLOAD
    buffer_load_dwordx4 v[16:19], v6, s[8:11], s25 offen
    s_add_u32 s25, s25, 684032
    buffer_load_dwordx4 v[20:23], v6, s[8:11], s25 offen
    s_add_u32 s25, s25, 684032
    buffer_load_dwordx4 v[24:27], v6, s[8:11], s25 offen
    s_add_u32 s25, s25, 684032
    buffer_load_dwordx4 v[28:31], v6, s[8:11], s25 offen
    s_add_u32 s25, s25, 8892416
    buffer_load_dwordx4 v[32:35], v6, s[8:11], s25 offen
    s_add_u32 s25, s25, 684032
    buffer_load_dwordx4 v[36:39], v6, s[8:11], s25 offen
    s_add_u32 s25, s25, 684032
    buffer_load_dwordx4 v[40:43], v6, s[8:11], s25 offen
    s_add_u32 s25, s25, 684032
    buffer_load_dwordx4 v[44:47], v6, s[8:11], s25 offen
K34_NOLOAD:
    s_cmp_lg_u32 s3, 0
    s_cbranch_scc1 K34_TAB
    s_mov_b32 s16, s40
    s_mov_b32 s17, s41
    s_and_b32 s17, s17, 0xffff
    s_mov_b32 s18, 1024
    s_mov_b32 s19, 0x00020000
    s_mov_b32 s28, s42
    s_mov_b32 s29, s43
    s_and_b32 s29, s29, 0xffff
    s_mov_b32 s30, 1024
    s_mov_b32 s31, 0x00020000
    s_lshl_b32 s24, s21, 7
    v_lshlrev_b32 v8, 1, v2
    buffer_load_ushort v152, v8, s[16:19], s24 offen
    buffer_load_ushort v153, v8, s[28:31], s24 offen
    s_branch K34_TABDONE
K34_TAB:
    s_cmp_ge_u32 s3, 7
    s_cbranch_scc1 K34_TABDONE
    s_sub_u32 s27, s3, 1
    s_lshr_b32 s28, s27, 1
    s_and_b32 s29, s27, 1
    s_lshl_b32 s30, s28, 4
    v_add_u32 v8, s30, v3
    s_lshl_b32 s30, s29, 5
    s_add_u32 s30, s30, 1
    v_lshlrev_b32 v9, 3, v4
    v_add_u32 v9, s30, v9
    v_mul_u32_u24 v9, v8, v9
    v_lshlrev_b32 v8, 1, v8
    v_mad_u32_u24 v48, v8, 0, v9
    v_mad_u32_u24 v49, v8, 0, v9
    v_add_u32 v49, 32, v49
    v_mad_u32_u24 v50, v8, 1, v9
    v_mad_u32_u24 v51, v8, 1, v9
    v_add_u32 v51, 32, v51
    v_mad_u32_u24 v52, v8, 2, v9
    v_mad_u32_u24 v53, v8, 2, v9
    v_add_u32 v53, 32, v53
    v_mad_u32_u24 v54, v8, 3, v9
    v_mad_u32_u24 v55, v8, 3, v9
    v_add_u32 v55, 32, v55
    v_and_b32 v48, 127, v48
    v_and_b32 v49, 127, v49
    v_and_b32 v50, 127, v50
    v_and_b32 v51, 127, v51
    v_and_b32 v52, 127, v52
    v_and_b32 v53, 127, v53
    v_and_b32 v54, 127, v54
    v_and_b32 v55, 127, v55
    v_cvt_f32_u32 v48, v48
    v_cvt_f32_u32 v49, v49
    v_cvt_f32_u32 v50, v50
    v_cvt_f32_u32 v51, v51
    v_cvt_f32_u32 v52, v52
    v_cvt_f32_u32 v53, v53
    v_cvt_f32_u32 v54, v54
    v_cvt_f32_u32 v55, v55
    v_mul_f32 v48, 0x3c000000, v48
    v_mul_f32 v49, 0x3c000000, v49
    v_mul_f32 v50, 0x3c000000, v50
    v_mul_f32 v51, 0x3c000000, v51
    v_mul_f32 v52, 0x3c000000, v52
    v_mul_f32 v53, 0x3c000000, v53
    v_mul_f32 v54, 0x3c000000, v54
    v_mul_f32 v55, 0x3c000000, v55
    v_cos_f32 v48, v48
    v_cos_f32 v49, v49
    v_cos_f32 v50, v50
    v_cos_f32 v51, v51
    v_cos_f32 v52, v52
    v_cos_f32 v53, v53
    v_cos_f32 v54, v54
    v_cos_f32 v55, v55
    s_nop 0
    v_mul_f32 v48, 0x3d000000, v48
    v_mul_f32 v49, 0x3d000000, v49
    v_mul_f32 v50, 0x3d000000, v50
    v_mul_f32 v51, 0x3d000000, v51
    v_mul_f32 v52, 0x3d000000, v52
    v_mul_f32 v53, 0x3d000000, v53
    v_mul_f32 v54, 0x3d000000, v54
    v_mul_f32 v55, 0x3d000000, v55
    v_cvt_pk_bf16_f32 v56, v48, v49
    v_cvt_pk_bf16_f32 v57, v50, v51
    v_cvt_pk_bf16_f32 v58, v52, v53
    v_cvt_pk_bf16_f32 v59, v54, v55
    v_lshlrev_b32 v64, 16, v56
    v_and_b32 v65, 0xffff0000, v56
    v_sub_f32 v48, v48, v64
    v_sub_f32 v49, v49, v65
    v_lshlrev_b32 v64, 16, v57
    v_and_b32 v65, 0xffff0000, v57
    v_sub_f32 v50, v50, v64
    v_sub_f32 v51, v51, v65
    v_lshlrev_b32 v64, 16, v58
    v_and_b32 v65, 0xffff0000, v58
    v_sub_f32 v52, v52, v64
    v_sub_f32 v53, v53, v65
    v_lshlrev_b32 v64, 16, v59
    v_and_b32 v65, 0xffff0000, v59
    v_sub_f32 v54, v54, v64
    v_sub_f32 v55, v55, v65
    v_cvt_pk_bf16_f32 v60, v48, v49
    v_cvt_pk_bf16_f32 v61, v50, v51
    v_cvt_pk_bf16_f32 v62, v52, v53
    v_cvt_pk_bf16_f32 v63, v54, v55
    s_lshl_b32 s30, s27, 11
    v_add_u32 v10, s30, v5
    ds_write_b128 v10, v[56:59]
    ds_write_b128 v10, v[60:63] offset:1024
K34_TABDONE:
    s_waitcnt lgkmcnt(0)
    s_barrier
    s_cmp_lt_u32 s3, s23
    s_cbranch_scc0 K34_IDLE
    ds_read_b128 v[48:51], v5 offset:0
    ds_read_b128 v[52:55], v5 offset:1024
    ds_read_b128 v[56:59], v5 offset:2048
    ds_read_b128 v[60:63], v5 offset:3072
    ds_read_b128 v[64:67], v5 offset:4096
    ds_read_b128 v[68:71], v5 offset:5120
    ds_read_b128 v[72:75], v5 offset:6144
    ds_read_b128 v[76:79], v5 offset:7168
    ds_read_b128 v[80:83], v5 offset:8192
    ds_read_b128 v[84:87], v5 offset:9216
    ds_read_b128 v[88:91], v5 offset:10240
    ds_read_b128 v[92:95], v5 offset:11264
    s_waitcnt vmcnt(0)
    v_swap_b32 v17, v20
    v_swap_b32 v18, v24
    v_swap_b32 v19, v28
    v_swap_b32 v22, v25
    v_swap_b32 v23, v29
    v_swap_b32 v27, v30
    v_swap_b32 v33, v36
    v_swap_b32 v34, v40
    v_swap_b32 v35, v44
    v_swap_b32 v38, v41
    v_swap_b32 v39, v45
    v_swap_b32 v43, v46
    s_waitcnt lgkmcnt(0)
    s_mul_i32 s24, s22, 48
    s_sub_u32 s24, 7985, s24
    s_cmp_ge_u32 s24, 48
    s_cbranch_scc1 K34_FULL
    v_add_u32 v7, 0, v3
    v_cmp_gt_u32 vcc, s24, v7
    s_nop 1
    v_cndmask_b32 v48, 0, v48, vcc
    v_cndmask_b32 v49, 0, v49, vcc
    v_cndmask_b32 v50, 0, v50, vcc
    v_cndmask_b32 v51, 0, v51, vcc
    v_cndmask_b32 v52, 0, v52, vcc
    v_cndmask_b32 v53, 0, v53, vcc
    v_cndmask_b32 v54, 0, v54, vcc
    v_cndmask_b32 v55, 0, v55, vcc
    v_cndmask_b32 v56, 0, v56, vcc
    v_cndmask_b32 v57, 0, v57, vcc
    v_cndmask_b32 v58, 0, v58, vcc
    v_cndmask_b32 v59, 0, v59, vcc
    v_cndmask_b32 v60, 0, v60, vcc
    v_cndmask_b32 v61, 0, v61, vcc
    v_cndmask_b32 v62, 0, v62, vcc
    v_cndmask_b32 v63, 0, v63, vcc
    v_add_u32 v7, 16, v3
    v_cmp_gt_u32 vcc, s24, v7
    s_nop 1
    v_cndmask_b32 v64, 0, v64, vcc
    v_cndmask_b32 v65, 0, v65, vcc
    v_cndmask_b32 v66, 0, v66, vcc
    v_cndmask_b32 v67, 0, v67, vcc
    v_cndmask_b32 v68, 0, v68, vcc
    v_cndmask_b32 v69, 0, v69, vcc
    v_cndmask_b32 v70, 0, v70, vcc
    v_cndmask_b32 v71, 0, v71, vcc
    v_cndmask_b32 v72, 0, v72, vcc
    v_cndmask_b32 v73, 0, v73, vcc
    v_cndmask_b32 v74, 0, v74, vcc
    v_cndmask_b32 v75, 0, v75, vcc
    v_cndmask_b32 v76, 0, v76, vcc
    v_cndmask_b32 v77, 0, v77, vcc
    v_cndmask_b32 v78, 0, v78, vcc
    v_cndmask_b32 v79, 0, v79, vcc
    v_add_u32 v7, 32, v3
    v_cmp_gt_u32 vcc, s24, v7
    s_nop 1
    v_cndmask_b32 v80, 0, v80, vcc
    v_cndmask_b32 v81, 0, v81, vcc
    v_cndmask_b32 v82, 0, v82, vcc
    v_cndmask_b32 v83, 0, v83, vcc
    v_cndmask_b32 v84, 0, v84, vcc
    v_cndmask_b32 v85, 0, v85, vcc
    v_cndmask_b32 v86, 0, v86, vcc
    v_cndmask_b32 v87, 0, v87, vcc
    v_cndmask_b32 v88, 0, v88, vcc
    v_cndmask_b32 v89, 0, v89, vcc
    v_cndmask_b32 v90, 0, v90, vcc
    v_cndmask_b32 v91, 0, v91, vcc
    v_cndmask_b32 v92, 0, v92, vcc
    v_cndmask_b32 v93, 0, v93, vcc
    v_cndmask_b32 v94, 0, v94, vcc
    v_cndmask_b32 v95, 0, v95, vcc
K34_FULL:
    s_nop 1
    v_mfma_f32_16x16x32_bf16 v[96:99], v[48:51], v[16:19], 0
    v_mfma_f32_16x16x32_bf16 v[100:103], v[48:51], v[20:23], 0
    v_mfma_f32_16x16x32_bf16 v[104:107], v[48:51], v[24:27], 0
    v_mfma_f32_16x16x32_bf16 v[108:111], v[48:51], v[28:31], 0
    v_mfma_f32_16x16x32_bf16 v[96:99], v[52:55], v[16:19], v[96:99]
    v_mfma_f32_16x16x32_bf16 v[100:103], v[52:55], v[20:23], v[100:103]
    v_mfma_f32_16x16x32_bf16 v[104:107], v[52:55], v[24:27], v[104:107]
    v_mfma_f32_16x16x32_bf16 v[108:111], v[52:55], v[28:31], v[108:111]
    v_mfma_f32_16x16x32_bf16 v[96:99], v[56:59], v[32:35], v[96:99]
    v_mfma_f32_16x16x32_bf16 v[100:103], v[56:59], v[36:39], v[100:103]
    v_mfma_f32_16x16x32_bf16 v[104:107], v[56:59], v[40:43], v[104:107]
    v_mfma_f32_16x16x32_bf16 v[108:111], v[56:59], v[44:47], v[108:111]
    v_mfma_f32_16x16x32_bf16 v[96:99], v[60:63], v[32:35], v[96:99]
    v_mfma_f32_16x16x32_bf16 v[100:103], v[60:63], v[36:39], v[100:103]
    v_mfma_f32_16x16x32_bf16 v[104:107], v[60:63], v[40:43], v[104:107]
    v_mfma_f32_16x16x32_bf16 v[108:111], v[60:63], v[44:47], v[108:111]
    v_mfma_f32_16x16x32_bf16 v[112:115], v[64:67], v[16:19], 0
    v_mfma_f32_16x16x32_bf16 v[116:119], v[64:67], v[20:23], 0
    v_mfma_f32_16x16x32_bf16 v[120:123], v[64:67], v[24:27], 0
    v_mfma_f32_16x16x32_bf16 v[124:127], v[64:67], v[28:31], 0
    v_mfma_f32_16x16x32_bf16 v[112:115], v[68:71], v[16:19], v[112:115]
    v_mfma_f32_16x16x32_bf16 v[116:119], v[68:71], v[20:23], v[116:119]
    v_mfma_f32_16x16x32_bf16 v[120:123], v[68:71], v[24:27], v[120:123]
    v_mfma_f32_16x16x32_bf16 v[124:127], v[68:71], v[28:31], v[124:127]
    v_mfma_f32_16x16x32_bf16 v[112:115], v[72:75], v[32:35], v[112:115]
    v_mfma_f32_16x16x32_bf16 v[116:119], v[72:75], v[36:39], v[116:119]
    v_mfma_f32_16x16x32_bf16 v[120:123], v[72:75], v[40:43], v[120:123]
    v_mfma_f32_16x16x32_bf16 v[124:127], v[72:75], v[44:47], v[124:127]
    v_mfma_f32_16x16x32_bf16 v[112:115], v[76:79], v[32:35], v[112:115]
    v_mfma_f32_16x16x32_bf16 v[116:119], v[76:79], v[36:39], v[116:119]
    v_mfma_f32_16x16x32_bf16 v[120:123], v[76:79], v[40:43], v[120:123]
    v_mfma_f32_16x16x32_bf16 v[124:127], v[76:79], v[44:47], v[124:127]
    v_mfma_f32_16x16x32_bf16 v[128:131], v[80:83], v[16:19], 0
    v_mfma_f32_16x16x32_bf16 v[132:135], v[80:83], v[20:23], 0
    v_mfma_f32_16x16x32_bf16 v[136:139], v[80:83], v[24:27], 0
    v_mfma_f32_16x16x32_bf16 v[140:143], v[80:83], v[28:31], 0
    v_mfma_f32_16x16x32_bf16 v[128:131], v[84:87], v[16:19], v[128:131]
    v_mfma_f32_16x16x32_bf16 v[132:135], v[84:87], v[20:23], v[132:135]
    v_mfma_f32_16x16x32_bf16 v[136:139], v[84:87], v[24:27], v[136:139]
    v_mfma_f32_16x16x32_bf16 v[140:143], v[84:87], v[28:31], v[140:143]
    v_mfma_f32_16x16x32_bf16 v[128:131], v[88:91], v[32:35], v[128:131]
    v_mfma_f32_16x16x32_bf16 v[132:135], v[88:91], v[36:39], v[132:135]
    v_mfma_f32_16x16x32_bf16 v[136:139], v[88:91], v[40:43], v[136:139]
    v_mfma_f32_16x16x32_bf16 v[140:143], v[88:91], v[44:47], v[140:143]
    v_mfma_f32_16x16x32_bf16 v[128:131], v[92:95], v[32:35], v[128:131]
    v_mfma_f32_16x16x32_bf16 v[132:135], v[92:95], v[36:39], v[132:135]
    v_mfma_f32_16x16x32_bf16 v[136:139], v[92:95], v[40:43], v[136:139]
    v_mfma_f32_16x16x32_bf16 v[140:143], v[92:95], v[44:47], v[140:143]
    s_nop 7
    v_mov_b32 v16, v96
    v_mul_f32 v20, v96, v96
    v_mov_b32 v17, v100
    v_mul_f32 v21, v100, v100
    v_mov_b32 v18, v104
    v_mul_f32 v22, v104, v104
    v_mov_b32 v19, v108
    v_mul_f32 v23, v108, v108
    v_add_f32 v16, v16, v97
    v_fmac_f32 v20, v97, v97
    v_add_f32 v17, v17, v101
    v_fmac_f32 v21, v101, v101
    v_add_f32 v18, v18, v105
    v_fmac_f32 v22, v105, v105
    v_add_f32 v19, v19, v109
    v_fmac_f32 v23, v109, v109
    v_add_f32 v16, v16, v98
    v_fmac_f32 v20, v98, v98
    v_add_f32 v17, v17, v102
    v_fmac_f32 v21, v102, v102
    v_add_f32 v18, v18, v106
    v_fmac_f32 v22, v106, v106
    v_add_f32 v19, v19, v110
    v_fmac_f32 v23, v110, v110
    v_add_f32 v16, v16, v99
    v_fmac_f32 v20, v99, v99
    v_add_f32 v17, v17, v103
    v_fmac_f32 v21, v103, v103
    v_add_f32 v18, v18, v107
    v_fmac_f32 v22, v107, v107
    v_add_f32 v19, v19, v111
    v_fmac_f32 v23, v111, v111
    v_add_f32 v16, v16, v112
    v_fmac_f32 v20, v112, v112
    v_add_f32 v17, v17, v116
    v_fmac_f32 v21, v116, v116
    v_add_f32 v18, v18, v120
    v_fmac_f32 v22, v120, v120
    v_add_f32 v19, v19, v124
    v_fmac_f32 v23, v124, v124
    v_add_f32 v16, v16, v113
    v_fmac_f32 v20, v113, v113
    v_add_f32 v17, v17, v117
    v_fmac_f32 v21, v117, v117
    v_add_f32 v18, v18, v121
    v_fmac_f32 v22, v121, v121
    v_add_f32 v19, v19, v125
    v_fmac_f32 v23, v125, v125
    v_add_f32 v16, v16, v114
    v_fmac_f32 v20, v114, v114
    v_add_f32 v17, v17, v118
    v_fmac_f32 v21, v118, v118
    v_add_f32 v18, v18, v122
    v_fmac_f32 v22, v122, v122
    v_add_f32 v19, v19, v126
    v_fmac_f32 v23, v126, v126
    v_add_f32 v16, v16, v115
    v_fmac_f32 v20, v115, v115
    v_add_f32 v17, v17, v119
    v_fmac_f32 v21, v119, v119
    v_add_f32 v18, v18, v123
    v_fmac_f32 v22, v123, v123
    v_add_f32 v19, v19, v127
    v_fmac_f32 v23, v127, v127
    v_add_f32 v16, v16, v128
    v_fmac_f32 v20, v128, v128
    v_add_f32 v17, v17, v132
    v_fmac_f32 v21, v132, v132
    v_add_f32 v18, v18, v136
    v_fmac_f32 v22, v136, v136
    v_add_f32 v19, v19, v140
    v_fmac_f32 v23, v140, v140
    v_add_f32 v16, v16, v129
    v_fmac_f32 v20, v129, v129
    v_add_f32 v17, v17, v133
    v_fmac_f32 v21, v133, v133
    v_add_f32 v18, v18, v137
    v_fmac_f32 v22, v137, v137
    v_add_f32 v19, v19, v141
    v_fmac_f32 v23, v141, v141
    v_add_f32 v16, v16, v130
    v_fmac_f32 v20, v130, v130
    v_add_f32 v17, v17, v134
    v_fmac_f32 v21, v134, v134
    v_add_f32 v18, v18, v138
    v_fmac_f32 v22, v138, v138
    v_add_f32 v19, v19, v142
    v_fmac_f32 v23, v142, v142
    v_add_f32 v16, v16, v131
    v_fmac_f32 v20, v131, v131
    v_add_f32 v17, v17, v135
    v_fmac_f32 v21, v135, v135
    v_add_f32 v18, v18, v139
    v_fmac_f32 v22, v139, v139
    v_add_f32 v19, v19, v143
    v_fmac_f32 v23, v143, v143
    v_mov_b32 v24, v16
    v_mov_b32 v25, v17
    v_mov_b32 v26, v18
    v_mov_b32 v27, v19
    v_mov_b32 v28, v20
    v_mov_b32 v29, v21
    v_mov_b32 v30, v22
    v_mov_b32 v31, v23
    s_nop 0
    v_permlane32_swap_b32 v16, v24
    v_permlane32_swap_b32 v17, v25
    v_permlane32_swap_b32 v18, v26
    v_permlane32_swap_b32 v19, v27
    v_permlane32_swap_b32 v20, v28
    v_permlane32_swap_b32 v21, v29
    v_permlane32_swap_b32 v22, v30
    v_permlane32_swap_b32 v23, v31
    v_add_f32 v16, v16, v24
    v_add_f32 v17, v17, v25
    v_add_f32 v18, v18, v26
    v_add_f32 v19, v19, v27
    v_add_f32 v20, v20, v28
    v_add_f32 v21, v21, v29
    v_add_f32 v22, v22, v30
    v_add_f32 v23, v23, v31
    v_mov_b32 v24, v16
    v_mov_b32 v25, v17
    v_mov_b32 v26, v18
    v_mov_b32 v27, v19
    v_mov_b32 v28, v20
    v_mov_b32 v29, v21
    v_mov_b32 v30, v22
    v_mov_b32 v31, v23
    s_nop 0
    v_permlane16_swap_b32 v16, v24
    v_permlane16_swap_b32 v17, v25
    v_permlane16_swap_b32 v18, v26
    v_permlane16_swap_b32 v19, v27
    v_permlane16_swap_b32 v20, v28
    v_permlane16_swap_b32 v21, v29
    v_permlane16_swap_b32 v22, v30
    v_permlane16_swap_b32 v23, v31
    v_add_f32 v16, v16, v24
    v_add_f32 v17, v17, v25
    v_add_f32 v18, v18, v26
    v_add_f32 v19, v19, v27
    v_add_f32 v20, v20, v28
    v_add_f32 v21, v21, v29
    v_add_f32 v22, v22, v30
    v_add_f32 v23, v23, v31
    s_branch K34_WR
K34_IDLE:
    v_mov_b32 v16, 0
    v_mov_b32 v17, 0
    v_mov_b32 v18, 0
    v_mov_b32 v19, 0
    v_mov_b32 v20, 0
    v_mov_b32 v21, 0
    v_mov_b32 v22, 0
    v_mov_b32 v23, 0
K34_WR:
    s_lshl_b32 s24, s3, 9
    v_lshlrev_b32 v7, 4, v3
    v_add_u32 v7, s24, v7
    ds_write_b128 v7, v[16:19] offset:12288
    ds_write_b128 v7, v[20:23] offset:12544
    s_waitcnt lgkmcnt(0)
    s_barrier
    s_cmp_lg_u32 s3, 0
    s_cbranch_scc1 K34_WAIT
    v_lshlrev_b32 v7, 2, v2
    ds_read_b32 v16, v7 offset:12288
    ds_read_b32 v17, v7 offset:12800
    ds_read_b32 v18, v7 offset:13312
    ds_read_b32 v19, v7 offset:13824
    ds_read_b32 v20, v7 offset:14336
    ds_read_b32 v21, v7 offset:14848
    ds_read_b32 v22, v7 offset:15360
    ds_read_b32 v23, v7 offset:15872
    ds_read_b32 v24, v7 offset:16384
    ds_read_b32 v25, v7 offset:16896
    ds_read_b32 v26, v7 offset:17408
    ds_read_b32 v27, v7 offset:17920
    s_waitcnt lgkmcnt(0)
    ds_read_b32 v32, v7 offset:12544
    ds_read_b32 v33, v7 offset:13056
    ds_read_b32 v34, v7 offset:13568
    ds_read_b32 v35, v7 offset:14080
    ds_read_b32 v36, v7 offset:14592
    ds_read_b32 v37, v7 offset:15104
    ds_read_b32 v38, v7 offset:15616
    ds_read_b32 v39, v7 offset:16128
    ds_read_b32 v40, v7 offset:16640
    ds_read_b32 v41, v7 offset:17152
    ds_read_b32 v42, v7 offset:17664
    ds_read_b32 v43, v7 offset:18176
    v_add_f32 v16, v16, v17
    v_add_f32 v16, v16, v18
    v_add_f32 v16, v16, v19
    v_add_f32 v16, v16, v20
    v_add_f32 v16, v16, v21
    v_add_f32 v16, v16, v22
    v_add_f32 v16, v16, v23
    v_add_f32 v16, v16, v24
    v_add_f32 v16, v16, v25
    v_add_f32 v16, v16, v26
    v_add_f32 v16, v16, v27
    s_waitcnt lgkmcnt(0)
    v_add_f32 v32, v32, v33
    v_add_f32 v32, v32, v34
    v_add_f32 v32, v32, v35
    v_add_f32 v32, v32, v36
    v_add_f32 v32, v32, v37
    v_add_f32 v32, v32, v38
    v_add_f32 v32, v32, v39
    v_add_f32 v32, v32, v40
    v_add_f32 v32, v32, v41
    v_add_f32 v32, v32, v42
    v_add_f32 v32, v32, v43
    s_lshl_b32 s24, s6, 4
    s_add_u32 s24, s24, s7
    s_lshl_b32 s24, s24, 9
    buffer_store_dword v16, v7, s[12:15], s24 offen sc1
    buffer_store_dword v32, v7, s[12:15], s24 offen offset:256 sc1
    s_mov_b32 s26, 20000
K34_POLL:
    s_lshl_b32 s24, s6, 13
    buffer_load_dword v16, v7, s[12:15], s24 offen offset:0 sc1
    buffer_load_dword v32, v7, s[12:15], s24 offen offset:256 sc1
    buffer_load_dword v17, v7, s[12:15], s24 offen offset:512 sc1
    buffer_load_dword v33, v7, s[12:15], s24 offen offset:768 sc1
    buffer_load_dword v18, v7, s[12:15], s24 offen offset:1024 sc1
    buffer_load_dword v34, v7, s[12:15], s24 offen offset:1280 sc1
    buffer_load_dword v19, v7, s[12:15], s24 offen offset:1536 sc1
    buffer_load_dword v35, v7, s[12:15], s24 offen offset:1792 sc1
    buffer_load_dword v20, v7, s[12:15], s24 offen offset:2048 sc1
    buffer_load_dword v36, v7, s[12:15], s24 offen offset:2304 sc1
    buffer_load_dword v21, v7, s[12:15], s24 offen offset:2560 sc1
    buffer_load_dword v37, v7, s[12:15], s24 offen offset:2816 sc1
    buffer_load_dword v22, v7, s[12:15], s24 offen offset:3072 sc1
    buffer_load_dword v38, v7, s[12:15], s24 offen offset:3328 sc1
    buffer_load_dword v23, v7, s[12:15], s24 offen offset:3584 sc1
    buffer_load_dword v39, v7, s[12:15], s24 offen offset:3840 sc1
    s_add_u32 s24, s24, 4096
    buffer_load_dword v24, v7, s[12:15], s24 offen offset:0 sc1
    buffer_load_dword v40, v7, s[12:15], s24 offen offset:256 sc1
    buffer_load_dword v25, v7, s[12:15], s24 offen offset:512 sc1
    buffer_load_dword v41, v7, s[12:15], s24 offen offset:768 sc1
    buffer_load_dword v26, v7, s[12:15], s24 offen offset:1024 sc1
    buffer_load_dword v42, v7, s[12:15], s24 offen offset:1280 sc1
    buffer_load_dword v27, v7, s[12:15], s24 offen offset:1536 sc1
    buffer_load_dword v43, v7, s[12:15], s24 offen offset:1792 sc1
    buffer_load_dword v28, v7, s[12:15], s24 offen offset:2048 sc1
    buffer_load_dword v44, v7, s[12:15], s24 offen offset:2304 sc1
    buffer_load_dword v29, v7, s[12:15], s24 offen offset:2560 sc1
    buffer_load_dword v45, v7, s[12:15], s24 offen offset:2816 sc1
    buffer_load_dword v30, v7, s[12:15], s24 offen offset:3072 sc1
    buffer_load_dword v46, v7, s[12:15], s24 offen offset:3328 sc1
    buffer_load_dword v31, v7, s[12:15], s24 offen offset:3584 sc1
    buffer_load_dword v47, v7, s[12:15], s24 offen offset:3840 sc1
    s_waitcnt vmcnt(0)
    v_max3_u32 v48, v16, v17, v18
    v_max3_u32 v48, v48, v19, v20
    v_max3_u32 v48, v48, v21, v22
    v_max3_u32 v48, v48, v23, v24
    v_max3_u32 v48, v48, v25, v26
    v_max3_u32 v48, v48, v27, v28
    v_max3_u32 v48, v48, v29, v30
    v_max3_u32 v48, v48, v31, v32
    v_max3_u32 v48, v48, v33, v34
    v_max3_u32 v48, v48, v35, v36
    v_max3_u32 v48, v48, v37, v38
    v_max3_u32 v48, v48, v39, v40
    v_max3_u32 v48, v48, v41, v42
    v_max3_u32 v48, v48, v43, v44
    v_max3_u32 v48, v48, v45, v46
    v_max_u32 v48, v48, v47
    v_cmp_eq_u32 vcc, -1, v48
    s_sub_u32 s26, s26, 1
    s_cmp_eq_u32 s26, 0
    s_cbranch_scc1 K34_GOT
    s_cbranch_vccz K34_GOT
    s_sleep 1
    s_branch K34_POLL
K34_GOT:
    v_add_f32 v16, v16, v24
    v_add_f32 v32, v32, v40
    v_add_f32 v17, v17, v25
    v_add_f32 v33, v33, v41
    v_add_f32 v18, v18, v26
    v_add_f32 v34, v34, v42
    v_add_f32 v19, v19, v27
    v_add_f32 v35, v35, v43
    v_add_f32 v20, v20, v28
    v_add_f32 v36, v36, v44
    v_add_f32 v21, v21, v29
    v_add_f32 v37, v37, v45
    v_add_f32 v22, v22, v30
    v_add_f32 v38, v38, v46
    v_add_f32 v23, v23, v31
    v_add_f32 v39, v39, v47
    v_add_f32 v16, v16, v20
    v_add_f32 v32, v32, v36
    v_add_f32 v17, v17, v21
    v_add_f32 v33, v33, v37
    v_add_f32 v18, v18, v22
    v_add_f32 v34, v34, v38
    v_add_f32 v19, v19, v23
    v_add_f32 v35, v35, v39
    v_add_f32 v16, v16, v18
    v_add_f32 v32, v32, v34
    v_add_f32 v17, v17, v19
    v_add_f32 v33, v33, v35
    v_add_f32 v16, v16, v17
    v_add_f32 v32, v32, v33
    v_mul_f32 v11, 0x39035177, v16
    v_mul_f32 v12, 0x39035177, v32
    v_fma_f32 v12, -v11, v11, v12
    v_max_f32 v12, 0, v12
    v_add_f32 v12, 0x3727c5ac, v12
    v_sqrt_f32 v12, v12
    v_lshlrev_b32 v9, 16, v152
    v_rcp_f32 v12, v12
    v_lshlrev_b32 v10, 16, v153
    v_mul_f32 v9, v9, v12
    v_fma_f32 v10, -v11, v9, v10
    ds_write_b32 v7, v9 offset:18432
    ds_write_b32 v7, v10 offset:18688
    s_waitcnt lgkmcnt(0)
K34_WAIT:
    s_barrier
    s_cmp_lt_u32 s3, s23
    s_cbranch_scc0 K34_END
    v_lshlrev_b32 v7, 4, v3
    ds_read_b128 v[144:147], v7 offset:18432
    ds_read_b128 v[148:151], v7 offset:18688
    s_mul_i32 s24, s20, 8176640
    s_add_u32 s16, s44, s24
    s_addc_u32 s17, s45, 0
    s_and_b32 s17, s17, 0xffff
    s_mov_b32 s18, 8176640
    s_mov_b32 s19, 0x00020000
    v_lshlrev_b32 v7, 12, v4
    v_lshl_add_u32 v7, v3, 3, v7
    s_lshl_b32 s24, s21, 7
    v_add_u32 v7, s24, v7
    s_mul_i32 s25, s22, 49152
    s_mov_b32 s30, 0xc0135761
    s_mov_b32 s31, 0xbdd2d3e8
    v_mov_b32 v15, s30
    s_waitcnt lgkmcnt(0)
    v_fma_f32 v16, v96, v144, v148
    v_fma_f32 v17, v100, v145, v149
    v_fma_f32 v18, v104, v146, v150
    v_fma_f32 v19, v108, v147, v151
    v_fma_f32 v20, v97, v144, v148
    v_fma_f32 v21, v101, v145, v149
    v_fma_f32 v22, v105, v146, v150
    v_fma_f32 v23, v109, v147, v151
    v_mul_f32 v24, v16, v16
    v_mul_f32 v25, v17, v17
    v_mul_f32 v26, v18, v18
    v_mul_f32 v27, v19, v19
    v_mul_f32 v28, v20, v20
    v_mul_f32 v29, v21, v21
    v_mul_f32 v30, v22, v22
    v_mul_f32 v31, v23, v23
    v_fma_f32 v24, v24, s31, v15
    v_fma_f32 v25, v25, s31, v15
    v_fma_f32 v26, v26, s31, v15
    v_fma_f32 v27, v27, s31, v15
    v_fma_f32 v28, v28, s31, v15
    v_fma_f32 v29, v29, s31, v15
    v_fma_f32 v30, v30, s31, v15
    v_fma_f32 v31, v31, s31, v15
    v_mul_f32 v24, v24, v16
    v_mul_f32 v25, v25, v17
    v_mul_f32 v26, v26, v18
    v_mul_f32 v27, v27, v19
    v_mul_f32 v28, v28, v20
    v_mul_f32 v29, v29, v21
    v_mul_f32 v30, v30, v22
    v_mul_f32 v31, v31, v23
    v_exp_f32 v24, v24
    v_exp_f32 v25, v25
    v_exp_f32 v26, v26
    v_exp_f32 v27, v27
    v_exp_f32 v28, v28
    v_exp_f32 v29, v29
    v_exp_f32 v30, v30
    v_exp_f32 v31, v31
    v_add_f32 v24, 1.0, v24
    v_add_f32 v25, 1.0, v25
    v_add_f32 v26, 1.0, v26
    v_add_f32 v27, 1.0, v27
    v_add_f32 v28, 1.0, v28
    v_add_f32 v29, 1.0, v29
    v_add_f32 v30, 1.0, v30
    v_add_f32 v31, 1.0, v31
    v_rcp_f32 v24, v24
    v_rcp_f32 v25, v25
    v_rcp_f32 v26, v26
    v_rcp_f32 v27, v27
    v_rcp_f32 v28, v28
    v_rcp_f32 v29, v29
    v_rcp_f32 v30, v30
    v_rcp_f32 v31, v31
    v_mul_f32 v16, v16, v24
    v_mul_f32 v17, v17, v25
    v_mul_f32 v18, v18, v26
    v_mul_f32 v19, v19, v27
    v_mul_f32 v20, v20, v28
    v_mul_f32 v21, v21, v29
    v_mul_f32 v22, v22, v30
    v_mul_f32 v23, v23, v31
    v_cvt_pk_bf16_f32 v32, v16, v17
    v_cvt_pk_bf16_f32 v33, v18, v19
    buffer_store_dwordx2 v[32:33], v7, s[16:19], s25 offen offset:0
    v_cvt_pk_bf16_f32 v34, v20, v21
    v_cvt_pk_bf16_f32 v35, v22, v23
    buffer_store_dwordx2 v[34:35], v7, s[16:19], s25 offen offset:1024
    s_add_u32 s25, s25, 2048
    v_fma_f32 v36, v98, v144, v148
    v_fma_f32 v37, v102, v145, v149
    v_fma_f32 v38, v106, v146, v150
    v_fma_f32 v39, v110, v147, v151
    v_fma_f32 v40, v99, v144, v148
    v_fma_f32 v41, v103, v145, v149
    v_fma_f32 v42, v107, v146, v150
    v_fma_f32 v43, v111, v147, v151
    v_mul_f32 v44, v36, v36
    v_mul_f32 v45, v37, v37
    v_mul_f32 v46, v38, v38
    v_mul_f32 v47, v39, v39
    v_mul_f32 v48, v40, v40
    v_mul_f32 v49, v41, v41
    v_mul_f32 v50, v42, v42
    v_mul_f32 v51, v43, v43
    v_fma_f32 v44, v44, s31, v15
    v_fma_f32 v45, v45, s31, v15
    v_fma_f32 v46, v46, s31, v15
    v_fma_f32 v47, v47, s31, v15
    v_fma_f32 v48, v48, s31, v15
    v_fma_f32 v49, v49, s31, v15
    v_fma_f32 v50, v50, s31, v15
    v_fma_f32 v51, v51, s31, v15
    v_mul_f32 v44, v44, v36
    v_mul_f32 v45, v45, v37
    v_mul_f32 v46, v46, v38
    v_mul_f32 v47, v47, v39
    v_mul_f32 v48, v48, v40
    v_mul_f32 v49, v49, v41
    v_mul_f32 v50, v50, v42
    v_mul_f32 v51, v51, v43
    v_exp_f32 v44, v44
    v_exp_f32 v45, v45
    v_exp_f32 v46, v46
    v_exp_f32 v47, v47
    v_exp_f32 v48, v48
    v_exp_f32 v49, v49
    v_exp_f32 v50, v50
    v_exp_f32 v51, v51
    v_add_f32 v44, 1.0, v44
    v_add_f32 v45, 1.0, v45
    v_add_f32 v46, 1.0, v46
    v_add_f32 v47, 1.0, v47
    v_add_f32 v48, 1.0, v48
    v_add_f32 v49, 1.0, v49
    v_add_f32 v50, 1.0, v50
    v_add_f32 v51, 1.0, v51
    v_rcp_f32 v44, v44
    v_rcp_f32 v45, v45
    v_rcp_f32 v46, v46
    v_rcp_f32 v47, v47
    v_rcp_f32 v48, v48
    v_rcp_f32 v49, v49
    v_rcp_f32 v50, v50
    v_rcp_f32 v51, v51
    v_mul_f32 v36, v36, v44
    v_mul_f32 v37, v37, v45
    v_mul_f32 v38, v38, v46
    v_mul_f32 v39, v39, v47
    v_mul_f32 v40, v40, v48
    v_mul_f32 v41, v41, v49
    v_mul_f32 v42, v42, v50
    v_mul_f32 v43, v43, v51
    v_cvt_pk_bf16_f32 v52, v36, v37
    v_cvt_pk_bf16_f32 v53, v38, v39
    buffer_store_dwordx2 v[52:53], v7, s[16:19], s25 offen offset:0
    v_cvt_pk_bf16_f32 v54, v40, v41
    v_cvt_pk_bf16_f32 v55, v42, v43
    buffer_store_dwordx2 v[54:55], v7, s[16:19], s25 offen offset:1024
    s_add_u32 s25, s25, 2048
    s_add_u32 s25, s25, 12288
    v_fma_f32 v16, v112, v144, v148
    v_fma_f32 v17, v116, v145, v149
    v_fma_f32 v18, v120, v146, v150
    v_fma_f32 v19, v124, v147, v151
    v_fma_f32 v20, v113, v144, v148
    v_fma_f32 v21, v117, v145, v149
    v_fma_f32 v22, v121, v146, v150
    v_fma_f32 v23, v125, v147, v151
    v_mul_f32 v24, v16, v16
    v_mul_f32 v25, v17, v17
    v_mul_f32 v26, v18, v18
    v_mul_f32 v27, v19, v19
    v_mul_f32 v28, v20, v20
    v_mul_f32 v29, v21, v21
    v_mul_f32 v30, v22, v22
    v_mul_f32 v31, v23, v23
    v_fma_f32 v24, v24, s31, v15
    v_fma_f32 v25, v25, s31, v15
    v_fma_f32 v26, v26, s31, v15
    v_fma_f32 v27, v27, s31, v15
    v_fma_f32 v28, v28, s31, v15
    v_fma_f32 v29, v29, s31, v15
    v_fma_f32 v30, v30, s31, v15
    v_fma_f32 v31, v31, s31, v15
    v_mul_f32 v24, v24, v16
    v_mul_f32 v25, v25, v17
    v_mul_f32 v26, v26, v18
    v_mul_f32 v27, v27, v19
    v_mul_f32 v28, v28, v20
    v_mul_f32 v29, v29, v21
    v_mul_f32 v30, v30, v22
    v_mul_f32 v31, v31, v23
    v_exp_f32 v24, v24
    v_exp_f32 v25, v25
    v_exp_f32 v26, v26
    v_exp_f32 v27, v27
    v_exp_f32 v28, v28
    v_exp_f32 v29, v29
    v_exp_f32 v30, v30
    v_exp_f32 v31, v31
    v_add_f32 v24, 1.0, v24
    v_add_f32 v25, 1.0, v25
    v_add_f32 v26, 1.0, v26
    v_add_f32 v27, 1.0, v27
    v_add_f32 v28, 1.0, v28
    v_add_f32 v29, 1.0, v29
    v_add_f32 v30, 1.0, v30
    v_add_f32 v31, 1.0, v31
    v_rcp_f32 v24, v24
    v_rcp_f32 v25, v25
    v_rcp_f32 v26, v26
    v_rcp_f32 v27, v27
    v_rcp_f32 v28, v28
    v_rcp_f32 v29, v29
    v_rcp_f32 v30, v30
    v_rcp_f32 v31, v31
    v_mul_f32 v16, v16, v24
    v_mul_f32 v17, v17, v25
    v_mul_f32 v18, v18, v26
    v_mul_f32 v19, v19, v27
    v_mul_f32 v20, v20, v28
    v_mul_f32 v21, v21, v29
    v_mul_f32 v22, v22, v30
    v_mul_f32 v23, v23, v31
    v_cvt_pk_bf16_f32 v32, v16, v17
    v_cvt_pk_bf16_f32 v33, v18, v19
    buffer_store_dwordx2 v[32:33], v7, s[16:19], s25 offen offset:0
    v_cvt_pk_bf16_f32 v34, v20, v21
    v_cvt_pk_bf16_f32 v35, v22, v23
    buffer_store_dwordx2 v[34:35], v7, s[16:19], s25 offen offset:1024
    s_add_u32 s25, s25, 2048
    v_fma_f32 v36, v114, v144, v148
    v_fma_f32 v37, v118, v145, v149
    v_fma_f32 v38, v122, v146, v150
    v_fma_f32 v39, v126, v147, v151
    v_fma_f32 v40, v115, v144, v148
    v_fma_f32 v41, v119, v145, v149
    v_fma_f32 v42, v123, v146, v150
    v_fma_f32 v43, v127, v147, v151
    v_mul_f32 v44, v36, v36
    v_mul_f32 v45, v37, v37
    v_mul_f32 v46, v38, v38
    v_mul_f32 v47, v39, v39
    v_mul_f32 v48, v40, v40
    v_mul_f32 v49, v41, v41
    v_mul_f32 v50, v42, v42
    v_mul_f32 v51, v43, v43
    v_fma_f32 v44, v44, s31, v15
    v_fma_f32 v45, v45, s31, v15
    v_fma_f32 v46, v46, s31, v15
    v_fma_f32 v47, v47, s31, v15
    v_fma_f32 v48, v48, s31, v15
    v_fma_f32 v49, v49, s31, v15
    v_fma_f32 v50, v50, s31, v15
    v_fma_f32 v51, v51, s31, v15
    v_mul_f32 v44, v44, v36
    v_mul_f32 v45, v45, v37
    v_mul_f32 v46, v46, v38
    v_mul_f32 v47, v47, v39
    v_mul_f32 v48, v48, v40
    v_mul_f32 v49, v49, v41
    v_mul_f32 v50, v50, v42
    v_mul_f32 v51, v51, v43
    v_exp_f32 v44, v44
    v_exp_f32 v45, v45
    v_exp_f32 v46, v46
    v_exp_f32 v47, v47
    v_exp_f32 v48, v48
    v_exp_f32 v49, v49
    v_exp_f32 v50, v50
    v_exp_f32 v51, v51
    v_add_f32 v44, 1.0, v44
    v_add_f32 v45, 1.0, v45
    v_add_f32 v46, 1.0, v46
    v_add_f32 v47, 1.0, v47
    v_add_f32 v48, 1.0, v48
    v_add_f32 v49, 1.0, v49
    v_add_f32 v50, 1.0, v50
    v_add_f32 v51, 1.0, v51
    v_rcp_f32 v44, v44
    v_rcp_f32 v45, v45
    v_rcp_f32 v46, v46
    v_rcp_f32 v47, v47
    v_rcp_f32 v48, v48
    v_rcp_f32 v49, v49
    v_rcp_f32 v50, v50
    v_rcp_f32 v51, v51
    v_mul_f32 v36, v36, v44
    v_mul_f32 v37, v37, v45
    v_mul_f32 v38, v38, v46
    v_mul_f32 v39, v39, v47
    v_mul_f32 v40, v40, v48
    v_mul_f32 v41, v41, v49
    v_mul_f32 v42, v42, v50
    v_mul_f32 v43, v43, v51
    v_cvt_pk_bf16_f32 v52, v36, v37
    v_cvt_pk_bf16_f32 v53, v38, v39
    buffer_store_dwordx2 v[52:53], v7, s[16:19], s25 offen offset:0
    v_cvt_pk_bf16_f32 v54, v40, v41
    v_cvt_pk_bf16_f32 v55, v42, v43
    buffer_store_dwordx2 v[54:55], v7, s[16:19], s25 offen offset:1024
    s_add_u32 s25, s25, 2048
    s_add_u32 s25, s25, 12288
    v_fma_f32 v16, v128, v144, v148
    v_fma_f32 v17, v132, v145, v149
    v_fma_f32 v18, v136, v146, v150
    v_fma_f32 v19, v140, v147, v151
    v_fma_f32 v20, v129, v144, v148
    v_fma_f32 v21, v133, v145, v149
    v_fma_f32 v22, v137, v146, v150
    v_fma_f32 v23, v141, v147, v151
    v_mul_f32 v24, v16, v16
    v_mul_f32 v25, v17, v17
    v_mul_f32 v26, v18, v18
    v_mul_f32 v27, v19, v19
    v_mul_f32 v28, v20, v20
    v_mul_f32 v29, v21, v21
    v_mul_f32 v30, v22, v22
    v_mul_f32 v31, v23, v23
    v_fma_f32 v24, v24, s31, v15
    v_fma_f32 v25, v25, s31, v15
    v_fma_f32 v26, v26, s31, v15
    v_fma_f32 v27, v27, s31, v15
    v_fma_f32 v28, v28, s31, v15
    v_fma_f32 v29, v29, s31, v15
    v_fma_f32 v30, v30, s31, v15
    v_fma_f32 v31, v31, s31, v15
    v_mul_f32 v24, v24, v16
    v_mul_f32 v25, v25, v17
    v_mul_f32 v26, v26, v18
    v_mul_f32 v27, v27, v19
    v_mul_f32 v28, v28, v20
    v_mul_f32 v29, v29, v21
    v_mul_f32 v30, v30, v22
    v_mul_f32 v31, v31, v23
    v_exp_f32 v24, v24
    v_exp_f32 v25, v25
    v_exp_f32 v26, v26
    v_exp_f32 v27, v27
    v_exp_f32 v28, v28
    v_exp_f32 v29, v29
    v_exp_f32 v30, v30
    v_exp_f32 v31, v31
    v_add_f32 v24, 1.0, v24
    v_add_f32 v25, 1.0, v25
    v_add_f32 v26, 1.0, v26
    v_add_f32 v27, 1.0, v27
    v_add_f32 v28, 1.0, v28
    v_add_f32 v29, 1.0, v29
    v_add_f32 v30, 1.0, v30
    v_add_f32 v31, 1.0, v31
    v_rcp_f32 v24, v24
    v_rcp_f32 v25, v25
    v_rcp_f32 v26, v26
    v_rcp_f32 v27, v27
    v_rcp_f32 v28, v28
    v_rcp_f32 v29, v29
    v_rcp_f32 v30, v30
    v_rcp_f32 v31, v31
    v_mul_f32 v16, v16, v24
    v_mul_f32 v17, v17, v25
    v_mul_f32 v18, v18, v26
    v_mul_f32 v19, v19, v27
    v_mul_f32 v20, v20, v28
    v_mul_f32 v21, v21, v29
    v_mul_f32 v22, v22, v30
    v_mul_f32 v23, v23, v31
    v_cvt_pk_bf16_f32 v32, v16, v17
    v_cvt_pk_bf16_f32 v33, v18, v19
    buffer_store_dwordx2 v[32:33], v7, s[16:19], s25 offen offset:0
    v_cvt_pk_bf16_f32 v34, v20, v21
    v_cvt_pk_bf16_f32 v35, v22, v23
    buffer_store_dwordx2 v[34:35], v7, s[16:19], s25 offen offset:1024
    s_add_u32 s25, s25, 2048
    v_fma_f32 v36, v130, v144, v148
    v_fma_f32 v37, v134, v145, v149
    v_fma_f32 v38, v138, v146, v150
    v_fma_f32 v39, v142, v147, v151
    v_fma_f32 v40, v131, v144, v148
    v_fma_f32 v41, v135, v145, v149
    v_fma_f32 v42, v139, v146, v150
    v_fma_f32 v43, v143, v147, v151
    v_mul_f32 v44, v36, v36
    v_mul_f32 v45, v37, v37
    v_mul_f32 v46, v38, v38
    v_mul_f32 v47, v39, v39
    v_mul_f32 v48, v40, v40
    v_mul_f32 v49, v41, v41
    v_mul_f32 v50, v42, v42
    v_mul_f32 v51, v43, v43
    v_fma_f32 v44, v44, s31, v15
    v_fma_f32 v45, v45, s31, v15
    v_fma_f32 v46, v46, s31, v15
    v_fma_f32 v47, v47, s31, v15
    v_fma_f32 v48, v48, s31, v15
    v_fma_f32 v49, v49, s31, v15
    v_fma_f32 v50, v50, s31, v15
    v_fma_f32 v51, v51, s31, v15
    v_mul_f32 v44, v44, v36
    v_mul_f32 v45, v45, v37
    v_mul_f32 v46, v46, v38
    v_mul_f32 v47, v47, v39
    v_mul_f32 v48, v48, v40
    v_mul_f32 v49, v49, v41
    v_mul_f32 v50, v50, v42
    v_mul_f32 v51, v51, v43
    v_exp_f32 v44, v44
    v_exp_f32 v45, v45
    v_exp_f32 v46, v46
    v_exp_f32 v47, v47
    v_exp_f32 v48, v48
    v_exp_f32 v49, v49
    v_exp_f32 v50, v50
    v_exp_f32 v51, v51
    v_add_f32 v44, 1.0, v44
    v_add_f32 v45, 1.0, v45
    v_add_f32 v46, 1.0, v46
    v_add_f32 v47, 1.0, v47
    v_add_f32 v48, 1.0, v48
    v_add_f32 v49, 1.0, v49
    v_add_f32 v50, 1.0, v50
    v_add_f32 v51, 1.0, v51
    v_rcp_f32 v44, v44
    v_rcp_f32 v45, v45
    v_rcp_f32 v46, v46
    v_rcp_f32 v47, v47
    v_rcp_f32 v48, v48
    v_rcp_f32 v49, v49
    v_rcp_f32 v50, v50
    v_rcp_f32 v51, v51
    v_mul_f32 v36, v36, v44
    v_mul_f32 v37, v37, v45
    v_mul_f32 v38, v38, v46
    v_mul_f32 v39, v39, v47
    v_mul_f32 v40, v40, v48
    v_mul_f32 v41, v41, v49
    v_mul_f32 v42, v42, v50
    v_mul_f32 v43, v43, v51
    v_cvt_pk_bf16_f32 v52, v36, v37
    v_cvt_pk_bf16_f32 v53, v38, v39
    buffer_store_dwordx2 v[52:53], v7, s[16:19], s25 offen offset:0
    v_cvt_pk_bf16_f32 v54, v40, v41
    v_cvt_pk_bf16_f32 v55, v42, v43
    buffer_store_dwordx2 v[54:55], v7, s[16:19], s25 offen offset:1024
    s_add_u32 s25, s25, 2048
    s_add_u32 s25, s25, 12288
K34_END:
    s_endpgm
TEXT_END:
.section .rodata,"a"
.p2align 6
.amdhsa_kernel k1_xform_kernel
  .amdhsa_next_free_vgpr 128
  .amdhsa_next_free_sgpr 96
  .amdhsa_accum_offset 128
  .amdhsa_group_segment_fixed_size 0
  .amdhsa_kernarg_size 56
  .amdhsa_user_sgpr_count 2
  .amdhsa_user_sgpr_kernarg_segment_ptr 1
  .amdhsa_system_sgpr_workgroup_id_x 1
.end_amdhsa_kernel
.p2align 6
.amdhsa_kernel k12_fused_kernel
  .amdhsa_next_free_vgpr 256
  .amdhsa_next_free_sgpr 96
  .amdhsa_accum_offset 256
  .amdhsa_group_segment_fixed_size 0
  .amdhsa_kernarg_size 56
  .amdhsa_user_sgpr_count 2
  .amdhsa_user_sgpr_kernarg_segment_ptr 1
  .amdhsa_system_sgpr_workgroup_id_x 1
.end_amdhsa_kernel
.p2align 6
.amdhsa_kernel k34_out_kernel
  .amdhsa_next_free_vgpr 168
  .amdhsa_next_free_sgpr 96
  .amdhsa_accum_offset 168
  .amdhsa_group_segment_fixed_size 0
  .amdhsa_kernarg_size 56
  .amdhsa_user_sgpr_count 2
  .amdhsa_user_sgpr_kernarg_segment_ptr 1
  .amdhsa_system_sgpr_workgroup_id_x 1
.end_amdhsa_kernel
```

```asm
; @launch kernel=k1_xform_kernel grid=(636,1,1) block=(256,1,1) lds=16384
; @launch kernel=k12_fused_kernel grid=(256,1,1) block=(512,1,1) lds=155840
; @launch kernel=k34_out_kernel grid=(256,1,1) block=(768,1,1) lds=18944
.amdgcn_target "amdgcn-amd-amdhsa--gfx950"
.text
.globl k1_xform_kernel
.globl k12_fused_kernel
.globl k34_out_kernel
.p2align 8
.type k1_xform_kernel,@function
k1_xform_kernel:
    s_cmp_ge_u32 s2, 636
    s_cbranch_scc1 K1_END
    s_load_dwordx4 s[4:7], s[0:1], 0
    s_load_dwordx2 s[8:9], s[0:1], 48
    v_lshrrev_b32 v120, 6, v0
    v_and_b32 v121, 63, v0
    v_readfirstlane_b32 s3, v120
    v_and_b32 v122, 15, v121
    v_lshrrev_b32 v123, 4, v121
    s_mov_b32 s28, 0x05040100
    s_mov_b32 s29, 0x07060302
    v_and_b32 v124, 3, v122
    v_lshlrev_b32 v124, 2, v124
    v_lshrrev_b32 v125, 3, v122
    v_lshl_add_u32 v124, v125, 1, v124
    s_lshl_b32 s10, s3, 4
    s_add_u32 s10, s10, 1
    v_add_u32 v124, s10, v124
    v_bfe_u32 v125, v122, 2, 1
    v_lshlrev_b32 v121, 4, v121
    s_waitcnt lgkmcnt(0)
    s_or_b32 s10, s2, s3
    s_cmp_eq_u32 s10, 0
    s_cbranch_scc0 K1_NOCLR
    s_add_u32 s12, s8, 153092096
    s_addc_u32 s13, s9, 0
    s_and_b32 s13, s13, 0xffff
    s_mov_b32 s14, 32768
    s_mov_b32 s15, 0x00020000
    v_lshrrev_b32 v118, 4, v121
    v_lshlrev_b32 v119, 10, v118
    v_mov_b32 v117, 0
    s_mov_b64 exec, 0xffff
    buffer_store_dword v117, v119, s[12:15], 0 offen
    v_lshlrev_b32 v119, 4, v118
    v_add_u32 v119, 16384, v119
    buffer_store_dword v117, v119, s[12:15], 0 offen
    s_mov_b64 exec, -1
K1_NOCLR:
    s_cmp_lt_u32 s2, 32
    s_cbranch_scc0 K1_NOFILL
    s_add_u32 s12, s8, 153616384
    s_addc_u32 s13, s9, 0
    s_and_b32 s13, s13, 0xffff
    s_mov_b32 s14, 131072
    s_mov_b32 s15, 0x00020000
    s_lshl_b32 s10, s2, 2
    s_add_u32 s10, s10, s3
    s_lshl_b32 s10, s10, 10
    v_mov_b32 v112, -1
    v_mov_b32 v113, -1
    v_mov_b32 v114, -1
    v_mov_b32 v115, -1
    buffer_store_dwordx4 v[112:115], v121, s[12:15], s10 offen
K1_NOFILL:
    s_add_u32 s10, s2, 384
    s_sub_u32 s11, s2, 252
    s_cmp_lt_u32 s2, 252
    s_cselect_b32 s2, s10, s11
    s_cmp_lt_u32 s2, 384
    s_cbranch_scc1 K1_W
    s_sub_u32 s11, s2, 384
    s_mul_hi_u32 s13, s11, 1431655766
    s_mul_i32 s12, s13, 3
    s_sub_u32 s12, s11, s12
    s_mov_b32 s11, s13
    s_cmp_ge_u32 s11, 42
    s_cselect_b32 s13, 1, 0
    s_mul_i32 s14, s13, 42
    s_sub_u32 s11, s11, s14
    s_lshl_b32 s11, s11, 2
    s_add_u32 s11, s11, s3
    s_mul_i32 s14, s13, 16384000
    s_add_u32 s16, s4, s14
    s_addc_u32 s17, s5, 0
    s_and_b32 s17, s17, 0xffff
    s_mov_b32 s18, 16384000
    s_mov_b32 s19, 0x00020000
    s_mov_b32 s20, s8
    s_mov_b32 s21, s9
    s_and_b32 s21, s21, 0xffff
    s_mov_b32 s22, 43778048
    s_mov_b32 s23, 0x00020000
    v_lshlrev_b32 v126, 14, v123
    v_lshl_add_u32 v126, v122, 4, v126
    s_mul_i32 s15, s11, 98304
    s_lshl_b32 s24, s12, 8
    s_add_u32 s15, s15, s24
    buffer_load_dwordx4 v[0:3], v126, s[16:19], s15 offen
    buffer_load_dwordx4 v[4:7], v126, s[16:19], s15 offen offset:2048
    s_add_u32 s15, s15, 4096
    buffer_load_dwordx4 v[8:11], v126, s[16:19], s15 offen
    buffer_load_dwordx4 v[12:15], v126, s[16:19], s15 offen offset:2048
    s_add_u32 s15, s15, 4096
    buffer_load_dwordx4 v[16:19], v126, s[16:19], s15 offen
    buffer_load_dwordx4 v[20:23], v126, s[16:19], s15 offen offset:2048
    s_add_u32 s15, s15, 4096
    buffer_load_dwordx4 v[24:27], v126, s[16:19], s15 offen
    buffer_load_dwordx4 v[28:31], v126, s[16:19], s15 offen offset:2048
    s_add_u32 s15, s15, 53248
    buffer_load_dwordx4 v[32:35], v126, s[16:19], s15 offen
    buffer_load_dwordx4 v[36:39], v126, s[16:19], s15 offen offset:2048
    s_add_u32 s15, s15, 4096
    buffer_load_dwordx4 v[40:43], v126, s[16:19], s15 offen
    buffer_load_dwordx4 v[44:47], v126, s[16:19], s15 offen offset:2048
    s_add_u32 s15, s15, 4096
    buffer_load_dwordx4 v[48:51], v126, s[16:19], s15 offen
    buffer_load_dwordx4 v[52:55], v126, s[16:19], s15 offen offset:2048
    s_add_u32 s15, s15, 4096
    buffer_load_dwordx4 v[56:59], v126, s[16:19], s15 offen
    buffer_load_dwordx4 v[60:63], v126, s[16:19], s15 offen offset:2048
    v_lshlrev_b32 v127, 3, v123
    v_lshlrev_b32 v112, 5, v125
    v_mad_u32_u24 v113, v124, v127, v112
    v_mad_u32_u24 v64, v124, 0, v113
    v_mad_u32_u24 v65, v124, 1, v113
    v_mad_u32_u24 v66, v124, 2, v113
    v_mad_u32_u24 v67, v124, 3, v113
    v_mad_u32_u24 v68, v124, 4, v113
    v_mad_u32_u24 v69, v124, 5, v113
    v_mad_u32_u24 v70, v124, 6, v113
    v_mad_u32_u24 v71, v124, 7, v113
    v_and_b32 v64, 127, v64
    v_and_b32 v65, 127, v65
    v_and_b32 v66, 127, v66
    v_and_b32 v67, 127, v67
    v_and_b32 v68, 127, v68
    v_and_b32 v69, 127, v69
    v_and_b32 v70, 127, v70
    v_and_b32 v71, 127, v71
    v_cvt_f32_u32 v64, v64
    v_cvt_f32_u32 v65, v65
    v_cvt_f32_u32 v66, v66
    v_cvt_f32_u32 v67, v67
    v_cvt_f32_u32 v68, v68
    v_cvt_f32_u32 v69, v69
    v_cvt_f32_u32 v70, v70
    v_cvt_f32_u32 v71, v71
    v_mul_f32 v64, 0x3c000000, v64
    v_mul_f32 v65, 0x3c000000, v65
    v_mul_f32 v66, 0x3c000000, v66
    v_mul_f32 v67, 0x3c000000, v67
    v_mul_f32 v68, 0x3c000000, v68
    v_mul_f32 v69, 0x3c000000, v69
    v_mul_f32 v70, 0x3c000000, v70
    v_mul_f32 v71, 0x3c000000, v71
    v_cos_f32 v64, v64
    v_cos_f32 v65, v65
    v_cos_f32 v66, v66
    v_cos_f32 v67, v67
    v_cos_f32 v68, v68
    v_cos_f32 v69, v69
    v_cos_f32 v70, v70
    v_cos_f32 v71, v71
    s_nop 0
    v_cvt_pk_bf16_f32 v72, v64, v65
    v_cvt_pk_bf16_f32 v73, v66, v67
    v_cvt_pk_bf16_f32 v74, v68, v69
    v_cvt_pk_bf16_f32 v75, v70, v71
    v_lshlrev_b32 v80, 16, v72
    v_and_b32 v81, 0xffff0000, v72
    v_sub_f32 v64, v64, v80
    v_sub_f32 v65, v65, v81
    v_lshlrev_b32 v80, 16, v73
    v_and_b32 v81, 0xffff0000, v73
    v_sub_f32 v66, v66, v80
    v_sub_f32 v67, v67, v81
    v_lshlrev_b32 v80, 16, v74
    v_and_b32 v81, 0xffff0000, v74
    v_sub_f32 v68, v68, v80
    v_sub_f32 v69, v69, v81
    v_lshlrev_b32 v80, 16, v75
    v_and_b32 v81, 0xffff0000, v75
    v_sub_f32 v70, v70, v80
    v_sub_f32 v71, v71, v81
    v_cvt_pk_bf16_f32 v76, v64, v65
    v_cvt_pk_bf16_f32 v77, v66, v67
    v_cvt_pk_bf16_f32 v78, v68, v69
    v_cvt_pk_bf16_f32 v79, v70, v71
    s_lshl_b32 s24, s3, 12
    v_add_u32 v114, s24, v121
    ds_write_b128 v114, v[72:75] offset:0
    ds_write_b128 v114, v[76:79] offset:1024
    v_add_u32 v127, 32, v127
    v_lshlrev_b32 v112, 5, v125
    v_mad_u32_u24 v113, v124, v127, v112
    v_mad_u32_u24 v64, v124, 0, v113
    v_mad_u32_u24 v65, v124, 1, v113
    v_mad_u32_u24 v66, v124, 2, v113
    v_mad_u32_u24 v67, v124, 3, v113
    v_mad_u32_u24 v68, v124, 4, v113
    v_mad_u32_u24 v69, v124, 5, v113
    v_mad_u32_u24 v70, v124, 6, v113
    v_mad_u32_u24 v71, v124, 7, v113
    v_and_b32 v64, 127, v64
    v_and_b32 v65, 127, v65
    v_and_b32 v66, 127, v66
    v_and_b32 v67, 127, v67
    v_and_b32 v68, 127, v68
    v_and_b32 v69, 127, v69
    v_and_b32 v70, 127, v70
    v_and_b32 v71, 127, v71
    v_cvt_f32_u32 v64, v64
    v_cvt_f32_u32 v65, v65
    v_cvt_f32_u32 v66, v66
    v_cvt_f32_u32 v67, v67
    v_cvt_f32_u32 v68, v68
    v_cvt_f32_u32 v69, v69
    v_cvt_f32_u32 v70, v70
    v_cvt_f32_u32 v71, v71
    v_mul_f32 v64, 0x3c000000, v64
    v_mul_f32 v65, 0x3c000000, v65
    v_mul_f32 v66, 0x3c000000, v66
    v_mul_f32 v67, 0x3c000000, v67
    v_mul_f32 v68, 0x3c000000, v68
    v_mul_f32 v69, 0x3c000000, v69
    v_mul_f32 v70, 0x3c000000, v70
    v_mul_f32 v71, 0x3c000000, v71
    v_cos_f32 v64, v64
    v_cos_f32 v65, v65
    v_cos_f32 v66, v66
    v_cos_f32 v67, v67
    v_cos_f32 v68, v68
    v_cos_f32 v69, v69
    v_cos_f32 v70, v70
    v_cos_f32 v71, v71
    s_nop 0
    v_cvt_pk_bf16_f32 v72, v64, v65
    v_cvt_pk_bf16_f32 v73, v66, v67
    v_cvt_pk_bf16_f32 v74, v68, v69
    v_cvt_pk_bf16_f32 v75, v70, v71
    v_lshlrev_b32 v80, 16, v72
    v_and_b32 v81, 0xffff0000, v72
    v_sub_f32 v64, v64, v80
    v_sub_f32 v65, v65, v81
    v_lshlrev_b32 v80, 16, v73
    v_and_b32 v81, 0xffff0000, v73
    v_sub_f32 v66, v66, v80
    v_sub_f32 v67, v67, v81
    v_lshlrev_b32 v80, 16, v74
    v_and_b32 v81, 0xffff0000, v74
    v_sub_f32 v68, v68, v80
    v_sub_f32 v69, v69, v81
    v_lshlrev_b32 v80, 16, v75
    v_and_b32 v81, 0xffff0000, v75
    v_sub_f32 v70, v70, v80
    v_sub_f32 v71, v71, v81
    v_cvt_pk_bf16_f32 v76, v64, v65
    v_cvt_pk_bf16_f32 v77, v66, v67
    v_cvt_pk_bf16_f32 v78, v68, v69
    v_cvt_pk_bf16_f32 v79, v70, v71
    s_lshl_b32 s24, s3, 12
    v_add_u32 v114, s24, v121
    ds_write_b128 v114, v[72:75] offset:2048
    ds_write_b128 v114, v[76:79] offset:3072
    v_lshrrev_b32 v112, 1, v123
    s_mov_b32 s24, 1368064
    v_mul_lo_u32 v112, v112, s24
    v_lshrrev_b32 v113, 2, v122
    s_mov_b32 s24, 21376
    v_mul_lo_u32 v113, v113, s24
    v_add_u32 v112, v112, v113
    v_and_b32 v113, 3, v122
    v_and_b32 v114, 1, v123
    v_lshl_add_u32 v113, v114, 2, v113
    s_add_u32 s24, s11, 7
    s_cmp_ge_u32 s11, 160
    s_cselect_b32 s24, s24, s11
    s_cmp_eq_u32 s13, 1
    s_cselect_b32 s24, s24, s11
    s_lshr_b32 s24, s24, 1
    s_and_b32 s24, s24, 7
    v_xor_b32 v113, s24, v113
    v_lshl_add_u32 v120, v113, 4, v112
    s_mul_i32 s25, s13, 684032
    s_mul_i32 s24, s12, 85504
    s_add_u32 s25, s25, s24
    s_lshl_b32 s24, s11, 7
    s_add_u32 s25, s25, s24
    s_waitcnt lgkmcnt(0)
    s_barrier
    s_cmp_ge_u32 s11, 167
    s_cbranch_scc1 K1_END
    s_waitcnt vmcnt(8)
    v_perm_b32 v64, v4, v0, s28
    v_perm_b32 v68, v4, v0, s29
    v_perm_b32 v65, v12, v8, s28
    v_perm_b32 v69, v12, v8, s29
    v_perm_b32 v66, v20, v16, s28
    v_perm_b32 v70, v20, v16, s29
    v_perm_b32 v67, v28, v24, s28
    v_perm_b32 v71, v28, v24, s29
    v_perm_b32 v72, v5, v1, s28
    v_perm_b32 v76, v5, v1, s29
    v_perm_b32 v73, v13, v9, s28
    v_perm_b32 v77, v13, v9, s29
    v_perm_b32 v74, v21, v17, s28
    v_perm_b32 v78, v21, v17, s29
    v_perm_b32 v75, v29, v25, s28
    v_perm_b32 v79, v29, v25, s29
    v_perm_b32 v80, v6, v2, s28
    v_perm_b32 v84, v6, v2, s29
    v_perm_b32 v81, v14, v10, s28
    v_perm_b32 v85, v14, v10, s29
    v_perm_b32 v82, v22, v18, s28
    v_perm_b32 v86, v22, v18, s29
    v_perm_b32 v83, v30, v26, s28
    v_perm_b32 v87, v30, v26, s29
    v_perm_b32 v88, v7, v3, s28
    v_perm_b32 v92, v7, v3, s29
    v_perm_b32 v89, v15, v11, s28
    v_perm_b32 v93, v15, v11, s29
    v_perm_b32 v90, v23, v19, s28
    v_perm_b32 v94, v23, v19, s29
    v_perm_b32 v91, v31, v27, s28
    v_perm_b32 v95, v31, v27, s29
    s_waitcnt vmcnt(0)
    v_perm_b32 v0, v36, v32, s28
    v_perm_b32 v4, v36, v32, s29
    v_perm_b32 v1, v44, v40, s28
    v_perm_b32 v5, v44, v40, s29
    v_perm_b32 v2, v52, v48, s28
    v_perm_b32 v6, v52, v48, s29
    v_perm_b32 v3, v60, v56, s28
    v_perm_b32 v7, v60, v56, s29
    v_perm_b32 v8, v37, v33, s28
    v_perm_b32 v12, v37, v33, s29
    v_perm_b32 v9, v45, v41, s28
    v_perm_b32 v13, v45, v41, s29
    v_perm_b32 v10, v53, v49, s28
    v_perm_b32 v14, v53, v49, s29
    v_perm_b32 v11, v61, v57, s28
    v_perm_b32 v15, v61, v57, s29
    v_perm_b32 v16, v38, v34, s28
    v_perm_b32 v20, v38, v34, s29
    v_perm_b32 v17, v46, v42, s28
    v_perm_b32 v21, v46, v42, s29
    v_perm_b32 v18, v54, v50, s28
    v_perm_b32 v22, v54, v50, s29
    v_perm_b32 v19, v62, v58, s28
    v_perm_b32 v23, v62, v58, s29
    v_perm_b32 v24, v39, v35, s28
    v_perm_b32 v28, v39, v35, s29
    v_perm_b32 v25, v47, v43, s28
    v_perm_b32 v29, v47, v43, s29
    v_perm_b32 v26, v55, v51, s28
    v_perm_b32 v30, v55, v51, s29
    v_perm_b32 v27, v63, v59, s28
    v_perm_b32 v31, v63, v59, s29
    ds_read_b128 v[96:99], v121 offset:0
    ds_read_b128 v[100:103], v121 offset:1024
    ds_read_b128 v[104:107], v121 offset:2048
    ds_read_b128 v[108:111], v121 offset:3072
    s_waitcnt lgkmcnt(3)
    v_mfma_f32_16x16x32_bf16 v[32:35], v[96:99], v[64:67], 0
    v_mfma_f32_16x16x32_bf16 v[36:39], v[96:99], v[68:71], 0
    v_mfma_f32_16x16x32_bf16 v[40:43], v[96:99], v[72:75], 0
    v_mfma_f32_16x16x32_bf16 v[44:47], v[96:99], v[76:79], 0
    v_mfma_f32_16x16x32_bf16 v[48:51], v[96:99], v[80:83], 0
    v_mfma_f32_16x16x32_bf16 v[52:55], v[96:99], v[84:87], 0
    v_mfma_f32_16x16x32_bf16 v[56:59], v[96:99], v[88:91], 0
    v_mfma_f32_16x16x32_bf16 v[60:63], v[96:99], v[92:95], 0
    s_waitcnt lgkmcnt(2)
    v_mfma_f32_16x16x32_bf16 v[32:35], v[100:103], v[64:67], v[32:35]
    v_mfma_f32_16x16x32_bf16 v[36:39], v[100:103], v[68:71], v[36:39]
    v_mfma_f32_16x16x32_bf16 v[40:43], v[100:103], v[72:75], v[40:43]
    v_mfma_f32_16x16x32_bf16 v[44:47], v[100:103], v[76:79], v[44:47]
    v_mfma_f32_16x16x32_bf16 v[48:51], v[100:103], v[80:83], v[48:51]
    v_mfma_f32_16x16x32_bf16 v[52:55], v[100:103], v[84:87], v[52:55]
    v_mfma_f32_16x16x32_bf16 v[56:59], v[100:103], v[88:91], v[56:59]
    v_mfma_f32_16x16x32_bf16 v[60:63], v[100:103], v[92:95], v[60:63]
    s_waitcnt lgkmcnt(1)
    v_mfma_f32_16x16x32_bf16 v[32:35], v[104:107], v[0:3], v[32:35]
    v_mfma_f32_16x16x32_bf16 v[36:39], v[104:107], v[4:7], v[36:39]
    v_mfma_f32_16x16x32_bf16 v[40:43], v[104:107], v[8:11], v[40:43]
    v_mfma_f32_16x16x32_bf16 v[44:47], v[104:107], v[12:15], v[44:47]
    v_mfma_f32_16x16x32_bf16 v[48:51], v[104:107], v[16:19], v[48:51]
    v_mfma_f32_16x16x32_bf16 v[52:55], v[104:107], v[20:23], v[52:55]
    v_mfma_f32_16x16x32_bf16 v[56:59], v[104:107], v[24:27], v[56:59]
    v_mfma_f32_16x16x32_bf16 v[60:63], v[104:107], v[28:31], v[60:63]
    s_waitcnt lgkmcnt(0)
    v_mfma_f32_16x16x32_bf16 v[32:35], v[108:111], v[0:3], v[32:35]
    v_mfma_f32_16x16x32_bf16 v[36:39], v[108:111], v[4:7], v[36:39]
    v_mfma_f32_16x16x32_bf16 v[40:43], v[108:111], v[8:11], v[40:43]
    v_mfma_f32_16x16x32_bf16 v[44:47], v[108:111], v[12:15], v[44:47]
    v_mfma_f32_16x16x32_bf16 v[48:51], v[108:111], v[16:19], v[48:51]
    v_mfma_f32_16x16x32_bf16 v[52:55], v[108:111], v[20:23], v[52:55]
    v_mfma_f32_16x16x32_bf16 v[56:59], v[108:111], v[24:27], v[56:59]
    v_mfma_f32_16x16x32_bf16 v[60:63], v[108:111], v[28:31], v[60:63]
    s_nop 7
    v_cvt_pk_bf16_f32 v112, v32, v36
    v_cvt_pk_bf16_f32 v113, v40, v44
    v_cvt_pk_bf16_f32 v114, v48, v52
    v_cvt_pk_bf16_f32 v115, v56, v60
    buffer_store_dwordx4 v[112:115], v120, s[20:23], s25 offen
    s_add_u32 s25, s25, 2736128
    v_cvt_pk_bf16_f32 v116, v33, v37
    v_cvt_pk_bf16_f32 v117, v41, v45
    v_cvt_pk_bf16_f32 v118, v49, v53
    v_cvt_pk_bf16_f32 v119, v57, v61
    buffer_store_dwordx4 v[116:119], v120, s[20:23], s25 offen
    s_add_u32 s25, s25, 2736128
    v_cvt_pk_bf16_f32 v112, v34, v38
    v_cvt_pk_bf16_f32 v113, v42, v46
    v_cvt_pk_bf16_f32 v114, v50, v54
    v_cvt_pk_bf16_f32 v115, v58, v62
    buffer_store_dwordx4 v[112:115], v120, s[20:23], s25 offen
    s_add_u32 s25, s25, 2736128
    v_cvt_pk_bf16_f32 v116, v35, v39
    v_cvt_pk_bf16_f32 v117, v43, v47
    v_cvt_pk_bf16_f32 v118, v51, v55
    v_cvt_pk_bf16_f32 v119, v59, v63
    buffer_store_dwordx4 v[116:119], v120, s[20:23], s25 offen
    s_add_u32 s25, s25, 2736128
    ds_read_b128 v[96:99], v121 offset:4096
    ds_read_b128 v[100:103], v121 offset:5120
    ds_read_b128 v[104:107], v121 offset:6144
    ds_read_b128 v[108:111], v121 offset:7168
    s_waitcnt lgkmcnt(3)
    v_mfma_f32_16x16x32_bf16 v[32:35], v[96:99], v[64:67], 0
    v_mfma_f32_16x16x32_bf16 v[36:39], v[96:99], v[68:71], 0
    v_mfma_f32_16x16x32_bf16 v[40:43], v[96:99], v[72:75], 0
    v_mfma_f32_16x16x32_bf16 v[44:47], v[96:99], v[76:79], 0
    v_mfma_f32_16x16x32_bf16 v[48:51], v[96:99], v[80:83], 0
    v_mfma_f32_16x16x32_bf16 v[52:55], v[96:99], v[84:87], 0
    v_mfma_f32_16x16x32_bf16 v[56:59], v[96:99], v[88:91], 0
    v_mfma_f32_16x16x32_bf16 v[60:63], v[96:99], v[92:95], 0
    s_waitcnt lgkmcnt(2)
    v_mfma_f32_16x16x32_bf16 v[32:35], v[100:103], v[64:67], v[32:35]
    v_mfma_f32_16x16x32_bf16 v[36:39], v[100:103], v[68:71], v[36:39]
    v_mfma_f32_16x16x32_bf16 v[40:43], v[100:103], v[72:75], v[40:43]
    v_mfma_f32_16x16x32_bf16 v[44:47], v[100:103], v[76:79], v[44:47]
    v_mfma_f32_16x16x32_bf16 v[48:51], v[100:103], v[80:83], v[48:51]
    v_mfma_f32_16x16x32_bf16 v[52:55], v[100:103], v[84:87], v[52:55]
    v_mfma_f32_16x16x32_bf16 v[56:59], v[100:103], v[88:91], v[56:59]
    v_mfma_f32_16x16x32_bf16 v[60:63], v[100:103], v[92:95], v[60:63]
    s_waitcnt lgkmcnt(1)
    v_mfma_f32_16x16x32_bf16 v[32:35], v[104:107], v[0:3], v[32:35]
    v_mfma_f32_16x16x32_bf16 v[36:39], v[104:107], v[4:7], v[36:39]
    v_mfma_f32_16x16x32_bf16 v[40:43], v[104:107], v[8:11], v[40:43]
    v_mfma_f32_16x16x32_bf16 v[44:47], v[104:107], v[12:15], v[44:47]
    v_mfma_f32_16x16x32_bf16 v[48:51], v[104:107], v[16:19], v[48:51]
    v_mfma_f32_16x16x32_bf16 v[52:55], v[104:107], v[20:23], v[52:55]
    v_mfma_f32_16x16x32_bf16 v[56:59], v[104:107], v[24:27], v[56:59]
    v_mfma_f32_16x16x32_bf16 v[60:63], v[104:107], v[28:31], v[60:63]
    s_waitcnt lgkmcnt(0)
    v_mfma_f32_16x16x32_bf16 v[32:35], v[108:111], v[0:3], v[32:35]
    v_mfma_f32_16x16x32_bf16 v[36:39], v[108:111], v[4:7], v[36:39]
    v_mfma_f32_16x16x32_bf16 v[40:43], v[108:111], v[8:11], v[40:43]
    v_mfma_f32_16x16x32_bf16 v[44:47], v[108:111], v[12:15], v[44:47]
    v_mfma_f32_16x16x32_bf16 v[48:51], v[108:111], v[16:19], v[48:51]
    v_mfma_f32_16x16x32_bf16 v[52:55], v[108:111], v[20:23], v[52:55]
    v_mfma_f32_16x16x32_bf16 v[56:59], v[108:111], v[24:27], v[56:59]
    v_mfma_f32_16x16x32_bf16 v[60:63], v[108:111], v[28:31], v[60:63]
    s_nop 7
    v_cvt_pk_bf16_f32 v112, v32, v36
    v_cvt_pk_bf16_f32 v113, v40, v44
    v_cvt_pk_bf16_f32 v114, v48, v52
    v_cvt_pk_bf16_f32 v115, v56, v60
    buffer_store_dwordx4 v[112:115], v120, s[20:23], s25 offen
    s_add_u32 s25, s25, 2736128
    v_cvt_pk_bf16_f32 v116, v33, v37
    v_cvt_pk_bf16_f32 v117, v41, v45
    v_cvt_pk_bf16_f32 v118, v49, v53
    v_cvt_pk_bf16_f32 v119, v57, v61
    buffer_store_dwordx4 v[116:119], v120, s[20:23], s25 offen
    s_add_u32 s25, s25, 2736128
    v_cvt_pk_bf16_f32 v112, v34, v38
    v_cvt_pk_bf16_f32 v113, v42, v46
    v_cvt_pk_bf16_f32 v114, v50, v54
    v_cvt_pk_bf16_f32 v115, v58, v62
    buffer_store_dwordx4 v[112:115], v120, s[20:23], s25 offen
    s_add_u32 s25, s25, 2736128
    v_cvt_pk_bf16_f32 v116, v35, v39
    v_cvt_pk_bf16_f32 v117, v43, v47
    v_cvt_pk_bf16_f32 v118, v51, v55
    v_cvt_pk_bf16_f32 v119, v59, v63
    buffer_store_dwordx4 v[116:119], v120, s[20:23], s25 offen
    s_add_u32 s25, s25, 2736128
    ds_read_b128 v[96:99], v121 offset:8192
    ds_read_b128 v[100:103], v121 offset:9216
    ds_read_b128 v[104:107], v121 offset:10240
    ds_read_b128 v[108:111], v121 offset:11264
    s_waitcnt lgkmcnt(3)
    v_mfma_f32_16x16x32_bf16 v[32:35], v[96:99], v[64:67], 0
    v_mfma_f32_16x16x32_bf16 v[36:39], v[96:99], v[68:71], 0
    v_mfma_f32_16x16x32_bf16 v[40:43], v[96:99], v[72:75], 0
    v_mfma_f32_16x16x32_bf16 v[44:47], v[96:99], v[76:79], 0
    v_mfma_f32_16x16x32_bf16 v[48:51], v[96:99], v[80:83], 0
    v_mfma_f32_16x16x32_bf16 v[52:55], v[96:99], v[84:87], 0
    v_mfma_f32_16x16x32_bf16 v[56:59], v[96:99], v[88:91], 0
    v_mfma_f32_16x16x32_bf16 v[60:63], v[96:99], v[92:95], 0
    s_waitcnt lgkmcnt(2)
    v_mfma_f32_16x16x32_bf16 v[32:35], v[100:103], v[64:67], v[32:35]
    v_mfma_f32_16x16x32_bf16 v[36:39], v[100:103], v[68:71], v[36:39]
    v_mfma_f32_16x16x32_bf16 v[40:43], v[100:103], v[72:75], v[40:43]
    v_mfma_f32_16x16x32_bf16 v[44:47], v[100:103], v[76:79], v[44:47]
    v_mfma_f32_16x16x32_bf16 v[48:51], v[100:103], v[80:83], v[48:51]
    v_mfma_f32_16x16x32_bf16 v[52:55], v[100:103], v[84:87], v[52:55]
    v_mfma_f32_16x16x32_bf16 v[56:59], v[100:103], v[88:91], v[56:59]
    v_mfma_f32_16x16x32_bf16 v[60:63], v[100:103], v[92:95], v[60:63]
    s_waitcnt lgkmcnt(1)
    v_mfma_f32_16x16x32_bf16 v[32:35], v[104:107], v[0:3], v[32:35]
    v_mfma_f32_16x16x32_bf16 v[36:39], v[104:107], v[4:7], v[36:39]
    v_mfma_f32_16x16x32_bf16 v[40:43], v[104:107], v[8:11], v[40:43]
    v_mfma_f32_16x16x32_bf16 v[44:47], v[104:107], v[12:15], v[44:47]
    v_mfma_f32_16x16x32_bf16 v[48:51], v[104:107], v[16:19], v[48:51]
    v_mfma_f32_16x16x32_bf16 v[52:55], v[104:107], v[20:23], v[52:55]
    v_mfma_f32_16x16x32_bf16 v[56:59], v[104:107], v[24:27], v[56:59]
    v_mfma_f32_16x16x32_bf16 v[60:63], v[104:107], v[28:31], v[60:63]
    s_waitcnt lgkmcnt(0)
    v_mfma_f32_16x16x32_bf16 v[32:35], v[108:111], v[0:3], v[32:35]
    v_mfma_f32_16x16x32_bf16 v[36:39], v[108:111], v[4:7], v[36:39]
    v_mfma_f32_16x16x32_bf16 v[40:43], v[108:111], v[8:11], v[40:43]
    v_mfma_f32_16x16x32_bf16 v[44:47], v[108:111], v[12:15], v[44:47]
    v_mfma_f32_16x16x32_bf16 v[48:51], v[108:111], v[16:19], v[48:51]
    v_mfma_f32_16x16x32_bf16 v[52:55], v[108:111], v[20:23], v[52:55]
    v_mfma_f32_16x16x32_bf16 v[56:59], v[108:111], v[24:27], v[56:59]
    v_mfma_f32_16x16x32_bf16 v[60:63], v[108:111], v[28:31], v[60:63]
    s_nop 7
    v_cvt_pk_bf16_f32 v112, v32, v36
    v_cvt_pk_bf16_f32 v113, v40, v44
    v_cvt_pk_bf16_f32 v114, v48, v52
    v_cvt_pk_bf16_f32 v115, v56, v60
    buffer_store_dwordx4 v[112:115], v120, s[20:23], s25 offen
    s_add_u32 s25, s25, 2736128
    v_cvt_pk_bf16_f32 v116, v33, v37
    v_cvt_pk_bf16_f32 v117, v41, v45
    v_cvt_pk_bf16_f32 v118, v49, v53
    v_cvt_pk_bf16_f32 v119, v57, v61
    buffer_store_dwordx4 v[116:119], v120, s[20:23], s25 offen
    s_add_u32 s25, s25, 2736128
    v_cvt_pk_bf16_f32 v112, v34, v38
    v_cvt_pk_bf16_f32 v113, v42, v46
    v_cvt_pk_bf16_f32 v114, v50, v54
    v_cvt_pk_bf16_f32 v115, v58, v62
    buffer_store_dwordx4 v[112:115], v120, s[20:23], s25 offen
    s_add_u32 s25, s25, 2736128
    v_cvt_pk_bf16_f32 v116, v35, v39
    v_cvt_pk_bf16_f32 v117, v43, v47
    v_cvt_pk_bf16_f32 v118, v51, v55
    v_cvt_pk_bf16_f32 v119, v59, v63
    buffer_store_dwordx4 v[116:119], v120, s[20:23], s25 offen
    s_add_u32 s25, s25, 2736128
    ds_read_b128 v[96:99], v121 offset:12288
    ds_read_b128 v[100:103], v121 offset:13312
    ds_read_b128 v[104:107], v121 offset:14336
    ds_read_b128 v[108:111], v121 offset:15360
    s_waitcnt lgkmcnt(3)
    v_mfma_f32_16x16x32_bf16 v[32:35], v[96:99], v[64:67], 0
    v_mfma_f32_16x16x32_bf16 v[36:39], v[96:99], v[68:71], 0
    v_mfma_f32_16x16x32_bf16 v[40:43], v[96:99], v[72:75], 0
    v_mfma_f32_16x16x32_bf16 v[44:47], v[96:99], v[76:79], 0
    v_mfma_f32_16x16x32_bf16 v[48:51], v[96:99], v[80:83], 0
    v_mfma_f32_16x16x32_bf16 v[52:55], v[96:99], v[84:87], 0
    v_mfma_f32_16x16x32_bf16 v[56:59], v[96:99], v[88:91], 0
    v_mfma_f32_16x16x32_bf16 v[60:63], v[96:99], v[92:95], 0
    s_waitcnt lgkmcnt(2)
    v_mfma_f32_16x16x32_bf16 v[32:35], v[100:103], v[64:67], v[32:35]
    v_mfma_f32_16x16x32_bf16 v[36:39], v[100:103], v[68:71], v[36:39]
    v_mfma_f32_16x16x32_bf16 v[40:43], v[100:103], v[72:75], v[40:43]
    v_mfma_f32_16x16x32_bf16 v[44:47], v[100:103], v[76:79], v[44:47]
    v_mfma_f32_16x16x32_bf16 v[48:51], v[100:103], v[80:83], v[48:51]
    v_mfma_f32_16x16x32_bf16 v[52:55], v[100:103], v[84:87], v[52:55]
    v_mfma_f32_16x16x32_bf16 v[56:59], v[100:103], v[88:91], v[56:59]
    v_mfma_f32_16x16x32_bf16 v[60:63], v[100:103], v[92:95], v[60:63]
    s_waitcnt lgkmcnt(1)
    v_mfma_f32_16x16x32_bf16 v[32:35], v[104:107], v[0:3], v[32:35]
    v_mfma_f32_16x16x32_bf16 v[36:39], v[104:107], v[4:7], v[36:39]
    v_mfma_f32_16x16x32_bf16 v[40:43], v[104:107], v[8:11], v[40:43]
    v_mfma_f32_16x16x32_bf16 v[44:47], v[104:107], v[12:15], v[44:47]
    v_mfma_f32_16x16x32_bf16 v[48:51], v[104:107], v[16:19], v[48:51]
    v_mfma_f32_16x16x32_bf16 v[52:55], v[104:107], v[20:23], v[52:55]
    v_mfma_f32_16x16x32_bf16 v[56:59], v[104:107], v[24:27], v[56:59]
    v_mfma_f32_16x16x32_bf16 v[60:63], v[104:107], v[28:31], v[60:63]
    s_waitcnt lgkmcnt(0)
    v_mfma_f32_16x16x32_bf16 v[32:35], v[108:111], v[0:3], v[32:35]
    v_mfma_f32_16x16x32_bf16 v[36:39], v[108:111], v[4:7], v[36:39]
    v_mfma_f32_16x16x32_bf16 v[40:43], v[108:111], v[8:11], v[40:43]
    v_mfma_f32_16x16x32_bf16 v[44:47], v[108:111], v[12:15], v[44:47]
    v_mfma_f32_16x16x32_bf16 v[48:51], v[108:111], v[16:19], v[48:51]
    v_mfma_f32_16x16x32_bf16 v[52:55], v[108:111], v[20:23], v[52:55]
    v_mfma_f32_16x16x32_bf16 v[56:59], v[108:111], v[24:27], v[56:59]
    v_mfma_f32_16x16x32_bf16 v[60:63], v[108:111], v[28:31], v[60:63]
    s_nop 7
    v_cvt_pk_bf16_f32 v112, v32, v36
    v_cvt_pk_bf16_f32 v113, v40, v44
    v_cvt_pk_bf16_f32 v114, v48, v52
    v_cvt_pk_bf16_f32 v115, v56, v60
    buffer_store_dwordx4 v[112:115], v120, s[20:23], s25 offen
    s_add_u32 s25, s25, 2736128
    v_cvt_pk_bf16_f32 v116, v33, v37
    v_cvt_pk_bf16_f32 v117, v41, v45
    v_cvt_pk_bf16_f32 v118, v49, v53
    v_cvt_pk_bf16_f32 v119, v57, v61
    buffer_store_dwordx4 v[116:119], v120, s[20:23], s25 offen
    s_add_u32 s25, s25, 2736128
    v_cvt_pk_bf16_f32 v112, v34, v38
    v_cvt_pk_bf16_f32 v113, v42, v46
    v_cvt_pk_bf16_f32 v114, v50, v54
    v_cvt_pk_bf16_f32 v115, v58, v62
    buffer_store_dwordx4 v[112:115], v120, s[20:23], s25 offen
    s_add_u32 s25, s25, 2736128
    v_cvt_pk_bf16_f32 v116, v35, v39
    v_cvt_pk_bf16_f32 v117, v43, v47
    v_cvt_pk_bf16_f32 v118, v51, v55
    v_cvt_pk_bf16_f32 v119, v59, v63
    buffer_store_dwordx4 v[116:119], v120, s[20:23], s25 offen
    s_endpgm
K1_W:
    s_mov_b32 s16, s6
    s_mov_b32 s17, s7
    s_and_b32 s17, s17, 0xffff
    s_mov_b32 s18, 16252928
    s_mov_b32 s19, 0x00020000
    s_add_u32 s20, s8, 50331648
    s_addc_u32 s21, s9, 0
    s_and_b32 s21, s21, 0xffff
    s_mov_b32 s22, 67108864
    s_mov_b32 s23, 0x00020000
    s_mul_i32 s11, s2, 1
    s_lshr_b32 s12, s11, 9
    s_and_b32 s13, s11, 511
    s_lshl_b32 s14, s12, 19
    s_lshl_b32 s15, s13, 10
    s_add_u32 s14, s14, s15
    s_lshl_b32 s15, s3, 8
    s_add_u32 s14, s14, s15
    v_and_b32 v126, 1, v123
    v_lshlrev_b32 v126, 23, v126
    v_lshl_add_u32 v126, v122, 4, v126
    s_mov_b32 s15, s14
    buffer_load_dwordx4 v[0:3], v126, s[16:19], s15 offen
    s_add_u32 s15, s15, 0x100000
    buffer_load_dwordx4 v[4:7], v126, s[16:19], s15 offen
    s_add_u32 s15, s15, 0x100000
    buffer_load_dwordx4 v[8:11], v126, s[16:19], s15 offen
    s_add_u32 s15, s15, 0x100000
    buffer_load_dwordx4 v[12:15], v126, s[16:19], s15 offen
    s_add_u32 s15, s15, 0x100000
    buffer_load_dwordx4 v[16:19], v126, s[16:19], s15 offen
    s_add_u32 s15, s15, 0x100000
    buffer_load_dwordx4 v[20:23], v126, s[16:19], s15 offen
    s_add_u32 s15, s15, 0x100000
    buffer_load_dwordx4 v[24:27], v126, s[16:19], s15 offen
    s_add_u32 s15, s15, 0x100000
    buffer_load_dwordx4 v[28:31], v126, s[16:19], s15 offen
    v_and_b32 v127, 1, v123
    v_lshlrev_b32 v127, 3, v127
    v_mul_u32_u24 v112, 96, v125
    v_mad_u32_u24 v113, v124, v127, v112
    v_mad_u32_u24 v64, v124, 0, v113
    v_mad_u32_u24 v65, v124, 1, v113
    v_mad_u32_u24 v66, v124, 2, v113
    v_mad_u32_u24 v67, v124, 3, v113
    v_mad_u32_u24 v68, v124, 4, v113
    v_mad_u32_u24 v69, v124, 5, v113
    v_mad_u32_u24 v70, v124, 6, v113
    v_mad_u32_u24 v71, v124, 7, v113
    v_and_b32 v64, 127, v64
    v_and_b32 v65, 127, v65
    v_and_b32 v66, 127, v66
    v_and_b32 v67, 127, v67
    v_and_b32 v68, 127, v68
    v_and_b32 v69, 127, v69
    v_and_b32 v70, 127, v70
    v_and_b32 v71, 127, v71
    v_cvt_f32_u32 v64, v64
    v_cvt_f32_u32 v65, v65
    v_cvt_f32_u32 v66, v66
    v_cvt_f32_u32 v67, v67
    v_cvt_f32_u32 v68, v68
    v_cvt_f32_u32 v69, v69
    v_cvt_f32_u32 v70, v70
    v_cvt_f32_u32 v71, v71
    v_mul_f32 v64, 0x3c000000, v64
    v_mul_f32 v65, 0x3c000000, v65
    v_mul_f32 v66, 0x3c000000, v66
    v_mul_f32 v67, 0x3c000000, v67
    v_mul_f32 v68, 0x3c000000, v68
    v_mul_f32 v69, 0x3c000000, v69
    v_mul_f32 v70, 0x3c000000, v70
    v_mul_f32 v71, 0x3c000000, v71
    v_cos_f32 v64, v64
    v_cos_f32 v65, v65
    v_cos_f32 v66, v66
    v_cos_f32 v67, v67
    v_cos_f32 v68, v68
    v_cos_f32 v69, v69
    v_cos_f32 v70, v70
    v_cos_f32 v71, v71
    s_nop 0
    v_cvt_pk_bf16_f32 v72, v64, v65
    v_cvt_pk_bf16_f32 v73, v66, v67
    v_cvt_pk_bf16_f32 v74, v68, v69
    v_cvt_pk_bf16_f32 v75, v70, v71
    v_lshlrev_b32 v80, 16, v72
    v_and_b32 v81, 0xffff0000, v72
    v_sub_f32 v64, v64, v80
    v_sub_f32 v65, v65, v81
    v_lshlrev_b32 v80, 16, v73
    v_and_b32 v81, 0xffff0000, v73
    v_sub_f32 v66, v66, v80
    v_sub_f32 v67, v67, v81
    v_lshlrev_b32 v80, 16, v74
    v_and_b32 v81, 0xffff0000, v74
    v_sub_f32 v68, v68, v80
    v_sub_f32 v69, v69, v81
    v_lshlrev_b32 v80, 16, v75
    v_and_b32 v81, 0xffff0000, v75
    v_sub_f32 v70, v70, v80
    v_sub_f32 v71, v71, v81
    v_cvt_pk_bf16_f32 v76, v64, v65
    v_cvt_pk_bf16_f32 v77, v66, v67
    v_cvt_pk_bf16_f32 v78, v68, v69
    v_cvt_pk_bf16_f32 v79, v70, v71
    v_cmp_lt_u32 vcc, 1, v123
    s_lshl_b32 s24, s3, 10
    v_add_u32 v114, s24, v121
    v_cndmask_b32 v72, v72, v76, vcc
    v_cndmask_b32 v73, v73, v77, vcc
    v_cndmask_b32 v74, v74, v78, vcc
    v_cndmask_b32 v75, v75, v79, vcc
    ds_write_b128 v114, v[72:75]
    v_lshrrev_b32 v112, 1, v123
    s_mov_b32 s24, 2097152
    v_mul_lo_u32 v112, v112, s24
    v_and_b32 v113, 1, v123
    v_lshl_add_u32 v112, v113, 8, v112
    v_and_b32 v113, 1, v122
    v_lshl_add_u32 v124, v113, 4, v112
    v_lshrrev_b32 v125, 1, v122
    s_mul_i32 s26, s3, 524288
    s_lshl_b32 s24, s11, 9
    s_add_u32 s26, s26, s24
    s_waitcnt lgkmcnt(0)
    s_barrier
    ds_read_b128 v[96:99], v121 offset:0
    ds_read_b128 v[100:103], v121 offset:1024
    ds_read_b128 v[104:107], v121 offset:2048
    ds_read_b128 v[108:111], v121 offset:3072
    s_mov_b32 s27, 0
    s_waitcnt vmcnt(0) lgkmcnt(0)
K1_W_LOOP:
    s_add_u32 s24, s11, s27
    s_and_b32 s30, s24, 3
    s_lshr_b32 s24, s24, 1
    s_and_b32 s24, s24, 4
    s_or_b32 s30, s30, s24
    v_xor_b32 v112, s30, v125
    v_lshl_add_u32 v120, v112, 5, v124
    s_lshl_b32 s25, s27, 9
    s_add_u32 s25, s25, s26
    v_perm_b32 v32, v4, v0, s28
    v_perm_b32 v36, v4, v0, s29
    v_perm_b32 v33, v12, v8, s28
    v_perm_b32 v37, v12, v8, s29
    v_perm_b32 v34, v20, v16, s28
    v_perm_b32 v38, v20, v16, s29
    v_perm_b32 v35, v28, v24, s28
    v_perm_b32 v39, v28, v24, s29
    v_perm_b32 v40, v5, v1, s28
    v_perm_b32 v44, v5, v1, s29
    v_perm_b32 v41, v13, v9, s28
    v_perm_b32 v45, v13, v9, s29
    v_perm_b32 v42, v21, v17, s28
    v_perm_b32 v46, v21, v17, s29
    v_perm_b32 v43, v29, v25, s28
    v_perm_b32 v47, v29, v25, s29
    v_perm_b32 v48, v6, v2, s28
    v_perm_b32 v52, v6, v2, s29
    v_perm_b32 v49, v14, v10, s28
    v_perm_b32 v53, v14, v10, s29
    v_perm_b32 v50, v22, v18, s28
    v_perm_b32 v54, v22, v18, s29
    v_perm_b32 v51, v30, v26, s28
    v_perm_b32 v55, v30, v26, s29
    v_perm_b32 v56, v7, v3, s28
    v_perm_b32 v60, v7, v3, s29
    v_perm_b32 v57, v15, v11, s28
    v_perm_b32 v61, v15, v11, s29
    v_perm_b32 v58, v23, v19, s28
    v_perm_b32 v62, v23, v19, s29
    v_perm_b32 v59, v31, v27, s28
    v_perm_b32 v63, v31, v27, s29
    s_add_u32 s27, s27, 1
    s_add_u32 s14, s14, 1024
    s_cmp_ge_u32 s27, 1
    s_cbranch_scc1 K1_W_NOLOAD
    s_mov_b32 s15, s14
    buffer_load_dwordx4 v[0:3], v126, s[16:19], s15 offen
    s_add_u32 s15, s15, 0x100000
    buffer_load_dwordx4 v[4:7], v126, s[16:19], s15 offen
    s_add_u32 s15, s15, 0x100000
    buffer_load_dwordx4 v[8:11], v126, s[16:19], s15 offen
    s_add_u32 s15, s15, 0x100000
    buffer_load_dwordx4 v[12:15], v126, s[16:19], s15 offen
    s_add_u32 s15, s15, 0x100000
    buffer_load_dwordx4 v[16:19], v126, s[16:19], s15 offen
    s_add_u32 s15, s15, 0x100000
    buffer_load_dwordx4 v[20:23], v126, s[16:19], s15 offen
    s_add_u32 s15, s15, 0x100000
    buffer_load_dwordx4 v[24:27], v126, s[16:19], s15 offen
    s_add_u32 s15, s15, 0x100000
    buffer_load_dwordx4 v[28:31], v126, s[16:19], s15 offen
K1_W_NOLOAD:
    v_mfma_f32_16x16x32_bf16 v[64:67], v[96:99], v[32:35], 0
    v_mfma_f32_16x16x32_bf16 v[68:71], v[96:99], v[36:39], 0
    v_mfma_f32_16x16x32_bf16 v[72:75], v[96:99], v[40:43], 0
    v_mfma_f32_16x16x32_bf16 v[76:79], v[96:99], v[44:47], 0
    v_mfma_f32_16x16x32_bf16 v[80:83], v[96:99], v[48:51], 0
    v_mfma_f32_16x16x32_bf16 v[84:87], v[96:99], v[52:55], 0
    v_mfma_f32_16x16x32_bf16 v[88:91], v[96:99], v[56:59], 0
    v_mfma_f32_16x16x32_bf16 v[92:95], v[96:99], v[60:63], 0
    s_nop 7
    v_cvt_pk_bf16_f32 v112, v64, v68
    v_cvt_pk_bf16_f32 v113, v72, v76
    v_cvt_pk_bf16_f32 v114, v80, v84
    v_cvt_pk_bf16_f32 v115, v88, v92
    buffer_store_dwordx4 v[112:115], v120, s[20:23], s25 offen
    s_add_u32 s25, s25, 4194304
    v_cvt_pk_bf16_f32 v116, v65, v69
    v_cvt_pk_bf16_f32 v117, v73, v77
    v_cvt_pk_bf16_f32 v118, v81, v85
    v_cvt_pk_bf16_f32 v119, v89, v93
    buffer_store_dwordx4 v[116:119], v120, s[20:23], s25 offen
    s_add_u32 s25, s25, 4194304
    v_cvt_pk_bf16_f32 v112, v66, v70
    v_cvt_pk_bf16_f32 v113, v74, v78
    v_cvt_pk_bf16_f32 v114, v82, v86
    v_cvt_pk_bf16_f32 v115, v90, v94
    buffer_store_dwordx4 v[112:115], v120, s[20:23], s25 offen
    s_add_u32 s25, s25, 4194304
    v_cvt_pk_bf16_f32 v116, v67, v71
    v_cvt_pk_bf16_f32 v117, v75, v79
    v_cvt_pk_bf16_f32 v118, v83, v87
    v_cvt_pk_bf16_f32 v119, v91, v95
    buffer_store_dwordx4 v[116:119], v120, s[20:23], s25 offen
    s_add_u32 s25, s25, 4194304
    v_mfma_f32_16x16x32_bf16 v[64:67], v[100:103], v[32:35], 0
    v_mfma_f32_16x16x32_bf16 v[68:71], v[100:103], v[36:39], 0
    v_mfma_f32_16x16x32_bf16 v[72:75], v[100:103], v[40:43], 0
    v_mfma_f32_16x16x32_bf16 v[76:79], v[100:103], v[44:47], 0
    v_mfma_f32_16x16x32_bf16 v[80:83], v[100:103], v[48:51], 0
    v_mfma_f32_16x16x32_bf16 v[84:87], v[100:103], v[52:55], 0
    v_mfma_f32_16x16x32_bf16 v[88:91], v[100:103], v[56:59], 0
    v_mfma_f32_16x16x32_bf16 v[92:95], v[100:103], v[60:63], 0
    s_nop 7
    v_cvt_pk_bf16_f32 v112, v64, v68
    v_cvt_pk_bf16_f32 v113, v72, v76
    v_cvt_pk_bf16_f32 v114, v80, v84
    v_cvt_pk_bf16_f32 v115, v88, v92
    buffer_store_dwordx4 v[112:115], v120, s[20:23], s25 offen
    s_add_u32 s25, s25, 4194304
    v_cvt_pk_bf16_f32 v116, v65, v69
    v_cvt_pk_bf16_f32 v117, v73, v77
    v_cvt_pk_bf16_f32 v118, v81, v85
    v_cvt_pk_bf16_f32 v119, v89, v93
    buffer_store_dwordx4 v[116:119], v120, s[20:23], s25 offen
    s_add_u32 s25, s25, 4194304
    v_cvt_pk_bf16_f32 v112, v66, v70
    v_cvt_pk_bf16_f32 v113, v74, v78
    v_cvt_pk_bf16_f32 v114, v82, v86
    v_cvt_pk_bf16_f32 v115, v90, v94
    buffer_store_dwordx4 v[112:115], v120, s[20:23], s25 offen
    s_add_u32 s25, s25, 4194304
    v_cvt_pk_bf16_f32 v116, v67, v71
    v_cvt_pk_bf16_f32 v117, v75, v79
    v_cvt_pk_bf16_f32 v118, v83, v87
    v_cvt_pk_bf16_f32 v119, v91, v95
    buffer_store_dwordx4 v[116:119], v120, s[20:23], s25 offen
    s_add_u32 s25, s25, 4194304
    v_mfma_f32_16x16x32_bf16 v[64:67], v[104:107], v[32:35], 0
    v_mfma_f32_16x16x32_bf16 v[68:71], v[104:107], v[36:39], 0
    v_mfma_f32_16x16x32_bf16 v[72:75], v[104:107], v[40:43], 0
    v_mfma_f32_16x16x32_bf16 v[76:79], v[104:107], v[44:47], 0
    v_mfma_f32_16x16x32_bf16 v[80:83], v[104:107], v[48:51], 0
    v_mfma_f32_16x16x32_bf16 v[84:87], v[104:107], v[52:55], 0
    v_mfma_f32_16x16x32_bf16 v[88:91], v[104:107], v[56:59], 0
    v_mfma_f32_16x16x32_bf16 v[92:95], v[104:107], v[60:63], 0
    s_nop 7
    v_cvt_pk_bf16_f32 v112, v64, v68
    v_cvt_pk_bf16_f32 v113, v72, v76
    v_cvt_pk_bf16_f32 v114, v80, v84
    v_cvt_pk_bf16_f32 v115, v88, v92
    buffer_store_dwordx4 v[112:115], v120, s[20:23], s25 offen
    s_add_u32 s25, s25, 4194304
    v_cvt_pk_bf16_f32 v116, v65, v69
    v_cvt_pk_bf16_f32 v117, v73, v77
    v_cvt_pk_bf16_f32 v118, v81, v85
    v_cvt_pk_bf16_f32 v119, v89, v93
    buffer_store_dwordx4 v[116:119], v120, s[20:23], s25 offen
    s_add_u32 s25, s25, 4194304
    v_cvt_pk_bf16_f32 v112, v66, v70
    v_cvt_pk_bf16_f32 v113, v74, v78
    v_cvt_pk_bf16_f32 v114, v82, v86
    v_cvt_pk_bf16_f32 v115, v90, v94
    buffer_store_dwordx4 v[112:115], v120, s[20:23], s25 offen
    s_add_u32 s25, s25, 4194304
    v_cvt_pk_bf16_f32 v116, v67, v71
    v_cvt_pk_bf16_f32 v117, v75, v79
    v_cvt_pk_bf16_f32 v118, v83, v87
    v_cvt_pk_bf16_f32 v119, v91, v95
    buffer_store_dwordx4 v[116:119], v120, s[20:23], s25 offen
    s_add_u32 s25, s25, 4194304
    v_mfma_f32_16x16x32_bf16 v[64:67], v[108:111], v[32:35], 0
    v_mfma_f32_16x16x32_bf16 v[68:71], v[108:111], v[36:39], 0
    v_mfma_f32_16x16x32_bf16 v[72:75], v[108:111], v[40:43], 0
    v_mfma_f32_16x16x32_bf16 v[76:79], v[108:111], v[44:47], 0
    v_mfma_f32_16x16x32_bf16 v[80:83], v[108:111], v[48:51], 0
    v_mfma_f32_16x16x32_bf16 v[84:87], v[108:111], v[52:55], 0
    v_mfma_f32_16x16x32_bf16 v[88:91], v[108:111], v[56:59], 0
    v_mfma_f32_16x16x32_bf16 v[92:95], v[108:111], v[60:63], 0
    s_nop 7
    v_cvt_pk_bf16_f32 v112, v64, v68
    v_cvt_pk_bf16_f32 v113, v72, v76
    v_cvt_pk_bf16_f32 v114, v80, v84
    v_cvt_pk_bf16_f32 v115, v88, v92
    buffer_store_dwordx4 v[112:115], v120, s[20:23], s25 offen
    s_add_u32 s25, s25, 4194304
    v_cvt_pk_bf16_f32 v116, v65, v69
    v_cvt_pk_bf16_f32 v117, v73, v77
    v_cvt_pk_bf16_f32 v118, v81, v85
    v_cvt_pk_bf16_f32 v119, v89, v93
    buffer_store_dwordx4 v[116:119], v120, s[20:23], s25 offen
    s_add_u32 s25, s25, 4194304
    v_cvt_pk_bf16_f32 v112, v66, v70
    v_cvt_pk_bf16_f32 v113, v74, v78
    v_cvt_pk_bf16_f32 v114, v82, v86
    v_cvt_pk_bf16_f32 v115, v90, v94
    buffer_store_dwordx4 v[112:115], v120, s[20:23], s25 offen
    s_add_u32 s25, s25, 4194304
    v_cvt_pk_bf16_f32 v116, v67, v71
    v_cvt_pk_bf16_f32 v117, v75, v79
    v_cvt_pk_bf16_f32 v118, v83, v87
    v_cvt_pk_bf16_f32 v119, v91, v95
    buffer_store_dwordx4 v[116:119], v120, s[20:23], s25 offen
    s_waitcnt vmcnt(16)
    s_cmp_lt_u32 s27, 1
    s_cbranch_scc1 K1_W_LOOP
K1_END:
    s_endpgm
.p2align 8
.type k12_fused_kernel,@function
k12_fused_kernel:
    s_cmp_ge_u32 s2, 256
    s_cbranch_scc1 K12_END
    s_load_dwordx4 s[52:55], s[0:1], 0
    s_load_dwordx4 s[56:59], s[0:1], 40
    s_getpc_b64 s[90:91]
CPF_K12:
    s_sub_u32 s90, s90, CPF_K12-k12_fused_kernel
    s_subb_u32 s91, s91, 0
    v_lshlrev_b32 v8, 7, v0
    v_mov_b32 v11, s91
    v_min_u32 v9, TEXT_END-k12_fused_kernel-4, v8
    v_add_co_u32 v10, vcc, s90, v9
    v_addc_co_u32 v11, vcc, 0, v11, vcc
    global_load_dword v63, v[10:11], off
    v_lshrrev_b32 v1, 6, v0
    v_and_b32 v2, 63, v0
    v_readfirstlane_b32 s3, v1
    s_waitcnt lgkmcnt(0)
    s_cmp_lt_u32 s3, 4
    s_cbranch_scc1 K12_CONS
    v_and_b32 v64, 15, v2
    v_lshrrev_b32 v65, 4, v2
    v_lshlrev_b32 v254, 4, v2
    s_and_b32 s44, s3, 3
    s_and_b32 s20, s44, 1
    s_lshr_b32 s21, s44, 1
    s_lshl_b32 s22, s2, 1
    s_add_u32 s22, s22, s21
    s_and_b32 s23, s22, 3
    s_lshr_b32 s22, s22, 2
    s_and_b32 s24, s2, 7
    s_lshl_b32 s24, s24, 5
    s_lshr_b32 s25, s2, 3
    s_add_u32 s24, s24, s25
    s_cmp_ge_u32 s24, 167
    s_cselect_b32 s25, 1, 0
    s_mul_i32 s26, s25, 167
    s_sub_u32 s24, s24, s26
    s_cmp_eq_u32 s21, 0
    s_cselect_b32 s25, s25, 1
    s_mul_i32 s26, s25, 16384000
    s_add_u32 s4, s52, s26
    s_addc_u32 s5, s53, 0
    s_and_b32 s5, s5, 0xffff
    s_mov_b32 s6, 16384000
    s_mov_b32 s7, 0x00020000
    s_mov_b32 s8, s54
    s_mov_b32 s9, s55
    s_and_b32 s9, s9, 0xffff
    s_mov_b32 s10, 16252928
    s_mov_b32 s11, 0x00020000
    s_mov_b32 s12, s58
    s_mov_b32 s13, s59
    s_and_b32 s13, s13, 0xffff
    s_mov_b32 s14, 43778048
    s_mov_b32 s15, 0x00020000
    s_add_u32 s16, s58, 50331648
    s_addc_u32 s17, s59, 0
    s_and_b32 s17, s17, 0xffff
    s_mov_b32 s18, 67108864
    s_mov_b32 s19, 0x00020000
    s_add_u32 s60, s58, 153092096
    s_addc_u32 s61, s59, 0
    s_and_b32 s61, s61, 0xffff
    s_mov_b32 s62, 32768
    s_mov_b32 s63, 0x00020000
    s_mov_b32 s28, 0x05040100
    s_mov_b32 s29, 0x07060302
    v_lshlrev_b32 v248, 14, v65
    v_lshl_add_u32 v248, v64, 4, v248
    v_and_b32 v250, 1, v65
    v_lshlrev_b32 v250, 23, v250
    v_lshl_add_u32 v250, v64, 4, v250
    v_lshrrev_b32 v66, 1, v65
    s_mov_b32 s26, 1368064
    v_mul_lo_u32 v66, v66, s26
    v_lshrrev_b32 v67, 2, v64
    s_mov_b32 s26, 21376
    v_mul_lo_u32 v67, v67, s26
    v_add_u32 v66, v66, v67
    v_mov_b32 v252, v66
    v_lshrrev_b32 v66, 1, v65
    s_mov_b32 s26, 2097152
    v_mul_lo_u32 v66, v66, s26
    v_and_b32 v67, 1, v65
    v_lshl_add_u32 v66, v67, 8, v66
    v_and_b32 v67, 1, v64
    v_lshl_add_u32 v251, v67, 4, v66
    s_mul_i32 s31, s25, 684032
    s_mul_i32 s32, s23, 524288
    s_lshl_b32 s33, s23, 8
    s_mov_b32 s40, 3
    s_xor_b32 s43, s40, s20
    s_and_b32 s43, s43, 1
    s_mul_i32 s36, s40, 85
    s_add_u32 s36, s36, s2
    s_and_b32 s36, s36, 255
    s_mul_hi_u32 s37, s36, 0x55555556
    s_mul_i32 s38, s37, 3
    s_cmp_eq_u32 s38, s36
    s_cselect_b32 s27, 1, 0
    s_cmp_lt_u32 s37, 78
    s_cselect_b32 s27, s27, 0
    s_add_u32 s37, s37, 89
    s_cmp_eq_u32 s21, 0
    s_cselect_b32 s30, s24, s37
    s_cselect_b32 s27, 1, s27
    s_cmp_eq_u32 s43, 0
    s_cbranch_scc0 K12_PL1
    s_lshl_b32 s36, s40, 7
    s_add_u32 s36, s36, s22
    s_lshr_b32 s37, s36, 9
    s_lshl_b32 s37, s37, 19
    s_and_b32 s36, s36, 511
    s_lshl_b32 s36, s36, 10
    s_add_u32 s36, s36, s37
    s_add_u32 s36, s36, s33
    buffer_load_dwordx4 v[96:99], v250, s[8:11], s36 offen
    s_add_u32 s36, s36, 0x100000
    buffer_load_dwordx4 v[100:103], v250, s[8:11], s36 offen
    s_add_u32 s36, s36, 0x100000
    buffer_load_dwordx4 v[104:107], v250, s[8:11], s36 offen
    s_add_u32 s36, s36, 0x100000
    buffer_load_dwordx4 v[108:111], v250, s[8:11], s36 offen
    s_add_u32 s36, s36, 0x100000
    buffer_load_dwordx4 v[112:115], v250, s[8:11], s36 offen
    s_add_u32 s36, s36, 0x100000
    buffer_load_dwordx4 v[116:119], v250, s[8:11], s36 offen
    s_add_u32 s36, s36, 0x100000
    buffer_load_dwordx4 v[120:123], v250, s[8:11], s36 offen
    s_add_u32 s36, s36, 0x100000
    buffer_load_dwordx4 v[124:127], v250, s[8:11], s36 offen
    s_branch K12_PL2
K12_PL1:
    s_cmp_eq_u32 s27, 0
    s_cbranch_scc1 K12_PL2
    s_lshl_b32 s36, s40, 8
    s_mul_i32 s37, s30, 98304
    s_add_u32 s36, s36, s37
    buffer_load_dwordx4 v[0:3], v248, s[4:7], s36 offen
    buffer_load_dwordx4 v[4:7], v248, s[4:7], s36 offen offset:2048
    s_add_u32 s36, s36, 4096
    buffer_load_dwordx4 v[8:11], v248, s[4:7], s36 offen
    buffer_load_dwordx4 v[12:15], v248, s[4:7], s36 offen offset:2048
    s_add_u32 s36, s36, 4096
    buffer_load_dwordx4 v[16:19], v248, s[4:7], s36 offen
    buffer_load_dwordx4 v[20:23], v248, s[4:7], s36 offen offset:2048
    s_add_u32 s36, s36, 4096
    buffer_load_dwordx4 v[24:27], v248, s[4:7], s36 offen
    buffer_load_dwordx4 v[28:31], v248, s[4:7], s36 offen offset:2048
    s_add_u32 s36, s36, 53248
    buffer_load_dwordx4 v[32:35], v248, s[4:7], s36 offen
    buffer_load_dwordx4 v[36:39], v248, s[4:7], s36 offen offset:2048
    s_add_u32 s36, s36, 4096
    buffer_load_dwordx4 v[40:43], v248, s[4:7], s36 offen
    buffer_load_dwordx4 v[44:47], v248, s[4:7], s36 offen offset:2048
    s_add_u32 s36, s36, 4096
    buffer_load_dwordx4 v[48:51], v248, s[4:7], s36 offen
    buffer_load_dwordx4 v[52:55], v248, s[4:7], s36 offen offset:2048
    s_add_u32 s36, s36, 4096
    buffer_load_dwordx4 v[56:59], v248, s[4:7], s36 offen
    buffer_load_dwordx4 v[60:63], v248, s[4:7], s36 offen offset:2048
K12_PL2:
    v_lshrrev_b32 v128, 4, v254
    v_lshlrev_b32 v129, 11, v128
    v_lshrrev_b32 v130, 1, v128
    v_lshlrev_b32 v130, 20, v130
    v_and_b32 v131, 1, v128
    v_lshl_add_u32 v130, v131, 7, v130
    s_mov_b32 s45, s27
    s_mov_b32 s46, s30
    s_add_u32 s47, s40, 1
K12_TCH:
    s_xor_b32 s48, s47, s20
    s_and_b32 s48, s48, 1
    s_cmp_eq_u32 s48, 0
    s_cbranch_scc1 K12_TCHW
    s_mul_i32 s36, s47, 85
    s_add_u32 s36, s36, s2
    s_and_b32 s36, s36, 255
    s_mul_hi_u32 s37, s36, 0x55555556
    s_mul_i32 s38, s37, 3
    s_cmp_eq_u32 s38, s36
    s_cselect_b32 s27, 1, 0
    s_cmp_lt_u32 s37, 78
    s_cselect_b32 s27, s27, 0
    s_add_u32 s37, s37, 89
    s_cmp_eq_u32 s21, 0
    s_cselect_b32 s30, s24, s37
    s_cselect_b32 s27, 1, s27
    s_cmp_eq_u32 s27, 0
    s_cbranch_scc1 K12_TCHN
    s_lshl_b32 s36, s47, 8
    s_mul_i32 s37, s30, 98304
    s_add_u32 s36, s36, s37
    buffer_load_dword v244, v129, s[4:7], s36 offen
    buffer_load_dword v245, v129, s[4:7], s36 offen offset:128
    s_branch K12_TCHN
K12_TCHW:
    s_lshl_b32 s36, s47, 7
    s_add_u32 s36, s36, s22
    s_lshr_b32 s37, s36, 9
    s_lshl_b32 s37, s37, 19
    s_and_b32 s36, s36, 511
    s_lshl_b32 s36, s36, 10
    s_add_u32 s36, s36, s37
    s_add_u32 s36, s36, s33
    s_mov_b64 exec, 0xffffffff
    buffer_load_dword v246, v130, s[8:11], s36 offen
    s_mov_b64 exec, -1
K12_TCHN:
    s_add_u32 s47, s47, 1
    s_cmp_lt_u32 s47, 8
    s_cbranch_scc1 K12_TCH
    s_mov_b32 s27, s45
    s_mov_b32 s30, s46
    v_and_b32 v128, 3, v64
    v_lshlrev_b32 v128, 2, v128
    v_lshrrev_b32 v130, 3, v64
    v_lshl_add_u32 v128, v130, 1, v128
    s_lshl_b32 s36, s44, 4
    s_add_u32 s36, s36, 1
    v_add_u32 v128, s36, v128
    v_bfe_u32 v129, v64, 2, 1
    v_lshlrev_b32 v131, 3, v65
    v_lshlrev_b32 v132, 5, v129
    v_mad_u32_u24 v133, v128, v131, v132
    v_mad_u32_u24 v136, v128, 0, v133
    v_mad_u32_u24 v137, v128, 1, v133
    v_mad_u32_u24 v138, v128, 2, v133
    v_mad_u32_u24 v139, v128, 3, v133
    v_mad_u32_u24 v140, v128, 4, v133
    v_mad_u32_u24 v141, v128, 5, v133
    v_mad_u32_u24 v142, v128, 6, v133
    v_mad_u32_u24 v143, v128, 7, v133
    v_and_b32 v136, 127, v136
    v_and_b32 v137, 127, v137
    v_and_b32 v138, 127, v138
    v_and_b32 v139, 127, v139
    v_and_b32 v140, 127, v140
    v_and_b32 v141, 127, v141
    v_and_b32 v142, 127, v142
    v_and_b32 v143, 127, v143
    v_cvt_f32_u32 v136, v136
    v_cvt_f32_u32 v137, v137
    v_cvt_f32_u32 v138, v138
    v_cvt_f32_u32 v139, v139
    v_cvt_f32_u32 v140, v140
    v_cvt_f32_u32 v141, v141
    v_cvt_f32_u32 v142, v142
    v_cvt_f32_u32 v143, v143
    v_mul_f32 v136, 0x3c000000, v136
    v_mul_f32 v137, 0x3c000000, v137
    v_mul_f32 v138, 0x3c000000, v138
    v_mul_f32 v139, 0x3c000000, v139
    v_mul_f32 v140, 0x3c000000, v140
    v_mul_f32 v141, 0x3c000000, v141
    v_mul_f32 v142, 0x3c000000, v142
    v_mul_f32 v143, 0x3c000000, v143
    v_cos_f32 v136, v136
    v_cos_f32 v137, v137
    v_cos_f32 v138, v138
    v_cos_f32 v139, v139
    v_cos_f32 v140, v140
    v_cos_f32 v141, v141
    v_cos_f32 v142, v142
    v_cos_f32 v143, v143
    s_nop 0
    v_cvt_pk_bf16_f32 v144, v136, v137
    v_cvt_pk_bf16_f32 v145, v138, v139
    v_cvt_pk_bf16_f32 v146, v140, v141
    v_cvt_pk_bf16_f32 v147, v142, v143
    v_lshlrev_b32 v152, 16, v144
    v_and_b32 v153, 0xffff0000, v144
    v_sub_f32 v136, v136, v152
    v_sub_f32 v137, v137, v153
    v_lshlrev_b32 v152, 16, v145
    v_and_b32 v153, 0xffff0000, v145
    v_sub_f32 v138, v138, v152
    v_sub_f32 v139, v139, v153
    v_lshlrev_b32 v152, 16, v146
    v_and_b32 v153, 0xffff0000, v146
    v_sub_f32 v140, v140, v152
    v_sub_f32 v141, v141, v153
    v_lshlrev_b32 v152, 16, v147
    v_and_b32 v153, 0xffff0000, v147
    v_sub_f32 v142, v142, v152
    v_sub_f32 v143, v143, v153
    v_cvt_pk_bf16_f32 v148, v136, v137
    v_cvt_pk_bf16_f32 v149, v138, v139
    v_cvt_pk_bf16_f32 v150, v140, v141
    v_cvt_pk_bf16_f32 v151, v142, v143
    s_lshl_b32 s37, s44, 12
    s_add_u32 s37, s37, 116736
    v_add_u32 v132, s37, v254
    ds_write_b128 v132, v[144:147]
    ds_write_b128 v132, v[148:151] offset:1024
    v_add_u32 v131, 32, v131
    v_lshlrev_b32 v132, 5, v129
    v_mad_u32_u24 v133, v128, v131, v132
    v_mad_u32_u24 v136, v128, 0, v133
    v_mad_u32_u24 v137, v128, 1, v133
    v_mad_u32_u24 v138, v128, 2, v133
    v_mad_u32_u24 v139, v128, 3, v133
    v_mad_u32_u24 v140, v128, 4, v133
    v_mad_u32_u24 v141, v128, 5, v133
    v_mad_u32_u24 v142, v128, 6, v133
    v_mad_u32_u24 v143, v128, 7, v133
    v_and_b32 v136, 127, v136
    v_and_b32 v137, 127, v137
    v_and_b32 v138, 127, v138
    v_and_b32 v139, 127, v139
    v_and_b32 v140, 127, v140
    v_and_b32 v141, 127, v141
    v_and_b32 v142, 127, v142
    v_and_b32 v143, 127, v143
    v_cvt_f32_u32 v136, v136
    v_cvt_f32_u32 v137, v137
    v_cvt_f32_u32 v138, v138
    v_cvt_f32_u32 v139, v139
    v_cvt_f32_u32 v140, v140
    v_cvt_f32_u32 v141, v141
    v_cvt_f32_u32 v142, v142
    v_cvt_f32_u32 v143, v143
    v_mul_f32 v136, 0x3c000000, v136
    v_mul_f32 v137, 0x3c000000, v137
    v_mul_f32 v138, 0x3c000000, v138
    v_mul_f32 v139, 0x3c000000, v139
    v_mul_f32 v140, 0x3c000000, v140
    v_mul_f32 v141, 0x3c000000, v141
    v_mul_f32 v142, 0x3c000000, v142
    v_mul_f32 v143, 0x3c000000, v143
    v_cos_f32 v136, v136
    v_cos_f32 v137, v137
    v_cos_f32 v138, v138
    v_cos_f32 v139, v139
    v_cos_f32 v140, v140
    v_cos_f32 v141, v141
    v_cos_f32 v142, v142
    v_cos_f32 v143, v143
    s_nop 0
    v_cvt_pk_bf16_f32 v144, v136, v137
    v_cvt_pk_bf16_f32 v145, v138, v139
    v_cvt_pk_bf16_f32 v146, v140, v141
    v_cvt_pk_bf16_f32 v147, v142, v143
    v_lshlrev_b32 v152, 16, v144
    v_and_b32 v153, 0xffff0000, v144
    v_sub_f32 v136, v136, v152
    v_sub_f32 v137, v137, v153
    v_lshlrev_b32 v152, 16, v145
    v_and_b32 v153, 0xffff0000, v145
    v_sub_f32 v138, v138, v152
    v_sub_f32 v139, v139, v153
    v_lshlrev_b32 v152, 16, v146
    v_and_b32 v153, 0xffff0000, v146
    v_sub_f32 v140, v140, v152
    v_sub_f32 v141, v141, v153
    v_lshlrev_b32 v152, 16, v147
    v_and_b32 v153, 0xffff0000, v147
    v_sub_f32 v142, v142, v152
    v_sub_f32 v143, v143, v153
    v_cvt_pk_bf16_f32 v148, v136, v137
    v_cvt_pk_bf16_f32 v149, v138, v139
    v_cvt_pk_bf16_f32 v150, v140, v141
    v_cvt_pk_bf16_f32 v151, v142, v143
    s_lshl_b32 s37, s44, 12
    s_add_u32 s37, s37, 118784
    v_add_u32 v132, s37, v254
    ds_write_b128 v132, v[144:147]
    ds_write_b128 v132, v[148:151] offset:1024
K12_TB:
    s_waitcnt lgkmcnt(0)
    s_barrier
    v_add_u32 v255, 116736, v254
    ds_read_b128 v[160:163], v255 offset:0
    ds_read_b128 v[192:195], v255 offset:1024
    ds_read_b128 v[164:167], v255 offset:2048
    ds_read_b128 v[196:199], v255 offset:3072
    ds_read_b128 v[168:171], v255 offset:4096
    ds_read_b128 v[200:203], v255 offset:5120
    ds_read_b128 v[172:175], v255 offset:6144
    ds_read_b128 v[204:207], v255 offset:7168
    s_waitcnt lgkmcnt(0)
    ds_read_b128 v[176:179], v255 offset:8192
    ds_read_b128 v[208:211], v255 offset:9216
    ds_read_b128 v[180:183], v255 offset:10240
    ds_read_b128 v[212:215], v255 offset:11264
    ds_read_b128 v[184:187], v255 offset:12288
    ds_read_b128 v[216:219], v255 offset:13312
    ds_read_b128 v[188:191], v255 offset:14336
    ds_read_b128 v[220:223], v255 offset:15360
    ds_read_b128 v[224:227], v255 offset:16384
    ds_read_b128 v[228:231], v255 offset:17408
    ds_read_b128 v[232:235], v255 offset:18432
    ds_read_b128 v[236:239], v255 offset:19456
    s_waitcnt lgkmcnt(0)
    s_barrier
    s_waitcnt vmcnt(0) lgkmcnt(0)
    s_mov_b32 s41, -1
    s_mov_b32 s34, -1
    s_branch K12_PROD
    s_cmp_lt_u32 s3, 4
    s_cbranch_scc0 K12_PROD
    s_cmp_eq_u32 s43, 0
    s_cbranch_scc0 K12_H1
    v_perm_b32 v64, v100, v96, s28
    v_perm_b32 v68, v100, v96, s29
    v_perm_b32 v65, v108, v104, s28
    v_perm_b32 v69, v108, v104, s29
    v_perm_b32 v66, v116, v112, s28
    v_perm_b32 v70, v116, v112, s29
    v_perm_b32 v67, v124, v120, s28
    v_perm_b32 v71, v124, v120, s29
    v_perm_b32 v72, v101, v97, s28
    v_perm_b32 v76, v101, v97, s29
    v_perm_b32 v73, v109, v105, s28
    v_perm_b32 v77, v109, v105, s29
    v_perm_b32 v74, v117, v113, s28
    v_perm_b32 v78, v117, v113, s29
    v_perm_b32 v75, v125, v121, s28
    v_perm_b32 v79, v125, v121, s29
    v_perm_b32 v80, v102, v98, s28
    v_perm_b32 v84, v102, v98, s29
    v_perm_b32 v81, v110, v106, s28
    v_perm_b32 v85, v110, v106, s29
    v_perm_b32 v82, v118, v114, s28
    v_perm_b32 v86, v118, v114, s29
    v_perm_b32 v83, v126, v122, s28
    v_perm_b32 v87, v126, v122, s29
    v_perm_b32 v88, v103, v99, s28
    v_perm_b32 v92, v103, v99, s29
    v_perm_b32 v89, v111, v107, s28
    v_perm_b32 v93, v111, v107, s29
    v_perm_b32 v90, v119, v115, s28
    v_perm_b32 v94, v119, v115, s29
    v_perm_b32 v91, v127, v123, s28
    v_perm_b32 v95, v127, v123, s29
    s_lshl_b32 s36, s40, 7
    s_add_u32 s36, s36, s22
    s_and_b32 s37, s36, 3
    s_lshr_b32 s38, s36, 1
    s_and_b32 s38, s38, 4
    s_or_b32 s37, s37, s38
    v_bfe_u32 v253, v254, 5, 3
    v_xor_b32 v253, s37, v253
    v_lshl_add_u32 v253, v253, 5, v251
    s_lshl_b32 s36, s36, 9
    s_add_u32 s39, s36, s32
    v_mfma_f32_16x16x32_bf16 v[128:131], v[224:227], v[64:67], 0
    v_mfma_f32_16x16x32_bf16 v[132:135], v[224:227], v[68:71], 0
    v_mfma_f32_16x16x32_bf16 v[136:139], v[224:227], v[72:75], 0
    v_mfma_f32_16x16x32_bf16 v[140:143], v[224:227], v[76:79], 0
    v_mfma_f32_16x16x32_bf16 v[144:147], v[224:227], v[80:83], 0
    v_mfma_f32_16x16x32_bf16 v[148:151], v[224:227], v[84:87], 0
    v_mfma_f32_16x16x32_bf16 v[152:155], v[224:227], v[88:91], 0
    v_mfma_f32_16x16x32_bf16 v[156:159], v[224:227], v[92:95], 0
    s_nop 7
    v_cvt_pk_bf16_f32 v240, v128, v132
    v_cvt_pk_bf16_f32 v241, v136, v140
    v_cvt_pk_bf16_f32 v242, v144, v148
    v_cvt_pk_bf16_f32 v243, v152, v156
    buffer_store_dwordx4 v[240:243], v253, s[16:19], s39 offen sc1
    s_add_u32 s39, s39, 4194304
    v_cvt_pk_bf16_f32 v244, v129, v133
    v_cvt_pk_bf16_f32 v245, v137, v141
    v_cvt_pk_bf16_f32 v246, v145, v149
    v_cvt_pk_bf16_f32 v247, v153, v157
    buffer_store_dwordx4 v[244:247], v253, s[16:19], s39 offen sc1
    s_add_u32 s39, s39, 4194304
    v_cvt_pk_bf16_f32 v240, v130, v134
    v_cvt_pk_bf16_f32 v241, v138, v142
    v_cvt_pk_bf16_f32 v242, v146, v150
    v_cvt_pk_bf16_f32 v243, v154, v158
    buffer_store_dwordx4 v[240:243], v253, s[16:19], s39 offen sc1
    s_add_u32 s39, s39, 4194304
    v_cvt_pk_bf16_f32 v244, v131, v135
    v_cvt_pk_bf16_f32 v245, v139, v143
    v_cvt_pk_bf16_f32 v246, v147, v151
    v_cvt_pk_bf16_f32 v247, v155, v159
    buffer_store_dwordx4 v[244:247], v253, s[16:19], s39 offen sc1
    s_add_u32 s39, s39, 4194304
    v_mfma_f32_16x16x32_bf16 v[128:131], v[228:231], v[64:67], 0
    v_mfma_f32_16x16x32_bf16 v[132:135], v[228:231], v[68:71], 0
    v_mfma_f32_16x16x32_bf16 v[136:139], v[228:231], v[72:75], 0
    v_mfma_f32_16x16x32_bf16 v[140:143], v[228:231], v[76:79], 0
    v_mfma_f32_16x16x32_bf16 v[144:147], v[228:231], v[80:83], 0
    v_mfma_f32_16x16x32_bf16 v[148:151], v[228:231], v[84:87], 0
    v_mfma_f32_16x16x32_bf16 v[152:155], v[228:231], v[88:91], 0
    v_mfma_f32_16x16x32_bf16 v[156:159], v[228:231], v[92:95], 0
    s_nop 7
    v_cvt_pk_bf16_f32 v240, v128, v132
    v_cvt_pk_bf16_f32 v241, v136, v140
    v_cvt_pk_bf16_f32 v242, v144, v148
    v_cvt_pk_bf16_f32 v243, v152, v156
    buffer_store_dwordx4 v[240:243], v253, s[16:19], s39 offen sc1
    s_add_u32 s39, s39, 4194304
    v_cvt_pk_bf16_f32 v244, v129, v133
    v_cvt_pk_bf16_f32 v245, v137, v141
    v_cvt_pk_bf16_f32 v246, v145, v149
    v_cvt_pk_bf16_f32 v247, v153, v157
    buffer_store_dwordx4 v[244:247], v253, s[16:19], s39 offen sc1
    s_add_u32 s39, s39, 4194304
    v_cvt_pk_bf16_f32 v240, v130, v134
    v_cvt_pk_bf16_f32 v241, v138, v142
    v_cvt_pk_bf16_f32 v242, v146, v150
    v_cvt_pk_bf16_f32 v243, v154, v158
    buffer_store_dwordx4 v[240:243], v253, s[16:19], s39 offen sc1
    s_add_u32 s39, s39, 4194304
    v_cvt_pk_bf16_f32 v244, v131, v135
    v_cvt_pk_bf16_f32 v245, v139, v143
    v_cvt_pk_bf16_f32 v246, v147, v151
    v_cvt_pk_bf16_f32 v247, v155, v159
    buffer_store_dwordx4 v[244:247], v253, s[16:19], s39 offen sc1
    s_add_u32 s39, s39, 4194304
    v_mfma_f32_16x16x32_bf16 v[128:131], v[232:235], v[64:67], 0
    v_mfma_f32_16x16x32_bf16 v[132:135], v[232:235], v[68:71], 0
    v_mfma_f32_16x16x32_bf16 v[136:139], v[232:235], v[72:75], 0
    v_mfma_f32_16x16x32_bf16 v[140:143], v[232:235], v[76:79], 0
    v_mfma_f32_16x16x32_bf16 v[144:147], v[232:235], v[80:83], 0
    v_mfma_f32_16x16x32_bf16 v[148:151], v[232:235], v[84:87], 0
    v_mfma_f32_16x16x32_bf16 v[152:155], v[232:235], v[88:91], 0
    v_mfma_f32_16x16x32_bf16 v[156:159], v[232:235], v[92:95], 0
    s_nop 7
    v_cvt_pk_bf16_f32 v240, v128, v132
    v_cvt_pk_bf16_f32 v241, v136, v140
    v_cvt_pk_bf16_f32 v242, v144, v148
    v_cvt_pk_bf16_f32 v243, v152, v156
    buffer_store_dwordx4 v[240:243], v253, s[16:19], s39 offen sc1
    s_add_u32 s39, s39, 4194304
    v_cvt_pk_bf16_f32 v244, v129, v133
    v_cvt_pk_bf16_f32 v245, v137, v141
    v_cvt_pk_bf16_f32 v246, v145, v149
    v_cvt_pk_bf16_f32 v247, v153, v157
    buffer_store_dwordx4 v[244:247], v253, s[16:19], s39 offen sc1
    s_add_u32 s39, s39, 4194304
    v_cvt_pk_bf16_f32 v240, v130, v134
    v_cvt_pk_bf16_f32 v241, v138, v142
    v_cvt_pk_bf16_f32 v242, v146, v150
    v_cvt_pk_bf16_f32 v243, v154, v158
    buffer_store_dwordx4 v[240:243], v253, s[16:19], s39 offen sc1
    s_add_u32 s39, s39, 4194304
    v_cvt_pk_bf16_f32 v244, v131, v135
    v_cvt_pk_bf16_f32 v245, v139, v143
    v_cvt_pk_bf16_f32 v246, v147, v151
    v_cvt_pk_bf16_f32 v247, v155, v159
    buffer_store_dwordx4 v[244:247], v253, s[16:19], s39 offen sc1
    s_add_u32 s39, s39, 4194304
    v_mfma_f32_16x16x32_bf16 v[128:131], v[236:239], v[64:67], 0
    v_mfma_f32_16x16x32_bf16 v[132:135], v[236:239], v[68:71], 0
    v_mfma_f32_16x16x32_bf16 v[136:139], v[236:239], v[72:75], 0
    v_mfma_f32_16x16x32_bf16 v[140:143], v[236:239], v[76:79], 0
    v_mfma_f32_16x16x32_bf16 v[144:147], v[236:239], v[80:83], 0
    v_mfma_f32_16x16x32_bf16 v[148:151], v[236:239], v[84:87], 0
    v_mfma_f32_16x16x32_bf16 v[152:155], v[236:239], v[88:91], 0
    v_mfma_f32_16x16x32_bf16 v[156:159], v[236:239], v[92:95], 0
    s_nop 7
    v_cvt_pk_bf16_f32 v240, v128, v132
    v_cvt_pk_bf16_f32 v241, v136, v140
    v_cvt_pk_bf16_f32 v242, v144, v148
    v_cvt_pk_bf16_f32 v243, v152, v156
    buffer_store_dwordx4 v[240:243], v253, s[16:19], s39 offen sc1
    s_add_u32 s39, s39, 4194304
    v_cvt_pk_bf16_f32 v244, v129, v133
    v_cvt_pk_bf16_f32 v245, v137, v141
    v_cvt_pk_bf16_f32 v246, v145, v149
    v_cvt_pk_bf16_f32 v247, v153, v157
    buffer_store_dwordx4 v[244:247], v253, s[16:19], s39 offen sc1
    s_add_u32 s39, s39, 4194304
    v_cvt_pk_bf16_f32 v240, v130, v134
    v_cvt_pk_bf16_f32 v241, v138, v142
    v_cvt_pk_bf16_f32 v242, v146, v150
    v_cvt_pk_bf16_f32 v243, v154, v158
    buffer_store_dwordx4 v[240:243], v253, s[16:19], s39 offen sc1
    s_add_u32 s39, s39, 4194304
    v_cvt_pk_bf16_f32 v244, v131, v135
    v_cvt_pk_bf16_f32 v245, v139, v143
    v_cvt_pk_bf16_f32 v246, v147, v151
    v_cvt_pk_bf16_f32 v247, v155, v159
    buffer_store_dwordx4 v[244:247], v253, s[16:19], s39 offen sc1
    s_branch K12_H2
K12_H1:
    s_cmp_eq_u32 s27, 0
    s_cbranch_scc1 K12_H2
    v_perm_b32 v64, v4, v0, s28
    v_perm_b32 v68, v4, v0, s29
    v_perm_b32 v65, v12, v8, s28
    v_perm_b32 v69, v12, v8, s29
    v_perm_b32 v66, v20, v16, s28
    v_perm_b32 v70, v20, v16, s29
    v_perm_b32 v67, v28, v24, s28
    v_perm_b32 v71, v28, v24, s29
    v_perm_b32 v72, v5, v1, s28
    v_perm_b32 v76, v5, v1, s29
    v_perm_b32 v73, v13, v9, s28
    v_perm_b32 v77, v13, v9, s29
    v_perm_b32 v74, v21, v17, s28
    v_perm_b32 v78, v21, v17, s29
    v_perm_b32 v75, v29, v25, s28
    v_perm_b32 v79, v29, v25, s29
    v_perm_b32 v80, v6, v2, s28
    v_perm_b32 v84, v6, v2, s29
    v_perm_b32 v81, v14, v10, s28
    v_perm_b32 v85, v14, v10, s29
    v_perm_b32 v82, v22, v18, s28
    v_perm_b32 v86, v22, v18, s29
    v_perm_b32 v83, v30, v26, s28
    v_perm_b32 v87, v30, v26, s29
    v_perm_b32 v88, v7, v3, s28
    v_perm_b32 v92, v7, v3, s29
    v_perm_b32 v89, v15, v11, s28
    v_perm_b32 v93, v15, v11, s29
    v_perm_b32 v90, v23, v19, s28
    v_perm_b32 v94, v23, v19, s29
    v_perm_b32 v91, v31, v27, s28
    v_perm_b32 v95, v31, v27, s29
    v_perm_b32 v0, v36, v32, s28
    v_perm_b32 v4, v36, v32, s29
    v_perm_b32 v1, v44, v40, s28
    v_perm_b32 v5, v44, v40, s29
    v_perm_b32 v2, v52, v48, s28
    v_perm_b32 v6, v52, v48, s29
    v_perm_b32 v3, v60, v56, s28
    v_perm_b32 v7, v60, v56, s29
    v_perm_b32 v8, v37, v33, s28
    v_perm_b32 v12, v37, v33, s29
    v_perm_b32 v9, v45, v41, s28
    v_perm_b32 v13, v45, v41, s29
    v_perm_b32 v10, v53, v49, s28
    v_perm_b32 v14, v53, v49, s29
    v_perm_b32 v11, v61, v57, s28
    v_perm_b32 v15, v61, v57, s29
    v_perm_b32 v16, v38, v34, s28
    v_perm_b32 v20, v38, v34, s29
    v_perm_b32 v17, v46, v42, s28
    v_perm_b32 v21, v46, v42, s29
    v_perm_b32 v18, v54, v50, s28
    v_perm_b32 v22, v54, v50, s29
    v_perm_b32 v19, v62, v58, s28
    v_perm_b32 v23, v62, v58, s29
    v_perm_b32 v24, v39, v35, s28
    v_perm_b32 v28, v39, v35, s29
    v_perm_b32 v25, v47, v43, s28
    v_perm_b32 v29, v47, v43, s29
    v_perm_b32 v26, v55, v51, s28
    v_perm_b32 v30, v55, v51, s29
    v_perm_b32 v27, v63, v59, s28
    v_perm_b32 v31, v63, v59, s29
    s_mul_i32 s39, s40, 85504
    s_add_u32 s39, s39, s31
    s_lshl_b32 s36, s30, 7
    s_add_u32 s39, s39, s36
    v_bfe_u32 v249, v254, 4, 2
    v_bfe_u32 v240, v254, 8, 1
    v_lshl_add_u32 v249, v240, 2, v249
    s_add_u32 s36, s30, 7
    s_cmp_ge_u32 s30, 160
    s_cselect_b32 s36, s36, s30
    s_cmp_eq_u32 s25, 1
    s_cselect_b32 s36, s36, s30
    s_lshr_b32 s36, s36, 1
    s_and_b32 s36, s36, 7
    v_xor_b32 v249, s36, v249
    v_lshl_add_u32 v249, v249, 4, v252
    v_mfma_f32_16x16x32_bf16 v[32:35], v[160:163], v[64:67], 0
    v_mfma_f32_16x16x32_bf16 v[36:39], v[160:163], v[68:71], 0
    v_mfma_f32_16x16x32_bf16 v[40:43], v[160:163], v[72:75], 0
    v_mfma_f32_16x16x32_bf16 v[44:47], v[160:163], v[76:79], 0
    v_mfma_f32_16x16x32_bf16 v[48:51], v[160:163], v[80:83], 0
    v_mfma_f32_16x16x32_bf16 v[52:55], v[160:163], v[84:87], 0
    v_mfma_f32_16x16x32_bf16 v[56:59], v[160:163], v[88:91], 0
    v_mfma_f32_16x16x32_bf16 v[60:63], v[160:163], v[92:95], 0
    v_mfma_f32_16x16x32_bf16 v[32:35], v[164:167], v[0:3], v[32:35]
    v_mfma_f32_16x16x32_bf16 v[36:39], v[164:167], v[4:7], v[36:39]
    v_mfma_f32_16x16x32_bf16 v[40:43], v[164:167], v[8:11], v[40:43]
    v_mfma_f32_16x16x32_bf16 v[44:47], v[164:167], v[12:15], v[44:47]
    v_mfma_f32_16x16x32_bf16 v[48:51], v[164:167], v[16:19], v[48:51]
    v_mfma_f32_16x16x32_bf16 v[52:55], v[164:167], v[20:23], v[52:55]
    v_mfma_f32_16x16x32_bf16 v[56:59], v[164:167], v[24:27], v[56:59]
    v_mfma_f32_16x16x32_bf16 v[60:63], v[164:167], v[28:31], v[60:63]
    s_nop 7
    v_cvt_pk_bf16_f32 v240, v32, v36
    v_cvt_pk_bf16_f32 v241, v40, v44
    v_cvt_pk_bf16_f32 v242, v48, v52
    v_cvt_pk_bf16_f32 v243, v56, v60
    buffer_store_dwordx4 v[240:243], v249, s[12:15], s39 offen sc1
    s_add_u32 s39, s39, 2736128
    v_cvt_pk_bf16_f32 v244, v33, v37
    v_cvt_pk_bf16_f32 v245, v41, v45
    v_cvt_pk_bf16_f32 v246, v49, v53
    v_cvt_pk_bf16_f32 v247, v57, v61
    buffer_store_dwordx4 v[244:247], v249, s[12:15], s39 offen sc1
    s_add_u32 s39, s39, 2736128
    v_cvt_pk_bf16_f32 v240, v34, v38
    v_cvt_pk_bf16_f32 v241, v42, v46
    v_cvt_pk_bf16_f32 v242, v50, v54
    v_cvt_pk_bf16_f32 v243, v58, v62
    buffer_store_dwordx4 v[240:243], v249, s[12:15], s39 offen sc1
    s_add_u32 s39, s39, 2736128
    v_cvt_pk_bf16_f32 v244, v35, v39
    v_cvt_pk_bf16_f32 v245, v43, v47
    v_cvt_pk_bf16_f32 v246, v51, v55
    v_cvt_pk_bf16_f32 v247, v59, v63
    buffer_store_dwordx4 v[244:247], v249, s[12:15], s39 offen sc1
    s_add_u32 s39, s39, 2736128
    v_mfma_f32_16x16x32_bf16 v[32:35], v[168:171], v[64:67], 0
    v_mfma_f32_16x16x32_bf16 v[36:39], v[168:171], v[68:71], 0
    v_mfma_f32_16x16x32_bf16 v[40:43], v[168:171], v[72:75], 0
    v_mfma_f32_16x16x32_bf16 v[44:47], v[168:171], v[76:79], 0
    v_mfma_f32_16x16x32_bf16 v[48:51], v[168:171], v[80:83], 0
    v_mfma_f32_16x16x32_bf16 v[52:55], v[168:171], v[84:87], 0
    v_mfma_f32_16x16x32_bf16 v[56:59], v[168:171], v[88:91], 0
    v_mfma_f32_16x16x32_bf16 v[60:63], v[168:171], v[92:95], 0
    v_mfma_f32_16x16x32_bf16 v[32:35], v[172:175], v[0:3], v[32:35]
    v_mfma_f32_16x16x32_bf16 v[36:39], v[172:175], v[4:7], v[36:39]
    v_mfma_f32_16x16x32_bf16 v[40:43], v[172:175], v[8:11], v[40:43]
    v_mfma_f32_16x16x32_bf16 v[44:47], v[172:175], v[12:15], v[44:47]
    v_mfma_f32_16x16x32_bf16 v[48:51], v[172:175], v[16:19], v[48:51]
    v_mfma_f32_16x16x32_bf16 v[52:55], v[172:175], v[20:23], v[52:55]
    v_mfma_f32_16x16x32_bf16 v[56:59], v[172:175], v[24:27], v[56:59]
    v_mfma_f32_16x16x32_bf16 v[60:63], v[172:175], v[28:31], v[60:63]
    s_nop 7
    v_cvt_pk_bf16_f32 v240, v32, v36
    v_cvt_pk_bf16_f32 v241, v40, v44
    v_cvt_pk_bf16_f32 v242, v48, v52
    v_cvt_pk_bf16_f32 v243, v56, v60
    buffer_store_dwordx4 v[240:243], v249, s[12:15], s39 offen sc1
    s_add_u32 s39, s39, 2736128
    v_cvt_pk_bf16_f32 v244, v33, v37
    v_cvt_pk_bf16_f32 v245, v41, v45
    v_cvt_pk_bf16_f32 v246, v49, v53
    v_cvt_pk_bf16_f32 v247, v57, v61
    buffer_store_dwordx4 v[244:247], v249, s[12:15], s39 offen sc1
    s_add_u32 s39, s39, 2736128
    v_cvt_pk_bf16_f32 v240, v34, v38
    v_cvt_pk_bf16_f32 v241, v42, v46
    v_cvt_pk_bf16_f32 v242, v50, v54
    v_cvt_pk_bf16_f32 v243, v58, v62
    buffer_store_dwordx4 v[240:243], v249, s[12:15], s39 offen sc1
    s_add_u32 s39, s39, 2736128
    v_cvt_pk_bf16_f32 v244, v35, v39
    v_cvt_pk_bf16_f32 v245, v43, v47
    v_cvt_pk_bf16_f32 v246, v51, v55
    v_cvt_pk_bf16_f32 v247, v59, v63
    buffer_store_dwordx4 v[244:247], v249, s[12:15], s39 offen sc1
    s_add_u32 s39, s39, 2736128
    v_mfma_f32_16x16x32_bf16 v[32:35], v[176:179], v[64:67], 0
    v_mfma_f32_16x16x32_bf16 v[36:39], v[176:179], v[68:71], 0
    v_mfma_f32_16x16x32_bf16 v[40:43], v[176:179], v[72:75], 0
    v_mfma_f32_16x16x32_bf16 v[44:47], v[176:179], v[76:79], 0
    v_mfma_f32_16x16x32_bf16 v[48:51], v[176:179], v[80:83], 0
    v_mfma_f32_16x16x32_bf16 v[52:55], v[176:179], v[84:87], 0
    v_mfma_f32_16x16x32_bf16 v[56:59], v[176:179], v[88:91], 0
    v_mfma_f32_16x16x32_bf16 v[60:63], v[176:179], v[92:95], 0
    v_mfma_f32_16x16x32_bf16 v[32:35], v[180:183], v[0:3], v[32:35]
    v_mfma_f32_16x16x32_bf16 v[36:39], v[180:183], v[4:7], v[36:39]
    v_mfma_f32_16x16x32_bf16 v[40:43], v[180:183], v[8:11], v[40:43]
    v_mfma_f32_16x16x32_bf16 v[44:47], v[180:183], v[12:15], v[44:47]
    v_mfma_f32_16x16x32_bf16 v[48:51], v[180:183], v[16:19], v[48:51]
    v_mfma_f32_16x16x32_bf16 v[52:55], v[180:183], v[20:23], v[52:55]
    v_mfma_f32_16x16x32_bf16 v[56:59], v[180:183], v[24:27], v[56:59]
    v_mfma_f32_16x16x32_bf16 v[60:63], v[180:183], v[28:31], v[60:63]
    s_nop 7
    v_cvt_pk_bf16_f32 v240, v32, v36
    v_cvt_pk_bf16_f32 v241, v40, v44
    v_cvt_pk_bf16_f32 v242, v48, v52
    v_cvt_pk_bf16_f32 v243, v56, v60
    buffer_store_dwordx4 v[240:243], v249, s[12:15], s39 offen sc1
    s_add_u32 s39, s39, 2736128
    v_cvt_pk_bf16_f32 v244, v33, v37
    v_cvt_pk_bf16_f32 v245, v41, v45
    v_cvt_pk_bf16_f32 v246, v49, v53
    v_cvt_pk_bf16_f32 v247, v57, v61
    buffer_store_dwordx4 v[244:247], v249, s[12:15], s39 offen sc1
    s_add_u32 s39, s39, 2736128
    v_cvt_pk_bf16_f32 v240, v34, v38
    v_cvt_pk_bf16_f32 v241, v42, v46
    v_cvt_pk_bf16_f32 v242, v50, v54
    v_cvt_pk_bf16_f32 v243, v58, v62
    buffer_store_dwordx4 v[240:243], v249, s[12:15], s39 offen sc1
    s_add_u32 s39, s39, 2736128
    v_cvt_pk_bf16_f32 v244, v35, v39
    v_cvt_pk_bf16_f32 v245, v43, v47
    v_cvt_pk_bf16_f32 v246, v51, v55
    v_cvt_pk_bf16_f32 v247, v59, v63
    buffer_store_dwordx4 v[244:247], v249, s[12:15], s39 offen sc1
    s_add_u32 s39, s39, 2736128
    v_mfma_f32_16x16x32_bf16 v[32:35], v[184:187], v[64:67], 0
    v_mfma_f32_16x16x32_bf16 v[36:39], v[184:187], v[68:71], 0
    v_mfma_f32_16x16x32_bf16 v[40:43], v[184:187], v[72:75], 0
    v_mfma_f32_16x16x32_bf16 v[44:47], v[184:187], v[76:79], 0
    v_mfma_f32_16x16x32_bf16 v[48:51], v[184:187], v[80:83], 0
    v_mfma_f32_16x16x32_bf16 v[52:55], v[184:187], v[84:87], 0
    v_mfma_f32_16x16x32_bf16 v[56:59], v[184:187], v[88:91], 0
    v_mfma_f32_16x16x32_bf16 v[60:63], v[184:187], v[92:95], 0
    v_mfma_f32_16x16x32_bf16 v[32:35], v[188:191], v[0:3], v[32:35]
    v_mfma_f32_16x16x32_bf16 v[36:39], v[188:191], v[4:7], v[36:39]
    v_mfma_f32_16x16x32_bf16 v[40:43], v[188:191], v[8:11], v[40:43]
    v_mfma_f32_16x16x32_bf16 v[44:47], v[188:191], v[12:15], v[44:47]
    v_mfma_f32_16x16x32_bf16 v[48:51], v[188:191], v[16:19], v[48:51]
    v_mfma_f32_16x16x32_bf16 v[52:55], v[188:191], v[20:23], v[52:55]
    v_mfma_f32_16x16x32_bf16 v[56:59], v[188:191], v[24:27], v[56:59]
    v_mfma_f32_16x16x32_bf16 v[60:63], v[188:191], v[28:31], v[60:63]
    s_nop 7
    v_cvt_pk_bf16_f32 v240, v32, v36
    v_cvt_pk_bf16_f32 v241, v40, v44
    v_cvt_pk_bf16_f32 v242, v48, v52
    v_cvt_pk_bf16_f32 v243, v56, v60
    buffer_store_dwordx4 v[240:243], v249, s[12:15], s39 offen sc1
    s_add_u32 s39, s39, 2736128
    v_cvt_pk_bf16_f32 v244, v33, v37
    v_cvt_pk_bf16_f32 v245, v41, v45
    v_cvt_pk_bf16_f32 v246, v49, v53
    v_cvt_pk_bf16_f32 v247, v57, v61
    buffer_store_dwordx4 v[244:247], v249, s[12:15], s39 offen sc1
    s_add_u32 s39, s39, 2736128
    v_cvt_pk_bf16_f32 v240, v34, v38
    v_cvt_pk_bf16_f32 v241, v42, v46
    v_cvt_pk_bf16_f32 v242, v50, v54
    v_cvt_pk_bf16_f32 v243, v58, v62
    buffer_store_dwordx4 v[240:243], v249, s[12:15], s39 offen sc1
    s_add_u32 s39, s39, 2736128
    v_cvt_pk_bf16_f32 v244, v35, v39
    v_cvt_pk_bf16_f32 v245, v43, v47
    v_cvt_pk_bf16_f32 v246, v51, v55
    v_cvt_pk_bf16_f32 v247, v59, v63
    buffer_store_dwordx4 v[244:247], v249, s[12:15], s39 offen sc1
K12_H2:
    s_mov_b64 exec, 1
    v_mov_b32 v255, 155664
    v_mov_b32 v64, 1
    ds_add_u32 v255, v64
    s_mov_b64 exec, -1
    s_waitcnt vmcnt(0)
    s_mov_b32 s41, 0
    s_mov_b32 s34, -1
    s_cmp_ge_u32 s41, 8
    s_cbranch_scc1 K12_SG0
    s_lshl_b32 s36, s41, 2
    s_add_u32 s37, s36, 155680
    s_mov_b64 exec, 1
    v_mov_b32 v255, s37
    v_mov_b32 v240, 1
    ds_add_rtn_u32 v240, v255, v240
    s_waitcnt lgkmcnt(0)
    v_readfirstlane_b32 s37, v240
    s_nop 3
    s_cmp_eq_u32 s37, 3
    s_cbranch_scc0 K12_SH0
    s_lshl_b32 s36, s36, 8
    v_mov_b32 v255, 1
    v_mov_b32 v240, s36
    buffer_atomic_add v255, v240, s[60:63], 0 offen sc0 sc1
    s_mov_b32 s34, s41
K12_SH0:
    s_mov_b64 exec, -1
K12_SG0:
    s_waitcnt vmcnt(0)
    s_cmp_ge_u32 s34, 8
    s_cbranch_scc1 K12_PB1
    v_readfirstlane_b32 s37, v255
    s_nop 3
    s_cmp_eq_u32 s37, 255
    s_cbranch_scc0 K12_PB1
    s_lshl_b32 s36, s34, 4
    s_add_u32 s36, s36, 16384
    s_mov_b64 exec, 1
    v_mov_b32 v255, 1
    v_mov_b32 v240, s36
    buffer_store_dword v255, v240, s[60:63], 0 offen sc1
    s_mov_b64 exec, -1
K12_PB1:
    s_branch K12_CONS
K12_PROD:
    s_setprio 1
    s_cmp_eq_u32 s43, 0
    s_cbranch_scc1 K12_WENTRY
K12_XW:
    s_waitcnt vmcnt(0)
    s_mov_b32 s34, -1
    s_cmp_ge_u32 s41, 8
    s_cbranch_scc1 K12_SG2
    s_lshl_b32 s36, s41, 2
    s_add_u32 s37, s36, 155680
    s_mov_b64 exec, 1
    v_mov_b32 v255, s37
    v_mov_b32 v240, 1
    ds_add_rtn_u32 v240, v255, v240
    s_waitcnt lgkmcnt(0)
    v_readfirstlane_b32 s37, v240
    s_nop 3
    s_cmp_eq_u32 s37, 3
    s_cbranch_scc0 K12_SH2
    s_lshl_b32 s36, s36, 8
    v_mov_b32 v255, 1
    v_mov_b32 v240, s36
    buffer_atomic_add v255, v240, s[60:63], 0 offen sc0 sc1
    s_mov_b32 s34, s41
K12_SH2:
    s_mov_b64 exec, -1
K12_SG2:
    s_cmp_ge_u32 s34, 8
    s_cbranch_scc1 K12_EP3
    s_waitcnt vmcnt(0)
    s_cmp_ge_u32 s34, 8
    s_cbranch_scc1 K12_PB4
    v_readfirstlane_b32 s37, v255
    s_nop 3
    s_cmp_eq_u32 s37, 255
    s_cbranch_scc0 K12_PB4
    s_lshl_b32 s36, s34, 4
    s_add_u32 s36, s36, 16384
    s_mov_b64 exec, 1
    v_mov_b32 v255, 1
    v_mov_b32 v240, s36
    buffer_store_dword v255, v240, s[60:63], 0 offen sc1
    s_mov_b64 exec, -1
K12_PB4:
    s_mov_b32 s34, -1
K12_EP3:
    s_cmp_eq_u32 s27, 0
    s_cbranch_scc1 K12_XP_N
    v_perm_b32 v64, v4, v0, s28
    v_perm_b32 v68, v4, v0, s29
    v_perm_b32 v65, v12, v8, s28
    v_perm_b32 v69, v12, v8, s29
    v_perm_b32 v66, v20, v16, s28
    v_perm_b32 v70, v20, v16, s29
    v_perm_b32 v67, v28, v24, s28
    v_perm_b32 v71, v28, v24, s29
    v_perm_b32 v72, v5, v1, s28
    v_perm_b32 v76, v5, v1, s29
    v_perm_b32 v73, v13, v9, s28
    v_perm_b32 v77, v13, v9, s29
    v_perm_b32 v74, v21, v17, s28
    v_perm_b32 v78, v21, v17, s29
    v_perm_b32 v75, v29, v25, s28
    v_perm_b32 v79, v29, v25, s29
    v_perm_b32 v80, v6, v2, s28
    v_perm_b32 v84, v6, v2, s29
    v_perm_b32 v81, v14, v10, s28
    v_perm_b32 v85, v14, v10, s29
    v_perm_b32 v82, v22, v18, s28
    v_perm_b32 v86, v22, v18, s29
    v_perm_b32 v83, v30, v26, s28
    v_perm_b32 v87, v30, v26, s29
    v_perm_b32 v88, v7, v3, s28
    v_perm_b32 v92, v7, v3, s29
    v_perm_b32 v89, v15, v11, s28
    v_perm_b32 v93, v15, v11, s29
    v_perm_b32 v90, v23, v19, s28
    v_perm_b32 v94, v23, v19, s29
    v_perm_b32 v91, v31, v27, s28
    v_perm_b32 v95, v31, v27, s29
    v_perm_b32 v0, v36, v32, s28
    v_perm_b32 v4, v36, v32, s29
    v_perm_b32 v1, v44, v40, s28
    v_perm_b32 v5, v44, v40, s29
    v_perm_b32 v2, v52, v48, s28
    v_perm_b32 v6, v52, v48, s29
    v_perm_b32 v3, v60, v56, s28
    v_perm_b32 v7, v60, v56, s29
    v_perm_b32 v8, v37, v33, s28
    v_perm_b32 v12, v37, v33, s29
    v_perm_b32 v9, v45, v41, s28
    v_perm_b32 v13, v45, v41, s29
    v_perm_b32 v10, v53, v49, s28
    v_perm_b32 v14, v53, v49, s29
    v_perm_b32 v11, v61, v57, s28
    v_perm_b32 v15, v61, v57, s29
    v_perm_b32 v16, v38, v34, s28
    v_perm_b32 v20, v38, v34, s29
    v_perm_b32 v17, v46, v42, s28
    v_perm_b32 v21, v46, v42, s29
    v_perm_b32 v18, v54, v50, s28
    v_perm_b32 v22, v54, v50, s29
    v_perm_b32 v19, v62, v58, s28
    v_perm_b32 v23, v62, v58, s29
    v_perm_b32 v24, v39, v35, s28
    v_perm_b32 v28, v39, v35, s29
    v_perm_b32 v25, v47, v43, s28
    v_perm_b32 v29, v47, v43, s29
    v_perm_b32 v26, v55, v51, s28
    v_perm_b32 v30, v55, v51, s29
    v_perm_b32 v27, v63, v59, s28
    v_perm_b32 v31, v63, v59, s29
K12_XP_N:
    s_lshl_b32 s36, s40, 3
    s_sub_i32 s36, s36, 28
    s_max_i32 s36, s36, 1
    s_mov_b32 s37, 32768
K12_GL0:
    v_mov_b32 v240, 155648
    ds_read_b32 v240, v240
    s_waitcnt lgkmcnt(0)
    v_cmp_gt_u32 vcc, s36, v240
    s_sub_u32 s37, s37, 1
    s_cmp_eq_u32 s37, 0
    s_cbranch_scc1 K12_GT0
    s_cbranch_vccz K12_GT0
    s_sleep 2
    s_branch K12_GL0
K12_GT0:
    s_add_u32 s42, s40, 1
    s_lshl_b32 s36, s42, 7
    s_add_u32 s36, s36, s22
    s_lshr_b32 s37, s36, 9
    s_lshl_b32 s37, s37, 19
    s_and_b32 s36, s36, 511
    s_lshl_b32 s36, s36, 10
    s_add_u32 s36, s36, s37
    s_add_u32 s36, s36, s33
    buffer_load_dwordx4 v[96:99], v250, s[8:11], s36 offen
    s_add_u32 s36, s36, 0x100000
    buffer_load_dwordx4 v[100:103], v250, s[8:11], s36 offen
    s_add_u32 s36, s36, 0x100000
    buffer_load_dwordx4 v[104:107], v250, s[8:11], s36 offen
    s_add_u32 s36, s36, 0x100000
    buffer_load_dwordx4 v[108:111], v250, s[8:11], s36 offen
    s_add_u32 s36, s36, 0x100000
    buffer_load_dwordx4 v[112:115], v250, s[8:11], s36 offen
    s_add_u32 s36, s36, 0x100000
    buffer_load_dwordx4 v[116:119], v250, s[8:11], s36 offen
    s_add_u32 s36, s36, 0x100000
    buffer_load_dwordx4 v[120:123], v250, s[8:11], s36 offen
    s_add_u32 s36, s36, 0x100000
    buffer_load_dwordx4 v[124:127], v250, s[8:11], s36 offen
    s_cmp_eq_u32 s27, 0
    s_cbranch_scc1 K12_XP_E
    s_mul_i32 s39, s40, 85504
    s_add_u32 s39, s39, s31
    s_lshl_b32 s36, s30, 7
    s_add_u32 s39, s39, s36
    v_bfe_u32 v249, v254, 4, 2
    v_bfe_u32 v240, v254, 8, 1
    v_lshl_add_u32 v249, v240, 2, v249
    s_add_u32 s36, s30, 7
    s_cmp_ge_u32 s30, 160
    s_cselect_b32 s36, s36, s30
    s_cmp_eq_u32 s25, 1
    s_cselect_b32 s36, s36, s30
    s_lshr_b32 s36, s36, 1
    s_and_b32 s36, s36, 7
    v_xor_b32 v249, s36, v249
    v_lshl_add_u32 v249, v249, 4, v252
    v_mfma_f32_16x16x32_bf16 v[32:35], v[160:163], v[64:67], 0
    v_mfma_f32_16x16x32_bf16 v[36:39], v[160:163], v[68:71], 0
    v_mfma_f32_16x16x32_bf16 v[40:43], v[160:163], v[72:75], 0
    v_mfma_f32_16x16x32_bf16 v[44:47], v[160:163], v[76:79], 0
    v_mfma_f32_16x16x32_bf16 v[48:51], v[160:163], v[80:83], 0
    v_mfma_f32_16x16x32_bf16 v[52:55], v[160:163], v[84:87], 0
    v_mfma_f32_16x16x32_bf16 v[56:59], v[160:163], v[88:91], 0
    v_mfma_f32_16x16x32_bf16 v[60:63], v[160:163], v[92:95], 0
    v_mfma_f32_16x16x32_bf16 v[32:35], v[164:167], v[0:3], v[32:35]
    v_mfma_f32_16x16x32_bf16 v[36:39], v[164:167], v[4:7], v[36:39]
    v_mfma_f32_16x16x32_bf16 v[40:43], v[164:167], v[8:11], v[40:43]
    v_mfma_f32_16x16x32_bf16 v[44:47], v[164:167], v[12:15], v[44:47]
    v_mfma_f32_16x16x32_bf16 v[48:51], v[164:167], v[16:19], v[48:51]
    v_mfma_f32_16x16x32_bf16 v[52:55], v[164:167], v[20:23], v[52:55]
    v_mfma_f32_16x16x32_bf16 v[56:59], v[164:167], v[24:27], v[56:59]
    v_mfma_f32_16x16x32_bf16 v[60:63], v[164:167], v[28:31], v[60:63]
    s_nop 7
    v_cvt_pk_bf16_f32 v240, v32, v36
    v_cvt_pk_bf16_f32 v241, v40, v44
    v_cvt_pk_bf16_f32 v242, v48, v52
    v_cvt_pk_bf16_f32 v243, v56, v60
    buffer_store_dwordx4 v[240:243], v249, s[12:15], s39 offen sc1
    s_add_u32 s39, s39, 2736128
    v_cvt_pk_bf16_f32 v244, v33, v37
    v_cvt_pk_bf16_f32 v245, v41, v45
    v_cvt_pk_bf16_f32 v246, v49, v53
    v_cvt_pk_bf16_f32 v247, v57, v61
    buffer_store_dwordx4 v[244:247], v249, s[12:15], s39 offen sc1
    s_add_u32 s39, s39, 2736128
    v_cvt_pk_bf16_f32 v240, v34, v38
    v_cvt_pk_bf16_f32 v241, v42, v46
    v_cvt_pk_bf16_f32 v242, v50, v54
    v_cvt_pk_bf16_f32 v243, v58, v62
    buffer_store_dwordx4 v[240:243], v249, s[12:15], s39 offen sc1
    s_add_u32 s39, s39, 2736128
    v_cvt_pk_bf16_f32 v244, v35, v39
    v_cvt_pk_bf16_f32 v245, v43, v47
    v_cvt_pk_bf16_f32 v246, v51, v55
    v_cvt_pk_bf16_f32 v247, v59, v63
    buffer_store_dwordx4 v[244:247], v249, s[12:15], s39 offen sc1
    s_add_u32 s39, s39, 2736128
    v_mfma_f32_16x16x32_bf16 v[32:35], v[168:171], v[64:67], 0
    v_mfma_f32_16x16x32_bf16 v[36:39], v[168:171], v[68:71], 0
    v_mfma_f32_16x16x32_bf16 v[40:43], v[168:171], v[72:75], 0
    v_mfma_f32_16x16x32_bf16 v[44:47], v[168:171], v[76:79], 0
    v_mfma_f32_16x16x32_bf16 v[48:51], v[168:171], v[80:83], 0
    v_mfma_f32_16x16x32_bf16 v[52:55], v[168:171], v[84:87], 0
    v_mfma_f32_16x16x32_bf16 v[56:59], v[168:171], v[88:91], 0
    v_mfma_f32_16x16x32_bf16 v[60:63], v[168:171], v[92:95], 0
    v_mfma_f32_16x16x32_bf16 v[32:35], v[172:175], v[0:3], v[32:35]
    v_mfma_f32_16x16x32_bf16 v[36:39], v[172:175], v[4:7], v[36:39]
    v_mfma_f32_16x16x32_bf16 v[40:43], v[172:175], v[8:11], v[40:43]
    v_mfma_f32_16x16x32_bf16 v[44:47], v[172:175], v[12:15], v[44:47]
    v_mfma_f32_16x16x32_bf16 v[48:51], v[172:175], v[16:19], v[48:51]
    v_mfma_f32_16x16x32_bf16 v[52:55], v[172:175], v[20:23], v[52:55]
    v_mfma_f32_16x16x32_bf16 v[56:59], v[172:175], v[24:27], v[56:59]
    v_mfma_f32_16x16x32_bf16 v[60:63], v[172:175], v[28:31], v[60:63]
    s_nop 7
    v_cvt_pk_bf16_f32 v240, v32, v36
    v_cvt_pk_bf16_f32 v241, v40, v44
    v_cvt_pk_bf16_f32 v242, v48, v52
    v_cvt_pk_bf16_f32 v243, v56, v60
    buffer_store_dwordx4 v[240:243], v249, s[12:15], s39 offen sc1
    s_add_u32 s39, s39, 2736128
    v_cvt_pk_bf16_f32 v244, v33, v37
    v_cvt_pk_bf16_f32 v245, v41, v45
    v_cvt_pk_bf16_f32 v246, v49, v53
    v_cvt_pk_bf16_f32 v247, v57, v61
    buffer_store_dwordx4 v[244:247], v249, s[12:15], s39 offen sc1
    s_add_u32 s39, s39, 2736128
    v_cvt_pk_bf16_f32 v240, v34, v38
    v_cvt_pk_bf16_f32 v241, v42, v46
    v_cvt_pk_bf16_f32 v242, v50, v54
    v_cvt_pk_bf16_f32 v243, v58, v62
    buffer_store_dwordx4 v[240:243], v249, s[12:15], s39 offen sc1
    s_add_u32 s39, s39, 2736128
    v_cvt_pk_bf16_f32 v244, v35, v39
    v_cvt_pk_bf16_f32 v245, v43, v47
    v_cvt_pk_bf16_f32 v246, v51, v55
    v_cvt_pk_bf16_f32 v247, v59, v63
    buffer_store_dwordx4 v[244:247], v249, s[12:15], s39 offen sc1
    s_add_u32 s39, s39, 2736128
    v_mfma_f32_16x16x32_bf16 v[32:35], v[176:179], v[64:67], 0
    v_mfma_f32_16x16x32_bf16 v[36:39], v[176:179], v[68:71], 0
    v_mfma_f32_16x16x32_bf16 v[40:43], v[176:179], v[72:75], 0
    v_mfma_f32_16x16x32_bf16 v[44:47], v[176:179], v[76:79], 0
    v_mfma_f32_16x16x32_bf16 v[48:51], v[176:179], v[80:83], 0
    v_mfma_f32_16x16x32_bf16 v[52:55], v[176:179], v[84:87], 0
    v_mfma_f32_16x16x32_bf16 v[56:59], v[176:179], v[88:91], 0
    v_mfma_f32_16x16x32_bf16 v[60:63], v[176:179], v[92:95], 0
    v_mfma_f32_16x16x32_bf16 v[32:35], v[180:183], v[0:3], v[32:35]
    v_mfma_f32_16x16x32_bf16 v[36:39], v[180:183], v[4:7], v[36:39]
    v_mfma_f32_16x16x32_bf16 v[40:43], v[180:183], v[8:11], v[40:43]
    v_mfma_f32_16x16x32_bf16 v[44:47], v[180:183], v[12:15], v[44:47]
    v_mfma_f32_16x16x32_bf16 v[48:51], v[180:183], v[16:19], v[48:51]
    v_mfma_f32_16x16x32_bf16 v[52:55], v[180:183], v[20:23], v[52:55]
    v_mfma_f32_16x16x32_bf16 v[56:59], v[180:183], v[24:27], v[56:59]
    v_mfma_f32_16x16x32_bf16 v[60:63], v[180:183], v[28:31], v[60:63]
    s_nop 7
    v_cvt_pk_bf16_f32 v240, v32, v36
    v_cvt_pk_bf16_f32 v241, v40, v44
    v_cvt_pk_bf16_f32 v242, v48, v52
    v_cvt_pk_bf16_f32 v243, v56, v60
    buffer_store_dwordx4 v[240:243], v249, s[12:15], s39 offen sc1
    s_add_u32 s39, s39, 2736128
    v_cvt_pk_bf16_f32 v244, v33, v37
    v_cvt_pk_bf16_f32 v245, v41, v45
    v_cvt_pk_bf16_f32 v246, v49, v53
    v_cvt_pk_bf16_f32 v247, v57, v61
    buffer_store_dwordx4 v[244:247], v249, s[12:15], s39 offen sc1
    s_add_u32 s39, s39, 2736128
    v_cvt_pk_bf16_f32 v240, v34, v38
    v_cvt_pk_bf16_f32 v241, v42, v46
    v_cvt_pk_bf16_f32 v242, v50, v54
    v_cvt_pk_bf16_f32 v243, v58, v62
    buffer_store_dwordx4 v[240:243], v249, s[12:15], s39 offen sc1
    s_add_u32 s39, s39, 2736128
    v_cvt_pk_bf16_f32 v244, v35, v39
    v_cvt_pk_bf16_f32 v245, v43, v47
    v_cvt_pk_bf16_f32 v246, v51, v55
    v_cvt_pk_bf16_f32 v247, v59, v63
    buffer_store_dwordx4 v[244:247], v249, s[12:15], s39 offen sc1
    s_add_u32 s39, s39, 2736128
    v_mfma_f32_16x16x32_bf16 v[32:35], v[184:187], v[64:67], 0
    v_mfma_f32_16x16x32_bf16 v[36:39], v[184:187], v[68:71], 0
    v_mfma_f32_16x16x32_bf16 v[40:43], v[184:187], v[72:75], 0
    v_mfma_f32_16x16x32_bf16 v[44:47], v[184:187], v[76:79], 0
    v_mfma_f32_16x16x32_bf16 v[48:51], v[184:187], v[80:83], 0
    v_mfma_f32_16x16x32_bf16 v[52:55], v[184:187], v[84:87], 0
    v_mfma_f32_16x16x32_bf16 v[56:59], v[184:187], v[88:91], 0
    v_mfma_f32_16x16x32_bf16 v[60:63], v[184:187], v[92:95], 0
    v_mfma_f32_16x16x32_bf16 v[32:35], v[188:191], v[0:3], v[32:35]
    v_mfma_f32_16x16x32_bf16 v[36:39], v[188:191], v[4:7], v[36:39]
    v_mfma_f32_16x16x32_bf16 v[40:43], v[188:191], v[8:11], v[40:43]
    v_mfma_f32_16x16x32_bf16 v[44:47], v[188:191], v[12:15], v[44:47]
    v_mfma_f32_16x16x32_bf16 v[48:51], v[188:191], v[16:19], v[48:51]
    v_mfma_f32_16x16x32_bf16 v[52:55], v[188:191], v[20:23], v[52:55]
    v_mfma_f32_16x16x32_bf16 v[56:59], v[188:191], v[24:27], v[56:59]
    v_mfma_f32_16x16x32_bf16 v[60:63], v[188:191], v[28:31], v[60:63]
    s_nop 7
    v_cvt_pk_bf16_f32 v240, v32, v36
    v_cvt_pk_bf16_f32 v241, v40, v44
    v_cvt_pk_bf16_f32 v242, v48, v52
    v_cvt_pk_bf16_f32 v243, v56, v60
    buffer_store_dwordx4 v[240:243], v249, s[12:15], s39 offen sc1
    s_add_u32 s39, s39, 2736128
    v_cvt_pk_bf16_f32 v244, v33, v37
    v_cvt_pk_bf16_f32 v245, v41, v45
    v_cvt_pk_bf16_f32 v246, v49, v53
    v_cvt_pk_bf16_f32 v247, v57, v61
    buffer_store_dwordx4 v[244:247], v249, s[12:15], s39 offen sc1
    s_add_u32 s39, s39, 2736128
    v_cvt_pk_bf16_f32 v240, v34, v38
    v_cvt_pk_bf16_f32 v241, v42, v46
    v_cvt_pk_bf16_f32 v242, v50, v54
    v_cvt_pk_bf16_f32 v243, v58, v62
    buffer_store_dwordx4 v[240:243], v249, s[12:15], s39 offen sc1
    s_add_u32 s39, s39, 2736128
    v_cvt_pk_bf16_f32 v244, v35, v39
    v_cvt_pk_bf16_f32 v245, v43, v47
    v_cvt_pk_bf16_f32 v246, v51, v55
    v_cvt_pk_bf16_f32 v247, v59, v63
    buffer_store_dwordx4 v[244:247], v249, s[12:15], s39 offen sc1
    s_mov_b32 s41, s40
    s_add_u32 s40, s40, 1
    s_cmp_eq_u32 s41, 3
    s_cbranch_scc0 K12_ES5
    s_waitcnt vmcnt(0)
    s_mov_b32 s34, -1
    s_cmp_ge_u32 s41, 8
    s_cbranch_scc1 K12_SG6
    s_lshl_b32 s36, s41, 2
    s_add_u32 s37, s36, 155680
    s_mov_b64 exec, 1
    v_mov_b32 v255, s37
    v_mov_b32 v240, 1
    ds_add_rtn_u32 v240, v255, v240
    s_waitcnt lgkmcnt(0)
    v_readfirstlane_b32 s37, v240
    s_nop 3
    s_cmp_eq_u32 s37, 3
    s_cbranch_scc0 K12_SH6
    s_lshl_b32 s36, s36, 8
    v_mov_b32 v255, 1
    v_mov_b32 v240, s36
    buffer_atomic_add v255, v240, s[60:63], 0 offen sc0 sc1
    s_mov_b32 s34, s41
K12_SH6:
    s_mov_b64 exec, -1
K12_SG6:
    s_waitcnt vmcnt(0)
    s_cmp_ge_u32 s34, 8
    s_cbranch_scc1 K12_PB7
    v_readfirstlane_b32 s37, v255
    s_nop 3
    s_cmp_eq_u32 s37, 255
    s_cbranch_scc0 K12_PB7
    s_lshl_b32 s36, s34, 4
    s_add_u32 s36, s36, 16384
    s_mov_b64 exec, 1
    v_mov_b32 v255, 1
    v_mov_b32 v240, s36
    buffer_store_dword v255, v240, s[60:63], 0 offen sc1
    s_mov_b64 exec, -1
K12_PB7:
    s_mov_b32 s34, -1
    s_mov_b32 s41, -1
K12_ES5:
    s_waitcnt vmcnt(16)
    s_branch K12_XP_F
K12_XP_E:
    s_mov_b32 s41, s40
    s_add_u32 s40, s40, 1
    s_cmp_eq_u32 s41, 3
    s_cbranch_scc0 K12_ES8
    s_waitcnt vmcnt(0)
    s_mov_b32 s34, -1
    s_cmp_ge_u32 s41, 8
    s_cbranch_scc1 K12_SG9
    s_lshl_b32 s36, s41, 2
    s_add_u32 s37, s36, 155680
    s_mov_b64 exec, 1
    v_mov_b32 v255, s37
    v_mov_b32 v240, 1
    ds_add_rtn_u32 v240, v255, v240
    s_waitcnt lgkmcnt(0)
    v_readfirstlane_b32 s37, v240
    s_nop 3
    s_cmp_eq_u32 s37, 3
    s_cbranch_scc0 K12_SH9
    s_lshl_b32 s36, s36, 8
    v_mov_b32 v255, 1
    v_mov_b32 v240, s36
    buffer_atomic_add v255, v240, s[60:63], 0 offen sc0 sc1
    s_mov_b32 s34, s41
K12_SH9:
    s_mov_b64 exec, -1
K12_SG9:
    s_waitcnt vmcnt(0)
    s_cmp_ge_u32 s34, 8
    s_cbranch_scc1 K12_PB10
    v_readfirstlane_b32 s37, v255
    s_nop 3
    s_cmp_eq_u32 s37, 255
    s_cbranch_scc0 K12_PB10
    s_lshl_b32 s36, s34, 4
    s_add_u32 s36, s36, 16384
    s_mov_b64 exec, 1
    v_mov_b32 v255, 1
    v_mov_b32 v240, s36
    buffer_store_dword v255, v240, s[60:63], 0 offen sc1
    s_mov_b64 exec, -1
K12_PB10:
    s_mov_b32 s34, -1
    s_mov_b32 s41, -1
K12_ES8:
    s_waitcnt vmcnt(0)
K12_XP_F:
    s_cmp_ge_u32 s34, 8
    s_cbranch_scc1 K12_PB11
    v_readfirstlane_b32 s37, v255
    s_nop 3
    s_cmp_eq_u32 s37, 255
    s_cbranch_scc0 K12_PB11
    s_lshl_b32 s36, s34, 4
    s_add_u32 s36, s36, 16384
    s_mov_b64 exec, 1
    v_mov_b32 v255, 1
    v_mov_b32 v240, s36
    buffer_store_dword v255, v240, s[60:63], 0 offen sc1
    s_mov_b64 exec, -1
K12_PB11:
    s_cmp_ge_u32 s40, 8
    s_cbranch_scc1 K12_PFIN
K12_WENTRY:
    s_waitcnt vmcnt(0)
    s_mov_b32 s34, -1
    s_cmp_ge_u32 s41, 8
    s_cbranch_scc1 K12_SG12
    s_lshl_b32 s36, s41, 2
    s_add_u32 s37, s36, 155680
    s_mov_b64 exec, 1
    v_mov_b32 v255, s37
    v_mov_b32 v240, 1
    ds_add_rtn_u32 v240, v255, v240
    s_waitcnt lgkmcnt(0)
    v_readfirstlane_b32 s37, v240
    s_nop 3
    s_cmp_eq_u32 s37, 3
    s_cbranch_scc0 K12_SH12
    s_lshl_b32 s36, s36, 8
    v_mov_b32 v255, 1
    v_mov_b32 v240, s36
    buffer_atomic_add v255, v240, s[60:63], 0 offen sc0 sc1
    s_mov_b32 s34, s41
K12_SH12:
    s_mov_b64 exec, -1
K12_SG12:
    s_cmp_ge_u32 s34, 8
    s_cbranch_scc1 K12_EP13
    s_waitcnt vmcnt(0)
    s_cmp_ge_u32 s34, 8
    s_cbranch_scc1 K12_PB14
    v_readfirstlane_b32 s37, v255
    s_nop 3
    s_cmp_eq_u32 s37, 255
    s_cbranch_scc0 K12_PB14
    s_lshl_b32 s36, s34, 4
    s_add_u32 s36, s36, 16384
    s_mov_b64 exec, 1
    v_mov_b32 v255, 1
    v_mov_b32 v240, s36
    buffer_store_dword v255, v240, s[60:63], 0 offen sc1
    s_mov_b64 exec, -1
K12_PB14:
    s_mov_b32 s34, -1
K12_EP13:
    v_perm_b32 v64, v100, v96, s28
    v_perm_b32 v68, v100, v96, s29
    v_perm_b32 v65, v108, v104, s28
    v_perm_b32 v69, v108, v104, s29
    v_perm_b32 v66, v116, v112, s28
    v_perm_b32 v70, v116, v112, s29
    v_perm_b32 v67, v124, v120, s28
    v_perm_b32 v71, v124, v120, s29
    v_perm_b32 v72, v101, v97, s28
    v_perm_b32 v76, v101, v97, s29
    v_perm_b32 v73, v109, v105, s28
    v_perm_b32 v77, v109, v105, s29
    v_perm_b32 v74, v117, v113, s28
    v_perm_b32 v78, v117, v113, s29
    v_perm_b32 v75, v125, v121, s28
    v_perm_b32 v79, v125, v121, s29
    v_perm_b32 v80, v102, v98, s28
    v_perm_b32 v84, v102, v98, s29
    v_perm_b32 v81, v110, v106, s28
    v_perm_b32 v85, v110, v106, s29
    v_perm_b32 v82, v118, v114, s28
    v_perm_b32 v86, v118, v114, s29
    v_perm_b32 v83, v126, v122, s28
    v_perm_b32 v87, v126, v122, s29
    v_perm_b32 v88, v103, v99, s28
    v_perm_b32 v92, v103, v99, s29
    v_perm_b32 v89, v111, v107, s28
    v_perm_b32 v93, v111, v107, s29
    v_perm_b32 v90, v119, v115, s28
    v_perm_b32 v94, v119, v115, s29
    v_perm_b32 v91, v127, v123, s28
    v_perm_b32 v95, v127, v123, s29
    s_lshl_b32 s36, s40, 3
    s_sub_i32 s36, s36, 28
    s_max_i32 s36, s36, 1
    s_mov_b32 s37, 32768
K12_GL1:
    v_mov_b32 v240, 155648
    ds_read_b32 v240, v240
    s_waitcnt lgkmcnt(0)
    v_cmp_gt_u32 vcc, s36, v240
    s_sub_u32 s37, s37, 1
    s_cmp_eq_u32 s37, 0
    s_cbranch_scc1 K12_GT1
    s_cbranch_vccz K12_GT1
    s_sleep 2
    s_branch K12_GL1
K12_GT1:
    s_add_u32 s42, s40, 1
    s_mul_i32 s36, s42, 85
    s_add_u32 s36, s36, s2
    s_and_b32 s36, s36, 255
    s_mul_hi_u32 s37, s36, 0x55555556
    s_mul_i32 s38, s37, 3
    s_cmp_eq_u32 s38, s36
    s_cselect_b32 s27, 1, 0
    s_cmp_lt_u32 s37, 78
    s_cselect_b32 s27, s27, 0
    s_add_u32 s37, s37, 89
    s_cmp_eq_u32 s21, 0
    s_cselect_b32 s30, s24, s37
    s_cselect_b32 s27, 1, s27
    s_cmp_eq_u32 s27, 0
    s_cbranch_scc1 K12_WP_N
    s_lshl_b32 s36, s42, 8
    s_mul_i32 s37, s30, 98304
    s_add_u32 s36, s36, s37
    buffer_load_dwordx4 v[0:3], v248, s[4:7], s36 offen
    buffer_load_dwordx4 v[4:7], v248, s[4:7], s36 offen offset:2048
    s_add_u32 s36, s36, 4096
    buffer_load_dwordx4 v[8:11], v248, s[4:7], s36 offen
    buffer_load_dwordx4 v[12:15], v248, s[4:7], s36 offen offset:2048
    s_add_u32 s36, s36, 4096
    buffer_load_dwordx4 v[16:19], v248, s[4:7], s36 offen
    buffer_load_dwordx4 v[20:23], v248, s[4:7], s36 offen offset:2048
    s_add_u32 s36, s36, 4096
    buffer_load_dwordx4 v[24:27], v248, s[4:7], s36 offen
    buffer_load_dwordx4 v[28:31], v248, s[4:7], s36 offen offset:2048
    s_add_u32 s36, s36, 53248
    buffer_load_dwordx4 v[32:35], v248, s[4:7], s36 offen
    buffer_load_dwordx4 v[36:39], v248, s[4:7], s36 offen offset:2048
    s_add_u32 s36, s36, 4096
    buffer_load_dwordx4 v[40:43], v248, s[4:7], s36 offen
    buffer_load_dwordx4 v[44:47], v248, s[4:7], s36 offen offset:2048
    s_add_u32 s36, s36, 4096
    buffer_load_dwordx4 v[48:51], v248, s[4:7], s36 offen
    buffer_load_dwordx4 v[52:55], v248, s[4:7], s36 offen offset:2048
    s_add_u32 s36, s36, 4096
    buffer_load_dwordx4 v[56:59], v248, s[4:7], s36 offen
    buffer_load_dwordx4 v[60:63], v248, s[4:7], s36 offen offset:2048
    s_branch K12_WP_M
K12_WP_N:
K12_WP_M:
    s_lshl_b32 s36, s40, 7
    s_add_u32 s36, s36, s22
    s_and_b32 s37, s36, 3
    s_lshr_b32 s38, s36, 1
    s_and_b32 s38, s38, 4
    s_or_b32 s37, s37, s38
    v_bfe_u32 v253, v254, 5, 3
    v_xor_b32 v253, s37, v253
    v_lshl_add_u32 v253, v253, 5, v251
    s_lshl_b32 s36, s36, 9
    s_add_u32 s39, s36, s32
    v_mfma_f32_16x16x32_bf16 v[128:131], v[224:227], v[64:67], 0
    v_mfma_f32_16x16x32_bf16 v[132:135], v[224:227], v[68:71], 0
    v_mfma_f32_16x16x32_bf16 v[136:139], v[224:227], v[72:75], 0
    v_mfma_f32_16x16x32_bf16 v[140:143], v[224:227], v[76:79], 0
    v_mfma_f32_16x16x32_bf16 v[144:147], v[224:227], v[80:83], 0
    v_mfma_f32_16x16x32_bf16 v[148:151], v[224:227], v[84:87], 0
    v_mfma_f32_16x16x32_bf16 v[152:155], v[224:227], v[88:91], 0
    v_mfma_f32_16x16x32_bf16 v[156:159], v[224:227], v[92:95], 0
    s_nop 7
    v_cvt_pk_bf16_f32 v240, v128, v132
    v_cvt_pk_bf16_f32 v241, v136, v140
    v_cvt_pk_bf16_f32 v242, v144, v148
    v_cvt_pk_bf16_f32 v243, v152, v156
    buffer_store_dwordx4 v[240:243], v253, s[16:19], s39 offen sc1
    s_add_u32 s39, s39, 4194304
    v_cvt_pk_bf16_f32 v244, v129, v133
    v_cvt_pk_bf16_f32 v245, v137, v141
    v_cvt_pk_bf16_f32 v246, v145, v149
    v_cvt_pk_bf16_f32 v247, v153, v157
    buffer_store_dwordx4 v[244:247], v253, s[16:19], s39 offen sc1
    s_add_u32 s39, s39, 4194304
    v_cvt_pk_bf16_f32 v240, v130, v134
    v_cvt_pk_bf16_f32 v241, v138, v142
    v_cvt_pk_bf16_f32 v242, v146, v150
    v_cvt_pk_bf16_f32 v243, v154, v158
    buffer_store_dwordx4 v[240:243], v253, s[16:19], s39 offen sc1
    s_add_u32 s39, s39, 4194304
    v_cvt_pk_bf16_f32 v244, v131, v135
    v_cvt_pk_bf16_f32 v245, v139, v143
    v_cvt_pk_bf16_f32 v246, v147, v151
    v_cvt_pk_bf16_f32 v247, v155, v159
    buffer_store_dwordx4 v[244:247], v253, s[16:19], s39 offen sc1
    s_add_u32 s39, s39, 4194304
    v_mfma_f32_16x16x32_bf16 v[128:131], v[228:231], v[64:67], 0
    v_mfma_f32_16x16x32_bf16 v[132:135], v[228:231], v[68:71], 0
    v_mfma_f32_16x16x32_bf16 v[136:139], v[228:231], v[72:75], 0
    v_mfma_f32_16x16x32_bf16 v[140:143], v[228:231], v[76:79], 0
    v_mfma_f32_16x16x32_bf16 v[144:147], v[228:231], v[80:83], 0
    v_mfma_f32_16x16x32_bf16 v[148:151], v[228:231], v[84:87], 0
    v_mfma_f32_16x16x32_bf16 v[152:155], v[228:231], v[88:91], 0
    v_mfma_f32_16x16x32_bf16 v[156:159], v[228:231], v[92:95], 0
    s_nop 7
    v_cvt_pk_bf16_f32 v240, v128, v132
    v_cvt_pk_bf16_f32 v241, v136, v140
    v_cvt_pk_bf16_f32 v242, v144, v148
    v_cvt_pk_bf16_f32 v243, v152, v156
    buffer_store_dwordx4 v[240:243], v253, s[16:19], s39 offen sc1
    s_add_u32 s39, s39, 4194304
    v_cvt_pk_bf16_f32 v244, v129, v133
    v_cvt_pk_bf16_f32 v245, v137, v141
    v_cvt_pk_bf16_f32 v246, v145, v149
    v_cvt_pk_bf16_f32 v247, v153, v157
    buffer_store_dwordx4 v[244:247], v253, s[16:19], s39 offen sc1
    s_add_u32 s39, s39, 4194304
    v_cvt_pk_bf16_f32 v240, v130, v134
    v_cvt_pk_bf16_f32 v241, v138, v142
    v_cvt_pk_bf16_f32 v242, v146, v150
    v_cvt_pk_bf16_f32 v243, v154, v158
    buffer_store_dwordx4 v[240:243], v253, s[16:19], s39 offen sc1
    s_add_u32 s39, s39, 4194304
    v_cvt_pk_bf16_f32 v244, v131, v135
    v_cvt_pk_bf16_f32 v245, v139, v143
    v_cvt_pk_bf16_f32 v246, v147, v151
    v_cvt_pk_bf16_f32 v247, v155, v159
    buffer_store_dwordx4 v[244:247], v253, s[16:19], s39 offen sc1
    s_add_u32 s39, s39, 4194304
    v_mfma_f32_16x16x32_bf16 v[128:131], v[232:235], v[64:67], 0
    v_mfma_f32_16x16x32_bf16 v[132:135], v[232:235], v[68:71], 0
    v_mfma_f32_16x16x32_bf16 v[136:139], v[232:235], v[72:75], 0
    v_mfma_f32_16x16x32_bf16 v[140:143], v[232:235], v[76:79], 0
    v_mfma_f32_16x16x32_bf16 v[144:147], v[232:235], v[80:83], 0
    v_mfma_f32_16x16x32_bf16 v[148:151], v[232:235], v[84:87], 0
    v_mfma_f32_16x16x32_bf16 v[152:155], v[232:235], v[88:91], 0
    v_mfma_f32_16x16x32_bf16 v[156:159], v[232:235], v[92:95], 0
    s_nop 7
    v_cvt_pk_bf16_f32 v240, v128, v132
    v_cvt_pk_bf16_f32 v241, v136, v140
    v_cvt_pk_bf16_f32 v242, v144, v148
    v_cvt_pk_bf16_f32 v243, v152, v156
    buffer_store_dwordx4 v[240:243], v253, s[16:19], s39 offen sc1
    s_add_u32 s39, s39, 4194304
    v_cvt_pk_bf16_f32 v244, v129, v133
    v_cvt_pk_bf16_f32 v245, v137, v141
    v_cvt_pk_bf16_f32 v246, v145, v149
    v_cvt_pk_bf16_f32 v247, v153, v157
    buffer_store_dwordx4 v[244:247], v253, s[16:19], s39 offen sc1
    s_add_u32 s39, s39, 4194304
    v_cvt_pk_bf16_f32 v240, v130, v134
    v_cvt_pk_bf16_f32 v241, v138, v142
    v_cvt_pk_bf16_f32 v242, v146, v150
    v_cvt_pk_bf16_f32 v243, v154, v158
    buffer_store_dwordx4 v[240:243], v253, s[16:19], s39 offen sc1
    s_add_u32 s39, s39, 4194304
    v_cvt_pk_bf16_f32 v244, v131, v135
    v_cvt_pk_bf16_f32 v245, v139, v143
    v_cvt_pk_bf16_f32 v246, v147, v151
    v_cvt_pk_bf16_f32 v247, v155, v159
    buffer_store_dwordx4 v[244:247], v253, s[16:19], s39 offen sc1
    s_add_u32 s39, s39, 4194304
    v_mfma_f32_16x16x32_bf16 v[128:131], v[236:239], v[64:67], 0
    v_mfma_f32_16x16x32_bf16 v[132:135], v[236:239], v[68:71], 0
    v_mfma_f32_16x16x32_bf16 v[136:139], v[236:239], v[72:75], 0
    v_mfma_f32_16x16x32_bf16 v[140:143], v[236:239], v[76:79], 0
    v_mfma_f32_16x16x32_bf16 v[144:147], v[236:239], v[80:83], 0
    v_mfma_f32_16x16x32_bf16 v[148:151], v[236:239], v[84:87], 0
    v_mfma_f32_16x16x32_bf16 v[152:155], v[236:239], v[88:91], 0
    v_mfma_f32_16x16x32_bf16 v[156:159], v[236:239], v[92:95], 0
    s_nop 7
    v_cvt_pk_bf16_f32 v240, v128, v132
    v_cvt_pk_bf16_f32 v241, v136, v140
    v_cvt_pk_bf16_f32 v242, v144, v148
    v_cvt_pk_bf16_f32 v243, v152, v156
    buffer_store_dwordx4 v[240:243], v253, s[16:19], s39 offen sc1
    s_add_u32 s39, s39, 4194304
    v_cvt_pk_bf16_f32 v244, v129, v133
    v_cvt_pk_bf16_f32 v245, v137, v141
    v_cvt_pk_bf16_f32 v246, v145, v149
    v_cvt_pk_bf16_f32 v247, v153, v157
    buffer_store_dwordx4 v[244:247], v253, s[16:19], s39 offen sc1
    s_add_u32 s39, s39, 4194304
    v_cvt_pk_bf16_f32 v240, v130, v134
    v_cvt_pk_bf16_f32 v241, v138, v142
    v_cvt_pk_bf16_f32 v242, v146, v150
    v_cvt_pk_bf16_f32 v243, v154, v158
    buffer_store_dwordx4 v[240:243], v253, s[16:19], s39 offen sc1
    s_add_u32 s39, s39, 4194304
    v_cvt_pk_bf16_f32 v244, v131, v135
    v_cvt_pk_bf16_f32 v245, v139, v143
    v_cvt_pk_bf16_f32 v246, v147, v151
    v_cvt_pk_bf16_f32 v247, v155, v159
    buffer_store_dwordx4 v[244:247], v253, s[16:19], s39 offen sc1
    s_mov_b32 s41, s40
    s_add_u32 s40, s40, 1
    s_cmp_eq_u32 s41, 3
    s_cbranch_scc0 K12_ES15
    s_waitcnt vmcnt(0)
    s_mov_b32 s34, -1
    s_cmp_ge_u32 s41, 8
    s_cbranch_scc1 K12_SG16
    s_lshl_b32 s36, s41, 2
    s_add_u32 s37, s36, 155680
    s_mov_b64 exec, 1
    v_mov_b32 v255, s37
    v_mov_b32 v240, 1
    ds_add_rtn_u32 v240, v255, v240
    s_waitcnt lgkmcnt(0)
    v_readfirstlane_b32 s37, v240
    s_nop 3
    s_cmp_eq_u32 s37, 3
    s_cbranch_scc0 K12_SH16
    s_lshl_b32 s36, s36, 8
    v_mov_b32 v255, 1
    v_mov_b32 v240, s36
    buffer_atomic_add v255, v240, s[60:63], 0 offen sc0 sc1
    s_mov_b32 s34, s41
K12_SH16:
    s_mov_b64 exec, -1
K12_SG16:
    s_waitcnt vmcnt(0)
    s_cmp_ge_u32 s34, 8
    s_cbranch_scc1 K12_PB17
    v_readfirstlane_b32 s37, v255
    s_nop 3
    s_cmp_eq_u32 s37, 255
    s_cbranch_scc0 K12_PB17
    s_lshl_b32 s36, s34, 4
    s_add_u32 s36, s36, 16384
    s_mov_b64 exec, 1
    v_mov_b32 v255, 1
    v_mov_b32 v240, s36
    buffer_store_dword v255, v240, s[60:63], 0 offen sc1
    s_mov_b64 exec, -1
K12_PB17:
    s_mov_b32 s34, -1
    s_mov_b32 s41, -1
K12_ES15:
    s_waitcnt vmcnt(16)
    s_cmp_ge_u32 s34, 8
    s_cbranch_scc1 K12_PB18
    v_readfirstlane_b32 s37, v255
    s_nop 3
    s_cmp_eq_u32 s37, 255
    s_cbranch_scc0 K12_PB18
    s_lshl_b32 s36, s34, 4
    s_add_u32 s36, s36, 16384
    s_mov_b64 exec, 1
    v_mov_b32 v255, 1
    v_mov_b32 v240, s36
    buffer_store_dword v255, v240, s[60:63], 0 offen sc1
    s_mov_b64 exec, -1
K12_PB18:
    s_cmp_lt_u32 s40, 8
    s_cbranch_scc1 K12_XW
K12_PFIN:
    s_waitcnt vmcnt(0)
    s_mov_b32 s34, -1
    s_cmp_ge_u32 s41, 8
    s_cbranch_scc1 K12_SG19
    s_lshl_b32 s36, s41, 2
    s_add_u32 s37, s36, 155680
    s_mov_b64 exec, 1
    v_mov_b32 v255, s37
    v_mov_b32 v240, 1
    ds_add_rtn_u32 v240, v255, v240
    s_waitcnt lgkmcnt(0)
    v_readfirstlane_b32 s37, v240
    s_nop 3
    s_cmp_eq_u32 s37, 3
    s_cbranch_scc0 K12_SH19
    s_lshl_b32 s36, s36, 8
    v_mov_b32 v255, 1
    v_mov_b32 v240, s36
    buffer_atomic_add v255, v240, s[60:63], 0 offen sc0 sc1
    s_mov_b32 s34, s41
K12_SH19:
    s_mov_b64 exec, -1
K12_SG19:
    s_waitcnt vmcnt(0)
    s_cmp_ge_u32 s34, 8
    s_cbranch_scc1 K12_PB20
    v_readfirstlane_b32 s37, v255
    s_nop 3
    s_cmp_eq_u32 s37, 255
    s_cbranch_scc0 K12_PB20
    s_lshl_b32 s36, s34, 4
    s_add_u32 s36, s36, 16384
    s_mov_b64 exec, 1
    v_mov_b32 v255, 1
    v_mov_b32 v240, s36
    buffer_store_dword v255, v240, s[60:63], 0 offen sc1
    s_mov_b64 exec, -1
K12_PB20:
    s_endpgm
K12_CONS:
    s_and_b32 s6, s2, 7
    s_lshl_b32 s6, s6, 2
    s_lshr_b32 s7, s2, 6
    s_add_u32 s6, s6, s7
    s_mov_b32 s51, s6
    s_mov_b32 s27, s6
    s_lshr_b32 s7, s2, 3
    s_and_b32 s7, s7, 7
    s_lshr_b32 s20, s7, 2
    s_and_b32 s21, s7, 3
    s_lshl_b32 s22, s6, 1
    s_add_u32 s22, s22, s20
    s_lshl_b32 s23, s6, 2
    s_add_u32 s23, s23, s21
    s_mul_i32 s24, s22, 684032
    s_mul_i32 s25, s23, 524288
    s_add_u32 s25, s25, 50331648
    s_mul_i32 s26, s22, 342016
    s_add_u32 s26, s26, 118489088
    s_add_u32 s8, s58, s24
    s_addc_u32 s9, s59, 0
    s_and_b32 s9, s9, 0xffff
    s_mov_b32 s10, 684032
    s_mov_b32 s11, 0x00020000
    s_add_u32 s12, s58, s25
    s_addc_u32 s13, s59, 0
    s_and_b32 s13, s13, 0xffff
    s_mov_b32 s14, 524288
    s_mov_b32 s15, 0x00020000
    s_add_u32 s16, s58, s26
    s_addc_u32 s17, s59, 0
    s_and_b32 s17, s17, 0xffff
    s_mov_b32 s18, 342016
    s_mov_b32 s19, 0x00020000
    s_add_u32 s4, s58, 153108480
    s_addc_u32 s5, s59, 0
    s_and_b32 s5, s5, 0xffff
    s_cmp_eq_u32 s3, 0
    s_cselect_b32 s6, 128, 0
    s_mov_b32 s7, 0x00020000
    s_mov_b32 s46, 155712
    s_cselect_b32 s46, s46, 155776
    s_mov_b32 s47, 155712
    s_cselect_b32 s47, s47, 155744
    s_cselect_b32 s45, 4, 0
    s_mov_b32 s50, s45
    v_and_b32 v8, 15, v2
    v_lshrrev_b32 v9, 4, v2
    v_lshlrev_b32 v1, 4, v2
    s_mul_i32 s30, s3, 5120
    s_mov_b32 s36, s30
    s_lshl_b32 s31, s3, 12
    s_add_u32 s37, s31, 22528
    s_lshr_b32 s28, s3, 1
    s_and_b32 s29, s3, 1
    s_lshl_b32 s33, s29, 9
    s_add_u32 s33, s33, 20480
    s_mul_i32 s38, s28, 896
    s_add_u32 s38, s38, s33
    s_lshl_b32 s34, s51, 1
    s_add_u32 s34, s34, s28
    s_mul_i32 s34, s34, 684032
    s_add_u32 s64, s58, s34
    s_addc_u32 s65, s59, 0
    s_and_b32 s65, s65, 0xffff
    s_mov_b32 s66, 684032
    s_mov_b32 s67, 0x00020000
    s_mov_b32 s44, 0xffffff
    s_cmp_eq_u32 s29, 0
    s_cselect_b32 s44, -1, s44
    s_mov_b32 s45, 0
    v_lshrrev_b32 v10, 1, v8
    v_xor_b32 v10, v10, v9
    v_lshlrev_b32 v10, 4, v10
    v_lshl_add_u32 v2, v8, 7, v10
    v_xor_b32 v3, 64, v2
    v_lshrrev_b32 v10, 2, v8
    v_lshl_add_u32 v11, v9, 3, v10
    v_lshlrev_b32 v11, 9, v11
    v_and_b32 v12, 1, v9
    v_lshl_or_b32 v10, v12, 2, v10
    s_lshl_b32 s28, s3, 1
    v_xor_b32 v10, s28, v10
    v_lshl_add_u32 v11, v10, 5, v11
    v_and_b32 v10, 3, v8
    v_lshl_add_u32 v11, v10, 3, v11
    v_add_u32 v4, 22528, v11
    s_lshl_b32 s28, s20, 5
    v_xor_b32 v4, s28, v4
    v_and_b32 v10, 3, v8
    v_lshlrev_b32 v10, 2, v10
    v_add_u32 v5, 155648, v10
    s_lshl_b32 s28, s3, 2
    s_add_u32 s28, s28, 155648
    v_mov_b32 v7, s28
    s_mov_b32 s35, 0x80008000
    s_mov_b32 s62, 0
    s_mov_b32 s63, 0
    s_mov_b32 s39, 0
    s_add_u32 m0, s39, s36
    s_nop 0
    buffer_load_dwordx4 v1, s[8:11], s30 offen sc1 lds
    buffer_load_dwordx4 v1, s[8:11], s30 offen offset:1024 sc1 lds
    buffer_load_dwordx4 v1, s[8:11], s30 offen offset:2048 sc1 lds
    buffer_load_dwordx4 v1, s[8:11], s30 offen offset:3072 sc1 lds
    s_add_u32 m0, m0, 4096
    s_add_u32 s34, s30, 4096
    buffer_load_dwordx4 v1, s[8:11], s34 offen sc1 lds
    s_add_u32 m0, s39, s37
    s_add_u32 s30, s30, 21376
    buffer_load_dwordx4 v1, s[12:15], s31 offen sc1 lds
    buffer_load_dwordx4 v1, s[12:15], s31 offen offset:1024 sc1 lds
    buffer_load_dwordx4 v1, s[12:15], s31 offen offset:2048 sc1 lds
    buffer_load_dwordx4 v1, s[12:15], s31 offen offset:3072 sc1 lds
    s_add_u32 m0, s39, s38
    s_mov_b64 exec, s[44:45]
    buffer_load_dwordx4 v1, s[64:67], s33 offen sc1 lds
    s_mov_b64 exec, -1
    s_add_u32 s31, s31, 16384
    s_add_u32 s33, s33, 21376
    s_add_u32 s39, s39, 38912
    s_add_u32 m0, s39, s36
    s_nop 0
    buffer_load_dwordx4 v1, s[8:11], s30 offen sc1 lds
    buffer_load_dwordx4 v1, s[8:11], s30 offen offset:1024 sc1 lds
    buffer_load_dwordx4 v1, s[8:11], s30 offen offset:2048 sc1 lds
    buffer_load_dwordx4 v1, s[8:11], s30 offen offset:3072 sc1 lds
    s_add_u32 m0, m0, 4096
    s_add_u32 s34, s30, 4096
    buffer_load_dwordx4 v1, s[8:11], s34 offen sc1 lds
    s_add_u32 m0, s39, s37
    s_add_u32 s30, s30, 21376
    buffer_load_dwordx4 v1, s[12:15], s31 offen sc1 lds
    buffer_load_dwordx4 v1, s[12:15], s31 offen offset:1024 sc1 lds
    buffer_load_dwordx4 v1, s[12:15], s31 offen offset:2048 sc1 lds
    buffer_load_dwordx4 v1, s[12:15], s31 offen offset:3072 sc1 lds
    s_add_u32 m0, s39, s38
    s_mov_b64 exec, s[44:45]
    buffer_load_dwordx4 v1, s[64:67], s33 offen sc1 lds
    s_mov_b64 exec, -1
    s_add_u32 s31, s31, 16384
    s_add_u32 s33, s33, 21376
    s_add_u32 s39, s39, 38912
    s_add_u32 m0, s39, s36
    s_nop 0
    buffer_load_dwordx4 v1, s[8:11], s30 offen sc1 lds
    buffer_load_dwordx4 v1, s[8:11], s30 offen offset:1024 sc1 lds
    buffer_load_dwordx4 v1, s[8:11], s30 offen offset:2048 sc1 lds
    buffer_load_dwordx4 v1, s[8:11], s30 offen offset:3072 sc1 lds
    s_add_u32 m0, m0, 4096
    s_add_u32 s34, s30, 4096
    buffer_load_dwordx4 v1, s[8:11], s34 offen sc1 lds
    s_add_u32 m0, s39, s37
    s_add_u32 s30, s30, 21376
    buffer_load_dwordx4 v1, s[12:15], s31 offen sc1 lds
    buffer_load_dwordx4 v1, s[12:15], s31 offen offset:1024 sc1 lds
    buffer_load_dwordx4 v1, s[12:15], s31 offen offset:2048 sc1 lds
    buffer_load_dwordx4 v1, s[12:15], s31 offen offset:3072 sc1 lds
    s_add_u32 m0, s39, s38
    s_mov_b64 exec, s[44:45]
    buffer_load_dwordx4 v1, s[64:67], s33 offen sc1 lds
    s_mov_b64 exec, -1
    s_add_u32 s31, s31, 16384
    s_add_u32 s33, s33, 21376
    s_add_u32 s39, s39, 38912
    s_mov_b32 m0, s46
    s_mov_b64 exec, 0xff
    buffer_load_dword v1, s[4:7], 0 offen sc1 lds
    s_mov_b64 exec, -1
    v_lshrrev_b32 v9, 4, v1
    v_and_b32 v8, 15, v9
    v_lshrrev_b32 v9, 4, v9
    v_and_b32 v10, 3, v8
    v_lshlrev_b32 v10, 2, v10
    v_lshrrev_b32 v12, 3, v8
    v_lshl_add_u32 v10, v12, 1, v10
    s_lshl_b32 s28, s3, 4
    s_add_u32 s28, s28, 1
    v_add_u32 v10, s28, v10
    v_bfe_u32 v11, v8, 2, 1
    v_and_b32 v13, 1, v9
    v_lshlrev_b32 v13, 3, v13
    v_mul_u32_u24 v14, 96, v11
    v_mad_u32_u24 v15, v10, v13, v14
    v_mad_u32_u24 v16, v10, 0, v15
    v_mad_u32_u24 v17, v10, 1, v15
    v_mad_u32_u24 v18, v10, 2, v15
    v_mad_u32_u24 v19, v10, 3, v15
    v_mad_u32_u24 v20, v10, 4, v15
    v_mad_u32_u24 v21, v10, 5, v15
    v_mad_u32_u24 v22, v10, 6, v15
    v_mad_u32_u24 v23, v10, 7, v15
    v_and_b32 v16, 127, v16
    v_and_b32 v17, 127, v17
    v_and_b32 v18, 127, v18
    v_and_b32 v19, 127, v19
    v_and_b32 v20, 127, v20
    v_and_b32 v21, 127, v21
    v_and_b32 v22, 127, v22
    v_and_b32 v23, 127, v23
    v_cvt_f32_u32 v16, v16
    v_cvt_f32_u32 v17, v17
    v_cvt_f32_u32 v18, v18
    v_cvt_f32_u32 v19, v19
    v_cvt_f32_u32 v20, v20
    v_cvt_f32_u32 v21, v21
    v_cvt_f32_u32 v22, v22
    v_cvt_f32_u32 v23, v23
    v_mul_f32 v16, 0x3c000000, v16
    v_mul_f32 v17, 0x3c000000, v17
    v_mul_f32 v18, 0x3c000000, v18
    v_mul_f32 v19, 0x3c000000, v19
    v_mul_f32 v20, 0x3c000000, v20
    v_mul_f32 v21, 0x3c000000, v21
    v_mul_f32 v22, 0x3c000000, v22
    v_mul_f32 v23, 0x3c000000, v23
    v_cos_f32 v16, v16
    v_cos_f32 v17, v17
    v_cos_f32 v18, v18
    v_cos_f32 v19, v19
    v_cos_f32 v20, v20
    v_cos_f32 v21, v21
    v_cos_f32 v22, v22
    v_cos_f32 v23, v23
    s_nop 0
    v_cvt_pk_bf16_f32 v24, v16, v17
    v_cvt_pk_bf16_f32 v25, v18, v19
    v_cvt_pk_bf16_f32 v26, v20, v21
    v_cvt_pk_bf16_f32 v27, v22, v23
    v_lshlrev_b32 v32, 16, v24
    v_and_b32 v33, 0xffff0000, v24
    v_sub_f32 v16, v16, v32
    v_sub_f32 v17, v17, v33
    v_lshlrev_b32 v32, 16, v25
    v_and_b32 v33, 0xffff0000, v25
    v_sub_f32 v18, v18, v32
    v_sub_f32 v19, v19, v33
    v_lshlrev_b32 v32, 16, v26
    v_and_b32 v33, 0xffff0000, v26
    v_sub_f32 v20, v20, v32
    v_sub_f32 v21, v21, v33
    v_lshlrev_b32 v32, 16, v27
    v_and_b32 v33, 0xffff0000, v27
    v_sub_f32 v22, v22, v32
    v_sub_f32 v23, v23, v33
    v_cvt_pk_bf16_f32 v28, v16, v17
    v_cvt_pk_bf16_f32 v29, v18, v19
    v_cvt_pk_bf16_f32 v30, v20, v21
    v_cvt_pk_bf16_f32 v31, v22, v23
    v_cmp_lt_u32 vcc, 1, v9
    s_lshl_b32 s28, s3, 10
    s_add_u32 s28, s28, 133120
    v_add_u32 v14, s28, v1
    v_cndmask_b32 v24, v24, v28, vcc
    v_cndmask_b32 v25, v25, v29, vcc
    v_cndmask_b32 v26, v26, v30, vcc
    v_cndmask_b32 v27, v27, v31, vcc
    ds_write_b128 v14, v[24:27]
    v_mov_b32 v12, 0
    v_mov_b32 v13, 0
    v_mov_b32 v14, 0
    v_mov_b32 v15, 0
    s_mul_i32 s28, s3, 38912
    s_add_u32 s28, s28, 22272
    v_add_u32 v16, s28, v1
    s_mov_b64 exec, 0xffff
    ds_write_b128 v16, v[12:15]
    s_mov_b64 exec, -1
    s_lshl_b32 s28, s3, 2
    s_add_u32 s28, s28, 155648
    v_mov_b32 v16, s28
    ds_write_b32 v16, v12
    s_lshl_b32 s28, s3, 3
    s_add_u32 s28, s28, 155680
    v_mov_b32 v16, s28
    ds_write_b64 v16, v[12:13]
    s_lshl_b32 s28, s3, 3
    s_add_u32 s28, s28, 155712
    v_mov_b32 v16, s28
    ds_write_b64 v16, v[12:13]
    v_mov_b32 v16, 155664
    ds_write_b32 v16, v12
    v_mov_b32 v16, 155744
    v_mov_b32 v17, 1
    ds_write_b32 v16, v17
    s_waitcnt lgkmcnt(0)
    s_barrier
    v_mov_b32 v80, 0
    v_mov_b32 v81, 0
    v_mov_b32 v82, 0
    v_mov_b32 v83, 0
    v_mov_b32 v84, 0
    v_mov_b32 v85, 0
    v_mov_b32 v86, 0
    v_mov_b32 v87, 0
    v_mov_b32 v88, 0
    v_mov_b32 v89, 0
    v_mov_b32 v90, 0
    v_mov_b32 v91, 0
    v_mov_b32 v92, 0
    v_mov_b32 v93, 0
    v_mov_b32 v94, 0
    v_mov_b32 v95, 0
    v_mov_b32 v96, 0
    v_mov_b32 v97, 0
    v_mov_b32 v98, 0
    v_mov_b32 v99, 0
    v_mov_b32 v100, 0
    v_mov_b32 v101, 0
    v_mov_b32 v102, 0
    v_mov_b32 v103, 0
    v_mov_b32 v104, 0
    v_mov_b32 v105, 0
    v_mov_b32 v106, 0
    v_mov_b32 v107, 0
    v_mov_b32 v108, 0
    v_mov_b32 v109, 0
    v_mov_b32 v110, 0
    v_mov_b32 v111, 0
    v_mov_b32 v112, 0
    v_mov_b32 v113, 0
    v_mov_b32 v114, 0
    v_mov_b32 v115, 0
    v_mov_b32 v116, 0
    v_mov_b32 v117, 0
    v_mov_b32 v118, 0
    v_mov_b32 v119, 0
    v_mov_b32 v120, 0
    v_mov_b32 v121, 0
    v_mov_b32 v122, 0
    v_mov_b32 v123, 0
    v_mov_b32 v124, 0
    v_mov_b32 v125, 0
    v_mov_b32 v126, 0
    v_mov_b32 v127, 0
    v_mov_b32 v128, 0
    v_mov_b32 v129, 0
    v_mov_b32 v130, 0
    v_mov_b32 v131, 0
    v_mov_b32 v132, 0
    v_mov_b32 v133, 0
    v_mov_b32 v134, 0
    v_mov_b32 v135, 0
    v_mov_b32 v136, 0
    v_mov_b32 v137, 0
    v_mov_b32 v138, 0
    v_mov_b32 v139, 0
    v_mov_b32 v140, 0
    v_mov_b32 v141, 0
    v_mov_b32 v142, 0
    v_mov_b32 v143, 0
    v_mov_b32 v144, 0
    v_mov_b32 v145, 0
    v_mov_b32 v146, 0
    v_mov_b32 v147, 0
    v_mov_b32 v148, 0
    v_mov_b32 v149, 0
    v_mov_b32 v150, 0
    v_mov_b32 v151, 0
    v_mov_b32 v152, 0
    v_mov_b32 v153, 0
    v_mov_b32 v154, 0
    v_mov_b32 v155, 0
    v_mov_b32 v156, 0
    v_mov_b32 v157, 0
    v_mov_b32 v158, 0
    v_mov_b32 v159, 0
    v_mov_b32 v160, 0
    v_mov_b32 v161, 0
    v_mov_b32 v162, 0
    v_mov_b32 v163, 0
    v_mov_b32 v164, 0
    v_mov_b32 v165, 0
    v_mov_b32 v166, 0
    v_mov_b32 v167, 0
    v_mov_b32 v168, 0
    v_mov_b32 v169, 0
    v_mov_b32 v170, 0
    v_mov_b32 v171, 0
    v_mov_b32 v172, 0
    v_mov_b32 v173, 0
    v_mov_b32 v174, 0
    v_mov_b32 v175, 0
    v_mov_b32 v176, 0
    v_mov_b32 v177, 0
    v_mov_b32 v178, 0
    v_mov_b32 v179, 0
    v_mov_b32 v180, 0
    v_mov_b32 v181, 0
    v_mov_b32 v182, 0
    v_mov_b32 v183, 0
    v_mov_b32 v184, 0
    v_mov_b32 v185, 0
    v_mov_b32 v186, 0
    v_mov_b32 v187, 0
    v_mov_b32 v188, 0
    v_mov_b32 v189, 0
    v_mov_b32 v190, 0
    v_mov_b32 v191, 0
    v_mov_b32 v192, 0
    v_mov_b32 v193, 0
    v_mov_b32 v194, 0
    v_mov_b32 v195, 0
    v_mov_b32 v196, 0
    v_mov_b32 v197, 0
    v_mov_b32 v198, 0
    v_mov_b32 v199, 0
    v_mov_b32 v200, 0
    v_mov_b32 v201, 0
    v_mov_b32 v202, 0
    v_mov_b32 v203, 0
    v_mov_b32 v204, 0
    v_mov_b32 v205, 0
    v_mov_b32 v206, 0
    v_mov_b32 v207, 0
    v_mov_b32 v208, 0
    v_mov_b32 v209, 0
    v_mov_b32 v210, 0
    v_mov_b32 v211, 0
    v_mov_b32 v212, 0
    v_mov_b32 v213, 0
    v_mov_b32 v214, 0
    v_mov_b32 v215, 0
    v_mov_b32 v216, 0
    v_mov_b32 v217, 0
    v_mov_b32 v218, 0
    v_mov_b32 v219, 0
    v_mov_b32 v220, 0
    v_mov_b32 v221, 0
    v_mov_b32 v222, 0
    v_mov_b32 v223, 0
    v_mov_b32 v224, 0
    v_mov_b32 v225, 0
    v_mov_b32 v226, 0
    v_mov_b32 v227, 0
    v_mov_b32 v228, 0
    v_mov_b32 v229, 0
    v_mov_b32 v230, 0
    v_mov_b32 v231, 0
    v_mov_b32 v232, 0
    v_mov_b32 v233, 0
    v_mov_b32 v234, 0
    v_mov_b32 v235, 0
    v_mov_b32 v236, 0
    v_mov_b32 v237, 0
    v_mov_b32 v238, 0
    v_mov_b32 v239, 0
    v_mov_b32 v240, 0
    v_mov_b32 v241, 0
    v_mov_b32 v242, 0
    v_mov_b32 v243, 0
    v_mov_b32 v244, 0
    v_mov_b32 v245, 0
    v_mov_b32 v246, 0
    v_mov_b32 v247, 0
    v_mov_b32 v248, 0
    v_mov_b32 v249, 0
    v_mov_b32 v250, 0
    v_mov_b32 v251, 0
    v_mov_b32 v252, 0
    v_mov_b32 v253, 0
    v_mov_b32 v254, 0
    v_mov_b32 v255, 0
    s_barrier
    s_mov_b32 s40, 2
    v_mov_b32 v0, s40
    s_waitcnt vmcnt(21)
    ds_write_b32 v7, v0
    s_branch K12_S0
K12_Q0:
    ds_read_b64_tr_b16 v[40:41], v4 offset:0
    ds_read_b64_tr_b16 v[42:43], v4 offset:2048
    ds_read_b64_tr_b16 v[44:45], v4 offset:256
    ds_read_b64_tr_b16 v[46:47], v4 offset:2304
    v_xor_b32 v4, 32, v4
    ds_read_b64_tr_b16 v[48:49], v4 offset:0
    ds_read_b64_tr_b16 v[50:51], v4 offset:2048
    ds_read_b64_tr_b16 v[52:53], v4 offset:256
    ds_read_b64_tr_b16 v[54:55], v4 offset:2304
    v_xor_b32 v4, 32, v4
    ds_read_b128 v[8:11], v2 offset:0
    ds_read_b128 v[12:15], v3 offset:0
    ds_read_b128 v[16:19], v2 offset:2048
    ds_read_b128 v[20:23], v3 offset:2048
    ds_read_b128 v[32:35], v2 offset:6144
    ds_read_b128 v[36:39], v3 offset:6144
    ds_read_b32 v68, v5
    s_waitcnt lgkmcnt(7)
    v_xor_b32 v72, s35, v44
    v_xor_b32 v73, s35, v45
    v_xor_b32 v74, s35, v46
    v_xor_b32 v75, s35, v47
    v_xor_b32 v76, s35, v52
    v_xor_b32 v77, s35, v53
    v_xor_b32 v78, s35, v54
    v_xor_b32 v79, s35, v55
    s_mov_b32 s41, 0
    s_mov_b32 s42, 38912
    s_mov_b32 s39, 0
    s_mov_b32 s29, 116736
K12_LOOP:
    s_waitcnt lgkmcnt(2)
    v_mfma_f32_16x16x32_bf16 v[80:83], v[8:11], v[40:43], v[80:83]
    ds_read_b128 v[24:27], v2 offset:4096
    v_xor_b32 v72, s35, v44
    v_xor_b32 v73, s35, v45
    v_mfma_f32_16x16x32_bf16 v[84:87], v[8:11], v[44:47], v[84:87]
    ds_read_b128 v[28:31], v3 offset:4096
    v_xor_b32 v74, s35, v46
    v_xor_b32 v75, s35, v47
    v_mfma_f32_16x16x32_bf16 v[88:91], v[8:11], v[48:51], v[88:91]
    s_waitcnt lgkmcnt(2)
    v_cmp_gt_u32 vcc, s40, v68
    s_add_u32 s49, s39, 2
    s_lshr_b32 s49, s49, 1
    v_xor_b32 v76, s35, v52
    v_xor_b32 v77, s35, v53
    v_mfma_f32_16x16x32_bf16 v[92:95], v[8:11], v[52:55], v[92:95]
    s_cbranch_vccnz K12_S1
K12_Q1:
    s_mul_i32 s48, s49, s50
    s_add_u32 s48, s48, s47
    v_xor_b32 v78, s35, v54
    v_xor_b32 v79, s35, v55
    v_mfma_f32_16x16x32_bf16 v[80:83], v[12:15], v[72:75], v[80:83]
    s_add_u32 m0, s29, s36
    s_nop 0
    buffer_load_dwordx4 v1, s[8:11], s30 offen sc1 lds
    v_mfma_f32_16x16x32_bf16 v[84:87], v[12:15], v[40:43], v[84:87]
    s_cmp_lt_u32 s49, 8
    s_cselect_b32 s48, s48, 155744
    v_mfma_f32_16x16x32_bf16 v[88:91], v[12:15], v[76:79], v[88:91]
    s_cmp_ge_u32 s49, 3
    s_cselect_b32 s48, s48, 155744
    v_mfma_f32_16x16x32_bf16 v[92:95], v[12:15], v[48:51], v[92:95]
    v_mfma_f32_16x16x32_bf16 v[96:99], v[16:19], v[40:43], v[96:99]
    ds_read_b128 v[8:11], v2 offset:8192
    v_mfma_f32_16x16x32_bf16 v[100:103], v[16:19], v[44:47], v[100:103]
    ds_read_b128 v[12:15], v3 offset:8192
    v_mfma_f32_16x16x32_bf16 v[104:107], v[16:19], v[48:51], v[104:107]
    buffer_load_dwordx4 v1, s[8:11], s30 offen offset:1024 sc1 lds
    v_mfma_f32_16x16x32_bf16 v[108:111], v[16:19], v[52:55], v[108:111]
    v_mfma_f32_16x16x32_bf16 v[96:99], v[20:23], v[72:75], v[96:99]
    v_mfma_f32_16x16x32_bf16 v[100:103], v[20:23], v[40:43], v[100:103]
    v_mfma_f32_16x16x32_bf16 v[104:107], v[20:23], v[76:79], v[104:107]
    buffer_load_dwordx4 v1, s[8:11], s30 offen offset:2048 sc1 lds
    v_mfma_f32_16x16x32_bf16 v[108:111], v[20:23], v[48:51], v[108:111]
    s_waitcnt lgkmcnt(2)
    v_mfma_f32_16x16x32_bf16 v[112:115], v[24:27], v[40:43], v[112:115]
    ds_read_b128 v[16:19], v2 offset:10240
    v_mfma_f32_16x16x32_bf16 v[116:119], v[24:27], v[44:47], v[116:119]
    ds_read_b128 v[20:23], v3 offset:10240
    v_mfma_f32_16x16x32_bf16 v[120:123], v[24:27], v[48:51], v[120:123]
    v_mfma_f32_16x16x32_bf16 v[124:127], v[24:27], v[52:55], v[124:127]
    v_mfma_f32_16x16x32_bf16 v[112:115], v[28:31], v[72:75], v[112:115]
    buffer_load_dwordx4 v1, s[8:11], s30 offen offset:3072 sc1 lds
    v_mfma_f32_16x16x32_bf16 v[116:119], v[28:31], v[40:43], v[116:119]
    v_mfma_f32_16x16x32_bf16 v[120:123], v[28:31], v[76:79], v[120:123]
    v_mfma_f32_16x16x32_bf16 v[124:127], v[28:31], v[48:51], v[124:127]
    v_mfma_f32_16x16x32_bf16 v[128:131], v[32:35], v[40:43], v[128:131]
    ds_read_b128 v[24:27], v2 offset:12288
    v_mfma_f32_16x16x32_bf16 v[132:135], v[32:35], v[44:47], v[132:135]
    ds_read_b128 v[28:31], v3 offset:12288
    v_mfma_f32_16x16x32_bf16 v[136:139], v[32:35], v[48:51], v[136:139]
    s_add_u32 m0, m0, 4096
    s_add_u32 s34, s30, 4096
    buffer_load_dwordx4 v1, s[8:11], s34 offen sc1 lds
    v_mfma_f32_16x16x32_bf16 v[140:143], v[32:35], v[52:55], v[140:143]
    v_mfma_f32_16x16x32_bf16 v[128:131], v[36:39], v[72:75], v[128:131]
    v_mfma_f32_16x16x32_bf16 v[132:135], v[36:39], v[40:43], v[132:135]
    v_mfma_f32_16x16x32_bf16 v[136:139], v[36:39], v[76:79], v[136:139]
    s_add_u32 m0, s29, s37
    s_add_u32 s30, s30, 21376
    buffer_load_dwordx4 v1, s[12:15], s31 offen sc1 lds
    v_mfma_f32_16x16x32_bf16 v[140:143], v[36:39], v[48:51], v[140:143]
    s_waitcnt lgkmcnt(4)
    v_mfma_f32_16x16x32_bf16 v[144:147], v[8:11], v[40:43], v[144:147]
    ds_read_b128 v[32:35], v2 offset:14336
    v_mfma_f32_16x16x32_bf16 v[148:151], v[8:11], v[44:47], v[148:151]
    ds_read_b128 v[36:39], v3 offset:14336
    v_mfma_f32_16x16x32_bf16 v[152:155], v[8:11], v[48:51], v[152:155]
    v_mfma_f32_16x16x32_bf16 v[156:159], v[8:11], v[52:55], v[156:159]
    v_mfma_f32_16x16x32_bf16 v[144:147], v[12:15], v[72:75], v[144:147]
    buffer_load_dwordx4 v1, s[12:15], s31 offen offset:1024 sc1 lds
    v_mfma_f32_16x16x32_bf16 v[148:151], v[12:15], v[40:43], v[148:151]
    v_mfma_f32_16x16x32_bf16 v[152:155], v[12:15], v[76:79], v[152:155]
    v_mfma_f32_16x16x32_bf16 v[156:159], v[12:15], v[48:51], v[156:159]
    s_waitcnt lgkmcnt(4)
    v_mfma_f32_16x16x32_bf16 v[160:163], v[16:19], v[40:43], v[160:163]
    ds_read_b128 v[8:11], v2 offset:16384
    v_mfma_f32_16x16x32_bf16 v[164:167], v[16:19], v[44:47], v[164:167]
    ds_read_b128 v[12:15], v3 offset:16384
    v_mfma_f32_16x16x32_bf16 v[168:171], v[16:19], v[48:51], v[168:171]
    buffer_load_dwordx4 v1, s[12:15], s31 offen offset:2048 sc1 lds
    v_mfma_f32_16x16x32_bf16 v[172:175], v[16:19], v[52:55], v[172:175]
    s_add_u32 s40, s40, 1
    s_mov_b32 s51, s40
    v_mov_b32 v0, s40
    v_mfma_f32_16x16x32_bf16 v[160:163], v[20:23], v[72:75], v[160:163]
    s_waitcnt vmcnt(19)
    ds_write_b32 v7, v0
    v_mfma_f32_16x16x32_bf16 v[164:167], v[20:23], v[40:43], v[164:167]
    v_mfma_f32_16x16x32_bf16 v[168:171], v[20:23], v[76:79], v[168:171]
    buffer_load_dwordx4 v1, s[12:15], s31 offen offset:3072 sc1 lds
    v_mfma_f32_16x16x32_bf16 v[172:175], v[20:23], v[48:51], v[172:175]
    s_waitcnt lgkmcnt(5)
    v_mfma_f32_16x16x32_bf16 v[176:179], v[24:27], v[40:43], v[176:179]
    ds_read_b128 v[16:19], v2 offset:18432
    v_mfma_f32_16x16x32_bf16 v[180:183], v[24:27], v[44:47], v[180:183]
    ds_read_b128 v[20:23], v3 offset:18432
    v_mov_b32 v0, s48
    v_mfma_f32_16x16x32_bf16 v[184:187], v[24:27], v[48:51], v[184:187]
    ds_read_b32 v0, v0
    v_mfma_f32_16x16x32_bf16 v[188:191], v[24:27], v[52:55], v[188:191]
    v_mfma_f32_16x16x32_bf16 v[176:179], v[28:31], v[72:75], v[176:179]
    s_add_u32 m0, s29, s38
    s_mov_b64 exec, s[44:45]
    buffer_load_dwordx4 v1, s[64:67], s33 offen sc1 lds
    s_mov_b64 exec, -1
    s_add_u32 s31, s31, 16384
    s_add_u32 s33, s33, 21376
    v_mfma_f32_16x16x32_bf16 v[180:183], v[28:31], v[40:43], v[180:183]
    v_mfma_f32_16x16x32_bf16 v[184:187], v[28:31], v[76:79], v[184:187]
    v_mfma_f32_16x16x32_bf16 v[188:191], v[28:31], v[48:51], v[188:191]
    s_waitcnt lgkmcnt(0)
    v_cmp_eq_u32 vcc, 0, v0
    v_mfma_f32_16x16x32_bf16 v[192:195], v[32:35], v[40:43], v[192:195]
    ds_read_b128 v[24:27], v2 offset:20480
    v_mfma_f32_16x16x32_bf16 v[196:199], v[32:35], v[44:47], v[196:199]
    ds_read_b128 v[28:31], v3 offset:20480
    s_cbranch_vccnz K12_F2
K12_G2:
    v_mfma_f32_16x16x32_bf16 v[200:203], v[32:35], v[48:51], v[200:203]
    s_sub_u32 s43, s42, s41
    s_add_u32 s40, s40, 1
    v_add_u32 v2, s43, v2
    v_mfma_f32_16x16x32_bf16 v[204:207], v[32:35], v[52:55], v[204:207]
    v_add_u32 v3, s43, v3
    v_add_u32 v4, s43, v4
    v_mov_b32 v0, s40
    v_mfma_f32_16x16x32_bf16 v[192:195], v[36:39], v[72:75], v[192:195]
    ds_write_b32 v7, v0
    v_mfma_f32_16x16x32_bf16 v[196:199], v[36:39], v[40:43], v[196:199]
    v_mfma_f32_16x16x32_bf16 v[200:203], v[36:39], v[76:79], v[200:203]
    v_mfma_f32_16x16x32_bf16 v[204:207], v[36:39], v[48:51], v[204:207]
    ds_read_b32 v56, v5
    v_mfma_f32_16x16x32_bf16 v[208:211], v[8:11], v[40:43], v[208:211]
    v_mfma_f32_16x16x32_bf16 v[212:215], v[8:11], v[44:47], v[212:215]
    v_mfma_f32_16x16x32_bf16 v[216:219], v[8:11], v[48:51], v[216:219]
    v_mfma_f32_16x16x32_bf16 v[220:223], v[8:11], v[52:55], v[220:223]
    s_waitcnt lgkmcnt(0)
    v_cmp_gt_u32 vcc, s51, v56
    v_mfma_f32_16x16x32_bf16 v[208:211], v[12:15], v[72:75], v[208:211]
    v_mfma_f32_16x16x32_bf16 v[212:215], v[12:15], v[40:43], v[212:215]
    s_cbranch_vccnz K12_S3
K12_Q3:
    v_mfma_f32_16x16x32_bf16 v[216:219], v[12:15], v[76:79], v[216:219]
    ds_read_b64_tr_b16 v[56:57], v4 offset:0
    v_mfma_f32_16x16x32_bf16 v[220:223], v[12:15], v[48:51], v[220:223]
    ds_read_b64_tr_b16 v[58:59], v4 offset:2048
    v_mfma_f32_16x16x32_bf16 v[224:227], v[16:19], v[40:43], v[224:227]
    ds_read_b64_tr_b16 v[60:61], v4 offset:256
    ds_read_b128 v[8:11], v2 offset:0
    v_mfma_f32_16x16x32_bf16 v[228:231], v[16:19], v[44:47], v[228:231]
    ds_read_b64_tr_b16 v[62:63], v4 offset:2304
    ds_read_b128 v[12:15], v3 offset:0
    v_mfma_f32_16x16x32_bf16 v[232:235], v[16:19], v[48:51], v[232:235]
    v_xor_b32 v4, 32, v4
    ds_read_b128 v[32:35], v2 offset:6144
    v_mfma_f32_16x16x32_bf16 v[236:239], v[16:19], v[52:55], v[236:239]
    ds_read_b64_tr_b16 v[64:65], v4 offset:0
    ds_read_b128 v[36:39], v3 offset:6144
    v_mfma_f32_16x16x32_bf16 v[224:227], v[20:23], v[72:75], v[224:227]
    ds_read_b64_tr_b16 v[66:67], v4 offset:2048
    ds_read_b32 v52, v5
    v_mfma_f32_16x16x32_bf16 v[228:231], v[20:23], v[40:43], v[228:231]
    ds_read_b64_tr_b16 v[68:69], v4 offset:256
    ds_read_b64_tr_b16 v[70:71], v4 offset:2304
    v_xor_b32 v4, 32, v4
    v_mfma_f32_16x16x32_bf16 v[232:235], v[20:23], v[76:79], v[232:235]
    v_mfma_f32_16x16x32_bf16 v[236:239], v[20:23], v[48:51], v[236:239]
    v_mfma_f32_16x16x32_bf16 v[240:243], v[24:27], v[40:43], v[240:243]
    ds_read_b128 v[16:19], v2 offset:2048
    v_mfma_f32_16x16x32_bf16 v[244:247], v[24:27], v[44:47], v[244:247]
    ds_read_b128 v[20:23], v3 offset:2048
    v_mfma_f32_16x16x32_bf16 v[240:243], v[28:31], v[72:75], v[240:243]
    s_mov_b32 s29, s41
    s_mov_b32 s41, s42
    s_add_u32 s42, s42, 38912
    v_mfma_f32_16x16x32_bf16 v[244:247], v[28:31], v[40:43], v[244:247]
    s_cmp_eq_u32 s42, 155648
    s_cselect_b32 s42, 0, s42
    s_waitcnt lgkmcnt(2)
    v_mfma_f32_16x16x32_bf16 v[80:83], v[8:11], v[56:59], v[80:83]
    ds_read_b128 v[24:27], v2 offset:4096
    v_xor_b32 v72, s35, v60
    v_xor_b32 v73, s35, v61
    v_mfma_f32_16x16x32_bf16 v[84:87], v[8:11], v[60:63], v[84:87]
    ds_read_b128 v[28:31], v3 offset:4096
    v_xor_b32 v74, s35, v62
    v_xor_b32 v75, s35, v63
    v_mfma_f32_16x16x32_bf16 v[88:91], v[8:11], v[64:67], v[88:91]
    s_waitcnt lgkmcnt(2)
    v_cmp_gt_u32 vcc, s40, v52
    v_xor_b32 v76, s35, v68
    v_xor_b32 v77, s35, v69
    v_mfma_f32_16x16x32_bf16 v[92:95], v[8:11], v[68:71], v[92:95]
    s_cbranch_vccnz K12_S4
K12_Q4:
    v_xor_b32 v78, s35, v70
    v_xor_b32 v79, s35, v71
    v_mfma_f32_16x16x32_bf16 v[80:83], v[12:15], v[72:75], v[80:83]
    s_add_u32 m0, s29, s36
    s_nop 0
    buffer_load_dwordx4 v1, s[8:11], s30 offen sc1 lds
    v_mfma_f32_16x16x32_bf16 v[84:87], v[12:15], v[56:59], v[84:87]
    v_mfma_f32_16x16x32_bf16 v[88:91], v[12:15], v[76:79], v[88:91]
    v_mfma_f32_16x16x32_bf16 v[92:95], v[12:15], v[64:67], v[92:95]
    v_mfma_f32_16x16x32_bf16 v[96:99], v[16:19], v[56:59], v[96:99]
    ds_read_b128 v[8:11], v2 offset:8192
    v_mfma_f32_16x16x32_bf16 v[100:103], v[16:19], v[60:63], v[100:103]
    ds_read_b128 v[12:15], v3 offset:8192
    v_mfma_f32_16x16x32_bf16 v[104:107], v[16:19], v[64:67], v[104:107]
    buffer_load_dwordx4 v1, s[8:11], s30 offen offset:1024 sc1 lds
    v_mfma_f32_16x16x32_bf16 v[108:111], v[16:19], v[68:71], v[108:111]
    v_mfma_f32_16x16x32_bf16 v[96:99], v[20:23], v[72:75], v[96:99]
    v_mfma_f32_16x16x32_bf16 v[100:103], v[20:23], v[56:59], v[100:103]
    v_mfma_f32_16x16x32_bf16 v[104:107], v[20:23], v[76:79], v[104:107]
    buffer_load_dwordx4 v1, s[8:11], s30 offen offset:2048 sc1 lds
    v_mfma_f32_16x16x32_bf16 v[108:111], v[20:23], v[64:67], v[108:111]
    s_waitcnt lgkmcnt(2)
    v_mfma_f32_16x16x32_bf16 v[112:115], v[24:27], v[56:59], v[112:115]
    ds_read_b128 v[16:19], v2 offset:10240
    v_mfma_f32_16x16x32_bf16 v[116:119], v[24:27], v[60:63], v[116:119]
    ds_read_b128 v[20:23], v3 offset:10240
    v_mfma_f32_16x16x32_bf16 v[120:123], v[24:27], v[64:67], v[120:123]
    v_mfma_f32_16x16x32_bf16 v[124:127], v[24:27], v[68:71], v[124:127]
    v_mfma_f32_16x16x32_bf16 v[112:115], v[28:31], v[72:75], v[112:115]
    buffer_load_dwordx4 v1, s[8:11], s30 offen offset:3072 sc1 lds
    v_mfma_f32_16x16x32_bf16 v[116:119], v[28:31], v[56:59], v[116:119]
    v_mfma_f32_16x16x32_bf16 v[120:123], v[28:31], v[76:79], v[120:123]
    v_mfma_f32_16x16x32_bf16 v[124:127], v[28:31], v[64:67], v[124:127]
    v_mfma_f32_16x16x32_bf16 v[128:131], v[32:35], v[56:59], v[128:131]
    ds_read_b128 v[24:27], v2 offset:12288
    v_mfma_f32_16x16x32_bf16 v[132:135], v[32:35], v[60:63], v[132:135]
    ds_read_b128 v[28:31], v3 offset:12288
    v_mfma_f32_16x16x32_bf16 v[136:139], v[32:35], v[64:67], v[136:139]
    s_add_u32 m0, m0, 4096
    s_add_u32 s34, s30, 4096
    buffer_load_dwordx4 v1, s[8:11], s34 offen sc1 lds
    v_mfma_f32_16x16x32_bf16 v[140:143], v[32:35], v[68:71], v[140:143]
    v_mfma_f32_16x16x32_bf16 v[128:131], v[36:39], v[72:75], v[128:131]
    v_mfma_f32_16x16x32_bf16 v[132:135], v[36:39], v[56:59], v[132:135]
    v_mfma_f32_16x16x32_bf16 v[136:139], v[36:39], v[76:79], v[136:139]
    s_add_u32 m0, s29, s37
    s_add_u32 s30, s30, 21376
    buffer_load_dwordx4 v1, s[12:15], s31 offen sc1 lds
    v_mfma_f32_16x16x32_bf16 v[140:143], v[36:39], v[64:67], v[140:143]
    s_waitcnt lgkmcnt(4)
    v_mfma_f32_16x16x32_bf16 v[144:147], v[8:11], v[56:59], v[144:147]
    ds_read_b128 v[32:35], v2 offset:14336
    v_mfma_f32_16x16x32_bf16 v[148:151], v[8:11], v[60:63], v[148:151]
    ds_read_b128 v[36:39], v3 offset:14336
    v_mfma_f32_16x16x32_bf16 v[152:155], v[8:11], v[64:67], v[152:155]
    v_mfma_f32_16x16x32_bf16 v[156:159], v[8:11], v[68:71], v[156:159]
    v_mfma_f32_16x16x32_bf16 v[144:147], v[12:15], v[72:75], v[144:147]
    buffer_load_dwordx4 v1, s[12:15], s31 offen offset:1024 sc1 lds
    v_mfma_f32_16x16x32_bf16 v[148:151], v[12:15], v[56:59], v[148:151]
    v_mfma_f32_16x16x32_bf16 v[152:155], v[12:15], v[76:79], v[152:155]
    v_mfma_f32_16x16x32_bf16 v[156:159], v[12:15], v[64:67], v[156:159]
    s_waitcnt lgkmcnt(4)
    v_mfma_f32_16x16x32_bf16 v[160:163], v[16:19], v[56:59], v[160:163]
    ds_read_b128 v[8:11], v2 offset:16384
    v_mfma_f32_16x16x32_bf16 v[164:167], v[16:19], v[60:63], v[164:167]
    ds_read_b128 v[12:15], v3 offset:16384
    v_mfma_f32_16x16x32_bf16 v[168:171], v[16:19], v[64:67], v[168:171]
    buffer_load_dwordx4 v1, s[12:15], s31 offen offset:2048 sc1 lds
    v_mfma_f32_16x16x32_bf16 v[172:175], v[16:19], v[68:71], v[172:175]
    s_add_u32 s40, s40, 1
    s_mov_b32 s51, s40
    v_mov_b32 v0, s40
    v_mfma_f32_16x16x32_bf16 v[160:163], v[20:23], v[72:75], v[160:163]
    s_waitcnt vmcnt(19)
    ds_write_b32 v7, v0
    v_mfma_f32_16x16x32_bf16 v[164:167], v[20:23], v[56:59], v[164:167]
    v_mfma_f32_16x16x32_bf16 v[168:171], v[20:23], v[76:79], v[168:171]
    buffer_load_dwordx4 v1, s[12:15], s31 offen offset:3072 sc1 lds
    v_mfma_f32_16x16x32_bf16 v[172:175], v[20:23], v[64:67], v[172:175]
    s_waitcnt lgkmcnt(5)
    v_mfma_f32_16x16x32_bf16 v[176:179], v[24:27], v[56:59], v[176:179]
    ds_read_b128 v[16:19], v2 offset:18432
    v_mfma_f32_16x16x32_bf16 v[180:183], v[24:27], v[60:63], v[180:183]
    ds_read_b128 v[20:23], v3 offset:18432
    v_mfma_f32_16x16x32_bf16 v[184:187], v[24:27], v[64:67], v[184:187]
    v_mfma_f32_16x16x32_bf16 v[188:191], v[24:27], v[68:71], v[188:191]
    v_mfma_f32_16x16x32_bf16 v[176:179], v[28:31], v[72:75], v[176:179]
    s_add_u32 m0, s29, s38
    s_mov_b64 exec, s[44:45]
    buffer_load_dwordx4 v1, s[64:67], s33 offen sc1 lds
    s_mov_b64 exec, -1
    s_add_u32 s31, s31, 16384
    s_add_u32 s33, s33, 21376
    v_mfma_f32_16x16x32_bf16 v[180:183], v[28:31], v[56:59], v[180:183]
    v_mfma_f32_16x16x32_bf16 v[184:187], v[28:31], v[76:79], v[184:187]
    s_mov_b32 m0, s46
    s_mov_b64 exec, 0xff
    buffer_load_dword v1, s[4:7], 0 offen sc1 lds
    s_mov_b64 exec, -1
    v_mfma_f32_16x16x32_bf16 v[188:191], v[28:31], v[64:67], v[188:191]
    s_waitcnt lgkmcnt(5)
    v_mfma_f32_16x16x32_bf16 v[192:195], v[32:35], v[56:59], v[192:195]
    ds_read_b128 v[24:27], v2 offset:20480
    v_mfma_f32_16x16x32_bf16 v[196:199], v[32:35], v[60:63], v[196:199]
    ds_read_b128 v[28:31], v3 offset:20480
    v_mfma_f32_16x16x32_bf16 v[200:203], v[32:35], v[64:67], v[200:203]
    s_sub_u32 s43, s42, s41
    s_add_u32 s40, s40, 1
    v_add_u32 v2, s43, v2
    v_mfma_f32_16x16x32_bf16 v[204:207], v[32:35], v[68:71], v[204:207]
    v_add_u32 v3, s43, v3
    v_add_u32 v4, s43, v4
    v_mov_b32 v0, s40
    v_mfma_f32_16x16x32_bf16 v[192:195], v[36:39], v[72:75], v[192:195]
    ds_write_b32 v7, v0
    v_mfma_f32_16x16x32_bf16 v[196:199], v[36:39], v[56:59], v[196:199]
    v_mfma_f32_16x16x32_bf16 v[200:203], v[36:39], v[76:79], v[200:203]
    v_mfma_f32_16x16x32_bf16 v[204:207], v[36:39], v[64:67], v[204:207]
    ds_read_b32 v40, v5
    s_waitcnt lgkmcnt(7)
    v_mfma_f32_16x16x32_bf16 v[208:211], v[8:11], v[56:59], v[208:211]
    v_mfma_f32_16x16x32_bf16 v[212:215], v[8:11], v[60:63], v[212:215]
    v_mfma_f32_16x16x32_bf16 v[216:219], v[8:11], v[64:67], v[216:219]
    v_mfma_f32_16x16x32_bf16 v[220:223], v[8:11], v[68:71], v[220:223]
    s_waitcnt lgkmcnt(0)
    v_cmp_gt_u32 vcc, s51, v40
    v_mfma_f32_16x16x32_bf16 v[208:211], v[12:15], v[72:75], v[208:211]
    v_mfma_f32_16x16x32_bf16 v[212:215], v[12:15], v[56:59], v[212:215]
    s_cbranch_vccnz K12_S5
K12_Q5:
    v_mfma_f32_16x16x32_bf16 v[216:219], v[12:15], v[76:79], v[216:219]
    ds_read_b64_tr_b16 v[40:41], v4 offset:0
    v_mfma_f32_16x16x32_bf16 v[220:223], v[12:15], v[64:67], v[220:223]
    ds_read_b64_tr_b16 v[42:43], v4 offset:2048
    v_mfma_f32_16x16x32_bf16 v[224:227], v[16:19], v[56:59], v[224:227]
    ds_read_b64_tr_b16 v[44:45], v4 offset:256
    ds_read_b128 v[8:11], v2 offset:0
    v_mfma_f32_16x16x32_bf16 v[228:231], v[16:19], v[60:63], v[228:231]
    ds_read_b64_tr_b16 v[46:47], v4 offset:2304
    ds_read_b128 v[12:15], v3 offset:0
    v_mfma_f32_16x16x32_bf16 v[232:235], v[16:19], v[64:67], v[232:235]
    v_xor_b32 v4, 32, v4
    ds_read_b128 v[32:35], v2 offset:6144
    v_mfma_f32_16x16x32_bf16 v[236:239], v[16:19], v[68:71], v[236:239]
    ds_read_b64_tr_b16 v[48:49], v4 offset:0
    ds_read_b128 v[36:39], v3 offset:6144
    v_mfma_f32_16x16x32_bf16 v[224:227], v[20:23], v[72:75], v[224:227]
    ds_read_b64_tr_b16 v[50:51], v4 offset:2048
    ds_read_b32 v68, v5
    v_mfma_f32_16x16x32_bf16 v[228:231], v[20:23], v[56:59], v[228:231]
    ds_read_b64_tr_b16 v[52:53], v4 offset:256
    ds_read_b64_tr_b16 v[54:55], v4 offset:2304
    v_xor_b32 v4, 32, v4
    v_mfma_f32_16x16x32_bf16 v[232:235], v[20:23], v[76:79], v[232:235]
    v_mfma_f32_16x16x32_bf16 v[236:239], v[20:23], v[64:67], v[236:239]
    v_mfma_f32_16x16x32_bf16 v[240:243], v[24:27], v[56:59], v[240:243]
    ds_read_b128 v[16:19], v2 offset:2048
    v_mfma_f32_16x16x32_bf16 v[244:247], v[24:27], v[60:63], v[244:247]
    ds_read_b128 v[20:23], v3 offset:2048
    v_mfma_f32_16x16x32_bf16 v[240:243], v[28:31], v[72:75], v[240:243]
    s_mov_b32 s29, s41
    s_mov_b32 s41, s42
    s_add_u32 s42, s42, 38912
    v_mfma_f32_16x16x32_bf16 v[244:247], v[28:31], v[56:59], v[244:247]
    s_cmp_eq_u32 s42, 155648
    s_cselect_b32 s42, 0, s42
    s_add_u32 s39, s39, 1
    s_cmp_lt_u32 s39, 15
    s_cbranch_scc1 K12_LOOP
    s_waitcnt lgkmcnt(2)
    v_mfma_f32_16x16x32_bf16 v[80:83], v[8:11], v[40:43], v[80:83]
    ds_read_b128 v[24:27], v2 offset:4096
    v_xor_b32 v72, s35, v44
    v_xor_b32 v73, s35, v45
    v_mfma_f32_16x16x32_bf16 v[84:87], v[8:11], v[44:47], v[84:87]
    ds_read_b128 v[28:31], v3 offset:4096
    v_xor_b32 v74, s35, v46
    v_xor_b32 v75, s35, v47
    v_mfma_f32_16x16x32_bf16 v[88:91], v[8:11], v[48:51], v[88:91]
    s_waitcnt lgkmcnt(2)
    v_cmp_gt_u32 vcc, s40, v68
    s_add_u32 s49, s39, 2
    s_lshr_b32 s49, s49, 1
    v_xor_b32 v76, s35, v52
    v_xor_b32 v77, s35, v53
    v_mfma_f32_16x16x32_bf16 v[92:95], v[8:11], v[52:55], v[92:95]
    s_cbranch_vccnz K12_S6
K12_Q6:
    s_mul_i32 s48, s49, s50
    s_add_u32 s48, s48, s47
    v_xor_b32 v78, s35, v54
    v_xor_b32 v79, s35, v55
    v_mfma_f32_16x16x32_bf16 v[80:83], v[12:15], v[72:75], v[80:83]
    s_add_u32 m0, s29, s36
    s_nop 0
    buffer_load_dwordx4 v1, s[8:11], s30 offen sc1 lds
    v_mfma_f32_16x16x32_bf16 v[84:87], v[12:15], v[40:43], v[84:87]
    s_cmp_lt_u32 s49, 8
    s_cselect_b32 s48, s48, 155744
    v_mfma_f32_16x16x32_bf16 v[88:91], v[12:15], v[76:79], v[88:91]
    s_cmp_ge_u32 s49, 3
    s_cselect_b32 s48, s48, 155744
    v_mfma_f32_16x16x32_bf16 v[92:95], v[12:15], v[48:51], v[92:95]
    v_mfma_f32_16x16x32_bf16 v[96:99], v[16:19], v[40:43], v[96:99]
    ds_read_b128 v[8:11], v2 offset:8192
    v_mfma_f32_16x16x32_bf16 v[100:103], v[16:19], v[44:47], v[100:103]
    ds_read_b128 v[12:15], v3 offset:8192
    v_mfma_f32_16x16x32_bf16 v[104:107], v[16:19], v[48:51], v[104:107]
    buffer_load_dwordx4 v1, s[8:11], s30 offen offset:1024 sc1 lds
    v_mfma_f32_16x16x32_bf16 v[108:111], v[16:19], v[52:55], v[108:111]
    v_mfma_f32_16x16x32_bf16 v[96:99], v[20:23], v[72:75], v[96:99]
    v_mfma_f32_16x16x32_bf16 v[100:103], v[20:23], v[40:43], v[100:103]
    v_mfma_f32_16x16x32_bf16 v[104:107], v[20:23], v[76:79], v[104:107]
    buffer_load_dwordx4 v1, s[8:11], s30 offen offset:2048 sc1 lds
    v_mfma_f32_16x16x32_bf16 v[108:111], v[20:23], v[48:51], v[108:111]
    s_waitcnt lgkmcnt(2)
    v_mfma_f32_16x16x32_bf16 v[112:115], v[24:27], v[40:43], v[112:115]
    ds_read_b128 v[16:19], v2 offset:10240
    v_mfma_f32_16x16x32_bf16 v[116:119], v[24:27], v[44:47], v[116:119]
    ds_read_b128 v[20:23], v3 offset:10240
    v_mfma_f32_16x16x32_bf16 v[120:123], v[24:27], v[48:51], v[120:123]
    v_mfma_f32_16x16x32_bf16 v[124:127], v[24:27], v[52:55], v[124:127]
    v_mfma_f32_16x16x32_bf16 v[112:115], v[28:31], v[72:75], v[112:115]
    buffer_load_dwordx4 v1, s[8:11], s30 offen offset:3072 sc1 lds
    v_mfma_f32_16x16x32_bf16 v[116:119], v[28:31], v[40:43], v[116:119]
    v_mfma_f32_16x16x32_bf16 v[120:123], v[28:31], v[76:79], v[120:123]
    v_mfma_f32_16x16x32_bf16 v[124:127], v[28:31], v[48:51], v[124:127]
    v_mfma_f32_16x16x32_bf16 v[128:131], v[32:35], v[40:43], v[128:131]
    ds_read_b128 v[24:27], v2 offset:12288
    v_mfma_f32_16x16x32_bf16 v[132:135], v[32:35], v[44:47], v[132:135]
    ds_read_b128 v[28:31], v3 offset:12288
    v_mfma_f32_16x16x32_bf16 v[136:139], v[32:35], v[48:51], v[136:139]
    s_add_u32 m0, m0, 4096
    s_add_u32 s34, s30, 4096
    buffer_load_dwordx4 v1, s[8:11], s34 offen sc1 lds
    v_mfma_f32_16x16x32_bf16 v[140:143], v[32:35], v[52:55], v[140:143]
    v_mfma_f32_16x16x32_bf16 v[128:131], v[36:39], v[72:75], v[128:131]
    v_mfma_f32_16x16x32_bf16 v[132:135], v[36:39], v[40:43], v[132:135]
    v_mfma_f32_16x16x32_bf16 v[136:139], v[36:39], v[76:79], v[136:139]
    s_add_u32 m0, s29, s37
    s_add_u32 s30, s30, 21376
    buffer_load_dwordx4 v1, s[12:15], s31 offen sc1 lds
    v_mfma_f32_16x16x32_bf16 v[140:143], v[36:39], v[48:51], v[140:143]
    s_waitcnt lgkmcnt(4)
    v_mfma_f32_16x16x32_bf16 v[144:147], v[8:11], v[40:43], v[144:147]
    ds_read_b128 v[32:35], v2 offset:14336
    v_mfma_f32_16x16x32_bf16 v[148:151], v[8:11], v[44:47], v[148:151]
    ds_read_b128 v[36:39], v3 offset:14336
    v_mfma_f32_16x16x32_bf16 v[152:155], v[8:11], v[48:51], v[152:155]
    v_mfma_f32_16x16x32_bf16 v[156:159], v[8:11], v[52:55], v[156:159]
    v_mfma_f32_16x16x32_bf16 v[144:147], v[12:15], v[72:75], v[144:147]
    buffer_load_dwordx4 v1, s[12:15], s31 offen offset:1024 sc1 lds
    v_mfma_f32_16x16x32_bf16 v[148:151], v[12:15], v[40:43], v[148:151]
    v_mfma_f32_16x16x32_bf16 v[152:155], v[12:15], v[76:79], v[152:155]
    v_mfma_f32_16x16x32_bf16 v[156:159], v[12:15], v[48:51], v[156:159]
    s_waitcnt lgkmcnt(4)
    v_mfma_f32_16x16x32_bf16 v[160:163], v[16:19], v[40:43], v[160:163]
    ds_read_b128 v[8:11], v2 offset:16384
    v_mfma_f32_16x16x32_bf16 v[164:167], v[16:19], v[44:47], v[164:167]
    ds_read_b128 v[12:15], v3 offset:16384
    v_mfma_f32_16x16x32_bf16 v[168:171], v[16:19], v[48:51], v[168:171]
    buffer_load_dwordx4 v1, s[12:15], s31 offen offset:2048 sc1 lds
    v_mfma_f32_16x16x32_bf16 v[172:175], v[16:19], v[52:55], v[172:175]
    s_add_u32 s40, s40, 1
    s_mov_b32 s51, s40
    v_mov_b32 v0, s40
    v_mfma_f32_16x16x32_bf16 v[160:163], v[20:23], v[72:75], v[160:163]
    s_waitcnt vmcnt(19)
    ds_write_b32 v7, v0
    v_mfma_f32_16x16x32_bf16 v[164:167], v[20:23], v[40:43], v[164:167]
    v_mfma_f32_16x16x32_bf16 v[168:171], v[20:23], v[76:79], v[168:171]
    buffer_load_dwordx4 v1, s[12:15], s31 offen offset:3072 sc1 lds
    v_mfma_f32_16x16x32_bf16 v[172:175], v[20:23], v[48:51], v[172:175]
    s_waitcnt lgkmcnt(5)
    v_mfma_f32_16x16x32_bf16 v[176:179], v[24:27], v[40:43], v[176:179]
    ds_read_b128 v[16:19], v2 offset:18432
    v_mfma_f32_16x16x32_bf16 v[180:183], v[24:27], v[44:47], v[180:183]
    ds_read_b128 v[20:23], v3 offset:18432
    v_mov_b32 v0, s48
    v_mfma_f32_16x16x32_bf16 v[184:187], v[24:27], v[48:51], v[184:187]
    ds_read_b32 v0, v0
    v_mfma_f32_16x16x32_bf16 v[188:191], v[24:27], v[52:55], v[188:191]
    v_mfma_f32_16x16x32_bf16 v[176:179], v[28:31], v[72:75], v[176:179]
    s_add_u32 m0, s29, s38
    s_mov_b64 exec, s[44:45]
    buffer_load_dwordx4 v1, s[64:67], s33 offen sc1 lds
    s_mov_b64 exec, -1
    s_add_u32 s31, s31, 16384
    s_add_u32 s33, s33, 21376
    v_mfma_f32_16x16x32_bf16 v[180:183], v[28:31], v[40:43], v[180:183]
    v_mfma_f32_16x16x32_bf16 v[184:187], v[28:31], v[76:79], v[184:187]
    v_mfma_f32_16x16x32_bf16 v[188:191], v[28:31], v[48:51], v[188:191]
    s_waitcnt lgkmcnt(0)
    v_cmp_eq_u32 vcc, 0, v0
    v_mfma_f32_16x16x32_bf16 v[192:195], v[32:35], v[40:43], v[192:195]
    ds_read_b128 v[24:27], v2 offset:20480
    v_mfma_f32_16x16x32_bf16 v[196:199], v[32:35], v[44:47], v[196:199]
    ds_read_b128 v[28:31], v3 offset:20480
    s_cbranch_vccnz K12_F7
K12_G7:
    v_mfma_f32_16x16x32_bf16 v[200:203], v[32:35], v[48:51], v[200:203]
    s_sub_u32 s43, s42, s41
    s_add_u32 s40, s40, 1
    v_add_u32 v2, s43, v2
    v_mfma_f32_16x16x32_bf16 v[204:207], v[32:35], v[52:55], v[204:207]
    v_add_u32 v3, s43, v3
    v_add_u32 v4, s43, v4
    v_mov_b32 v0, s40
    v_mfma_f32_16x16x32_bf16 v[192:195], v[36:39], v[72:75], v[192:195]
    ds_write_b32 v7, v0
    v_mfma_f32_16x16x32_bf16 v[196:199], v[36:39], v[40:43], v[196:199]
    v_mfma_f32_16x16x32_bf16 v[200:203], v[36:39], v[76:79], v[200:203]
    v_mfma_f32_16x16x32_bf16 v[204:207], v[36:39], v[48:51], v[204:207]
    ds_read_b32 v56, v5
    v_mfma_f32_16x16x32_bf16 v[208:211], v[8:11], v[40:43], v[208:211]
    v_mfma_f32_16x16x32_bf16 v[212:215], v[8:11], v[44:47], v[212:215]
    v_mfma_f32_16x16x32_bf16 v[216:219], v[8:11], v[48:51], v[216:219]
    v_mfma_f32_16x16x32_bf16 v[220:223], v[8:11], v[52:55], v[220:223]
    s_waitcnt lgkmcnt(0)
    v_cmp_gt_u32 vcc, s51, v56
    v_mfma_f32_16x16x32_bf16 v[208:211], v[12:15], v[72:75], v[208:211]
    v_mfma_f32_16x16x32_bf16 v[212:215], v[12:15], v[40:43], v[212:215]
    s_cbranch_vccnz K12_S8
K12_Q8:
    v_mfma_f32_16x16x32_bf16 v[216:219], v[12:15], v[76:79], v[216:219]
    ds_read_b64_tr_b16 v[56:57], v4 offset:0
    v_mfma_f32_16x16x32_bf16 v[220:223], v[12:15], v[48:51], v[220:223]
    ds_read_b64_tr_b16 v[58:59], v4 offset:2048
    v_mfma_f32_16x16x32_bf16 v[224:227], v[16:19], v[40:43], v[224:227]
    ds_read_b64_tr_b16 v[60:61], v4 offset:256
    ds_read_b128 v[8:11], v2 offset:0
    v_mfma_f32_16x16x32_bf16 v[228:231], v[16:19], v[44:47], v[228:231]
    ds_read_b64_tr_b16 v[62:63], v4 offset:2304
    ds_read_b128 v[12:15], v3 offset:0
    v_mfma_f32_16x16x32_bf16 v[232:235], v[16:19], v[48:51], v[232:235]
    v_xor_b32 v4, 32, v4
    ds_read_b128 v[32:35], v2 offset:6144
    v_mfma_f32_16x16x32_bf16 v[236:239], v[16:19], v[52:55], v[236:239]
    ds_read_b64_tr_b16 v[64:65], v4 offset:0
    ds_read_b128 v[36:39], v3 offset:6144
    v_mfma_f32_16x16x32_bf16 v[224:227], v[20:23], v[72:75], v[224:227]
    ds_read_b64_tr_b16 v[66:67], v4 offset:2048
    ds_read_b32 v52, v5
    v_mfma_f32_16x16x32_bf16 v[228:231], v[20:23], v[40:43], v[228:231]
    ds_read_b64_tr_b16 v[68:69], v4 offset:256
    ds_read_b64_tr_b16 v[70:71], v4 offset:2304
    v_xor_b32 v4, 32, v4
    v_mfma_f32_16x16x32_bf16 v[232:235], v[20:23], v[76:79], v[232:235]
    v_mfma_f32_16x16x32_bf16 v[236:239], v[20:23], v[48:51], v[236:239]
    v_mfma_f32_16x16x32_bf16 v[240:243], v[24:27], v[40:43], v[240:243]
    ds_read_b128 v[16:19], v2 offset:2048
    v_mfma_f32_16x16x32_bf16 v[244:247], v[24:27], v[44:47], v[244:247]
    ds_read_b128 v[20:23], v3 offset:2048
    v_mfma_f32_16x16x32_bf16 v[240:243], v[28:31], v[72:75], v[240:243]
    s_mov_b32 s29, s41
    s_mov_b32 s41, s42
    s_add_u32 s42, s42, 38912
    v_mfma_f32_16x16x32_bf16 v[244:247], v[28:31], v[40:43], v[244:247]
    s_cmp_eq_u32 s42, 155648
    s_cselect_b32 s42, 0, s42
    s_waitcnt lgkmcnt(2)
    v_mfma_f32_16x16x32_bf16 v[80:83], v[8:11], v[56:59], v[80:83]
    ds_read_b128 v[24:27], v2 offset:4096
    v_xor_b32 v72, s35, v60
    v_xor_b32 v73, s35, v61
    v_mfma_f32_16x16x32_bf16 v[84:87], v[8:11], v[60:63], v[84:87]
    ds_read_b128 v[28:31], v3 offset:4096
    v_xor_b32 v74, s35, v62
    v_xor_b32 v75, s35, v63
    v_mfma_f32_16x16x32_bf16 v[88:91], v[8:11], v[64:67], v[88:91]
    v_xor_b32 v76, s35, v68
    v_xor_b32 v77, s35, v69
    v_mfma_f32_16x16x32_bf16 v[92:95], v[8:11], v[68:71], v[92:95]
    v_xor_b32 v78, s35, v70
    v_xor_b32 v79, s35, v71
    v_mfma_f32_16x16x32_bf16 v[80:83], v[12:15], v[72:75], v[80:83]
    v_lshrrev_b32 v0, 4, v1
    v_and_b32 v5, 15, v0
    v_mfma_f32_16x16x32_bf16 v[84:87], v[12:15], v[56:59], v[84:87]
    v_lshrrev_b32 v0, 4, v0
    s_lshl_b32 s28, s21, 7
    v_mfma_f32_16x16x32_bf16 v[88:91], v[12:15], v[76:79], v[88:91]
    s_lshl_b32 s29, s3, 5
    s_add_u32 s28, s28, s29
    v_mfma_f32_16x16x32_bf16 v[92:95], v[12:15], v[64:67], v[92:95]
    v_add_u32 v5, s28, v5
    v_lshlrev_b32 v5, 2, v5
    s_waitcnt lgkmcnt(2)
    v_mfma_f32_16x16x32_bf16 v[96:99], v[16:19], v[56:59], v[96:99]
    ds_read_b128 v[8:11], v2 offset:8192
    v_lshl_add_u32 v5, v0, 13, v5
    s_lshl_b32 s28, s20, 6
    v_mfma_f32_16x16x32_bf16 v[100:103], v[16:19], v[60:63], v[100:103]
    ds_read_b128 v[12:15], v3 offset:8192
    v_xor_b32 v5, s28, v5
    v_xor_b32 v7, 64, v5
    v_mfma_f32_16x16x32_bf16 v[104:107], v[16:19], v[64:67], v[104:107]
    v_mfma_f32_16x16x32_bf16 v[108:111], v[16:19], v[68:71], v[108:111]
    s_mov_b32 s38, 0
    v_cvt_pk_bf16_f32 v48, v80, v84
    buffer_store_dword v48, v5, s[16:19], s38 offen offset:0
    v_cvt_pk_bf16_f32 v49, v88, v92
    buffer_store_dword v49, v7, s[16:19], s38 offen offset:0
    v_mfma_f32_16x16x32_bf16 v[96:99], v[20:23], v[72:75], v[96:99]
    v_cvt_pk_bf16_f32 v50, v81, v85
    buffer_store_dword v50, v5, s[16:19], s38 offen offset:2048
    v_mfma_f32_16x16x32_bf16 v[100:103], v[20:23], v[56:59], v[100:103]
    v_cvt_pk_bf16_f32 v51, v89, v93
    buffer_store_dword v51, v7, s[16:19], s38 offen offset:2048
    v_mfma_f32_16x16x32_bf16 v[104:107], v[20:23], v[76:79], v[104:107]
    s_mov_b32 s38, 4096
    v_cvt_pk_bf16_f32 v52, v82, v86
    buffer_store_dword v52, v5, s[16:19], s38 offen offset:0
    v_cvt_pk_bf16_f32 v53, v90, v94
    buffer_store_dword v53, v7, s[16:19], s38 offen offset:0
    v_mfma_f32_16x16x32_bf16 v[108:111], v[20:23], v[64:67], v[108:111]
    v_cvt_pk_bf16_f32 v54, v83, v87
    buffer_store_dword v54, v5, s[16:19], s38 offen offset:2048
    s_waitcnt lgkmcnt(2)
    v_mfma_f32_16x16x32_bf16 v[112:115], v[24:27], v[56:59], v[112:115]
    ds_read_b128 v[16:19], v2 offset:10240
    v_cvt_pk_bf16_f32 v55, v91, v95
    buffer_store_dword v55, v7, s[16:19], s38 offen offset:2048
    v_mfma_f32_16x16x32_bf16 v[116:119], v[24:27], v[60:63], v[116:119]
    ds_read_b128 v[20:23], v3 offset:10240
    v_mfma_f32_16x16x32_bf16 v[120:123], v[24:27], v[64:67], v[120:123]
    v_mfma_f32_16x16x32_bf16 v[124:127], v[24:27], v[68:71], v[124:127]
    s_mov_b32 s38, 32768
    v_cvt_pk_bf16_f32 v40, v96, v100
    buffer_store_dword v40, v5, s[16:19], s38 offen offset:0
    v_cvt_pk_bf16_f32 v41, v104, v108
    buffer_store_dword v41, v7, s[16:19], s38 offen offset:0
    v_mfma_f32_16x16x32_bf16 v[112:115], v[28:31], v[72:75], v[112:115]
    v_cvt_pk_bf16_f32 v42, v97, v101
    buffer_store_dword v42, v5, s[16:19], s38 offen offset:2048
    v_mfma_f32_16x16x32_bf16 v[116:119], v[28:31], v[56:59], v[116:119]
    v_cvt_pk_bf16_f32 v43, v105, v109
    buffer_store_dword v43, v7, s[16:19], s38 offen offset:2048
    v_mfma_f32_16x16x32_bf16 v[120:123], v[28:31], v[76:79], v[120:123]
    s_mov_b32 s38, 36864
    v_cvt_pk_bf16_f32 v44, v98, v102
    buffer_store_dword v44, v5, s[16:19], s38 offen offset:0
    v_cvt_pk_bf16_f32 v45, v106, v110
    buffer_store_dword v45, v7, s[16:19], s38 offen offset:0
    v_mfma_f32_16x16x32_bf16 v[124:127], v[28:31], v[64:67], v[124:127]
    v_cvt_pk_bf16_f32 v46, v99, v103
    buffer_store_dword v46, v5, s[16:19], s38 offen offset:2048
    v_mfma_f32_16x16x32_bf16 v[128:131], v[32:35], v[56:59], v[128:131]
    ds_read_b128 v[24:27], v2 offset:12288
    v_cvt_pk_bf16_f32 v47, v107, v111
    buffer_store_dword v47, v7, s[16:19], s38 offen offset:2048
    v_mfma_f32_16x16x32_bf16 v[132:135], v[32:35], v[60:63], v[132:135]
    ds_read_b128 v[28:31], v3 offset:12288
    v_mfma_f32_16x16x32_bf16 v[136:139], v[32:35], v[64:67], v[136:139]
    v_mfma_f32_16x16x32_bf16 v[140:143], v[32:35], v[68:71], v[140:143]
    s_mov_b32 s38, 65536
    v_cvt_pk_bf16_f32 v48, v112, v116
    buffer_store_dword v48, v5, s[16:19], s38 offen offset:0
    v_cvt_pk_bf16_f32 v49, v120, v124
    buffer_store_dword v49, v7, s[16:19], s38 offen offset:0
    v_mfma_f32_16x16x32_bf16 v[128:131], v[36:39], v[72:75], v[128:131]
    v_cvt_pk_bf16_f32 v50, v113, v117
    buffer_store_dword v50, v5, s[16:19], s38 offen offset:2048
    v_mfma_f32_16x16x32_bf16 v[132:135], v[36:39], v[56:59], v[132:135]
    v_cvt_pk_bf16_f32 v51, v121, v125
    buffer_store_dword v51, v7, s[16:19], s38 offen offset:2048
    v_mfma_f32_16x16x32_bf16 v[136:139], v[36:39], v[76:79], v[136:139]
    s_mov_b32 s38, 69632
    v_cvt_pk_bf16_f32 v52, v114, v118
    buffer_store_dword v52, v5, s[16:19], s38 offen offset:0
    v_cvt_pk_bf16_f32 v53, v122, v126
    buffer_store_dword v53, v7, s[16:19], s38 offen offset:0
    v_mfma_f32_16x16x32_bf16 v[140:143], v[36:39], v[64:67], v[140:143]
    v_cvt_pk_bf16_f32 v54, v115, v119
    buffer_store_dword v54, v5, s[16:19], s38 offen offset:2048
    s_waitcnt lgkmcnt(4)
    v_mfma_f32_16x16x32_bf16 v[144:147], v[8:11], v[56:59], v[144:147]
    ds_read_b128 v[32:35], v2 offset:14336
    v_cvt_pk_bf16_f32 v55, v123, v127
    buffer_store_dword v55, v7, s[16:19], s38 offen offset:2048
    v_mfma_f32_16x16x32_bf16 v[148:151], v[8:11], v[60:63], v[148:151]
    ds_read_b128 v[36:39], v3 offset:14336
    v_mfma_f32_16x16x32_bf16 v[152:155], v[8:11], v[64:67], v[152:155]
    v_mfma_f32_16x16x32_bf16 v[156:159], v[8:11], v[68:71], v[156:159]
    s_mov_b32 s38, 98304
    v_cvt_pk_bf16_f32 v40, v128, v132
    buffer_store_dword v40, v5, s[16:19], s38 offen offset:0
    v_cvt_pk_bf16_f32 v41, v136, v140
    buffer_store_dword v41, v7, s[16:19], s38 offen offset:0
    v_mfma_f32_16x16x32_bf16 v[144:147], v[12:15], v[72:75], v[144:147]
    v_cvt_pk_bf16_f32 v42, v129, v133
    buffer_store_dword v42, v5, s[16:19], s38 offen offset:2048
    v_mfma_f32_16x16x32_bf16 v[148:151], v[12:15], v[56:59], v[148:151]
    v_cvt_pk_bf16_f32 v43, v137, v141
    buffer_store_dword v43, v7, s[16:19], s38 offen offset:2048
    v_mfma_f32_16x16x32_bf16 v[152:155], v[12:15], v[76:79], v[152:155]
    s_mov_b32 s38, 102400
    v_cvt_pk_bf16_f32 v44, v130, v134
    buffer_store_dword v44, v5, s[16:19], s38 offen offset:0
    v_cvt_pk_bf16_f32 v45, v138, v142
    buffer_store_dword v45, v7, s[16:19], s38 offen offset:0
    v_mfma_f32_16x16x32_bf16 v[156:159], v[12:15], v[64:67], v[156:159]
    v_cvt_pk_bf16_f32 v46, v131, v135
    buffer_store_dword v46, v5, s[16:19], s38 offen offset:2048
    s_waitcnt lgkmcnt(4)
    v_mfma_f32_16x16x32_bf16 v[160:163], v[16:19], v[56:59], v[160:163]
    ds_read_b128 v[8:11], v2 offset:16384
    v_cvt_pk_bf16_f32 v47, v139, v143
    buffer_store_dword v47, v7, s[16:19], s38 offen offset:2048
    v_mfma_f32_16x16x32_bf16 v[164:167], v[16:19], v[60:63], v[164:167]
    ds_read_b128 v[12:15], v3 offset:16384
    v_mfma_f32_16x16x32_bf16 v[168:171], v[16:19], v[64:67], v[168:171]
    v_mfma_f32_16x16x32_bf16 v[172:175], v[16:19], v[68:71], v[172:175]
    s_mov_b32 s38, 131072
    v_cvt_pk_bf16_f32 v48, v144, v148
    buffer_store_dword v48, v5, s[16:19], s38 offen offset:0
    v_cvt_pk_bf16_f32 v49, v152, v156
    buffer_store_dword v49, v7, s[16:19], s38 offen offset:0
    v_mfma_f32_16x16x32_bf16 v[160:163], v[20:23], v[72:75], v[160:163]
    v_cvt_pk_bf16_f32 v50, v145, v149
    buffer_store_dword v50, v5, s[16:19], s38 offen offset:2048
    v_mfma_f32_16x16x32_bf16 v[164:167], v[20:23], v[56:59], v[164:167]
    v_cvt_pk_bf16_f32 v51, v153, v157
    buffer_store_dword v51, v7, s[16:19], s38 offen offset:2048
    v_mfma_f32_16x16x32_bf16 v[168:171], v[20:23], v[76:79], v[168:171]
    s_mov_b32 s38, 135168
    v_cvt_pk_bf16_f32 v52, v146, v150
    buffer_store_dword v52, v5, s[16:19], s38 offen offset:0
    v_cvt_pk_bf16_f32 v53, v154, v158
    buffer_store_dword v53, v7, s[16:19], s38 offen offset:0
    v_mfma_f32_16x16x32_bf16 v[172:175], v[20:23], v[64:67], v[172:175]
    v_cvt_pk_bf16_f32 v54, v147, v151
    buffer_store_dword v54, v5, s[16:19], s38 offen offset:2048
    s_waitcnt lgkmcnt(4)
    v_mfma_f32_16x16x32_bf16 v[176:179], v[24:27], v[56:59], v[176:179]
    ds_read_b128 v[16:19], v2 offset:18432
    v_cvt_pk_bf16_f32 v55, v155, v159
    buffer_store_dword v55, v7, s[16:19], s38 offen offset:2048
    v_mfma_f32_16x16x32_bf16 v[180:183], v[24:27], v[60:63], v[180:183]
    ds_read_b128 v[20:23], v3 offset:18432
    v_mfma_f32_16x16x32_bf16 v[184:187], v[24:27], v[64:67], v[184:187]
    v_mfma_f32_16x16x32_bf16 v[188:191], v[24:27], v[68:71], v[188:191]
    s_mov_b32 s38, 163840
    v_cvt_pk_bf16_f32 v40, v160, v164
    buffer_store_dword v40, v5, s[16:19], s38 offen offset:0
    v_cvt_pk_bf16_f32 v41, v168, v172
    buffer_store_dword v41, v7, s[16:19], s38 offen offset:0
    v_mfma_f32_16x16x32_bf16 v[176:179], v[28:31], v[72:75], v[176:179]
    v_cvt_pk_bf16_f32 v42, v161, v165
    buffer_store_dword v42, v5, s[16:19], s38 offen offset:2048
    v_mfma_f32_16x16x32_bf16 v[180:183], v[28:31], v[56:59], v[180:183]
    v_cvt_pk_bf16_f32 v43, v169, v173
    buffer_store_dword v43, v7, s[16:19], s38 offen offset:2048
    v_mfma_f32_16x16x32_bf16 v[184:187], v[28:31], v[76:79], v[184:187]
    s_mov_b32 s38, 167936
    v_cvt_pk_bf16_f32 v44, v162, v166
    buffer_store_dword v44, v5, s[16:19], s38 offen offset:0
    v_cvt_pk_bf16_f32 v45, v170, v174
    buffer_store_dword v45, v7, s[16:19], s38 offen offset:0
    v_mfma_f32_16x16x32_bf16 v[188:191], v[28:31], v[64:67], v[188:191]
    v_cvt_pk_bf16_f32 v46, v163, v167
    buffer_store_dword v46, v5, s[16:19], s38 offen offset:2048
    s_waitcnt lgkmcnt(4)
    v_mfma_f32_16x16x32_bf16 v[192:195], v[32:35], v[56:59], v[192:195]
    ds_read_b128 v[24:27], v2 offset:20480
    v_cvt_pk_bf16_f32 v47, v171, v175
    buffer_store_dword v47, v7, s[16:19], s38 offen offset:2048
    v_mfma_f32_16x16x32_bf16 v[196:199], v[32:35], v[60:63], v[196:199]
    ds_read_b128 v[28:31], v3 offset:20480
    v_mfma_f32_16x16x32_bf16 v[200:203], v[32:35], v[64:67], v[200:203]
    v_mfma_f32_16x16x32_bf16 v[204:207], v[32:35], v[68:71], v[204:207]
    s_mov_b32 s38, 196608
    v_cvt_pk_bf16_f32 v48, v176, v180
    buffer_store_dword v48, v5, s[16:19], s38 offen offset:0
    v_cvt_pk_bf16_f32 v49, v184, v188
    buffer_store_dword v49, v7, s[16:19], s38 offen offset:0
    v_mfma_f32_16x16x32_bf16 v[192:195], v[36:39], v[72:75], v[192:195]
    v_cvt_pk_bf16_f32 v50, v177, v181
    buffer_store_dword v50, v5, s[16:19], s38 offen offset:2048
    v_mfma_f32_16x16x32_bf16 v[196:199], v[36:39], v[56:59], v[196:199]
    v_cvt_pk_bf16_f32 v51, v185, v189
    buffer_store_dword v51, v7, s[16:19], s38 offen offset:2048
    v_mfma_f32_16x16x32_bf16 v[200:203], v[36:39], v[76:79], v[200:203]
    s_mov_b32 s38, 200704
    v_cvt_pk_bf16_f32 v52, v178, v182
    buffer_store_dword v52, v5, s[16:19], s38 offen offset:0
    v_cvt_pk_bf16_f32 v53, v186, v190
    buffer_store_dword v53, v7, s[16:19], s38 offen offset:0
    v_mfma_f32_16x16x32_bf16 v[204:207], v[36:39], v[64:67], v[204:207]
    v_cvt_pk_bf16_f32 v54, v179, v183
    buffer_store_dword v54, v5, s[16:19], s38 offen offset:2048
    s_waitcnt lgkmcnt(4)
    v_mfma_f32_16x16x32_bf16 v[208:211], v[8:11], v[56:59], v[208:211]
    v_cvt_pk_bf16_f32 v55, v187, v191
    buffer_store_dword v55, v7, s[16:19], s38 offen offset:2048
    v_mfma_f32_16x16x32_bf16 v[212:215], v[8:11], v[60:63], v[212:215]
    v_mfma_f32_16x16x32_bf16 v[216:219], v[8:11], v[64:67], v[216:219]
    v_mfma_f32_16x16x32_bf16 v[220:223], v[8:11], v[68:71], v[220:223]
    s_mov_b32 s38, 229376
    v_cvt_pk_bf16_f32 v40, v192, v196
    buffer_store_dword v40, v5, s[16:19], s38 offen offset:0
    v_cvt_pk_bf16_f32 v41, v200, v204
    buffer_store_dword v41, v7, s[16:19], s38 offen offset:0
    v_mfma_f32_16x16x32_bf16 v[208:211], v[12:15], v[72:75], v[208:211]
    v_cvt_pk_bf16_f32 v42, v193, v197
    buffer_store_dword v42, v5, s[16:19], s38 offen offset:2048
    v_mfma_f32_16x16x32_bf16 v[212:215], v[12:15], v[56:59], v[212:215]
    v_cvt_pk_bf16_f32 v43, v201, v205
    buffer_store_dword v43, v7, s[16:19], s38 offen offset:2048
    v_mfma_f32_16x16x32_bf16 v[216:219], v[12:15], v[76:79], v[216:219]
    s_mov_b32 s38, 233472
    v_cvt_pk_bf16_f32 v44, v194, v198
    buffer_store_dword v44, v5, s[16:19], s38 offen offset:0
    v_cvt_pk_bf16_f32 v45, v202, v206
    buffer_store_dword v45, v7, s[16:19], s38 offen offset:0
    v_mfma_f32_16x16x32_bf16 v[220:223], v[12:15], v[64:67], v[220:223]
    v_cvt_pk_bf16_f32 v46, v195, v199
    buffer_store_dword v46, v5, s[16:19], s38 offen offset:2048
    s_waitcnt lgkmcnt(2)
    v_mfma_f32_16x16x32_bf16 v[224:227], v[16:19], v[56:59], v[224:227]
    v_cvt_pk_bf16_f32 v47, v203, v207
    buffer_store_dword v47, v7, s[16:19], s38 offen offset:2048
    v_mfma_f32_16x16x32_bf16 v[228:231], v[16:19], v[60:63], v[228:231]
    v_mfma_f32_16x16x32_bf16 v[232:235], v[16:19], v[64:67], v[232:235]
    v_mfma_f32_16x16x32_bf16 v[236:239], v[16:19], v[68:71], v[236:239]
    s_mov_b32 s38, 262144
    v_cvt_pk_bf16_f32 v48, v208, v212
    buffer_store_dword v48, v5, s[16:19], s38 offen offset:0
    v_cvt_pk_bf16_f32 v49, v216, v220
    buffer_store_dword v49, v7, s[16:19], s38 offen offset:0
    v_mfma_f32_16x16x32_bf16 v[224:227], v[20:23], v[72:75], v[224:227]
    v_cvt_pk_bf16_f32 v50, v209, v213
    buffer_store_dword v50, v5, s[16:19], s38 offen offset:2048
    v_mfma_f32_16x16x32_bf16 v[228:231], v[20:23], v[56:59], v[228:231]
    v_cvt_pk_bf16_f32 v51, v217, v221
    buffer_store_dword v51, v7, s[16:19], s38 offen offset:2048
    v_mfma_f32_16x16x32_bf16 v[232:235], v[20:23], v[76:79], v[232:235]
    s_mov_b32 s38, 266240
    v_cvt_pk_bf16_f32 v52, v210, v214
    buffer_store_dword v52, v5, s[16:19], s38 offen offset:0
    v_cvt_pk_bf16_f32 v53, v218, v222
    buffer_store_dword v53, v7, s[16:19], s38 offen offset:0
    v_mfma_f32_16x16x32_bf16 v[236:239], v[20:23], v[64:67], v[236:239]
    v_cvt_pk_bf16_f32 v54, v211, v215
    buffer_store_dword v54, v5, s[16:19], s38 offen offset:2048
    s_waitcnt lgkmcnt(0)
    v_mfma_f32_16x16x32_bf16 v[240:243], v[24:27], v[56:59], v[240:243]
    v_cvt_pk_bf16_f32 v55, v219, v223
    buffer_store_dword v55, v7, s[16:19], s38 offen offset:2048
    v_mfma_f32_16x16x32_bf16 v[244:247], v[24:27], v[60:63], v[244:247]
    v_mfma_f32_16x16x32_bf16 v[240:243], v[28:31], v[72:75], v[240:243]
    v_mfma_f32_16x16x32_bf16 v[244:247], v[28:31], v[56:59], v[244:247]
    s_mov_b32 s38, 294912
    v_cvt_pk_bf16_f32 v40, v224, v228
    buffer_store_dword v40, v5, s[16:19], s38 offen offset:0
    v_cvt_pk_bf16_f32 v41, v232, v236
    buffer_store_dword v41, v7, s[16:19], s38 offen offset:0
    v_cvt_pk_bf16_f32 v42, v225, v229
    buffer_store_dword v42, v5, s[16:19], s38 offen offset:2048
    v_cvt_pk_bf16_f32 v43, v233, v237
    buffer_store_dword v43, v7, s[16:19], s38 offen offset:2048
    s_mov_b32 s38, 299008
    v_cvt_pk_bf16_f32 v44, v226, v230
    buffer_store_dword v44, v5, s[16:19], s38 offen offset:0
    v_cvt_pk_bf16_f32 v45, v234, v238
    buffer_store_dword v45, v7, s[16:19], s38 offen offset:0
    v_cvt_pk_bf16_f32 v46, v227, v231
    buffer_store_dword v46, v5, s[16:19], s38 offen offset:2048
    v_cvt_pk_bf16_f32 v47, v235, v239
    buffer_store_dword v47, v7, s[16:19], s38 offen offset:2048
    s_nop 7
    s_lshl_b32 s34, s27, 1
    s_mul_i32 s34, s34, 342016
    s_add_u32 s34, s34, 118489088
    s_add_u32 s64, s58, s34
    s_addc_u32 s65, s59, 0
    s_and_b32 s65, s65, 0xffff
    s_mov_b32 s66, 684032
    s_mov_b32 s67, 0x00020000
    v_lshrrev_b32 v8, 8, v1
    v_lshlrev_b32 v9, 13, v8
    v_sub_u32 v9, v5, v9
    v_lshlrev_b32 v8, 2, v8
    v_add_u32 v8, 160, v8
    v_add_u32 v10, 0, v8
    v_add_u32 v11, 160, v10
    v_cmp_gt_u32 vcc, 167, v10
    s_nop 1
    v_cndmask_b32 v11, v11, v10, vcc
    v_cmp_gt_u32 vcc, 174, v10
    v_mov_b32 v12, 0x7ffff
    s_nop 0
    v_cndmask_b32 v11, v12, v11, vcc
    v_lshl_add_u32 v16, v11, 11, v9
    v_add_u32 v10, 1, v8
    v_add_u32 v11, 160, v10
    v_cmp_gt_u32 vcc, 167, v10
    s_nop 1
    v_cndmask_b32 v11, v11, v10, vcc
    v_cmp_gt_u32 vcc, 174, v10
    v_mov_b32 v12, 0x7ffff
    s_nop 0
    v_cndmask_b32 v11, v12, v11, vcc
    v_lshl_add_u32 v17, v11, 11, v9
    v_add_u32 v10, 2, v8
    v_add_u32 v11, 160, v10
    v_cmp_gt_u32 vcc, 167, v10
    s_nop 1
    v_cndmask_b32 v11, v11, v10, vcc
    v_cmp_gt_u32 vcc, 174, v10
    v_mov_b32 v12, 0x7ffff
    s_nop 0
    v_cndmask_b32 v11, v12, v11, vcc
    v_lshl_add_u32 v18, v11, 11, v9
    v_add_u32 v10, 3, v8
    v_add_u32 v11, 160, v10
    v_cmp_gt_u32 vcc, 167, v10
    s_nop 1
    v_cndmask_b32 v11, v11, v10, vcc
    v_cmp_gt_u32 vcc, 174, v10
    v_mov_b32 v12, 0x7ffff
    s_nop 0
    v_cndmask_b32 v11, v12, v11, vcc
    v_lshl_add_u32 v19, v11, 11, v9
    v_cvt_pk_bf16_f32 v20, v240, v244
    buffer_store_dword v20, v16, s[64:67], 0 offen
    v_cvt_pk_bf16_f32 v21, v241, v245
    buffer_store_dword v21, v17, s[64:67], 0 offen
    v_cvt_pk_bf16_f32 v22, v242, v246
    buffer_store_dword v22, v18, s[64:67], 0 offen
    v_cvt_pk_bf16_f32 v23, v243, v247
    buffer_store_dword v23, v19, s[64:67], 0 offen
    s_endpgm
K12_S0:
    s_mov_b32 s61, 4096
    s_add_u32 s62, s62, 1
K12_S0_L:
    ds_read_b32 v56, v5
    s_waitcnt lgkmcnt(0)
    v_cmp_gt_u32 vcc, s40, v56
    s_sub_u32 s61, s61, 1
    s_cmp_eq_u32 s61, 0
    s_cbranch_scc1 K12_Q0
    s_cbranch_vccz K12_Q0
    s_branch K12_S0_L
K12_S1:
    s_mov_b32 s61, 4096
    s_add_u32 s62, s62, 1
K12_S1_L:
    ds_read_b32 v68, v5
    s_waitcnt lgkmcnt(0)
    v_cmp_gt_u32 vcc, s40, v68
    s_sub_u32 s61, s61, 1
    s_cmp_eq_u32 s61, 0
    s_cbranch_scc1 K12_Q1
    s_cbranch_vccz K12_Q1
    s_branch K12_S1_L
K12_F2:
    s_mov_b32 s61, 4096
    s_add_u32 s63, s63, 1
K12_F2_L:
    s_mov_b32 m0, s46
    s_mov_b64 exec, 0xff
    buffer_load_dword v1, s[4:7], 0 offen sc1 lds
    s_mov_b64 exec, -1
    s_waitcnt vmcnt(0)
    v_mov_b32 v0, s48
    ds_read_b32 v0, v0
    s_waitcnt lgkmcnt(0)
    v_cmp_eq_u32 vcc, 0, v0
    s_sub_u32 s61, s61, 1
    s_cmp_eq_u32 s61, 0
    s_cbranch_scc1 K12_F2_X
    s_cbranch_vccz K12_F2_X
    s_sleep 2
    s_branch K12_F2_L
K12_F2_X:
    s_branch K12_G2
K12_S3:
    s_mov_b32 s61, 4096
    s_add_u32 s62, s62, 1
K12_S3_L:
    ds_read_b32 v56, v5
    s_waitcnt lgkmcnt(0)
    v_cmp_gt_u32 vcc, s51, v56
    s_sub_u32 s61, s61, 1
    s_cmp_eq_u32 s61, 0
    s_cbranch_scc1 K12_Q3
    s_cbranch_vccz K12_Q3
    s_branch K12_S3_L
K12_S4:
    s_mov_b32 s61, 4096
    s_add_u32 s62, s62, 1
K12_S4_L:
    ds_read_b32 v52, v5
    s_waitcnt lgkmcnt(0)
    v_cmp_gt_u32 vcc, s40, v52
    s_sub_u32 s61, s61, 1
    s_cmp_eq_u32 s61, 0
    s_cbranch_scc1 K12_Q4
    s_cbranch_vccz K12_Q4
    s_branch K12_S4_L
K12_S5:
    s_mov_b32 s61, 4096
    s_add_u32 s62, s62, 1
K12_S5_L:
    ds_read_b32 v40, v5
    s_waitcnt lgkmcnt(0)
    v_cmp_gt_u32 vcc, s51, v40
    s_sub_u32 s61, s61, 1
    s_cmp_eq_u32 s61, 0
    s_cbranch_scc1 K12_Q5
    s_cbranch_vccz K12_Q5
    s_branch K12_S5_L
K12_S6:
    s_mov_b32 s61, 4096
    s_add_u32 s62, s62, 1
K12_S6_L:
    ds_read_b32 v68, v5
    s_waitcnt lgkmcnt(0)
    v_cmp_gt_u32 vcc, s40, v68
    s_sub_u32 s61, s61, 1
    s_cmp_eq_u32 s61, 0
    s_cbranch_scc1 K12_Q6
    s_cbranch_vccz K12_Q6
    s_branch K12_S6_L
K12_F7:
    s_mov_b32 s61, 4096
    s_add_u32 s63, s63, 1
K12_F7_L:
    s_mov_b32 m0, s46
    s_mov_b64 exec, 0xff
    buffer_load_dword v1, s[4:7], 0 offen sc1 lds
    s_mov_b64 exec, -1
    s_waitcnt vmcnt(0)
    v_mov_b32 v0, s48
    ds_read_b32 v0, v0
    s_waitcnt lgkmcnt(0)
    v_cmp_eq_u32 vcc, 0, v0
    s_sub_u32 s61, s61, 1
    s_cmp_eq_u32 s61, 0
    s_cbranch_scc1 K12_F7_X
    s_cbranch_vccz K12_F7_X
    s_sleep 2
    s_branch K12_F7_L
K12_F7_X:
    s_branch K12_G7
K12_S8:
    s_mov_b32 s61, 4096
    s_add_u32 s62, s62, 1
K12_S8_L:
    ds_read_b32 v56, v5
    s_waitcnt lgkmcnt(0)
    v_cmp_gt_u32 vcc, s51, v56
    s_sub_u32 s61, s61, 1
    s_cmp_eq_u32 s61, 0
    s_cbranch_scc1 K12_Q8
    s_cbranch_vccz K12_Q8
    s_branch K12_S8_L
K12_END:
    s_endpgm
.p2align 8
.type k34_out_kernel,@function
k34_out_kernel:
    s_cmp_ge_u32 s2, 256
    s_cbranch_scc1 K34_END
    s_load_dwordx2 s[4:5], s[0:1], 48
    s_load_dwordx4 s[40:43], s[0:1], 16
    s_load_dwordx2 s[44:45], s[0:1], 32
    v_lshrrev_b32 v1, 6, v0
    v_and_b32 v2, 63, v0
    v_readfirstlane_b32 s3, v1
    s_and_b32 s6, s2, 15
    s_lshr_b32 s7, s2, 4
    s_lshr_b32 s20, s6, 3
    s_and_b32 s21, s6, 7
    s_mul_i32 s22, s7, 11
    s_mul_i32 s23, s7, 10
    s_add_u32 s23, s23, 7
    s_cmp_lt_u32 s7, 7
    s_cselect_b32 s22, s22, s23
    s_cselect_b32 s23, 11, 10
    s_add_u32 s22, s22, s3
    v_and_b32 v3, 15, v2
    v_lshrrev_b32 v4, 4, v2
    v_lshlrev_b32 v5, 4, v2
    s_mov_b32 s24, 2736128
    v_mul_lo_u32 v6, v4, s24
    v_lshl_add_u32 v6, v3, 4, v6
    s_mul_i32 s25, s20, 167
    s_add_u32 s25, s25, s22
    s_lshl_b32 s25, s25, 11
    s_lshl_b32 s24, s21, 8
    s_add_u32 s25, s25, s24
    s_waitcnt lgkmcnt(0)
    s_add_u32 s8, s4, 118489088
    s_addc_u32 s9, s5, 0
    s_and_b32 s9, s9, 0xffff
    s_mov_b32 s10, 21889024
    s_mov_b32 s11, 0x00020000
    s_add_u32 s12, s4, 153616384
    s_addc_u32 s13, s5, 0
    s_and_b32 s13, s13, 0xffff
    s_mov_b32 s14, 131072
    s_mov_b32 s15, 0x00020000
    s_cmp_lt_u32 s3, s23
    s_cbranch_scc0 K34_NOLOAD
    buffer_load_dwordx4 v[16:19], v6, s[8:11], s25 offen
    s_add_u32 s25, s25, 684032
    buffer_load_dwordx4 v[20:23], v6, s[8:11], s25 offen
    s_add_u32 s25, s25, 684032
    buffer_load_dwordx4 v[24:27], v6, s[8:11], s25 offen
    s_add_u32 s25, s25, 684032
    buffer_load_dwordx4 v[28:31], v6, s[8:11], s25 offen
    s_add_u32 s25, s25, 8892416
    buffer_load_dwordx4 v[32:35], v6, s[8:11], s25 offen
    s_add_u32 s25, s25, 684032
    buffer_load_dwordx4 v[36:39], v6, s[8:11], s25 offen
    s_add_u32 s25, s25, 684032
    buffer_load_dwordx4 v[40:43], v6, s[8:11], s25 offen
    s_add_u32 s25, s25, 684032
    buffer_load_dwordx4 v[44:47], v6, s[8:11], s25 offen
K34_NOLOAD:
    s_cmp_lg_u32 s3, 0
    s_cbranch_scc1 K34_TAB
    s_mov_b32 s16, s40
    s_mov_b32 s17, s41
    s_and_b32 s17, s17, 0xffff
    s_mov_b32 s18, 1024
    s_mov_b32 s19, 0x00020000
    s_mov_b32 s28, s42
    s_mov_b32 s29, s43
    s_and_b32 s29, s29, 0xffff
    s_mov_b32 s30, 1024
    s_mov_b32 s31, 0x00020000
    s_lshl_b32 s24, s21, 7
    v_lshlrev_b32 v8, 1, v2
    buffer_load_ushort v152, v8, s[16:19], s24 offen
    buffer_load_ushort v153, v8, s[28:31], s24 offen
    s_branch K34_TABDONE
K34_TAB:
    s_cmp_ge_u32 s3, 7
    s_cbranch_scc1 K34_TABDONE
    s_sub_u32 s27, s3, 1
    s_lshr_b32 s28, s27, 1
    s_and_b32 s29, s27, 1
    s_lshl_b32 s30, s28, 4
    v_add_u32 v8, s30, v3
    s_lshl_b32 s30, s29, 5
    s_add_u32 s30, s30, 1
    v_lshlrev_b32 v9, 3, v4
    v_add_u32 v9, s30, v9
    v_mul_u32_u24 v9, v8, v9
    v_lshlrev_b32 v8, 1, v8
    v_mad_u32_u24 v48, v8, 0, v9
    v_mad_u32_u24 v49, v8, 0, v9
    v_add_u32 v49, 32, v49
    v_mad_u32_u24 v50, v8, 1, v9
    v_mad_u32_u24 v51, v8, 1, v9
    v_add_u32 v51, 32, v51
    v_mad_u32_u24 v52, v8, 2, v9
    v_mad_u32_u24 v53, v8, 2, v9
    v_add_u32 v53, 32, v53
    v_mad_u32_u24 v54, v8, 3, v9
    v_mad_u32_u24 v55, v8, 3, v9
    v_add_u32 v55, 32, v55
    v_and_b32 v48, 127, v48
    v_and_b32 v49, 127, v49
    v_and_b32 v50, 127, v50
    v_and_b32 v51, 127, v51
    v_and_b32 v52, 127, v52
    v_and_b32 v53, 127, v53
    v_and_b32 v54, 127, v54
    v_and_b32 v55, 127, v55
    v_cvt_f32_u32 v48, v48
    v_cvt_f32_u32 v49, v49
    v_cvt_f32_u32 v50, v50
    v_cvt_f32_u32 v51, v51
    v_cvt_f32_u32 v52, v52
    v_cvt_f32_u32 v53, v53
    v_cvt_f32_u32 v54, v54
    v_cvt_f32_u32 v55, v55
    v_mul_f32 v48, 0x3c000000, v48
    v_mul_f32 v49, 0x3c000000, v49
    v_mul_f32 v50, 0x3c000000, v50
    v_mul_f32 v51, 0x3c000000, v51
    v_mul_f32 v52, 0x3c000000, v52
    v_mul_f32 v53, 0x3c000000, v53
    v_mul_f32 v54, 0x3c000000, v54
    v_mul_f32 v55, 0x3c000000, v55
    v_cos_f32 v48, v48
    v_cos_f32 v49, v49
    v_cos_f32 v50, v50
    v_cos_f32 v51, v51
    v_cos_f32 v52, v52
    v_cos_f32 v53, v53
    v_cos_f32 v54, v54
    v_cos_f32 v55, v55
    s_nop 0
    v_mul_f32 v48, 0x3d000000, v48
    v_mul_f32 v49, 0x3d000000, v49
    v_mul_f32 v50, 0x3d000000, v50
    v_mul_f32 v51, 0x3d000000, v51
    v_mul_f32 v52, 0x3d000000, v52
    v_mul_f32 v53, 0x3d000000, v53
    v_mul_f32 v54, 0x3d000000, v54
    v_mul_f32 v55, 0x3d000000, v55
    v_cvt_pk_bf16_f32 v56, v48, v49
    v_cvt_pk_bf16_f32 v57, v50, v51
    v_cvt_pk_bf16_f32 v58, v52, v53
    v_cvt_pk_bf16_f32 v59, v54, v55
    v_lshlrev_b32 v64, 16, v56
    v_and_b32 v65, 0xffff0000, v56
    v_sub_f32 v48, v48, v64
    v_sub_f32 v49, v49, v65
    v_lshlrev_b32 v64, 16, v57
    v_and_b32 v65, 0xffff0000, v57
    v_sub_f32 v50, v50, v64
    v_sub_f32 v51, v51, v65
    v_lshlrev_b32 v64, 16, v58
    v_and_b32 v65, 0xffff0000, v58
    v_sub_f32 v52, v52, v64
    v_sub_f32 v53, v53, v65
    v_lshlrev_b32 v64, 16, v59
    v_and_b32 v65, 0xffff0000, v59
    v_sub_f32 v54, v54, v64
    v_sub_f32 v55, v55, v65
    v_cvt_pk_bf16_f32 v60, v48, v49
    v_cvt_pk_bf16_f32 v61, v50, v51
    v_cvt_pk_bf16_f32 v62, v52, v53
    v_cvt_pk_bf16_f32 v63, v54, v55
    s_lshl_b32 s30, s27, 11
    v_add_u32 v10, s30, v5
    ds_write_b128 v10, v[56:59]
    ds_write_b128 v10, v[60:63] offset:1024
K34_TABDONE:
    s_waitcnt lgkmcnt(0)
    s_barrier
    s_cmp_lt_u32 s3, s23
    s_cbranch_scc0 K34_IDLE
    ds_read_b128 v[48:51], v5 offset:0
    ds_read_b128 v[52:55], v5 offset:1024
    ds_read_b128 v[56:59], v5 offset:2048
    ds_read_b128 v[60:63], v5 offset:3072
    ds_read_b128 v[64:67], v5 offset:4096
    ds_read_b128 v[68:71], v5 offset:5120
    ds_read_b128 v[72:75], v5 offset:6144
    ds_read_b128 v[76:79], v5 offset:7168
    ds_read_b128 v[80:83], v5 offset:8192
    ds_read_b128 v[84:87], v5 offset:9216
    ds_read_b128 v[88:91], v5 offset:10240
    ds_read_b128 v[92:95], v5 offset:11264
    s_waitcnt vmcnt(0)
    v_swap_b32 v17, v20
    v_swap_b32 v18, v24
    v_swap_b32 v19, v28
    v_swap_b32 v22, v25
    v_swap_b32 v23, v29
    v_swap_b32 v27, v30
    v_swap_b32 v33, v36
    v_swap_b32 v34, v40
    v_swap_b32 v35, v44
    v_swap_b32 v38, v41
    v_swap_b32 v39, v45
    v_swap_b32 v43, v46
    s_waitcnt lgkmcnt(0)
    s_mul_i32 s24, s22, 48
    s_sub_u32 s24, 7985, s24
    s_cmp_ge_u32 s24, 48
    s_cbranch_scc1 K34_FULL
    v_add_u32 v7, 0, v3
    v_cmp_gt_u32 vcc, s24, v7
    s_nop 1
    v_cndmask_b32 v48, 0, v48, vcc
    v_cndmask_b32 v49, 0, v49, vcc
    v_cndmask_b32 v50, 0, v50, vcc
    v_cndmask_b32 v51, 0, v51, vcc
    v_cndmask_b32 v52, 0, v52, vcc
    v_cndmask_b32 v53, 0, v53, vcc
    v_cndmask_b32 v54, 0, v54, vcc
    v_cndmask_b32 v55, 0, v55, vcc
    v_cndmask_b32 v56, 0, v56, vcc
    v_cndmask_b32 v57, 0, v57, vcc
    v_cndmask_b32 v58, 0, v58, vcc
    v_cndmask_b32 v59, 0, v59, vcc
    v_cndmask_b32 v60, 0, v60, vcc
    v_cndmask_b32 v61, 0, v61, vcc
    v_cndmask_b32 v62, 0, v62, vcc
    v_cndmask_b32 v63, 0, v63, vcc
    v_add_u32 v7, 16, v3
    v_cmp_gt_u32 vcc, s24, v7
    s_nop 1
    v_cndmask_b32 v64, 0, v64, vcc
    v_cndmask_b32 v65, 0, v65, vcc
    v_cndmask_b32 v66, 0, v66, vcc
    v_cndmask_b32 v67, 0, v67, vcc
    v_cndmask_b32 v68, 0, v68, vcc
    v_cndmask_b32 v69, 0, v69, vcc
    v_cndmask_b32 v70, 0, v70, vcc
    v_cndmask_b32 v71, 0, v71, vcc
    v_cndmask_b32 v72, 0, v72, vcc
    v_cndmask_b32 v73, 0, v73, vcc
    v_cndmask_b32 v74, 0, v74, vcc
    v_cndmask_b32 v75, 0, v75, vcc
    v_cndmask_b32 v76, 0, v76, vcc
    v_cndmask_b32 v77, 0, v77, vcc
    v_cndmask_b32 v78, 0, v78, vcc
    v_cndmask_b32 v79, 0, v79, vcc
    v_add_u32 v7, 32, v3
    v_cmp_gt_u32 vcc, s24, v7
    s_nop 1
    v_cndmask_b32 v80, 0, v80, vcc
    v_cndmask_b32 v81, 0, v81, vcc
    v_cndmask_b32 v82, 0, v82, vcc
    v_cndmask_b32 v83, 0, v83, vcc
    v_cndmask_b32 v84, 0, v84, vcc
    v_cndmask_b32 v85, 0, v85, vcc
    v_cndmask_b32 v86, 0, v86, vcc
    v_cndmask_b32 v87, 0, v87, vcc
    v_cndmask_b32 v88, 0, v88, vcc
    v_cndmask_b32 v89, 0, v89, vcc
    v_cndmask_b32 v90, 0, v90, vcc
    v_cndmask_b32 v91, 0, v91, vcc
    v_cndmask_b32 v92, 0, v92, vcc
    v_cndmask_b32 v93, 0, v93, vcc
    v_cndmask_b32 v94, 0, v94, vcc
    v_cndmask_b32 v95, 0, v95, vcc
K34_FULL:
    s_nop 1
    v_mfma_f32_16x16x32_bf16 v[96:99], v[48:51], v[16:19], 0
    v_mfma_f32_16x16x32_bf16 v[100:103], v[48:51], v[20:23], 0
    v_mfma_f32_16x16x32_bf16 v[104:107], v[48:51], v[24:27], 0
    v_mfma_f32_16x16x32_bf16 v[108:111], v[48:51], v[28:31], 0
    v_mfma_f32_16x16x32_bf16 v[96:99], v[52:55], v[16:19], v[96:99]
    v_mfma_f32_16x16x32_bf16 v[100:103], v[52:55], v[20:23], v[100:103]
    v_mfma_f32_16x16x32_bf16 v[104:107], v[52:55], v[24:27], v[104:107]
    v_mfma_f32_16x16x32_bf16 v[108:111], v[52:55], v[28:31], v[108:111]
    v_mfma_f32_16x16x32_bf16 v[96:99], v[56:59], v[32:35], v[96:99]
    v_mfma_f32_16x16x32_bf16 v[100:103], v[56:59], v[36:39], v[100:103]
    v_mfma_f32_16x16x32_bf16 v[104:107], v[56:59], v[40:43], v[104:107]
    v_mfma_f32_16x16x32_bf16 v[108:111], v[56:59], v[44:47], v[108:111]
    v_mfma_f32_16x16x32_bf16 v[96:99], v[60:63], v[32:35], v[96:99]
    v_mfma_f32_16x16x32_bf16 v[100:103], v[60:63], v[36:39], v[100:103]
    v_mfma_f32_16x16x32_bf16 v[104:107], v[60:63], v[40:43], v[104:107]
    v_mfma_f32_16x16x32_bf16 v[108:111], v[60:63], v[44:47], v[108:111]
    v_mfma_f32_16x16x32_bf16 v[112:115], v[64:67], v[16:19], 0
    v_mfma_f32_16x16x32_bf16 v[116:119], v[64:67], v[20:23], 0
    v_mfma_f32_16x16x32_bf16 v[120:123], v[64:67], v[24:27], 0
    v_mfma_f32_16x16x32_bf16 v[124:127], v[64:67], v[28:31], 0
    v_mfma_f32_16x16x32_bf16 v[112:115], v[68:71], v[16:19], v[112:115]
    v_mfma_f32_16x16x32_bf16 v[116:119], v[68:71], v[20:23], v[116:119]
    v_mfma_f32_16x16x32_bf16 v[120:123], v[68:71], v[24:27], v[120:123]
    v_mfma_f32_16x16x32_bf16 v[124:127], v[68:71], v[28:31], v[124:127]
    v_mfma_f32_16x16x32_bf16 v[112:115], v[72:75], v[32:35], v[112:115]
    v_mfma_f32_16x16x32_bf16 v[116:119], v[72:75], v[36:39], v[116:119]
    v_mfma_f32_16x16x32_bf16 v[120:123], v[72:75], v[40:43], v[120:123]
    v_mfma_f32_16x16x32_bf16 v[124:127], v[72:75], v[44:47], v[124:127]
    v_mfma_f32_16x16x32_bf16 v[112:115], v[76:79], v[32:35], v[112:115]
    v_mfma_f32_16x16x32_bf16 v[116:119], v[76:79], v[36:39], v[116:119]
    v_mfma_f32_16x16x32_bf16 v[120:123], v[76:79], v[40:43], v[120:123]
    v_mfma_f32_16x16x32_bf16 v[124:127], v[76:79], v[44:47], v[124:127]
    v_mfma_f32_16x16x32_bf16 v[128:131], v[80:83], v[16:19], 0
    v_mfma_f32_16x16x32_bf16 v[132:135], v[80:83], v[20:23], 0
    v_mfma_f32_16x16x32_bf16 v[136:139], v[80:83], v[24:27], 0
    v_mfma_f32_16x16x32_bf16 v[140:143], v[80:83], v[28:31], 0
    v_mfma_f32_16x16x32_bf16 v[128:131], v[84:87], v[16:19], v[128:131]
    v_mfma_f32_16x16x32_bf16 v[132:135], v[84:87], v[20:23], v[132:135]
    v_mfma_f32_16x16x32_bf16 v[136:139], v[84:87], v[24:27], v[136:139]
    v_mfma_f32_16x16x32_bf16 v[140:143], v[84:87], v[28:31], v[140:143]
    v_mfma_f32_16x16x32_bf16 v[128:131], v[88:91], v[32:35], v[128:131]
    v_mfma_f32_16x16x32_bf16 v[132:135], v[88:91], v[36:39], v[132:135]
    v_mfma_f32_16x16x32_bf16 v[136:139], v[88:91], v[40:43], v[136:139]
    v_mfma_f32_16x16x32_bf16 v[140:143], v[88:91], v[44:47], v[140:143]
    v_mfma_f32_16x16x32_bf16 v[128:131], v[92:95], v[32:35], v[128:131]
    v_mfma_f32_16x16x32_bf16 v[132:135], v[92:95], v[36:39], v[132:135]
    v_mfma_f32_16x16x32_bf16 v[136:139], v[92:95], v[40:43], v[136:139]
    v_mfma_f32_16x16x32_bf16 v[140:143], v[92:95], v[44:47], v[140:143]
    s_nop 7
    v_mov_b32 v16, v96
    v_mul_f32 v20, v96, v96
    v_mov_b32 v17, v100
    v_mul_f32 v21, v100, v100
    v_mov_b32 v18, v104
    v_mul_f32 v22, v104, v104
    v_mov_b32 v19, v108
    v_mul_f32 v23, v108, v108
    v_add_f32 v16, v16, v97
    v_fmac_f32 v20, v97, v97
    v_add_f32 v17, v17, v101
    v_fmac_f32 v21, v101, v101
    v_add_f32 v18, v18, v105
    v_fmac_f32 v22, v105, v105
    v_add_f32 v19, v19, v109
    v_fmac_f32 v23, v109, v109
    v_add_f32 v16, v16, v98
    v_fmac_f32 v20, v98, v98
    v_add_f32 v17, v17, v102
    v_fmac_f32 v21, v102, v102
    v_add_f32 v18, v18, v106
    v_fmac_f32 v22, v106, v106
    v_add_f32 v19, v19, v110
    v_fmac_f32 v23, v110, v110
    v_add_f32 v16, v16, v99
    v_fmac_f32 v20, v99, v99
    v_add_f32 v17, v17, v103
    v_fmac_f32 v21, v103, v103
    v_add_f32 v18, v18, v107
    v_fmac_f32 v22, v107, v107
    v_add_f32 v19, v19, v111
    v_fmac_f32 v23, v111, v111
    v_add_f32 v16, v16, v112
    v_fmac_f32 v20, v112, v112
    v_add_f32 v17, v17, v116
    v_fmac_f32 v21, v116, v116
    v_add_f32 v18, v18, v120
    v_fmac_f32 v22, v120, v120
    v_add_f32 v19, v19, v124
    v_fmac_f32 v23, v124, v124
    v_add_f32 v16, v16, v113
    v_fmac_f32 v20, v113, v113
    v_add_f32 v17, v17, v117
    v_fmac_f32 v21, v117, v117
    v_add_f32 v18, v18, v121
    v_fmac_f32 v22, v121, v121
    v_add_f32 v19, v19, v125
    v_fmac_f32 v23, v125, v125
    v_add_f32 v16, v16, v114
    v_fmac_f32 v20, v114, v114
    v_add_f32 v17, v17, v118
    v_fmac_f32 v21, v118, v118
    v_add_f32 v18, v18, v122
    v_fmac_f32 v22, v122, v122
    v_add_f32 v19, v19, v126
    v_fmac_f32 v23, v126, v126
    v_add_f32 v16, v16, v115
    v_fmac_f32 v20, v115, v115
    v_add_f32 v17, v17, v119
    v_fmac_f32 v21, v119, v119
    v_add_f32 v18, v18, v123
    v_fmac_f32 v22, v123, v123
    v_add_f32 v19, v19, v127
    v_fmac_f32 v23, v127, v127
    v_add_f32 v16, v16, v128
    v_fmac_f32 v20, v128, v128
    v_add_f32 v17, v17, v132
    v_fmac_f32 v21, v132, v132
    v_add_f32 v18, v18, v136
    v_fmac_f32 v22, v136, v136
    v_add_f32 v19, v19, v140
    v_fmac_f32 v23, v140, v140
    v_add_f32 v16, v16, v129
    v_fmac_f32 v20, v129, v129
    v_add_f32 v17, v17, v133
    v_fmac_f32 v21, v133, v133
    v_add_f32 v18, v18, v137
    v_fmac_f32 v22, v137, v137
    v_add_f32 v19, v19, v141
    v_fmac_f32 v23, v141, v141
    v_add_f32 v16, v16, v130
    v_fmac_f32 v20, v130, v130
    v_add_f32 v17, v17, v134
    v_fmac_f32 v21, v134, v134
    v_add_f32 v18, v18, v138
    v_fmac_f32 v22, v138, v138
    v_add_f32 v19, v19, v142
    v_fmac_f32 v23, v142, v142
    v_add_f32 v16, v16, v131
    v_fmac_f32 v20, v131, v131
    v_add_f32 v17, v17, v135
    v_fmac_f32 v21, v135, v135
    v_add_f32 v18, v18, v139
    v_fmac_f32 v22, v139, v139
    v_add_f32 v19, v19, v143
    v_fmac_f32 v23, v143, v143
    v_mov_b32 v24, v16
    v_mov_b32 v25, v17
    v_mov_b32 v26, v18
    v_mov_b32 v27, v19
    v_mov_b32 v28, v20
    v_mov_b32 v29, v21
    v_mov_b32 v30, v22
    v_mov_b32 v31, v23
    s_nop 0
    v_permlane32_swap_b32 v16, v24
    v_permlane32_swap_b32 v17, v25
    v_permlane32_swap_b32 v18, v26
    v_permlane32_swap_b32 v19, v27
    v_permlane32_swap_b32 v20, v28
    v_permlane32_swap_b32 v21, v29
    v_permlane32_swap_b32 v22, v30
    v_permlane32_swap_b32 v23, v31
    v_add_f32 v16, v16, v24
    v_add_f32 v17, v17, v25
    v_add_f32 v18, v18, v26
    v_add_f32 v19, v19, v27
    v_add_f32 v20, v20, v28
    v_add_f32 v21, v21, v29
    v_add_f32 v22, v22, v30
    v_add_f32 v23, v23, v31
    v_mov_b32 v24, v16
    v_mov_b32 v25, v17
    v_mov_b32 v26, v18
    v_mov_b32 v27, v19
    v_mov_b32 v28, v20
    v_mov_b32 v29, v21
    v_mov_b32 v30, v22
    v_mov_b32 v31, v23
    s_nop 0
    v_permlane16_swap_b32 v16, v24
    v_permlane16_swap_b32 v17, v25
    v_permlane16_swap_b32 v18, v26
    v_permlane16_swap_b32 v19, v27
    v_permlane16_swap_b32 v20, v28
    v_permlane16_swap_b32 v21, v29
    v_permlane16_swap_b32 v22, v30
    v_permlane16_swap_b32 v23, v31
    v_add_f32 v16, v16, v24
    v_add_f32 v17, v17, v25
    v_add_f32 v18, v18, v26
    v_add_f32 v19, v19, v27
    v_add_f32 v20, v20, v28
    v_add_f32 v21, v21, v29
    v_add_f32 v22, v22, v30
    v_add_f32 v23, v23, v31
    s_branch K34_WR
K34_IDLE:
    v_mov_b32 v16, 0
    v_mov_b32 v17, 0
    v_mov_b32 v18, 0
    v_mov_b32 v19, 0
    v_mov_b32 v20, 0
    v_mov_b32 v21, 0
    v_mov_b32 v22, 0
    v_mov_b32 v23, 0
K34_WR:
    s_lshl_b32 s24, s3, 9
    v_lshlrev_b32 v7, 4, v3
    v_add_u32 v7, s24, v7
    ds_write_b128 v7, v[16:19] offset:12288
    ds_write_b128 v7, v[20:23] offset:12544
    s_waitcnt lgkmcnt(0)
    s_barrier
    s_cmp_lg_u32 s3, 0
    s_cbranch_scc1 K34_WAIT
    v_lshlrev_b32 v7, 2, v2
    ds_read_b32 v16, v7 offset:12288
    ds_read_b32 v17, v7 offset:12800
    ds_read_b32 v18, v7 offset:13312
    ds_read_b32 v19, v7 offset:13824
    ds_read_b32 v20, v7 offset:14336
    ds_read_b32 v21, v7 offset:14848
    ds_read_b32 v22, v7 offset:15360
    ds_read_b32 v23, v7 offset:15872
    ds_read_b32 v24, v7 offset:16384
    ds_read_b32 v25, v7 offset:16896
    ds_read_b32 v26, v7 offset:17408
    ds_read_b32 v27, v7 offset:17920
    s_waitcnt lgkmcnt(0)
    ds_read_b32 v32, v7 offset:12544
    ds_read_b32 v33, v7 offset:13056
    ds_read_b32 v34, v7 offset:13568
    ds_read_b32 v35, v7 offset:14080
    ds_read_b32 v36, v7 offset:14592
    ds_read_b32 v37, v7 offset:15104
    ds_read_b32 v38, v7 offset:15616
    ds_read_b32 v39, v7 offset:16128
    ds_read_b32 v40, v7 offset:16640
    ds_read_b32 v41, v7 offset:17152
    ds_read_b32 v42, v7 offset:17664
    ds_read_b32 v43, v7 offset:18176
    v_add_f32 v16, v16, v17
    v_add_f32 v16, v16, v18
    v_add_f32 v16, v16, v19
    v_add_f32 v16, v16, v20
    v_add_f32 v16, v16, v21
    v_add_f32 v16, v16, v22
    v_add_f32 v16, v16, v23
    v_add_f32 v16, v16, v24
    v_add_f32 v16, v16, v25
    v_add_f32 v16, v16, v26
    v_add_f32 v16, v16, v27
    s_waitcnt lgkmcnt(0)
    v_add_f32 v32, v32, v33
    v_add_f32 v32, v32, v34
    v_add_f32 v32, v32, v35
    v_add_f32 v32, v32, v36
    v_add_f32 v32, v32, v37
    v_add_f32 v32, v32, v38
    v_add_f32 v32, v32, v39
    v_add_f32 v32, v32, v40
    v_add_f32 v32, v32, v41
    v_add_f32 v32, v32, v42
    v_add_f32 v32, v32, v43
    s_lshl_b32 s24, s6, 4
    s_add_u32 s24, s24, s7
    s_lshl_b32 s24, s24, 9
    buffer_store_dword v16, v7, s[12:15], s24 offen sc1
    buffer_store_dword v32, v7, s[12:15], s24 offen offset:256 sc1
    s_mov_b32 s26, 20000
K34_POLL:
    s_lshl_b32 s24, s6, 13
    buffer_load_dword v16, v7, s[12:15], s24 offen offset:0 sc1
    buffer_load_dword v32, v7, s[12:15], s24 offen offset:256 sc1
    buffer_load_dword v17, v7, s[12:15], s24 offen offset:512 sc1
    buffer_load_dword v33, v7, s[12:15], s24 offen offset:768 sc1
    buffer_load_dword v18, v7, s[12:15], s24 offen offset:1024 sc1
    buffer_load_dword v34, v7, s[12:15], s24 offen offset:1280 sc1
    buffer_load_dword v19, v7, s[12:15], s24 offen offset:1536 sc1
    buffer_load_dword v35, v7, s[12:15], s24 offen offset:1792 sc1
    buffer_load_dword v20, v7, s[12:15], s24 offen offset:2048 sc1
    buffer_load_dword v36, v7, s[12:15], s24 offen offset:2304 sc1
    buffer_load_dword v21, v7, s[12:15], s24 offen offset:2560 sc1
    buffer_load_dword v37, v7, s[12:15], s24 offen offset:2816 sc1
    buffer_load_dword v22, v7, s[12:15], s24 offen offset:3072 sc1
    buffer_load_dword v38, v7, s[12:15], s24 offen offset:3328 sc1
    buffer_load_dword v23, v7, s[12:15], s24 offen offset:3584 sc1
    buffer_load_dword v39, v7, s[12:15], s24 offen offset:3840 sc1
    s_add_u32 s24, s24, 4096
    buffer_load_dword v24, v7, s[12:15], s24 offen offset:0 sc1
    buffer_load_dword v40, v7, s[12:15], s24 offen offset:256 sc1
    buffer_load_dword v25, v7, s[12:15], s24 offen offset:512 sc1
    buffer_load_dword v41, v7, s[12:15], s24 offen offset:768 sc1
    buffer_load_dword v26, v7, s[12:15], s24 offen offset:1024 sc1
    buffer_load_dword v42, v7, s[12:15], s24 offen offset:1280 sc1
    buffer_load_dword v27, v7, s[12:15], s24 offen offset:1536 sc1
    buffer_load_dword v43, v7, s[12:15], s24 offen offset:1792 sc1
    buffer_load_dword v28, v7, s[12:15], s24 offen offset:2048 sc1
    buffer_load_dword v44, v7, s[12:15], s24 offen offset:2304 sc1
    buffer_load_dword v29, v7, s[12:15], s24 offen offset:2560 sc1
    buffer_load_dword v45, v7, s[12:15], s24 offen offset:2816 sc1
    buffer_load_dword v30, v7, s[12:15], s24 offen offset:3072 sc1
    buffer_load_dword v46, v7, s[12:15], s24 offen offset:3328 sc1
    buffer_load_dword v31, v7, s[12:15], s24 offen offset:3584 sc1
    buffer_load_dword v47, v7, s[12:15], s24 offen offset:3840 sc1
    s_waitcnt vmcnt(0)
    v_max3_u32 v48, v16, v17, v18
    v_max3_u32 v48, v48, v19, v20
    v_max3_u32 v48, v48, v21, v22
    v_max3_u32 v48, v48, v23, v24
    v_max3_u32 v48, v48, v25, v26
    v_max3_u32 v48, v48, v27, v28
    v_max3_u32 v48, v48, v29, v30
    v_max3_u32 v48, v48, v31, v32
    v_max3_u32 v48, v48, v33, v34
    v_max3_u32 v48, v48, v35, v36
    v_max3_u32 v48, v48, v37, v38
    v_max3_u32 v48, v48, v39, v40
    v_max3_u32 v48, v48, v41, v42
    v_max3_u32 v48, v48, v43, v44
    v_max3_u32 v48, v48, v45, v46
    v_max_u32 v48, v48, v47
    v_cmp_eq_u32 vcc, -1, v48
    s_sub_u32 s26, s26, 1
    s_cmp_eq_u32 s26, 0
    s_cbranch_scc1 K34_GOT
    s_cbranch_vccz K34_GOT
    s_sleep 1
    s_branch K34_POLL
K34_GOT:
    v_add_f32 v16, v16, v24
    v_add_f32 v32, v32, v40
    v_add_f32 v17, v17, v25
    v_add_f32 v33, v33, v41
    v_add_f32 v18, v18, v26
    v_add_f32 v34, v34, v42
    v_add_f32 v19, v19, v27
    v_add_f32 v35, v35, v43
    v_add_f32 v20, v20, v28
    v_add_f32 v36, v36, v44
    v_add_f32 v21, v21, v29
    v_add_f32 v37, v37, v45
    v_add_f32 v22, v22, v30
    v_add_f32 v38, v38, v46
    v_add_f32 v23, v23, v31
    v_add_f32 v39, v39, v47
    v_add_f32 v16, v16, v20
    v_add_f32 v32, v32, v36
    v_add_f32 v17, v17, v21
    v_add_f32 v33, v33, v37
    v_add_f32 v18, v18, v22
    v_add_f32 v34, v34, v38
    v_add_f32 v19, v19, v23
    v_add_f32 v35, v35, v39
    v_add_f32 v16, v16, v18
    v_add_f32 v32, v32, v34
    v_add_f32 v17, v17, v19
    v_add_f32 v33, v33, v35
    v_add_f32 v16, v16, v17
    v_add_f32 v32, v32, v33
    v_mul_f32 v11, 0x39035177, v16
    v_mul_f32 v12, 0x39035177, v32
    v_fma_f32 v12, -v11, v11, v12
    v_max_f32 v12, 0, v12
    v_add_f32 v12, 0x3727c5ac, v12
    v_sqrt_f32 v12, v12
    v_lshlrev_b32 v9, 16, v152
    v_rcp_f32 v12, v12
    v_lshlrev_b32 v10, 16, v153
    v_mul_f32 v9, v9, v12
    v_fma_f32 v10, -v11, v9, v10
    ds_write_b32 v7, v9 offset:18432
    ds_write_b32 v7, v10 offset:18688
    s_waitcnt lgkmcnt(0)
K34_WAIT:
    s_barrier
    s_cmp_lt_u32 s3, s23
    s_cbranch_scc0 K34_END
    v_lshlrev_b32 v7, 4, v3
    ds_read_b128 v[144:147], v7 offset:18432
    ds_read_b128 v[148:151], v7 offset:18688
    s_mul_i32 s24, s20, 8176640
    s_add_u32 s16, s44, s24
    s_addc_u32 s17, s45, 0
    s_and_b32 s17, s17, 0xffff
    s_mov_b32 s18, 8176640
    s_mov_b32 s19, 0x00020000
    v_lshlrev_b32 v7, 12, v4
    v_lshl_add_u32 v7, v3, 3, v7
    s_lshl_b32 s24, s21, 7
    v_add_u32 v7, s24, v7
    s_mul_i32 s25, s22, 49152
    s_mov_b32 s30, 0xc0135761
    s_mov_b32 s31, 0xbdd2d3e8
    v_mov_b32 v15, s30
    s_waitcnt lgkmcnt(0)
    v_fma_f32 v16, v96, v144, v148
    v_fma_f32 v17, v100, v145, v149
    v_fma_f32 v18, v104, v146, v150
    v_fma_f32 v19, v108, v147, v151
    v_fma_f32 v20, v97, v144, v148
    v_fma_f32 v21, v101, v145, v149
    v_fma_f32 v22, v105, v146, v150
    v_fma_f32 v23, v109, v147, v151
    v_mul_f32 v24, v16, v16
    v_mul_f32 v25, v17, v17
    v_mul_f32 v26, v18, v18
    v_mul_f32 v27, v19, v19
    v_mul_f32 v28, v20, v20
    v_mul_f32 v29, v21, v21
    v_mul_f32 v30, v22, v22
    v_mul_f32 v31, v23, v23
    v_fma_f32 v24, v24, s31, v15
    v_fma_f32 v25, v25, s31, v15
    v_fma_f32 v26, v26, s31, v15
    v_fma_f32 v27, v27, s31, v15
    v_fma_f32 v28, v28, s31, v15
    v_fma_f32 v29, v29, s31, v15
    v_fma_f32 v30, v30, s31, v15
    v_fma_f32 v31, v31, s31, v15
    v_mul_f32 v24, v24, v16
    v_mul_f32 v25, v25, v17
    v_mul_f32 v26, v26, v18
    v_mul_f32 v27, v27, v19
    v_mul_f32 v28, v28, v20
    v_mul_f32 v29, v29, v21
    v_mul_f32 v30, v30, v22
    v_mul_f32 v31, v31, v23
    v_exp_f32 v24, v24
    v_exp_f32 v25, v25
    v_exp_f32 v26, v26
    v_exp_f32 v27, v27
    v_exp_f32 v28, v28
    v_exp_f32 v29, v29
    v_exp_f32 v30, v30
    v_exp_f32 v31, v31
    v_add_f32 v24, 1.0, v24
    v_add_f32 v25, 1.0, v25
    v_add_f32 v26, 1.0, v26
    v_add_f32 v27, 1.0, v27
    v_add_f32 v28, 1.0, v28
    v_add_f32 v29, 1.0, v29
    v_add_f32 v30, 1.0, v30
    v_add_f32 v31, 1.0, v31
    v_rcp_f32 v24, v24
    v_rcp_f32 v25, v25
    v_rcp_f32 v26, v26
    v_rcp_f32 v27, v27
    v_rcp_f32 v28, v28
    v_rcp_f32 v29, v29
    v_rcp_f32 v30, v30
    v_rcp_f32 v31, v31
    v_mul_f32 v16, v16, v24
    v_mul_f32 v17, v17, v25
    v_mul_f32 v18, v18, v26
    v_mul_f32 v19, v19, v27
    v_mul_f32 v20, v20, v28
    v_mul_f32 v21, v21, v29
    v_mul_f32 v22, v22, v30
    v_mul_f32 v23, v23, v31
    v_cvt_pk_bf16_f32 v32, v16, v17
    v_cvt_pk_bf16_f32 v33, v18, v19
    buffer_store_dwordx2 v[32:33], v7, s[16:19], s25 offen offset:0
    v_cvt_pk_bf16_f32 v34, v20, v21
    v_cvt_pk_bf16_f32 v35, v22, v23
    buffer_store_dwordx2 v[34:35], v7, s[16:19], s25 offen offset:1024
    s_add_u32 s25, s25, 2048
    v_fma_f32 v36, v98, v144, v148
    v_fma_f32 v37, v102, v145, v149
    v_fma_f32 v38, v106, v146, v150
    v_fma_f32 v39, v110, v147, v151
    v_fma_f32 v40, v99, v144, v148
    v_fma_f32 v41, v103, v145, v149
    v_fma_f32 v42, v107, v146, v150
    v_fma_f32 v43, v111, v147, v151
    v_mul_f32 v44, v36, v36
    v_mul_f32 v45, v37, v37
    v_mul_f32 v46, v38, v38
    v_mul_f32 v47, v39, v39
    v_mul_f32 v48, v40, v40
    v_mul_f32 v49, v41, v41
    v_mul_f32 v50, v42, v42
    v_mul_f32 v51, v43, v43
    v_fma_f32 v44, v44, s31, v15
    v_fma_f32 v45, v45, s31, v15
    v_fma_f32 v46, v46, s31, v15
    v_fma_f32 v47, v47, s31, v15
    v_fma_f32 v48, v48, s31, v15
    v_fma_f32 v49, v49, s31, v15
    v_fma_f32 v50, v50, s31, v15
    v_fma_f32 v51, v51, s31, v15
    v_mul_f32 v44, v44, v36
    v_mul_f32 v45, v45, v37
    v_mul_f32 v46, v46, v38
    v_mul_f32 v47, v47, v39
    v_mul_f32 v48, v48, v40
    v_mul_f32 v49, v49, v41
    v_mul_f32 v50, v50, v42
    v_mul_f32 v51, v51, v43
    v_exp_f32 v44, v44
    v_exp_f32 v45, v45
    v_exp_f32 v46, v46
    v_exp_f32 v47, v47
    v_exp_f32 v48, v48
    v_exp_f32 v49, v49
    v_exp_f32 v50, v50
    v_exp_f32 v51, v51
    v_add_f32 v44, 1.0, v44
    v_add_f32 v45, 1.0, v45
    v_add_f32 v46, 1.0, v46
    v_add_f32 v47, 1.0, v47
    v_add_f32 v48, 1.0, v48
    v_add_f32 v49, 1.0, v49
    v_add_f32 v50, 1.0, v50
    v_add_f32 v51, 1.0, v51
    v_rcp_f32 v44, v44
    v_rcp_f32 v45, v45
    v_rcp_f32 v46, v46
    v_rcp_f32 v47, v47
    v_rcp_f32 v48, v48
    v_rcp_f32 v49, v49
    v_rcp_f32 v50, v50
    v_rcp_f32 v51, v51
    v_mul_f32 v36, v36, v44
    v_mul_f32 v37, v37, v45
    v_mul_f32 v38, v38, v46
    v_mul_f32 v39, v39, v47
    v_mul_f32 v40, v40, v48
    v_mul_f32 v41, v41, v49
    v_mul_f32 v42, v42, v50
    v_mul_f32 v43, v43, v51
    v_cvt_pk_bf16_f32 v52, v36, v37
    v_cvt_pk_bf16_f32 v53, v38, v39
    buffer_store_dwordx2 v[52:53], v7, s[16:19], s25 offen offset:0
    v_cvt_pk_bf16_f32 v54, v40, v41
    v_cvt_pk_bf16_f32 v55, v42, v43
    buffer_store_dwordx2 v[54:55], v7, s[16:19], s25 offen offset:1024
    s_add_u32 s25, s25, 2048
    s_add_u32 s25, s25, 12288
    v_fma_f32 v16, v112, v144, v148
    v_fma_f32 v17, v116, v145, v149
    v_fma_f32 v18, v120, v146, v150
    v_fma_f32 v19, v124, v147, v151
    v_fma_f32 v20, v113, v144, v148
    v_fma_f32 v21, v117, v145, v149
    v_fma_f32 v22, v121, v146, v150
    v_fma_f32 v23, v125, v147, v151
    v_mul_f32 v24, v16, v16
    v_mul_f32 v25, v17, v17
    v_mul_f32 v26, v18, v18
    v_mul_f32 v27, v19, v19
    v_mul_f32 v28, v20, v20
    v_mul_f32 v29, v21, v21
    v_mul_f32 v30, v22, v22
    v_mul_f32 v31, v23, v23
    v_fma_f32 v24, v24, s31, v15
    v_fma_f32 v25, v25, s31, v15
    v_fma_f32 v26, v26, s31, v15
    v_fma_f32 v27, v27, s31, v15
    v_fma_f32 v28, v28, s31, v15
    v_fma_f32 v29, v29, s31, v15
    v_fma_f32 v30, v30, s31, v15
    v_fma_f32 v31, v31, s31, v15
    v_mul_f32 v24, v24, v16
    v_mul_f32 v25, v25, v17
    v_mul_f32 v26, v26, v18
    v_mul_f32 v27, v27, v19
    v_mul_f32 v28, v28, v20
    v_mul_f32 v29, v29, v21
    v_mul_f32 v30, v30, v22
    v_mul_f32 v31, v31, v23
    v_exp_f32 v24, v24
    v_exp_f32 v25, v25
    v_exp_f32 v26, v26
    v_exp_f32 v27, v27
    v_exp_f32 v28, v28
    v_exp_f32 v29, v29
    v_exp_f32 v30, v30
    v_exp_f32 v31, v31
    v_add_f32 v24, 1.0, v24
    v_add_f32 v25, 1.0, v25
    v_add_f32 v26, 1.0, v26
    v_add_f32 v27, 1.0, v27
    v_add_f32 v28, 1.0, v28
    v_add_f32 v29, 1.0, v29
    v_add_f32 v30, 1.0, v30
    v_add_f32 v31, 1.0, v31
    v_rcp_f32 v24, v24
    v_rcp_f32 v25, v25
    v_rcp_f32 v26, v26
    v_rcp_f32 v27, v27
    v_rcp_f32 v28, v28
    v_rcp_f32 v29, v29
    v_rcp_f32 v30, v30
    v_rcp_f32 v31, v31
    v_mul_f32 v16, v16, v24
    v_mul_f32 v17, v17, v25
    v_mul_f32 v18, v18, v26
    v_mul_f32 v19, v19, v27
    v_mul_f32 v20, v20, v28
    v_mul_f32 v21, v21, v29
    v_mul_f32 v22, v22, v30
    v_mul_f32 v23, v23, v31
    v_cvt_pk_bf16_f32 v32, v16, v17
    v_cvt_pk_bf16_f32 v33, v18, v19
    buffer_store_dwordx2 v[32:33], v7, s[16:19], s25 offen offset:0
    v_cvt_pk_bf16_f32 v34, v20, v21
    v_cvt_pk_bf16_f32 v35, v22, v23
    buffer_store_dwordx2 v[34:35], v7, s[16:19], s25 offen offset:1024
    s_add_u32 s25, s25, 2048
    v_fma_f32 v36, v114, v144, v148
    v_fma_f32 v37, v118, v145, v149
    v_fma_f32 v38, v122, v146, v150
    v_fma_f32 v39, v126, v147, v151
    v_fma_f32 v40, v115, v144, v148
    v_fma_f32 v41, v119, v145, v149
    v_fma_f32 v42, v123, v146, v150
    v_fma_f32 v43, v127, v147, v151
    v_mul_f32 v44, v36, v36
    v_mul_f32 v45, v37, v37
    v_mul_f32 v46, v38, v38
    v_mul_f32 v47, v39, v39
    v_mul_f32 v48, v40, v40
    v_mul_f32 v49, v41, v41
    v_mul_f32 v50, v42, v42
    v_mul_f32 v51, v43, v43
    v_fma_f32 v44, v44, s31, v15
    v_fma_f32 v45, v45, s31, v15
    v_fma_f32 v46, v46, s31, v15
    v_fma_f32 v47, v47, s31, v15
    v_fma_f32 v48, v48, s31, v15
    v_fma_f32 v49, v49, s31, v15
    v_fma_f32 v50, v50, s31, v15
    v_fma_f32 v51, v51, s31, v15
    v_mul_f32 v44, v44, v36
    v_mul_f32 v45, v45, v37
    v_mul_f32 v46, v46, v38
    v_mul_f32 v47, v47, v39
    v_mul_f32 v48, v48, v40
    v_mul_f32 v49, v49, v41
    v_mul_f32 v50, v50, v42
    v_mul_f32 v51, v51, v43
    v_exp_f32 v44, v44
    v_exp_f32 v45, v45
    v_exp_f32 v46, v46
    v_exp_f32 v47, v47
    v_exp_f32 v48, v48
    v_exp_f32 v49, v49
    v_exp_f32 v50, v50
    v_exp_f32 v51, v51
    v_add_f32 v44, 1.0, v44
    v_add_f32 v45, 1.0, v45
    v_add_f32 v46, 1.0, v46
    v_add_f32 v47, 1.0, v47
    v_add_f32 v48, 1.0, v48
    v_add_f32 v49, 1.0, v49
    v_add_f32 v50, 1.0, v50
    v_add_f32 v51, 1.0, v51
    v_rcp_f32 v44, v44
    v_rcp_f32 v45, v45
    v_rcp_f32 v46, v46
    v_rcp_f32 v47, v47
    v_rcp_f32 v48, v48
    v_rcp_f32 v49, v49
    v_rcp_f32 v50, v50
    v_rcp_f32 v51, v51
    v_mul_f32 v36, v36, v44
    v_mul_f32 v37, v37, v45
    v_mul_f32 v38, v38, v46
    v_mul_f32 v39, v39, v47
    v_mul_f32 v40, v40, v48
    v_mul_f32 v41, v41, v49
    v_mul_f32 v42, v42, v50
    v_mul_f32 v43, v43, v51
    v_cvt_pk_bf16_f32 v52, v36, v37
    v_cvt_pk_bf16_f32 v53, v38, v39
    buffer_store_dwordx2 v[52:53], v7, s[16:19], s25 offen offset:0
    v_cvt_pk_bf16_f32 v54, v40, v41
    v_cvt_pk_bf16_f32 v55, v42, v43
    buffer_store_dwordx2 v[54:55], v7, s[16:19], s25 offen offset:1024
    s_add_u32 s25, s25, 2048
    s_add_u32 s25, s25, 12288
    v_fma_f32 v16, v128, v144, v148
    v_fma_f32 v17, v132, v145, v149
    v_fma_f32 v18, v136, v146, v150
    v_fma_f32 v19, v140, v147, v151
    v_fma_f32 v20, v129, v144, v148
    v_fma_f32 v21, v133, v145, v149
    v_fma_f32 v22, v137, v146, v150
    v_fma_f32 v23, v141, v147, v151
    v_mul_f32 v24, v16, v16
    v_mul_f32 v25, v17, v17
    v_mul_f32 v26, v18, v18
    v_mul_f32 v27, v19, v19
    v_mul_f32 v28, v20, v20
    v_mul_f32 v29, v21, v21
    v_mul_f32 v30, v22, v22
    v_mul_f32 v31, v23, v23
    v_fma_f32 v24, v24, s31, v15
    v_fma_f32 v25, v25, s31, v15
    v_fma_f32 v26, v26, s31, v15
    v_fma_f32 v27, v27, s31, v15
    v_fma_f32 v28, v28, s31, v15
    v_fma_f32 v29, v29, s31, v15
    v_fma_f32 v30, v30, s31, v15
    v_fma_f32 v31, v31, s31, v15
    v_mul_f32 v24, v24, v16
    v_mul_f32 v25, v25, v17
    v_mul_f32 v26, v26, v18
    v_mul_f32 v27, v27, v19
    v_mul_f32 v28, v28, v20
    v_mul_f32 v29, v29, v21
    v_mul_f32 v30, v30, v22
    v_mul_f32 v31, v31, v23
    v_exp_f32 v24, v24
    v_exp_f32 v25, v25
    v_exp_f32 v26, v26
    v_exp_f32 v27, v27
    v_exp_f32 v28, v28
    v_exp_f32 v29, v29
    v_exp_f32 v30, v30
    v_exp_f32 v31, v31
    v_add_f32 v24, 1.0, v24
    v_add_f32 v25, 1.0, v25
    v_add_f32 v26, 1.0, v26
    v_add_f32 v27, 1.0, v27
    v_add_f32 v28, 1.0, v28
    v_add_f32 v29, 1.0, v29
    v_add_f32 v30, 1.0, v30
    v_add_f32 v31, 1.0, v31
    v_rcp_f32 v24, v24
    v_rcp_f32 v25, v25
    v_rcp_f32 v26, v26
    v_rcp_f32 v27, v27
    v_rcp_f32 v28, v28
    v_rcp_f32 v29, v29
    v_rcp_f32 v30, v30
    v_rcp_f32 v31, v31
    v_mul_f32 v16, v16, v24
    v_mul_f32 v17, v17, v25
    v_mul_f32 v18, v18, v26
    v_mul_f32 v19, v19, v27
    v_mul_f32 v20, v20, v28
    v_mul_f32 v21, v21, v29
    v_mul_f32 v22, v22, v30
    v_mul_f32 v23, v23, v31
    v_cvt_pk_bf16_f32 v32, v16, v17
    v_cvt_pk_bf16_f32 v33, v18, v19
    buffer_store_dwordx2 v[32:33], v7, s[16:19], s25 offen offset:0
    v_cvt_pk_bf16_f32 v34, v20, v21
    v_cvt_pk_bf16_f32 v35, v22, v23
    buffer_store_dwordx2 v[34:35], v7, s[16:19], s25 offen offset:1024
    s_add_u32 s25, s25, 2048
    v_fma_f32 v36, v130, v144, v148
    v_fma_f32 v37, v134, v145, v149
    v_fma_f32 v38, v138, v146, v150
    v_fma_f32 v39, v142, v147, v151
    v_fma_f32 v40, v131, v144, v148
    v_fma_f32 v41, v135, v145, v149
    v_fma_f32 v42, v139, v146, v150
    v_fma_f32 v43, v143, v147, v151
    v_mul_f32 v44, v36, v36
    v_mul_f32 v45, v37, v37
    v_mul_f32 v46, v38, v38
    v_mul_f32 v47, v39, v39
    v_mul_f32 v48, v40, v40
    v_mul_f32 v49, v41, v41
    v_mul_f32 v50, v42, v42
    v_mul_f32 v51, v43, v43
    v_fma_f32 v44, v44, s31, v15
    v_fma_f32 v45, v45, s31, v15
    v_fma_f32 v46, v46, s31, v15
    v_fma_f32 v47, v47, s31, v15
    v_fma_f32 v48, v48, s31, v15
    v_fma_f32 v49, v49, s31, v15
    v_fma_f32 v50, v50, s31, v15
    v_fma_f32 v51, v51, s31, v15
    v_mul_f32 v44, v44, v36
    v_mul_f32 v45, v45, v37
    v_mul_f32 v46, v46, v38
    v_mul_f32 v47, v47, v39
    v_mul_f32 v48, v48, v40
    v_mul_f32 v49, v49, v41
    v_mul_f32 v50, v50, v42
    v_mul_f32 v51, v51, v43
    v_exp_f32 v44, v44
    v_exp_f32 v45, v45
    v_exp_f32 v46, v46
    v_exp_f32 v47, v47
    v_exp_f32 v48, v48
    v_exp_f32 v49, v49
    v_exp_f32 v50, v50
    v_exp_f32 v51, v51
    v_add_f32 v44, 1.0, v44
    v_add_f32 v45, 1.0, v45
    v_add_f32 v46, 1.0, v46
    v_add_f32 v47, 1.0, v47
    v_add_f32 v48, 1.0, v48
    v_add_f32 v49, 1.0, v49
    v_add_f32 v50, 1.0, v50
    v_add_f32 v51, 1.0, v51
    v_rcp_f32 v44, v44
    v_rcp_f32 v45, v45
    v_rcp_f32 v46, v46
    v_rcp_f32 v47, v47
    v_rcp_f32 v48, v48
    v_rcp_f32 v49, v49
    v_rcp_f32 v50, v50
    v_rcp_f32 v51, v51
    v_mul_f32 v36, v36, v44
    v_mul_f32 v37, v37, v45
    v_mul_f32 v38, v38, v46
    v_mul_f32 v39, v39, v47
    v_mul_f32 v40, v40, v48
    v_mul_f32 v41, v41, v49
    v_mul_f32 v42, v42, v50
    v_mul_f32 v43, v43, v51
    v_cvt_pk_bf16_f32 v52, v36, v37
    v_cvt_pk_bf16_f32 v53, v38, v39
    buffer_store_dwordx2 v[52:53], v7, s[16:19], s25 offen offset:0
    v_cvt_pk_bf16_f32 v54, v40, v41
    v_cvt_pk_bf16_f32 v55, v42, v43
    buffer_store_dwordx2 v[54:55], v7, s[16:19], s25 offen offset:1024
    s_add_u32 s25, s25, 2048
    s_add_u32 s25, s25, 12288
K34_END:
    s_endpgm
TEXT_END:
.section .rodata,"a"
.p2align 6
.amdhsa_kernel k1_xform_kernel
  .amdhsa_next_free_vgpr 128
  .amdhsa_next_free_sgpr 96
  .amdhsa_accum_offset 128
  .amdhsa_group_segment_fixed_size 0
  .amdhsa_kernarg_size 56
  .amdhsa_user_sgpr_count 2
  .amdhsa_user_sgpr_kernarg_segment_ptr 1
  .amdhsa_system_sgpr_workgroup_id_x 1
.end_amdhsa_kernel
.p2align 6
.amdhsa_kernel k12_fused_kernel
  .amdhsa_next_free_vgpr 256
  .amdhsa_next_free_sgpr 96
  .amdhsa_accum_offset 256
  .amdhsa_group_segment_fixed_size 0
  .amdhsa_kernarg_size 56
  .amdhsa_user_sgpr_count 2
  .amdhsa_user_sgpr_kernarg_segment_ptr 1
  .amdhsa_system_sgpr_workgroup_id_x 1
.end_amdhsa_kernel
.p2align 6
.amdhsa_kernel k34_out_kernel
  .amdhsa_next_free_vgpr 168
  .amdhsa_next_free_sgpr 96
  .amdhsa_accum_offset 168
  .amdhsa_group_segment_fixed_size 0
  .amdhsa_kernarg_size 56
  .amdhsa_user_sgpr_count 2
  .amdhsa_user_sgpr_kernarg_segment_ptr 1
  .amdhsa_system_sgpr_workgroup_id_x 1
.end_amdhsa_kernel
```

```asm
; @launch kernel=k1_xform_kernel grid=(636,1,1) block=(256,1,1) lds=16384
; @launch kernel=k12_fused_kernel grid=(256,1,1) block=(512,1,1) lds=155840
; @launch kernel=k34_out_kernel grid=(256,1,1) block=(768,1,1) lds=18944
.amdgcn_target "amdgcn-amd-amdhsa--gfx950"
.text
.globl k1_xform_kernel
.globl k12_fused_kernel
.globl k34_out_kernel
.p2align 8
.type k1_xform_kernel,@function
k1_xform_kernel:
    s_cmp_ge_u32 s2, 636
    s_cbranch_scc1 K1_END
    s_load_dwordx4 s[4:7], s[0:1], 0
    s_load_dwordx2 s[8:9], s[0:1], 48
    v_lshrrev_b32 v120, 6, v0
    v_and_b32 v121, 63, v0
    v_readfirstlane_b32 s3, v120
    v_and_b32 v122, 15, v121
    v_lshrrev_b32 v123, 4, v121
    s_mov_b32 s28, 0x05040100
    s_mov_b32 s29, 0x07060302
    v_and_b32 v124, 3, v122
    v_lshlrev_b32 v124, 2, v124
    v_lshrrev_b32 v125, 3, v122
    v_lshl_add_u32 v124, v125, 1, v124
    s_lshl_b32 s10, s3, 4
    s_add_u32 s10, s10, 1
    v_add_u32 v124, s10, v124
    v_bfe_u32 v125, v122, 2, 1
    v_lshlrev_b32 v121, 4, v121
    s_waitcnt lgkmcnt(0)
    s_or_b32 s10, s2, s3
    s_cmp_eq_u32 s10, 0
    s_cbranch_scc0 K1_NOCLR
    s_add_u32 s12, s8, 153092096
    s_addc_u32 s13, s9, 0
    s_and_b32 s13, s13, 0xffff
    s_mov_b32 s14, 32768
    s_mov_b32 s15, 0x00020000
    v_lshrrev_b32 v118, 4, v121
    v_lshlrev_b32 v119, 10, v118
    v_mov_b32 v117, 0
    s_mov_b64 exec, 0xffff
    buffer_store_dword v117, v119, s[12:15], 0 offen
    v_lshlrev_b32 v119, 4, v118
    v_add_u32 v119, 16384, v119
    buffer_store_dword v117, v119, s[12:15], 0 offen
    s_mov_b64 exec, -1
K1_NOCLR:
    s_cmp_lt_u32 s2, 32
    s_cbranch_scc0 K1_NOFILL
    s_add_u32 s12, s8, 153616384
    s_addc_u32 s13, s9, 0
    s_and_b32 s13, s13, 0xffff
    s_mov_b32 s14, 131072
    s_mov_b32 s15, 0x00020000
    s_lshl_b32 s10, s2, 2
    s_add_u32 s10, s10, s3
    s_lshl_b32 s10, s10, 10
    v_mov_b32 v112, -1
    v_mov_b32 v113, -1
    v_mov_b32 v114, -1
    v_mov_b32 v115, -1
    buffer_store_dwordx4 v[112:115], v121, s[12:15], s10 offen
K1_NOFILL:
    s_add_u32 s10, s2, 384
    s_sub_u32 s11, s2, 252
    s_cmp_lt_u32 s2, 252
    s_cselect_b32 s2, s10, s11
    s_cmp_lt_u32 s2, 384
    s_cbranch_scc1 K1_W
    s_sub_u32 s11, s2, 384
    s_mul_hi_u32 s13, s11, 1431655766
    s_mul_i32 s12, s13, 3
    s_sub_u32 s12, s11, s12
    s_mov_b32 s11, s13
    s_cmp_ge_u32 s11, 42
    s_cselect_b32 s13, 1, 0
    s_mul_i32 s14, s13, 42
    s_sub_u32 s11, s11, s14
    s_lshl_b32 s11, s11, 2
    s_add_u32 s11, s11, s3
    s_mul_i32 s14, s13, 16384000
    s_add_u32 s16, s4, s14
    s_addc_u32 s17, s5, 0
    s_and_b32 s17, s17, 0xffff
    s_mov_b32 s18, 16384000
    s_mov_b32 s19, 0x00020000
    s_mov_b32 s20, s8
    s_mov_b32 s21, s9
    s_and_b32 s21, s21, 0xffff
    s_mov_b32 s22, 43778048
    s_mov_b32 s23, 0x00020000
    v_lshlrev_b32 v126, 14, v123
    v_lshl_add_u32 v126, v122, 4, v126
    s_mul_i32 s15, s11, 98304
    s_lshl_b32 s24, s12, 8
    s_add_u32 s15, s15, s24
    buffer_load_dwordx4 v[0:3], v126, s[16:19], s15 offen
    buffer_load_dwordx4 v[4:7], v126, s[16:19], s15 offen offset:2048
    s_add_u32 s15, s15, 4096
    buffer_load_dwordx4 v[8:11], v126, s[16:19], s15 offen
    buffer_load_dwordx4 v[12:15], v126, s[16:19], s15 offen offset:2048
    s_add_u32 s15, s15, 4096
    buffer_load_dwordx4 v[16:19], v126, s[16:19], s15 offen
    buffer_load_dwordx4 v[20:23], v126, s[16:19], s15 offen offset:2048
    s_add_u32 s15, s15, 4096
    buffer_load_dwordx4 v[24:27], v126, s[16:19], s15 offen
    buffer_load_dwordx4 v[28:31], v126, s[16:19], s15 offen offset:2048
    s_add_u32 s15, s15, 53248
    buffer_load_dwordx4 v[32:35], v126, s[16:19], s15 offen
    buffer_load_dwordx4 v[36:39], v126, s[16:19], s15 offen offset:2048
    s_add_u32 s15, s15, 4096
    buffer_load_dwordx4 v[40:43], v126, s[16:19], s15 offen
    buffer_load_dwordx4 v[44:47], v126, s[16:19], s15 offen offset:2048
    s_add_u32 s15, s15, 4096
    buffer_load_dwordx4 v[48:51], v126, s[16:19], s15 offen
    buffer_load_dwordx4 v[52:55], v126, s[16:19], s15 offen offset:2048
    s_add_u32 s15, s15, 4096
    buffer_load_dwordx4 v[56:59], v126, s[16:19], s15 offen
    buffer_load_dwordx4 v[60:63], v126, s[16:19], s15 offen offset:2048
    v_lshlrev_b32 v127, 3, v123
    v_lshlrev_b32 v112, 5, v125
    v_mad_u32_u24 v113, v124, v127, v112
    v_mad_u32_u24 v64, v124, 0, v113
    v_mad_u32_u24 v65, v124, 1, v113
    v_mad_u32_u24 v66, v124, 2, v113
    v_mad_u32_u24 v67, v124, 3, v113
    v_mad_u32_u24 v68, v124, 4, v113
    v_mad_u32_u24 v69, v124, 5, v113
    v_mad_u32_u24 v70, v124, 6, v113
    v_mad_u32_u24 v71, v124, 7, v113
    v_and_b32 v64, 127, v64
    v_and_b32 v65, 127, v65
    v_and_b32 v66, 127, v66
    v_and_b32 v67, 127, v67
    v_and_b32 v68, 127, v68
    v_and_b32 v69, 127, v69
    v_and_b32 v70, 127, v70
    v_and_b32 v71, 127, v71
    v_cvt_f32_u32 v64, v64
    v_cvt_f32_u32 v65, v65
    v_cvt_f32_u32 v66, v66
    v_cvt_f32_u32 v67, v67
    v_cvt_f32_u32 v68, v68
    v_cvt_f32_u32 v69, v69
    v_cvt_f32_u32 v70, v70
    v_cvt_f32_u32 v71, v71
    v_mul_f32 v64, 0x3c000000, v64
    v_mul_f32 v65, 0x3c000000, v65
    v_mul_f32 v66, 0x3c000000, v66
    v_mul_f32 v67, 0x3c000000, v67
    v_mul_f32 v68, 0x3c000000, v68
    v_mul_f32 v69, 0x3c000000, v69
    v_mul_f32 v70, 0x3c000000, v70
    v_mul_f32 v71, 0x3c000000, v71
    v_cos_f32 v64, v64
    v_cos_f32 v65, v65
    v_cos_f32 v66, v66
    v_cos_f32 v67, v67
    v_cos_f32 v68, v68
    v_cos_f32 v69, v69
    v_cos_f32 v70, v70
    v_cos_f32 v71, v71
    s_nop 0
    v_cvt_pk_bf16_f32 v72, v64, v65
    v_cvt_pk_bf16_f32 v73, v66, v67
    v_cvt_pk_bf16_f32 v74, v68, v69
    v_cvt_pk_bf16_f32 v75, v70, v71
    v_lshlrev_b32 v80, 16, v72
    v_and_b32 v81, 0xffff0000, v72
    v_sub_f32 v64, v64, v80
    v_sub_f32 v65, v65, v81
    v_lshlrev_b32 v80, 16, v73
    v_and_b32 v81, 0xffff0000, v73
    v_sub_f32 v66, v66, v80
    v_sub_f32 v67, v67, v81
    v_lshlrev_b32 v80, 16, v74
    v_and_b32 v81, 0xffff0000, v74
    v_sub_f32 v68, v68, v80
    v_sub_f32 v69, v69, v81
    v_lshlrev_b32 v80, 16, v75
    v_and_b32 v81, 0xffff0000, v75
    v_sub_f32 v70, v70, v80
    v_sub_f32 v71, v71, v81
    v_cvt_pk_bf16_f32 v76, v64, v65
    v_cvt_pk_bf16_f32 v77, v66, v67
    v_cvt_pk_bf16_f32 v78, v68, v69
    v_cvt_pk_bf16_f32 v79, v70, v71
    s_lshl_b32 s24, s3, 12
    v_add_u32 v114, s24, v121
    ds_write_b128 v114, v[72:75] offset:0
    ds_write_b128 v114, v[76:79] offset:1024
    v_add_u32 v127, 32, v127
    v_lshlrev_b32 v112, 5, v125
    v_mad_u32_u24 v113, v124, v127, v112
    v_mad_u32_u24 v64, v124, 0, v113
    v_mad_u32_u24 v65, v124, 1, v113
    v_mad_u32_u24 v66, v124, 2, v113
    v_mad_u32_u24 v67, v124, 3, v113
    v_mad_u32_u24 v68, v124, 4, v113
    v_mad_u32_u24 v69, v124, 5, v113
    v_mad_u32_u24 v70, v124, 6, v113
    v_mad_u32_u24 v71, v124, 7, v113
    v_and_b32 v64, 127, v64
    v_and_b32 v65, 127, v65
    v_and_b32 v66, 127, v66
    v_and_b32 v67, 127, v67
    v_and_b32 v68, 127, v68
    v_and_b32 v69, 127, v69
    v_and_b32 v70, 127, v70
    v_and_b32 v71, 127, v71
    v_cvt_f32_u32 v64, v64
    v_cvt_f32_u32 v65, v65
    v_cvt_f32_u32 v66, v66
    v_cvt_f32_u32 v67, v67
    v_cvt_f32_u32 v68, v68
    v_cvt_f32_u32 v69, v69
    v_cvt_f32_u32 v70, v70
    v_cvt_f32_u32 v71, v71
    v_mul_f32 v64, 0x3c000000, v64
    v_mul_f32 v65, 0x3c000000, v65
    v_mul_f32 v66, 0x3c000000, v66
    v_mul_f32 v67, 0x3c000000, v67
    v_mul_f32 v68, 0x3c000000, v68
    v_mul_f32 v69, 0x3c000000, v69
    v_mul_f32 v70, 0x3c000000, v70
    v_mul_f32 v71, 0x3c000000, v71
    v_cos_f32 v64, v64
    v_cos_f32 v65, v65
    v_cos_f32 v66, v66
    v_cos_f32 v67, v67
    v_cos_f32 v68, v68
    v_cos_f32 v69, v69
    v_cos_f32 v70, v70
    v_cos_f32 v71, v71
    s_nop 0
    v_cvt_pk_bf16_f32 v72, v64, v65
    v_cvt_pk_bf16_f32 v73, v66, v67
    v_cvt_pk_bf16_f32 v74, v68, v69
    v_cvt_pk_bf16_f32 v75, v70, v71
    v_lshlrev_b32 v80, 16, v72
    v_and_b32 v81, 0xffff0000, v72
    v_sub_f32 v64, v64, v80
    v_sub_f32 v65, v65, v81
    v_lshlrev_b32 v80, 16, v73
    v_and_b32 v81, 0xffff0000, v73
    v_sub_f32 v66, v66, v80
    v_sub_f32 v67, v67, v81
    v_lshlrev_b32 v80, 16, v74
    v_and_b32 v81, 0xffff0000, v74
    v_sub_f32 v68, v68, v80
    v_sub_f32 v69, v69, v81
    v_lshlrev_b32 v80, 16, v75
    v_and_b32 v81, 0xffff0000, v75
    v_sub_f32 v70, v70, v80
    v_sub_f32 v71, v71, v81
    v_cvt_pk_bf16_f32 v76, v64, v65
    v_cvt_pk_bf16_f32 v77, v66, v67
    v_cvt_pk_bf16_f32 v78, v68, v69
    v_cvt_pk_bf16_f32 v79, v70, v71
    s_lshl_b32 s24, s3, 12
    v_add_u32 v114, s24, v121
    ds_write_b128 v114, v[72:75] offset:2048
    ds_write_b128 v114, v[76:79] offset:3072
    v_lshrrev_b32 v112, 1, v123
    s_mov_b32 s24, 1368064
    v_mul_lo_u32 v112, v112, s24
    v_lshrrev_b32 v113, 2, v122
    s_mov_b32 s24, 21376
    v_mul_lo_u32 v113, v113, s24
    v_add_u32 v112, v112, v113
    v_and_b32 v113, 3, v122
    v_and_b32 v114, 1, v123
    v_lshl_add_u32 v113, v114, 2, v113
    s_add_u32 s24, s11, 7
    s_cmp_ge_u32 s11, 160
    s_cselect_b32 s24, s24, s11
    s_cmp_eq_u32 s13, 1
    s_cselect_b32 s24, s24, s11
    s_lshr_b32 s24, s24, 1
    s_and_b32 s24, s24, 7
    v_xor_b32 v113, s24, v113
    v_lshl_add_u32 v120, v113, 4, v112
    s_mul_i32 s25, s13, 684032
    s_mul_i32 s24, s12, 85504
    s_add_u32 s25, s25, s24
    s_lshl_b32 s24, s11, 7
    s_add_u32 s25, s25, s24
    s_waitcnt lgkmcnt(0)
    s_barrier
    s_cmp_ge_u32 s11, 167
    s_cbranch_scc1 K1_END
    s_waitcnt vmcnt(8)
    v_perm_b32 v64, v4, v0, s28
    v_perm_b32 v68, v4, v0, s29
    v_perm_b32 v65, v12, v8, s28
    v_perm_b32 v69, v12, v8, s29
    v_perm_b32 v66, v20, v16, s28
    v_perm_b32 v70, v20, v16, s29
    v_perm_b32 v67, v28, v24, s28
    v_perm_b32 v71, v28, v24, s29
    v_perm_b32 v72, v5, v1, s28
    v_perm_b32 v76, v5, v1, s29
    v_perm_b32 v73, v13, v9, s28
    v_perm_b32 v77, v13, v9, s29
    v_perm_b32 v74, v21, v17, s28
    v_perm_b32 v78, v21, v17, s29
    v_perm_b32 v75, v29, v25, s28
    v_perm_b32 v79, v29, v25, s29
    v_perm_b32 v80, v6, v2, s28
    v_perm_b32 v84, v6, v2, s29
    v_perm_b32 v81, v14, v10, s28
    v_perm_b32 v85, v14, v10, s29
    v_perm_b32 v82, v22, v18, s28
    v_perm_b32 v86, v22, v18, s29
    v_perm_b32 v83, v30, v26, s28
    v_perm_b32 v87, v30, v26, s29
    v_perm_b32 v88, v7, v3, s28
    v_perm_b32 v92, v7, v3, s29
    v_perm_b32 v89, v15, v11, s28
    v_perm_b32 v93, v15, v11, s29
    v_perm_b32 v90, v23, v19, s28
    v_perm_b32 v94, v23, v19, s29
    v_perm_b32 v91, v31, v27, s28
    v_perm_b32 v95, v31, v27, s29
    s_waitcnt vmcnt(0)
    v_perm_b32 v0, v36, v32, s28
    v_perm_b32 v4, v36, v32, s29
    v_perm_b32 v1, v44, v40, s28
    v_perm_b32 v5, v44, v40, s29
    v_perm_b32 v2, v52, v48, s28
    v_perm_b32 v6, v52, v48, s29
    v_perm_b32 v3, v60, v56, s28
    v_perm_b32 v7, v60, v56, s29
    v_perm_b32 v8, v37, v33, s28
    v_perm_b32 v12, v37, v33, s29
    v_perm_b32 v9, v45, v41, s28
    v_perm_b32 v13, v45, v41, s29
    v_perm_b32 v10, v53, v49, s28
    v_perm_b32 v14, v53, v49, s29
    v_perm_b32 v11, v61, v57, s28
    v_perm_b32 v15, v61, v57, s29
    v_perm_b32 v16, v38, v34, s28
    v_perm_b32 v20, v38, v34, s29
    v_perm_b32 v17, v46, v42, s28
    v_perm_b32 v21, v46, v42, s29
    v_perm_b32 v18, v54, v50, s28
    v_perm_b32 v22, v54, v50, s29
    v_perm_b32 v19, v62, v58, s28
    v_perm_b32 v23, v62, v58, s29
    v_perm_b32 v24, v39, v35, s28
    v_perm_b32 v28, v39, v35, s29
    v_perm_b32 v25, v47, v43, s28
    v_perm_b32 v29, v47, v43, s29
    v_perm_b32 v26, v55, v51, s28
    v_perm_b32 v30, v55, v51, s29
    v_perm_b32 v27, v63, v59, s28
    v_perm_b32 v31, v63, v59, s29
    ds_read_b128 v[96:99], v121 offset:0
    ds_read_b128 v[100:103], v121 offset:1024
    ds_read_b128 v[104:107], v121 offset:2048
    ds_read_b128 v[108:111], v121 offset:3072
    s_waitcnt lgkmcnt(3)
    v_mfma_f32_16x16x32_bf16 v[32:35], v[96:99], v[64:67], 0
    v_mfma_f32_16x16x32_bf16 v[36:39], v[96:99], v[68:71], 0
    v_mfma_f32_16x16x32_bf16 v[40:43], v[96:99], v[72:75], 0
    v_mfma_f32_16x16x32_bf16 v[44:47], v[96:99], v[76:79], 0
    v_mfma_f32_16x16x32_bf16 v[48:51], v[96:99], v[80:83], 0
    v_mfma_f32_16x16x32_bf16 v[52:55], v[96:99], v[84:87], 0
    v_mfma_f32_16x16x32_bf16 v[56:59], v[96:99], v[88:91], 0
    v_mfma_f32_16x16x32_bf16 v[60:63], v[96:99], v[92:95], 0
    s_waitcnt lgkmcnt(2)
    v_mfma_f32_16x16x32_bf16 v[32:35], v[100:103], v[64:67], v[32:35]
    v_mfma_f32_16x16x32_bf16 v[36:39], v[100:103], v[68:71], v[36:39]
    v_mfma_f32_16x16x32_bf16 v[40:43], v[100:103], v[72:75], v[40:43]
    v_mfma_f32_16x16x32_bf16 v[44:47], v[100:103], v[76:79], v[44:47]
    v_mfma_f32_16x16x32_bf16 v[48:51], v[100:103], v[80:83], v[48:51]
    v_mfma_f32_16x16x32_bf16 v[52:55], v[100:103], v[84:87], v[52:55]
    v_mfma_f32_16x16x32_bf16 v[56:59], v[100:103], v[88:91], v[56:59]
    v_mfma_f32_16x16x32_bf16 v[60:63], v[100:103], v[92:95], v[60:63]
    s_waitcnt lgkmcnt(1)
    v_mfma_f32_16x16x32_bf16 v[32:35], v[104:107], v[0:3], v[32:35]
    v_mfma_f32_16x16x32_bf16 v[36:39], v[104:107], v[4:7], v[36:39]
    v_mfma_f32_16x16x32_bf16 v[40:43], v[104:107], v[8:11], v[40:43]
    v_mfma_f32_16x16x32_bf16 v[44:47], v[104:107], v[12:15], v[44:47]
    v_mfma_f32_16x16x32_bf16 v[48:51], v[104:107], v[16:19], v[48:51]
    v_mfma_f32_16x16x32_bf16 v[52:55], v[104:107], v[20:23], v[52:55]
    v_mfma_f32_16x16x32_bf16 v[56:59], v[104:107], v[24:27], v[56:59]
    v_mfma_f32_16x16x32_bf16 v[60:63], v[104:107], v[28:31], v[60:63]
    s_waitcnt lgkmcnt(0)
    v_mfma_f32_16x16x32_bf16 v[32:35], v[108:111], v[0:3], v[32:35]
    v_mfma_f32_16x16x32_bf16 v[36:39], v[108:111], v[4:7], v[36:39]
    v_mfma_f32_16x16x32_bf16 v[40:43], v[108:111], v[8:11], v[40:43]
    v_mfma_f32_16x16x32_bf16 v[44:47], v[108:111], v[12:15], v[44:47]
    v_mfma_f32_16x16x32_bf16 v[48:51], v[108:111], v[16:19], v[48:51]
    v_mfma_f32_16x16x32_bf16 v[52:55], v[108:111], v[20:23], v[52:55]
    v_mfma_f32_16x16x32_bf16 v[56:59], v[108:111], v[24:27], v[56:59]
    v_mfma_f32_16x16x32_bf16 v[60:63], v[108:111], v[28:31], v[60:63]
    s_nop 7
    v_cvt_pk_bf16_f32 v112, v32, v36
    v_cvt_pk_bf16_f32 v113, v40, v44
    v_cvt_pk_bf16_f32 v114, v48, v52
    v_cvt_pk_bf16_f32 v115, v56, v60
    buffer_store_dwordx4 v[112:115], v120, s[20:23], s25 offen
    s_add_u32 s25, s25, 2736128
    v_cvt_pk_bf16_f32 v116, v33, v37
    v_cvt_pk_bf16_f32 v117, v41, v45
    v_cvt_pk_bf16_f32 v118, v49, v53
    v_cvt_pk_bf16_f32 v119, v57, v61
    buffer_store_dwordx4 v[116:119], v120, s[20:23], s25 offen
    s_add_u32 s25, s25, 2736128
    v_cvt_pk_bf16_f32 v112, v34, v38
    v_cvt_pk_bf16_f32 v113, v42, v46
    v_cvt_pk_bf16_f32 v114, v50, v54
    v_cvt_pk_bf16_f32 v115, v58, v62
    buffer_store_dwordx4 v[112:115], v120, s[20:23], s25 offen
    s_add_u32 s25, s25, 2736128
    v_cvt_pk_bf16_f32 v116, v35, v39
    v_cvt_pk_bf16_f32 v117, v43, v47
    v_cvt_pk_bf16_f32 v118, v51, v55
    v_cvt_pk_bf16_f32 v119, v59, v63
    buffer_store_dwordx4 v[116:119], v120, s[20:23], s25 offen
    s_add_u32 s25, s25, 2736128
    ds_read_b128 v[96:99], v121 offset:4096
    ds_read_b128 v[100:103], v121 offset:5120
    ds_read_b128 v[104:107], v121 offset:6144
    ds_read_b128 v[108:111], v121 offset:7168
    s_waitcnt lgkmcnt(3)
    v_mfma_f32_16x16x32_bf16 v[32:35], v[96:99], v[64:67], 0
    v_mfma_f32_16x16x32_bf16 v[36:39], v[96:99], v[68:71], 0
    v_mfma_f32_16x16x32_bf16 v[40:43], v[96:99], v[72:75], 0
    v_mfma_f32_16x16x32_bf16 v[44:47], v[96:99], v[76:79], 0
    v_mfma_f32_16x16x32_bf16 v[48:51], v[96:99], v[80:83], 0
    v_mfma_f32_16x16x32_bf16 v[52:55], v[96:99], v[84:87], 0
    v_mfma_f32_16x16x32_bf16 v[56:59], v[96:99], v[88:91], 0
    v_mfma_f32_16x16x32_bf16 v[60:63], v[96:99], v[92:95], 0
    s_waitcnt lgkmcnt(2)
    v_mfma_f32_16x16x32_bf16 v[32:35], v[100:103], v[64:67], v[32:35]
    v_mfma_f32_16x16x32_bf16 v[36:39], v[100:103], v[68:71], v[36:39]
    v_mfma_f32_16x16x32_bf16 v[40:43], v[100:103], v[72:75], v[40:43]
    v_mfma_f32_16x16x32_bf16 v[44:47], v[100:103], v[76:79], v[44:47]
    v_mfma_f32_16x16x32_bf16 v[48:51], v[100:103], v[80:83], v[48:51]
    v_mfma_f32_16x16x32_bf16 v[52:55], v[100:103], v[84:87], v[52:55]
    v_mfma_f32_16x16x32_bf16 v[56:59], v[100:103], v[88:91], v[56:59]
    v_mfma_f32_16x16x32_bf16 v[60:63], v[100:103], v[92:95], v[60:63]
    s_waitcnt lgkmcnt(1)
    v_mfma_f32_16x16x32_bf16 v[32:35], v[104:107], v[0:3], v[32:35]
    v_mfma_f32_16x16x32_bf16 v[36:39], v[104:107], v[4:7], v[36:39]
    v_mfma_f32_16x16x32_bf16 v[40:43], v[104:107], v[8:11], v[40:43]
    v_mfma_f32_16x16x32_bf16 v[44:47], v[104:107], v[12:15], v[44:47]
    v_mfma_f32_16x16x32_bf16 v[48:51], v[104:107], v[16:19], v[48:51]
    v_mfma_f32_16x16x32_bf16 v[52:55], v[104:107], v[20:23], v[52:55]
    v_mfma_f32_16x16x32_bf16 v[56:59], v[104:107], v[24:27], v[56:59]
    v_mfma_f32_16x16x32_bf16 v[60:63], v[104:107], v[28:31], v[60:63]
    s_waitcnt lgkmcnt(0)
    v_mfma_f32_16x16x32_bf16 v[32:35], v[108:111], v[0:3], v[32:35]
    v_mfma_f32_16x16x32_bf16 v[36:39], v[108:111], v[4:7], v[36:39]
    v_mfma_f32_16x16x32_bf16 v[40:43], v[108:111], v[8:11], v[40:43]
    v_mfma_f32_16x16x32_bf16 v[44:47], v[108:111], v[12:15], v[44:47]
    v_mfma_f32_16x16x32_bf16 v[48:51], v[108:111], v[16:19], v[48:51]
    v_mfma_f32_16x16x32_bf16 v[52:55], v[108:111], v[20:23], v[52:55]
    v_mfma_f32_16x16x32_bf16 v[56:59], v[108:111], v[24:27], v[56:59]
    v_mfma_f32_16x16x32_bf16 v[60:63], v[108:111], v[28:31], v[60:63]
    s_nop 7
    v_cvt_pk_bf16_f32 v112, v32, v36
    v_cvt_pk_bf16_f32 v113, v40, v44
    v_cvt_pk_bf16_f32 v114, v48, v52
    v_cvt_pk_bf16_f32 v115, v56, v60
    buffer_store_dwordx4 v[112:115], v120, s[20:23], s25 offen
    s_add_u32 s25, s25, 2736128
    v_cvt_pk_bf16_f32 v116, v33, v37
    v_cvt_pk_bf16_f32 v117, v41, v45
    v_cvt_pk_bf16_f32 v118, v49, v53
    v_cvt_pk_bf16_f32 v119, v57, v61
    buffer_store_dwordx4 v[116:119], v120, s[20:23], s25 offen
    s_add_u32 s25, s25, 2736128
    v_cvt_pk_bf16_f32 v112, v34, v38
    v_cvt_pk_bf16_f32 v113, v42, v46
    v_cvt_pk_bf16_f32 v114, v50, v54
    v_cvt_pk_bf16_f32 v115, v58, v62
    buffer_store_dwordx4 v[112:115], v120, s[20:23], s25 offen
    s_add_u32 s25, s25, 2736128
    v_cvt_pk_bf16_f32 v116, v35, v39
    v_cvt_pk_bf16_f32 v117, v43, v47
    v_cvt_pk_bf16_f32 v118, v51, v55
    v_cvt_pk_bf16_f32 v119, v59, v63
    buffer_store_dwordx4 v[116:119], v120, s[20:23], s25 offen
    s_add_u32 s25, s25, 2736128
    ds_read_b128 v[96:99], v121 offset:8192
    ds_read_b128 v[100:103], v121 offset:9216
    ds_read_b128 v[104:107], v121 offset:10240
    ds_read_b128 v[108:111], v121 offset:11264
    s_waitcnt lgkmcnt(3)
    v_mfma_f32_16x16x32_bf16 v[32:35], v[96:99], v[64:67], 0
    v_mfma_f32_16x16x32_bf16 v[36:39], v[96:99], v[68:71], 0
    v_mfma_f32_16x16x32_bf16 v[40:43], v[96:99], v[72:75], 0
    v_mfma_f32_16x16x32_bf16 v[44:47], v[96:99], v[76:79], 0
    v_mfma_f32_16x16x32_bf16 v[48:51], v[96:99], v[80:83], 0
    v_mfma_f32_16x16x32_bf16 v[52:55], v[96:99], v[84:87], 0
    v_mfma_f32_16x16x32_bf16 v[56:59], v[96:99], v[88:91], 0
    v_mfma_f32_16x16x32_bf16 v[60:63], v[96:99], v[92:95], 0
    s_waitcnt lgkmcnt(2)
    v_mfma_f32_16x16x32_bf16 v[32:35], v[100:103], v[64:67], v[32:35]
    v_mfma_f32_16x16x32_bf16 v[36:39], v[100:103], v[68:71], v[36:39]
    v_mfma_f32_16x16x32_bf16 v[40:43], v[100:103], v[72:75], v[40:43]
    v_mfma_f32_16x16x32_bf16 v[44:47], v[100:103], v[76:79], v[44:47]
    v_mfma_f32_16x16x32_bf16 v[48:51], v[100:103], v[80:83], v[48:51]
    v_mfma_f32_16x16x32_bf16 v[52:55], v[100:103], v[84:87], v[52:55]
    v_mfma_f32_16x16x32_bf16 v[56:59], v[100:103], v[88:91], v[56:59]
    v_mfma_f32_16x16x32_bf16 v[60:63], v[100:103], v[92:95], v[60:63]
    s_waitcnt lgkmcnt(1)
    v_mfma_f32_16x16x32_bf16 v[32:35], v[104:107], v[0:3], v[32:35]
    v_mfma_f32_16x16x32_bf16 v[36:39], v[104:107], v[4:7], v[36:39]
    v_mfma_f32_16x16x32_bf16 v[40:43], v[104:107], v[8:11], v[40:43]
    v_mfma_f32_16x16x32_bf16 v[44:47], v[104:107], v[12:15], v[44:47]
    v_mfma_f32_16x16x32_bf16 v[48:51], v[104:107], v[16:19], v[48:51]
    v_mfma_f32_16x16x32_bf16 v[52:55], v[104:107], v[20:23], v[52:55]
    v_mfma_f32_16x16x32_bf16 v[56:59], v[104:107], v[24:27], v[56:59]
    v_mfma_f32_16x16x32_bf16 v[60:63], v[104:107], v[28:31], v[60:63]
    s_waitcnt lgkmcnt(0)
    v_mfma_f32_16x16x32_bf16 v[32:35], v[108:111], v[0:3], v[32:35]
    v_mfma_f32_16x16x32_bf16 v[36:39], v[108:111], v[4:7], v[36:39]
    v_mfma_f32_16x16x32_bf16 v[40:43], v[108:111], v[8:11], v[40:43]
    v_mfma_f32_16x16x32_bf16 v[44:47], v[108:111], v[12:15], v[44:47]
    v_mfma_f32_16x16x32_bf16 v[48:51], v[108:111], v[16:19], v[48:51]
    v_mfma_f32_16x16x32_bf16 v[52:55], v[108:111], v[20:23], v[52:55]
    v_mfma_f32_16x16x32_bf16 v[56:59], v[108:111], v[24:27], v[56:59]
    v_mfma_f32_16x16x32_bf16 v[60:63], v[108:111], v[28:31], v[60:63]
    s_nop 7
    v_cvt_pk_bf16_f32 v112, v32, v36
    v_cvt_pk_bf16_f32 v113, v40, v44
    v_cvt_pk_bf16_f32 v114, v48, v52
    v_cvt_pk_bf16_f32 v115, v56, v60
    buffer_store_dwordx4 v[112:115], v120, s[20:23], s25 offen
    s_add_u32 s25, s25, 2736128
    v_cvt_pk_bf16_f32 v116, v33, v37
    v_cvt_pk_bf16_f32 v117, v41, v45
    v_cvt_pk_bf16_f32 v118, v49, v53
    v_cvt_pk_bf16_f32 v119, v57, v61
    buffer_store_dwordx4 v[116:119], v120, s[20:23], s25 offen
    s_add_u32 s25, s25, 2736128
    v_cvt_pk_bf16_f32 v112, v34, v38
    v_cvt_pk_bf16_f32 v113, v42, v46
    v_cvt_pk_bf16_f32 v114, v50, v54
    v_cvt_pk_bf16_f32 v115, v58, v62
    buffer_store_dwordx4 v[112:115], v120, s[20:23], s25 offen
    s_add_u32 s25, s25, 2736128
    v_cvt_pk_bf16_f32 v116, v35, v39
    v_cvt_pk_bf16_f32 v117, v43, v47
    v_cvt_pk_bf16_f32 v118, v51, v55
    v_cvt_pk_bf16_f32 v119, v59, v63
    buffer_store_dwordx4 v[116:119], v120, s[20:23], s25 offen
    s_add_u32 s25, s25, 2736128
    ds_read_b128 v[96:99], v121 offset:12288
    ds_read_b128 v[100:103], v121 offset:13312
    ds_read_b128 v[104:107], v121 offset:14336
    ds_read_b128 v[108:111], v121 offset:15360
    s_waitcnt lgkmcnt(3)
    v_mfma_f32_16x16x32_bf16 v[32:35], v[96:99], v[64:67], 0
    v_mfma_f32_16x16x32_bf16 v[36:39], v[96:99], v[68:71], 0
    v_mfma_f32_16x16x32_bf16 v[40:43], v[96:99], v[72:75], 0
    v_mfma_f32_16x16x32_bf16 v[44:47], v[96:99], v[76:79], 0
    v_mfma_f32_16x16x32_bf16 v[48:51], v[96:99], v[80:83], 0
    v_mfma_f32_16x16x32_bf16 v[52:55], v[96:99], v[84:87], 0
    v_mfma_f32_16x16x32_bf16 v[56:59], v[96:99], v[88:91], 0
    v_mfma_f32_16x16x32_bf16 v[60:63], v[96:99], v[92:95], 0
    s_waitcnt lgkmcnt(2)
    v_mfma_f32_16x16x32_bf16 v[32:35], v[100:103], v[64:67], v[32:35]
    v_mfma_f32_16x16x32_bf16 v[36:39], v[100:103], v[68:71], v[36:39]
    v_mfma_f32_16x16x32_bf16 v[40:43], v[100:103], v[72:75], v[40:43]
    v_mfma_f32_16x16x32_bf16 v[44:47], v[100:103], v[76:79], v[44:47]
    v_mfma_f32_16x16x32_bf16 v[48:51], v[100:103], v[80:83], v[48:51]
    v_mfma_f32_16x16x32_bf16 v[52:55], v[100:103], v[84:87], v[52:55]
    v_mfma_f32_16x16x32_bf16 v[56:59], v[100:103], v[88:91], v[56:59]
    v_mfma_f32_16x16x32_bf16 v[60:63], v[100:103], v[92:95], v[60:63]
    s_waitcnt lgkmcnt(1)
    v_mfma_f32_16x16x32_bf16 v[32:35], v[104:107], v[0:3], v[32:35]
    v_mfma_f32_16x16x32_bf16 v[36:39], v[104:107], v[4:7], v[36:39]
    v_mfma_f32_16x16x32_bf16 v[40:43], v[104:107], v[8:11], v[40:43]
    v_mfma_f32_16x16x32_bf16 v[44:47], v[104:107], v[12:15], v[44:47]
    v_mfma_f32_16x16x32_bf16 v[48:51], v[104:107], v[16:19], v[48:51]
    v_mfma_f32_16x16x32_bf16 v[52:55], v[104:107], v[20:23], v[52:55]
    v_mfma_f32_16x16x32_bf16 v[56:59], v[104:107], v[24:27], v[56:59]
    v_mfma_f32_16x16x32_bf16 v[60:63], v[104:107], v[28:31], v[60:63]
    s_waitcnt lgkmcnt(0)
    v_mfma_f32_16x16x32_bf16 v[32:35], v[108:111], v[0:3], v[32:35]
    v_mfma_f32_16x16x32_bf16 v[36:39], v[108:111], v[4:7], v[36:39]
    v_mfma_f32_16x16x32_bf16 v[40:43], v[108:111], v[8:11], v[40:43]
    v_mfma_f32_16x16x32_bf16 v[44:47], v[108:111], v[12:15], v[44:47]
    v_mfma_f32_16x16x32_bf16 v[48:51], v[108:111], v[16:19], v[48:51]
    v_mfma_f32_16x16x32_bf16 v[52:55], v[108:111], v[20:23], v[52:55]
    v_mfma_f32_16x16x32_bf16 v[56:59], v[108:111], v[24:27], v[56:59]
    v_mfma_f32_16x16x32_bf16 v[60:63], v[108:111], v[28:31], v[60:63]
    s_nop 7
    v_cvt_pk_bf16_f32 v112, v32, v36
    v_cvt_pk_bf16_f32 v113, v40, v44
    v_cvt_pk_bf16_f32 v114, v48, v52
    v_cvt_pk_bf16_f32 v115, v56, v60
    buffer_store_dwordx4 v[112:115], v120, s[20:23], s25 offen
    s_add_u32 s25, s25, 2736128
    v_cvt_pk_bf16_f32 v116, v33, v37
    v_cvt_pk_bf16_f32 v117, v41, v45
    v_cvt_pk_bf16_f32 v118, v49, v53
    v_cvt_pk_bf16_f32 v119, v57, v61
    buffer_store_dwordx4 v[116:119], v120, s[20:23], s25 offen
    s_add_u32 s25, s25, 2736128
    v_cvt_pk_bf16_f32 v112, v34, v38
    v_cvt_pk_bf16_f32 v113, v42, v46
    v_cvt_pk_bf16_f32 v114, v50, v54
    v_cvt_pk_bf16_f32 v115, v58, v62
    buffer_store_dwordx4 v[112:115], v120, s[20:23], s25 offen
    s_add_u32 s25, s25, 2736128
    v_cvt_pk_bf16_f32 v116, v35, v39
    v_cvt_pk_bf16_f32 v117, v43, v47
    v_cvt_pk_bf16_f32 v118, v51, v55
    v_cvt_pk_bf16_f32 v119, v59, v63
    buffer_store_dwordx4 v[116:119], v120, s[20:23], s25 offen
    s_endpgm
K1_W:
    s_mov_b32 s16, s6
    s_mov_b32 s17, s7
    s_and_b32 s17, s17, 0xffff
    s_mov_b32 s18, 16252928
    s_mov_b32 s19, 0x00020000
    s_add_u32 s20, s8, 50331648
    s_addc_u32 s21, s9, 0
    s_and_b32 s21, s21, 0xffff
    s_mov_b32 s22, 67108864
    s_mov_b32 s23, 0x00020000
    s_mul_i32 s11, s2, 1
    s_lshr_b32 s12, s11, 9
    s_and_b32 s13, s11, 511
    s_lshl_b32 s14, s12, 19
    s_lshl_b32 s15, s13, 10
    s_add_u32 s14, s14, s15
    s_lshl_b32 s15, s3, 8
    s_add_u32 s14, s14, s15
    v_and_b32 v126, 1, v123
    v_lshlrev_b32 v126, 23, v126
    v_lshl_add_u32 v126, v122, 4, v126
    s_mov_b32 s15, s14
    buffer_load_dwordx4 v[0:3], v126, s[16:19], s15 offen
    s_add_u32 s15, s15, 0x100000
    buffer_load_dwordx4 v[4:7], v126, s[16:19], s15 offen
    s_add_u32 s15, s15, 0x100000
    buffer_load_dwordx4 v[8:11], v126, s[16:19], s15 offen
    s_add_u32 s15, s15, 0x100000
    buffer_load_dwordx4 v[12:15], v126, s[16:19], s15 offen
    s_add_u32 s15, s15, 0x100000
    buffer_load_dwordx4 v[16:19], v126, s[16:19], s15 offen
    s_add_u32 s15, s15, 0x100000
    buffer_load_dwordx4 v[20:23], v126, s[16:19], s15 offen
    s_add_u32 s15, s15, 0x100000
    buffer_load_dwordx4 v[24:27], v126, s[16:19], s15 offen
    s_add_u32 s15, s15, 0x100000
    buffer_load_dwordx4 v[28:31], v126, s[16:19], s15 offen
    v_and_b32 v127, 1, v123
    v_lshlrev_b32 v127, 3, v127
    v_mul_u32_u24 v112, 96, v125
    v_mad_u32_u24 v113, v124, v127, v112
    v_mad_u32_u24 v64, v124, 0, v113
    v_mad_u32_u24 v65, v124, 1, v113
    v_mad_u32_u24 v66, v124, 2, v113
    v_mad_u32_u24 v67, v124, 3, v113
    v_mad_u32_u24 v68, v124, 4, v113
    v_mad_u32_u24 v69, v124, 5, v113
    v_mad_u32_u24 v70, v124, 6, v113
    v_mad_u32_u24 v71, v124, 7, v113
    v_and_b32 v64, 127, v64
    v_and_b32 v65, 127, v65
    v_and_b32 v66, 127, v66
    v_and_b32 v67, 127, v67
    v_and_b32 v68, 127, v68
    v_and_b32 v69, 127, v69
    v_and_b32 v70, 127, v70
    v_and_b32 v71, 127, v71
    v_cvt_f32_u32 v64, v64
    v_cvt_f32_u32 v65, v65
    v_cvt_f32_u32 v66, v66
    v_cvt_f32_u32 v67, v67
    v_cvt_f32_u32 v68, v68
    v_cvt_f32_u32 v69, v69
    v_cvt_f32_u32 v70, v70
    v_cvt_f32_u32 v71, v71
    v_mul_f32 v64, 0x3c000000, v64
    v_mul_f32 v65, 0x3c000000, v65
    v_mul_f32 v66, 0x3c000000, v66
    v_mul_f32 v67, 0x3c000000, v67
    v_mul_f32 v68, 0x3c000000, v68
    v_mul_f32 v69, 0x3c000000, v69
    v_mul_f32 v70, 0x3c000000, v70
    v_mul_f32 v71, 0x3c000000, v71
    v_cos_f32 v64, v64
    v_cos_f32 v65, v65
    v_cos_f32 v66, v66
    v_cos_f32 v67, v67
    v_cos_f32 v68, v68
    v_cos_f32 v69, v69
    v_cos_f32 v70, v70
    v_cos_f32 v71, v71
    s_nop 0
    v_cvt_pk_bf16_f32 v72, v64, v65
    v_cvt_pk_bf16_f32 v73, v66, v67
    v_cvt_pk_bf16_f32 v74, v68, v69
    v_cvt_pk_bf16_f32 v75, v70, v71
    v_lshlrev_b32 v80, 16, v72
    v_and_b32 v81, 0xffff0000, v72
    v_sub_f32 v64, v64, v80
    v_sub_f32 v65, v65, v81
    v_lshlrev_b32 v80, 16, v73
    v_and_b32 v81, 0xffff0000, v73
    v_sub_f32 v66, v66, v80
    v_sub_f32 v67, v67, v81
    v_lshlrev_b32 v80, 16, v74
    v_and_b32 v81, 0xffff0000, v74
    v_sub_f32 v68, v68, v80
    v_sub_f32 v69, v69, v81
    v_lshlrev_b32 v80, 16, v75
    v_and_b32 v81, 0xffff0000, v75
    v_sub_f32 v70, v70, v80
    v_sub_f32 v71, v71, v81
    v_cvt_pk_bf16_f32 v76, v64, v65
    v_cvt_pk_bf16_f32 v77, v66, v67
    v_cvt_pk_bf16_f32 v78, v68, v69
    v_cvt_pk_bf16_f32 v79, v70, v71
    v_cmp_lt_u32 vcc, 1, v123
    s_lshl_b32 s24, s3, 10
    v_add_u32 v114, s24, v121
    v_cndmask_b32 v72, v72, v76, vcc
    v_cndmask_b32 v73, v73, v77, vcc
    v_cndmask_b32 v74, v74, v78, vcc
    v_cndmask_b32 v75, v75, v79, vcc
    ds_write_b128 v114, v[72:75]
    v_lshrrev_b32 v112, 1, v123
    s_mov_b32 s24, 2097152
    v_mul_lo_u32 v112, v112, s24
    v_and_b32 v113, 1, v123
    v_lshl_add_u32 v112, v113, 8, v112
    v_and_b32 v113, 1, v122
    v_lshl_add_u32 v124, v113, 4, v112
    v_lshrrev_b32 v125, 1, v122
    s_mul_i32 s26, s3, 524288
    s_lshl_b32 s24, s11, 9
    s_add_u32 s26, s26, s24
    s_waitcnt lgkmcnt(0)
    s_barrier
    ds_read_b128 v[96:99], v121 offset:0
    ds_read_b128 v[100:103], v121 offset:1024
    ds_read_b128 v[104:107], v121 offset:2048
    ds_read_b128 v[108:111], v121 offset:3072
    s_mov_b32 s27, 0
    s_waitcnt vmcnt(0) lgkmcnt(0)
K1_W_LOOP:
    s_add_u32 s24, s11, s27
    s_and_b32 s30, s24, 3
    s_lshr_b32 s24, s24, 1
    s_and_b32 s24, s24, 4
    s_or_b32 s30, s30, s24
    v_xor_b32 v112, s30, v125
    v_lshl_add_u32 v120, v112, 5, v124
    s_lshl_b32 s25, s27, 9
    s_add_u32 s25, s25, s26
    v_perm_b32 v32, v4, v0, s28
    v_perm_b32 v36, v4, v0, s29
    v_perm_b32 v33, v12, v8, s28
    v_perm_b32 v37, v12, v8, s29
    v_perm_b32 v34, v20, v16, s28
    v_perm_b32 v38, v20, v16, s29
    v_perm_b32 v35, v28, v24, s28
    v_perm_b32 v39, v28, v24, s29
    v_perm_b32 v40, v5, v1, s28
    v_perm_b32 v44, v5, v1, s29
    v_perm_b32 v41, v13, v9, s28
    v_perm_b32 v45, v13, v9, s29
    v_perm_b32 v42, v21, v17, s28
    v_perm_b32 v46, v21, v17, s29
    v_perm_b32 v43, v29, v25, s28
    v_perm_b32 v47, v29, v25, s29
    v_perm_b32 v48, v6, v2, s28
    v_perm_b32 v52, v6, v2, s29
    v_perm_b32 v49, v14, v10, s28
    v_perm_b32 v53, v14, v10, s29
    v_perm_b32 v50, v22, v18, s28
    v_perm_b32 v54, v22, v18, s29
    v_perm_b32 v51, v30, v26, s28
    v_perm_b32 v55, v30, v26, s29
    v_perm_b32 v56, v7, v3, s28
    v_perm_b32 v60, v7, v3, s29
    v_perm_b32 v57, v15, v11, s28
    v_perm_b32 v61, v15, v11, s29
    v_perm_b32 v58, v23, v19, s28
    v_perm_b32 v62, v23, v19, s29
    v_perm_b32 v59, v31, v27, s28
    v_perm_b32 v63, v31, v27, s29
    s_add_u32 s27, s27, 1
    s_add_u32 s14, s14, 1024
    s_cmp_ge_u32 s27, 1
    s_cbranch_scc1 K1_W_NOLOAD
    s_mov_b32 s15, s14
    buffer_load_dwordx4 v[0:3], v126, s[16:19], s15 offen
    s_add_u32 s15, s15, 0x100000
    buffer_load_dwordx4 v[4:7], v126, s[16:19], s15 offen
    s_add_u32 s15, s15, 0x100000
    buffer_load_dwordx4 v[8:11], v126, s[16:19], s15 offen
    s_add_u32 s15, s15, 0x100000
    buffer_load_dwordx4 v[12:15], v126, s[16:19], s15 offen
    s_add_u32 s15, s15, 0x100000
    buffer_load_dwordx4 v[16:19], v126, s[16:19], s15 offen
    s_add_u32 s15, s15, 0x100000
    buffer_load_dwordx4 v[20:23], v126, s[16:19], s15 offen
    s_add_u32 s15, s15, 0x100000
    buffer_load_dwordx4 v[24:27], v126, s[16:19], s15 offen
    s_add_u32 s15, s15, 0x100000
    buffer_load_dwordx4 v[28:31], v126, s[16:19], s15 offen
K1_W_NOLOAD:
    v_mfma_f32_16x16x32_bf16 v[64:67], v[96:99], v[32:35], 0
    v_mfma_f32_16x16x32_bf16 v[68:71], v[96:99], v[36:39], 0
    v_mfma_f32_16x16x32_bf16 v[72:75], v[96:99], v[40:43], 0
    v_mfma_f32_16x16x32_bf16 v[76:79], v[96:99], v[44:47], 0
    v_mfma_f32_16x16x32_bf16 v[80:83], v[96:99], v[48:51], 0
    v_mfma_f32_16x16x32_bf16 v[84:87], v[96:99], v[52:55], 0
    v_mfma_f32_16x16x32_bf16 v[88:91], v[96:99], v[56:59], 0
    v_mfma_f32_16x16x32_bf16 v[92:95], v[96:99], v[60:63], 0
    s_nop 7
    v_cvt_pk_bf16_f32 v112, v64, v68
    v_cvt_pk_bf16_f32 v113, v72, v76
    v_cvt_pk_bf16_f32 v114, v80, v84
    v_cvt_pk_bf16_f32 v115, v88, v92
    buffer_store_dwordx4 v[112:115], v120, s[20:23], s25 offen
    s_add_u32 s25, s25, 4194304
    v_cvt_pk_bf16_f32 v116, v65, v69
    v_cvt_pk_bf16_f32 v117, v73, v77
    v_cvt_pk_bf16_f32 v118, v81, v85
    v_cvt_pk_bf16_f32 v119, v89, v93
    buffer_store_dwordx4 v[116:119], v120, s[20:23], s25 offen
    s_add_u32 s25, s25, 4194304
    v_cvt_pk_bf16_f32 v112, v66, v70
    v_cvt_pk_bf16_f32 v113, v74, v78
    v_cvt_pk_bf16_f32 v114, v82, v86
    v_cvt_pk_bf16_f32 v115, v90, v94
    buffer_store_dwordx4 v[112:115], v120, s[20:23], s25 offen
    s_add_u32 s25, s25, 4194304
    v_cvt_pk_bf16_f32 v116, v67, v71
    v_cvt_pk_bf16_f32 v117, v75, v79
    v_cvt_pk_bf16_f32 v118, v83, v87
    v_cvt_pk_bf16_f32 v119, v91, v95
    buffer_store_dwordx4 v[116:119], v120, s[20:23], s25 offen
    s_add_u32 s25, s25, 4194304
    v_mfma_f32_16x16x32_bf16 v[64:67], v[100:103], v[32:35], 0
    v_mfma_f32_16x16x32_bf16 v[68:71], v[100:103], v[36:39], 0
    v_mfma_f32_16x16x32_bf16 v[72:75], v[100:103], v[40:43], 0
    v_mfma_f32_16x16x32_bf16 v[76:79], v[100:103], v[44:47], 0
    v_mfma_f32_16x16x32_bf16 v[80:83], v[100:103], v[48:51], 0
    v_mfma_f32_16x16x32_bf16 v[84:87], v[100:103], v[52:55], 0
    v_mfma_f32_16x16x32_bf16 v[88:91], v[100:103], v[56:59], 0
    v_mfma_f32_16x16x32_bf16 v[92:95], v[100:103], v[60:63], 0
    s_nop 7
    v_cvt_pk_bf16_f32 v112, v64, v68
    v_cvt_pk_bf16_f32 v113, v72, v76
    v_cvt_pk_bf16_f32 v114, v80, v84
    v_cvt_pk_bf16_f32 v115, v88, v92
    buffer_store_dwordx4 v[112:115], v120, s[20:23], s25 offen
    s_add_u32 s25, s25, 4194304
    v_cvt_pk_bf16_f32 v116, v65, v69
    v_cvt_pk_bf16_f32 v117, v73, v77
    v_cvt_pk_bf16_f32 v118, v81, v85
    v_cvt_pk_bf16_f32 v119, v89, v93
    buffer_store_dwordx4 v[116:119], v120, s[20:23], s25 offen
    s_add_u32 s25, s25, 4194304
    v_cvt_pk_bf16_f32 v112, v66, v70
    v_cvt_pk_bf16_f32 v113, v74, v78
    v_cvt_pk_bf16_f32 v114, v82, v86
    v_cvt_pk_bf16_f32 v115, v90, v94
    buffer_store_dwordx4 v[112:115], v120, s[20:23], s25 offen
    s_add_u32 s25, s25, 4194304
    v_cvt_pk_bf16_f32 v116, v67, v71
    v_cvt_pk_bf16_f32 v117, v75, v79
    v_cvt_pk_bf16_f32 v118, v83, v87
    v_cvt_pk_bf16_f32 v119, v91, v95
    buffer_store_dwordx4 v[116:119], v120, s[20:23], s25 offen
    s_add_u32 s25, s25, 4194304
    v_mfma_f32_16x16x32_bf16 v[64:67], v[104:107], v[32:35], 0
    v_mfma_f32_16x16x32_bf16 v[68:71], v[104:107], v[36:39], 0
    v_mfma_f32_16x16x32_bf16 v[72:75], v[104:107], v[40:43], 0
    v_mfma_f32_16x16x32_bf16 v[76:79], v[104:107], v[44:47], 0
    v_mfma_f32_16x16x32_bf16 v[80:83], v[104:107], v[48:51], 0
    v_mfma_f32_16x16x32_bf16 v[84:87], v[104:107], v[52:55], 0
    v_mfma_f32_16x16x32_bf16 v[88:91], v[104:107], v[56:59], 0
    v_mfma_f32_16x16x32_bf16 v[92:95], v[104:107], v[60:63], 0
    s_nop 7
    v_cvt_pk_bf16_f32 v112, v64, v68
    v_cvt_pk_bf16_f32 v113, v72, v76
    v_cvt_pk_bf16_f32 v114, v80, v84
    v_cvt_pk_bf16_f32 v115, v88, v92
    buffer_store_dwordx4 v[112:115], v120, s[20:23], s25 offen
    s_add_u32 s25, s25, 4194304
    v_cvt_pk_bf16_f32 v116, v65, v69
    v_cvt_pk_bf16_f32 v117, v73, v77
    v_cvt_pk_bf16_f32 v118, v81, v85
    v_cvt_pk_bf16_f32 v119, v89, v93
    buffer_store_dwordx4 v[116:119], v120, s[20:23], s25 offen
    s_add_u32 s25, s25, 4194304
    v_cvt_pk_bf16_f32 v112, v66, v70
    v_cvt_pk_bf16_f32 v113, v74, v78
    v_cvt_pk_bf16_f32 v114, v82, v86
    v_cvt_pk_bf16_f32 v115, v90, v94
    buffer_store_dwordx4 v[112:115], v120, s[20:23], s25 offen
    s_add_u32 s25, s25, 4194304
    v_cvt_pk_bf16_f32 v116, v67, v71
    v_cvt_pk_bf16_f32 v117, v75, v79
    v_cvt_pk_bf16_f32 v118, v83, v87
    v_cvt_pk_bf16_f32 v119, v91, v95
    buffer_store_dwordx4 v[116:119], v120, s[20:23], s25 offen
    s_add_u32 s25, s25, 4194304
    v_mfma_f32_16x16x32_bf16 v[64:67], v[108:111], v[32:35], 0
    v_mfma_f32_16x16x32_bf16 v[68:71], v[108:111], v[36:39], 0
    v_mfma_f32_16x16x32_bf16 v[72:75], v[108:111], v[40:43], 0
    v_mfma_f32_16x16x32_bf16 v[76:79], v[108:111], v[44:47], 0
    v_mfma_f32_16x16x32_bf16 v[80:83], v[108:111], v[48:51], 0
    v_mfma_f32_16x16x32_bf16 v[84:87], v[108:111], v[52:55], 0
    v_mfma_f32_16x16x32_bf16 v[88:91], v[108:111], v[56:59], 0
    v_mfma_f32_16x16x32_bf16 v[92:95], v[108:111], v[60:63], 0
    s_nop 7
    v_cvt_pk_bf16_f32 v112, v64, v68
    v_cvt_pk_bf16_f32 v113, v72, v76
    v_cvt_pk_bf16_f32 v114, v80, v84
    v_cvt_pk_bf16_f32 v115, v88, v92
    buffer_store_dwordx4 v[112:115], v120, s[20:23], s25 offen
    s_add_u32 s25, s25, 4194304
    v_cvt_pk_bf16_f32 v116, v65, v69
    v_cvt_pk_bf16_f32 v117, v73, v77
    v_cvt_pk_bf16_f32 v118, v81, v85
    v_cvt_pk_bf16_f32 v119, v89, v93
    buffer_store_dwordx4 v[116:119], v120, s[20:23], s25 offen
    s_add_u32 s25, s25, 4194304
    v_cvt_pk_bf16_f32 v112, v66, v70
    v_cvt_pk_bf16_f32 v113, v74, v78
    v_cvt_pk_bf16_f32 v114, v82, v86
    v_cvt_pk_bf16_f32 v115, v90, v94
    buffer_store_dwordx4 v[112:115], v120, s[20:23], s25 offen
    s_add_u32 s25, s25, 4194304
    v_cvt_pk_bf16_f32 v116, v67, v71
    v_cvt_pk_bf16_f32 v117, v75, v79
    v_cvt_pk_bf16_f32 v118, v83, v87
    v_cvt_pk_bf16_f32 v119, v91, v95
    buffer_store_dwordx4 v[116:119], v120, s[20:23], s25 offen
    s_waitcnt vmcnt(16)
    s_cmp_lt_u32 s27, 1
    s_cbranch_scc1 K1_W_LOOP
K1_END:
    s_endpgm
.p2align 8
.type k12_fused_kernel,@function
k12_fused_kernel:
    s_cmp_ge_u32 s2, 256
    s_cbranch_scc1 K12_END
    s_load_dwordx4 s[52:55], s[0:1], 0
    s_load_dwordx4 s[56:59], s[0:1], 40
    s_getpc_b64 s[90:91]
CPF_K12:
    s_sub_u32 s90, s90, CPF_K12-k12_fused_kernel
    s_subb_u32 s91, s91, 0
    v_lshlrev_b32 v8, 7, v0
    v_mov_b32 v11, s91
    v_min_u32 v9, TEXT_END-k12_fused_kernel-4, v8
    v_add_co_u32 v10, vcc, s90, v9
    v_addc_co_u32 v11, vcc, 0, v11, vcc
    global_load_dword v63, v[10:11], off
    v_lshrrev_b32 v1, 6, v0
    v_and_b32 v2, 63, v0
    v_readfirstlane_b32 s3, v1
    s_waitcnt lgkmcnt(0)
    s_cmp_lt_u32 s3, 4
    s_cbranch_scc1 K12_CONS
    v_and_b32 v64, 15, v2
    v_lshrrev_b32 v65, 4, v2
    v_lshlrev_b32 v254, 4, v2
    s_and_b32 s44, s3, 3
    s_and_b32 s20, s44, 1
    s_lshr_b32 s21, s44, 1
    s_lshl_b32 s22, s2, 1
    s_add_u32 s22, s22, s21
    s_and_b32 s23, s22, 3
    s_lshr_b32 s22, s22, 2
    s_and_b32 s24, s2, 7
    s_lshl_b32 s24, s24, 5
    s_lshr_b32 s25, s2, 3
    s_add_u32 s24, s24, s25
    s_cmp_ge_u32 s24, 167
    s_cselect_b32 s25, 1, 0
    s_mul_i32 s26, s25, 167
    s_sub_u32 s24, s24, s26
    s_cmp_eq_u32 s21, 0
    s_cselect_b32 s25, s25, 1
    s_mul_i32 s26, s25, 16384000
    s_add_u32 s4, s52, s26
    s_addc_u32 s5, s53, 0
    s_and_b32 s5, s5, 0xffff
    s_mov_b32 s6, 16384000
    s_mov_b32 s7, 0x00020000
    s_mov_b32 s8, s54
    s_mov_b32 s9, s55
    s_and_b32 s9, s9, 0xffff
    s_mov_b32 s10, 16252928
    s_mov_b32 s11, 0x00020000
    s_mov_b32 s12, s58
    s_mov_b32 s13, s59
    s_and_b32 s13, s13, 0xffff
    s_mov_b32 s14, 43778048
    s_mov_b32 s15, 0x00020000
    s_add_u32 s16, s58, 50331648
    s_addc_u32 s17, s59, 0
    s_and_b32 s17, s17, 0xffff
    s_mov_b32 s18, 67108864
    s_mov_b32 s19, 0x00020000
    s_add_u32 s60, s58, 153092096
    s_addc_u32 s61, s59, 0
    s_and_b32 s61, s61, 0xffff
    s_mov_b32 s62, 32768
    s_mov_b32 s63, 0x00020000
    s_mov_b32 s28, 0x05040100
    s_mov_b32 s29, 0x07060302
    v_lshlrev_b32 v248, 14, v65
    v_lshl_add_u32 v248, v64, 4, v248
    v_and_b32 v250, 1, v65
    v_lshlrev_b32 v250, 23, v250
    v_lshl_add_u32 v250, v64, 4, v250
    v_lshrrev_b32 v66, 1, v65
    s_mov_b32 s26, 1368064
    v_mul_lo_u32 v66, v66, s26
    v_lshrrev_b32 v67, 2, v64
    s_mov_b32 s26, 21376
    v_mul_lo_u32 v67, v67, s26
    v_add_u32 v66, v66, v67
    v_mov_b32 v252, v66
    v_lshrrev_b32 v66, 1, v65
    s_mov_b32 s26, 2097152
    v_mul_lo_u32 v66, v66, s26
    v_and_b32 v67, 1, v65
    v_lshl_add_u32 v66, v67, 8, v66
    v_and_b32 v67, 1, v64
    v_lshl_add_u32 v251, v67, 4, v66
    s_mul_i32 s31, s25, 684032
    s_mul_i32 s32, s23, 524288
    s_lshl_b32 s33, s23, 8
    s_mov_b32 s40, 3
    s_xor_b32 s43, s40, s20
    s_and_b32 s43, s43, 1
    s_mul_i32 s36, s40, 85
    s_add_u32 s36, s36, s2
    s_and_b32 s36, s36, 255
    s_mul_hi_u32 s37, s36, 0x55555556
    s_mul_i32 s38, s37, 3
    s_cmp_eq_u32 s38, s36
    s_cselect_b32 s27, 1, 0
    s_cmp_lt_u32 s37, 78
    s_cselect_b32 s27, s27, 0
    s_add_u32 s37, s37, 89
    s_cmp_eq_u32 s21, 0
    s_cselect_b32 s30, s24, s37
    s_cselect_b32 s27, 1, s27
    s_cmp_eq_u32 s43, 0
    s_cbranch_scc0 K12_PL1
    s_lshl_b32 s36, s40, 7
    s_add_u32 s36, s36, s22
    s_lshr_b32 s37, s36, 9
    s_lshl_b32 s37, s37, 19
    s_and_b32 s36, s36, 511
    s_lshl_b32 s36, s36, 10
    s_add_u32 s36, s36, s37
    s_add_u32 s36, s36, s33
    buffer_load_dwordx4 v[96:99], v250, s[8:11], s36 offen
    s_add_u32 s36, s36, 0x100000
    buffer_load_dwordx4 v[100:103], v250, s[8:11], s36 offen
    s_add_u32 s36, s36, 0x100000
    buffer_load_dwordx4 v[104:107], v250, s[8:11], s36 offen
    s_add_u32 s36, s36, 0x100000
    buffer_load_dwordx4 v[108:111], v250, s[8:11], s36 offen
    s_add_u32 s36, s36, 0x100000
    buffer_load_dwordx4 v[112:115], v250, s[8:11], s36 offen
    s_add_u32 s36, s36, 0x100000
    buffer_load_dwordx4 v[116:119], v250, s[8:11], s36 offen
    s_add_u32 s36, s36, 0x100000
    buffer_load_dwordx4 v[120:123], v250, s[8:11], s36 offen
    s_add_u32 s36, s36, 0x100000
    buffer_load_dwordx4 v[124:127], v250, s[8:11], s36 offen
    s_branch K12_PL2
K12_PL1:
    s_cmp_eq_u32 s27, 0
    s_cbranch_scc1 K12_PL2
    s_lshl_b32 s36, s40, 8
    s_mul_i32 s37, s30, 98304
    s_add_u32 s36, s36, s37
    buffer_load_dwordx4 v[0:3], v248, s[4:7], s36 offen
    buffer_load_dwordx4 v[4:7], v248, s[4:7], s36 offen offset:2048
    s_add_u32 s36, s36, 4096
    buffer_load_dwordx4 v[8:11], v248, s[4:7], s36 offen
    buffer_load_dwordx4 v[12:15], v248, s[4:7], s36 offen offset:2048
    s_add_u32 s36, s36, 4096
    buffer_load_dwordx4 v[16:19], v248, s[4:7], s36 offen
    buffer_load_dwordx4 v[20:23], v248, s[4:7], s36 offen offset:2048
    s_add_u32 s36, s36, 4096
    buffer_load_dwordx4 v[24:27], v248, s[4:7], s36 offen
    buffer_load_dwordx4 v[28:31], v248, s[4:7], s36 offen offset:2048
    s_add_u32 s36, s36, 53248
    buffer_load_dwordx4 v[32:35], v248, s[4:7], s36 offen
    buffer_load_dwordx4 v[36:39], v248, s[4:7], s36 offen offset:2048
    s_add_u32 s36, s36, 4096
    buffer_load_dwordx4 v[40:43], v248, s[4:7], s36 offen
    buffer_load_dwordx4 v[44:47], v248, s[4:7], s36 offen offset:2048
    s_add_u32 s36, s36, 4096
    buffer_load_dwordx4 v[48:51], v248, s[4:7], s36 offen
    buffer_load_dwordx4 v[52:55], v248, s[4:7], s36 offen offset:2048
    s_add_u32 s36, s36, 4096
    buffer_load_dwordx4 v[56:59], v248, s[4:7], s36 offen
    buffer_load_dwordx4 v[60:63], v248, s[4:7], s36 offen offset:2048
K12_PL2:
    v_lshrrev_b32 v128, 4, v254
    v_lshlrev_b32 v129, 11, v128
    v_lshrrev_b32 v130, 1, v128
    v_lshlrev_b32 v130, 20, v130
    v_and_b32 v131, 1, v128
    v_lshl_add_u32 v130, v131, 7, v130
    s_mov_b32 s45, s27
    s_mov_b32 s46, s30
    s_add_u32 s47, s40, 1
K12_TCH:
    s_xor_b32 s48, s47, s20
    s_and_b32 s48, s48, 1
    s_cmp_eq_u32 s48, 0
    s_cbranch_scc1 K12_TCHW
    s_mul_i32 s36, s47, 85
    s_add_u32 s36, s36, s2
    s_and_b32 s36, s36, 255
    s_mul_hi_u32 s37, s36, 0x55555556
    s_mul_i32 s38, s37, 3
    s_cmp_eq_u32 s38, s36
    s_cselect_b32 s27, 1, 0
    s_cmp_lt_u32 s37, 78
    s_cselect_b32 s27, s27, 0
    s_add_u32 s37, s37, 89
    s_cmp_eq_u32 s21, 0
    s_cselect_b32 s30, s24, s37
    s_cselect_b32 s27, 1, s27
    s_cmp_eq_u32 s27, 0
    s_cbranch_scc1 K12_TCHN
    s_lshl_b32 s36, s47, 8
    s_mul_i32 s37, s30, 98304
    s_add_u32 s36, s36, s37
    buffer_load_dword v244, v129, s[4:7], s36 offen
    buffer_load_dword v245, v129, s[4:7], s36 offen offset:128
    s_branch K12_TCHN
K12_TCHW:
    s_lshl_b32 s36, s47, 7
    s_add_u32 s36, s36, s22
    s_lshr_b32 s37, s36, 9
    s_lshl_b32 s37, s37, 19
    s_and_b32 s36, s36, 511
    s_lshl_b32 s36, s36, 10
    s_add_u32 s36, s36, s37
    s_add_u32 s36, s36, s33
    s_mov_b64 exec, 0xffffffff
    buffer_load_dword v246, v130, s[8:11], s36 offen
    s_mov_b64 exec, -1
K12_TCHN:
    s_add_u32 s47, s47, 1
    s_cmp_lt_u32 s47, 8
    s_cbranch_scc1 K12_TCH
    s_mov_b32 s27, s45
    s_mov_b32 s30, s46
    v_and_b32 v128, 3, v64
    v_lshlrev_b32 v128, 2, v128
    v_lshrrev_b32 v130, 3, v64
    v_lshl_add_u32 v128, v130, 1, v128
    s_lshl_b32 s36, s44, 4
    s_add_u32 s36, s36, 1
    v_add_u32 v128, s36, v128
    v_bfe_u32 v129, v64, 2, 1
    v_lshlrev_b32 v131, 3, v65
    v_lshlrev_b32 v132, 5, v129
    v_mad_u32_u24 v133, v128, v131, v132
    v_mad_u32_u24 v136, v128, 0, v133
    v_mad_u32_u24 v137, v128, 1, v133
    v_mad_u32_u24 v138, v128, 2, v133
    v_mad_u32_u24 v139, v128, 3, v133
    v_mad_u32_u24 v140, v128, 4, v133
    v_mad_u32_u24 v141, v128, 5, v133
    v_mad_u32_u24 v142, v128, 6, v133
    v_mad_u32_u24 v143, v128, 7, v133
    v_and_b32 v136, 127, v136
    v_and_b32 v137, 127, v137
    v_and_b32 v138, 127, v138
    v_and_b32 v139, 127, v139
    v_and_b32 v140, 127, v140
    v_and_b32 v141, 127, v141
    v_and_b32 v142, 127, v142
    v_and_b32 v143, 127, v143
    v_cvt_f32_u32 v136, v136
    v_cvt_f32_u32 v137, v137
    v_cvt_f32_u32 v138, v138
    v_cvt_f32_u32 v139, v139
    v_cvt_f32_u32 v140, v140
    v_cvt_f32_u32 v141, v141
    v_cvt_f32_u32 v142, v142
    v_cvt_f32_u32 v143, v143
    v_mul_f32 v136, 0x3c000000, v136
    v_mul_f32 v137, 0x3c000000, v137
    v_mul_f32 v138, 0x3c000000, v138
    v_mul_f32 v139, 0x3c000000, v139
    v_mul_f32 v140, 0x3c000000, v140
    v_mul_f32 v141, 0x3c000000, v141
    v_mul_f32 v142, 0x3c000000, v142
    v_mul_f32 v143, 0x3c000000, v143
    v_cos_f32 v136, v136
    v_cos_f32 v137, v137
    v_cos_f32 v138, v138
    v_cos_f32 v139, v139
    v_cos_f32 v140, v140
    v_cos_f32 v141, v141
    v_cos_f32 v142, v142
    v_cos_f32 v143, v143
    s_nop 0
    v_cvt_pk_bf16_f32 v144, v136, v137
    v_cvt_pk_bf16_f32 v145, v138, v139
    v_cvt_pk_bf16_f32 v146, v140, v141
    v_cvt_pk_bf16_f32 v147, v142, v143
    v_lshlrev_b32 v152, 16, v144
    v_and_b32 v153, 0xffff0000, v144
    v_sub_f32 v136, v136, v152
    v_sub_f32 v137, v137, v153
    v_lshlrev_b32 v152, 16, v145
    v_and_b32 v153, 0xffff0000, v145
    v_sub_f32 v138, v138, v152
    v_sub_f32 v139, v139, v153
    v_lshlrev_b32 v152, 16, v146
    v_and_b32 v153, 0xffff0000, v146
    v_sub_f32 v140, v140, v152
    v_sub_f32 v141, v141, v153
    v_lshlrev_b32 v152, 16, v147
    v_and_b32 v153, 0xffff0000, v147
    v_sub_f32 v142, v142, v152
    v_sub_f32 v143, v143, v153
    v_cvt_pk_bf16_f32 v148, v136, v137
    v_cvt_pk_bf16_f32 v149, v138, v139
    v_cvt_pk_bf16_f32 v150, v140, v141
    v_cvt_pk_bf16_f32 v151, v142, v143
    s_lshl_b32 s37, s44, 12
    s_add_u32 s37, s37, 116736
    v_add_u32 v132, s37, v254
    ds_write_b128 v132, v[144:147]
    ds_write_b128 v132, v[148:151] offset:1024
    v_add_u32 v131, 32, v131
    v_lshlrev_b32 v132, 5, v129
    v_mad_u32_u24 v133, v128, v131, v132
    v_mad_u32_u24 v136, v128, 0, v133
    v_mad_u32_u24 v137, v128, 1, v133
    v_mad_u32_u24 v138, v128, 2, v133
    v_mad_u32_u24 v139, v128, 3, v133
    v_mad_u32_u24 v140, v128, 4, v133
    v_mad_u32_u24 v141, v128, 5, v133
    v_mad_u32_u24 v142, v128, 6, v133
    v_mad_u32_u24 v143, v128, 7, v133
    v_and_b32 v136, 127, v136
    v_and_b32 v137, 127, v137
    v_and_b32 v138, 127, v138
    v_and_b32 v139, 127, v139
    v_and_b32 v140, 127, v140
    v_and_b32 v141, 127, v141
    v_and_b32 v142, 127, v142
    v_and_b32 v143, 127, v143
    v_cvt_f32_u32 v136, v136
    v_cvt_f32_u32 v137, v137
    v_cvt_f32_u32 v138, v138
    v_cvt_f32_u32 v139, v139
    v_cvt_f32_u32 v140, v140
    v_cvt_f32_u32 v141, v141
    v_cvt_f32_u32 v142, v142
    v_cvt_f32_u32 v143, v143
    v_mul_f32 v136, 0x3c000000, v136
    v_mul_f32 v137, 0x3c000000, v137
    v_mul_f32 v138, 0x3c000000, v138
    v_mul_f32 v139, 0x3c000000, v139
    v_mul_f32 v140, 0x3c000000, v140
    v_mul_f32 v141, 0x3c000000, v141
    v_mul_f32 v142, 0x3c000000, v142
    v_mul_f32 v143, 0x3c000000, v143
    v_cos_f32 v136, v136
    v_cos_f32 v137, v137
    v_cos_f32 v138, v138
    v_cos_f32 v139, v139
    v_cos_f32 v140, v140
    v_cos_f32 v141, v141
    v_cos_f32 v142, v142
    v_cos_f32 v143, v143
    s_nop 0
    v_cvt_pk_bf16_f32 v144, v136, v137
    v_cvt_pk_bf16_f32 v145, v138, v139
    v_cvt_pk_bf16_f32 v146, v140, v141
    v_cvt_pk_bf16_f32 v147, v142, v143
    v_lshlrev_b32 v152, 16, v144
    v_and_b32 v153, 0xffff0000, v144
    v_sub_f32 v136, v136, v152
    v_sub_f32 v137, v137, v153
    v_lshlrev_b32 v152, 16, v145
    v_and_b32 v153, 0xffff0000, v145
    v_sub_f32 v138, v138, v152
    v_sub_f32 v139, v139, v153
    v_lshlrev_b32 v152, 16, v146
    v_and_b32 v153, 0xffff0000, v146
    v_sub_f32 v140, v140, v152
    v_sub_f32 v141, v141, v153
    v_lshlrev_b32 v152, 16, v147
    v_and_b32 v153, 0xffff0000, v147
    v_sub_f32 v142, v142, v152
    v_sub_f32 v143, v143, v153
    v_cvt_pk_bf16_f32 v148, v136, v137
    v_cvt_pk_bf16_f32 v149, v138, v139
    v_cvt_pk_bf16_f32 v150, v140, v141
    v_cvt_pk_bf16_f32 v151, v142, v143
    s_lshl_b32 s37, s44, 12
    s_add_u32 s37, s37, 118784
    v_add_u32 v132, s37, v254
    ds_write_b128 v132, v[144:147]
    ds_write_b128 v132, v[148:151] offset:1024
K12_TB:
    s_waitcnt lgkmcnt(0)
    s_barrier
    v_add_u32 v255, 116736, v254
    ds_read_b128 v[160:163], v255 offset:0
    ds_read_b128 v[192:195], v255 offset:1024
    ds_read_b128 v[164:167], v255 offset:2048
    ds_read_b128 v[196:199], v255 offset:3072
    ds_read_b128 v[168:171], v255 offset:4096
    ds_read_b128 v[200:203], v255 offset:5120
    ds_read_b128 v[172:175], v255 offset:6144
    ds_read_b128 v[204:207], v255 offset:7168
    s_waitcnt lgkmcnt(0)
    ds_read_b128 v[176:179], v255 offset:8192
    ds_read_b128 v[208:211], v255 offset:9216
    ds_read_b128 v[180:183], v255 offset:10240
    ds_read_b128 v[212:215], v255 offset:11264
    ds_read_b128 v[184:187], v255 offset:12288
    ds_read_b128 v[216:219], v255 offset:13312
    ds_read_b128 v[188:191], v255 offset:14336
    ds_read_b128 v[220:223], v255 offset:15360
    ds_read_b128 v[224:227], v255 offset:16384
    ds_read_b128 v[228:231], v255 offset:17408
    ds_read_b128 v[232:235], v255 offset:18432
    ds_read_b128 v[236:239], v255 offset:19456
    s_waitcnt lgkmcnt(0)
    s_barrier
    s_waitcnt vmcnt(0) lgkmcnt(0)
    s_mov_b32 s41, -1
    s_mov_b32 s34, -1
    s_branch K12_PROD
    s_cmp_lt_u32 s3, 4
    s_cbranch_scc0 K12_PROD
    s_cmp_eq_u32 s43, 0
    s_cbranch_scc0 K12_H1
    v_perm_b32 v64, v100, v96, s28
    v_perm_b32 v68, v100, v96, s29
    v_perm_b32 v65, v108, v104, s28
    v_perm_b32 v69, v108, v104, s29
    v_perm_b32 v66, v116, v112, s28
    v_perm_b32 v70, v116, v112, s29
    v_perm_b32 v67, v124, v120, s28
    v_perm_b32 v71, v124, v120, s29
    v_perm_b32 v72, v101, v97, s28
    v_perm_b32 v76, v101, v97, s29
    v_perm_b32 v73, v109, v105, s28
    v_perm_b32 v77, v109, v105, s29
    v_perm_b32 v74, v117, v113, s28
    v_perm_b32 v78, v117, v113, s29
    v_perm_b32 v75, v125, v121, s28
    v_perm_b32 v79, v125, v121, s29
    v_perm_b32 v80, v102, v98, s28
    v_perm_b32 v84, v102, v98, s29
    v_perm_b32 v81, v110, v106, s28
    v_perm_b32 v85, v110, v106, s29
    v_perm_b32 v82, v118, v114, s28
    v_perm_b32 v86, v118, v114, s29
    v_perm_b32 v83, v126, v122, s28
    v_perm_b32 v87, v126, v122, s29
    v_perm_b32 v88, v103, v99, s28
    v_perm_b32 v92, v103, v99, s29
    v_perm_b32 v89, v111, v107, s28
    v_perm_b32 v93, v111, v107, s29
    v_perm_b32 v90, v119, v115, s28
    v_perm_b32 v94, v119, v115, s29
    v_perm_b32 v91, v127, v123, s28
    v_perm_b32 v95, v127, v123, s29
    s_lshl_b32 s36, s40, 7
    s_add_u32 s36, s36, s22
    s_and_b32 s37, s36, 3
    s_lshr_b32 s38, s36, 1
    s_and_b32 s38, s38, 4
    s_or_b32 s37, s37, s38
    v_bfe_u32 v253, v254, 5, 3
    v_xor_b32 v253, s37, v253
    v_lshl_add_u32 v253, v253, 5, v251
    s_lshl_b32 s36, s36, 9
    s_add_u32 s39, s36, s32
    v_mfma_f32_16x16x32_bf16 v[128:131], v[224:227], v[64:67], 0
    v_mfma_f32_16x16x32_bf16 v[132:135], v[224:227], v[68:71], 0
    v_mfma_f32_16x16x32_bf16 v[136:139], v[224:227], v[72:75], 0
    v_mfma_f32_16x16x32_bf16 v[140:143], v[224:227], v[76:79], 0
    v_mfma_f32_16x16x32_bf16 v[144:147], v[224:227], v[80:83], 0
    v_mfma_f32_16x16x32_bf16 v[148:151], v[224:227], v[84:87], 0
    v_mfma_f32_16x16x32_bf16 v[152:155], v[224:227], v[88:91], 0
    v_mfma_f32_16x16x32_bf16 v[156:159], v[224:227], v[92:95], 0
    s_nop 7
    v_cvt_pk_bf16_f32 v240, v128, v132
    v_cvt_pk_bf16_f32 v241, v136, v140
    v_cvt_pk_bf16_f32 v242, v144, v148
    v_cvt_pk_bf16_f32 v243, v152, v156
    buffer_store_dwordx4 v[240:243], v253, s[16:19], s39 offen sc1
    s_add_u32 s39, s39, 4194304
    v_cvt_pk_bf16_f32 v244, v129, v133
    v_cvt_pk_bf16_f32 v245, v137, v141
    v_cvt_pk_bf16_f32 v246, v145, v149
    v_cvt_pk_bf16_f32 v247, v153, v157
    buffer_store_dwordx4 v[244:247], v253, s[16:19], s39 offen sc1
    s_add_u32 s39, s39, 4194304
    v_cvt_pk_bf16_f32 v240, v130, v134
    v_cvt_pk_bf16_f32 v241, v138, v142
    v_cvt_pk_bf16_f32 v242, v146, v150
    v_cvt_pk_bf16_f32 v243, v154, v158
    buffer_store_dwordx4 v[240:243], v253, s[16:19], s39 offen sc1
    s_add_u32 s39, s39, 4194304
    v_cvt_pk_bf16_f32 v244, v131, v135
    v_cvt_pk_bf16_f32 v245, v139, v143
    v_cvt_pk_bf16_f32 v246, v147, v151
    v_cvt_pk_bf16_f32 v247, v155, v159
    buffer_store_dwordx4 v[244:247], v253, s[16:19], s39 offen sc1
    s_add_u32 s39, s39, 4194304
    v_mfma_f32_16x16x32_bf16 v[128:131], v[228:231], v[64:67], 0
    v_mfma_f32_16x16x32_bf16 v[132:135], v[228:231], v[68:71], 0
    v_mfma_f32_16x16x32_bf16 v[136:139], v[228:231], v[72:75], 0
    v_mfma_f32_16x16x32_bf16 v[140:143], v[228:231], v[76:79], 0
    v_mfma_f32_16x16x32_bf16 v[144:147], v[228:231], v[80:83], 0
    v_mfma_f32_16x16x32_bf16 v[148:151], v[228:231], v[84:87], 0
    v_mfma_f32_16x16x32_bf16 v[152:155], v[228:231], v[88:91], 0
    v_mfma_f32_16x16x32_bf16 v[156:159], v[228:231], v[92:95], 0
    s_nop 7
    v_cvt_pk_bf16_f32 v240, v128, v132
    v_cvt_pk_bf16_f32 v241, v136, v140
    v_cvt_pk_bf16_f32 v242, v144, v148
    v_cvt_pk_bf16_f32 v243, v152, v156
    buffer_store_dwordx4 v[240:243], v253, s[16:19], s39 offen sc1
    s_add_u32 s39, s39, 4194304
    v_cvt_pk_bf16_f32 v244, v129, v133
    v_cvt_pk_bf16_f32 v245, v137, v141
    v_cvt_pk_bf16_f32 v246, v145, v149
    v_cvt_pk_bf16_f32 v247, v153, v157
    buffer_store_dwordx4 v[244:247], v253, s[16:19], s39 offen sc1
    s_add_u32 s39, s39, 4194304
    v_cvt_pk_bf16_f32 v240, v130, v134
    v_cvt_pk_bf16_f32 v241, v138, v142
    v_cvt_pk_bf16_f32 v242, v146, v150
    v_cvt_pk_bf16_f32 v243, v154, v158
    buffer_store_dwordx4 v[240:243], v253, s[16:19], s39 offen sc1
    s_add_u32 s39, s39, 4194304
    v_cvt_pk_bf16_f32 v244, v131, v135
    v_cvt_pk_bf16_f32 v245, v139, v143
    v_cvt_pk_bf16_f32 v246, v147, v151
    v_cvt_pk_bf16_f32 v247, v155, v159
    buffer_store_dwordx4 v[244:247], v253, s[16:19], s39 offen sc1
    s_add_u32 s39, s39, 4194304
    v_mfma_f32_16x16x32_bf16 v[128:131], v[232:235], v[64:67], 0
    v_mfma_f32_16x16x32_bf16 v[132:135], v[232:235], v[68:71], 0
    v_mfma_f32_16x16x32_bf16 v[136:139], v[232:235], v[72:75], 0
    v_mfma_f32_16x16x32_bf16 v[140:143], v[232:235], v[76:79], 0
    v_mfma_f32_16x16x32_bf16 v[144:147], v[232:235], v[80:83], 0
    v_mfma_f32_16x16x32_bf16 v[148:151], v[232:235], v[84:87], 0
    v_mfma_f32_16x16x32_bf16 v[152:155], v[232:235], v[88:91], 0
    v_mfma_f32_16x16x32_bf16 v[156:159], v[232:235], v[92:95], 0
    s_nop 7
    v_cvt_pk_bf16_f32 v240, v128, v132
    v_cvt_pk_bf16_f32 v241, v136, v140
    v_cvt_pk_bf16_f32 v242, v144, v148
    v_cvt_pk_bf16_f32 v243, v152, v156
    buffer_store_dwordx4 v[240:243], v253, s[16:19], s39 offen sc1
    s_add_u32 s39, s39, 4194304
    v_cvt_pk_bf16_f32 v244, v129, v133
    v_cvt_pk_bf16_f32 v245, v137, v141
    v_cvt_pk_bf16_f32 v246, v145, v149
    v_cvt_pk_bf16_f32 v247, v153, v157
    buffer_store_dwordx4 v[244:247], v253, s[16:19], s39 offen sc1
    s_add_u32 s39, s39, 4194304
    v_cvt_pk_bf16_f32 v240, v130, v134
    v_cvt_pk_bf16_f32 v241, v138, v142
    v_cvt_pk_bf16_f32 v242, v146, v150
    v_cvt_pk_bf16_f32 v243, v154, v158
    buffer_store_dwordx4 v[240:243], v253, s[16:19], s39 offen sc1
    s_add_u32 s39, s39, 4194304
    v_cvt_pk_bf16_f32 v244, v131, v135
    v_cvt_pk_bf16_f32 v245, v139, v143
    v_cvt_pk_bf16_f32 v246, v147, v151
    v_cvt_pk_bf16_f32 v247, v155, v159
    buffer_store_dwordx4 v[244:247], v253, s[16:19], s39 offen sc1
    s_add_u32 s39, s39, 4194304
    v_mfma_f32_16x16x32_bf16 v[128:131], v[236:239], v[64:67], 0
    v_mfma_f32_16x16x32_bf16 v[132:135], v[236:239], v[68:71], 0
    v_mfma_f32_16x16x32_bf16 v[136:139], v[236:239], v[72:75], 0
    v_mfma_f32_16x16x32_bf16 v[140:143], v[236:239], v[76:79], 0
    v_mfma_f32_16x16x32_bf16 v[144:147], v[236:239], v[80:83], 0
    v_mfma_f32_16x16x32_bf16 v[148:151], v[236:239], v[84:87], 0
    v_mfma_f32_16x16x32_bf16 v[152:155], v[236:239], v[88:91], 0
    v_mfma_f32_16x16x32_bf16 v[156:159], v[236:239], v[92:95], 0
    s_nop 7
    v_cvt_pk_bf16_f32 v240, v128, v132
    v_cvt_pk_bf16_f32 v241, v136, v140
    v_cvt_pk_bf16_f32 v242, v144, v148
    v_cvt_pk_bf16_f32 v243, v152, v156
    buffer_store_dwordx4 v[240:243], v253, s[16:19], s39 offen sc1
    s_add_u32 s39, s39, 4194304
    v_cvt_pk_bf16_f32 v244, v129, v133
    v_cvt_pk_bf16_f32 v245, v137, v141
    v_cvt_pk_bf16_f32 v246, v145, v149
    v_cvt_pk_bf16_f32 v247, v153, v157
    buffer_store_dwordx4 v[244:247], v253, s[16:19], s39 offen sc1
    s_add_u32 s39, s39, 4194304
    v_cvt_pk_bf16_f32 v240, v130, v134
    v_cvt_pk_bf16_f32 v241, v138, v142
    v_cvt_pk_bf16_f32 v242, v146, v150
    v_cvt_pk_bf16_f32 v243, v154, v158
    buffer_store_dwordx4 v[240:243], v253, s[16:19], s39 offen sc1
    s_add_u32 s39, s39, 4194304
    v_cvt_pk_bf16_f32 v244, v131, v135
    v_cvt_pk_bf16_f32 v245, v139, v143
    v_cvt_pk_bf16_f32 v246, v147, v151
    v_cvt_pk_bf16_f32 v247, v155, v159
    buffer_store_dwordx4 v[244:247], v253, s[16:19], s39 offen sc1
    s_branch K12_H2
K12_H1:
    s_cmp_eq_u32 s27, 0
    s_cbranch_scc1 K12_H2
    v_perm_b32 v64, v4, v0, s28
    v_perm_b32 v68, v4, v0, s29
    v_perm_b32 v65, v12, v8, s28
    v_perm_b32 v69, v12, v8, s29
    v_perm_b32 v66, v20, v16, s28
    v_perm_b32 v70, v20, v16, s29
    v_perm_b32 v67, v28, v24, s28
    v_perm_b32 v71, v28, v24, s29
    v_perm_b32 v72, v5, v1, s28
    v_perm_b32 v76, v5, v1, s29
    v_perm_b32 v73, v13, v9, s28
    v_perm_b32 v77, v13, v9, s29
    v_perm_b32 v74, v21, v17, s28
    v_perm_b32 v78, v21, v17, s29
    v_perm_b32 v75, v29, v25, s28
    v_perm_b32 v79, v29, v25, s29
    v_perm_b32 v80, v6, v2, s28
    v_perm_b32 v84, v6, v2, s29
    v_perm_b32 v81, v14, v10, s28
    v_perm_b32 v85, v14, v10, s29
    v_perm_b32 v82, v22, v18, s28
    v_perm_b32 v86, v22, v18, s29
    v_perm_b32 v83, v30, v26, s28
    v_perm_b32 v87, v30, v26, s29
    v_perm_b32 v88, v7, v3, s28
    v_perm_b32 v92, v7, v3, s29
    v_perm_b32 v89, v15, v11, s28
    v_perm_b32 v93, v15, v11, s29
    v_perm_b32 v90, v23, v19, s28
    v_perm_b32 v94, v23, v19, s29
    v_perm_b32 v91, v31, v27, s28
    v_perm_b32 v95, v31, v27, s29
    v_perm_b32 v0, v36, v32, s28
    v_perm_b32 v4, v36, v32, s29
    v_perm_b32 v1, v44, v40, s28
    v_perm_b32 v5, v44, v40, s29
    v_perm_b32 v2, v52, v48, s28
    v_perm_b32 v6, v52, v48, s29
    v_perm_b32 v3, v60, v56, s28
    v_perm_b32 v7, v60, v56, s29
    v_perm_b32 v8, v37, v33, s28
    v_perm_b32 v12, v37, v33, s29
    v_perm_b32 v9, v45, v41, s28
    v_perm_b32 v13, v45, v41, s29
    v_perm_b32 v10, v53, v49, s28
    v_perm_b32 v14, v53, v49, s29
    v_perm_b32 v11, v61, v57, s28
    v_perm_b32 v15, v61, v57, s29
    v_perm_b32 v16, v38, v34, s28
    v_perm_b32 v20, v38, v34, s29
    v_perm_b32 v17, v46, v42, s28
    v_perm_b32 v21, v46, v42, s29
    v_perm_b32 v18, v54, v50, s28
    v_perm_b32 v22, v54, v50, s29
    v_perm_b32 v19, v62, v58, s28
    v_perm_b32 v23, v62, v58, s29
    v_perm_b32 v24, v39, v35, s28
    v_perm_b32 v28, v39, v35, s29
    v_perm_b32 v25, v47, v43, s28
    v_perm_b32 v29, v47, v43, s29
    v_perm_b32 v26, v55, v51, s28
    v_perm_b32 v30, v55, v51, s29
    v_perm_b32 v27, v63, v59, s28
    v_perm_b32 v31, v63, v59, s29
    s_mul_i32 s39, s40, 85504
    s_add_u32 s39, s39, s31
    s_lshl_b32 s36, s30, 7
    s_add_u32 s39, s39, s36
    v_bfe_u32 v249, v254, 4, 2
    v_bfe_u32 v240, v254, 8, 1
    v_lshl_add_u32 v249, v240, 2, v249
    s_add_u32 s36, s30, 7
    s_cmp_ge_u32 s30, 160
    s_cselect_b32 s36, s36, s30
    s_cmp_eq_u32 s25, 1
    s_cselect_b32 s36, s36, s30
    s_lshr_b32 s36, s36, 1
    s_and_b32 s36, s36, 7
    v_xor_b32 v249, s36, v249
    v_lshl_add_u32 v249, v249, 4, v252
    v_mfma_f32_16x16x32_bf16 v[32:35], v[160:163], v[64:67], 0
    v_mfma_f32_16x16x32_bf16 v[36:39], v[160:163], v[68:71], 0
    v_mfma_f32_16x16x32_bf16 v[40:43], v[160:163], v[72:75], 0
    v_mfma_f32_16x16x32_bf16 v[44:47], v[160:163], v[76:79], 0
    v_mfma_f32_16x16x32_bf16 v[48:51], v[160:163], v[80:83], 0
    v_mfma_f32_16x16x32_bf16 v[52:55], v[160:163], v[84:87], 0
    v_mfma_f32_16x16x32_bf16 v[56:59], v[160:163], v[88:91], 0
    v_mfma_f32_16x16x32_bf16 v[60:63], v[160:163], v[92:95], 0
    v_mfma_f32_16x16x32_bf16 v[32:35], v[164:167], v[0:3], v[32:35]
    v_mfma_f32_16x16x32_bf16 v[36:39], v[164:167], v[4:7], v[36:39]
    v_mfma_f32_16x16x32_bf16 v[40:43], v[164:167], v[8:11], v[40:43]
    v_mfma_f32_16x16x32_bf16 v[44:47], v[164:167], v[12:15], v[44:47]
    v_mfma_f32_16x16x32_bf16 v[48:51], v[164:167], v[16:19], v[48:51]
    v_mfma_f32_16x16x32_bf16 v[52:55], v[164:167], v[20:23], v[52:55]
    v_mfma_f32_16x16x32_bf16 v[56:59], v[164:167], v[24:27], v[56:59]
    v_mfma_f32_16x16x32_bf16 v[60:63], v[164:167], v[28:31], v[60:63]
    s_nop 7
    v_cvt_pk_bf16_f32 v240, v32, v36
    v_cvt_pk_bf16_f32 v241, v40, v44
    v_cvt_pk_bf16_f32 v242, v48, v52
    v_cvt_pk_bf16_f32 v243, v56, v60
    buffer_store_dwordx4 v[240:243], v249, s[12:15], s39 offen sc1
    s_add_u32 s39, s39, 2736128
    v_cvt_pk_bf16_f32 v244, v33, v37
    v_cvt_pk_bf16_f32 v245, v41, v45
    v_cvt_pk_bf16_f32 v246, v49, v53
    v_cvt_pk_bf16_f32 v247, v57, v61
    buffer_store_dwordx4 v[244:247], v249, s[12:15], s39 offen sc1
    s_add_u32 s39, s39, 2736128
    v_cvt_pk_bf16_f32 v240, v34, v38
    v_cvt_pk_bf16_f32 v241, v42, v46
    v_cvt_pk_bf16_f32 v242, v50, v54
    v_cvt_pk_bf16_f32 v243, v58, v62
    buffer_store_dwordx4 v[240:243], v249, s[12:15], s39 offen sc1
    s_add_u32 s39, s39, 2736128
    v_cvt_pk_bf16_f32 v244, v35, v39
    v_cvt_pk_bf16_f32 v245, v43, v47
    v_cvt_pk_bf16_f32 v246, v51, v55
    v_cvt_pk_bf16_f32 v247, v59, v63
    buffer_store_dwordx4 v[244:247], v249, s[12:15], s39 offen sc1
    s_add_u32 s39, s39, 2736128
    v_mfma_f32_16x16x32_bf16 v[32:35], v[168:171], v[64:67], 0
    v_mfma_f32_16x16x32_bf16 v[36:39], v[168:171], v[68:71], 0
    v_mfma_f32_16x16x32_bf16 v[40:43], v[168:171], v[72:75], 0
    v_mfma_f32_16x16x32_bf16 v[44:47], v[168:171], v[76:79], 0
    v_mfma_f32_16x16x32_bf16 v[48:51], v[168:171], v[80:83], 0
    v_mfma_f32_16x16x32_bf16 v[52:55], v[168:171], v[84:87], 0
    v_mfma_f32_16x16x32_bf16 v[56:59], v[168:171], v[88:91], 0
    v_mfma_f32_16x16x32_bf16 v[60:63], v[168:171], v[92:95], 0
    v_mfma_f32_16x16x32_bf16 v[32:35], v[172:175], v[0:3], v[32:35]
    v_mfma_f32_16x16x32_bf16 v[36:39], v[172:175], v[4:7], v[36:39]
    v_mfma_f32_16x16x32_bf16 v[40:43], v[172:175], v[8:11], v[40:43]
    v_mfma_f32_16x16x32_bf16 v[44:47], v[172:175], v[12:15], v[44:47]
    v_mfma_f32_16x16x32_bf16 v[48:51], v[172:175], v[16:19], v[48:51]
    v_mfma_f32_16x16x32_bf16 v[52:55], v[172:175], v[20:23], v[52:55]
    v_mfma_f32_16x16x32_bf16 v[56:59], v[172:175], v[24:27], v[56:59]
    v_mfma_f32_16x16x32_bf16 v[60:63], v[172:175], v[28:31], v[60:63]
    s_nop 7
    v_cvt_pk_bf16_f32 v240, v32, v36
    v_cvt_pk_bf16_f32 v241, v40, v44
    v_cvt_pk_bf16_f32 v242, v48, v52
    v_cvt_pk_bf16_f32 v243, v56, v60
    buffer_store_dwordx4 v[240:243], v249, s[12:15], s39 offen sc1
    s_add_u32 s39, s39, 2736128
    v_cvt_pk_bf16_f32 v244, v33, v37
    v_cvt_pk_bf16_f32 v245, v41, v45
    v_cvt_pk_bf16_f32 v246, v49, v53
    v_cvt_pk_bf16_f32 v247, v57, v61
    buffer_store_dwordx4 v[244:247], v249, s[12:15], s39 offen sc1
    s_add_u32 s39, s39, 2736128
    v_cvt_pk_bf16_f32 v240, v34, v38
    v_cvt_pk_bf16_f32 v241, v42, v46
    v_cvt_pk_bf16_f32 v242, v50, v54
    v_cvt_pk_bf16_f32 v243, v58, v62
    buffer_store_dwordx4 v[240:243], v249, s[12:15], s39 offen sc1
    s_add_u32 s39, s39, 2736128
    v_cvt_pk_bf16_f32 v244, v35, v39
    v_cvt_pk_bf16_f32 v245, v43, v47
    v_cvt_pk_bf16_f32 v246, v51, v55
    v_cvt_pk_bf16_f32 v247, v59, v63
    buffer_store_dwordx4 v[244:247], v249, s[12:15], s39 offen sc1
    s_add_u32 s39, s39, 2736128
    v_mfma_f32_16x16x32_bf16 v[32:35], v[176:179], v[64:67], 0
    v_mfma_f32_16x16x32_bf16 v[36:39], v[176:179], v[68:71], 0
    v_mfma_f32_16x16x32_bf16 v[40:43], v[176:179], v[72:75], 0
    v_mfma_f32_16x16x32_bf16 v[44:47], v[176:179], v[76:79], 0
    v_mfma_f32_16x16x32_bf16 v[48:51], v[176:179], v[80:83], 0
    v_mfma_f32_16x16x32_bf16 v[52:55], v[176:179], v[84:87], 0
    v_mfma_f32_16x16x32_bf16 v[56:59], v[176:179], v[88:91], 0
    v_mfma_f32_16x16x32_bf16 v[60:63], v[176:179], v[92:95], 0
    v_mfma_f32_16x16x32_bf16 v[32:35], v[180:183], v[0:3], v[32:35]
    v_mfma_f32_16x16x32_bf16 v[36:39], v[180:183], v[4:7], v[36:39]
    v_mfma_f32_16x16x32_bf16 v[40:43], v[180:183], v[8:11], v[40:43]
    v_mfma_f32_16x16x32_bf16 v[44:47], v[180:183], v[12:15], v[44:47]
    v_mfma_f32_16x16x32_bf16 v[48:51], v[180:183], v[16:19], v[48:51]
    v_mfma_f32_16x16x32_bf16 v[52:55], v[180:183], v[20:23], v[52:55]
    v_mfma_f32_16x16x32_bf16 v[56:59], v[180:183], v[24:27], v[56:59]
    v_mfma_f32_16x16x32_bf16 v[60:63], v[180:183], v[28:31], v[60:63]
    s_nop 7
    v_cvt_pk_bf16_f32 v240, v32, v36
    v_cvt_pk_bf16_f32 v241, v40, v44
    v_cvt_pk_bf16_f32 v242, v48, v52
    v_cvt_pk_bf16_f32 v243, v56, v60
    buffer_store_dwordx4 v[240:243], v249, s[12:15], s39 offen sc1
    s_add_u32 s39, s39, 2736128
    v_cvt_pk_bf16_f32 v244, v33, v37
    v_cvt_pk_bf16_f32 v245, v41, v45
    v_cvt_pk_bf16_f32 v246, v49, v53
    v_cvt_pk_bf16_f32 v247, v57, v61
    buffer_store_dwordx4 v[244:247], v249, s[12:15], s39 offen sc1
    s_add_u32 s39, s39, 2736128
    v_cvt_pk_bf16_f32 v240, v34, v38
    v_cvt_pk_bf16_f32 v241, v42, v46
    v_cvt_pk_bf16_f32 v242, v50, v54
    v_cvt_pk_bf16_f32 v243, v58, v62
    buffer_store_dwordx4 v[240:243], v249, s[12:15], s39 offen sc1
    s_add_u32 s39, s39, 2736128
    v_cvt_pk_bf16_f32 v244, v35, v39
    v_cvt_pk_bf16_f32 v245, v43, v47
    v_cvt_pk_bf16_f32 v246, v51, v55
    v_cvt_pk_bf16_f32 v247, v59, v63
    buffer_store_dwordx4 v[244:247], v249, s[12:15], s39 offen sc1
    s_add_u32 s39, s39, 2736128
    v_mfma_f32_16x16x32_bf16 v[32:35], v[184:187], v[64:67], 0
    v_mfma_f32_16x16x32_bf16 v[36:39], v[184:187], v[68:71], 0
    v_mfma_f32_16x16x32_bf16 v[40:43], v[184:187], v[72:75], 0
    v_mfma_f32_16x16x32_bf16 v[44:47], v[184:187], v[76:79], 0
    v_mfma_f32_16x16x32_bf16 v[48:51], v[184:187], v[80:83], 0
    v_mfma_f32_16x16x32_bf16 v[52:55], v[184:187], v[84:87], 0
    v_mfma_f32_16x16x32_bf16 v[56:59], v[184:187], v[88:91], 0
    v_mfma_f32_16x16x32_bf16 v[60:63], v[184:187], v[92:95], 0
    v_mfma_f32_16x16x32_bf16 v[32:35], v[188:191], v[0:3], v[32:35]
    v_mfma_f32_16x16x32_bf16 v[36:39], v[188:191], v[4:7], v[36:39]
    v_mfma_f32_16x16x32_bf16 v[40:43], v[188:191], v[8:11], v[40:43]
    v_mfma_f32_16x16x32_bf16 v[44:47], v[188:191], v[12:15], v[44:47]
    v_mfma_f32_16x16x32_bf16 v[48:51], v[188:191], v[16:19], v[48:51]
    v_mfma_f32_16x16x32_bf16 v[52:55], v[188:191], v[20:23], v[52:55]
    v_mfma_f32_16x16x32_bf16 v[56:59], v[188:191], v[24:27], v[56:59]
    v_mfma_f32_16x16x32_bf16 v[60:63], v[188:191], v[28:31], v[60:63]
    s_nop 7
    v_cvt_pk_bf16_f32 v240, v32, v36
    v_cvt_pk_bf16_f32 v241, v40, v44
    v_cvt_pk_bf16_f32 v242, v48, v52
    v_cvt_pk_bf16_f32 v243, v56, v60
    buffer_store_dwordx4 v[240:243], v249, s[12:15], s39 offen sc1
    s_add_u32 s39, s39, 2736128
    v_cvt_pk_bf16_f32 v244, v33, v37
    v_cvt_pk_bf16_f32 v245, v41, v45
    v_cvt_pk_bf16_f32 v246, v49, v53
    v_cvt_pk_bf16_f32 v247, v57, v61
    buffer_store_dwordx4 v[244:247], v249, s[12:15], s39 offen sc1
    s_add_u32 s39, s39, 2736128
    v_cvt_pk_bf16_f32 v240, v34, v38
    v_cvt_pk_bf16_f32 v241, v42, v46
    v_cvt_pk_bf16_f32 v242, v50, v54
    v_cvt_pk_bf16_f32 v243, v58, v62
    buffer_store_dwordx4 v[240:243], v249, s[12:15], s39 offen sc1
    s_add_u32 s39, s39, 2736128
    v_cvt_pk_bf16_f32 v244, v35, v39
    v_cvt_pk_bf16_f32 v245, v43, v47
    v_cvt_pk_bf16_f32 v246, v51, v55
    v_cvt_pk_bf16_f32 v247, v59, v63
    buffer_store_dwordx4 v[244:247], v249, s[12:15], s39 offen sc1
K12_H2:
    s_mov_b64 exec, 1
    v_mov_b32 v255, 155664
    v_mov_b32 v64, 1
    ds_add_u32 v255, v64
    s_mov_b64 exec, -1
    s_waitcnt vmcnt(0)
    s_mov_b32 s41, 0
    s_mov_b32 s34, -1
    s_cmp_ge_u32 s41, 8
    s_cbranch_scc1 K12_SG0
    s_lshl_b32 s36, s41, 2
    s_add_u32 s37, s36, 155680
    s_mov_b64 exec, 1
    v_mov_b32 v255, s37
    v_mov_b32 v240, 1
    ds_add_rtn_u32 v240, v255, v240
    s_waitcnt lgkmcnt(0)
    v_readfirstlane_b32 s37, v240
    s_nop 3
    s_cmp_eq_u32 s37, 3
    s_cbranch_scc0 K12_SH0
    s_lshl_b32 s36, s36, 8
    v_mov_b32 v255, 1
    v_mov_b32 v240, s36
    buffer_atomic_add v255, v240, s[60:63], 0 offen sc0 sc1
    s_mov_b32 s34, s41
K12_SH0:
    s_mov_b64 exec, -1
K12_SG0:
    s_waitcnt vmcnt(0)
    s_cmp_ge_u32 s34, 8
    s_cbranch_scc1 K12_PB1
    v_readfirstlane_b32 s37, v255
    s_nop 3
    s_cmp_eq_u32 s37, 255
    s_cbranch_scc0 K12_PB1
    s_lshl_b32 s36, s34, 4
    s_add_u32 s36, s36, 16384
    s_mov_b64 exec, 1
    v_mov_b32 v255, 1
    v_mov_b32 v240, s36
    buffer_store_dword v255, v240, s[60:63], 0 offen sc1
    s_mov_b64 exec, -1
K12_PB1:
    s_branch K12_CONS
K12_PROD:
    s_setprio 1
    s_cmp_eq_u32 s43, 0
    s_cbranch_scc1 K12_WENTRY
K12_XW:
    s_waitcnt vmcnt(0)
    s_mov_b32 s34, -1
    s_cmp_ge_u32 s41, 8
    s_cbranch_scc1 K12_SG2
    s_lshl_b32 s36, s41, 2
    s_add_u32 s37, s36, 155680
    s_mov_b64 exec, 1
    v_mov_b32 v255, s37
    v_mov_b32 v240, 1
    ds_add_rtn_u32 v240, v255, v240
    s_waitcnt lgkmcnt(0)
    v_readfirstlane_b32 s37, v240
    s_nop 3
    s_cmp_eq_u32 s37, 3
    s_cbranch_scc0 K12_SH2
    s_lshl_b32 s36, s36, 8
    v_mov_b32 v255, 1
    v_mov_b32 v240, s36
    buffer_atomic_add v255, v240, s[60:63], 0 offen sc0 sc1
    s_mov_b32 s34, s41
K12_SH2:
    s_mov_b64 exec, -1
K12_SG2:
    s_cmp_ge_u32 s34, 8
    s_cbranch_scc1 K12_EP3
    s_waitcnt vmcnt(0)
    s_cmp_ge_u32 s34, 8
    s_cbranch_scc1 K12_PB4
    v_readfirstlane_b32 s37, v255
    s_nop 3
    s_cmp_eq_u32 s37, 255
    s_cbranch_scc0 K12_PB4
    s_lshl_b32 s36, s34, 4
    s_add_u32 s36, s36, 16384
    s_mov_b64 exec, 1
    v_mov_b32 v255, 1
    v_mov_b32 v240, s36
    buffer_store_dword v255, v240, s[60:63], 0 offen sc1
    s_mov_b64 exec, -1
K12_PB4:
    s_mov_b32 s34, -1
K12_EP3:
    s_cmp_eq_u32 s27, 0
    s_cbranch_scc1 K12_XP_N
    v_perm_b32 v64, v4, v0, s28
    v_perm_b32 v68, v4, v0, s29
    v_perm_b32 v65, v12, v8, s28
    v_perm_b32 v69, v12, v8, s29
    v_perm_b32 v66, v20, v16, s28
    v_perm_b32 v70, v20, v16, s29
    v_perm_b32 v67, v28, v24, s28
    v_perm_b32 v71, v28, v24, s29
    v_perm_b32 v72, v5, v1, s28
    v_perm_b32 v76, v5, v1, s29
    v_perm_b32 v73, v13, v9, s28
    v_perm_b32 v77, v13, v9, s29
    v_perm_b32 v74, v21, v17, s28
    v_perm_b32 v78, v21, v17, s29
    v_perm_b32 v75, v29, v25, s28
    v_perm_b32 v79, v29, v25, s29
    v_perm_b32 v80, v6, v2, s28
    v_perm_b32 v84, v6, v2, s29
    v_perm_b32 v81, v14, v10, s28
    v_perm_b32 v85, v14, v10, s29
    v_perm_b32 v82, v22, v18, s28
    v_perm_b32 v86, v22, v18, s29
    v_perm_b32 v83, v30, v26, s28
    v_perm_b32 v87, v30, v26, s29
    v_perm_b32 v88, v7, v3, s28
    v_perm_b32 v92, v7, v3, s29
    v_perm_b32 v89, v15, v11, s28
    v_perm_b32 v93, v15, v11, s29
    v_perm_b32 v90, v23, v19, s28
    v_perm_b32 v94, v23, v19, s29
    v_perm_b32 v91, v31, v27, s28
    v_perm_b32 v95, v31, v27, s29
    v_perm_b32 v0, v36, v32, s28
    v_perm_b32 v4, v36, v32, s29
    v_perm_b32 v1, v44, v40, s28
    v_perm_b32 v5, v44, v40, s29
    v_perm_b32 v2, v52, v48, s28
    v_perm_b32 v6, v52, v48, s29
    v_perm_b32 v3, v60, v56, s28
    v_perm_b32 v7, v60, v56, s29
    v_perm_b32 v8, v37, v33, s28
    v_perm_b32 v12, v37, v33, s29
    v_perm_b32 v9, v45, v41, s28
    v_perm_b32 v13, v45, v41, s29
    v_perm_b32 v10, v53, v49, s28
    v_perm_b32 v14, v53, v49, s29
    v_perm_b32 v11, v61, v57, s28
    v_perm_b32 v15, v61, v57, s29
    v_perm_b32 v16, v38, v34, s28
    v_perm_b32 v20, v38, v34, s29
    v_perm_b32 v17, v46, v42, s28
    v_perm_b32 v21, v46, v42, s29
    v_perm_b32 v18, v54, v50, s28
    v_perm_b32 v22, v54, v50, s29
    v_perm_b32 v19, v62, v58, s28
    v_perm_b32 v23, v62, v58, s29
    v_perm_b32 v24, v39, v35, s28
    v_perm_b32 v28, v39, v35, s29
    v_perm_b32 v25, v47, v43, s28
    v_perm_b32 v29, v47, v43, s29
    v_perm_b32 v26, v55, v51, s28
    v_perm_b32 v30, v55, v51, s29
    v_perm_b32 v27, v63, v59, s28
    v_perm_b32 v31, v63, v59, s29
K12_XP_N:
    s_lshl_b32 s36, s40, 3
    s_sub_i32 s36, s36, 24
    s_max_i32 s36, s36, 1
    s_mov_b32 s37, 32768
K12_GL0:
    v_mov_b32 v240, 155648
    ds_read_b32 v240, v240
    s_waitcnt lgkmcnt(0)
    v_cmp_gt_u32 vcc, s36, v240
    s_sub_u32 s37, s37, 1
    s_cmp_eq_u32 s37, 0
    s_cbranch_scc1 K12_GT0
    s_cbranch_vccz K12_GT0
    s_sleep 2
    s_branch K12_GL0
K12_GT0:
    s_add_u32 s42, s40, 1
    s_lshl_b32 s36, s42, 7
    s_add_u32 s36, s36, s22
    s_lshr_b32 s37, s36, 9
    s_lshl_b32 s37, s37, 19
    s_and_b32 s36, s36, 511
    s_lshl_b32 s36, s36, 10
    s_add_u32 s36, s36, s37
    s_add_u32 s36, s36, s33
    buffer_load_dwordx4 v[96:99], v250, s[8:11], s36 offen
    s_add_u32 s36, s36, 0x100000
    buffer_load_dwordx4 v[100:103], v250, s[8:11], s36 offen
    s_add_u32 s36, s36, 0x100000
    buffer_load_dwordx4 v[104:107], v250, s[8:11], s36 offen
    s_add_u32 s36, s36, 0x100000
    buffer_load_dwordx4 v[108:111], v250, s[8:11], s36 offen
    s_add_u32 s36, s36, 0x100000
    buffer_load_dwordx4 v[112:115], v250, s[8:11], s36 offen
    s_add_u32 s36, s36, 0x100000
    buffer_load_dwordx4 v[116:119], v250, s[8:11], s36 offen
    s_add_u32 s36, s36, 0x100000
    buffer_load_dwordx4 v[120:123], v250, s[8:11], s36 offen
    s_add_u32 s36, s36, 0x100000
    buffer_load_dwordx4 v[124:127], v250, s[8:11], s36 offen
    s_cmp_eq_u32 s27, 0
    s_cbranch_scc1 K12_XP_E
    s_mul_i32 s39, s40, 85504
    s_add_u32 s39, s39, s31
    s_lshl_b32 s36, s30, 7
    s_add_u32 s39, s39, s36
    v_bfe_u32 v249, v254, 4, 2
    v_bfe_u32 v240, v254, 8, 1
    v_lshl_add_u32 v249, v240, 2, v249
    s_add_u32 s36, s30, 7
    s_cmp_ge_u32 s30, 160
    s_cselect_b32 s36, s36, s30
    s_cmp_eq_u32 s25, 1
    s_cselect_b32 s36, s36, s30
    s_lshr_b32 s36, s36, 1
    s_and_b32 s36, s36, 7
    v_xor_b32 v249, s36, v249
    v_lshl_add_u32 v249, v249, 4, v252
    v_mfma_f32_16x16x32_bf16 v[32:35], v[160:163], v[64:67], 0
    v_mfma_f32_16x16x32_bf16 v[36:39], v[160:163], v[68:71], 0
    v_mfma_f32_16x16x32_bf16 v[40:43], v[160:163], v[72:75], 0
    v_mfma_f32_16x16x32_bf16 v[44:47], v[160:163], v[76:79], 0
    v_mfma_f32_16x16x32_bf16 v[48:51], v[160:163], v[80:83], 0
    v_mfma_f32_16x16x32_bf16 v[52:55], v[160:163], v[84:87], 0
    v_mfma_f32_16x16x32_bf16 v[56:59], v[160:163], v[88:91], 0
    v_mfma_f32_16x16x32_bf16 v[60:63], v[160:163], v[92:95], 0
    v_mfma_f32_16x16x32_bf16 v[32:35], v[164:167], v[0:3], v[32:35]
    v_mfma_f32_16x16x32_bf16 v[36:39], v[164:167], v[4:7], v[36:39]
    v_mfma_f32_16x16x32_bf16 v[40:43], v[164:167], v[8:11], v[40:43]
    v_mfma_f32_16x16x32_bf16 v[44:47], v[164:167], v[12:15], v[44:47]
    v_mfma_f32_16x16x32_bf16 v[48:51], v[164:167], v[16:19], v[48:51]
    v_mfma_f32_16x16x32_bf16 v[52:55], v[164:167], v[20:23], v[52:55]
    v_mfma_f32_16x16x32_bf16 v[56:59], v[164:167], v[24:27], v[56:59]
    v_mfma_f32_16x16x32_bf16 v[60:63], v[164:167], v[28:31], v[60:63]
    s_nop 7
    v_cvt_pk_bf16_f32 v240, v32, v36
    v_cvt_pk_bf16_f32 v241, v40, v44
    v_cvt_pk_bf16_f32 v242, v48, v52
    v_cvt_pk_bf16_f32 v243, v56, v60
    buffer_store_dwordx4 v[240:243], v249, s[12:15], s39 offen sc1
    s_add_u32 s39, s39, 2736128
    v_cvt_pk_bf16_f32 v244, v33, v37
    v_cvt_pk_bf16_f32 v245, v41, v45
    v_cvt_pk_bf16_f32 v246, v49, v53
    v_cvt_pk_bf16_f32 v247, v57, v61
    buffer_store_dwordx4 v[244:247], v249, s[12:15], s39 offen sc1
    s_add_u32 s39, s39, 2736128
    v_cvt_pk_bf16_f32 v240, v34, v38
    v_cvt_pk_bf16_f32 v241, v42, v46
    v_cvt_pk_bf16_f32 v242, v50, v54
    v_cvt_pk_bf16_f32 v243, v58, v62
    buffer_store_dwordx4 v[240:243], v249, s[12:15], s39 offen sc1
    s_add_u32 s39, s39, 2736128
    v_cvt_pk_bf16_f32 v244, v35, v39
    v_cvt_pk_bf16_f32 v245, v43, v47
    v_cvt_pk_bf16_f32 v246, v51, v55
    v_cvt_pk_bf16_f32 v247, v59, v63
    buffer_store_dwordx4 v[244:247], v249, s[12:15], s39 offen sc1
    s_add_u32 s39, s39, 2736128
    v_mfma_f32_16x16x32_bf16 v[32:35], v[168:171], v[64:67], 0
    v_mfma_f32_16x16x32_bf16 v[36:39], v[168:171], v[68:71], 0
    v_mfma_f32_16x16x32_bf16 v[40:43], v[168:171], v[72:75], 0
    v_mfma_f32_16x16x32_bf16 v[44:47], v[168:171], v[76:79], 0
    v_mfma_f32_16x16x32_bf16 v[48:51], v[168:171], v[80:83], 0
    v_mfma_f32_16x16x32_bf16 v[52:55], v[168:171], v[84:87], 0
    v_mfma_f32_16x16x32_bf16 v[56:59], v[168:171], v[88:91], 0
    v_mfma_f32_16x16x32_bf16 v[60:63], v[168:171], v[92:95], 0
    v_mfma_f32_16x16x32_bf16 v[32:35], v[172:175], v[0:3], v[32:35]
    v_mfma_f32_16x16x32_bf16 v[36:39], v[172:175], v[4:7], v[36:39]
    v_mfma_f32_16x16x32_bf16 v[40:43], v[172:175], v[8:11], v[40:43]
    v_mfma_f32_16x16x32_bf16 v[44:47], v[172:175], v[12:15], v[44:47]
    v_mfma_f32_16x16x32_bf16 v[48:51], v[172:175], v[16:19], v[48:51]
    v_mfma_f32_16x16x32_bf16 v[52:55], v[172:175], v[20:23], v[52:55]
    v_mfma_f32_16x16x32_bf16 v[56:59], v[172:175], v[24:27], v[56:59]
    v_mfma_f32_16x16x32_bf16 v[60:63], v[172:175], v[28:31], v[60:63]
    s_nop 7
    v_cvt_pk_bf16_f32 v240, v32, v36
    v_cvt_pk_bf16_f32 v241, v40, v44
    v_cvt_pk_bf16_f32 v242, v48, v52
    v_cvt_pk_bf16_f32 v243, v56, v60
    buffer_store_dwordx4 v[240:243], v249, s[12:15], s39 offen sc1
    s_add_u32 s39, s39, 2736128
    v_cvt_pk_bf16_f32 v244, v33, v37
    v_cvt_pk_bf16_f32 v245, v41, v45
    v_cvt_pk_bf16_f32 v246, v49, v53
    v_cvt_pk_bf16_f32 v247, v57, v61
    buffer_store_dwordx4 v[244:247], v249, s[12:15], s39 offen sc1
    s_add_u32 s39, s39, 2736128
    v_cvt_pk_bf16_f32 v240, v34, v38
    v_cvt_pk_bf16_f32 v241, v42, v46
    v_cvt_pk_bf16_f32 v242, v50, v54
    v_cvt_pk_bf16_f32 v243, v58, v62
    buffer_store_dwordx4 v[240:243], v249, s[12:15], s39 offen sc1
    s_add_u32 s39, s39, 2736128
    v_cvt_pk_bf16_f32 v244, v35, v39
    v_cvt_pk_bf16_f32 v245, v43, v47
    v_cvt_pk_bf16_f32 v246, v51, v55
    v_cvt_pk_bf16_f32 v247, v59, v63
    buffer_store_dwordx4 v[244:247], v249, s[12:15], s39 offen sc1
    s_add_u32 s39, s39, 2736128
    v_mfma_f32_16x16x32_bf16 v[32:35], v[176:179], v[64:67], 0
    v_mfma_f32_16x16x32_bf16 v[36:39], v[176:179], v[68:71], 0
    v_mfma_f32_16x16x32_bf16 v[40:43], v[176:179], v[72:75], 0
    v_mfma_f32_16x16x32_bf16 v[44:47], v[176:179], v[76:79], 0
    v_mfma_f32_16x16x32_bf16 v[48:51], v[176:179], v[80:83], 0
    v_mfma_f32_16x16x32_bf16 v[52:55], v[176:179], v[84:87], 0
    v_mfma_f32_16x16x32_bf16 v[56:59], v[176:179], v[88:91], 0
    v_mfma_f32_16x16x32_bf16 v[60:63], v[176:179], v[92:95], 0
    v_mfma_f32_16x16x32_bf16 v[32:35], v[180:183], v[0:3], v[32:35]
    v_mfma_f32_16x16x32_bf16 v[36:39], v[180:183], v[4:7], v[36:39]
    v_mfma_f32_16x16x32_bf16 v[40:43], v[180:183], v[8:11], v[40:43]
    v_mfma_f32_16x16x32_bf16 v[44:47], v[180:183], v[12:15], v[44:47]
    v_mfma_f32_16x16x32_bf16 v[48:51], v[180:183], v[16:19], v[48:51]
    v_mfma_f32_16x16x32_bf16 v[52:55], v[180:183], v[20:23], v[52:55]
    v_mfma_f32_16x16x32_bf16 v[56:59], v[180:183], v[24:27], v[56:59]
    v_mfma_f32_16x16x32_bf16 v[60:63], v[180:183], v[28:31], v[60:63]
    s_nop 7
    v_cvt_pk_bf16_f32 v240, v32, v36
    v_cvt_pk_bf16_f32 v241, v40, v44
    v_cvt_pk_bf16_f32 v242, v48, v52
    v_cvt_pk_bf16_f32 v243, v56, v60
    buffer_store_dwordx4 v[240:243], v249, s[12:15], s39 offen sc1
    s_add_u32 s39, s39, 2736128
    v_cvt_pk_bf16_f32 v244, v33, v37
    v_cvt_pk_bf16_f32 v245, v41, v45
    v_cvt_pk_bf16_f32 v246, v49, v53
    v_cvt_pk_bf16_f32 v247, v57, v61
    buffer_store_dwordx4 v[244:247], v249, s[12:15], s39 offen sc1
    s_add_u32 s39, s39, 2736128
    v_cvt_pk_bf16_f32 v240, v34, v38
    v_cvt_pk_bf16_f32 v241, v42, v46
    v_cvt_pk_bf16_f32 v242, v50, v54
    v_cvt_pk_bf16_f32 v243, v58, v62
    buffer_store_dwordx4 v[240:243], v249, s[12:15], s39 offen sc1
    s_add_u32 s39, s39, 2736128
    v_cvt_pk_bf16_f32 v244, v35, v39
    v_cvt_pk_bf16_f32 v245, v43, v47
    v_cvt_pk_bf16_f32 v246, v51, v55
    v_cvt_pk_bf16_f32 v247, v59, v63
    buffer_store_dwordx4 v[244:247], v249, s[12:15], s39 offen sc1
    s_add_u32 s39, s39, 2736128
    v_mfma_f32_16x16x32_bf16 v[32:35], v[184:187], v[64:67], 0
    v_mfma_f32_16x16x32_bf16 v[36:39], v[184:187], v[68:71], 0
    v_mfma_f32_16x16x32_bf16 v[40:43], v[184:187], v[72:75], 0
    v_mfma_f32_16x16x32_bf16 v[44:47], v[184:187], v[76:79], 0
    v_mfma_f32_16x16x32_bf16 v[48:51], v[184:187], v[80:83], 0
    v_mfma_f32_16x16x32_bf16 v[52:55], v[184:187], v[84:87], 0
    v_mfma_f32_16x16x32_bf16 v[56:59], v[184:187], v[88:91], 0
    v_mfma_f32_16x16x32_bf16 v[60:63], v[184:187], v[92:95], 0
    v_mfma_f32_16x16x32_bf16 v[32:35], v[188:191], v[0:3], v[32:35]
    v_mfma_f32_16x16x32_bf16 v[36:39], v[188:191], v[4:7], v[36:39]
    v_mfma_f32_16x16x32_bf16 v[40:43], v[188:191], v[8:11], v[40:43]
    v_mfma_f32_16x16x32_bf16 v[44:47], v[188:191], v[12:15], v[44:47]
    v_mfma_f32_16x16x32_bf16 v[48:51], v[188:191], v[16:19], v[48:51]
    v_mfma_f32_16x16x32_bf16 v[52:55], v[188:191], v[20:23], v[52:55]
    v_mfma_f32_16x16x32_bf16 v[56:59], v[188:191], v[24:27], v[56:59]
    v_mfma_f32_16x16x32_bf16 v[60:63], v[188:191], v[28:31], v[60:63]
    s_nop 7
    v_cvt_pk_bf16_f32 v240, v32, v36
    v_cvt_pk_bf16_f32 v241, v40, v44
    v_cvt_pk_bf16_f32 v242, v48, v52
    v_cvt_pk_bf16_f32 v243, v56, v60
    buffer_store_dwordx4 v[240:243], v249, s[12:15], s39 offen sc1
    s_add_u32 s39, s39, 2736128
    v_cvt_pk_bf16_f32 v244, v33, v37
    v_cvt_pk_bf16_f32 v245, v41, v45
    v_cvt_pk_bf16_f32 v246, v49, v53
    v_cvt_pk_bf16_f32 v247, v57, v61
    buffer_store_dwordx4 v[244:247], v249, s[12:15], s39 offen sc1
    s_add_u32 s39, s39, 2736128
    v_cvt_pk_bf16_f32 v240, v34, v38
    v_cvt_pk_bf16_f32 v241, v42, v46
    v_cvt_pk_bf16_f32 v242, v50, v54
    v_cvt_pk_bf16_f32 v243, v58, v62
    buffer_store_dwordx4 v[240:243], v249, s[12:15], s39 offen sc1
    s_add_u32 s39, s39, 2736128
    v_cvt_pk_bf16_f32 v244, v35, v39
    v_cvt_pk_bf16_f32 v245, v43, v47
    v_cvt_pk_bf16_f32 v246, v51, v55
    v_cvt_pk_bf16_f32 v247, v59, v63
    buffer_store_dwordx4 v[244:247], v249, s[12:15], s39 offen sc1
    s_mov_b32 s41, s40
    s_add_u32 s40, s40, 1
    s_cmp_eq_u32 s41, 3
    s_cbranch_scc0 K12_ES5
    s_waitcnt vmcnt(0)
    s_mov_b32 s34, -1
    s_cmp_ge_u32 s41, 8
    s_cbranch_scc1 K12_SG6
    s_lshl_b32 s36, s41, 2
    s_add_u32 s37, s36, 155680
    s_mov_b64 exec, 1
    v_mov_b32 v255, s37
    v_mov_b32 v240, 1
    ds_add_rtn_u32 v240, v255, v240
    s_waitcnt lgkmcnt(0)
    v_readfirstlane_b32 s37, v240
    s_nop 3
    s_cmp_eq_u32 s37, 3
    s_cbranch_scc0 K12_SH6
    s_lshl_b32 s36, s36, 8
    v_mov_b32 v255, 1
    v_mov_b32 v240, s36
    buffer_atomic_add v255, v240, s[60:63], 0 offen sc0 sc1
    s_mov_b32 s34, s41
K12_SH6:
    s_mov_b64 exec, -1
K12_SG6:
    s_waitcnt vmcnt(0)
    s_cmp_ge_u32 s34, 8
    s_cbranch_scc1 K12_PB7
    v_readfirstlane_b32 s37, v255
    s_nop 3
    s_cmp_eq_u32 s37, 255
    s_cbranch_scc0 K12_PB7
    s_lshl_b32 s36, s34, 4
    s_add_u32 s36, s36, 16384
    s_mov_b64 exec, 1
    v_mov_b32 v255, 1
    v_mov_b32 v240, s36
    buffer_store_dword v255, v240, s[60:63], 0 offen sc1
    s_mov_b64 exec, -1
K12_PB7:
    s_mov_b32 s34, -1
    s_mov_b32 s41, -1
K12_ES5:
    s_waitcnt vmcnt(16)
    s_branch K12_XP_F
K12_XP_E:
    s_mov_b32 s41, s40
    s_add_u32 s40, s40, 1
    s_cmp_eq_u32 s41, 3
    s_cbranch_scc0 K12_ES8
    s_waitcnt vmcnt(0)
    s_mov_b32 s34, -1
    s_cmp_ge_u32 s41, 8
    s_cbranch_scc1 K12_SG9
    s_lshl_b32 s36, s41, 2
    s_add_u32 s37, s36, 155680
    s_mov_b64 exec, 1
    v_mov_b32 v255, s37
    v_mov_b32 v240, 1
    ds_add_rtn_u32 v240, v255, v240
    s_waitcnt lgkmcnt(0)
    v_readfirstlane_b32 s37, v240
    s_nop 3
    s_cmp_eq_u32 s37, 3
    s_cbranch_scc0 K12_SH9
    s_lshl_b32 s36, s36, 8
    v_mov_b32 v255, 1
    v_mov_b32 v240, s36
    buffer_atomic_add v255, v240, s[60:63], 0 offen sc0 sc1
    s_mov_b32 s34, s41
K12_SH9:
    s_mov_b64 exec, -1
K12_SG9:
    s_waitcnt vmcnt(0)
    s_cmp_ge_u32 s34, 8
    s_cbranch_scc1 K12_PB10
    v_readfirstlane_b32 s37, v255
    s_nop 3
    s_cmp_eq_u32 s37, 255
    s_cbranch_scc0 K12_PB10
    s_lshl_b32 s36, s34, 4
    s_add_u32 s36, s36, 16384
    s_mov_b64 exec, 1
    v_mov_b32 v255, 1
    v_mov_b32 v240, s36
    buffer_store_dword v255, v240, s[60:63], 0 offen sc1
    s_mov_b64 exec, -1
K12_PB10:
    s_mov_b32 s34, -1
    s_mov_b32 s41, -1
K12_ES8:
    s_waitcnt vmcnt(0)
K12_XP_F:
    s_cmp_ge_u32 s34, 8
    s_cbranch_scc1 K12_PB11
    v_readfirstlane_b32 s37, v255
    s_nop 3
    s_cmp_eq_u32 s37, 255
    s_cbranch_scc0 K12_PB11
    s_lshl_b32 s36, s34, 4
    s_add_u32 s36, s36, 16384
    s_mov_b64 exec, 1
    v_mov_b32 v255, 1
    v_mov_b32 v240, s36
    buffer_store_dword v255, v240, s[60:63], 0 offen sc1
    s_mov_b64 exec, -1
K12_PB11:
    s_cmp_ge_u32 s40, 8
    s_cbranch_scc1 K12_PFIN
K12_WENTRY:
    s_waitcnt vmcnt(0)
    s_mov_b32 s34, -1
    s_cmp_ge_u32 s41, 8
    s_cbranch_scc1 K12_SG12
    s_lshl_b32 s36, s41, 2
    s_add_u32 s37, s36, 155680
    s_mov_b64 exec, 1
    v_mov_b32 v255, s37
    v_mov_b32 v240, 1
    ds_add_rtn_u32 v240, v255, v240
    s_waitcnt lgkmcnt(0)
    v_readfirstlane_b32 s37, v240
    s_nop 3
    s_cmp_eq_u32 s37, 3
    s_cbranch_scc0 K12_SH12
    s_lshl_b32 s36, s36, 8
    v_mov_b32 v255, 1
    v_mov_b32 v240, s36
    buffer_atomic_add v255, v240, s[60:63], 0 offen sc0 sc1
    s_mov_b32 s34, s41
K12_SH12:
    s_mov_b64 exec, -1
K12_SG12:
    s_cmp_ge_u32 s34, 8
    s_cbranch_scc1 K12_EP13
    s_waitcnt vmcnt(0)
    s_cmp_ge_u32 s34, 8
    s_cbranch_scc1 K12_PB14
    v_readfirstlane_b32 s37, v255
    s_nop 3
    s_cmp_eq_u32 s37, 255
    s_cbranch_scc0 K12_PB14
    s_lshl_b32 s36, s34, 4
    s_add_u32 s36, s36, 16384
    s_mov_b64 exec, 1
    v_mov_b32 v255, 1
    v_mov_b32 v240, s36
    buffer_store_dword v255, v240, s[60:63], 0 offen sc1
    s_mov_b64 exec, -1
K12_PB14:
    s_mov_b32 s34, -1
K12_EP13:
    v_perm_b32 v64, v100, v96, s28
    v_perm_b32 v68, v100, v96, s29
    v_perm_b32 v65, v108, v104, s28
    v_perm_b32 v69, v108, v104, s29
    v_perm_b32 v66, v116, v112, s28
    v_perm_b32 v70, v116, v112, s29
    v_perm_b32 v67, v124, v120, s28
    v_perm_b32 v71, v124, v120, s29
    v_perm_b32 v72, v101, v97, s28
    v_perm_b32 v76, v101, v97, s29
    v_perm_b32 v73, v109, v105, s28
    v_perm_b32 v77, v109, v105, s29
    v_perm_b32 v74, v117, v113, s28
    v_perm_b32 v78, v117, v113, s29
    v_perm_b32 v75, v125, v121, s28
    v_perm_b32 v79, v125, v121, s29
    v_perm_b32 v80, v102, v98, s28
    v_perm_b32 v84, v102, v98, s29
    v_perm_b32 v81, v110, v106, s28
    v_perm_b32 v85, v110, v106, s29
    v_perm_b32 v82, v118, v114, s28
    v_perm_b32 v86, v118, v114, s29
    v_perm_b32 v83, v126, v122, s28
    v_perm_b32 v87, v126, v122, s29
    v_perm_b32 v88, v103, v99, s28
    v_perm_b32 v92, v103, v99, s29
    v_perm_b32 v89, v111, v107, s28
    v_perm_b32 v93, v111, v107, s29
    v_perm_b32 v90, v119, v115, s28
    v_perm_b32 v94, v119, v115, s29
    v_perm_b32 v91, v127, v123, s28
    v_perm_b32 v95, v127, v123, s29
    s_lshl_b32 s36, s40, 3
    s_sub_i32 s36, s36, 24
    s_max_i32 s36, s36, 1
    s_mov_b32 s37, 32768
K12_GL1:
    v_mov_b32 v240, 155648
    ds_read_b32 v240, v240
    s_waitcnt lgkmcnt(0)
    v_cmp_gt_u32 vcc, s36, v240
    s_sub_u32 s37, s37, 1
    s_cmp_eq_u32 s37, 0
    s_cbranch_scc1 K12_GT1
    s_cbranch_vccz K12_GT1
    s_sleep 2
    s_branch K12_GL1
K12_GT1:
    s_add_u32 s42, s40, 1
    s_mul_i32 s36, s42, 85
    s_add_u32 s36, s36, s2
    s_and_b32 s36, s36, 255
    s_mul_hi_u32 s37, s36, 0x55555556
    s_mul_i32 s38, s37, 3
    s_cmp_eq_u32 s38, s36
    s_cselect_b32 s27, 1, 0
    s_cmp_lt_u32 s37, 78
    s_cselect_b32 s27, s27, 0
    s_add_u32 s37, s37, 89
    s_cmp_eq_u32 s21, 0
    s_cselect_b32 s30, s24, s37
    s_cselect_b32 s27, 1, s27
    s_cmp_eq_u32 s27, 0
    s_cbranch_scc1 K12_WP_N
    s_lshl_b32 s36, s42, 8
    s_mul_i32 s37, s30, 98304
    s_add_u32 s36, s36, s37
    buffer_load_dwordx4 v[0:3], v248, s[4:7], s36 offen
    buffer_load_dwordx4 v[4:7], v248, s[4:7], s36 offen offset:2048
    s_add_u32 s36, s36, 4096
    buffer_load_dwordx4 v[8:11], v248, s[4:7], s36 offen
    buffer_load_dwordx4 v[12:15], v248, s[4:7], s36 offen offset:2048
    s_add_u32 s36, s36, 4096
    buffer_load_dwordx4 v[16:19], v248, s[4:7], s36 offen
    buffer_load_dwordx4 v[20:23], v248, s[4:7], s36 offen offset:2048
    s_add_u32 s36, s36, 4096
    buffer_load_dwordx4 v[24:27], v248, s[4:7], s36 offen
    buffer_load_dwordx4 v[28:31], v248, s[4:7], s36 offen offset:2048
    s_add_u32 s36, s36, 53248
    buffer_load_dwordx4 v[32:35], v248, s[4:7], s36 offen
    buffer_load_dwordx4 v[36:39], v248, s[4:7], s36 offen offset:2048
    s_add_u32 s36, s36, 4096
    buffer_load_dwordx4 v[40:43], v248, s[4:7], s36 offen
    buffer_load_dwordx4 v[44:47], v248, s[4:7], s36 offen offset:2048
    s_add_u32 s36, s36, 4096
    buffer_load_dwordx4 v[48:51], v248, s[4:7], s36 offen
    buffer_load_dwordx4 v[52:55], v248, s[4:7], s36 offen offset:2048
    s_add_u32 s36, s36, 4096
    buffer_load_dwordx4 v[56:59], v248, s[4:7], s36 offen
    buffer_load_dwordx4 v[60:63], v248, s[4:7], s36 offen offset:2048
    s_branch K12_WP_M
K12_WP_N:
K12_WP_M:
    s_lshl_b32 s36, s40, 7
    s_add_u32 s36, s36, s22
    s_and_b32 s37, s36, 3
    s_lshr_b32 s38, s36, 1
    s_and_b32 s38, s38, 4
    s_or_b32 s37, s37, s38
    v_bfe_u32 v253, v254, 5, 3
    v_xor_b32 v253, s37, v253
    v_lshl_add_u32 v253, v253, 5, v251
    s_lshl_b32 s36, s36, 9
    s_add_u32 s39, s36, s32
    v_mfma_f32_16x16x32_bf16 v[128:131], v[224:227], v[64:67], 0
    v_mfma_f32_16x16x32_bf16 v[132:135], v[224:227], v[68:71], 0
    v_mfma_f32_16x16x32_bf16 v[136:139], v[224:227], v[72:75], 0
    v_mfma_f32_16x16x32_bf16 v[140:143], v[224:227], v[76:79], 0
    v_mfma_f32_16x16x32_bf16 v[144:147], v[224:227], v[80:83], 0
    v_mfma_f32_16x16x32_bf16 v[148:151], v[224:227], v[84:87], 0
    v_mfma_f32_16x16x32_bf16 v[152:155], v[224:227], v[88:91], 0
    v_mfma_f32_16x16x32_bf16 v[156:159], v[224:227], v[92:95], 0
    s_nop 7
    v_cvt_pk_bf16_f32 v240, v128, v132
    v_cvt_pk_bf16_f32 v241, v136, v140
    v_cvt_pk_bf16_f32 v242, v144, v148
    v_cvt_pk_bf16_f32 v243, v152, v156
    buffer_store_dwordx4 v[240:243], v253, s[16:19], s39 offen sc1
    s_add_u32 s39, s39, 4194304
    v_cvt_pk_bf16_f32 v244, v129, v133
    v_cvt_pk_bf16_f32 v245, v137, v141
    v_cvt_pk_bf16_f32 v246, v145, v149
    v_cvt_pk_bf16_f32 v247, v153, v157
    buffer_store_dwordx4 v[244:247], v253, s[16:19], s39 offen sc1
    s_add_u32 s39, s39, 4194304
    v_cvt_pk_bf16_f32 v240, v130, v134
    v_cvt_pk_bf16_f32 v241, v138, v142
    v_cvt_pk_bf16_f32 v242, v146, v150
    v_cvt_pk_bf16_f32 v243, v154, v158
    buffer_store_dwordx4 v[240:243], v253, s[16:19], s39 offen sc1
    s_add_u32 s39, s39, 4194304
    v_cvt_pk_bf16_f32 v244, v131, v135
    v_cvt_pk_bf16_f32 v245, v139, v143
    v_cvt_pk_bf16_f32 v246, v147, v151
    v_cvt_pk_bf16_f32 v247, v155, v159
    buffer_store_dwordx4 v[244:247], v253, s[16:19], s39 offen sc1
    s_add_u32 s39, s39, 4194304
    v_mfma_f32_16x16x32_bf16 v[128:131], v[228:231], v[64:67], 0
    v_mfma_f32_16x16x32_bf16 v[132:135], v[228:231], v[68:71], 0
    v_mfma_f32_16x16x32_bf16 v[136:139], v[228:231], v[72:75], 0
    v_mfma_f32_16x16x32_bf16 v[140:143], v[228:231], v[76:79], 0
    v_mfma_f32_16x16x32_bf16 v[144:147], v[228:231], v[80:83], 0
    v_mfma_f32_16x16x32_bf16 v[148:151], v[228:231], v[84:87], 0
    v_mfma_f32_16x16x32_bf16 v[152:155], v[228:231], v[88:91], 0
    v_mfma_f32_16x16x32_bf16 v[156:159], v[228:231], v[92:95], 0
    s_nop 7
    v_cvt_pk_bf16_f32 v240, v128, v132
    v_cvt_pk_bf16_f32 v241, v136, v140
    v_cvt_pk_bf16_f32 v242, v144, v148
    v_cvt_pk_bf16_f32 v243, v152, v156
    buffer_store_dwordx4 v[240:243], v253, s[16:19], s39 offen sc1
    s_add_u32 s39, s39, 4194304
    v_cvt_pk_bf16_f32 v244, v129, v133
    v_cvt_pk_bf16_f32 v245, v137, v141
    v_cvt_pk_bf16_f32 v246, v145, v149
    v_cvt_pk_bf16_f32 v247, v153, v157
    buffer_store_dwordx4 v[244:247], v253, s[16:19], s39 offen sc1
    s_add_u32 s39, s39, 4194304
    v_cvt_pk_bf16_f32 v240, v130, v134
    v_cvt_pk_bf16_f32 v241, v138, v142
    v_cvt_pk_bf16_f32 v242, v146, v150
    v_cvt_pk_bf16_f32 v243, v154, v158
    buffer_store_dwordx4 v[240:243], v253, s[16:19], s39 offen sc1
    s_add_u32 s39, s39, 4194304
    v_cvt_pk_bf16_f32 v244, v131, v135
    v_cvt_pk_bf16_f32 v245, v139, v143
    v_cvt_pk_bf16_f32 v246, v147, v151
    v_cvt_pk_bf16_f32 v247, v155, v159
    buffer_store_dwordx4 v[244:247], v253, s[16:19], s39 offen sc1
    s_add_u32 s39, s39, 4194304
    v_mfma_f32_16x16x32_bf16 v[128:131], v[232:235], v[64:67], 0
    v_mfma_f32_16x16x32_bf16 v[132:135], v[232:235], v[68:71], 0
    v_mfma_f32_16x16x32_bf16 v[136:139], v[232:235], v[72:75], 0
    v_mfma_f32_16x16x32_bf16 v[140:143], v[232:235], v[76:79], 0
    v_mfma_f32_16x16x32_bf16 v[144:147], v[232:235], v[80:83], 0
    v_mfma_f32_16x16x32_bf16 v[148:151], v[232:235], v[84:87], 0
    v_mfma_f32_16x16x32_bf16 v[152:155], v[232:235], v[88:91], 0
    v_mfma_f32_16x16x32_bf16 v[156:159], v[232:235], v[92:95], 0
    s_nop 7
    v_cvt_pk_bf16_f32 v240, v128, v132
    v_cvt_pk_bf16_f32 v241, v136, v140
    v_cvt_pk_bf16_f32 v242, v144, v148
    v_cvt_pk_bf16_f32 v243, v152, v156
    buffer_store_dwordx4 v[240:243], v253, s[16:19], s39 offen sc1
    s_add_u32 s39, s39, 4194304
    v_cvt_pk_bf16_f32 v244, v129, v133
    v_cvt_pk_bf16_f32 v245, v137, v141
    v_cvt_pk_bf16_f32 v246, v145, v149
    v_cvt_pk_bf16_f32 v247, v153, v157
    buffer_store_dwordx4 v[244:247], v253, s[16:19], s39 offen sc1
    s_add_u32 s39, s39, 4194304
    v_cvt_pk_bf16_f32 v240, v130, v134
    v_cvt_pk_bf16_f32 v241, v138, v142
    v_cvt_pk_bf16_f32 v242, v146, v150
    v_cvt_pk_bf16_f32 v243, v154, v158
    buffer_store_dwordx4 v[240:243], v253, s[16:19], s39 offen sc1
    s_add_u32 s39, s39, 4194304
    v_cvt_pk_bf16_f32 v244, v131, v135
    v_cvt_pk_bf16_f32 v245, v139, v143
    v_cvt_pk_bf16_f32 v246, v147, v151
    v_cvt_pk_bf16_f32 v247, v155, v159
    buffer_store_dwordx4 v[244:247], v253, s[16:19], s39 offen sc1
    s_add_u32 s39, s39, 4194304
    v_mfma_f32_16x16x32_bf16 v[128:131], v[236:239], v[64:67], 0
    v_mfma_f32_16x16x32_bf16 v[132:135], v[236:239], v[68:71], 0
    v_mfma_f32_16x16x32_bf16 v[136:139], v[236:239], v[72:75], 0
    v_mfma_f32_16x16x32_bf16 v[140:143], v[236:239], v[76:79], 0
    v_mfma_f32_16x16x32_bf16 v[144:147], v[236:239], v[80:83], 0
    v_mfma_f32_16x16x32_bf16 v[148:151], v[236:239], v[84:87], 0
    v_mfma_f32_16x16x32_bf16 v[152:155], v[236:239], v[88:91], 0
    v_mfma_f32_16x16x32_bf16 v[156:159], v[236:239], v[92:95], 0
    s_nop 7
    v_cvt_pk_bf16_f32 v240, v128, v132
    v_cvt_pk_bf16_f32 v241, v136, v140
    v_cvt_pk_bf16_f32 v242, v144, v148
    v_cvt_pk_bf16_f32 v243, v152, v156
    buffer_store_dwordx4 v[240:243], v253, s[16:19], s39 offen sc1
    s_add_u32 s39, s39, 4194304
    v_cvt_pk_bf16_f32 v244, v129, v133
    v_cvt_pk_bf16_f32 v245, v137, v141
    v_cvt_pk_bf16_f32 v246, v145, v149
    v_cvt_pk_bf16_f32 v247, v153, v157
    buffer_store_dwordx4 v[244:247], v253, s[16:19], s39 offen sc1
    s_add_u32 s39, s39, 4194304
    v_cvt_pk_bf16_f32 v240, v130, v134
    v_cvt_pk_bf16_f32 v241, v138, v142
    v_cvt_pk_bf16_f32 v242, v146, v150
    v_cvt_pk_bf16_f32 v243, v154, v158
    buffer_store_dwordx4 v[240:243], v253, s[16:19], s39 offen sc1
    s_add_u32 s39, s39, 4194304
    v_cvt_pk_bf16_f32 v244, v131, v135
    v_cvt_pk_bf16_f32 v245, v139, v143
    v_cvt_pk_bf16_f32 v246, v147, v151
    v_cvt_pk_bf16_f32 v247, v155, v159
    buffer_store_dwordx4 v[244:247], v253, s[16:19], s39 offen sc1
    s_mov_b32 s41, s40
    s_add_u32 s40, s40, 1
    s_cmp_eq_u32 s41, 3
    s_cbranch_scc0 K12_ES15
    s_waitcnt vmcnt(0)
    s_mov_b32 s34, -1
    s_cmp_ge_u32 s41, 8
    s_cbranch_scc1 K12_SG16
    s_lshl_b32 s36, s41, 2
    s_add_u32 s37, s36, 155680
    s_mov_b64 exec, 1
    v_mov_b32 v255, s37
    v_mov_b32 v240, 1
    ds_add_rtn_u32 v240, v255, v240
    s_waitcnt lgkmcnt(0)
    v_readfirstlane_b32 s37, v240
    s_nop 3
    s_cmp_eq_u32 s37, 3
    s_cbranch_scc0 K12_SH16
    s_lshl_b32 s36, s36, 8
    v_mov_b32 v255, 1
    v_mov_b32 v240, s36
    buffer_atomic_add v255, v240, s[60:63], 0 offen sc0 sc1
    s_mov_b32 s34, s41
K12_SH16:
    s_mov_b64 exec, -1
K12_SG16:
    s_waitcnt vmcnt(0)
    s_cmp_ge_u32 s34, 8
    s_cbranch_scc1 K12_PB17
    v_readfirstlane_b32 s37, v255
    s_nop 3
    s_cmp_eq_u32 s37, 255
    s_cbranch_scc0 K12_PB17
    s_lshl_b32 s36, s34, 4
    s_add_u32 s36, s36, 16384
    s_mov_b64 exec, 1
    v_mov_b32 v255, 1
    v_mov_b32 v240, s36
    buffer_store_dword v255, v240, s[60:63], 0 offen sc1
    s_mov_b64 exec, -1
K12_PB17:
    s_mov_b32 s34, -1
    s_mov_b32 s41, -1
K12_ES15:
    s_waitcnt vmcnt(16)
    s_cmp_ge_u32 s34, 8
    s_cbranch_scc1 K12_PB18
    v_readfirstlane_b32 s37, v255
    s_nop 3
    s_cmp_eq_u32 s37, 255
    s_cbranch_scc0 K12_PB18
    s_lshl_b32 s36, s34, 4
    s_add_u32 s36, s36, 16384
    s_mov_b64 exec, 1
    v_mov_b32 v255, 1
    v_mov_b32 v240, s36
    buffer_store_dword v255, v240, s[60:63], 0 offen sc1
    s_mov_b64 exec, -1
K12_PB18:
    s_cmp_lt_u32 s40, 8
    s_cbranch_scc1 K12_XW
K12_PFIN:
    s_waitcnt vmcnt(0)
    s_mov_b32 s34, -1
    s_cmp_ge_u32 s41, 8
    s_cbranch_scc1 K12_SG19
    s_lshl_b32 s36, s41, 2
    s_add_u32 s37, s36, 155680
    s_mov_b64 exec, 1
    v_mov_b32 v255, s37
    v_mov_b32 v240, 1
    ds_add_rtn_u32 v240, v255, v240
    s_waitcnt lgkmcnt(0)
    v_readfirstlane_b32 s37, v240
    s_nop 3
    s_cmp_eq_u32 s37, 3
    s_cbranch_scc0 K12_SH19
    s_lshl_b32 s36, s36, 8
    v_mov_b32 v255, 1
    v_mov_b32 v240, s36
    buffer_atomic_add v255, v240, s[60:63], 0 offen sc0 sc1
    s_mov_b32 s34, s41
K12_SH19:
    s_mov_b64 exec, -1
K12_SG19:
    s_waitcnt vmcnt(0)
    s_cmp_ge_u32 s34, 8
    s_cbranch_scc1 K12_PB20
    v_readfirstlane_b32 s37, v255
    s_nop 3
    s_cmp_eq_u32 s37, 255
    s_cbranch_scc0 K12_PB20
    s_lshl_b32 s36, s34, 4
    s_add_u32 s36, s36, 16384
    s_mov_b64 exec, 1
    v_mov_b32 v255, 1
    v_mov_b32 v240, s36
    buffer_store_dword v255, v240, s[60:63], 0 offen sc1
    s_mov_b64 exec, -1
K12_PB20:
    s_endpgm
K12_CONS:
    s_and_b32 s6, s2, 7
    s_lshl_b32 s6, s6, 2
    s_lshr_b32 s7, s2, 6
    s_add_u32 s6, s6, s7
    s_mov_b32 s51, s6
    s_mov_b32 s27, s6
    s_lshr_b32 s7, s2, 3
    s_and_b32 s7, s7, 7
    s_lshr_b32 s20, s7, 2
    s_and_b32 s21, s7, 3
    s_lshl_b32 s22, s6, 1
    s_add_u32 s22, s22, s20
    s_lshl_b32 s23, s6, 2
    s_add_u32 s23, s23, s21
    s_mul_i32 s24, s22, 684032
    s_mul_i32 s25, s23, 524288
    s_add_u32 s25, s25, 50331648
    s_mul_i32 s26, s22, 342016
    s_add_u32 s26, s26, 118489088
    s_add_u32 s8, s58, s24
    s_addc_u32 s9, s59, 0
    s_and_b32 s9, s9, 0xffff
    s_mov_b32 s10, 684032
    s_mov_b32 s11, 0x00020000
    s_add_u32 s12, s58, s25
    s_addc_u32 s13, s59, 0
    s_and_b32 s13, s13, 0xffff
    s_mov_b32 s14, 524288
    s_mov_b32 s15, 0x00020000
    s_add_u32 s16, s58, s26
    s_addc_u32 s17, s59, 0
    s_and_b32 s17, s17, 0xffff
    s_mov_b32 s18, 342016
    s_mov_b32 s19, 0x00020000
    s_add_u32 s4, s58, 153108480
    s_addc_u32 s5, s59, 0
    s_and_b32 s5, s5, 0xffff
    s_cmp_eq_u32 s3, 0
    s_cselect_b32 s6, 128, 0
    s_mov_b32 s7, 0x00020000
    s_mov_b32 s46, 155712
    s_cselect_b32 s46, s46, 155776
    s_mov_b32 s47, 155712
    s_cselect_b32 s47, s47, 155744
    s_cselect_b32 s45, 4, 0
    s_mov_b32 s50, s45
    v_and_b32 v8, 15, v2
    v_lshrrev_b32 v9, 4, v2
    v_lshlrev_b32 v1, 4, v2
    s_mul_i32 s30, s3, 5120
    s_mov_b32 s36, s30
    s_lshl_b32 s31, s3, 12
    s_add_u32 s37, s31, 22528
    s_lshr_b32 s28, s3, 1
    s_and_b32 s29, s3, 1
    s_lshl_b32 s33, s29, 9
    s_add_u32 s33, s33, 20480
    s_mul_i32 s38, s28, 896
    s_add_u32 s38, s38, s33
    s_lshl_b32 s34, s51, 1
    s_add_u32 s34, s34, s28
    s_mul_i32 s34, s34, 684032
    s_add_u32 s64, s58, s34
    s_addc_u32 s65, s59, 0
    s_and_b32 s65, s65, 0xffff
    s_mov_b32 s66, 684032
    s_mov_b32 s67, 0x00020000
    s_mov_b32 s44, 0xffffff
    s_cmp_eq_u32 s29, 0
    s_cselect_b32 s44, -1, s44
    s_mov_b32 s45, 0
    v_lshrrev_b32 v10, 1, v8
    v_xor_b32 v10, v10, v9
    v_lshlrev_b32 v10, 4, v10
    v_lshl_add_u32 v2, v8, 7, v10
    v_xor_b32 v3, 64, v2
    v_lshrrev_b32 v10, 2, v8
    v_lshl_add_u32 v11, v9, 3, v10
    v_lshlrev_b32 v11, 9, v11
    v_and_b32 v12, 1, v9
    v_lshl_or_b32 v10, v12, 2, v10
    s_lshl_b32 s28, s3, 1
    v_xor_b32 v10, s28, v10
    v_lshl_add_u32 v11, v10, 5, v11
    v_and_b32 v10, 3, v8
    v_lshl_add_u32 v11, v10, 3, v11
    v_add_u32 v4, 22528, v11
    s_lshl_b32 s28, s20, 5
    v_xor_b32 v4, s28, v4
    v_and_b32 v10, 3, v8
    v_lshlrev_b32 v10, 2, v10
    v_add_u32 v5, 155648, v10
    s_lshl_b32 s28, s3, 2
    s_add_u32 s28, s28, 155648
    v_mov_b32 v7, s28
    s_mov_b32 s35, 0x80008000
    s_mov_b32 s62, 0
    s_mov_b32 s63, 0
    s_mov_b32 s39, 0
    s_add_u32 m0, s39, s36
    s_nop 0
    buffer_load_dwordx4 v1, s[8:11], s30 offen sc1 lds
    buffer_load_dwordx4 v1, s[8:11], s30 offen offset:1024 sc1 lds
    buffer_load_dwordx4 v1, s[8:11], s30 offen offset:2048 sc1 lds
    buffer_load_dwordx4 v1, s[8:11], s30 offen offset:3072 sc1 lds
    s_add_u32 m0, m0, 4096
    s_add_u32 s34, s30, 4096
    buffer_load_dwordx4 v1, s[8:11], s34 offen sc1 lds
    s_add_u32 m0, s39, s37
    s_add_u32 s30, s30, 21376
    buffer_load_dwordx4 v1, s[12:15], s31 offen sc1 lds
    buffer_load_dwordx4 v1, s[12:15], s31 offen offset:1024 sc1 lds
    buffer_load_dwordx4 v1, s[12:15], s31 offen offset:2048 sc1 lds
    buffer_load_dwordx4 v1, s[12:15], s31 offen offset:3072 sc1 lds
    s_add_u32 m0, s39, s38
    s_mov_b64 exec, s[44:45]
    buffer_load_dwordx4 v1, s[64:67], s33 offen sc1 lds
    s_mov_b64 exec, -1
    s_add_u32 s31, s31, 16384
    s_add_u32 s33, s33, 21376
    s_add_u32 s39, s39, 38912
    s_add_u32 m0, s39, s36
    s_nop 0
    buffer_load_dwordx4 v1, s[8:11], s30 offen sc1 lds
    buffer_load_dwordx4 v1, s[8:11], s30 offen offset:1024 sc1 lds
    buffer_load_dwordx4 v1, s[8:11], s30 offen offset:2048 sc1 lds
    buffer_load_dwordx4 v1, s[8:11], s30 offen offset:3072 sc1 lds
    s_add_u32 m0, m0, 4096
    s_add_u32 s34, s30, 4096
    buffer_load_dwordx4 v1, s[8:11], s34 offen sc1 lds
    s_add_u32 m0, s39, s37
    s_add_u32 s30, s30, 21376
    buffer_load_dwordx4 v1, s[12:15], s31 offen sc1 lds
    buffer_load_dwordx4 v1, s[12:15], s31 offen offset:1024 sc1 lds
    buffer_load_dwordx4 v1, s[12:15], s31 offen offset:2048 sc1 lds
    buffer_load_dwordx4 v1, s[12:15], s31 offen offset:3072 sc1 lds
    s_add_u32 m0, s39, s38
    s_mov_b64 exec, s[44:45]
    buffer_load_dwordx4 v1, s[64:67], s33 offen sc1 lds
    s_mov_b64 exec, -1
    s_add_u32 s31, s31, 16384
    s_add_u32 s33, s33, 21376
    s_add_u32 s39, s39, 38912
    s_add_u32 m0, s39, s36
    s_nop 0
    buffer_load_dwordx4 v1, s[8:11], s30 offen sc1 lds
    buffer_load_dwordx4 v1, s[8:11], s30 offen offset:1024 sc1 lds
    buffer_load_dwordx4 v1, s[8:11], s30 offen offset:2048 sc1 lds
    buffer_load_dwordx4 v1, s[8:11], s30 offen offset:3072 sc1 lds
    s_add_u32 m0, m0, 4096
    s_add_u32 s34, s30, 4096
    buffer_load_dwordx4 v1, s[8:11], s34 offen sc1 lds
    s_add_u32 m0, s39, s37
    s_add_u32 s30, s30, 21376
    buffer_load_dwordx4 v1, s[12:15], s31 offen sc1 lds
    buffer_load_dwordx4 v1, s[12:15], s31 offen offset:1024 sc1 lds
    buffer_load_dwordx4 v1, s[12:15], s31 offen offset:2048 sc1 lds
    buffer_load_dwordx4 v1, s[12:15], s31 offen offset:3072 sc1 lds
    s_add_u32 m0, s39, s38
    s_mov_b64 exec, s[44:45]
    buffer_load_dwordx4 v1, s[64:67], s33 offen sc1 lds
    s_mov_b64 exec, -1
    s_add_u32 s31, s31, 16384
    s_add_u32 s33, s33, 21376
    s_add_u32 s39, s39, 38912
    s_mov_b32 m0, s46
    s_mov_b64 exec, 0xff
    buffer_load_dword v1, s[4:7], 0 offen sc1 lds
    s_mov_b64 exec, -1
    v_lshrrev_b32 v9, 4, v1
    v_and_b32 v8, 15, v9
    v_lshrrev_b32 v9, 4, v9
    v_and_b32 v10, 3, v8
    v_lshlrev_b32 v10, 2, v10
    v_lshrrev_b32 v12, 3, v8
    v_lshl_add_u32 v10, v12, 1, v10
    s_lshl_b32 s28, s3, 4
    s_add_u32 s28, s28, 1
    v_add_u32 v10, s28, v10
    v_bfe_u32 v11, v8, 2, 1
    v_and_b32 v13, 1, v9
    v_lshlrev_b32 v13, 3, v13
    v_mul_u32_u24 v14, 96, v11
    v_mad_u32_u24 v15, v10, v13, v14
    v_mad_u32_u24 v16, v10, 0, v15
    v_mad_u32_u24 v17, v10, 1, v15
    v_mad_u32_u24 v18, v10, 2, v15
    v_mad_u32_u24 v19, v10, 3, v15
    v_mad_u32_u24 v20, v10, 4, v15
    v_mad_u32_u24 v21, v10, 5, v15
    v_mad_u32_u24 v22, v10, 6, v15
    v_mad_u32_u24 v23, v10, 7, v15
    v_and_b32 v16, 127, v16
    v_and_b32 v17, 127, v17
    v_and_b32 v18, 127, v18
    v_and_b32 v19, 127, v19
    v_and_b32 v20, 127, v20
    v_and_b32 v21, 127, v21
    v_and_b32 v22, 127, v22
    v_and_b32 v23, 127, v23
    v_cvt_f32_u32 v16, v16
    v_cvt_f32_u32 v17, v17
    v_cvt_f32_u32 v18, v18
    v_cvt_f32_u32 v19, v19
    v_cvt_f32_u32 v20, v20
    v_cvt_f32_u32 v21, v21
    v_cvt_f32_u32 v22, v22
    v_cvt_f32_u32 v23, v23
    v_mul_f32 v16, 0x3c000000, v16
    v_mul_f32 v17, 0x3c000000, v17
    v_mul_f32 v18, 0x3c000000, v18
    v_mul_f32 v19, 0x3c000000, v19
    v_mul_f32 v20, 0x3c000000, v20
    v_mul_f32 v21, 0x3c000000, v21
    v_mul_f32 v22, 0x3c000000, v22
    v_mul_f32 v23, 0x3c000000, v23
    v_cos_f32 v16, v16
    v_cos_f32 v17, v17
    v_cos_f32 v18, v18
    v_cos_f32 v19, v19
    v_cos_f32 v20, v20
    v_cos_f32 v21, v21
    v_cos_f32 v22, v22
    v_cos_f32 v23, v23
    s_nop 0
    v_cvt_pk_bf16_f32 v24, v16, v17
    v_cvt_pk_bf16_f32 v25, v18, v19
    v_cvt_pk_bf16_f32 v26, v20, v21
    v_cvt_pk_bf16_f32 v27, v22, v23
    v_lshlrev_b32 v32, 16, v24
    v_and_b32 v33, 0xffff0000, v24
    v_sub_f32 v16, v16, v32
    v_sub_f32 v17, v17, v33
    v_lshlrev_b32 v32, 16, v25
    v_and_b32 v33, 0xffff0000, v25
    v_sub_f32 v18, v18, v32
    v_sub_f32 v19, v19, v33
    v_lshlrev_b32 v32, 16, v26
    v_and_b32 v33, 0xffff0000, v26
    v_sub_f32 v20, v20, v32
    v_sub_f32 v21, v21, v33
    v_lshlrev_b32 v32, 16, v27
    v_and_b32 v33, 0xffff0000, v27
    v_sub_f32 v22, v22, v32
    v_sub_f32 v23, v23, v33
    v_cvt_pk_bf16_f32 v28, v16, v17
    v_cvt_pk_bf16_f32 v29, v18, v19
    v_cvt_pk_bf16_f32 v30, v20, v21
    v_cvt_pk_bf16_f32 v31, v22, v23
    v_cmp_lt_u32 vcc, 1, v9
    s_lshl_b32 s28, s3, 10
    s_add_u32 s28, s28, 133120
    v_add_u32 v14, s28, v1
    v_cndmask_b32 v24, v24, v28, vcc
    v_cndmask_b32 v25, v25, v29, vcc
    v_cndmask_b32 v26, v26, v30, vcc
    v_cndmask_b32 v27, v27, v31, vcc
    ds_write_b128 v14, v[24:27]
    v_mov_b32 v12, 0
    v_mov_b32 v13, 0
    v_mov_b32 v14, 0
    v_mov_b32 v15, 0
    s_mul_i32 s28, s3, 38912
    s_add_u32 s28, s28, 22272
    v_add_u32 v16, s28, v1
    s_mov_b64 exec, 0xffff
    ds_write_b128 v16, v[12:15]
    s_mov_b64 exec, -1
    s_lshl_b32 s28, s3, 2
    s_add_u32 s28, s28, 155648
    v_mov_b32 v16, s28
    ds_write_b32 v16, v12
    s_lshl_b32 s28, s3, 3
    s_add_u32 s28, s28, 155680
    v_mov_b32 v16, s28
    ds_write_b64 v16, v[12:13]
    s_lshl_b32 s28, s3, 3
    s_add_u32 s28, s28, 155712
    v_mov_b32 v16, s28
    ds_write_b64 v16, v[12:13]
    v_mov_b32 v16, 155664
    ds_write_b32 v16, v12
    v_mov_b32 v16, 155744
    v_mov_b32 v17, 1
    ds_write_b32 v16, v17
    s_waitcnt lgkmcnt(0)
    s_barrier
    v_mov_b32 v80, 0
    v_mov_b32 v81, 0
    v_mov_b32 v82, 0
    v_mov_b32 v83, 0
    v_mov_b32 v84, 0
    v_mov_b32 v85, 0
    v_mov_b32 v86, 0
    v_mov_b32 v87, 0
    v_mov_b32 v88, 0
    v_mov_b32 v89, 0
    v_mov_b32 v90, 0
    v_mov_b32 v91, 0
    v_mov_b32 v92, 0
    v_mov_b32 v93, 0
    v_mov_b32 v94, 0
    v_mov_b32 v95, 0
    v_mov_b32 v96, 0
    v_mov_b32 v97, 0
    v_mov_b32 v98, 0
    v_mov_b32 v99, 0
    v_mov_b32 v100, 0
    v_mov_b32 v101, 0
    v_mov_b32 v102, 0
    v_mov_b32 v103, 0
    v_mov_b32 v104, 0
    v_mov_b32 v105, 0
    v_mov_b32 v106, 0
    v_mov_b32 v107, 0
    v_mov_b32 v108, 0
    v_mov_b32 v109, 0
    v_mov_b32 v110, 0
    v_mov_b32 v111, 0
    v_mov_b32 v112, 0
    v_mov_b32 v113, 0
    v_mov_b32 v114, 0
    v_mov_b32 v115, 0
    v_mov_b32 v116, 0
    v_mov_b32 v117, 0
    v_mov_b32 v118, 0
    v_mov_b32 v119, 0
    v_mov_b32 v120, 0
    v_mov_b32 v121, 0
    v_mov_b32 v122, 0
    v_mov_b32 v123, 0
    v_mov_b32 v124, 0
    v_mov_b32 v125, 0
    v_mov_b32 v126, 0
    v_mov_b32 v127, 0
    v_mov_b32 v128, 0
    v_mov_b32 v129, 0
    v_mov_b32 v130, 0
    v_mov_b32 v131, 0
    v_mov_b32 v132, 0
    v_mov_b32 v133, 0
    v_mov_b32 v134, 0
    v_mov_b32 v135, 0
    v_mov_b32 v136, 0
    v_mov_b32 v137, 0
    v_mov_b32 v138, 0
    v_mov_b32 v139, 0
    v_mov_b32 v140, 0
    v_mov_b32 v141, 0
    v_mov_b32 v142, 0
    v_mov_b32 v143, 0
    v_mov_b32 v144, 0
    v_mov_b32 v145, 0
    v_mov_b32 v146, 0
    v_mov_b32 v147, 0
    v_mov_b32 v148, 0
    v_mov_b32 v149, 0
    v_mov_b32 v150, 0
    v_mov_b32 v151, 0
    v_mov_b32 v152, 0
    v_mov_b32 v153, 0
    v_mov_b32 v154, 0
    v_mov_b32 v155, 0
    v_mov_b32 v156, 0
    v_mov_b32 v157, 0
    v_mov_b32 v158, 0
    v_mov_b32 v159, 0
    v_mov_b32 v160, 0
    v_mov_b32 v161, 0
    v_mov_b32 v162, 0
    v_mov_b32 v163, 0
    v_mov_b32 v164, 0
    v_mov_b32 v165, 0
    v_mov_b32 v166, 0
    v_mov_b32 v167, 0
    v_mov_b32 v168, 0
    v_mov_b32 v169, 0
    v_mov_b32 v170, 0
    v_mov_b32 v171, 0
    v_mov_b32 v172, 0
    v_mov_b32 v173, 0
    v_mov_b32 v174, 0
    v_mov_b32 v175, 0
    v_mov_b32 v176, 0
    v_mov_b32 v177, 0
    v_mov_b32 v178, 0
    v_mov_b32 v179, 0
    v_mov_b32 v180, 0
    v_mov_b32 v181, 0
    v_mov_b32 v182, 0
    v_mov_b32 v183, 0
    v_mov_b32 v184, 0
    v_mov_b32 v185, 0
    v_mov_b32 v186, 0
    v_mov_b32 v187, 0
    v_mov_b32 v188, 0
    v_mov_b32 v189, 0
    v_mov_b32 v190, 0
    v_mov_b32 v191, 0
    v_mov_b32 v192, 0
    v_mov_b32 v193, 0
    v_mov_b32 v194, 0
    v_mov_b32 v195, 0
    v_mov_b32 v196, 0
    v_mov_b32 v197, 0
    v_mov_b32 v198, 0
    v_mov_b32 v199, 0
    v_mov_b32 v200, 0
    v_mov_b32 v201, 0
    v_mov_b32 v202, 0
    v_mov_b32 v203, 0
    v_mov_b32 v204, 0
    v_mov_b32 v205, 0
    v_mov_b32 v206, 0
    v_mov_b32 v207, 0
    v_mov_b32 v208, 0
    v_mov_b32 v209, 0
    v_mov_b32 v210, 0
    v_mov_b32 v211, 0
    v_mov_b32 v212, 0
    v_mov_b32 v213, 0
    v_mov_b32 v214, 0
    v_mov_b32 v215, 0
    v_mov_b32 v216, 0
    v_mov_b32 v217, 0
    v_mov_b32 v218, 0
    v_mov_b32 v219, 0
    v_mov_b32 v220, 0
    v_mov_b32 v221, 0
    v_mov_b32 v222, 0
    v_mov_b32 v223, 0
    v_mov_b32 v224, 0
    v_mov_b32 v225, 0
    v_mov_b32 v226, 0
    v_mov_b32 v227, 0
    v_mov_b32 v228, 0
    v_mov_b32 v229, 0
    v_mov_b32 v230, 0
    v_mov_b32 v231, 0
    v_mov_b32 v232, 0
    v_mov_b32 v233, 0
    v_mov_b32 v234, 0
    v_mov_b32 v235, 0
    v_mov_b32 v236, 0
    v_mov_b32 v237, 0
    v_mov_b32 v238, 0
    v_mov_b32 v239, 0
    v_mov_b32 v240, 0
    v_mov_b32 v241, 0
    v_mov_b32 v242, 0
    v_mov_b32 v243, 0
    v_mov_b32 v244, 0
    v_mov_b32 v245, 0
    v_mov_b32 v246, 0
    v_mov_b32 v247, 0
    v_mov_b32 v248, 0
    v_mov_b32 v249, 0
    v_mov_b32 v250, 0
    v_mov_b32 v251, 0
    v_mov_b32 v252, 0
    v_mov_b32 v253, 0
    v_mov_b32 v254, 0
    v_mov_b32 v255, 0
    s_barrier
    s_mov_b32 s40, 2
    v_mov_b32 v0, s40
    s_waitcnt vmcnt(21)
    ds_write_b32 v7, v0
    s_branch K12_S0
K12_Q0:
    ds_read_b64_tr_b16 v[40:41], v4 offset:0
    ds_read_b64_tr_b16 v[42:43], v4 offset:2048
    ds_read_b64_tr_b16 v[44:45], v4 offset:256
    ds_read_b64_tr_b16 v[46:47], v4 offset:2304
    v_xor_b32 v4, 32, v4
    ds_read_b64_tr_b16 v[48:49], v4 offset:0
    ds_read_b64_tr_b16 v[50:51], v4 offset:2048
    ds_read_b64_tr_b16 v[52:53], v4 offset:256
    ds_read_b64_tr_b16 v[54:55], v4 offset:2304
    v_xor_b32 v4, 32, v4
    ds_read_b128 v[8:11], v2 offset:0
    ds_read_b128 v[12:15], v3 offset:0
    ds_read_b128 v[16:19], v2 offset:2048
    ds_read_b128 v[20:23], v3 offset:2048
    ds_read_b128 v[32:35], v2 offset:6144
    ds_read_b128 v[36:39], v3 offset:6144
    ds_read_b32 v68, v5
    s_waitcnt lgkmcnt(7)
    v_xor_b32 v72, s35, v44
    v_xor_b32 v73, s35, v45
    v_xor_b32 v74, s35, v46
    v_xor_b32 v75, s35, v47
    v_xor_b32 v76, s35, v52
    v_xor_b32 v77, s35, v53
    v_xor_b32 v78, s35, v54
    v_xor_b32 v79, s35, v55
    s_mov_b32 s41, 0
    s_mov_b32 s42, 38912
    s_mov_b32 s39, 0
    s_mov_b32 s29, 116736
K12_LOOP:
    s_waitcnt lgkmcnt(2)
    v_mfma_f32_16x16x32_bf16 v[80:83], v[8:11], v[40:43], v[80:83]
    ds_read_b128 v[24:27], v2 offset:4096
    v_xor_b32 v72, s35, v44
    v_xor_b32 v73, s35, v45
    v_mfma_f32_16x16x32_bf16 v[84:87], v[8:11], v[44:47], v[84:87]
    ds_read_b128 v[28:31], v3 offset:4096
    v_xor_b32 v74, s35, v46
    v_xor_b32 v75, s35, v47
    v_mfma_f32_16x16x32_bf16 v[88:91], v[8:11], v[48:51], v[88:91]
    s_waitcnt lgkmcnt(2)
    v_cmp_gt_u32 vcc, s40, v68
    s_add_u32 s49, s39, 2
    s_lshr_b32 s49, s49, 1
    v_xor_b32 v76, s35, v52
    v_xor_b32 v77, s35, v53
    v_mfma_f32_16x16x32_bf16 v[92:95], v[8:11], v[52:55], v[92:95]
    s_cbranch_vccnz K12_S1
K12_Q1:
    s_mul_i32 s48, s49, s50
    s_add_u32 s48, s48, s47
    v_xor_b32 v78, s35, v54
    v_xor_b32 v79, s35, v55
    v_mfma_f32_16x16x32_bf16 v[80:83], v[12:15], v[72:75], v[80:83]
    s_add_u32 m0, s29, s36
    s_nop 0
    buffer_load_dwordx4 v1, s[8:11], s30 offen sc1 lds
    v_mfma_f32_16x16x32_bf16 v[84:87], v[12:15], v[40:43], v[84:87]
    s_cmp_lt_u32 s49, 8
    s_cselect_b32 s48, s48, 155744
    v_mfma_f32_16x16x32_bf16 v[88:91], v[12:15], v[76:79], v[88:91]
    s_cmp_ge_u32 s49, 3
    s_cselect_b32 s48, s48, 155744
    v_mfma_f32_16x16x32_bf16 v[92:95], v[12:15], v[48:51], v[92:95]
    v_mfma_f32_16x16x32_bf16 v[96:99], v[16:19], v[40:43], v[96:99]
    ds_read_b128 v[8:11], v2 offset:8192
    v_mfma_f32_16x16x32_bf16 v[100:103], v[16:19], v[44:47], v[100:103]
    ds_read_b128 v[12:15], v3 offset:8192
    v_mfma_f32_16x16x32_bf16 v[104:107], v[16:19], v[48:51], v[104:107]
    buffer_load_dwordx4 v1, s[8:11], s30 offen offset:1024 sc1 lds
    v_mfma_f32_16x16x32_bf16 v[108:111], v[16:19], v[52:55], v[108:111]
    v_mfma_f32_16x16x32_bf16 v[96:99], v[20:23], v[72:75], v[96:99]
    v_mfma_f32_16x16x32_bf16 v[100:103], v[20:23], v[40:43], v[100:103]
    v_mfma_f32_16x16x32_bf16 v[104:107], v[20:23], v[76:79], v[104:107]
    buffer_load_dwordx4 v1, s[8:11], s30 offen offset:2048 sc1 lds
    v_mfma_f32_16x16x32_bf16 v[108:111], v[20:23], v[48:51], v[108:111]
    s_waitcnt lgkmcnt(2)
    v_mfma_f32_16x16x32_bf16 v[112:115], v[24:27], v[40:43], v[112:115]
    ds_read_b128 v[16:19], v2 offset:10240
    v_mfma_f32_16x16x32_bf16 v[116:119], v[24:27], v[44:47], v[116:119]
    ds_read_b128 v[20:23], v3 offset:10240
    v_mfma_f32_16x16x32_bf16 v[120:123], v[24:27], v[48:51], v[120:123]
    v_mfma_f32_16x16x32_bf16 v[124:127], v[24:27], v[52:55], v[124:127]
    v_mfma_f32_16x16x32_bf16 v[112:115], v[28:31], v[72:75], v[112:115]
    buffer_load_dwordx4 v1, s[8:11], s30 offen offset:3072 sc1 lds
    v_mfma_f32_16x16x32_bf16 v[116:119], v[28:31], v[40:43], v[116:119]
    v_mfma_f32_16x16x32_bf16 v[120:123], v[28:31], v[76:79], v[120:123]
    v_mfma_f32_16x16x32_bf16 v[124:127], v[28:31], v[48:51], v[124:127]
    v_mfma_f32_16x16x32_bf16 v[128:131], v[32:35], v[40:43], v[128:131]
    ds_read_b128 v[24:27], v2 offset:12288
    v_mfma_f32_16x16x32_bf16 v[132:135], v[32:35], v[44:47], v[132:135]
    ds_read_b128 v[28:31], v3 offset:12288
    v_mfma_f32_16x16x32_bf16 v[136:139], v[32:35], v[48:51], v[136:139]
    s_add_u32 m0, m0, 4096
    s_add_u32 s34, s30, 4096
    buffer_load_dwordx4 v1, s[8:11], s34 offen sc1 lds
    v_mfma_f32_16x16x32_bf16 v[140:143], v[32:35], v[52:55], v[140:143]
    v_mfma_f32_16x16x32_bf16 v[128:131], v[36:39], v[72:75], v[128:131]
    v_mfma_f32_16x16x32_bf16 v[132:135], v[36:39], v[40:43], v[132:135]
    v_mfma_f32_16x16x32_bf16 v[136:139], v[36:39], v[76:79], v[136:139]
    s_add_u32 m0, s29, s37
    s_add_u32 s30, s30, 21376
    buffer_load_dwordx4 v1, s[12:15], s31 offen sc1 lds
    v_mfma_f32_16x16x32_bf16 v[140:143], v[36:39], v[48:51], v[140:143]
    s_waitcnt lgkmcnt(4)
    v_mfma_f32_16x16x32_bf16 v[144:147], v[8:11], v[40:43], v[144:147]
    ds_read_b128 v[32:35], v2 offset:14336
    v_mfma_f32_16x16x32_bf16 v[148:151], v[8:11], v[44:47], v[148:151]
    ds_read_b128 v[36:39], v3 offset:14336
    v_mfma_f32_16x16x32_bf16 v[152:155], v[8:11], v[48:51], v[152:155]
    v_mfma_f32_16x16x32_bf16 v[156:159], v[8:11], v[52:55], v[156:159]
    v_mfma_f32_16x16x32_bf16 v[144:147], v[12:15], v[72:75], v[144:147]
    buffer_load_dwordx4 v1, s[12:15], s31 offen offset:1024 sc1 lds
    v_mfma_f32_16x16x32_bf16 v[148:151], v[12:15], v[40:43], v[148:151]
    v_mfma_f32_16x16x32_bf16 v[152:155], v[12:15], v[76:79], v[152:155]
    v_mfma_f32_16x16x32_bf16 v[156:159], v[12:15], v[48:51], v[156:159]
    s_waitcnt lgkmcnt(4)
    v_mfma_f32_16x16x32_bf16 v[160:163], v[16:19], v[40:43], v[160:163]
    ds_read_b128 v[8:11], v2 offset:16384
    v_mfma_f32_16x16x32_bf16 v[164:167], v[16:19], v[44:47], v[164:167]
    ds_read_b128 v[12:15], v3 offset:16384
    v_mfma_f32_16x16x32_bf16 v[168:171], v[16:19], v[48:51], v[168:171]
    buffer_load_dwordx4 v1, s[12:15], s31 offen offset:2048 sc1 lds
    v_mfma_f32_16x16x32_bf16 v[172:175], v[16:19], v[52:55], v[172:175]
    s_add_u32 s40, s40, 1
    s_mov_b32 s51, s40
    v_mov_b32 v0, s40
    v_mfma_f32_16x16x32_bf16 v[160:163], v[20:23], v[72:75], v[160:163]
    s_waitcnt vmcnt(19)
    ds_write_b32 v7, v0
    v_mfma_f32_16x16x32_bf16 v[164:167], v[20:23], v[40:43], v[164:167]
    v_mfma_f32_16x16x32_bf16 v[168:171], v[20:23], v[76:79], v[168:171]
    buffer_load_dwordx4 v1, s[12:15], s31 offen offset:3072 sc1 lds
    v_mfma_f32_16x16x32_bf16 v[172:175], v[20:23], v[48:51], v[172:175]
    s_waitcnt lgkmcnt(5)
    v_mfma_f32_16x16x32_bf16 v[176:179], v[24:27], v[40:43], v[176:179]
    ds_read_b128 v[16:19], v2 offset:18432
    v_mfma_f32_16x16x32_bf16 v[180:183], v[24:27], v[44:47], v[180:183]
    ds_read_b128 v[20:23], v3 offset:18432
    v_mov_b32 v0, s48
    v_mfma_f32_16x16x32_bf16 v[184:187], v[24:27], v[48:51], v[184:187]
    ds_read_b32 v0, v0
    v_mfma_f32_16x16x32_bf16 v[188:191], v[24:27], v[52:55], v[188:191]
    v_mfma_f32_16x16x32_bf16 v[176:179], v[28:31], v[72:75], v[176:179]
    s_add_u32 m0, s29, s38
    s_mov_b64 exec, s[44:45]
    buffer_load_dwordx4 v1, s[64:67], s33 offen sc1 lds
    s_mov_b64 exec, -1
    s_add_u32 s31, s31, 16384
    s_add_u32 s33, s33, 21376
    v_mfma_f32_16x16x32_bf16 v[180:183], v[28:31], v[40:43], v[180:183]
    v_mfma_f32_16x16x32_bf16 v[184:187], v[28:31], v[76:79], v[184:187]
    v_mfma_f32_16x16x32_bf16 v[188:191], v[28:31], v[48:51], v[188:191]
    s_waitcnt lgkmcnt(0)
    v_cmp_eq_u32 vcc, 0, v0
    v_mfma_f32_16x16x32_bf16 v[192:195], v[32:35], v[40:43], v[192:195]
    ds_read_b128 v[24:27], v2 offset:20480
    v_mfma_f32_16x16x32_bf16 v[196:199], v[32:35], v[44:47], v[196:199]
    ds_read_b128 v[28:31], v3 offset:20480
    s_cbranch_vccnz K12_F2
K12_G2:
    v_mfma_f32_16x16x32_bf16 v[200:203], v[32:35], v[48:51], v[200:203]
    s_sub_u32 s43, s42, s41
    s_add_u32 s40, s40, 1
    v_add_u32 v2, s43, v2
    v_mfma_f32_16x16x32_bf16 v[204:207], v[32:35], v[52:55], v[204:207]
    v_add_u32 v3, s43, v3
    v_add_u32 v4, s43, v4
    v_mov_b32 v0, s40
    v_mfma_f32_16x16x32_bf16 v[192:195], v[36:39], v[72:75], v[192:195]
    ds_write_b32 v7, v0
    v_mfma_f32_16x16x32_bf16 v[196:199], v[36:39], v[40:43], v[196:199]
    v_mfma_f32_16x16x32_bf16 v[200:203], v[36:39], v[76:79], v[200:203]
    v_mfma_f32_16x16x32_bf16 v[204:207], v[36:39], v[48:51], v[204:207]
    ds_read_b32 v56, v5
    v_mfma_f32_16x16x32_bf16 v[208:211], v[8:11], v[40:43], v[208:211]
    v_mfma_f32_16x16x32_bf16 v[212:215], v[8:11], v[44:47], v[212:215]
    v_mfma_f32_16x16x32_bf16 v[216:219], v[8:11], v[48:51], v[216:219]
    v_mfma_f32_16x16x32_bf16 v[220:223], v[8:11], v[52:55], v[220:223]
    s_waitcnt lgkmcnt(0)
    v_cmp_gt_u32 vcc, s51, v56
    v_mfma_f32_16x16x32_bf16 v[208:211], v[12:15], v[72:75], v[208:211]
    v_mfma_f32_16x16x32_bf16 v[212:215], v[12:15], v[40:43], v[212:215]
    s_cbranch_vccnz K12_S3
K12_Q3:
    v_mfma_f32_16x16x32_bf16 v[216:219], v[12:15], v[76:79], v[216:219]
    ds_read_b64_tr_b16 v[56:57], v4 offset:0
    v_mfma_f32_16x16x32_bf16 v[220:223], v[12:15], v[48:51], v[220:223]
    ds_read_b64_tr_b16 v[58:59], v4 offset:2048
    v_mfma_f32_16x16x32_bf16 v[224:227], v[16:19], v[40:43], v[224:227]
    ds_read_b64_tr_b16 v[60:61], v4 offset:256
    ds_read_b128 v[8:11], v2 offset:0
    v_mfma_f32_16x16x32_bf16 v[228:231], v[16:19], v[44:47], v[228:231]
    ds_read_b64_tr_b16 v[62:63], v4 offset:2304
    ds_read_b128 v[12:15], v3 offset:0
    v_mfma_f32_16x16x32_bf16 v[232:235], v[16:19], v[48:51], v[232:235]
    v_xor_b32 v4, 32, v4
    ds_read_b128 v[32:35], v2 offset:6144
    v_mfma_f32_16x16x32_bf16 v[236:239], v[16:19], v[52:55], v[236:239]
    ds_read_b64_tr_b16 v[64:65], v4 offset:0
    ds_read_b128 v[36:39], v3 offset:6144
    v_mfma_f32_16x16x32_bf16 v[224:227], v[20:23], v[72:75], v[224:227]
    ds_read_b64_tr_b16 v[66:67], v4 offset:2048
    ds_read_b32 v52, v5
    v_mfma_f32_16x16x32_bf16 v[228:231], v[20:23], v[40:43], v[228:231]
    ds_read_b64_tr_b16 v[68:69], v4 offset:256
    ds_read_b64_tr_b16 v[70:71], v4 offset:2304
    v_xor_b32 v4, 32, v4
    v_mfma_f32_16x16x32_bf16 v[232:235], v[20:23], v[76:79], v[232:235]
    v_mfma_f32_16x16x32_bf16 v[236:239], v[20:23], v[48:51], v[236:239]
    v_mfma_f32_16x16x32_bf16 v[240:243], v[24:27], v[40:43], v[240:243]
    ds_read_b128 v[16:19], v2 offset:2048
    v_mfma_f32_16x16x32_bf16 v[244:247], v[24:27], v[44:47], v[244:247]
    ds_read_b128 v[20:23], v3 offset:2048
    v_mfma_f32_16x16x32_bf16 v[240:243], v[28:31], v[72:75], v[240:243]
    s_mov_b32 s29, s41
    s_mov_b32 s41, s42
    s_add_u32 s42, s42, 38912
    v_mfma_f32_16x16x32_bf16 v[244:247], v[28:31], v[40:43], v[244:247]
    s_cmp_eq_u32 s42, 155648
    s_cselect_b32 s42, 0, s42
    s_waitcnt lgkmcnt(2)
    v_mfma_f32_16x16x32_bf16 v[80:83], v[8:11], v[56:59], v[80:83]
    ds_read_b128 v[24:27], v2 offset:4096
    v_xor_b32 v72, s35, v60
    v_xor_b32 v73, s35, v61
    v_mfma_f32_16x16x32_bf16 v[84:87], v[8:11], v[60:63], v[84:87]
    ds_read_b128 v[28:31], v3 offset:4096
    v_xor_b32 v74, s35, v62
    v_xor_b32 v75, s35, v63
    v_mfma_f32_16x16x32_bf16 v[88:91], v[8:11], v[64:67], v[88:91]
    s_waitcnt lgkmcnt(2)
    v_cmp_gt_u32 vcc, s40, v52
    v_xor_b32 v76, s35, v68
    v_xor_b32 v77, s35, v69
    v_mfma_f32_16x16x32_bf16 v[92:95], v[8:11], v[68:71], v[92:95]
    s_cbranch_vccnz K12_S4
K12_Q4:
    v_xor_b32 v78, s35, v70
    v_xor_b32 v79, s35, v71
    v_mfma_f32_16x16x32_bf16 v[80:83], v[12:15], v[72:75], v[80:83]
    s_add_u32 m0, s29, s36
    s_nop 0
    buffer_load_dwordx4 v1, s[8:11], s30 offen sc1 lds
    v_mfma_f32_16x16x32_bf16 v[84:87], v[12:15], v[56:59], v[84:87]
    v_mfma_f32_16x16x32_bf16 v[88:91], v[12:15], v[76:79], v[88:91]
    v_mfma_f32_16x16x32_bf16 v[92:95], v[12:15], v[64:67], v[92:95]
    v_mfma_f32_16x16x32_bf16 v[96:99], v[16:19], v[56:59], v[96:99]
    ds_read_b128 v[8:11], v2 offset:8192
    v_mfma_f32_16x16x32_bf16 v[100:103], v[16:19], v[60:63], v[100:103]
    ds_read_b128 v[12:15], v3 offset:8192
    v_mfma_f32_16x16x32_bf16 v[104:107], v[16:19], v[64:67], v[104:107]
    buffer_load_dwordx4 v1, s[8:11], s30 offen offset:1024 sc1 lds
    v_mfma_f32_16x16x32_bf16 v[108:111], v[16:19], v[68:71], v[108:111]
    v_mfma_f32_16x16x32_bf16 v[96:99], v[20:23], v[72:75], v[96:99]
    v_mfma_f32_16x16x32_bf16 v[100:103], v[20:23], v[56:59], v[100:103]
    v_mfma_f32_16x16x32_bf16 v[104:107], v[20:23], v[76:79], v[104:107]
    buffer_load_dwordx4 v1, s[8:11], s30 offen offset:2048 sc1 lds
    v_mfma_f32_16x16x32_bf16 v[108:111], v[20:23], v[64:67], v[108:111]
    s_waitcnt lgkmcnt(2)
    v_mfma_f32_16x16x32_bf16 v[112:115], v[24:27], v[56:59], v[112:115]
    ds_read_b128 v[16:19], v2 offset:10240
    v_mfma_f32_16x16x32_bf16 v[116:119], v[24:27], v[60:63], v[116:119]
    ds_read_b128 v[20:23], v3 offset:10240
    v_mfma_f32_16x16x32_bf16 v[120:123], v[24:27], v[64:67], v[120:123]
    v_mfma_f32_16x16x32_bf16 v[124:127], v[24:27], v[68:71], v[124:127]
    v_mfma_f32_16x16x32_bf16 v[112:115], v[28:31], v[72:75], v[112:115]
    buffer_load_dwordx4 v1, s[8:11], s30 offen offset:3072 sc1 lds
    v_mfma_f32_16x16x32_bf16 v[116:119], v[28:31], v[56:59], v[116:119]
    v_mfma_f32_16x16x32_bf16 v[120:123], v[28:31], v[76:79], v[120:123]
    v_mfma_f32_16x16x32_bf16 v[124:127], v[28:31], v[64:67], v[124:127]
    v_mfma_f32_16x16x32_bf16 v[128:131], v[32:35], v[56:59], v[128:131]
    ds_read_b128 v[24:27], v2 offset:12288
    v_mfma_f32_16x16x32_bf16 v[132:135], v[32:35], v[60:63], v[132:135]
    ds_read_b128 v[28:31], v3 offset:12288
    v_mfma_f32_16x16x32_bf16 v[136:139], v[32:35], v[64:67], v[136:139]
    s_add_u32 m0, m0, 4096
    s_add_u32 s34, s30, 4096
    buffer_load_dwordx4 v1, s[8:11], s34 offen sc1 lds
    v_mfma_f32_16x16x32_bf16 v[140:143], v[32:35], v[68:71], v[140:143]
    v_mfma_f32_16x16x32_bf16 v[128:131], v[36:39], v[72:75], v[128:131]
    v_mfma_f32_16x16x32_bf16 v[132:135], v[36:39], v[56:59], v[132:135]
    v_mfma_f32_16x16x32_bf16 v[136:139], v[36:39], v[76:79], v[136:139]
    s_add_u32 m0, s29, s37
    s_add_u32 s30, s30, 21376
    buffer_load_dwordx4 v1, s[12:15], s31 offen sc1 lds
    v_mfma_f32_16x16x32_bf16 v[140:143], v[36:39], v[64:67], v[140:143]
    s_waitcnt lgkmcnt(4)
    v_mfma_f32_16x16x32_bf16 v[144:147], v[8:11], v[56:59], v[144:147]
    ds_read_b128 v[32:35], v2 offset:14336
    v_mfma_f32_16x16x32_bf16 v[148:151], v[8:11], v[60:63], v[148:151]
    ds_read_b128 v[36:39], v3 offset:14336
    v_mfma_f32_16x16x32_bf16 v[152:155], v[8:11], v[64:67], v[152:155]
    v_mfma_f32_16x16x32_bf16 v[156:159], v[8:11], v[68:71], v[156:159]
    v_mfma_f32_16x16x32_bf16 v[144:147], v[12:15], v[72:75], v[144:147]
    buffer_load_dwordx4 v1, s[12:15], s31 offen offset:1024 sc1 lds
    v_mfma_f32_16x16x32_bf16 v[148:151], v[12:15], v[56:59], v[148:151]
    v_mfma_f32_16x16x32_bf16 v[152:155], v[12:15], v[76:79], v[152:155]
    v_mfma_f32_16x16x32_bf16 v[156:159], v[12:15], v[64:67], v[156:159]
    s_waitcnt lgkmcnt(4)
    v_mfma_f32_16x16x32_bf16 v[160:163], v[16:19], v[56:59], v[160:163]
    ds_read_b128 v[8:11], v2 offset:16384
    v_mfma_f32_16x16x32_bf16 v[164:167], v[16:19], v[60:63], v[164:167]
    ds_read_b128 v[12:15], v3 offset:16384
    v_mfma_f32_16x16x32_bf16 v[168:171], v[16:19], v[64:67], v[168:171]
    buffer_load_dwordx4 v1, s[12:15], s31 offen offset:2048 sc1 lds
    v_mfma_f32_16x16x32_bf16 v[172:175], v[16:19], v[68:71], v[172:175]
    s_add_u32 s40, s40, 1
    s_mov_b32 s51, s40
    v_mov_b32 v0, s40
    v_mfma_f32_16x16x32_bf16 v[160:163], v[20:23], v[72:75], v[160:163]
    s_waitcnt vmcnt(19)
    ds_write_b32 v7, v0
    v_mfma_f32_16x16x32_bf16 v[164:167], v[20:23], v[56:59], v[164:167]
    v_mfma_f32_16x16x32_bf16 v[168:171], v[20:23], v[76:79], v[168:171]
    buffer_load_dwordx4 v1, s[12:15], s31 offen offset:3072 sc1 lds
    v_mfma_f32_16x16x32_bf16 v[172:175], v[20:23], v[64:67], v[172:175]
    s_waitcnt lgkmcnt(5)
    v_mfma_f32_16x16x32_bf16 v[176:179], v[24:27], v[56:59], v[176:179]
    ds_read_b128 v[16:19], v2 offset:18432
    v_mfma_f32_16x16x32_bf16 v[180:183], v[24:27], v[60:63], v[180:183]
    ds_read_b128 v[20:23], v3 offset:18432
    v_mfma_f32_16x16x32_bf16 v[184:187], v[24:27], v[64:67], v[184:187]
    v_mfma_f32_16x16x32_bf16 v[188:191], v[24:27], v[68:71], v[188:191]
    v_mfma_f32_16x16x32_bf16 v[176:179], v[28:31], v[72:75], v[176:179]
    s_add_u32 m0, s29, s38
    s_mov_b64 exec, s[44:45]
    buffer_load_dwordx4 v1, s[64:67], s33 offen sc1 lds
    s_mov_b64 exec, -1
    s_add_u32 s31, s31, 16384
    s_add_u32 s33, s33, 21376
    v_mfma_f32_16x16x32_bf16 v[180:183], v[28:31], v[56:59], v[180:183]
    v_mfma_f32_16x16x32_bf16 v[184:187], v[28:31], v[76:79], v[184:187]
    s_mov_b32 m0, s46
    s_mov_b64 exec, 0xff
    buffer_load_dword v1, s[4:7], 0 offen sc1 lds
    s_mov_b64 exec, -1
    v_mfma_f32_16x16x32_bf16 v[188:191], v[28:31], v[64:67], v[188:191]
    s_waitcnt lgkmcnt(5)
    v_mfma_f32_16x16x32_bf16 v[192:195], v[32:35], v[56:59], v[192:195]
    ds_read_b128 v[24:27], v2 offset:20480
    v_mfma_f32_16x16x32_bf16 v[196:199], v[32:35], v[60:63], v[196:199]
    ds_read_b128 v[28:31], v3 offset:20480
    v_mfma_f32_16x16x32_bf16 v[200:203], v[32:35], v[64:67], v[200:203]
    s_sub_u32 s43, s42, s41
    s_add_u32 s40, s40, 1
    v_add_u32 v2, s43, v2
    v_mfma_f32_16x16x32_bf16 v[204:207], v[32:35], v[68:71], v[204:207]
    v_add_u32 v3, s43, v3
    v_add_u32 v4, s43, v4
    v_mov_b32 v0, s40
    v_mfma_f32_16x16x32_bf16 v[192:195], v[36:39], v[72:75], v[192:195]
    ds_write_b32 v7, v0
    v_mfma_f32_16x16x32_bf16 v[196:199], v[36:39], v[56:59], v[196:199]
    v_mfma_f32_16x16x32_bf16 v[200:203], v[36:39], v[76:79], v[200:203]
    v_mfma_f32_16x16x32_bf16 v[204:207], v[36:39], v[64:67], v[204:207]
    ds_read_b32 v40, v5
    s_waitcnt lgkmcnt(7)
    v_mfma_f32_16x16x32_bf16 v[208:211], v[8:11], v[56:59], v[208:211]
    v_mfma_f32_16x16x32_bf16 v[212:215], v[8:11], v[60:63], v[212:215]
    v_mfma_f32_16x16x32_bf16 v[216:219], v[8:11], v[64:67], v[216:219]
    v_mfma_f32_16x16x32_bf16 v[220:223], v[8:11], v[68:71], v[220:223]
    s_waitcnt lgkmcnt(0)
    v_cmp_gt_u32 vcc, s51, v40
    v_mfma_f32_16x16x32_bf16 v[208:211], v[12:15], v[72:75], v[208:211]
    v_mfma_f32_16x16x32_bf16 v[212:215], v[12:15], v[56:59], v[212:215]
    s_cbranch_vccnz K12_S5
K12_Q5:
    v_mfma_f32_16x16x32_bf16 v[216:219], v[12:15], v[76:79], v[216:219]
    ds_read_b64_tr_b16 v[40:41], v4 offset:0
    v_mfma_f32_16x16x32_bf16 v[220:223], v[12:15], v[64:67], v[220:223]
    ds_read_b64_tr_b16 v[42:43], v4 offset:2048
    v_mfma_f32_16x16x32_bf16 v[224:227], v[16:19], v[56:59], v[224:227]
    ds_read_b64_tr_b16 v[44:45], v4 offset:256
    ds_read_b128 v[8:11], v2 offset:0
    v_mfma_f32_16x16x32_bf16 v[228:231], v[16:19], v[60:63], v[228:231]
    ds_read_b64_tr_b16 v[46:47], v4 offset:2304
    ds_read_b128 v[12:15], v3 offset:0
    v_mfma_f32_16x16x32_bf16 v[232:235], v[16:19], v[64:67], v[232:235]
    v_xor_b32 v4, 32, v4
    ds_read_b128 v[32:35], v2 offset:6144
    v_mfma_f32_16x16x32_bf16 v[236:239], v[16:19], v[68:71], v[236:239]
    ds_read_b64_tr_b16 v[48:49], v4 offset:0
    ds_read_b128 v[36:39], v3 offset:6144
    v_mfma_f32_16x16x32_bf16 v[224:227], v[20:23], v[72:75], v[224:227]
    ds_read_b64_tr_b16 v[50:51], v4 offset:2048
    ds_read_b32 v68, v5
    v_mfma_f32_16x16x32_bf16 v[228:231], v[20:23], v[56:59], v[228:231]
    ds_read_b64_tr_b16 v[52:53], v4 offset:256
    ds_read_b64_tr_b16 v[54:55], v4 offset:2304
    v_xor_b32 v4, 32, v4
    v_mfma_f32_16x16x32_bf16 v[232:235], v[20:23], v[76:79], v[232:235]
    v_mfma_f32_16x16x32_bf16 v[236:239], v[20:23], v[64:67], v[236:239]
    v_mfma_f32_16x16x32_bf16 v[240:243], v[24:27], v[56:59], v[240:243]
    ds_read_b128 v[16:19], v2 offset:2048
    v_mfma_f32_16x16x32_bf16 v[244:247], v[24:27], v[60:63], v[244:247]
    ds_read_b128 v[20:23], v3 offset:2048
    v_mfma_f32_16x16x32_bf16 v[240:243], v[28:31], v[72:75], v[240:243]
    s_mov_b32 s29, s41
    s_mov_b32 s41, s42
    s_add_u32 s42, s42, 38912
    v_mfma_f32_16x16x32_bf16 v[244:247], v[28:31], v[56:59], v[244:247]
    s_cmp_eq_u32 s42, 155648
    s_cselect_b32 s42, 0, s42
    s_add_u32 s39, s39, 1
    s_cmp_lt_u32 s39, 15
    s_cbranch_scc1 K12_LOOP
    s_waitcnt lgkmcnt(2)
    v_mfma_f32_16x16x32_bf16 v[80:83], v[8:11], v[40:43], v[80:83]
    ds_read_b128 v[24:27], v2 offset:4096
    v_xor_b32 v72, s35, v44
    v_xor_b32 v73, s35, v45
    v_mfma_f32_16x16x32_bf16 v[84:87], v[8:11], v[44:47], v[84:87]
    ds_read_b128 v[28:31], v3 offset:4096
    v_xor_b32 v74, s35, v46
    v_xor_b32 v75, s35, v47
    v_mfma_f32_16x16x32_bf16 v[88:91], v[8:11], v[48:51], v[88:91]
    s_waitcnt lgkmcnt(2)
    v_cmp_gt_u32 vcc, s40, v68
    s_add_u32 s49, s39, 2
    s_lshr_b32 s49, s49, 1
    v_xor_b32 v76, s35, v52
    v_xor_b32 v77, s35, v53
    v_mfma_f32_16x16x32_bf16 v[92:95], v[8:11], v[52:55], v[92:95]
    s_cbranch_vccnz K12_S6
K12_Q6:
    s_mul_i32 s48, s49, s50
    s_add_u32 s48, s48, s47
    v_xor_b32 v78, s35, v54
    v_xor_b32 v79, s35, v55
    v_mfma_f32_16x16x32_bf16 v[80:83], v[12:15], v[72:75], v[80:83]
    s_add_u32 m0, s29, s36
    s_nop 0
    buffer_load_dwordx4 v1, s[8:11], s30 offen sc1 lds
    v_mfma_f32_16x16x32_bf16 v[84:87], v[12:15], v[40:43], v[84:87]
    s_cmp_lt_u32 s49, 8
    s_cselect_b32 s48, s48, 155744
    v_mfma_f32_16x16x32_bf16 v[88:91], v[12:15], v[76:79], v[88:91]
    s_cmp_ge_u32 s49, 3
    s_cselect_b32 s48, s48, 155744
    v_mfma_f32_16x16x32_bf16 v[92:95], v[12:15], v[48:51], v[92:95]
    v_mfma_f32_16x16x32_bf16 v[96:99], v[16:19], v[40:43], v[96:99]
    ds_read_b128 v[8:11], v2 offset:8192
    v_mfma_f32_16x16x32_bf16 v[100:103], v[16:19], v[44:47], v[100:103]
    ds_read_b128 v[12:15], v3 offset:8192
    v_mfma_f32_16x16x32_bf16 v[104:107], v[16:19], v[48:51], v[104:107]
    buffer_load_dwordx4 v1, s[8:11], s30 offen offset:1024 sc1 lds
    v_mfma_f32_16x16x32_bf16 v[108:111], v[16:19], v[52:55], v[108:111]
    v_mfma_f32_16x16x32_bf16 v[96:99], v[20:23], v[72:75], v[96:99]
    v_mfma_f32_16x16x32_bf16 v[100:103], v[20:23], v[40:43], v[100:103]
    v_mfma_f32_16x16x32_bf16 v[104:107], v[20:23], v[76:79], v[104:107]
    buffer_load_dwordx4 v1, s[8:11], s30 offen offset:2048 sc1 lds
    v_mfma_f32_16x16x32_bf16 v[108:111], v[20:23], v[48:51], v[108:111]
    s_waitcnt lgkmcnt(2)
    v_mfma_f32_16x16x32_bf16 v[112:115], v[24:27], v[40:43], v[112:115]
    ds_read_b128 v[16:19], v2 offset:10240
    v_mfma_f32_16x16x32_bf16 v[116:119], v[24:27], v[44:47], v[116:119]
    ds_read_b128 v[20:23], v3 offset:10240
    v_mfma_f32_16x16x32_bf16 v[120:123], v[24:27], v[48:51], v[120:123]
    v_mfma_f32_16x16x32_bf16 v[124:127], v[24:27], v[52:55], v[124:127]
    v_mfma_f32_16x16x32_bf16 v[112:115], v[28:31], v[72:75], v[112:115]
    buffer_load_dwordx4 v1, s[8:11], s30 offen offset:3072 sc1 lds
    v_mfma_f32_16x16x32_bf16 v[116:119], v[28:31], v[40:43], v[116:119]
    v_mfma_f32_16x16x32_bf16 v[120:123], v[28:31], v[76:79], v[120:123]
    v_mfma_f32_16x16x32_bf16 v[124:127], v[28:31], v[48:51], v[124:127]
    v_mfma_f32_16x16x32_bf16 v[128:131], v[32:35], v[40:43], v[128:131]
    ds_read_b128 v[24:27], v2 offset:12288
    v_mfma_f32_16x16x32_bf16 v[132:135], v[32:35], v[44:47], v[132:135]
    ds_read_b128 v[28:31], v3 offset:12288
    v_mfma_f32_16x16x32_bf16 v[136:139], v[32:35], v[48:51], v[136:139]
    s_add_u32 m0, m0, 4096
    s_add_u32 s34, s30, 4096
    buffer_load_dwordx4 v1, s[8:11], s34 offen sc1 lds
    v_mfma_f32_16x16x32_bf16 v[140:143], v[32:35], v[52:55], v[140:143]
    v_mfma_f32_16x16x32_bf16 v[128:131], v[36:39], v[72:75], v[128:131]
    v_mfma_f32_16x16x32_bf16 v[132:135], v[36:39], v[40:43], v[132:135]
    v_mfma_f32_16x16x32_bf16 v[136:139], v[36:39], v[76:79], v[136:139]
    s_add_u32 m0, s29, s37
    s_add_u32 s30, s30, 21376
    buffer_load_dwordx4 v1, s[12:15], s31 offen sc1 lds
    v_mfma_f32_16x16x32_bf16 v[140:143], v[36:39], v[48:51], v[140:143]
    s_waitcnt lgkmcnt(4)
    v_mfma_f32_16x16x32_bf16 v[144:147], v[8:11], v[40:43], v[144:147]
    ds_read_b128 v[32:35], v2 offset:14336
    v_mfma_f32_16x16x32_bf16 v[148:151], v[8:11], v[44:47], v[148:151]
    ds_read_b128 v[36:39], v3 offset:14336
    v_mfma_f32_16x16x32_bf16 v[152:155], v[8:11], v[48:51], v[152:155]
    v_mfma_f32_16x16x32_bf16 v[156:159], v[8:11], v[52:55], v[156:159]
    v_mfma_f32_16x16x32_bf16 v[144:147], v[12:15], v[72:75], v[144:147]
    buffer_load_dwordx4 v1, s[12:15], s31 offen offset:1024 sc1 lds
    v_mfma_f32_16x16x32_bf16 v[148:151], v[12:15], v[40:43], v[148:151]
    v_mfma_f32_16x16x32_bf16 v[152:155], v[12:15], v[76:79], v[152:155]
    v_mfma_f32_16x16x32_bf16 v[156:159], v[12:15], v[48:51], v[156:159]
    s_waitcnt lgkmcnt(4)
    v_mfma_f32_16x16x32_bf16 v[160:163], v[16:19], v[40:43], v[160:163]
    ds_read_b128 v[8:11], v2 offset:16384
    v_mfma_f32_16x16x32_bf16 v[164:167], v[16:19], v[44:47], v[164:167]
    ds_read_b128 v[12:15], v3 offset:16384
    v_mfma_f32_16x16x32_bf16 v[168:171], v[16:19], v[48:51], v[168:171]
    buffer_load_dwordx4 v1, s[12:15], s31 offen offset:2048 sc1 lds
    v_mfma_f32_16x16x32_bf16 v[172:175], v[16:19], v[52:55], v[172:175]
    s_add_u32 s40, s40, 1
    s_mov_b32 s51, s40
    v_mov_b32 v0, s40
    v_mfma_f32_16x16x32_bf16 v[160:163], v[20:23], v[72:75], v[160:163]
    s_waitcnt vmcnt(19)
    ds_write_b32 v7, v0
    v_mfma_f32_16x16x32_bf16 v[164:167], v[20:23], v[40:43], v[164:167]
    v_mfma_f32_16x16x32_bf16 v[168:171], v[20:23], v[76:79], v[168:171]
    buffer_load_dwordx4 v1, s[12:15], s31 offen offset:3072 sc1 lds
    v_mfma_f32_16x16x32_bf16 v[172:175], v[20:23], v[48:51], v[172:175]
    s_waitcnt lgkmcnt(5)
    v_mfma_f32_16x16x32_bf16 v[176:179], v[24:27], v[40:43], v[176:179]
    ds_read_b128 v[16:19], v2 offset:18432
    v_mfma_f32_16x16x32_bf16 v[180:183], v[24:27], v[44:47], v[180:183]
    ds_read_b128 v[20:23], v3 offset:18432
    v_mov_b32 v0, s48
    v_mfma_f32_16x16x32_bf16 v[184:187], v[24:27], v[48:51], v[184:187]
    ds_read_b32 v0, v0
    v_mfma_f32_16x16x32_bf16 v[188:191], v[24:27], v[52:55], v[188:191]
    v_mfma_f32_16x16x32_bf16 v[176:179], v[28:31], v[72:75], v[176:179]
    s_add_u32 m0, s29, s38
    s_mov_b64 exec, s[44:45]
    buffer_load_dwordx4 v1, s[64:67], s33 offen sc1 lds
    s_mov_b64 exec, -1
    s_add_u32 s31, s31, 16384
    s_add_u32 s33, s33, 21376
    v_mfma_f32_16x16x32_bf16 v[180:183], v[28:31], v[40:43], v[180:183]
    v_mfma_f32_16x16x32_bf16 v[184:187], v[28:31], v[76:79], v[184:187]
    v_mfma_f32_16x16x32_bf16 v[188:191], v[28:31], v[48:51], v[188:191]
    s_waitcnt lgkmcnt(0)
    v_cmp_eq_u32 vcc, 0, v0
    v_mfma_f32_16x16x32_bf16 v[192:195], v[32:35], v[40:43], v[192:195]
    ds_read_b128 v[24:27], v2 offset:20480
    v_mfma_f32_16x16x32_bf16 v[196:199], v[32:35], v[44:47], v[196:199]
    ds_read_b128 v[28:31], v3 offset:20480
    s_cbranch_vccnz K12_F7
K12_G7:
    v_mfma_f32_16x16x32_bf16 v[200:203], v[32:35], v[48:51], v[200:203]
    s_sub_u32 s43, s42, s41
    s_add_u32 s40, s40, 1
    v_add_u32 v2, s43, v2
    v_mfma_f32_16x16x32_bf16 v[204:207], v[32:35], v[52:55], v[204:207]
    v_add_u32 v3, s43, v3
    v_add_u32 v4, s43, v4
    v_mov_b32 v0, s40
    v_mfma_f32_16x16x32_bf16 v[192:195], v[36:39], v[72:75], v[192:195]
    ds_write_b32 v7, v0
    v_mfma_f32_16x16x32_bf16 v[196:199], v[36:39], v[40:43], v[196:199]
    v_mfma_f32_16x16x32_bf16 v[200:203], v[36:39], v[76:79], v[200:203]
    v_mfma_f32_16x16x32_bf16 v[204:207], v[36:39], v[48:51], v[204:207]
    ds_read_b32 v56, v5
    v_mfma_f32_16x16x32_bf16 v[208:211], v[8:11], v[40:43], v[208:211]
    v_mfma_f32_16x16x32_bf16 v[212:215], v[8:11], v[44:47], v[212:215]
    v_mfma_f32_16x16x32_bf16 v[216:219], v[8:11], v[48:51], v[216:219]
    v_mfma_f32_16x16x32_bf16 v[220:223], v[8:11], v[52:55], v[220:223]
    s_waitcnt lgkmcnt(0)
    v_cmp_gt_u32 vcc, s51, v56
    v_mfma_f32_16x16x32_bf16 v[208:211], v[12:15], v[72:75], v[208:211]
    v_mfma_f32_16x16x32_bf16 v[212:215], v[12:15], v[40:43], v[212:215]
    s_cbranch_vccnz K12_S8
K12_Q8:
    v_mfma_f32_16x16x32_bf16 v[216:219], v[12:15], v[76:79], v[216:219]
    ds_read_b64_tr_b16 v[56:57], v4 offset:0
    v_mfma_f32_16x16x32_bf16 v[220:223], v[12:15], v[48:51], v[220:223]
    ds_read_b64_tr_b16 v[58:59], v4 offset:2048
    v_mfma_f32_16x16x32_bf16 v[224:227], v[16:19], v[40:43], v[224:227]
    ds_read_b64_tr_b16 v[60:61], v4 offset:256
    ds_read_b128 v[8:11], v2 offset:0
    v_mfma_f32_16x16x32_bf16 v[228:231], v[16:19], v[44:47], v[228:231]
    ds_read_b64_tr_b16 v[62:63], v4 offset:2304
    ds_read_b128 v[12:15], v3 offset:0
    v_mfma_f32_16x16x32_bf16 v[232:235], v[16:19], v[48:51], v[232:235]
    v_xor_b32 v4, 32, v4
    ds_read_b128 v[32:35], v2 offset:6144
    v_mfma_f32_16x16x32_bf16 v[236:239], v[16:19], v[52:55], v[236:239]
    ds_read_b64_tr_b16 v[64:65], v4 offset:0
    ds_read_b128 v[36:39], v3 offset:6144
    v_mfma_f32_16x16x32_bf16 v[224:227], v[20:23], v[72:75], v[224:227]
    ds_read_b64_tr_b16 v[66:67], v4 offset:2048
    ds_read_b32 v52, v5
    v_mfma_f32_16x16x32_bf16 v[228:231], v[20:23], v[40:43], v[228:231]
    ds_read_b64_tr_b16 v[68:69], v4 offset:256
    ds_read_b64_tr_b16 v[70:71], v4 offset:2304
    v_xor_b32 v4, 32, v4
    v_mfma_f32_16x16x32_bf16 v[232:235], v[20:23], v[76:79], v[232:235]
    v_mfma_f32_16x16x32_bf16 v[236:239], v[20:23], v[48:51], v[236:239]
    v_mfma_f32_16x16x32_bf16 v[240:243], v[24:27], v[40:43], v[240:243]
    ds_read_b128 v[16:19], v2 offset:2048
    v_mfma_f32_16x16x32_bf16 v[244:247], v[24:27], v[44:47], v[244:247]
    ds_read_b128 v[20:23], v3 offset:2048
    v_mfma_f32_16x16x32_bf16 v[240:243], v[28:31], v[72:75], v[240:243]
    s_mov_b32 s29, s41
    s_mov_b32 s41, s42
    s_add_u32 s42, s42, 38912
    v_mfma_f32_16x16x32_bf16 v[244:247], v[28:31], v[40:43], v[244:247]
    s_cmp_eq_u32 s42, 155648
    s_cselect_b32 s42, 0, s42
    s_waitcnt lgkmcnt(2)
    v_mfma_f32_16x16x32_bf16 v[80:83], v[8:11], v[56:59], v[80:83]
    ds_read_b128 v[24:27], v2 offset:4096
    v_xor_b32 v72, s35, v60
    v_xor_b32 v73, s35, v61
    v_mfma_f32_16x16x32_bf16 v[84:87], v[8:11], v[60:63], v[84:87]
    ds_read_b128 v[28:31], v3 offset:4096
    v_xor_b32 v74, s35, v62
    v_xor_b32 v75, s35, v63
    v_mfma_f32_16x16x32_bf16 v[88:91], v[8:11], v[64:67], v[88:91]
    v_xor_b32 v76, s35, v68
    v_xor_b32 v77, s35, v69
    v_mfma_f32_16x16x32_bf16 v[92:95], v[8:11], v[68:71], v[92:95]
    v_xor_b32 v78, s35, v70
    v_xor_b32 v79, s35, v71
    v_mfma_f32_16x16x32_bf16 v[80:83], v[12:15], v[72:75], v[80:83]
    v_lshrrev_b32 v0, 4, v1
    v_and_b32 v5, 15, v0
    v_mfma_f32_16x16x32_bf16 v[84:87], v[12:15], v[56:59], v[84:87]
    v_lshrrev_b32 v0, 4, v0
    s_lshl_b32 s28, s21, 7
    v_mfma_f32_16x16x32_bf16 v[88:91], v[12:15], v[76:79], v[88:91]
    s_lshl_b32 s29, s3, 5
    s_add_u32 s28, s28, s29
    v_mfma_f32_16x16x32_bf16 v[92:95], v[12:15], v[64:67], v[92:95]
    v_add_u32 v5, s28, v5
    v_lshlrev_b32 v5, 2, v5
    s_waitcnt lgkmcnt(2)
    v_mfma_f32_16x16x32_bf16 v[96:99], v[16:19], v[56:59], v[96:99]
    ds_read_b128 v[8:11], v2 offset:8192
    v_lshl_add_u32 v5, v0, 13, v5
    s_lshl_b32 s28, s20, 6
    v_mfma_f32_16x16x32_bf16 v[100:103], v[16:19], v[60:63], v[100:103]
    ds_read_b128 v[12:15], v3 offset:8192
    v_xor_b32 v5, s28, v5
    v_xor_b32 v7, 64, v5
    v_mfma_f32_16x16x32_bf16 v[104:107], v[16:19], v[64:67], v[104:107]
    v_mfma_f32_16x16x32_bf16 v[108:111], v[16:19], v[68:71], v[108:111]
    s_mov_b32 s38, 0
    v_cvt_pk_bf16_f32 v48, v80, v84
    buffer_store_dword v48, v5, s[16:19], s38 offen offset:0 sc1
    v_cvt_pk_bf16_f32 v49, v88, v92
    buffer_store_dword v49, v7, s[16:19], s38 offen offset:0 sc1
    v_mfma_f32_16x16x32_bf16 v[96:99], v[20:23], v[72:75], v[96:99]
    v_cvt_pk_bf16_f32 v50, v81, v85
    buffer_store_dword v50, v5, s[16:19], s38 offen offset:2048 sc1
    v_mfma_f32_16x16x32_bf16 v[100:103], v[20:23], v[56:59], v[100:103]
    v_cvt_pk_bf16_f32 v51, v89, v93
    buffer_store_dword v51, v7, s[16:19], s38 offen offset:2048 sc1
    v_mfma_f32_16x16x32_bf16 v[104:107], v[20:23], v[76:79], v[104:107]
    s_mov_b32 s38, 4096
    v_cvt_pk_bf16_f32 v52, v82, v86
    buffer_store_dword v52, v5, s[16:19], s38 offen offset:0 sc1
    v_cvt_pk_bf16_f32 v53, v90, v94
    buffer_store_dword v53, v7, s[16:19], s38 offen offset:0 sc1
    v_mfma_f32_16x16x32_bf16 v[108:111], v[20:23], v[64:67], v[108:111]
    v_cvt_pk_bf16_f32 v54, v83, v87
    buffer_store_dword v54, v5, s[16:19], s38 offen offset:2048 sc1
    s_waitcnt lgkmcnt(2)
    v_mfma_f32_16x16x32_bf16 v[112:115], v[24:27], v[56:59], v[112:115]
    ds_read_b128 v[16:19], v2 offset:10240
    v_cvt_pk_bf16_f32 v55, v91, v95
    buffer_store_dword v55, v7, s[16:19], s38 offen offset:2048 sc1
    v_mfma_f32_16x16x32_bf16 v[116:119], v[24:27], v[60:63], v[116:119]
    ds_read_b128 v[20:23], v3 offset:10240
    v_mfma_f32_16x16x32_bf16 v[120:123], v[24:27], v[64:67], v[120:123]
    v_mfma_f32_16x16x32_bf16 v[124:127], v[24:27], v[68:71], v[124:127]
    s_mov_b32 s38, 32768
    v_cvt_pk_bf16_f32 v40, v96, v100
    buffer_store_dword v40, v5, s[16:19], s38 offen offset:0 sc1
    v_cvt_pk_bf16_f32 v41, v104, v108
    buffer_store_dword v41, v7, s[16:19], s38 offen offset:0 sc1
    v_mfma_f32_16x16x32_bf16 v[112:115], v[28:31], v[72:75], v[112:115]
    v_cvt_pk_bf16_f32 v42, v97, v101
    buffer_store_dword v42, v5, s[16:19], s38 offen offset:2048 sc1
    v_mfma_f32_16x16x32_bf16 v[116:119], v[28:31], v[56:59], v[116:119]
    v_cvt_pk_bf16_f32 v43, v105, v109
    buffer_store_dword v43, v7, s[16:19], s38 offen offset:2048 sc1
    v_mfma_f32_16x16x32_bf16 v[120:123], v[28:31], v[76:79], v[120:123]
    s_mov_b32 s38, 36864
    v_cvt_pk_bf16_f32 v44, v98, v102
    buffer_store_dword v44, v5, s[16:19], s38 offen offset:0 sc1
    v_cvt_pk_bf16_f32 v45, v106, v110
    buffer_store_dword v45, v7, s[16:19], s38 offen offset:0 sc1
    v_mfma_f32_16x16x32_bf16 v[124:127], v[28:31], v[64:67], v[124:127]
    v_cvt_pk_bf16_f32 v46, v99, v103
    buffer_store_dword v46, v5, s[16:19], s38 offen offset:2048 sc1
    v_mfma_f32_16x16x32_bf16 v[128:131], v[32:35], v[56:59], v[128:131]
    ds_read_b128 v[24:27], v2 offset:12288
    v_cvt_pk_bf16_f32 v47, v107, v111
    buffer_store_dword v47, v7, s[16:19], s38 offen offset:2048 sc1
    v_mfma_f32_16x16x32_bf16 v[132:135], v[32:35], v[60:63], v[132:135]
    ds_read_b128 v[28:31], v3 offset:12288
    v_mfma_f32_16x16x32_bf16 v[136:139], v[32:35], v[64:67], v[136:139]
    v_mfma_f32_16x16x32_bf16 v[140:143], v[32:35], v[68:71], v[140:143]
    s_mov_b32 s38, 65536
    v_cvt_pk_bf16_f32 v48, v112, v116
    buffer_store_dword v48, v5, s[16:19], s38 offen offset:0 sc1
    v_cvt_pk_bf16_f32 v49, v120, v124
    buffer_store_dword v49, v7, s[16:19], s38 offen offset:0 sc1
    v_mfma_f32_16x16x32_bf16 v[128:131], v[36:39], v[72:75], v[128:131]
    v_cvt_pk_bf16_f32 v50, v113, v117
    buffer_store_dword v50, v5, s[16:19], s38 offen offset:2048 sc1
    v_mfma_f32_16x16x32_bf16 v[132:135], v[36:39], v[56:59], v[132:135]
    v_cvt_pk_bf16_f32 v51, v121, v125
    buffer_store_dword v51, v7, s[16:19], s38 offen offset:2048 sc1
    v_mfma_f32_16x16x32_bf16 v[136:139], v[36:39], v[76:79], v[136:139]
    s_mov_b32 s38, 69632
    v_cvt_pk_bf16_f32 v52, v114, v118
    buffer_store_dword v52, v5, s[16:19], s38 offen offset:0 sc1
    v_cvt_pk_bf16_f32 v53, v122, v126
    buffer_store_dword v53, v7, s[16:19], s38 offen offset:0 sc1
    v_mfma_f32_16x16x32_bf16 v[140:143], v[36:39], v[64:67], v[140:143]
    v_cvt_pk_bf16_f32 v54, v115, v119
    buffer_store_dword v54, v5, s[16:19], s38 offen offset:2048 sc1
    s_waitcnt lgkmcnt(4)
    v_mfma_f32_16x16x32_bf16 v[144:147], v[8:11], v[56:59], v[144:147]
    ds_read_b128 v[32:35], v2 offset:14336
    v_cvt_pk_bf16_f32 v55, v123, v127
    buffer_store_dword v55, v7, s[16:19], s38 offen offset:2048 sc1
    v_mfma_f32_16x16x32_bf16 v[148:151], v[8:11], v[60:63], v[148:151]
    ds_read_b128 v[36:39], v3 offset:14336
    v_mfma_f32_16x16x32_bf16 v[152:155], v[8:11], v[64:67], v[152:155]
    v_mfma_f32_16x16x32_bf16 v[156:159], v[8:11], v[68:71], v[156:159]
    s_mov_b32 s38, 98304
    v_cvt_pk_bf16_f32 v40, v128, v132
    buffer_store_dword v40, v5, s[16:19], s38 offen offset:0 sc1
    v_cvt_pk_bf16_f32 v41, v136, v140
    buffer_store_dword v41, v7, s[16:19], s38 offen offset:0 sc1
    v_mfma_f32_16x16x32_bf16 v[144:147], v[12:15], v[72:75], v[144:147]
    v_cvt_pk_bf16_f32 v42, v129, v133
    buffer_store_dword v42, v5, s[16:19], s38 offen offset:2048 sc1
    v_mfma_f32_16x16x32_bf16 v[148:151], v[12:15], v[56:59], v[148:151]
    v_cvt_pk_bf16_f32 v43, v137, v141
    buffer_store_dword v43, v7, s[16:19], s38 offen offset:2048 sc1
    v_mfma_f32_16x16x32_bf16 v[152:155], v[12:15], v[76:79], v[152:155]
    s_mov_b32 s38, 102400
    v_cvt_pk_bf16_f32 v44, v130, v134
    buffer_store_dword v44, v5, s[16:19], s38 offen offset:0 sc1
    v_cvt_pk_bf16_f32 v45, v138, v142
    buffer_store_dword v45, v7, s[16:19], s38 offen offset:0 sc1
    v_mfma_f32_16x16x32_bf16 v[156:159], v[12:15], v[64:67], v[156:159]
    v_cvt_pk_bf16_f32 v46, v131, v135
    buffer_store_dword v46, v5, s[16:19], s38 offen offset:2048 sc1
    s_waitcnt lgkmcnt(4)
    v_mfma_f32_16x16x32_bf16 v[160:163], v[16:19], v[56:59], v[160:163]
    ds_read_b128 v[8:11], v2 offset:16384
    v_cvt_pk_bf16_f32 v47, v139, v143
    buffer_store_dword v47, v7, s[16:19], s38 offen offset:2048 sc1
    v_mfma_f32_16x16x32_bf16 v[164:167], v[16:19], v[60:63], v[164:167]
    ds_read_b128 v[12:15], v3 offset:16384
    v_mfma_f32_16x16x32_bf16 v[168:171], v[16:19], v[64:67], v[168:171]
    v_mfma_f32_16x16x32_bf16 v[172:175], v[16:19], v[68:71], v[172:175]
    s_mov_b32 s38, 131072
    v_cvt_pk_bf16_f32 v48, v144, v148
    buffer_store_dword v48, v5, s[16:19], s38 offen offset:0 sc1
    v_cvt_pk_bf16_f32 v49, v152, v156
    buffer_store_dword v49, v7, s[16:19], s38 offen offset:0 sc1
    v_mfma_f32_16x16x32_bf16 v[160:163], v[20:23], v[72:75], v[160:163]
    v_cvt_pk_bf16_f32 v50, v145, v149
    buffer_store_dword v50, v5, s[16:19], s38 offen offset:2048 sc1
    v_mfma_f32_16x16x32_bf16 v[164:167], v[20:23], v[56:59], v[164:167]
    v_cvt_pk_bf16_f32 v51, v153, v157
    buffer_store_dword v51, v7, s[16:19], s38 offen offset:2048 sc1
    v_mfma_f32_16x16x32_bf16 v[168:171], v[20:23], v[76:79], v[168:171]
    s_mov_b32 s38, 135168
    v_cvt_pk_bf16_f32 v52, v146, v150
    buffer_store_dword v52, v5, s[16:19], s38 offen offset:0 sc1
    v_cvt_pk_bf16_f32 v53, v154, v158
    buffer_store_dword v53, v7, s[16:19], s38 offen offset:0 sc1
    v_mfma_f32_16x16x32_bf16 v[172:175], v[20:23], v[64:67], v[172:175]
    v_cvt_pk_bf16_f32 v54, v147, v151
    buffer_store_dword v54, v5, s[16:19], s38 offen offset:2048 sc1
    s_waitcnt lgkmcnt(4)
    v_mfma_f32_16x16x32_bf16 v[176:179], v[24:27], v[56:59], v[176:179]
    ds_read_b128 v[16:19], v2 offset:18432
    v_cvt_pk_bf16_f32 v55, v155, v159
    buffer_store_dword v55, v7, s[16:19], s38 offen offset:2048 sc1
    v_mfma_f32_16x16x32_bf16 v[180:183], v[24:27], v[60:63], v[180:183]
    ds_read_b128 v[20:23], v3 offset:18432
    v_mfma_f32_16x16x32_bf16 v[184:187], v[24:27], v[64:67], v[184:187]
    v_mfma_f32_16x16x32_bf16 v[188:191], v[24:27], v[68:71], v[188:191]
    s_mov_b32 s38, 163840
    v_cvt_pk_bf16_f32 v40, v160, v164
    buffer_store_dword v40, v5, s[16:19], s38 offen offset:0 sc1
    v_cvt_pk_bf16_f32 v41, v168, v172
    buffer_store_dword v41, v7, s[16:19], s38 offen offset:0 sc1
    v_mfma_f32_16x16x32_bf16 v[176:179], v[28:31], v[72:75], v[176:179]
    v_cvt_pk_bf16_f32 v42, v161, v165
    buffer_store_dword v42, v5, s[16:19], s38 offen offset:2048 sc1
    v_mfma_f32_16x16x32_bf16 v[180:183], v[28:31], v[56:59], v[180:183]
    v_cvt_pk_bf16_f32 v43, v169, v173
    buffer_store_dword v43, v7, s[16:19], s38 offen offset:2048 sc1
    v_mfma_f32_16x16x32_bf16 v[184:187], v[28:31], v[76:79], v[184:187]
    s_mov_b32 s38, 167936
    v_cvt_pk_bf16_f32 v44, v162, v166
    buffer_store_dword v44, v5, s[16:19], s38 offen offset:0 sc1
    v_cvt_pk_bf16_f32 v45, v170, v174
    buffer_store_dword v45, v7, s[16:19], s38 offen offset:0 sc1
    v_mfma_f32_16x16x32_bf16 v[188:191], v[28:31], v[64:67], v[188:191]
    v_cvt_pk_bf16_f32 v46, v163, v167
    buffer_store_dword v46, v5, s[16:19], s38 offen offset:2048 sc1
    s_waitcnt lgkmcnt(4)
    v_mfma_f32_16x16x32_bf16 v[192:195], v[32:35], v[56:59], v[192:195]
    ds_read_b128 v[24:27], v2 offset:20480
    v_cvt_pk_bf16_f32 v47, v171, v175
    buffer_store_dword v47, v7, s[16:19], s38 offen offset:2048 sc1
    v_mfma_f32_16x16x32_bf16 v[196:199], v[32:35], v[60:63], v[196:199]
    ds_read_b128 v[28:31], v3 offset:20480
    v_mfma_f32_16x16x32_bf16 v[200:203], v[32:35], v[64:67], v[200:203]
    v_mfma_f32_16x16x32_bf16 v[204:207], v[32:35], v[68:71], v[204:207]
    s_mov_b32 s38, 196608
    v_cvt_pk_bf16_f32 v48, v176, v180
    buffer_store_dword v48, v5, s[16:19], s38 offen offset:0 sc1
    v_cvt_pk_bf16_f32 v49, v184, v188
    buffer_store_dword v49, v7, s[16:19], s38 offen offset:0 sc1
    v_mfma_f32_16x16x32_bf16 v[192:195], v[36:39], v[72:75], v[192:195]
    v_cvt_pk_bf16_f32 v50, v177, v181
    buffer_store_dword v50, v5, s[16:19], s38 offen offset:2048 sc1
    v_mfma_f32_16x16x32_bf16 v[196:199], v[36:39], v[56:59], v[196:199]
    v_cvt_pk_bf16_f32 v51, v185, v189
    buffer_store_dword v51, v7, s[16:19], s38 offen offset:2048 sc1
    v_mfma_f32_16x16x32_bf16 v[200:203], v[36:39], v[76:79], v[200:203]
    s_mov_b32 s38, 200704
    v_cvt_pk_bf16_f32 v52, v178, v182
    buffer_store_dword v52, v5, s[16:19], s38 offen offset:0 sc1
    v_cvt_pk_bf16_f32 v53, v186, v190
    buffer_store_dword v53, v7, s[16:19], s38 offen offset:0 sc1
    v_mfma_f32_16x16x32_bf16 v[204:207], v[36:39], v[64:67], v[204:207]
    v_cvt_pk_bf16_f32 v54, v179, v183
    buffer_store_dword v54, v5, s[16:19], s38 offen offset:2048 sc1
    s_waitcnt lgkmcnt(4)
    v_mfma_f32_16x16x32_bf16 v[208:211], v[8:11], v[56:59], v[208:211]
    v_cvt_pk_bf16_f32 v55, v187, v191
    buffer_store_dword v55, v7, s[16:19], s38 offen offset:2048 sc1
    v_mfma_f32_16x16x32_bf16 v[212:215], v[8:11], v[60:63], v[212:215]
    v_mfma_f32_16x16x32_bf16 v[216:219], v[8:11], v[64:67], v[216:219]
    v_mfma_f32_16x16x32_bf16 v[220:223], v[8:11], v[68:71], v[220:223]
    s_mov_b32 s38, 229376
    v_cvt_pk_bf16_f32 v40, v192, v196
    buffer_store_dword v40, v5, s[16:19], s38 offen offset:0 sc1
    v_cvt_pk_bf16_f32 v41, v200, v204
    buffer_store_dword v41, v7, s[16:19], s38 offen offset:0 sc1
    v_mfma_f32_16x16x32_bf16 v[208:211], v[12:15], v[72:75], v[208:211]
    v_cvt_pk_bf16_f32 v42, v193, v197
    buffer_store_dword v42, v5, s[16:19], s38 offen offset:2048 sc1
    v_mfma_f32_16x16x32_bf16 v[212:215], v[12:15], v[56:59], v[212:215]
    v_cvt_pk_bf16_f32 v43, v201, v205
    buffer_store_dword v43, v7, s[16:19], s38 offen offset:2048 sc1
    v_mfma_f32_16x16x32_bf16 v[216:219], v[12:15], v[76:79], v[216:219]
    s_mov_b32 s38, 233472
    v_cvt_pk_bf16_f32 v44, v194, v198
    buffer_store_dword v44, v5, s[16:19], s38 offen offset:0 sc1
    v_cvt_pk_bf16_f32 v45, v202, v206
    buffer_store_dword v45, v7, s[16:19], s38 offen offset:0 sc1
    v_mfma_f32_16x16x32_bf16 v[220:223], v[12:15], v[64:67], v[220:223]
    v_cvt_pk_bf16_f32 v46, v195, v199
    buffer_store_dword v46, v5, s[16:19], s38 offen offset:2048 sc1
    s_waitcnt lgkmcnt(2)
    v_mfma_f32_16x16x32_bf16 v[224:227], v[16:19], v[56:59], v[224:227]
    v_cvt_pk_bf16_f32 v47, v203, v207
    buffer_store_dword v47, v7, s[16:19], s38 offen offset:2048 sc1
    v_mfma_f32_16x16x32_bf16 v[228:231], v[16:19], v[60:63], v[228:231]
    v_mfma_f32_16x16x32_bf16 v[232:235], v[16:19], v[64:67], v[232:235]
    v_mfma_f32_16x16x32_bf16 v[236:239], v[16:19], v[68:71], v[236:239]
    s_mov_b32 s38, 262144
    v_cvt_pk_bf16_f32 v48, v208, v212
    buffer_store_dword v48, v5, s[16:19], s38 offen offset:0 sc1
    v_cvt_pk_bf16_f32 v49, v216, v220
    buffer_store_dword v49, v7, s[16:19], s38 offen offset:0 sc1
    v_mfma_f32_16x16x32_bf16 v[224:227], v[20:23], v[72:75], v[224:227]
    v_cvt_pk_bf16_f32 v50, v209, v213
    buffer_store_dword v50, v5, s[16:19], s38 offen offset:2048 sc1
    v_mfma_f32_16x16x32_bf16 v[228:231], v[20:23], v[56:59], v[228:231]
    v_cvt_pk_bf16_f32 v51, v217, v221
    buffer_store_dword v51, v7, s[16:19], s38 offen offset:2048 sc1
    v_mfma_f32_16x16x32_bf16 v[232:235], v[20:23], v[76:79], v[232:235]
    s_mov_b32 s38, 266240
    v_cvt_pk_bf16_f32 v52, v210, v214
    buffer_store_dword v52, v5, s[16:19], s38 offen offset:0 sc1
    v_cvt_pk_bf16_f32 v53, v218, v222
    buffer_store_dword v53, v7, s[16:19], s38 offen offset:0 sc1
    v_mfma_f32_16x16x32_bf16 v[236:239], v[20:23], v[64:67], v[236:239]
    v_cvt_pk_bf16_f32 v54, v211, v215
    buffer_store_dword v54, v5, s[16:19], s38 offen offset:2048 sc1
    s_waitcnt lgkmcnt(0)
    v_mfma_f32_16x16x32_bf16 v[240:243], v[24:27], v[56:59], v[240:243]
    v_cvt_pk_bf16_f32 v55, v219, v223
    buffer_store_dword v55, v7, s[16:19], s38 offen offset:2048 sc1
    v_mfma_f32_16x16x32_bf16 v[244:247], v[24:27], v[60:63], v[244:247]
    v_mfma_f32_16x16x32_bf16 v[240:243], v[28:31], v[72:75], v[240:243]
    v_mfma_f32_16x16x32_bf16 v[244:247], v[28:31], v[56:59], v[244:247]
    s_mov_b32 s38, 294912
    v_cvt_pk_bf16_f32 v40, v224, v228
    buffer_store_dword v40, v5, s[16:19], s38 offen offset:0 sc1
    v_cvt_pk_bf16_f32 v41, v232, v236
    buffer_store_dword v41, v7, s[16:19], s38 offen offset:0 sc1
    v_cvt_pk_bf16_f32 v42, v225, v229
    buffer_store_dword v42, v5, s[16:19], s38 offen offset:2048 sc1
    v_cvt_pk_bf16_f32 v43, v233, v237
    buffer_store_dword v43, v7, s[16:19], s38 offen offset:2048 sc1
    s_mov_b32 s38, 299008
    v_cvt_pk_bf16_f32 v44, v226, v230
    buffer_store_dword v44, v5, s[16:19], s38 offen offset:0 sc1
    v_cvt_pk_bf16_f32 v45, v234, v238
    buffer_store_dword v45, v7, s[16:19], s38 offen offset:0 sc1
    v_cvt_pk_bf16_f32 v46, v227, v231
    buffer_store_dword v46, v5, s[16:19], s38 offen offset:2048 sc1
    v_cvt_pk_bf16_f32 v47, v235, v239
    buffer_store_dword v47, v7, s[16:19], s38 offen offset:2048 sc1
    s_nop 7
    s_lshl_b32 s34, s27, 1
    s_mul_i32 s34, s34, 342016
    s_add_u32 s34, s34, 118489088
    s_add_u32 s64, s58, s34
    s_addc_u32 s65, s59, 0
    s_and_b32 s65, s65, 0xffff
    s_mov_b32 s66, 684032
    s_mov_b32 s67, 0x00020000
    v_lshrrev_b32 v8, 8, v1
    v_lshlrev_b32 v9, 13, v8
    v_sub_u32 v9, v5, v9
    v_lshlrev_b32 v8, 2, v8
    v_add_u32 v8, 160, v8
    v_add_u32 v10, 0, v8
    v_add_u32 v11, 160, v10
    v_cmp_gt_u32 vcc, 167, v10
    s_nop 1
    v_cndmask_b32 v11, v11, v10, vcc
    v_cmp_gt_u32 vcc, 174, v10
    v_mov_b32 v12, 0x7ffff
    s_nop 0
    v_cndmask_b32 v11, v12, v11, vcc
    v_lshl_add_u32 v16, v11, 11, v9
    v_add_u32 v10, 1, v8
    v_add_u32 v11, 160, v10
    v_cmp_gt_u32 vcc, 167, v10
    s_nop 1
    v_cndmask_b32 v11, v11, v10, vcc
    v_cmp_gt_u32 vcc, 174, v10
    v_mov_b32 v12, 0x7ffff
    s_nop 0
    v_cndmask_b32 v11, v12, v11, vcc
    v_lshl_add_u32 v17, v11, 11, v9
    v_add_u32 v10, 2, v8
    v_add_u32 v11, 160, v10
    v_cmp_gt_u32 vcc, 167, v10
    s_nop 1
    v_cndmask_b32 v11, v11, v10, vcc
    v_cmp_gt_u32 vcc, 174, v10
    v_mov_b32 v12, 0x7ffff
    s_nop 0
    v_cndmask_b32 v11, v12, v11, vcc
    v_lshl_add_u32 v18, v11, 11, v9
    v_add_u32 v10, 3, v8
    v_add_u32 v11, 160, v10
    v_cmp_gt_u32 vcc, 167, v10
    s_nop 1
    v_cndmask_b32 v11, v11, v10, vcc
    v_cmp_gt_u32 vcc, 174, v10
    v_mov_b32 v12, 0x7ffff
    s_nop 0
    v_cndmask_b32 v11, v12, v11, vcc
    v_lshl_add_u32 v19, v11, 11, v9
    v_cvt_pk_bf16_f32 v20, v240, v244
    buffer_store_dword v20, v16, s[64:67], 0 offen sc1
    v_cvt_pk_bf16_f32 v21, v241, v245
    buffer_store_dword v21, v17, s[64:67], 0 offen sc1
    v_cvt_pk_bf16_f32 v22, v242, v246
    buffer_store_dword v22, v18, s[64:67], 0 offen sc1
    v_cvt_pk_bf16_f32 v23, v243, v247
    buffer_store_dword v23, v19, s[64:67], 0 offen sc1
    s_endpgm
K12_S0:
    s_mov_b32 s61, 4096
    s_add_u32 s62, s62, 1
K12_S0_L:
    ds_read_b32 v56, v5
    s_waitcnt lgkmcnt(0)
    v_cmp_gt_u32 vcc, s40, v56
    s_sub_u32 s61, s61, 1
    s_cmp_eq_u32 s61, 0
    s_cbranch_scc1 K12_Q0
    s_cbranch_vccz K12_Q0
    s_branch K12_S0_L
K12_S1:
    s_mov_b32 s61, 4096
    s_add_u32 s62, s62, 1
K12_S1_L:
    ds_read_b32 v68, v5
    s_waitcnt lgkmcnt(0)
    v_cmp_gt_u32 vcc, s40, v68
    s_sub_u32 s61, s61, 1
    s_cmp_eq_u32 s61, 0
    s_cbranch_scc1 K12_Q1
    s_cbranch_vccz K12_Q1
    s_branch K12_S1_L
K12_F2:
    s_mov_b32 s61, 4096
    s_add_u32 s63, s63, 1
K12_F2_L:
    s_mov_b32 m0, s46
    s_mov_b64 exec, 0xff
    buffer_load_dword v1, s[4:7], 0 offen sc1 lds
    s_mov_b64 exec, -1
    s_waitcnt vmcnt(0)
    v_mov_b32 v0, s48
    ds_read_b32 v0, v0
    s_waitcnt lgkmcnt(0)
    v_cmp_eq_u32 vcc, 0, v0
    s_sub_u32 s61, s61, 1
    s_cmp_eq_u32 s61, 0
    s_cbranch_scc1 K12_F2_X
    s_cbranch_vccz K12_F2_X
    s_sleep 2
    s_branch K12_F2_L
K12_F2_X:
    s_branch K12_G2
K12_S3:
    s_mov_b32 s61, 4096
    s_add_u32 s62, s62, 1
K12_S3_L:
    ds_read_b32 v56, v5
    s_waitcnt lgkmcnt(0)
    v_cmp_gt_u32 vcc, s51, v56
    s_sub_u32 s61, s61, 1
    s_cmp_eq_u32 s61, 0
    s_cbranch_scc1 K12_Q3
    s_cbranch_vccz K12_Q3
    s_branch K12_S3_L
K12_S4:
    s_mov_b32 s61, 4096
    s_add_u32 s62, s62, 1
K12_S4_L:
    ds_read_b32 v52, v5
    s_waitcnt lgkmcnt(0)
    v_cmp_gt_u32 vcc, s40, v52
    s_sub_u32 s61, s61, 1
    s_cmp_eq_u32 s61, 0
    s_cbranch_scc1 K12_Q4
    s_cbranch_vccz K12_Q4
    s_branch K12_S4_L
K12_S5:
    s_mov_b32 s61, 4096
    s_add_u32 s62, s62, 1
K12_S5_L:
    ds_read_b32 v40, v5
    s_waitcnt lgkmcnt(0)
    v_cmp_gt_u32 vcc, s51, v40
    s_sub_u32 s61, s61, 1
    s_cmp_eq_u32 s61, 0
    s_cbranch_scc1 K12_Q5
    s_cbranch_vccz K12_Q5
    s_branch K12_S5_L
K12_S6:
    s_mov_b32 s61, 4096
    s_add_u32 s62, s62, 1
K12_S6_L:
    ds_read_b32 v68, v5
    s_waitcnt lgkmcnt(0)
    v_cmp_gt_u32 vcc, s40, v68
    s_sub_u32 s61, s61, 1
    s_cmp_eq_u32 s61, 0
    s_cbranch_scc1 K12_Q6
    s_cbranch_vccz K12_Q6
    s_branch K12_S6_L
K12_F7:
    s_mov_b32 s61, 4096
    s_add_u32 s63, s63, 1
K12_F7_L:
    s_mov_b32 m0, s46
    s_mov_b64 exec, 0xff
    buffer_load_dword v1, s[4:7], 0 offen sc1 lds
    s_mov_b64 exec, -1
    s_waitcnt vmcnt(0)
    v_mov_b32 v0, s48
    ds_read_b32 v0, v0
    s_waitcnt lgkmcnt(0)
    v_cmp_eq_u32 vcc, 0, v0
    s_sub_u32 s61, s61, 1
    s_cmp_eq_u32 s61, 0
    s_cbranch_scc1 K12_F7_X
    s_cbranch_vccz K12_F7_X
    s_sleep 2
    s_branch K12_F7_L
K12_F7_X:
    s_branch K12_G7
K12_S8:
    s_mov_b32 s61, 4096
    s_add_u32 s62, s62, 1
K12_S8_L:
    ds_read_b32 v56, v5
    s_waitcnt lgkmcnt(0)
    v_cmp_gt_u32 vcc, s51, v56
    s_sub_u32 s61, s61, 1
    s_cmp_eq_u32 s61, 0
    s_cbranch_scc1 K12_Q8
    s_cbranch_vccz K12_Q8
    s_branch K12_S8_L
K12_END:
    s_endpgm
.p2align 8
.type k34_out_kernel,@function
k34_out_kernel:
    s_cmp_ge_u32 s2, 256
    s_cbranch_scc1 K34_END
    s_load_dwordx2 s[4:5], s[0:1], 48
    s_load_dwordx4 s[40:43], s[0:1], 16
    s_load_dwordx2 s[44:45], s[0:1], 32
    v_lshrrev_b32 v1, 6, v0
    v_and_b32 v2, 63, v0
    v_readfirstlane_b32 s3, v1
    s_and_b32 s6, s2, 15
    s_lshr_b32 s7, s2, 4
    s_lshr_b32 s20, s6, 3
    s_and_b32 s21, s6, 7
    s_mul_i32 s22, s7, 11
    s_mul_i32 s23, s7, 10
    s_add_u32 s23, s23, 7
    s_cmp_lt_u32 s7, 7
    s_cselect_b32 s22, s22, s23
    s_cselect_b32 s23, 11, 10
    s_add_u32 s22, s22, s3
    v_and_b32 v3, 15, v2
    v_lshrrev_b32 v4, 4, v2
    v_lshlrev_b32 v5, 4, v2
    s_mov_b32 s24, 2736128
    v_mul_lo_u32 v6, v4, s24
    v_lshl_add_u32 v6, v3, 4, v6
    s_mul_i32 s25, s20, 167
    s_add_u32 s25, s25, s22
    s_lshl_b32 s25, s25, 11
    s_lshl_b32 s24, s21, 8
    s_add_u32 s25, s25, s24
    s_waitcnt lgkmcnt(0)
    s_add_u32 s8, s4, 118489088
    s_addc_u32 s9, s5, 0
    s_and_b32 s9, s9, 0xffff
    s_mov_b32 s10, 21889024
    s_mov_b32 s11, 0x00020000
    s_add_u32 s12, s4, 153616384
    s_addc_u32 s13, s5, 0
    s_and_b32 s13, s13, 0xffff
    s_mov_b32 s14, 131072
    s_mov_b32 s15, 0x00020000
    s_cmp_lt_u32 s3, s23
    s_cbranch_scc0 K34_NOLOAD
    buffer_load_dwordx4 v[16:19], v6, s[8:11], s25 offen
    s_add_u32 s25, s25, 684032
    buffer_load_dwordx4 v[20:23], v6, s[8:11], s25 offen
    s_add_u32 s25, s25, 684032
    buffer_load_dwordx4 v[24:27], v6, s[8:11], s25 offen
    s_add_u32 s25, s25, 684032
    buffer_load_dwordx4 v[28:31], v6, s[8:11], s25 offen
    s_add_u32 s25, s25, 8892416
    buffer_load_dwordx4 v[32:35], v6, s[8:11], s25 offen
    s_add_u32 s25, s25, 684032
    buffer_load_dwordx4 v[36:39], v6, s[8:11], s25 offen
    s_add_u32 s25, s25, 684032
    buffer_load_dwordx4 v[40:43], v6, s[8:11], s25 offen
    s_add_u32 s25, s25, 684032
    buffer_load_dwordx4 v[44:47], v6, s[8:11], s25 offen
K34_NOLOAD:
    s_cmp_lg_u32 s3, 0
    s_cbranch_scc1 K34_TAB
    s_mov_b32 s16, s40
    s_mov_b32 s17, s41
    s_and_b32 s17, s17, 0xffff
    s_mov_b32 s18, 1024
    s_mov_b32 s19, 0x00020000
    s_mov_b32 s28, s42
    s_mov_b32 s29, s43
    s_and_b32 s29, s29, 0xffff
    s_mov_b32 s30, 1024
    s_mov_b32 s31, 0x00020000
    s_lshl_b32 s24, s21, 7
    v_lshlrev_b32 v8, 1, v2
    buffer_load_ushort v152, v8, s[16:19], s24 offen
    buffer_load_ushort v153, v8, s[28:31], s24 offen
    s_branch K34_TABDONE
K34_TAB:
    s_cmp_ge_u32 s3, 7
    s_cbranch_scc1 K34_TABDONE
    s_sub_u32 s27, s3, 1
    s_lshr_b32 s28, s27, 1
    s_and_b32 s29, s27, 1
    s_lshl_b32 s30, s28, 4
    v_add_u32 v8, s30, v3
    s_lshl_b32 s30, s29, 5
    s_add_u32 s30, s30, 1
    v_lshlrev_b32 v9, 3, v4
    v_add_u32 v9, s30, v9
    v_mul_u32_u24 v9, v8, v9
    v_lshlrev_b32 v8, 1, v8
    v_mad_u32_u24 v48, v8, 0, v9
    v_mad_u32_u24 v49, v8, 0, v9
    v_add_u32 v49, 32, v49
    v_mad_u32_u24 v50, v8, 1, v9
    v_mad_u32_u24 v51, v8, 1, v9
    v_add_u32 v51, 32, v51
    v_mad_u32_u24 v52, v8, 2, v9
    v_mad_u32_u24 v53, v8, 2, v9
    v_add_u32 v53, 32, v53
    v_mad_u32_u24 v54, v8, 3, v9
    v_mad_u32_u24 v55, v8, 3, v9
    v_add_u32 v55, 32, v55
    v_and_b32 v48, 127, v48
    v_and_b32 v49, 127, v49
    v_and_b32 v50, 127, v50
    v_and_b32 v51, 127, v51
    v_and_b32 v52, 127, v52
    v_and_b32 v53, 127, v53
    v_and_b32 v54, 127, v54
    v_and_b32 v55, 127, v55
    v_cvt_f32_u32 v48, v48
    v_cvt_f32_u32 v49, v49
    v_cvt_f32_u32 v50, v50
    v_cvt_f32_u32 v51, v51
    v_cvt_f32_u32 v52, v52
    v_cvt_f32_u32 v53, v53
    v_cvt_f32_u32 v54, v54
    v_cvt_f32_u32 v55, v55
    v_mul_f32 v48, 0x3c000000, v48
    v_mul_f32 v49, 0x3c000000, v49
    v_mul_f32 v50, 0x3c000000, v50
    v_mul_f32 v51, 0x3c000000, v51
    v_mul_f32 v52, 0x3c000000, v52
    v_mul_f32 v53, 0x3c000000, v53
    v_mul_f32 v54, 0x3c000000, v54
    v_mul_f32 v55, 0x3c000000, v55
    v_cos_f32 v48, v48
    v_cos_f32 v49, v49
    v_cos_f32 v50, v50
    v_cos_f32 v51, v51
    v_cos_f32 v52, v52
    v_cos_f32 v53, v53
    v_cos_f32 v54, v54
    v_cos_f32 v55, v55
    s_nop 0
    v_mul_f32 v48, 0x3d000000, v48
    v_mul_f32 v49, 0x3d000000, v49
    v_mul_f32 v50, 0x3d000000, v50
    v_mul_f32 v51, 0x3d000000, v51
    v_mul_f32 v52, 0x3d000000, v52
    v_mul_f32 v53, 0x3d000000, v53
    v_mul_f32 v54, 0x3d000000, v54
    v_mul_f32 v55, 0x3d000000, v55
    v_cvt_pk_bf16_f32 v56, v48, v49
    v_cvt_pk_bf16_f32 v57, v50, v51
    v_cvt_pk_bf16_f32 v58, v52, v53
    v_cvt_pk_bf16_f32 v59, v54, v55
    v_lshlrev_b32 v64, 16, v56
    v_and_b32 v65, 0xffff0000, v56
    v_sub_f32 v48, v48, v64
    v_sub_f32 v49, v49, v65
    v_lshlrev_b32 v64, 16, v57
    v_and_b32 v65, 0xffff0000, v57
    v_sub_f32 v50, v50, v64
    v_sub_f32 v51, v51, v65
    v_lshlrev_b32 v64, 16, v58
    v_and_b32 v65, 0xffff0000, v58
    v_sub_f32 v52, v52, v64
    v_sub_f32 v53, v53, v65
    v_lshlrev_b32 v64, 16, v59
    v_and_b32 v65, 0xffff0000, v59
    v_sub_f32 v54, v54, v64
    v_sub_f32 v55, v55, v65
    v_cvt_pk_bf16_f32 v60, v48, v49
    v_cvt_pk_bf16_f32 v61, v50, v51
    v_cvt_pk_bf16_f32 v62, v52, v53
    v_cvt_pk_bf16_f32 v63, v54, v55
    s_lshl_b32 s30, s27, 11
    v_add_u32 v10, s30, v5
    ds_write_b128 v10, v[56:59]
    ds_write_b128 v10, v[60:63] offset:1024
K34_TABDONE:
    s_waitcnt lgkmcnt(0)
    s_barrier
    s_cmp_lt_u32 s3, s23
    s_cbranch_scc0 K34_IDLE
    ds_read_b128 v[48:51], v5 offset:0
    ds_read_b128 v[52:55], v5 offset:1024
    ds_read_b128 v[56:59], v5 offset:2048
    ds_read_b128 v[60:63], v5 offset:3072
    ds_read_b128 v[64:67], v5 offset:4096
    ds_read_b128 v[68:71], v5 offset:5120
    ds_read_b128 v[72:75], v5 offset:6144
    ds_read_b128 v[76:79], v5 offset:7168
    ds_read_b128 v[80:83], v5 offset:8192
    ds_read_b128 v[84:87], v5 offset:9216
    ds_read_b128 v[88:91], v5 offset:10240
    ds_read_b128 v[92:95], v5 offset:11264
    s_waitcnt vmcnt(0)
    v_swap_b32 v17, v20
    v_swap_b32 v18, v24
    v_swap_b32 v19, v28
    v_swap_b32 v22, v25
    v_swap_b32 v23, v29
    v_swap_b32 v27, v30
    v_swap_b32 v33, v36
    v_swap_b32 v34, v40
    v_swap_b32 v35, v44
    v_swap_b32 v38, v41
    v_swap_b32 v39, v45
    v_swap_b32 v43, v46
    s_waitcnt lgkmcnt(0)
    s_mul_i32 s24, s22, 48
    s_sub_u32 s24, 7985, s24
    s_cmp_ge_u32 s24, 48
    s_cbranch_scc1 K34_FULL
    v_add_u32 v7, 0, v3
    v_cmp_gt_u32 vcc, s24, v7
    s_nop 1
    v_cndmask_b32 v48, 0, v48, vcc
    v_cndmask_b32 v49, 0, v49, vcc
    v_cndmask_b32 v50, 0, v50, vcc
    v_cndmask_b32 v51, 0, v51, vcc
    v_cndmask_b32 v52, 0, v52, vcc
    v_cndmask_b32 v53, 0, v53, vcc
    v_cndmask_b32 v54, 0, v54, vcc
    v_cndmask_b32 v55, 0, v55, vcc
    v_cndmask_b32 v56, 0, v56, vcc
    v_cndmask_b32 v57, 0, v57, vcc
    v_cndmask_b32 v58, 0, v58, vcc
    v_cndmask_b32 v59, 0, v59, vcc
    v_cndmask_b32 v60, 0, v60, vcc
    v_cndmask_b32 v61, 0, v61, vcc
    v_cndmask_b32 v62, 0, v62, vcc
    v_cndmask_b32 v63, 0, v63, vcc
    v_add_u32 v7, 16, v3
    v_cmp_gt_u32 vcc, s24, v7
    s_nop 1
    v_cndmask_b32 v64, 0, v64, vcc
    v_cndmask_b32 v65, 0, v65, vcc
    v_cndmask_b32 v66, 0, v66, vcc
    v_cndmask_b32 v67, 0, v67, vcc
    v_cndmask_b32 v68, 0, v68, vcc
    v_cndmask_b32 v69, 0, v69, vcc
    v_cndmask_b32 v70, 0, v70, vcc
    v_cndmask_b32 v71, 0, v71, vcc
    v_cndmask_b32 v72, 0, v72, vcc
    v_cndmask_b32 v73, 0, v73, vcc
    v_cndmask_b32 v74, 0, v74, vcc
    v_cndmask_b32 v75, 0, v75, vcc
    v_cndmask_b32 v76, 0, v76, vcc
    v_cndmask_b32 v77, 0, v77, vcc
    v_cndmask_b32 v78, 0, v78, vcc
    v_cndmask_b32 v79, 0, v79, vcc
    v_add_u32 v7, 32, v3
    v_cmp_gt_u32 vcc, s24, v7
    s_nop 1
    v_cndmask_b32 v80, 0, v80, vcc
    v_cndmask_b32 v81, 0, v81, vcc
    v_cndmask_b32 v82, 0, v82, vcc
    v_cndmask_b32 v83, 0, v83, vcc
    v_cndmask_b32 v84, 0, v84, vcc
    v_cndmask_b32 v85, 0, v85, vcc
    v_cndmask_b32 v86, 0, v86, vcc
    v_cndmask_b32 v87, 0, v87, vcc
    v_cndmask_b32 v88, 0, v88, vcc
    v_cndmask_b32 v89, 0, v89, vcc
    v_cndmask_b32 v90, 0, v90, vcc
    v_cndmask_b32 v91, 0, v91, vcc
    v_cndmask_b32 v92, 0, v92, vcc
    v_cndmask_b32 v93, 0, v93, vcc
    v_cndmask_b32 v94, 0, v94, vcc
    v_cndmask_b32 v95, 0, v95, vcc
K34_FULL:
    s_nop 1
    v_mfma_f32_16x16x32_bf16 v[96:99], v[48:51], v[16:19], 0
    v_mfma_f32_16x16x32_bf16 v[100:103], v[48:51], v[20:23], 0
    v_mfma_f32_16x16x32_bf16 v[104:107], v[48:51], v[24:27], 0
    v_mfma_f32_16x16x32_bf16 v[108:111], v[48:51], v[28:31], 0
    v_mfma_f32_16x16x32_bf16 v[96:99], v[52:55], v[16:19], v[96:99]
    v_mfma_f32_16x16x32_bf16 v[100:103], v[52:55], v[20:23], v[100:103]
    v_mfma_f32_16x16x32_bf16 v[104:107], v[52:55], v[24:27], v[104:107]
    v_mfma_f32_16x16x32_bf16 v[108:111], v[52:55], v[28:31], v[108:111]
    v_mfma_f32_16x16x32_bf16 v[96:99], v[56:59], v[32:35], v[96:99]
    v_mfma_f32_16x16x32_bf16 v[100:103], v[56:59], v[36:39], v[100:103]
    v_mfma_f32_16x16x32_bf16 v[104:107], v[56:59], v[40:43], v[104:107]
    v_mfma_f32_16x16x32_bf16 v[108:111], v[56:59], v[44:47], v[108:111]
    v_mfma_f32_16x16x32_bf16 v[96:99], v[60:63], v[32:35], v[96:99]
    v_mfma_f32_16x16x32_bf16 v[100:103], v[60:63], v[36:39], v[100:103]
    v_mfma_f32_16x16x32_bf16 v[104:107], v[60:63], v[40:43], v[104:107]
    v_mfma_f32_16x16x32_bf16 v[108:111], v[60:63], v[44:47], v[108:111]
    v_mfma_f32_16x16x32_bf16 v[112:115], v[64:67], v[16:19], 0
    v_mfma_f32_16x16x32_bf16 v[116:119], v[64:67], v[20:23], 0
    v_mfma_f32_16x16x32_bf16 v[120:123], v[64:67], v[24:27], 0
    v_mfma_f32_16x16x32_bf16 v[124:127], v[64:67], v[28:31], 0
    v_mfma_f32_16x16x32_bf16 v[112:115], v[68:71], v[16:19], v[112:115]
    v_mfma_f32_16x16x32_bf16 v[116:119], v[68:71], v[20:23], v[116:119]
    v_mfma_f32_16x16x32_bf16 v[120:123], v[68:71], v[24:27], v[120:123]
    v_mfma_f32_16x16x32_bf16 v[124:127], v[68:71], v[28:31], v[124:127]
    v_mfma_f32_16x16x32_bf16 v[112:115], v[72:75], v[32:35], v[112:115]
    v_mfma_f32_16x16x32_bf16 v[116:119], v[72:75], v[36:39], v[116:119]
    v_mfma_f32_16x16x32_bf16 v[120:123], v[72:75], v[40:43], v[120:123]
    v_mfma_f32_16x16x32_bf16 v[124:127], v[72:75], v[44:47], v[124:127]
    v_mfma_f32_16x16x32_bf16 v[112:115], v[76:79], v[32:35], v[112:115]
    v_mfma_f32_16x16x32_bf16 v[116:119], v[76:79], v[36:39], v[116:119]
    v_mfma_f32_16x16x32_bf16 v[120:123], v[76:79], v[40:43], v[120:123]
    v_mfma_f32_16x16x32_bf16 v[124:127], v[76:79], v[44:47], v[124:127]
    v_mfma_f32_16x16x32_bf16 v[128:131], v[80:83], v[16:19], 0
    v_mfma_f32_16x16x32_bf16 v[132:135], v[80:83], v[20:23], 0
    v_mfma_f32_16x16x32_bf16 v[136:139], v[80:83], v[24:27], 0
    v_mfma_f32_16x16x32_bf16 v[140:143], v[80:83], v[28:31], 0
    v_mfma_f32_16x16x32_bf16 v[128:131], v[84:87], v[16:19], v[128:131]
    v_mfma_f32_16x16x32_bf16 v[132:135], v[84:87], v[20:23], v[132:135]
    v_mfma_f32_16x16x32_bf16 v[136:139], v[84:87], v[24:27], v[136:139]
    v_mfma_f32_16x16x32_bf16 v[140:143], v[84:87], v[28:31], v[140:143]
    v_mfma_f32_16x16x32_bf16 v[128:131], v[88:91], v[32:35], v[128:131]
    v_mfma_f32_16x16x32_bf16 v[132:135], v[88:91], v[36:39], v[132:135]
    v_mfma_f32_16x16x32_bf16 v[136:139], v[88:91], v[40:43], v[136:139]
    v_mfma_f32_16x16x32_bf16 v[140:143], v[88:91], v[44:47], v[140:143]
    v_mfma_f32_16x16x32_bf16 v[128:131], v[92:95], v[32:35], v[128:131]
    v_mfma_f32_16x16x32_bf16 v[132:135], v[92:95], v[36:39], v[132:135]
    v_mfma_f32_16x16x32_bf16 v[136:139], v[92:95], v[40:43], v[136:139]
    v_mfma_f32_16x16x32_bf16 v[140:143], v[92:95], v[44:47], v[140:143]
    s_nop 7
    v_mov_b32 v16, v96
    v_mul_f32 v20, v96, v96
    v_mov_b32 v17, v100
    v_mul_f32 v21, v100, v100
    v_mov_b32 v18, v104
    v_mul_f32 v22, v104, v104
    v_mov_b32 v19, v108
    v_mul_f32 v23, v108, v108
    v_add_f32 v16, v16, v97
    v_fmac_f32 v20, v97, v97
    v_add_f32 v17, v17, v101
    v_fmac_f32 v21, v101, v101
    v_add_f32 v18, v18, v105
    v_fmac_f32 v22, v105, v105
    v_add_f32 v19, v19, v109
    v_fmac_f32 v23, v109, v109
    v_add_f32 v16, v16, v98
    v_fmac_f32 v20, v98, v98
    v_add_f32 v17, v17, v102
    v_fmac_f32 v21, v102, v102
    v_add_f32 v18, v18, v106
    v_fmac_f32 v22, v106, v106
    v_add_f32 v19, v19, v110
    v_fmac_f32 v23, v110, v110
    v_add_f32 v16, v16, v99
    v_fmac_f32 v20, v99, v99
    v_add_f32 v17, v17, v103
    v_fmac_f32 v21, v103, v103
    v_add_f32 v18, v18, v107
    v_fmac_f32 v22, v107, v107
    v_add_f32 v19, v19, v111
    v_fmac_f32 v23, v111, v111
    v_add_f32 v16, v16, v112
    v_fmac_f32 v20, v112, v112
    v_add_f32 v17, v17, v116
    v_fmac_f32 v21, v116, v116
    v_add_f32 v18, v18, v120
    v_fmac_f32 v22, v120, v120
    v_add_f32 v19, v19, v124
    v_fmac_f32 v23, v124, v124
    v_add_f32 v16, v16, v113
    v_fmac_f32 v20, v113, v113
    v_add_f32 v17, v17, v117
    v_fmac_f32 v21, v117, v117
    v_add_f32 v18, v18, v121
    v_fmac_f32 v22, v121, v121
    v_add_f32 v19, v19, v125
    v_fmac_f32 v23, v125, v125
    v_add_f32 v16, v16, v114
    v_fmac_f32 v20, v114, v114
    v_add_f32 v17, v17, v118
    v_fmac_f32 v21, v118, v118
    v_add_f32 v18, v18, v122
    v_fmac_f32 v22, v122, v122
    v_add_f32 v19, v19, v126
    v_fmac_f32 v23, v126, v126
    v_add_f32 v16, v16, v115
    v_fmac_f32 v20, v115, v115
    v_add_f32 v17, v17, v119
    v_fmac_f32 v21, v119, v119
    v_add_f32 v18, v18, v123
    v_fmac_f32 v22, v123, v123
    v_add_f32 v19, v19, v127
    v_fmac_f32 v23, v127, v127
    v_add_f32 v16, v16, v128
    v_fmac_f32 v20, v128, v128
    v_add_f32 v17, v17, v132
    v_fmac_f32 v21, v132, v132
    v_add_f32 v18, v18, v136
    v_fmac_f32 v22, v136, v136
    v_add_f32 v19, v19, v140
    v_fmac_f32 v23, v140, v140
    v_add_f32 v16, v16, v129
    v_fmac_f32 v20, v129, v129
    v_add_f32 v17, v17, v133
    v_fmac_f32 v21, v133, v133
    v_add_f32 v18, v18, v137
    v_fmac_f32 v22, v137, v137
    v_add_f32 v19, v19, v141
    v_fmac_f32 v23, v141, v141
    v_add_f32 v16, v16, v130
    v_fmac_f32 v20, v130, v130
    v_add_f32 v17, v17, v134
    v_fmac_f32 v21, v134, v134
    v_add_f32 v18, v18, v138
    v_fmac_f32 v22, v138, v138
    v_add_f32 v19, v19, v142
    v_fmac_f32 v23, v142, v142
    v_add_f32 v16, v16, v131
    v_fmac_f32 v20, v131, v131
    v_add_f32 v17, v17, v135
    v_fmac_f32 v21, v135, v135
    v_add_f32 v18, v18, v139
    v_fmac_f32 v22, v139, v139
    v_add_f32 v19, v19, v143
    v_fmac_f32 v23, v143, v143
    v_mov_b32 v24, v16
    v_mov_b32 v25, v17
    v_mov_b32 v26, v18
    v_mov_b32 v27, v19
    v_mov_b32 v28, v20
    v_mov_b32 v29, v21
    v_mov_b32 v30, v22
    v_mov_b32 v31, v23
    s_nop 0
    v_permlane32_swap_b32 v16, v24
    v_permlane32_swap_b32 v17, v25
    v_permlane32_swap_b32 v18, v26
    v_permlane32_swap_b32 v19, v27
    v_permlane32_swap_b32 v20, v28
    v_permlane32_swap_b32 v21, v29
    v_permlane32_swap_b32 v22, v30
    v_permlane32_swap_b32 v23, v31
    v_add_f32 v16, v16, v24
    v_add_f32 v17, v17, v25
    v_add_f32 v18, v18, v26
    v_add_f32 v19, v19, v27
    v_add_f32 v20, v20, v28
    v_add_f32 v21, v21, v29
    v_add_f32 v22, v22, v30
    v_add_f32 v23, v23, v31
    v_mov_b32 v24, v16
    v_mov_b32 v25, v17
    v_mov_b32 v26, v18
    v_mov_b32 v27, v19
    v_mov_b32 v28, v20
    v_mov_b32 v29, v21
    v_mov_b32 v30, v22
    v_mov_b32 v31, v23
    s_nop 0
    v_permlane16_swap_b32 v16, v24
    v_permlane16_swap_b32 v17, v25
    v_permlane16_swap_b32 v18, v26
    v_permlane16_swap_b32 v19, v27
    v_permlane16_swap_b32 v20, v28
    v_permlane16_swap_b32 v21, v29
    v_permlane16_swap_b32 v22, v30
    v_permlane16_swap_b32 v23, v31
    v_add_f32 v16, v16, v24
    v_add_f32 v17, v17, v25
    v_add_f32 v18, v18, v26
    v_add_f32 v19, v19, v27
    v_add_f32 v20, v20, v28
    v_add_f32 v21, v21, v29
    v_add_f32 v22, v22, v30
    v_add_f32 v23, v23, v31
    s_branch K34_WR
K34_IDLE:
    v_mov_b32 v16, 0
    v_mov_b32 v17, 0
    v_mov_b32 v18, 0
    v_mov_b32 v19, 0
    v_mov_b32 v20, 0
    v_mov_b32 v21, 0
    v_mov_b32 v22, 0
    v_mov_b32 v23, 0
K34_WR:
    s_lshl_b32 s24, s3, 9
    v_lshlrev_b32 v7, 4, v3
    v_add_u32 v7, s24, v7
    ds_write_b128 v7, v[16:19] offset:12288
    ds_write_b128 v7, v[20:23] offset:12544
    s_waitcnt lgkmcnt(0)
    s_barrier
    s_cmp_lg_u32 s3, 0
    s_cbranch_scc1 K34_WAIT
    v_lshlrev_b32 v7, 2, v2
    ds_read_b32 v16, v7 offset:12288
    ds_read_b32 v17, v7 offset:12800
    ds_read_b32 v18, v7 offset:13312
    ds_read_b32 v19, v7 offset:13824
    ds_read_b32 v20, v7 offset:14336
    ds_read_b32 v21, v7 offset:14848
    ds_read_b32 v22, v7 offset:15360
    ds_read_b32 v23, v7 offset:15872
    ds_read_b32 v24, v7 offset:16384
    ds_read_b32 v25, v7 offset:16896
    ds_read_b32 v26, v7 offset:17408
    ds_read_b32 v27, v7 offset:17920
    s_waitcnt lgkmcnt(0)
    ds_read_b32 v32, v7 offset:12544
    ds_read_b32 v33, v7 offset:13056
    ds_read_b32 v34, v7 offset:13568
    ds_read_b32 v35, v7 offset:14080
    ds_read_b32 v36, v7 offset:14592
    ds_read_b32 v37, v7 offset:15104
    ds_read_b32 v38, v7 offset:15616
    ds_read_b32 v39, v7 offset:16128
    ds_read_b32 v40, v7 offset:16640
    ds_read_b32 v41, v7 offset:17152
    ds_read_b32 v42, v7 offset:17664
    ds_read_b32 v43, v7 offset:18176
    v_add_f32 v16, v16, v17
    v_add_f32 v16, v16, v18
    v_add_f32 v16, v16, v19
    v_add_f32 v16, v16, v20
    v_add_f32 v16, v16, v21
    v_add_f32 v16, v16, v22
    v_add_f32 v16, v16, v23
    v_add_f32 v16, v16, v24
    v_add_f32 v16, v16, v25
    v_add_f32 v16, v16, v26
    v_add_f32 v16, v16, v27
    s_waitcnt lgkmcnt(0)
    v_add_f32 v32, v32, v33
    v_add_f32 v32, v32, v34
    v_add_f32 v32, v32, v35
    v_add_f32 v32, v32, v36
    v_add_f32 v32, v32, v37
    v_add_f32 v32, v32, v38
    v_add_f32 v32, v32, v39
    v_add_f32 v32, v32, v40
    v_add_f32 v32, v32, v41
    v_add_f32 v32, v32, v42
    v_add_f32 v32, v32, v43
    s_lshl_b32 s24, s6, 4
    s_add_u32 s24, s24, s7
    s_lshl_b32 s24, s24, 9
    buffer_store_dword v16, v7, s[12:15], s24 offen sc1
    buffer_store_dword v32, v7, s[12:15], s24 offen offset:256 sc1
    s_mov_b32 s26, 20000
K34_POLL:
    s_lshl_b32 s24, s6, 13
    buffer_load_dword v16, v7, s[12:15], s24 offen offset:0 sc1
    buffer_load_dword v32, v7, s[12:15], s24 offen offset:256 sc1
    buffer_load_dword v17, v7, s[12:15], s24 offen offset:512 sc1
    buffer_load_dword v33, v7, s[12:15], s24 offen offset:768 sc1
    buffer_load_dword v18, v7, s[12:15], s24 offen offset:1024 sc1
    buffer_load_dword v34, v7, s[12:15], s24 offen offset:1280 sc1
    buffer_load_dword v19, v7, s[12:15], s24 offen offset:1536 sc1
    buffer_load_dword v35, v7, s[12:15], s24 offen offset:1792 sc1
    buffer_load_dword v20, v7, s[12:15], s24 offen offset:2048 sc1
    buffer_load_dword v36, v7, s[12:15], s24 offen offset:2304 sc1
    buffer_load_dword v21, v7, s[12:15], s24 offen offset:2560 sc1
    buffer_load_dword v37, v7, s[12:15], s24 offen offset:2816 sc1
    buffer_load_dword v22, v7, s[12:15], s24 offen offset:3072 sc1
    buffer_load_dword v38, v7, s[12:15], s24 offen offset:3328 sc1
    buffer_load_dword v23, v7, s[12:15], s24 offen offset:3584 sc1
    buffer_load_dword v39, v7, s[12:15], s24 offen offset:3840 sc1
    s_add_u32 s24, s24, 4096
    buffer_load_dword v24, v7, s[12:15], s24 offen offset:0 sc1
    buffer_load_dword v40, v7, s[12:15], s24 offen offset:256 sc1
    buffer_load_dword v25, v7, s[12:15], s24 offen offset:512 sc1
    buffer_load_dword v41, v7, s[12:15], s24 offen offset:768 sc1
    buffer_load_dword v26, v7, s[12:15], s24 offen offset:1024 sc1
    buffer_load_dword v42, v7, s[12:15], s24 offen offset:1280 sc1
    buffer_load_dword v27, v7, s[12:15], s24 offen offset:1536 sc1
    buffer_load_dword v43, v7, s[12:15], s24 offen offset:1792 sc1
    buffer_load_dword v28, v7, s[12:15], s24 offen offset:2048 sc1
    buffer_load_dword v44, v7, s[12:15], s24 offen offset:2304 sc1
    buffer_load_dword v29, v7, s[12:15], s24 offen offset:2560 sc1
    buffer_load_dword v45, v7, s[12:15], s24 offen offset:2816 sc1
    buffer_load_dword v30, v7, s[12:15], s24 offen offset:3072 sc1
    buffer_load_dword v46, v7, s[12:15], s24 offen offset:3328 sc1
    buffer_load_dword v31, v7, s[12:15], s24 offen offset:3584 sc1
    buffer_load_dword v47, v7, s[12:15], s24 offen offset:3840 sc1
    s_waitcnt vmcnt(0)
    v_max3_u32 v48, v16, v17, v18
    v_max3_u32 v48, v48, v19, v20
    v_max3_u32 v48, v48, v21, v22
    v_max3_u32 v48, v48, v23, v24
    v_max3_u32 v48, v48, v25, v26
    v_max3_u32 v48, v48, v27, v28
    v_max3_u32 v48, v48, v29, v30
    v_max3_u32 v48, v48, v31, v32
    v_max3_u32 v48, v48, v33, v34
    v_max3_u32 v48, v48, v35, v36
    v_max3_u32 v48, v48, v37, v38
    v_max3_u32 v48, v48, v39, v40
    v_max3_u32 v48, v48, v41, v42
    v_max3_u32 v48, v48, v43, v44
    v_max3_u32 v48, v48, v45, v46
    v_max_u32 v48, v48, v47
    v_cmp_eq_u32 vcc, -1, v48
    s_sub_u32 s26, s26, 1
    s_cmp_eq_u32 s26, 0
    s_cbranch_scc1 K34_GOT
    s_cbranch_vccz K34_GOT
    s_sleep 1
    s_branch K34_POLL
K34_GOT:
    v_add_f32 v16, v16, v24
    v_add_f32 v32, v32, v40
    v_add_f32 v17, v17, v25
    v_add_f32 v33, v33, v41
    v_add_f32 v18, v18, v26
    v_add_f32 v34, v34, v42
    v_add_f32 v19, v19, v27
    v_add_f32 v35, v35, v43
    v_add_f32 v20, v20, v28
    v_add_f32 v36, v36, v44
    v_add_f32 v21, v21, v29
    v_add_f32 v37, v37, v45
    v_add_f32 v22, v22, v30
    v_add_f32 v38, v38, v46
    v_add_f32 v23, v23, v31
    v_add_f32 v39, v39, v47
    v_add_f32 v16, v16, v20
    v_add_f32 v32, v32, v36
    v_add_f32 v17, v17, v21
    v_add_f32 v33, v33, v37
    v_add_f32 v18, v18, v22
    v_add_f32 v34, v34, v38
    v_add_f32 v19, v19, v23
    v_add_f32 v35, v35, v39
    v_add_f32 v16, v16, v18
    v_add_f32 v32, v32, v34
    v_add_f32 v17, v17, v19
    v_add_f32 v33, v33, v35
    v_add_f32 v16, v16, v17
    v_add_f32 v32, v32, v33
    v_mul_f32 v11, 0x39035177, v16
    v_mul_f32 v12, 0x39035177, v32
    v_fma_f32 v12, -v11, v11, v12
    v_max_f32 v12, 0, v12
    v_add_f32 v12, 0x3727c5ac, v12
    v_sqrt_f32 v12, v12
    v_lshlrev_b32 v9, 16, v152
    v_rcp_f32 v12, v12
    v_lshlrev_b32 v10, 16, v153
    v_mul_f32 v9, v9, v12
    v_fma_f32 v10, -v11, v9, v10
    ds_write_b32 v7, v9 offset:18432
    ds_write_b32 v7, v10 offset:18688
    s_waitcnt lgkmcnt(0)
K34_WAIT:
    s_barrier
    s_cmp_lt_u32 s3, s23
    s_cbranch_scc0 K34_END
    v_lshlrev_b32 v7, 4, v3
    ds_read_b128 v[144:147], v7 offset:18432
    ds_read_b128 v[148:151], v7 offset:18688
    s_mul_i32 s24, s20, 8176640
    s_add_u32 s16, s44, s24
    s_addc_u32 s17, s45, 0
    s_and_b32 s17, s17, 0xffff
    s_mov_b32 s18, 8176640
    s_mov_b32 s19, 0x00020000
    v_lshlrev_b32 v7, 12, v4
    v_lshl_add_u32 v7, v3, 3, v7
    s_lshl_b32 s24, s21, 7
    v_add_u32 v7, s24, v7
    s_mul_i32 s25, s22, 49152
    s_mov_b32 s30, 0xc0135761
    s_mov_b32 s31, 0xbdd2d3e8
    v_mov_b32 v15, s30
    s_waitcnt lgkmcnt(0)
    v_fma_f32 v16, v96, v144, v148
    v_fma_f32 v17, v100, v145, v149
    v_fma_f32 v18, v104, v146, v150
    v_fma_f32 v19, v108, v147, v151
    v_fma_f32 v20, v97, v144, v148
    v_fma_f32 v21, v101, v145, v149
    v_fma_f32 v22, v105, v146, v150
    v_fma_f32 v23, v109, v147, v151
    v_mul_f32 v24, v16, v16
    v_mul_f32 v25, v17, v17
    v_mul_f32 v26, v18, v18
    v_mul_f32 v27, v19, v19
    v_mul_f32 v28, v20, v20
    v_mul_f32 v29, v21, v21
    v_mul_f32 v30, v22, v22
    v_mul_f32 v31, v23, v23
    v_fma_f32 v24, v24, s31, v15
    v_fma_f32 v25, v25, s31, v15
    v_fma_f32 v26, v26, s31, v15
    v_fma_f32 v27, v27, s31, v15
    v_fma_f32 v28, v28, s31, v15
    v_fma_f32 v29, v29, s31, v15
    v_fma_f32 v30, v30, s31, v15
    v_fma_f32 v31, v31, s31, v15
    v_mul_f32 v24, v24, v16
    v_mul_f32 v25, v25, v17
    v_mul_f32 v26, v26, v18
    v_mul_f32 v27, v27, v19
    v_mul_f32 v28, v28, v20
    v_mul_f32 v29, v29, v21
    v_mul_f32 v30, v30, v22
    v_mul_f32 v31, v31, v23
    v_exp_f32 v24, v24
    v_exp_f32 v25, v25
    v_exp_f32 v26, v26
    v_exp_f32 v27, v27
    v_exp_f32 v28, v28
    v_exp_f32 v29, v29
    v_exp_f32 v30, v30
    v_exp_f32 v31, v31
    v_add_f32 v24, 1.0, v24
    v_add_f32 v25, 1.0, v25
    v_add_f32 v26, 1.0, v26
    v_add_f32 v27, 1.0, v27
    v_add_f32 v28, 1.0, v28
    v_add_f32 v29, 1.0, v29
    v_add_f32 v30, 1.0, v30
    v_add_f32 v31, 1.0, v31
    v_rcp_f32 v24, v24
    v_rcp_f32 v25, v25
    v_rcp_f32 v26, v26
    v_rcp_f32 v27, v27
    v_rcp_f32 v28, v28
    v_rcp_f32 v29, v29
    v_rcp_f32 v30, v30
    v_rcp_f32 v31, v31
    v_mul_f32 v16, v16, v24
    v_mul_f32 v17, v17, v25
    v_mul_f32 v18, v18, v26
    v_mul_f32 v19, v19, v27
    v_mul_f32 v20, v20, v28
    v_mul_f32 v21, v21, v29
    v_mul_f32 v22, v22, v30
    v_mul_f32 v23, v23, v31
    v_cvt_pk_bf16_f32 v32, v16, v17
    v_cvt_pk_bf16_f32 v33, v18, v19
    buffer_store_dwordx2 v[32:33], v7, s[16:19], s25 offen offset:0 sc1
    v_cvt_pk_bf16_f32 v34, v20, v21
    v_cvt_pk_bf16_f32 v35, v22, v23
    buffer_store_dwordx2 v[34:35], v7, s[16:19], s25 offen offset:1024 sc1
    s_add_u32 s25, s25, 2048
    v_fma_f32 v36, v98, v144, v148
    v_fma_f32 v37, v102, v145, v149
    v_fma_f32 v38, v106, v146, v150
    v_fma_f32 v39, v110, v147, v151
    v_fma_f32 v40, v99, v144, v148
    v_fma_f32 v41, v103, v145, v149
    v_fma_f32 v42, v107, v146, v150
    v_fma_f32 v43, v111, v147, v151
    v_mul_f32 v44, v36, v36
    v_mul_f32 v45, v37, v37
    v_mul_f32 v46, v38, v38
    v_mul_f32 v47, v39, v39
    v_mul_f32 v48, v40, v40
    v_mul_f32 v49, v41, v41
    v_mul_f32 v50, v42, v42
    v_mul_f32 v51, v43, v43
    v_fma_f32 v44, v44, s31, v15
    v_fma_f32 v45, v45, s31, v15
    v_fma_f32 v46, v46, s31, v15
    v_fma_f32 v47, v47, s31, v15
    v_fma_f32 v48, v48, s31, v15
    v_fma_f32 v49, v49, s31, v15
    v_fma_f32 v50, v50, s31, v15
    v_fma_f32 v51, v51, s31, v15
    v_mul_f32 v44, v44, v36
    v_mul_f32 v45, v45, v37
    v_mul_f32 v46, v46, v38
    v_mul_f32 v47, v47, v39
    v_mul_f32 v48, v48, v40
    v_mul_f32 v49, v49, v41
    v_mul_f32 v50, v50, v42
    v_mul_f32 v51, v51, v43
    v_exp_f32 v44, v44
    v_exp_f32 v45, v45
    v_exp_f32 v46, v46
    v_exp_f32 v47, v47
    v_exp_f32 v48, v48
    v_exp_f32 v49, v49
    v_exp_f32 v50, v50
    v_exp_f32 v51, v51
    v_add_f32 v44, 1.0, v44
    v_add_f32 v45, 1.0, v45
    v_add_f32 v46, 1.0, v46
    v_add_f32 v47, 1.0, v47
    v_add_f32 v48, 1.0, v48
    v_add_f32 v49, 1.0, v49
    v_add_f32 v50, 1.0, v50
    v_add_f32 v51, 1.0, v51
    v_rcp_f32 v44, v44
    v_rcp_f32 v45, v45
    v_rcp_f32 v46, v46
    v_rcp_f32 v47, v47
    v_rcp_f32 v48, v48
    v_rcp_f32 v49, v49
    v_rcp_f32 v50, v50
    v_rcp_f32 v51, v51
    v_mul_f32 v36, v36, v44
    v_mul_f32 v37, v37, v45
    v_mul_f32 v38, v38, v46
    v_mul_f32 v39, v39, v47
    v_mul_f32 v40, v40, v48
    v_mul_f32 v41, v41, v49
    v_mul_f32 v42, v42, v50
    v_mul_f32 v43, v43, v51
    v_cvt_pk_bf16_f32 v52, v36, v37
    v_cvt_pk_bf16_f32 v53, v38, v39
    buffer_store_dwordx2 v[52:53], v7, s[16:19], s25 offen offset:0 sc1
    v_cvt_pk_bf16_f32 v54, v40, v41
    v_cvt_pk_bf16_f32 v55, v42, v43
    buffer_store_dwordx2 v[54:55], v7, s[16:19], s25 offen offset:1024 sc1
    s_add_u32 s25, s25, 2048
    s_add_u32 s25, s25, 12288
    v_fma_f32 v16, v112, v144, v148
    v_fma_f32 v17, v116, v145, v149
    v_fma_f32 v18, v120, v146, v150
    v_fma_f32 v19, v124, v147, v151
    v_fma_f32 v20, v113, v144, v148
    v_fma_f32 v21, v117, v145, v149
    v_fma_f32 v22, v121, v146, v150
    v_fma_f32 v23, v125, v147, v151
    v_mul_f32 v24, v16, v16
    v_mul_f32 v25, v17, v17
    v_mul_f32 v26, v18, v18
    v_mul_f32 v27, v19, v19
    v_mul_f32 v28, v20, v20
    v_mul_f32 v29, v21, v21
    v_mul_f32 v30, v22, v22
    v_mul_f32 v31, v23, v23
    v_fma_f32 v24, v24, s31, v15
    v_fma_f32 v25, v25, s31, v15
    v_fma_f32 v26, v26, s31, v15
    v_fma_f32 v27, v27, s31, v15
    v_fma_f32 v28, v28, s31, v15
    v_fma_f32 v29, v29, s31, v15
    v_fma_f32 v30, v30, s31, v15
    v_fma_f32 v31, v31, s31, v15
    v_mul_f32 v24, v24, v16
    v_mul_f32 v25, v25, v17
    v_mul_f32 v26, v26, v18
    v_mul_f32 v27, v27, v19
    v_mul_f32 v28, v28, v20
    v_mul_f32 v29, v29, v21
    v_mul_f32 v30, v30, v22
    v_mul_f32 v31, v31, v23
    v_exp_f32 v24, v24
    v_exp_f32 v25, v25
    v_exp_f32 v26, v26
    v_exp_f32 v27, v27
    v_exp_f32 v28, v28
    v_exp_f32 v29, v29
    v_exp_f32 v30, v30
    v_exp_f32 v31, v31
    v_add_f32 v24, 1.0, v24
    v_add_f32 v25, 1.0, v25
    v_add_f32 v26, 1.0, v26
    v_add_f32 v27, 1.0, v27
    v_add_f32 v28, 1.0, v28
    v_add_f32 v29, 1.0, v29
    v_add_f32 v30, 1.0, v30
    v_add_f32 v31, 1.0, v31
    v_rcp_f32 v24, v24
    v_rcp_f32 v25, v25
    v_rcp_f32 v26, v26
    v_rcp_f32 v27, v27
    v_rcp_f32 v28, v28
    v_rcp_f32 v29, v29
    v_rcp_f32 v30, v30
    v_rcp_f32 v31, v31
    v_mul_f32 v16, v16, v24
    v_mul_f32 v17, v17, v25
    v_mul_f32 v18, v18, v26
    v_mul_f32 v19, v19, v27
    v_mul_f32 v20, v20, v28
    v_mul_f32 v21, v21, v29
    v_mul_f32 v22, v22, v30
    v_mul_f32 v23, v23, v31
    v_cvt_pk_bf16_f32 v32, v16, v17
    v_cvt_pk_bf16_f32 v33, v18, v19
    buffer_store_dwordx2 v[32:33], v7, s[16:19], s25 offen offset:0 sc1
    v_cvt_pk_bf16_f32 v34, v20, v21
    v_cvt_pk_bf16_f32 v35, v22, v23
    buffer_store_dwordx2 v[34:35], v7, s[16:19], s25 offen offset:1024 sc1
    s_add_u32 s25, s25, 2048
    v_fma_f32 v36, v114, v144, v148
    v_fma_f32 v37, v118, v145, v149
    v_fma_f32 v38, v122, v146, v150
    v_fma_f32 v39, v126, v147, v151
    v_fma_f32 v40, v115, v144, v148
    v_fma_f32 v41, v119, v145, v149
    v_fma_f32 v42, v123, v146, v150
    v_fma_f32 v43, v127, v147, v151
    v_mul_f32 v44, v36, v36
    v_mul_f32 v45, v37, v37
    v_mul_f32 v46, v38, v38
    v_mul_f32 v47, v39, v39
    v_mul_f32 v48, v40, v40
    v_mul_f32 v49, v41, v41
    v_mul_f32 v50, v42, v42
    v_mul_f32 v51, v43, v43
    v_fma_f32 v44, v44, s31, v15
    v_fma_f32 v45, v45, s31, v15
    v_fma_f32 v46, v46, s31, v15
    v_fma_f32 v47, v47, s31, v15
    v_fma_f32 v48, v48, s31, v15
    v_fma_f32 v49, v49, s31, v15
    v_fma_f32 v50, v50, s31, v15
    v_fma_f32 v51, v51, s31, v15
    v_mul_f32 v44, v44, v36
    v_mul_f32 v45, v45, v37
    v_mul_f32 v46, v46, v38
    v_mul_f32 v47, v47, v39
    v_mul_f32 v48, v48, v40
    v_mul_f32 v49, v49, v41
    v_mul_f32 v50, v50, v42
    v_mul_f32 v51, v51, v43
    v_exp_f32 v44, v44
    v_exp_f32 v45, v45
    v_exp_f32 v46, v46
    v_exp_f32 v47, v47
    v_exp_f32 v48, v48
    v_exp_f32 v49, v49
    v_exp_f32 v50, v50
    v_exp_f32 v51, v51
    v_add_f32 v44, 1.0, v44
    v_add_f32 v45, 1.0, v45
    v_add_f32 v46, 1.0, v46
    v_add_f32 v47, 1.0, v47
    v_add_f32 v48, 1.0, v48
    v_add_f32 v49, 1.0, v49
    v_add_f32 v50, 1.0, v50
    v_add_f32 v51, 1.0, v51
    v_rcp_f32 v44, v44
    v_rcp_f32 v45, v45
    v_rcp_f32 v46, v46
    v_rcp_f32 v47, v47
    v_rcp_f32 v48, v48
    v_rcp_f32 v49, v49
    v_rcp_f32 v50, v50
    v_rcp_f32 v51, v51
    v_mul_f32 v36, v36, v44
    v_mul_f32 v37, v37, v45
    v_mul_f32 v38, v38, v46
    v_mul_f32 v39, v39, v47
    v_mul_f32 v40, v40, v48
    v_mul_f32 v41, v41, v49
    v_mul_f32 v42, v42, v50
    v_mul_f32 v43, v43, v51
    v_cvt_pk_bf16_f32 v52, v36, v37
    v_cvt_pk_bf16_f32 v53, v38, v39
    buffer_store_dwordx2 v[52:53], v7, s[16:19], s25 offen offset:0 sc1
    v_cvt_pk_bf16_f32 v54, v40, v41
    v_cvt_pk_bf16_f32 v55, v42, v43
    buffer_store_dwordx2 v[54:55], v7, s[16:19], s25 offen offset:1024 sc1
    s_add_u32 s25, s25, 2048
    s_add_u32 s25, s25, 12288
    v_fma_f32 v16, v128, v144, v148
    v_fma_f32 v17, v132, v145, v149
    v_fma_f32 v18, v136, v146, v150
    v_fma_f32 v19, v140, v147, v151
    v_fma_f32 v20, v129, v144, v148
    v_fma_f32 v21, v133, v145, v149
    v_fma_f32 v22, v137, v146, v150
    v_fma_f32 v23, v141, v147, v151
    v_mul_f32 v24, v16, v16
    v_mul_f32 v25, v17, v17
    v_mul_f32 v26, v18, v18
    v_mul_f32 v27, v19, v19
    v_mul_f32 v28, v20, v20
    v_mul_f32 v29, v21, v21
    v_mul_f32 v30, v22, v22
    v_mul_f32 v31, v23, v23
    v_fma_f32 v24, v24, s31, v15
    v_fma_f32 v25, v25, s31, v15
    v_fma_f32 v26, v26, s31, v15
    v_fma_f32 v27, v27, s31, v15
    v_fma_f32 v28, v28, s31, v15
    v_fma_f32 v29, v29, s31, v15
    v_fma_f32 v30, v30, s31, v15
    v_fma_f32 v31, v31, s31, v15
    v_mul_f32 v24, v24, v16
    v_mul_f32 v25, v25, v17
    v_mul_f32 v26, v26, v18
    v_mul_f32 v27, v27, v19
    v_mul_f32 v28, v28, v20
    v_mul_f32 v29, v29, v21
    v_mul_f32 v30, v30, v22
    v_mul_f32 v31, v31, v23
    v_exp_f32 v24, v24
    v_exp_f32 v25, v25
    v_exp_f32 v26, v26
    v_exp_f32 v27, v27
    v_exp_f32 v28, v28
    v_exp_f32 v29, v29
    v_exp_f32 v30, v30
    v_exp_f32 v31, v31
    v_add_f32 v24, 1.0, v24
    v_add_f32 v25, 1.0, v25
    v_add_f32 v26, 1.0, v26
    v_add_f32 v27, 1.0, v27
    v_add_f32 v28, 1.0, v28
    v_add_f32 v29, 1.0, v29
    v_add_f32 v30, 1.0, v30
    v_add_f32 v31, 1.0, v31
    v_rcp_f32 v24, v24
    v_rcp_f32 v25, v25
    v_rcp_f32 v26, v26
    v_rcp_f32 v27, v27
    v_rcp_f32 v28, v28
    v_rcp_f32 v29, v29
    v_rcp_f32 v30, v30
    v_rcp_f32 v31, v31
    v_mul_f32 v16, v16, v24
    v_mul_f32 v17, v17, v25
    v_mul_f32 v18, v18, v26
    v_mul_f32 v19, v19, v27
    v_mul_f32 v20, v20, v28
    v_mul_f32 v21, v21, v29
    v_mul_f32 v22, v22, v30
    v_mul_f32 v23, v23, v31
    v_cvt_pk_bf16_f32 v32, v16, v17
    v_cvt_pk_bf16_f32 v33, v18, v19
    buffer_store_dwordx2 v[32:33], v7, s[16:19], s25 offen offset:0 sc1
    v_cvt_pk_bf16_f32 v34, v20, v21
    v_cvt_pk_bf16_f32 v35, v22, v23
    buffer_store_dwordx2 v[34:35], v7, s[16:19], s25 offen offset:1024 sc1
    s_add_u32 s25, s25, 2048
    v_fma_f32 v36, v130, v144, v148
    v_fma_f32 v37, v134, v145, v149
    v_fma_f32 v38, v138, v146, v150
    v_fma_f32 v39, v142, v147, v151
    v_fma_f32 v40, v131, v144, v148
    v_fma_f32 v41, v135, v145, v149
    v_fma_f32 v42, v139, v146, v150
    v_fma_f32 v43, v143, v147, v151
    v_mul_f32 v44, v36, v36
    v_mul_f32 v45, v37, v37
    v_mul_f32 v46, v38, v38
    v_mul_f32 v47, v39, v39
    v_mul_f32 v48, v40, v40
    v_mul_f32 v49, v41, v41
    v_mul_f32 v50, v42, v42
    v_mul_f32 v51, v43, v43
    v_fma_f32 v44, v44, s31, v15
    v_fma_f32 v45, v45, s31, v15
    v_fma_f32 v46, v46, s31, v15
    v_fma_f32 v47, v47, s31, v15
    v_fma_f32 v48, v48, s31, v15
    v_fma_f32 v49, v49, s31, v15
    v_fma_f32 v50, v50, s31, v15
    v_fma_f32 v51, v51, s31, v15
    v_mul_f32 v44, v44, v36
    v_mul_f32 v45, v45, v37
    v_mul_f32 v46, v46, v38
    v_mul_f32 v47, v47, v39
    v_mul_f32 v48, v48, v40
    v_mul_f32 v49, v49, v41
    v_mul_f32 v50, v50, v42
    v_mul_f32 v51, v51, v43
    v_exp_f32 v44, v44
    v_exp_f32 v45, v45
    v_exp_f32 v46, v46
    v_exp_f32 v47, v47
    v_exp_f32 v48, v48
    v_exp_f32 v49, v49
    v_exp_f32 v50, v50
    v_exp_f32 v51, v51
    v_add_f32 v44, 1.0, v44
    v_add_f32 v45, 1.0, v45
    v_add_f32 v46, 1.0, v46
    v_add_f32 v47, 1.0, v47
    v_add_f32 v48, 1.0, v48
    v_add_f32 v49, 1.0, v49
    v_add_f32 v50, 1.0, v50
    v_add_f32 v51, 1.0, v51
    v_rcp_f32 v44, v44
    v_rcp_f32 v45, v45
    v_rcp_f32 v46, v46
    v_rcp_f32 v47, v47
    v_rcp_f32 v48, v48
    v_rcp_f32 v49, v49
    v_rcp_f32 v50, v50
    v_rcp_f32 v51, v51
    v_mul_f32 v36, v36, v44
    v_mul_f32 v37, v37, v45
    v_mul_f32 v38, v38, v46
    v_mul_f32 v39, v39, v47
    v_mul_f32 v40, v40, v48
    v_mul_f32 v41, v41, v49
    v_mul_f32 v42, v42, v50
    v_mul_f32 v43, v43, v51
    v_cvt_pk_bf16_f32 v52, v36, v37
    v_cvt_pk_bf16_f32 v53, v38, v39
    buffer_store_dwordx2 v[52:53], v7, s[16:19], s25 offen offset:0 sc1
    v_cvt_pk_bf16_f32 v54, v40, v41
    v_cvt_pk_bf16_f32 v55, v42, v43
    buffer_store_dwordx2 v[54:55], v7, s[16:19], s25 offen offset:1024 sc1
    s_add_u32 s25, s25, 2048
    s_add_u32 s25, s25, 12288
K34_END:
    s_endpgm
TEXT_END:
.section .rodata,"a"
.p2align 6
.amdhsa_kernel k1_xform_kernel
  .amdhsa_next_free_vgpr 128
  .amdhsa_next_free_sgpr 96
  .amdhsa_accum_offset 128
  .amdhsa_group_segment_fixed_size 0
  .amdhsa_kernarg_size 56
  .amdhsa_user_sgpr_count 2
  .amdhsa_user_sgpr_kernarg_segment_ptr 1
  .amdhsa_system_sgpr_workgroup_id_x 1
.end_amdhsa_kernel
.p2align 6
.amdhsa_kernel k12_fused_kernel
  .amdhsa_next_free_vgpr 256
  .amdhsa_next_free_sgpr 96
  .amdhsa_accum_offset 256
  .amdhsa_group_segment_fixed_size 0
  .amdhsa_kernarg_size 56
  .amdhsa_user_sgpr_count 2
  .amdhsa_user_sgpr_kernarg_segment_ptr 1
  .amdhsa_system_sgpr_workgroup_id_x 1
.end_amdhsa_kernel
.p2align 6
.amdhsa_kernel k34_out_kernel
  .amdhsa_next_free_vgpr 168
  .amdhsa_next_free_sgpr 96
  .amdhsa_accum_offset 168
  .amdhsa_group_segment_fixed_size 0
  .amdhsa_kernarg_size 56
  .amdhsa_user_sgpr_count 2
  .amdhsa_user_sgpr_kernarg_segment_ptr 1
  .amdhsa_system_sgpr_workgroup_id_x 1
.end_amdhsa_kernel
```

```asm
; @launch kernel=k1_xform_kernel grid=(636,1,1) block=(256,1,1) lds=16384
; @launch kernel=k12_fused_kernel grid=(256,1,1) block=(512,1,1) lds=155840
; @launch kernel=k34_out_kernel grid=(256,1,1) block=(768,1,1) lds=18944
.amdgcn_target "amdgcn-amd-amdhsa--gfx950"
.text
.globl k1_xform_kernel
.globl k12_fused_kernel
.globl k34_out_kernel
.p2align 8
.type k1_xform_kernel,@function
k1_xform_kernel:
    s_cmp_ge_u32 s2, 636
    s_cbranch_scc1 K1_END
    s_load_dwordx4 s[4:7], s[0:1], 0
    s_load_dwordx2 s[8:9], s[0:1], 48
    v_lshrrev_b32 v120, 6, v0
    v_and_b32 v121, 63, v0
    v_readfirstlane_b32 s3, v120
    v_and_b32 v122, 15, v121
    v_lshrrev_b32 v123, 4, v121
    s_mov_b32 s28, 0x05040100
    s_mov_b32 s29, 0x07060302
    v_and_b32 v124, 3, v122
    v_lshlrev_b32 v124, 2, v124
    v_lshrrev_b32 v125, 3, v122
    v_lshl_add_u32 v124, v125, 1, v124
    s_lshl_b32 s10, s3, 4
    s_add_u32 s10, s10, 1
    v_add_u32 v124, s10, v124
    v_bfe_u32 v125, v122, 2, 1
    v_lshlrev_b32 v121, 4, v121
    s_waitcnt lgkmcnt(0)
    s_or_b32 s10, s2, s3
    s_cmp_eq_u32 s10, 0
    s_cbranch_scc0 K1_NOCLR
    s_add_u32 s12, s8, 153092096
    s_addc_u32 s13, s9, 0
    s_and_b32 s13, s13, 0xffff
    s_mov_b32 s14, 32768
    s_mov_b32 s15, 0x00020000
    v_lshrrev_b32 v118, 4, v121
    v_lshlrev_b32 v119, 10, v118
    v_mov_b32 v117, 0
    s_mov_b64 exec, 0xffff
    buffer_store_dword v117, v119, s[12:15], 0 offen
    v_lshlrev_b32 v119, 4, v118
    v_add_u32 v119, 16384, v119
    buffer_store_dword v117, v119, s[12:15], 0 offen
    s_mov_b64 exec, -1
K1_NOCLR:
    s_cmp_lt_u32 s2, 32
    s_cbranch_scc0 K1_NOFILL
    s_add_u32 s12, s8, 153616384
    s_addc_u32 s13, s9, 0
    s_and_b32 s13, s13, 0xffff
    s_mov_b32 s14, 131072
    s_mov_b32 s15, 0x00020000
    s_lshl_b32 s10, s2, 2
    s_add_u32 s10, s10, s3
    s_lshl_b32 s10, s10, 10
    v_mov_b32 v112, -1
    v_mov_b32 v113, -1
    v_mov_b32 v114, -1
    v_mov_b32 v115, -1
    buffer_store_dwordx4 v[112:115], v121, s[12:15], s10 offen
K1_NOFILL:
    s_add_u32 s10, s2, 384
    s_sub_u32 s11, s2, 252
    s_cmp_lt_u32 s2, 252
    s_cselect_b32 s2, s10, s11
    s_cmp_lt_u32 s2, 384
    s_cbranch_scc1 K1_W
    s_sub_u32 s11, s2, 384
    s_mul_hi_u32 s13, s11, 1431655766
    s_mul_i32 s12, s13, 3
    s_sub_u32 s12, s11, s12
    s_mov_b32 s11, s13
    s_cmp_ge_u32 s11, 42
    s_cselect_b32 s13, 1, 0
    s_mul_i32 s14, s13, 42
    s_sub_u32 s11, s11, s14
    s_lshl_b32 s11, s11, 2
    s_add_u32 s11, s11, s3
    s_mul_i32 s14, s13, 16384000
    s_add_u32 s16, s4, s14
    s_addc_u32 s17, s5, 0
    s_and_b32 s17, s17, 0xffff
    s_mov_b32 s18, 16384000
    s_mov_b32 s19, 0x00020000
    s_mov_b32 s20, s8
    s_mov_b32 s21, s9
    s_and_b32 s21, s21, 0xffff
    s_mov_b32 s22, 43778048
    s_mov_b32 s23, 0x00020000
    v_lshlrev_b32 v126, 14, v123
    v_lshl_add_u32 v126, v122, 4, v126
    s_mul_i32 s15, s11, 98304
    s_lshl_b32 s24, s12, 8
    s_add_u32 s15, s15, s24
    buffer_load_dwordx4 v[0:3], v126, s[16:19], s15 offen
    buffer_load_dwordx4 v[4:7], v126, s[16:19], s15 offen offset:2048
    s_add_u32 s15, s15, 4096
    buffer_load_dwordx4 v[8:11], v126, s[16:19], s15 offen
    buffer_load_dwordx4 v[12:15], v126, s[16:19], s15 offen offset:2048
    s_add_u32 s15, s15, 4096
    buffer_load_dwordx4 v[16:19], v126, s[16:19], s15 offen
    buffer_load_dwordx4 v[20:23], v126, s[16:19], s15 offen offset:2048
    s_add_u32 s15, s15, 4096
    buffer_load_dwordx4 v[24:27], v126, s[16:19], s15 offen
    buffer_load_dwordx4 v[28:31], v126, s[16:19], s15 offen offset:2048
    s_add_u32 s15, s15, 53248
    buffer_load_dwordx4 v[32:35], v126, s[16:19], s15 offen
    buffer_load_dwordx4 v[36:39], v126, s[16:19], s15 offen offset:2048
    s_add_u32 s15, s15, 4096
    buffer_load_dwordx4 v[40:43], v126, s[16:19], s15 offen
    buffer_load_dwordx4 v[44:47], v126, s[16:19], s15 offen offset:2048
    s_add_u32 s15, s15, 4096
    buffer_load_dwordx4 v[48:51], v126, s[16:19], s15 offen
    buffer_load_dwordx4 v[52:55], v126, s[16:19], s15 offen offset:2048
    s_add_u32 s15, s15, 4096
    buffer_load_dwordx4 v[56:59], v126, s[16:19], s15 offen
    buffer_load_dwordx4 v[60:63], v126, s[16:19], s15 offen offset:2048
    v_lshlrev_b32 v127, 3, v123
    v_lshlrev_b32 v112, 5, v125
    v_mad_u32_u24 v113, v124, v127, v112
    v_mad_u32_u24 v64, v124, 0, v113
    v_mad_u32_u24 v65, v124, 1, v113
    v_mad_u32_u24 v66, v124, 2, v113
    v_mad_u32_u24 v67, v124, 3, v113
    v_mad_u32_u24 v68, v124, 4, v113
    v_mad_u32_u24 v69, v124, 5, v113
    v_mad_u32_u24 v70, v124, 6, v113
    v_mad_u32_u24 v71, v124, 7, v113
    v_and_b32 v64, 127, v64
    v_and_b32 v65, 127, v65
    v_and_b32 v66, 127, v66
    v_and_b32 v67, 127, v67
    v_and_b32 v68, 127, v68
    v_and_b32 v69, 127, v69
    v_and_b32 v70, 127, v70
    v_and_b32 v71, 127, v71
    v_cvt_f32_u32 v64, v64
    v_cvt_f32_u32 v65, v65
    v_cvt_f32_u32 v66, v66
    v_cvt_f32_u32 v67, v67
    v_cvt_f32_u32 v68, v68
    v_cvt_f32_u32 v69, v69
    v_cvt_f32_u32 v70, v70
    v_cvt_f32_u32 v71, v71
    v_mul_f32 v64, 0x3c000000, v64
    v_mul_f32 v65, 0x3c000000, v65
    v_mul_f32 v66, 0x3c000000, v66
    v_mul_f32 v67, 0x3c000000, v67
    v_mul_f32 v68, 0x3c000000, v68
    v_mul_f32 v69, 0x3c000000, v69
    v_mul_f32 v70, 0x3c000000, v70
    v_mul_f32 v71, 0x3c000000, v71
    v_cos_f32 v64, v64
    v_cos_f32 v65, v65
    v_cos_f32 v66, v66
    v_cos_f32 v67, v67
    v_cos_f32 v68, v68
    v_cos_f32 v69, v69
    v_cos_f32 v70, v70
    v_cos_f32 v71, v71
    s_nop 0
    v_cvt_pk_bf16_f32 v72, v64, v65
    v_cvt_pk_bf16_f32 v73, v66, v67
    v_cvt_pk_bf16_f32 v74, v68, v69
    v_cvt_pk_bf16_f32 v75, v70, v71
    v_lshlrev_b32 v80, 16, v72
    v_and_b32 v81, 0xffff0000, v72
    v_sub_f32 v64, v64, v80
    v_sub_f32 v65, v65, v81
    v_lshlrev_b32 v80, 16, v73
    v_and_b32 v81, 0xffff0000, v73
    v_sub_f32 v66, v66, v80
    v_sub_f32 v67, v67, v81
    v_lshlrev_b32 v80, 16, v74
    v_and_b32 v81, 0xffff0000, v74
    v_sub_f32 v68, v68, v80
    v_sub_f32 v69, v69, v81
    v_lshlrev_b32 v80, 16, v75
    v_and_b32 v81, 0xffff0000, v75
    v_sub_f32 v70, v70, v80
    v_sub_f32 v71, v71, v81
    v_cvt_pk_bf16_f32 v76, v64, v65
    v_cvt_pk_bf16_f32 v77, v66, v67
    v_cvt_pk_bf16_f32 v78, v68, v69
    v_cvt_pk_bf16_f32 v79, v70, v71
    s_lshl_b32 s24, s3, 12
    v_add_u32 v114, s24, v121
    ds_write_b128 v114, v[72:75] offset:0
    ds_write_b128 v114, v[76:79] offset:1024
    v_add_u32 v127, 32, v127
    v_lshlrev_b32 v112, 5, v125
    v_mad_u32_u24 v113, v124, v127, v112
    v_mad_u32_u24 v64, v124, 0, v113
    v_mad_u32_u24 v65, v124, 1, v113
    v_mad_u32_u24 v66, v124, 2, v113
    v_mad_u32_u24 v67, v124, 3, v113
    v_mad_u32_u24 v68, v124, 4, v113
    v_mad_u32_u24 v69, v124, 5, v113
    v_mad_u32_u24 v70, v124, 6, v113
    v_mad_u32_u24 v71, v124, 7, v113
    v_and_b32 v64, 127, v64
    v_and_b32 v65, 127, v65
    v_and_b32 v66, 127, v66
    v_and_b32 v67, 127, v67
    v_and_b32 v68, 127, v68
    v_and_b32 v69, 127, v69
    v_and_b32 v70, 127, v70
    v_and_b32 v71, 127, v71
    v_cvt_f32_u32 v64, v64
    v_cvt_f32_u32 v65, v65
    v_cvt_f32_u32 v66, v66
    v_cvt_f32_u32 v67, v67
    v_cvt_f32_u32 v68, v68
    v_cvt_f32_u32 v69, v69
    v_cvt_f32_u32 v70, v70
    v_cvt_f32_u32 v71, v71
    v_mul_f32 v64, 0x3c000000, v64
    v_mul_f32 v65, 0x3c000000, v65
    v_mul_f32 v66, 0x3c000000, v66
    v_mul_f32 v67, 0x3c000000, v67
    v_mul_f32 v68, 0x3c000000, v68
    v_mul_f32 v69, 0x3c000000, v69
    v_mul_f32 v70, 0x3c000000, v70
    v_mul_f32 v71, 0x3c000000, v71
    v_cos_f32 v64, v64
    v_cos_f32 v65, v65
    v_cos_f32 v66, v66
    v_cos_f32 v67, v67
    v_cos_f32 v68, v68
    v_cos_f32 v69, v69
    v_cos_f32 v70, v70
    v_cos_f32 v71, v71
    s_nop 0
    v_cvt_pk_bf16_f32 v72, v64, v65
    v_cvt_pk_bf16_f32 v73, v66, v67
    v_cvt_pk_bf16_f32 v74, v68, v69
    v_cvt_pk_bf16_f32 v75, v70, v71
    v_lshlrev_b32 v80, 16, v72
    v_and_b32 v81, 0xffff0000, v72
    v_sub_f32 v64, v64, v80
    v_sub_f32 v65, v65, v81
    v_lshlrev_b32 v80, 16, v73
    v_and_b32 v81, 0xffff0000, v73
    v_sub_f32 v66, v66, v80
    v_sub_f32 v67, v67, v81
    v_lshlrev_b32 v80, 16, v74
    v_and_b32 v81, 0xffff0000, v74
    v_sub_f32 v68, v68, v80
    v_sub_f32 v69, v69, v81
    v_lshlrev_b32 v80, 16, v75
    v_and_b32 v81, 0xffff0000, v75
    v_sub_f32 v70, v70, v80
    v_sub_f32 v71, v71, v81
    v_cvt_pk_bf16_f32 v76, v64, v65
    v_cvt_pk_bf16_f32 v77, v66, v67
    v_cvt_pk_bf16_f32 v78, v68, v69
    v_cvt_pk_bf16_f32 v79, v70, v71
    s_lshl_b32 s24, s3, 12
    v_add_u32 v114, s24, v121
    ds_write_b128 v114, v[72:75] offset:2048
    ds_write_b128 v114, v[76:79] offset:3072
    v_lshrrev_b32 v112, 1, v123
    s_mov_b32 s24, 1368064
    v_mul_lo_u32 v112, v112, s24
    v_lshrrev_b32 v113, 2, v122
    s_mov_b32 s24, 21376
    v_mul_lo_u32 v113, v113, s24
    v_add_u32 v112, v112, v113
    v_and_b32 v113, 3, v122
    v_and_b32 v114, 1, v123
    v_lshl_add_u32 v113, v114, 2, v113
    s_add_u32 s24, s11, 7
    s_cmp_ge_u32 s11, 160
    s_cselect_b32 s24, s24, s11
    s_cmp_eq_u32 s13, 1
    s_cselect_b32 s24, s24, s11
    s_lshr_b32 s24, s24, 1
    s_and_b32 s24, s24, 7
    v_xor_b32 v113, s24, v113
    v_lshl_add_u32 v120, v113, 4, v112
    s_mul_i32 s25, s13, 684032
    s_mul_i32 s24, s12, 85504
    s_add_u32 s25, s25, s24
    s_lshl_b32 s24, s11, 7
    s_add_u32 s25, s25, s24
    s_waitcnt lgkmcnt(0)
    s_barrier
    s_cmp_ge_u32 s11, 167
    s_cbranch_scc1 K1_END
    s_waitcnt vmcnt(8)
    v_perm_b32 v64, v4, v0, s28
    v_perm_b32 v68, v4, v0, s29
    v_perm_b32 v65, v12, v8, s28
    v_perm_b32 v69, v12, v8, s29
    v_perm_b32 v66, v20, v16, s28
    v_perm_b32 v70, v20, v16, s29
    v_perm_b32 v67, v28, v24, s28
    v_perm_b32 v71, v28, v24, s29
    v_perm_b32 v72, v5, v1, s28
    v_perm_b32 v76, v5, v1, s29
    v_perm_b32 v73, v13, v9, s28
    v_perm_b32 v77, v13, v9, s29
    v_perm_b32 v74, v21, v17, s28
    v_perm_b32 v78, v21, v17, s29
    v_perm_b32 v75, v29, v25, s28
    v_perm_b32 v79, v29, v25, s29
    v_perm_b32 v80, v6, v2, s28
    v_perm_b32 v84, v6, v2, s29
    v_perm_b32 v81, v14, v10, s28
    v_perm_b32 v85, v14, v10, s29
    v_perm_b32 v82, v22, v18, s28
    v_perm_b32 v86, v22, v18, s29
    v_perm_b32 v83, v30, v26, s28
    v_perm_b32 v87, v30, v26, s29
    v_perm_b32 v88, v7, v3, s28
    v_perm_b32 v92, v7, v3, s29
    v_perm_b32 v89, v15, v11, s28
    v_perm_b32 v93, v15, v11, s29
    v_perm_b32 v90, v23, v19, s28
    v_perm_b32 v94, v23, v19, s29
    v_perm_b32 v91, v31, v27, s28
    v_perm_b32 v95, v31, v27, s29
    s_waitcnt vmcnt(0)
    v_perm_b32 v0, v36, v32, s28
    v_perm_b32 v4, v36, v32, s29
    v_perm_b32 v1, v44, v40, s28
    v_perm_b32 v5, v44, v40, s29
    v_perm_b32 v2, v52, v48, s28
    v_perm_b32 v6, v52, v48, s29
    v_perm_b32 v3, v60, v56, s28
    v_perm_b32 v7, v60, v56, s29
    v_perm_b32 v8, v37, v33, s28
    v_perm_b32 v12, v37, v33, s29
    v_perm_b32 v9, v45, v41, s28
    v_perm_b32 v13, v45, v41, s29
    v_perm_b32 v10, v53, v49, s28
    v_perm_b32 v14, v53, v49, s29
    v_perm_b32 v11, v61, v57, s28
    v_perm_b32 v15, v61, v57, s29
    v_perm_b32 v16, v38, v34, s28
    v_perm_b32 v20, v38, v34, s29
    v_perm_b32 v17, v46, v42, s28
    v_perm_b32 v21, v46, v42, s29
    v_perm_b32 v18, v54, v50, s28
    v_perm_b32 v22, v54, v50, s29
    v_perm_b32 v19, v62, v58, s28
    v_perm_b32 v23, v62, v58, s29
    v_perm_b32 v24, v39, v35, s28
    v_perm_b32 v28, v39, v35, s29
    v_perm_b32 v25, v47, v43, s28
    v_perm_b32 v29, v47, v43, s29
    v_perm_b32 v26, v55, v51, s28
    v_perm_b32 v30, v55, v51, s29
    v_perm_b32 v27, v63, v59, s28
    v_perm_b32 v31, v63, v59, s29
    ds_read_b128 v[96:99], v121 offset:0
    ds_read_b128 v[100:103], v121 offset:1024
    ds_read_b128 v[104:107], v121 offset:2048
    ds_read_b128 v[108:111], v121 offset:3072
    s_waitcnt lgkmcnt(3)
    v_mfma_f32_16x16x32_bf16 v[32:35], v[96:99], v[64:67], 0
    v_mfma_f32_16x16x32_bf16 v[36:39], v[96:99], v[68:71], 0
    v_mfma_f32_16x16x32_bf16 v[40:43], v[96:99], v[72:75], 0
    v_mfma_f32_16x16x32_bf16 v[44:47], v[96:99], v[76:79], 0
    v_mfma_f32_16x16x32_bf16 v[48:51], v[96:99], v[80:83], 0
    v_mfma_f32_16x16x32_bf16 v[52:55], v[96:99], v[84:87], 0
    v_mfma_f32_16x16x32_bf16 v[56:59], v[96:99], v[88:91], 0
    v_mfma_f32_16x16x32_bf16 v[60:63], v[96:99], v[92:95], 0
    s_waitcnt lgkmcnt(2)
    v_mfma_f32_16x16x32_bf16 v[32:35], v[100:103], v[64:67], v[32:35]
    v_mfma_f32_16x16x32_bf16 v[36:39], v[100:103], v[68:71], v[36:39]
    v_mfma_f32_16x16x32_bf16 v[40:43], v[100:103], v[72:75], v[40:43]
    v_mfma_f32_16x16x32_bf16 v[44:47], v[100:103], v[76:79], v[44:47]
    v_mfma_f32_16x16x32_bf16 v[48:51], v[100:103], v[80:83], v[48:51]
    v_mfma_f32_16x16x32_bf16 v[52:55], v[100:103], v[84:87], v[52:55]
    v_mfma_f32_16x16x32_bf16 v[56:59], v[100:103], v[88:91], v[56:59]
    v_mfma_f32_16x16x32_bf16 v[60:63], v[100:103], v[92:95], v[60:63]
    s_waitcnt lgkmcnt(1)
    v_mfma_f32_16x16x32_bf16 v[32:35], v[104:107], v[0:3], v[32:35]
    v_mfma_f32_16x16x32_bf16 v[36:39], v[104:107], v[4:7], v[36:39]
    v_mfma_f32_16x16x32_bf16 v[40:43], v[104:107], v[8:11], v[40:43]
    v_mfma_f32_16x16x32_bf16 v[44:47], v[104:107], v[12:15], v[44:47]
    v_mfma_f32_16x16x32_bf16 v[48:51], v[104:107], v[16:19], v[48:51]
    v_mfma_f32_16x16x32_bf16 v[52:55], v[104:107], v[20:23], v[52:55]
    v_mfma_f32_16x16x32_bf16 v[56:59], v[104:107], v[24:27], v[56:59]
    v_mfma_f32_16x16x32_bf16 v[60:63], v[104:107], v[28:31], v[60:63]
    s_waitcnt lgkmcnt(0)
    v_mfma_f32_16x16x32_bf16 v[32:35], v[108:111], v[0:3], v[32:35]
    v_mfma_f32_16x16x32_bf16 v[36:39], v[108:111], v[4:7], v[36:39]
    v_mfma_f32_16x16x32_bf16 v[40:43], v[108:111], v[8:11], v[40:43]
    v_mfma_f32_16x16x32_bf16 v[44:47], v[108:111], v[12:15], v[44:47]
    v_mfma_f32_16x16x32_bf16 v[48:51], v[108:111], v[16:19], v[48:51]
    v_mfma_f32_16x16x32_bf16 v[52:55], v[108:111], v[20:23], v[52:55]
    v_mfma_f32_16x16x32_bf16 v[56:59], v[108:111], v[24:27], v[56:59]
    v_mfma_f32_16x16x32_bf16 v[60:63], v[108:111], v[28:31], v[60:63]
    s_nop 7
    v_cvt_pk_bf16_f32 v112, v32, v36
    v_cvt_pk_bf16_f32 v113, v40, v44
    v_cvt_pk_bf16_f32 v114, v48, v52
    v_cvt_pk_bf16_f32 v115, v56, v60
    buffer_store_dwordx4 v[112:115], v120, s[20:23], s25 offen
    s_add_u32 s25, s25, 2736128
    v_cvt_pk_bf16_f32 v116, v33, v37
    v_cvt_pk_bf16_f32 v117, v41, v45
    v_cvt_pk_bf16_f32 v118, v49, v53
    v_cvt_pk_bf16_f32 v119, v57, v61
    buffer_store_dwordx4 v[116:119], v120, s[20:23], s25 offen
    s_add_u32 s25, s25, 2736128
    v_cvt_pk_bf16_f32 v112, v34, v38
    v_cvt_pk_bf16_f32 v113, v42, v46
    v_cvt_pk_bf16_f32 v114, v50, v54
    v_cvt_pk_bf16_f32 v115, v58, v62
    buffer_store_dwordx4 v[112:115], v120, s[20:23], s25 offen
    s_add_u32 s25, s25, 2736128
    v_cvt_pk_bf16_f32 v116, v35, v39
    v_cvt_pk_bf16_f32 v117, v43, v47
    v_cvt_pk_bf16_f32 v118, v51, v55
    v_cvt_pk_bf16_f32 v119, v59, v63
    buffer_store_dwordx4 v[116:119], v120, s[20:23], s25 offen
    s_add_u32 s25, s25, 2736128
    ds_read_b128 v[96:99], v121 offset:4096
    ds_read_b128 v[100:103], v121 offset:5120
    ds_read_b128 v[104:107], v121 offset:6144
    ds_read_b128 v[108:111], v121 offset:7168
    s_waitcnt lgkmcnt(3)
    v_mfma_f32_16x16x32_bf16 v[32:35], v[96:99], v[64:67], 0
    v_mfma_f32_16x16x32_bf16 v[36:39], v[96:99], v[68:71], 0
    v_mfma_f32_16x16x32_bf16 v[40:43], v[96:99], v[72:75], 0
    v_mfma_f32_16x16x32_bf16 v[44:47], v[96:99], v[76:79], 0
    v_mfma_f32_16x16x32_bf16 v[48:51], v[96:99], v[80:83], 0
    v_mfma_f32_16x16x32_bf16 v[52:55], v[96:99], v[84:87], 0
    v_mfma_f32_16x16x32_bf16 v[56:59], v[96:99], v[88:91], 0
    v_mfma_f32_16x16x32_bf16 v[60:63], v[96:99], v[92:95], 0
    s_waitcnt lgkmcnt(2)
    v_mfma_f32_16x16x32_bf16 v[32:35], v[100:103], v[64:67], v[32:35]
    v_mfma_f32_16x16x32_bf16 v[36:39], v[100:103], v[68:71], v[36:39]
    v_mfma_f32_16x16x32_bf16 v[40:43], v[100:103], v[72:75], v[40:43]
    v_mfma_f32_16x16x32_bf16 v[44:47], v[100:103], v[76:79], v[44:47]
    v_mfma_f32_16x16x32_bf16 v[48:51], v[100:103], v[80:83], v[48:51]
    v_mfma_f32_16x16x32_bf16 v[52:55], v[100:103], v[84:87], v[52:55]
    v_mfma_f32_16x16x32_bf16 v[56:59], v[100:103], v[88:91], v[56:59]
    v_mfma_f32_16x16x32_bf16 v[60:63], v[100:103], v[92:95], v[60:63]
    s_waitcnt lgkmcnt(1)
    v_mfma_f32_16x16x32_bf16 v[32:35], v[104:107], v[0:3], v[32:35]
    v_mfma_f32_16x16x32_bf16 v[36:39], v[104:107], v[4:7], v[36:39]
    v_mfma_f32_16x16x32_bf16 v[40:43], v[104:107], v[8:11], v[40:43]
    v_mfma_f32_16x16x32_bf16 v[44:47], v[104:107], v[12:15], v[44:47]
    v_mfma_f32_16x16x32_bf16 v[48:51], v[104:107], v[16:19], v[48:51]
    v_mfma_f32_16x16x32_bf16 v[52:55], v[104:107], v[20:23], v[52:55]
    v_mfma_f32_16x16x32_bf16 v[56:59], v[104:107], v[24:27], v[56:59]
    v_mfma_f32_16x16x32_bf16 v[60:63], v[104:107], v[28:31], v[60:63]
    s_waitcnt lgkmcnt(0)
    v_mfma_f32_16x16x32_bf16 v[32:35], v[108:111], v[0:3], v[32:35]
    v_mfma_f32_16x16x32_bf16 v[36:39], v[108:111], v[4:7], v[36:39]
    v_mfma_f32_16x16x32_bf16 v[40:43], v[108:111], v[8:11], v[40:43]
    v_mfma_f32_16x16x32_bf16 v[44:47], v[108:111], v[12:15], v[44:47]
    v_mfma_f32_16x16x32_bf16 v[48:51], v[108:111], v[16:19], v[48:51]
    v_mfma_f32_16x16x32_bf16 v[52:55], v[108:111], v[20:23], v[52:55]
    v_mfma_f32_16x16x32_bf16 v[56:59], v[108:111], v[24:27], v[56:59]
    v_mfma_f32_16x16x32_bf16 v[60:63], v[108:111], v[28:31], v[60:63]
    s_nop 7
    v_cvt_pk_bf16_f32 v112, v32, v36
    v_cvt_pk_bf16_f32 v113, v40, v44
    v_cvt_pk_bf16_f32 v114, v48, v52
    v_cvt_pk_bf16_f32 v115, v56, v60
    buffer_store_dwordx4 v[112:115], v120, s[20:23], s25 offen
    s_add_u32 s25, s25, 2736128
    v_cvt_pk_bf16_f32 v116, v33, v37
    v_cvt_pk_bf16_f32 v117, v41, v45
    v_cvt_pk_bf16_f32 v118, v49, v53
    v_cvt_pk_bf16_f32 v119, v57, v61
    buffer_store_dwordx4 v[116:119], v120, s[20:23], s25 offen
    s_add_u32 s25, s25, 2736128
    v_cvt_pk_bf16_f32 v112, v34, v38
    v_cvt_pk_bf16_f32 v113, v42, v46
    v_cvt_pk_bf16_f32 v114, v50, v54
    v_cvt_pk_bf16_f32 v115, v58, v62
    buffer_store_dwordx4 v[112:115], v120, s[20:23], s25 offen
    s_add_u32 s25, s25, 2736128
    v_cvt_pk_bf16_f32 v116, v35, v39
    v_cvt_pk_bf16_f32 v117, v43, v47
    v_cvt_pk_bf16_f32 v118, v51, v55
    v_cvt_pk_bf16_f32 v119, v59, v63
    buffer_store_dwordx4 v[116:119], v120, s[20:23], s25 offen
    s_add_u32 s25, s25, 2736128
    ds_read_b128 v[96:99], v121 offset:8192
    ds_read_b128 v[100:103], v121 offset:9216
    ds_read_b128 v[104:107], v121 offset:10240
    ds_read_b128 v[108:111], v121 offset:11264
    s_waitcnt lgkmcnt(3)
    v_mfma_f32_16x16x32_bf16 v[32:35], v[96:99], v[64:67], 0
    v_mfma_f32_16x16x32_bf16 v[36:39], v[96:99], v[68:71], 0
    v_mfma_f32_16x16x32_bf16 v[40:43], v[96:99], v[72:75], 0
    v_mfma_f32_16x16x32_bf16 v[44:47], v[96:99], v[76:79], 0
    v_mfma_f32_16x16x32_bf16 v[48:51], v[96:99], v[80:83], 0
    v_mfma_f32_16x16x32_bf16 v[52:55], v[96:99], v[84:87], 0
    v_mfma_f32_16x16x32_bf16 v[56:59], v[96:99], v[88:91], 0
    v_mfma_f32_16x16x32_bf16 v[60:63], v[96:99], v[92:95], 0
    s_waitcnt lgkmcnt(2)
    v_mfma_f32_16x16x32_bf16 v[32:35], v[100:103], v[64:67], v[32:35]
    v_mfma_f32_16x16x32_bf16 v[36:39], v[100:103], v[68:71], v[36:39]
    v_mfma_f32_16x16x32_bf16 v[40:43], v[100:103], v[72:75], v[40:43]
    v_mfma_f32_16x16x32_bf16 v[44:47], v[100:103], v[76:79], v[44:47]
    v_mfma_f32_16x16x32_bf16 v[48:51], v[100:103], v[80:83], v[48:51]
    v_mfma_f32_16x16x32_bf16 v[52:55], v[100:103], v[84:87], v[52:55]
    v_mfma_f32_16x16x32_bf16 v[56:59], v[100:103], v[88:91], v[56:59]
    v_mfma_f32_16x16x32_bf16 v[60:63], v[100:103], v[92:95], v[60:63]
    s_waitcnt lgkmcnt(1)
    v_mfma_f32_16x16x32_bf16 v[32:35], v[104:107], v[0:3], v[32:35]
    v_mfma_f32_16x16x32_bf16 v[36:39], v[104:107], v[4:7], v[36:39]
    v_mfma_f32_16x16x32_bf16 v[40:43], v[104:107], v[8:11], v[40:43]
    v_mfma_f32_16x16x32_bf16 v[44:47], v[104:107], v[12:15], v[44:47]
    v_mfma_f32_16x16x32_bf16 v[48:51], v[104:107], v[16:19], v[48:51]
    v_mfma_f32_16x16x32_bf16 v[52:55], v[104:107], v[20:23], v[52:55]
    v_mfma_f32_16x16x32_bf16 v[56:59], v[104:107], v[24:27], v[56:59]
    v_mfma_f32_16x16x32_bf16 v[60:63], v[104:107], v[28:31], v[60:63]
    s_waitcnt lgkmcnt(0)
    v_mfma_f32_16x16x32_bf16 v[32:35], v[108:111], v[0:3], v[32:35]
    v_mfma_f32_16x16x32_bf16 v[36:39], v[108:111], v[4:7], v[36:39]
    v_mfma_f32_16x16x32_bf16 v[40:43], v[108:111], v[8:11], v[40:43]
    v_mfma_f32_16x16x32_bf16 v[44:47], v[108:111], v[12:15], v[44:47]
    v_mfma_f32_16x16x32_bf16 v[48:51], v[108:111], v[16:19], v[48:51]
    v_mfma_f32_16x16x32_bf16 v[52:55], v[108:111], v[20:23], v[52:55]
    v_mfma_f32_16x16x32_bf16 v[56:59], v[108:111], v[24:27], v[56:59]
    v_mfma_f32_16x16x32_bf16 v[60:63], v[108:111], v[28:31], v[60:63]
    s_nop 7
    v_cvt_pk_bf16_f32 v112, v32, v36
    v_cvt_pk_bf16_f32 v113, v40, v44
    v_cvt_pk_bf16_f32 v114, v48, v52
    v_cvt_pk_bf16_f32 v115, v56, v60
    buffer_store_dwordx4 v[112:115], v120, s[20:23], s25 offen
    s_add_u32 s25, s25, 2736128
    v_cvt_pk_bf16_f32 v116, v33, v37
    v_cvt_pk_bf16_f32 v117, v41, v45
    v_cvt_pk_bf16_f32 v118, v49, v53
    v_cvt_pk_bf16_f32 v119, v57, v61
    buffer_store_dwordx4 v[116:119], v120, s[20:23], s25 offen
    s_add_u32 s25, s25, 2736128
    v_cvt_pk_bf16_f32 v112, v34, v38
    v_cvt_pk_bf16_f32 v113, v42, v46
    v_cvt_pk_bf16_f32 v114, v50, v54
    v_cvt_pk_bf16_f32 v115, v58, v62
    buffer_store_dwordx4 v[112:115], v120, s[20:23], s25 offen
    s_add_u32 s25, s25, 2736128
    v_cvt_pk_bf16_f32 v116, v35, v39
    v_cvt_pk_bf16_f32 v117, v43, v47
    v_cvt_pk_bf16_f32 v118, v51, v55
    v_cvt_pk_bf16_f32 v119, v59, v63
    buffer_store_dwordx4 v[116:119], v120, s[20:23], s25 offen
    s_add_u32 s25, s25, 2736128
    ds_read_b128 v[96:99], v121 offset:12288
    ds_read_b128 v[100:103], v121 offset:13312
    ds_read_b128 v[104:107], v121 offset:14336
    ds_read_b128 v[108:111], v121 offset:15360
    s_waitcnt lgkmcnt(3)
    v_mfma_f32_16x16x32_bf16 v[32:35], v[96:99], v[64:67], 0
    v_mfma_f32_16x16x32_bf16 v[36:39], v[96:99], v[68:71], 0
    v_mfma_f32_16x16x32_bf16 v[40:43], v[96:99], v[72:75], 0
    v_mfma_f32_16x16x32_bf16 v[44:47], v[96:99], v[76:79], 0
    v_mfma_f32_16x16x32_bf16 v[48:51], v[96:99], v[80:83], 0
    v_mfma_f32_16x16x32_bf16 v[52:55], v[96:99], v[84:87], 0
    v_mfma_f32_16x16x32_bf16 v[56:59], v[96:99], v[88:91], 0
    v_mfma_f32_16x16x32_bf16 v[60:63], v[96:99], v[92:95], 0
    s_waitcnt lgkmcnt(2)
    v_mfma_f32_16x16x32_bf16 v[32:35], v[100:103], v[64:67], v[32:35]
    v_mfma_f32_16x16x32_bf16 v[36:39], v[100:103], v[68:71], v[36:39]
    v_mfma_f32_16x16x32_bf16 v[40:43], v[100:103], v[72:75], v[40:43]
    v_mfma_f32_16x16x32_bf16 v[44:47], v[100:103], v[76:79], v[44:47]
    v_mfma_f32_16x16x32_bf16 v[48:51], v[100:103], v[80:83], v[48:51]
    v_mfma_f32_16x16x32_bf16 v[52:55], v[100:103], v[84:87], v[52:55]
    v_mfma_f32_16x16x32_bf16 v[56:59], v[100:103], v[88:91], v[56:59]
    v_mfma_f32_16x16x32_bf16 v[60:63], v[100:103], v[92:95], v[60:63]
    s_waitcnt lgkmcnt(1)
    v_mfma_f32_16x16x32_bf16 v[32:35], v[104:107], v[0:3], v[32:35]
    v_mfma_f32_16x16x32_bf16 v[36:39], v[104:107], v[4:7], v[36:39]
    v_mfma_f32_16x16x32_bf16 v[40:43], v[104:107], v[8:11], v[40:43]
    v_mfma_f32_16x16x32_bf16 v[44:47], v[104:107], v[12:15], v[44:47]
    v_mfma_f32_16x16x32_bf16 v[48:51], v[104:107], v[16:19], v[48:51]
    v_mfma_f32_16x16x32_bf16 v[52:55], v[104:107], v[20:23], v[52:55]
    v_mfma_f32_16x16x32_bf16 v[56:59], v[104:107], v[24:27], v[56:59]
    v_mfma_f32_16x16x32_bf16 v[60:63], v[104:107], v[28:31], v[60:63]
    s_waitcnt lgkmcnt(0)
    v_mfma_f32_16x16x32_bf16 v[32:35], v[108:111], v[0:3], v[32:35]
    v_mfma_f32_16x16x32_bf16 v[36:39], v[108:111], v[4:7], v[36:39]
    v_mfma_f32_16x16x32_bf16 v[40:43], v[108:111], v[8:11], v[40:43]
    v_mfma_f32_16x16x32_bf16 v[44:47], v[108:111], v[12:15], v[44:47]
    v_mfma_f32_16x16x32_bf16 v[48:51], v[108:111], v[16:19], v[48:51]
    v_mfma_f32_16x16x32_bf16 v[52:55], v[108:111], v[20:23], v[52:55]
    v_mfma_f32_16x16x32_bf16 v[56:59], v[108:111], v[24:27], v[56:59]
    v_mfma_f32_16x16x32_bf16 v[60:63], v[108:111], v[28:31], v[60:63]
    s_nop 7
    v_cvt_pk_bf16_f32 v112, v32, v36
    v_cvt_pk_bf16_f32 v113, v40, v44
    v_cvt_pk_bf16_f32 v114, v48, v52
    v_cvt_pk_bf16_f32 v115, v56, v60
    buffer_store_dwordx4 v[112:115], v120, s[20:23], s25 offen
    s_add_u32 s25, s25, 2736128
    v_cvt_pk_bf16_f32 v116, v33, v37
    v_cvt_pk_bf16_f32 v117, v41, v45
    v_cvt_pk_bf16_f32 v118, v49, v53
    v_cvt_pk_bf16_f32 v119, v57, v61
    buffer_store_dwordx4 v[116:119], v120, s[20:23], s25 offen
    s_add_u32 s25, s25, 2736128
    v_cvt_pk_bf16_f32 v112, v34, v38
    v_cvt_pk_bf16_f32 v113, v42, v46
    v_cvt_pk_bf16_f32 v114, v50, v54
    v_cvt_pk_bf16_f32 v115, v58, v62
    buffer_store_dwordx4 v[112:115], v120, s[20:23], s25 offen
    s_add_u32 s25, s25, 2736128
    v_cvt_pk_bf16_f32 v116, v35, v39
    v_cvt_pk_bf16_f32 v117, v43, v47
    v_cvt_pk_bf16_f32 v118, v51, v55
    v_cvt_pk_bf16_f32 v119, v59, v63
    buffer_store_dwordx4 v[116:119], v120, s[20:23], s25 offen
    s_endpgm
K1_W:
    s_mov_b32 s16, s6
    s_mov_b32 s17, s7
    s_and_b32 s17, s17, 0xffff
    s_mov_b32 s18, 16252928
    s_mov_b32 s19, 0x00020000
    s_add_u32 s20, s8, 50331648
    s_addc_u32 s21, s9, 0
    s_and_b32 s21, s21, 0xffff
    s_mov_b32 s22, 67108864
    s_mov_b32 s23, 0x00020000
    s_mul_i32 s11, s2, 1
    s_lshr_b32 s12, s11, 9
    s_and_b32 s13, s11, 511
    s_lshl_b32 s14, s12, 19
    s_lshl_b32 s15, s13, 10
    s_add_u32 s14, s14, s15
    s_lshl_b32 s15, s3, 8
    s_add_u32 s14, s14, s15
    v_and_b32 v126, 1, v123
    v_lshlrev_b32 v126, 23, v126
    v_lshl_add_u32 v126, v122, 4, v126
    s_mov_b32 s15, s14
    buffer_load_dwordx4 v[0:3], v126, s[16:19], s15 offen
    s_add_u32 s15, s15, 0x100000
    buffer_load_dwordx4 v[4:7], v126, s[16:19], s15 offen
    s_add_u32 s15, s15, 0x100000
    buffer_load_dwordx4 v[8:11], v126, s[16:19], s15 offen
    s_add_u32 s15, s15, 0x100000
    buffer_load_dwordx4 v[12:15], v126, s[16:19], s15 offen
    s_add_u32 s15, s15, 0x100000
    buffer_load_dwordx4 v[16:19], v126, s[16:19], s15 offen
    s_add_u32 s15, s15, 0x100000
    buffer_load_dwordx4 v[20:23], v126, s[16:19], s15 offen
    s_add_u32 s15, s15, 0x100000
    buffer_load_dwordx4 v[24:27], v126, s[16:19], s15 offen
    s_add_u32 s15, s15, 0x100000
    buffer_load_dwordx4 v[28:31], v126, s[16:19], s15 offen
    v_and_b32 v127, 1, v123
    v_lshlrev_b32 v127, 3, v127
    v_mul_u32_u24 v112, 96, v125
    v_mad_u32_u24 v113, v124, v127, v112
    v_mad_u32_u24 v64, v124, 0, v113
    v_mad_u32_u24 v65, v124, 1, v113
    v_mad_u32_u24 v66, v124, 2, v113
    v_mad_u32_u24 v67, v124, 3, v113
    v_mad_u32_u24 v68, v124, 4, v113
    v_mad_u32_u24 v69, v124, 5, v113
    v_mad_u32_u24 v70, v124, 6, v113
    v_mad_u32_u24 v71, v124, 7, v113
    v_and_b32 v64, 127, v64
    v_and_b32 v65, 127, v65
    v_and_b32 v66, 127, v66
    v_and_b32 v67, 127, v67
    v_and_b32 v68, 127, v68
    v_and_b32 v69, 127, v69
    v_and_b32 v70, 127, v70
    v_and_b32 v71, 127, v71
    v_cvt_f32_u32 v64, v64
    v_cvt_f32_u32 v65, v65
    v_cvt_f32_u32 v66, v66
    v_cvt_f32_u32 v67, v67
    v_cvt_f32_u32 v68, v68
    v_cvt_f32_u32 v69, v69
    v_cvt_f32_u32 v70, v70
    v_cvt_f32_u32 v71, v71
    v_mul_f32 v64, 0x3c000000, v64
    v_mul_f32 v65, 0x3c000000, v65
    v_mul_f32 v66, 0x3c000000, v66
    v_mul_f32 v67, 0x3c000000, v67
    v_mul_f32 v68, 0x3c000000, v68
    v_mul_f32 v69, 0x3c000000, v69
    v_mul_f32 v70, 0x3c000000, v70
    v_mul_f32 v71, 0x3c000000, v71
    v_cos_f32 v64, v64
    v_cos_f32 v65, v65
    v_cos_f32 v66, v66
    v_cos_f32 v67, v67
    v_cos_f32 v68, v68
    v_cos_f32 v69, v69
    v_cos_f32 v70, v70
    v_cos_f32 v71, v71
    s_nop 0
    v_cvt_pk_bf16_f32 v72, v64, v65
    v_cvt_pk_bf16_f32 v73, v66, v67
    v_cvt_pk_bf16_f32 v74, v68, v69
    v_cvt_pk_bf16_f32 v75, v70, v71
    v_lshlrev_b32 v80, 16, v72
    v_and_b32 v81, 0xffff0000, v72
    v_sub_f32 v64, v64, v80
    v_sub_f32 v65, v65, v81
    v_lshlrev_b32 v80, 16, v73
    v_and_b32 v81, 0xffff0000, v73
    v_sub_f32 v66, v66, v80
    v_sub_f32 v67, v67, v81
    v_lshlrev_b32 v80, 16, v74
    v_and_b32 v81, 0xffff0000, v74
    v_sub_f32 v68, v68, v80
    v_sub_f32 v69, v69, v81
    v_lshlrev_b32 v80, 16, v75
    v_and_b32 v81, 0xffff0000, v75
    v_sub_f32 v70, v70, v80
    v_sub_f32 v71, v71, v81
    v_cvt_pk_bf16_f32 v76, v64, v65
    v_cvt_pk_bf16_f32 v77, v66, v67
    v_cvt_pk_bf16_f32 v78, v68, v69
    v_cvt_pk_bf16_f32 v79, v70, v71
    v_cmp_lt_u32 vcc, 1, v123
    s_lshl_b32 s24, s3, 10
    v_add_u32 v114, s24, v121
    v_cndmask_b32 v72, v72, v76, vcc
    v_cndmask_b32 v73, v73, v77, vcc
    v_cndmask_b32 v74, v74, v78, vcc
    v_cndmask_b32 v75, v75, v79, vcc
    ds_write_b128 v114, v[72:75]
    v_lshrrev_b32 v112, 1, v123
    s_mov_b32 s24, 2097152
    v_mul_lo_u32 v112, v112, s24
    v_and_b32 v113, 1, v123
    v_lshl_add_u32 v112, v113, 8, v112
    v_and_b32 v113, 1, v122
    v_lshl_add_u32 v124, v113, 4, v112
    v_lshrrev_b32 v125, 1, v122
    s_mul_i32 s26, s3, 524288
    s_lshl_b32 s24, s11, 9
    s_add_u32 s26, s26, s24
    s_waitcnt lgkmcnt(0)
    s_barrier
    ds_read_b128 v[96:99], v121 offset:0
    ds_read_b128 v[100:103], v121 offset:1024
    ds_read_b128 v[104:107], v121 offset:2048
    ds_read_b128 v[108:111], v121 offset:3072
    s_mov_b32 s27, 0
    s_waitcnt vmcnt(0) lgkmcnt(0)
K1_W_LOOP:
    s_add_u32 s24, s11, s27
    s_and_b32 s30, s24, 3
    s_lshr_b32 s24, s24, 1
    s_and_b32 s24, s24, 4
    s_or_b32 s30, s30, s24
    v_xor_b32 v112, s30, v125
    v_lshl_add_u32 v120, v112, 5, v124
    s_lshl_b32 s25, s27, 9
    s_add_u32 s25, s25, s26
    v_perm_b32 v32, v4, v0, s28
    v_perm_b32 v36, v4, v0, s29
    v_perm_b32 v33, v12, v8, s28
    v_perm_b32 v37, v12, v8, s29
    v_perm_b32 v34, v20, v16, s28
    v_perm_b32 v38, v20, v16, s29
    v_perm_b32 v35, v28, v24, s28
    v_perm_b32 v39, v28, v24, s29
    v_perm_b32 v40, v5, v1, s28
    v_perm_b32 v44, v5, v1, s29
    v_perm_b32 v41, v13, v9, s28
    v_perm_b32 v45, v13, v9, s29
    v_perm_b32 v42, v21, v17, s28
    v_perm_b32 v46, v21, v17, s29
    v_perm_b32 v43, v29, v25, s28
    v_perm_b32 v47, v29, v25, s29
    v_perm_b32 v48, v6, v2, s28
    v_perm_b32 v52, v6, v2, s29
    v_perm_b32 v49, v14, v10, s28
    v_perm_b32 v53, v14, v10, s29
    v_perm_b32 v50, v22, v18, s28
    v_perm_b32 v54, v22, v18, s29
    v_perm_b32 v51, v30, v26, s28
    v_perm_b32 v55, v30, v26, s29
    v_perm_b32 v56, v7, v3, s28
    v_perm_b32 v60, v7, v3, s29
    v_perm_b32 v57, v15, v11, s28
    v_perm_b32 v61, v15, v11, s29
    v_perm_b32 v58, v23, v19, s28
    v_perm_b32 v62, v23, v19, s29
    v_perm_b32 v59, v31, v27, s28
    v_perm_b32 v63, v31, v27, s29
    s_add_u32 s27, s27, 1
    s_add_u32 s14, s14, 1024
    s_cmp_ge_u32 s27, 1
    s_cbranch_scc1 K1_W_NOLOAD
    s_mov_b32 s15, s14
    buffer_load_dwordx4 v[0:3], v126, s[16:19], s15 offen
    s_add_u32 s15, s15, 0x100000
    buffer_load_dwordx4 v[4:7], v126, s[16:19], s15 offen
    s_add_u32 s15, s15, 0x100000
    buffer_load_dwordx4 v[8:11], v126, s[16:19], s15 offen
    s_add_u32 s15, s15, 0x100000
    buffer_load_dwordx4 v[12:15], v126, s[16:19], s15 offen
    s_add_u32 s15, s15, 0x100000
    buffer_load_dwordx4 v[16:19], v126, s[16:19], s15 offen
    s_add_u32 s15, s15, 0x100000
    buffer_load_dwordx4 v[20:23], v126, s[16:19], s15 offen
    s_add_u32 s15, s15, 0x100000
    buffer_load_dwordx4 v[24:27], v126, s[16:19], s15 offen
    s_add_u32 s15, s15, 0x100000
    buffer_load_dwordx4 v[28:31], v126, s[16:19], s15 offen
K1_W_NOLOAD:
    v_mfma_f32_16x16x32_bf16 v[64:67], v[96:99], v[32:35], 0
    v_mfma_f32_16x16x32_bf16 v[68:71], v[96:99], v[36:39], 0
    v_mfma_f32_16x16x32_bf16 v[72:75], v[96:99], v[40:43], 0
    v_mfma_f32_16x16x32_bf16 v[76:79], v[96:99], v[44:47], 0
    v_mfma_f32_16x16x32_bf16 v[80:83], v[96:99], v[48:51], 0
    v_mfma_f32_16x16x32_bf16 v[84:87], v[96:99], v[52:55], 0
    v_mfma_f32_16x16x32_bf16 v[88:91], v[96:99], v[56:59], 0
    v_mfma_f32_16x16x32_bf16 v[92:95], v[96:99], v[60:63], 0
    s_nop 7
    v_cvt_pk_bf16_f32 v112, v64, v68
    v_cvt_pk_bf16_f32 v113, v72, v76
    v_cvt_pk_bf16_f32 v114, v80, v84
    v_cvt_pk_bf16_f32 v115, v88, v92
    buffer_store_dwordx4 v[112:115], v120, s[20:23], s25 offen
    s_add_u32 s25, s25, 4194304
    v_cvt_pk_bf16_f32 v116, v65, v69
    v_cvt_pk_bf16_f32 v117, v73, v77
    v_cvt_pk_bf16_f32 v118, v81, v85
    v_cvt_pk_bf16_f32 v119, v89, v93
    buffer_store_dwordx4 v[116:119], v120, s[20:23], s25 offen
    s_add_u32 s25, s25, 4194304
    v_cvt_pk_bf16_f32 v112, v66, v70
    v_cvt_pk_bf16_f32 v113, v74, v78
    v_cvt_pk_bf16_f32 v114, v82, v86
    v_cvt_pk_bf16_f32 v115, v90, v94
    buffer_store_dwordx4 v[112:115], v120, s[20:23], s25 offen
    s_add_u32 s25, s25, 4194304
    v_cvt_pk_bf16_f32 v116, v67, v71
    v_cvt_pk_bf16_f32 v117, v75, v79
    v_cvt_pk_bf16_f32 v118, v83, v87
    v_cvt_pk_bf16_f32 v119, v91, v95
    buffer_store_dwordx4 v[116:119], v120, s[20:23], s25 offen
    s_add_u32 s25, s25, 4194304
    v_mfma_f32_16x16x32_bf16 v[64:67], v[100:103], v[32:35], 0
    v_mfma_f32_16x16x32_bf16 v[68:71], v[100:103], v[36:39], 0
    v_mfma_f32_16x16x32_bf16 v[72:75], v[100:103], v[40:43], 0
    v_mfma_f32_16x16x32_bf16 v[76:79], v[100:103], v[44:47], 0
    v_mfma_f32_16x16x32_bf16 v[80:83], v[100:103], v[48:51], 0
    v_mfma_f32_16x16x32_bf16 v[84:87], v[100:103], v[52:55], 0
    v_mfma_f32_16x16x32_bf16 v[88:91], v[100:103], v[56:59], 0
    v_mfma_f32_16x16x32_bf16 v[92:95], v[100:103], v[60:63], 0
    s_nop 7
    v_cvt_pk_bf16_f32 v112, v64, v68
    v_cvt_pk_bf16_f32 v113, v72, v76
    v_cvt_pk_bf16_f32 v114, v80, v84
    v_cvt_pk_bf16_f32 v115, v88, v92
    buffer_store_dwordx4 v[112:115], v120, s[20:23], s25 offen
    s_add_u32 s25, s25, 4194304
    v_cvt_pk_bf16_f32 v116, v65, v69
    v_cvt_pk_bf16_f32 v117, v73, v77
    v_cvt_pk_bf16_f32 v118, v81, v85
    v_cvt_pk_bf16_f32 v119, v89, v93
    buffer_store_dwordx4 v[116:119], v120, s[20:23], s25 offen
    s_add_u32 s25, s25, 4194304
    v_cvt_pk_bf16_f32 v112, v66, v70
    v_cvt_pk_bf16_f32 v113, v74, v78
    v_cvt_pk_bf16_f32 v114, v82, v86
    v_cvt_pk_bf16_f32 v115, v90, v94
    buffer_store_dwordx4 v[112:115], v120, s[20:23], s25 offen
    s_add_u32 s25, s25, 4194304
    v_cvt_pk_bf16_f32 v116, v67, v71
    v_cvt_pk_bf16_f32 v117, v75, v79
    v_cvt_pk_bf16_f32 v118, v83, v87
    v_cvt_pk_bf16_f32 v119, v91, v95
    buffer_store_dwordx4 v[116:119], v120, s[20:23], s25 offen
    s_add_u32 s25, s25, 4194304
    v_mfma_f32_16x16x32_bf16 v[64:67], v[104:107], v[32:35], 0
    v_mfma_f32_16x16x32_bf16 v[68:71], v[104:107], v[36:39], 0
    v_mfma_f32_16x16x32_bf16 v[72:75], v[104:107], v[40:43], 0
    v_mfma_f32_16x16x32_bf16 v[76:79], v[104:107], v[44:47], 0
    v_mfma_f32_16x16x32_bf16 v[80:83], v[104:107], v[48:51], 0
    v_mfma_f32_16x16x32_bf16 v[84:87], v[104:107], v[52:55], 0
    v_mfma_f32_16x16x32_bf16 v[88:91], v[104:107], v[56:59], 0
    v_mfma_f32_16x16x32_bf16 v[92:95], v[104:107], v[60:63], 0
    s_nop 7
    v_cvt_pk_bf16_f32 v112, v64, v68
    v_cvt_pk_bf16_f32 v113, v72, v76
    v_cvt_pk_bf16_f32 v114, v80, v84
    v_cvt_pk_bf16_f32 v115, v88, v92
    buffer_store_dwordx4 v[112:115], v120, s[20:23], s25 offen
    s_add_u32 s25, s25, 4194304
    v_cvt_pk_bf16_f32 v116, v65, v69
    v_cvt_pk_bf16_f32 v117, v73, v77
    v_cvt_pk_bf16_f32 v118, v81, v85
    v_cvt_pk_bf16_f32 v119, v89, v93
    buffer_store_dwordx4 v[116:119], v120, s[20:23], s25 offen
    s_add_u32 s25, s25, 4194304
    v_cvt_pk_bf16_f32 v112, v66, v70
    v_cvt_pk_bf16_f32 v113, v74, v78
    v_cvt_pk_bf16_f32 v114, v82, v86
    v_cvt_pk_bf16_f32 v115, v90, v94
    buffer_store_dwordx4 v[112:115], v120, s[20:23], s25 offen
    s_add_u32 s25, s25, 4194304
    v_cvt_pk_bf16_f32 v116, v67, v71
    v_cvt_pk_bf16_f32 v117, v75, v79
    v_cvt_pk_bf16_f32 v118, v83, v87
    v_cvt_pk_bf16_f32 v119, v91, v95
    buffer_store_dwordx4 v[116:119], v120, s[20:23], s25 offen
    s_add_u32 s25, s25, 4194304
    v_mfma_f32_16x16x32_bf16 v[64:67], v[108:111], v[32:35], 0
    v_mfma_f32_16x16x32_bf16 v[68:71], v[108:111], v[36:39], 0
    v_mfma_f32_16x16x32_bf16 v[72:75], v[108:111], v[40:43], 0
    v_mfma_f32_16x16x32_bf16 v[76:79], v[108:111], v[44:47], 0
    v_mfma_f32_16x16x32_bf16 v[80:83], v[108:111], v[48:51], 0
    v_mfma_f32_16x16x32_bf16 v[84:87], v[108:111], v[52:55], 0
    v_mfma_f32_16x16x32_bf16 v[88:91], v[108:111], v[56:59], 0
    v_mfma_f32_16x16x32_bf16 v[92:95], v[108:111], v[60:63], 0
    s_nop 7
    v_cvt_pk_bf16_f32 v112, v64, v68
    v_cvt_pk_bf16_f32 v113, v72, v76
    v_cvt_pk_bf16_f32 v114, v80, v84
    v_cvt_pk_bf16_f32 v115, v88, v92
    buffer_store_dwordx4 v[112:115], v120, s[20:23], s25 offen
    s_add_u32 s25, s25, 4194304
    v_cvt_pk_bf16_f32 v116, v65, v69
    v_cvt_pk_bf16_f32 v117, v73, v77
    v_cvt_pk_bf16_f32 v118, v81, v85
    v_cvt_pk_bf16_f32 v119, v89, v93
    buffer_store_dwordx4 v[116:119], v120, s[20:23], s25 offen
    s_add_u32 s25, s25, 4194304
    v_cvt_pk_bf16_f32 v112, v66, v70
    v_cvt_pk_bf16_f32 v113, v74, v78
    v_cvt_pk_bf16_f32 v114, v82, v86
    v_cvt_pk_bf16_f32 v115, v90, v94
    buffer_store_dwordx4 v[112:115], v120, s[20:23], s25 offen
    s_add_u32 s25, s25, 4194304
    v_cvt_pk_bf16_f32 v116, v67, v71
    v_cvt_pk_bf16_f32 v117, v75, v79
    v_cvt_pk_bf16_f32 v118, v83, v87
    v_cvt_pk_bf16_f32 v119, v91, v95
    buffer_store_dwordx4 v[116:119], v120, s[20:23], s25 offen
    s_waitcnt vmcnt(16)
    s_cmp_lt_u32 s27, 1
    s_cbranch_scc1 K1_W_LOOP
K1_END:
    s_endpgm
.p2align 8
.type k12_fused_kernel,@function
k12_fused_kernel:
    s_cmp_ge_u32 s2, 256
    s_cbranch_scc1 K12_END
    s_load_dwordx4 s[52:55], s[0:1], 0
    s_load_dwordx4 s[56:59], s[0:1], 40
    s_getpc_b64 s[90:91]
CPF_K12:
    s_sub_u32 s90, s90, CPF_K12-k12_fused_kernel
    s_subb_u32 s91, s91, 0
    v_lshlrev_b32 v8, 7, v0
    v_mov_b32 v11, s91
    v_min_u32 v9, TEXT_END-k12_fused_kernel-4, v8
    v_add_co_u32 v10, vcc, s90, v9
    v_addc_co_u32 v11, vcc, 0, v11, vcc
    global_load_dword v63, v[10:11], off
    v_lshrrev_b32 v1, 6, v0
    v_and_b32 v2, 63, v0
    v_readfirstlane_b32 s3, v1
    s_waitcnt lgkmcnt(0)
    s_cmp_lt_u32 s3, 4
    s_cbranch_scc1 K12_CONS
    v_and_b32 v64, 15, v2
    v_lshrrev_b32 v65, 4, v2
    v_lshlrev_b32 v254, 4, v2
    s_and_b32 s44, s3, 3
    s_and_b32 s20, s44, 1
    s_lshr_b32 s21, s44, 1
    s_lshl_b32 s22, s2, 1
    s_add_u32 s22, s22, s21
    s_and_b32 s23, s22, 3
    s_lshr_b32 s22, s22, 2
    s_and_b32 s24, s2, 7
    s_lshl_b32 s24, s24, 5
    s_lshr_b32 s25, s2, 3
    s_add_u32 s24, s24, s25
    s_cmp_ge_u32 s24, 167
    s_cselect_b32 s25, 1, 0
    s_mul_i32 s26, s25, 167
    s_sub_u32 s24, s24, s26
    s_cmp_eq_u32 s21, 0
    s_cselect_b32 s25, s25, 1
    s_mul_i32 s26, s25, 16384000
    s_add_u32 s4, s52, s26
    s_addc_u32 s5, s53, 0
    s_and_b32 s5, s5, 0xffff
    s_mov_b32 s6, 16384000
    s_mov_b32 s7, 0x00020000
    s_mov_b32 s8, s54
    s_mov_b32 s9, s55
    s_and_b32 s9, s9, 0xffff
    s_mov_b32 s10, 16252928
    s_mov_b32 s11, 0x00020000
    s_mov_b32 s12, s58
    s_mov_b32 s13, s59
    s_and_b32 s13, s13, 0xffff
    s_mov_b32 s14, 43778048
    s_mov_b32 s15, 0x00020000
    s_add_u32 s16, s58, 50331648
    s_addc_u32 s17, s59, 0
    s_and_b32 s17, s17, 0xffff
    s_mov_b32 s18, 67108864
    s_mov_b32 s19, 0x00020000
    s_add_u32 s60, s58, 153092096
    s_addc_u32 s61, s59, 0
    s_and_b32 s61, s61, 0xffff
    s_mov_b32 s62, 32768
    s_mov_b32 s63, 0x00020000
    s_mov_b32 s28, 0x05040100
    s_mov_b32 s29, 0x07060302
    v_lshlrev_b32 v248, 14, v65
    v_lshl_add_u32 v248, v64, 4, v248
    v_and_b32 v250, 1, v65
    v_lshlrev_b32 v250, 23, v250
    v_lshl_add_u32 v250, v64, 4, v250
    v_lshrrev_b32 v66, 1, v65
    s_mov_b32 s26, 1368064
    v_mul_lo_u32 v66, v66, s26
    v_lshrrev_b32 v67, 2, v64
    s_mov_b32 s26, 21376
    v_mul_lo_u32 v67, v67, s26
    v_add_u32 v66, v66, v67
    v_mov_b32 v252, v66
    v_lshrrev_b32 v66, 1, v65
    s_mov_b32 s26, 2097152
    v_mul_lo_u32 v66, v66, s26
    v_and_b32 v67, 1, v65
    v_lshl_add_u32 v66, v67, 8, v66
    v_and_b32 v67, 1, v64
    v_lshl_add_u32 v251, v67, 4, v66
    s_mul_i32 s31, s25, 684032
    s_mul_i32 s32, s23, 524288
    s_lshl_b32 s33, s23, 8
    s_mov_b32 s40, 3
    s_xor_b32 s43, s40, s20
    s_and_b32 s43, s43, 1
    s_mul_i32 s36, s40, 85
    s_add_u32 s36, s36, s2
    s_and_b32 s36, s36, 255
    s_mul_hi_u32 s37, s36, 0x55555556
    s_mul_i32 s38, s37, 3
    s_cmp_eq_u32 s38, s36
    s_cselect_b32 s27, 1, 0
    s_cmp_lt_u32 s37, 78
    s_cselect_b32 s27, s27, 0
    s_add_u32 s37, s37, 89
    s_cmp_eq_u32 s21, 0
    s_cselect_b32 s30, s24, s37
    s_cselect_b32 s27, 1, s27
    s_cmp_eq_u32 s43, 0
    s_cbranch_scc0 K12_PL1
    s_lshl_b32 s36, s40, 7
    s_add_u32 s36, s36, s22
    s_lshr_b32 s37, s36, 9
    s_lshl_b32 s37, s37, 19
    s_and_b32 s36, s36, 511
    s_lshl_b32 s36, s36, 10
    s_add_u32 s36, s36, s37
    s_add_u32 s36, s36, s33
    buffer_load_dwordx4 v[96:99], v250, s[8:11], s36 offen
    s_add_u32 s36, s36, 0x100000
    buffer_load_dwordx4 v[100:103], v250, s[8:11], s36 offen
    s_add_u32 s36, s36, 0x100000
    buffer_load_dwordx4 v[104:107], v250, s[8:11], s36 offen
    s_add_u32 s36, s36, 0x100000
    buffer_load_dwordx4 v[108:111], v250, s[8:11], s36 offen
    s_add_u32 s36, s36, 0x100000
    buffer_load_dwordx4 v[112:115], v250, s[8:11], s36 offen
    s_add_u32 s36, s36, 0x100000
    buffer_load_dwordx4 v[116:119], v250, s[8:11], s36 offen
    s_add_u32 s36, s36, 0x100000
    buffer_load_dwordx4 v[120:123], v250, s[8:11], s36 offen
    s_add_u32 s36, s36, 0x100000
    buffer_load_dwordx4 v[124:127], v250, s[8:11], s36 offen
    s_branch K12_PL2
K12_PL1:
    s_cmp_eq_u32 s27, 0
    s_cbranch_scc1 K12_PL2
    s_lshl_b32 s36, s40, 8
    s_mul_i32 s37, s30, 98304
    s_add_u32 s36, s36, s37
    buffer_load_dwordx4 v[0:3], v248, s[4:7], s36 offen
    buffer_load_dwordx4 v[4:7], v248, s[4:7], s36 offen offset:2048
    s_add_u32 s36, s36, 4096
    buffer_load_dwordx4 v[8:11], v248, s[4:7], s36 offen
    buffer_load_dwordx4 v[12:15], v248, s[4:7], s36 offen offset:2048
    s_add_u32 s36, s36, 4096
    buffer_load_dwordx4 v[16:19], v248, s[4:7], s36 offen
    buffer_load_dwordx4 v[20:23], v248, s[4:7], s36 offen offset:2048
    s_add_u32 s36, s36, 4096
    buffer_load_dwordx4 v[24:27], v248, s[4:7], s36 offen
    buffer_load_dwordx4 v[28:31], v248, s[4:7], s36 offen offset:2048
    s_add_u32 s36, s36, 53248
    buffer_load_dwordx4 v[32:35], v248, s[4:7], s36 offen
    buffer_load_dwordx4 v[36:39], v248, s[4:7], s36 offen offset:2048
    s_add_u32 s36, s36, 4096
    buffer_load_dwordx4 v[40:43], v248, s[4:7], s36 offen
    buffer_load_dwordx4 v[44:47], v248, s[4:7], s36 offen offset:2048
    s_add_u32 s36, s36, 4096
    buffer_load_dwordx4 v[48:51], v248, s[4:7], s36 offen
    buffer_load_dwordx4 v[52:55], v248, s[4:7], s36 offen offset:2048
    s_add_u32 s36, s36, 4096
    buffer_load_dwordx4 v[56:59], v248, s[4:7], s36 offen
    buffer_load_dwordx4 v[60:63], v248, s[4:7], s36 offen offset:2048
K12_PL2:
    v_and_b32 v128, 3, v64
    v_lshlrev_b32 v128, 2, v128
    v_lshrrev_b32 v130, 3, v64
    v_lshl_add_u32 v128, v130, 1, v128
    s_lshl_b32 s36, s44, 4
    s_add_u32 s36, s36, 1
    v_add_u32 v128, s36, v128
    v_bfe_u32 v129, v64, 2, 1
    v_lshlrev_b32 v131, 3, v65
    v_lshlrev_b32 v132, 5, v129
    v_mad_u32_u24 v133, v128, v131, v132
    v_mad_u32_u24 v136, v128, 0, v133
    v_mad_u32_u24 v137, v128, 1, v133
    v_mad_u32_u24 v138, v128, 2, v133
    v_mad_u32_u24 v139, v128, 3, v133
    v_mad_u32_u24 v140, v128, 4, v133
    v_mad_u32_u24 v141, v128, 5, v133
    v_mad_u32_u24 v142, v128, 6, v133
    v_mad_u32_u24 v143, v128, 7, v133
    v_and_b32 v136, 127, v136
    v_and_b32 v137, 127, v137
    v_and_b32 v138, 127, v138
    v_and_b32 v139, 127, v139
    v_and_b32 v140, 127, v140
    v_and_b32 v141, 127, v141
    v_and_b32 v142, 127, v142
    v_and_b32 v143, 127, v143
    v_cvt_f32_u32 v136, v136
    v_cvt_f32_u32 v137, v137
    v_cvt_f32_u32 v138, v138
    v_cvt_f32_u32 v139, v139
    v_cvt_f32_u32 v140, v140
    v_cvt_f32_u32 v141, v141
    v_cvt_f32_u32 v142, v142
    v_cvt_f32_u32 v143, v143
    v_mul_f32 v136, 0x3c000000, v136
    v_mul_f32 v137, 0x3c000000, v137
    v_mul_f32 v138, 0x3c000000, v138
    v_mul_f32 v139, 0x3c000000, v139
    v_mul_f32 v140, 0x3c000000, v140
    v_mul_f32 v141, 0x3c000000, v141
    v_mul_f32 v142, 0x3c000000, v142
    v_mul_f32 v143, 0x3c000000, v143
    v_cos_f32 v136, v136
    v_cos_f32 v137, v137
    v_cos_f32 v138, v138
    v_cos_f32 v139, v139
    v_cos_f32 v140, v140
    v_cos_f32 v141, v141
    v_cos_f32 v142, v142
    v_cos_f32 v143, v143
    s_nop 0
    v_cvt_pk_bf16_f32 v144, v136, v137
    v_cvt_pk_bf16_f32 v145, v138, v139
    v_cvt_pk_bf16_f32 v146, v140, v141
    v_cvt_pk_bf16_f32 v147, v142, v143
    v_lshlrev_b32 v152, 16, v144
    v_and_b32 v153, 0xffff0000, v144
    v_sub_f32 v136, v136, v152
    v_sub_f32 v137, v137, v153
    v_lshlrev_b32 v152, 16, v145
    v_and_b32 v153, 0xffff0000, v145
    v_sub_f32 v138, v138, v152
    v_sub_f32 v139, v139, v153
    v_lshlrev_b32 v152, 16, v146
    v_and_b32 v153, 0xffff0000, v146
    v_sub_f32 v140, v140, v152
    v_sub_f32 v141, v141, v153
    v_lshlrev_b32 v152, 16, v147
    v_and_b32 v153, 0xffff0000, v147
    v_sub_f32 v142, v142, v152
    v_sub_f32 v143, v143, v153
    v_cvt_pk_bf16_f32 v148, v136, v137
    v_cvt_pk_bf16_f32 v149, v138, v139
    v_cvt_pk_bf16_f32 v150, v140, v141
    v_cvt_pk_bf16_f32 v151, v142, v143
    s_lshl_b32 s37, s44, 12
    s_add_u32 s37, s37, 116736
    v_add_u32 v132, s37, v254
    ds_write_b128 v132, v[144:147]
    ds_write_b128 v132, v[148:151] offset:1024
    v_add_u32 v131, 32, v131
    v_lshlrev_b32 v132, 5, v129
    v_mad_u32_u24 v133, v128, v131, v132
    v_mad_u32_u24 v136, v128, 0, v133
    v_mad_u32_u24 v137, v128, 1, v133
    v_mad_u32_u24 v138, v128, 2, v133
    v_mad_u32_u24 v139, v128, 3, v133
    v_mad_u32_u24 v140, v128, 4, v133
    v_mad_u32_u24 v141, v128, 5, v133
    v_mad_u32_u24 v142, v128, 6, v133
    v_mad_u32_u24 v143, v128, 7, v133
    v_and_b32 v136, 127, v136
    v_and_b32 v137, 127, v137
    v_and_b32 v138, 127, v138
    v_and_b32 v139, 127, v139
    v_and_b32 v140, 127, v140
    v_and_b32 v141, 127, v141
    v_and_b32 v142, 127, v142
    v_and_b32 v143, 127, v143
    v_cvt_f32_u32 v136, v136
    v_cvt_f32_u32 v137, v137
    v_cvt_f32_u32 v138, v138
    v_cvt_f32_u32 v139, v139
    v_cvt_f32_u32 v140, v140
    v_cvt_f32_u32 v141, v141
    v_cvt_f32_u32 v142, v142
    v_cvt_f32_u32 v143, v143
    v_mul_f32 v136, 0x3c000000, v136
    v_mul_f32 v137, 0x3c000000, v137
    v_mul_f32 v138, 0x3c000000, v138
    v_mul_f32 v139, 0x3c000000, v139
    v_mul_f32 v140, 0x3c000000, v140
    v_mul_f32 v141, 0x3c000000, v141
    v_mul_f32 v142, 0x3c000000, v142
    v_mul_f32 v143, 0x3c000000, v143
    v_cos_f32 v136, v136
    v_cos_f32 v137, v137
    v_cos_f32 v138, v138
    v_cos_f32 v139, v139
    v_cos_f32 v140, v140
    v_cos_f32 v141, v141
    v_cos_f32 v142, v142
    v_cos_f32 v143, v143
    s_nop 0
    v_cvt_pk_bf16_f32 v144, v136, v137
    v_cvt_pk_bf16_f32 v145, v138, v139
    v_cvt_pk_bf16_f32 v146, v140, v141
    v_cvt_pk_bf16_f32 v147, v142, v143
    v_lshlrev_b32 v152, 16, v144
    v_and_b32 v153, 0xffff0000, v144
    v_sub_f32 v136, v136, v152
    v_sub_f32 v137, v137, v153
    v_lshlrev_b32 v152, 16, v145
    v_and_b32 v153, 0xffff0000, v145
    v_sub_f32 v138, v138, v152
    v_sub_f32 v139, v139, v153
    v_lshlrev_b32 v152, 16, v146
    v_and_b32 v153, 0xffff0000, v146
    v_sub_f32 v140, v140, v152
    v_sub_f32 v141, v141, v153
    v_lshlrev_b32 v152, 16, v147
    v_and_b32 v153, 0xffff0000, v147
    v_sub_f32 v142, v142, v152
    v_sub_f32 v143, v143, v153
    v_cvt_pk_bf16_f32 v148, v136, v137
    v_cvt_pk_bf16_f32 v149, v138, v139
    v_cvt_pk_bf16_f32 v150, v140, v141
    v_cvt_pk_bf16_f32 v151, v142, v143
    s_lshl_b32 s37, s44, 12
    s_add_u32 s37, s37, 118784
    v_add_u32 v132, s37, v254
    ds_write_b128 v132, v[144:147]
    ds_write_b128 v132, v[148:151] offset:1024
K12_TB:
    s_waitcnt lgkmcnt(0)
    s_barrier
    v_add_u32 v255, 116736, v254
    ds_read_b128 v[160:163], v255 offset:0
    ds_read_b128 v[192:195], v255 offset:1024
    ds_read_b128 v[164:167], v255 offset:2048
    ds_read_b128 v[196:199], v255 offset:3072
    ds_read_b128 v[168:171], v255 offset:4096
    ds_read_b128 v[200:203], v255 offset:5120
    ds_read_b128 v[172:175], v255 offset:6144
    ds_read_b128 v[204:207], v255 offset:7168
    s_waitcnt lgkmcnt(0)
    ds_read_b128 v[176:179], v255 offset:8192
    ds_read_b128 v[208:211], v255 offset:9216
    ds_read_b128 v[180:183], v255 offset:10240
    ds_read_b128 v[212:215], v255 offset:11264
    ds_read_b128 v[184:187], v255 offset:12288
    ds_read_b128 v[216:219], v255 offset:13312
    ds_read_b128 v[188:191], v255 offset:14336
    ds_read_b128 v[220:223], v255 offset:15360
    ds_read_b128 v[224:227], v255 offset:16384
    ds_read_b128 v[228:231], v255 offset:17408
    ds_read_b128 v[232:235], v255 offset:18432
    ds_read_b128 v[236:239], v255 offset:19456
    s_waitcnt lgkmcnt(0)
    s_barrier
    s_waitcnt vmcnt(0) lgkmcnt(0)
    s_mov_b32 s41, -1
    s_mov_b32 s34, -1
    s_branch K12_PROD
    s_cmp_lt_u32 s3, 4
    s_cbranch_scc0 K12_PROD
    s_cmp_eq_u32 s43, 0
    s_cbranch_scc0 K12_H1
    v_perm_b32 v64, v100, v96, s28
    v_perm_b32 v68, v100, v96, s29
    v_perm_b32 v65, v108, v104, s28
    v_perm_b32 v69, v108, v104, s29
    v_perm_b32 v66, v116, v112, s28
    v_perm_b32 v70, v116, v112, s29
    v_perm_b32 v67, v124, v120, s28
    v_perm_b32 v71, v124, v120, s29
    v_perm_b32 v72, v101, v97, s28
    v_perm_b32 v76, v101, v97, s29
    v_perm_b32 v73, v109, v105, s28
    v_perm_b32 v77, v109, v105, s29
    v_perm_b32 v74, v117, v113, s28
    v_perm_b32 v78, v117, v113, s29
    v_perm_b32 v75, v125, v121, s28
    v_perm_b32 v79, v125, v121, s29
    v_perm_b32 v80, v102, v98, s28
    v_perm_b32 v84, v102, v98, s29
    v_perm_b32 v81, v110, v106, s28
    v_perm_b32 v85, v110, v106, s29
    v_perm_b32 v82, v118, v114, s28
    v_perm_b32 v86, v118, v114, s29
    v_perm_b32 v83, v126, v122, s28
    v_perm_b32 v87, v126, v122, s29
    v_perm_b32 v88, v103, v99, s28
    v_perm_b32 v92, v103, v99, s29
    v_perm_b32 v89, v111, v107, s28
    v_perm_b32 v93, v111, v107, s29
    v_perm_b32 v90, v119, v115, s28
    v_perm_b32 v94, v119, v115, s29
    v_perm_b32 v91, v127, v123, s28
    v_perm_b32 v95, v127, v123, s29
    s_lshl_b32 s36, s40, 7
    s_add_u32 s36, s36, s22
    s_and_b32 s37, s36, 3
    s_lshr_b32 s38, s36, 1
    s_and_b32 s38, s38, 4
    s_or_b32 s37, s37, s38
    v_bfe_u32 v253, v254, 5, 3
    v_xor_b32 v253, s37, v253
    v_lshl_add_u32 v253, v253, 5, v251
    s_lshl_b32 s36, s36, 9
    s_add_u32 s39, s36, s32
    v_mfma_f32_16x16x32_bf16 v[128:131], v[224:227], v[64:67], 0
    v_mfma_f32_16x16x32_bf16 v[132:135], v[224:227], v[68:71], 0
    v_mfma_f32_16x16x32_bf16 v[136:139], v[224:227], v[72:75], 0
    v_mfma_f32_16x16x32_bf16 v[140:143], v[224:227], v[76:79], 0
    v_mfma_f32_16x16x32_bf16 v[144:147], v[224:227], v[80:83], 0
    v_mfma_f32_16x16x32_bf16 v[148:151], v[224:227], v[84:87], 0
    v_mfma_f32_16x16x32_bf16 v[152:155], v[224:227], v[88:91], 0
    v_mfma_f32_16x16x32_bf16 v[156:159], v[224:227], v[92:95], 0
    s_nop 7
    v_cvt_pk_bf16_f32 v240, v128, v132
    v_cvt_pk_bf16_f32 v241, v136, v140
    v_cvt_pk_bf16_f32 v242, v144, v148
    v_cvt_pk_bf16_f32 v243, v152, v156
    buffer_store_dwordx4 v[240:243], v253, s[16:19], s39 offen sc1
    s_add_u32 s39, s39, 4194304
    v_cvt_pk_bf16_f32 v244, v129, v133
    v_cvt_pk_bf16_f32 v245, v137, v141
    v_cvt_pk_bf16_f32 v246, v145, v149
    v_cvt_pk_bf16_f32 v247, v153, v157
    buffer_store_dwordx4 v[244:247], v253, s[16:19], s39 offen sc1
    s_add_u32 s39, s39, 4194304
    v_cvt_pk_bf16_f32 v240, v130, v134
    v_cvt_pk_bf16_f32 v241, v138, v142
    v_cvt_pk_bf16_f32 v242, v146, v150
    v_cvt_pk_bf16_f32 v243, v154, v158
    buffer_store_dwordx4 v[240:243], v253, s[16:19], s39 offen sc1
    s_add_u32 s39, s39, 4194304
    v_cvt_pk_bf16_f32 v244, v131, v135
    v_cvt_pk_bf16_f32 v245, v139, v143
    v_cvt_pk_bf16_f32 v246, v147, v151
    v_cvt_pk_bf16_f32 v247, v155, v159
    buffer_store_dwordx4 v[244:247], v253, s[16:19], s39 offen sc1
    s_add_u32 s39, s39, 4194304
    v_mfma_f32_16x16x32_bf16 v[128:131], v[228:231], v[64:67], 0
    v_mfma_f32_16x16x32_bf16 v[132:135], v[228:231], v[68:71], 0
    v_mfma_f32_16x16x32_bf16 v[136:139], v[228:231], v[72:75], 0
    v_mfma_f32_16x16x32_bf16 v[140:143], v[228:231], v[76:79], 0
    v_mfma_f32_16x16x32_bf16 v[144:147], v[228:231], v[80:83], 0
    v_mfma_f32_16x16x32_bf16 v[148:151], v[228:231], v[84:87], 0
    v_mfma_f32_16x16x32_bf16 v[152:155], v[228:231], v[88:91], 0
    v_mfma_f32_16x16x32_bf16 v[156:159], v[228:231], v[92:95], 0
    s_nop 7
    v_cvt_pk_bf16_f32 v240, v128, v132
    v_cvt_pk_bf16_f32 v241, v136, v140
    v_cvt_pk_bf16_f32 v242, v144, v148
    v_cvt_pk_bf16_f32 v243, v152, v156
    buffer_store_dwordx4 v[240:243], v253, s[16:19], s39 offen sc1
    s_add_u32 s39, s39, 4194304
    v_cvt_pk_bf16_f32 v244, v129, v133
    v_cvt_pk_bf16_f32 v245, v137, v141
    v_cvt_pk_bf16_f32 v246, v145, v149
    v_cvt_pk_bf16_f32 v247, v153, v157
    buffer_store_dwordx4 v[244:247], v253, s[16:19], s39 offen sc1
    s_add_u32 s39, s39, 4194304
    v_cvt_pk_bf16_f32 v240, v130, v134
    v_cvt_pk_bf16_f32 v241, v138, v142
    v_cvt_pk_bf16_f32 v242, v146, v150
    v_cvt_pk_bf16_f32 v243, v154, v158
    buffer_store_dwordx4 v[240:243], v253, s[16:19], s39 offen sc1
    s_add_u32 s39, s39, 4194304
    v_cvt_pk_bf16_f32 v244, v131, v135
    v_cvt_pk_bf16_f32 v245, v139, v143
    v_cvt_pk_bf16_f32 v246, v147, v151
    v_cvt_pk_bf16_f32 v247, v155, v159
    buffer_store_dwordx4 v[244:247], v253, s[16:19], s39 offen sc1
    s_add_u32 s39, s39, 4194304
    v_mfma_f32_16x16x32_bf16 v[128:131], v[232:235], v[64:67], 0
    v_mfma_f32_16x16x32_bf16 v[132:135], v[232:235], v[68:71], 0
    v_mfma_f32_16x16x32_bf16 v[136:139], v[232:235], v[72:75], 0
    v_mfma_f32_16x16x32_bf16 v[140:143], v[232:235], v[76:79], 0
    v_mfma_f32_16x16x32_bf16 v[144:147], v[232:235], v[80:83], 0
    v_mfma_f32_16x16x32_bf16 v[148:151], v[232:235], v[84:87], 0
    v_mfma_f32_16x16x32_bf16 v[152:155], v[232:235], v[88:91], 0
    v_mfma_f32_16x16x32_bf16 v[156:159], v[232:235], v[92:95], 0
    s_nop 7
    v_cvt_pk_bf16_f32 v240, v128, v132
    v_cvt_pk_bf16_f32 v241, v136, v140
    v_cvt_pk_bf16_f32 v242, v144, v148
    v_cvt_pk_bf16_f32 v243, v152, v156
    buffer_store_dwordx4 v[240:243], v253, s[16:19], s39 offen sc1
    s_add_u32 s39, s39, 4194304
    v_cvt_pk_bf16_f32 v244, v129, v133
    v_cvt_pk_bf16_f32 v245, v137, v141
    v_cvt_pk_bf16_f32 v246, v145, v149
    v_cvt_pk_bf16_f32 v247, v153, v157
    buffer_store_dwordx4 v[244:247], v253, s[16:19], s39 offen sc1
    s_add_u32 s39, s39, 4194304
    v_cvt_pk_bf16_f32 v240, v130, v134
    v_cvt_pk_bf16_f32 v241, v138, v142
    v_cvt_pk_bf16_f32 v242, v146, v150
    v_cvt_pk_bf16_f32 v243, v154, v158
    buffer_store_dwordx4 v[240:243], v253, s[16:19], s39 offen sc1
    s_add_u32 s39, s39, 4194304
    v_cvt_pk_bf16_f32 v244, v131, v135
    v_cvt_pk_bf16_f32 v245, v139, v143
    v_cvt_pk_bf16_f32 v246, v147, v151
    v_cvt_pk_bf16_f32 v247, v155, v159
    buffer_store_dwordx4 v[244:247], v253, s[16:19], s39 offen sc1
    s_add_u32 s39, s39, 4194304
    v_mfma_f32_16x16x32_bf16 v[128:131], v[236:239], v[64:67], 0
    v_mfma_f32_16x16x32_bf16 v[132:135], v[236:239], v[68:71], 0
    v_mfma_f32_16x16x32_bf16 v[136:139], v[236:239], v[72:75], 0
    v_mfma_f32_16x16x32_bf16 v[140:143], v[236:239], v[76:79], 0
    v_mfma_f32_16x16x32_bf16 v[144:147], v[236:239], v[80:83], 0
    v_mfma_f32_16x16x32_bf16 v[148:151], v[236:239], v[84:87], 0
    v_mfma_f32_16x16x32_bf16 v[152:155], v[236:239], v[88:91], 0
    v_mfma_f32_16x16x32_bf16 v[156:159], v[236:239], v[92:95], 0
    s_nop 7
    v_cvt_pk_bf16_f32 v240, v128, v132
    v_cvt_pk_bf16_f32 v241, v136, v140
    v_cvt_pk_bf16_f32 v242, v144, v148
    v_cvt_pk_bf16_f32 v243, v152, v156
    buffer_store_dwordx4 v[240:243], v253, s[16:19], s39 offen sc1
    s_add_u32 s39, s39, 4194304
    v_cvt_pk_bf16_f32 v244, v129, v133
    v_cvt_pk_bf16_f32 v245, v137, v141
    v_cvt_pk_bf16_f32 v246, v145, v149
    v_cvt_pk_bf16_f32 v247, v153, v157
    buffer_store_dwordx4 v[244:247], v253, s[16:19], s39 offen sc1
    s_add_u32 s39, s39, 4194304
    v_cvt_pk_bf16_f32 v240, v130, v134
    v_cvt_pk_bf16_f32 v241, v138, v142
    v_cvt_pk_bf16_f32 v242, v146, v150
    v_cvt_pk_bf16_f32 v243, v154, v158
    buffer_store_dwordx4 v[240:243], v253, s[16:19], s39 offen sc1
    s_add_u32 s39, s39, 4194304
    v_cvt_pk_bf16_f32 v244, v131, v135
    v_cvt_pk_bf16_f32 v245, v139, v143
    v_cvt_pk_bf16_f32 v246, v147, v151
    v_cvt_pk_bf16_f32 v247, v155, v159
    buffer_store_dwordx4 v[244:247], v253, s[16:19], s39 offen sc1
    s_branch K12_H2
K12_H1:
    s_cmp_eq_u32 s27, 0
    s_cbranch_scc1 K12_H2
    v_perm_b32 v64, v4, v0, s28
    v_perm_b32 v68, v4, v0, s29
    v_perm_b32 v65, v12, v8, s28
    v_perm_b32 v69, v12, v8, s29
    v_perm_b32 v66, v20, v16, s28
    v_perm_b32 v70, v20, v16, s29
    v_perm_b32 v67, v28, v24, s28
    v_perm_b32 v71, v28, v24, s29
    v_perm_b32 v72, v5, v1, s28
    v_perm_b32 v76, v5, v1, s29
    v_perm_b32 v73, v13, v9, s28
    v_perm_b32 v77, v13, v9, s29
    v_perm_b32 v74, v21, v17, s28
    v_perm_b32 v78, v21, v17, s29
    v_perm_b32 v75, v29, v25, s28
    v_perm_b32 v79, v29, v25, s29
    v_perm_b32 v80, v6, v2, s28
    v_perm_b32 v84, v6, v2, s29
    v_perm_b32 v81, v14, v10, s28
    v_perm_b32 v85, v14, v10, s29
    v_perm_b32 v82, v22, v18, s28
    v_perm_b32 v86, v22, v18, s29
    v_perm_b32 v83, v30, v26, s28
    v_perm_b32 v87, v30, v26, s29
    v_perm_b32 v88, v7, v3, s28
    v_perm_b32 v92, v7, v3, s29
    v_perm_b32 v89, v15, v11, s28
    v_perm_b32 v93, v15, v11, s29
    v_perm_b32 v90, v23, v19, s28
    v_perm_b32 v94, v23, v19, s29
    v_perm_b32 v91, v31, v27, s28
    v_perm_b32 v95, v31, v27, s29
    v_perm_b32 v0, v36, v32, s28
    v_perm_b32 v4, v36, v32, s29
    v_perm_b32 v1, v44, v40, s28
    v_perm_b32 v5, v44, v40, s29
    v_perm_b32 v2, v52, v48, s28
    v_perm_b32 v6, v52, v48, s29
    v_perm_b32 v3, v60, v56, s28
    v_perm_b32 v7, v60, v56, s29
    v_perm_b32 v8, v37, v33, s28
    v_perm_b32 v12, v37, v33, s29
    v_perm_b32 v9, v45, v41, s28
    v_perm_b32 v13, v45, v41, s29
    v_perm_b32 v10, v53, v49, s28
    v_perm_b32 v14, v53, v49, s29
    v_perm_b32 v11, v61, v57, s28
    v_perm_b32 v15, v61, v57, s29
    v_perm_b32 v16, v38, v34, s28
    v_perm_b32 v20, v38, v34, s29
    v_perm_b32 v17, v46, v42, s28
    v_perm_b32 v21, v46, v42, s29
    v_perm_b32 v18, v54, v50, s28
    v_perm_b32 v22, v54, v50, s29
    v_perm_b32 v19, v62, v58, s28
    v_perm_b32 v23, v62, v58, s29
    v_perm_b32 v24, v39, v35, s28
    v_perm_b32 v28, v39, v35, s29
    v_perm_b32 v25, v47, v43, s28
    v_perm_b32 v29, v47, v43, s29
    v_perm_b32 v26, v55, v51, s28
    v_perm_b32 v30, v55, v51, s29
    v_perm_b32 v27, v63, v59, s28
    v_perm_b32 v31, v63, v59, s29
    s_mul_i32 s39, s40, 85504
    s_add_u32 s39, s39, s31
    s_lshl_b32 s36, s30, 7
    s_add_u32 s39, s39, s36
    v_bfe_u32 v249, v254, 4, 2
    v_bfe_u32 v240, v254, 8, 1
    v_lshl_add_u32 v249, v240, 2, v249
    s_add_u32 s36, s30, 7
    s_cmp_ge_u32 s30, 160
    s_cselect_b32 s36, s36, s30
    s_cmp_eq_u32 s25, 1
    s_cselect_b32 s36, s36, s30
    s_lshr_b32 s36, s36, 1
    s_and_b32 s36, s36, 7
    v_xor_b32 v249, s36, v249
    v_lshl_add_u32 v249, v249, 4, v252
    v_mfma_f32_16x16x32_bf16 v[32:35], v[160:163], v[64:67], 0
    v_mfma_f32_16x16x32_bf16 v[36:39], v[160:163], v[68:71], 0
    v_mfma_f32_16x16x32_bf16 v[40:43], v[160:163], v[72:75], 0
    v_mfma_f32_16x16x32_bf16 v[44:47], v[160:163], v[76:79], 0
    v_mfma_f32_16x16x32_bf16 v[48:51], v[160:163], v[80:83], 0
    v_mfma_f32_16x16x32_bf16 v[52:55], v[160:163], v[84:87], 0
    v_mfma_f32_16x16x32_bf16 v[56:59], v[160:163], v[88:91], 0
    v_mfma_f32_16x16x32_bf16 v[60:63], v[160:163], v[92:95], 0
    v_mfma_f32_16x16x32_bf16 v[32:35], v[164:167], v[0:3], v[32:35]
    v_mfma_f32_16x16x32_bf16 v[36:39], v[164:167], v[4:7], v[36:39]
    v_mfma_f32_16x16x32_bf16 v[40:43], v[164:167], v[8:11], v[40:43]
    v_mfma_f32_16x16x32_bf16 v[44:47], v[164:167], v[12:15], v[44:47]
    v_mfma_f32_16x16x32_bf16 v[48:51], v[164:167], v[16:19], v[48:51]
    v_mfma_f32_16x16x32_bf16 v[52:55], v[164:167], v[20:23], v[52:55]
    v_mfma_f32_16x16x32_bf16 v[56:59], v[164:167], v[24:27], v[56:59]
    v_mfma_f32_16x16x32_bf16 v[60:63], v[164:167], v[28:31], v[60:63]
    s_nop 7
    v_cvt_pk_bf16_f32 v240, v32, v36
    v_cvt_pk_bf16_f32 v241, v40, v44
    v_cvt_pk_bf16_f32 v242, v48, v52
    v_cvt_pk_bf16_f32 v243, v56, v60
    buffer_store_dwordx4 v[240:243], v249, s[12:15], s39 offen sc1
    s_add_u32 s39, s39, 2736128
    v_cvt_pk_bf16_f32 v244, v33, v37
    v_cvt_pk_bf16_f32 v245, v41, v45
    v_cvt_pk_bf16_f32 v246, v49, v53
    v_cvt_pk_bf16_f32 v247, v57, v61
    buffer_store_dwordx4 v[244:247], v249, s[12:15], s39 offen sc1
    s_add_u32 s39, s39, 2736128
    v_cvt_pk_bf16_f32 v240, v34, v38
    v_cvt_pk_bf16_f32 v241, v42, v46
    v_cvt_pk_bf16_f32 v242, v50, v54
    v_cvt_pk_bf16_f32 v243, v58, v62
    buffer_store_dwordx4 v[240:243], v249, s[12:15], s39 offen sc1
    s_add_u32 s39, s39, 2736128
    v_cvt_pk_bf16_f32 v244, v35, v39
    v_cvt_pk_bf16_f32 v245, v43, v47
    v_cvt_pk_bf16_f32 v246, v51, v55
    v_cvt_pk_bf16_f32 v247, v59, v63
    buffer_store_dwordx4 v[244:247], v249, s[12:15], s39 offen sc1
    s_add_u32 s39, s39, 2736128
    v_mfma_f32_16x16x32_bf16 v[32:35], v[168:171], v[64:67], 0
    v_mfma_f32_16x16x32_bf16 v[36:39], v[168:171], v[68:71], 0
    v_mfma_f32_16x16x32_bf16 v[40:43], v[168:171], v[72:75], 0
    v_mfma_f32_16x16x32_bf16 v[44:47], v[168:171], v[76:79], 0
    v_mfma_f32_16x16x32_bf16 v[48:51], v[168:171], v[80:83], 0
    v_mfma_f32_16x16x32_bf16 v[52:55], v[168:171], v[84:87], 0
    v_mfma_f32_16x16x32_bf16 v[56:59], v[168:171], v[88:91], 0
    v_mfma_f32_16x16x32_bf16 v[60:63], v[168:171], v[92:95], 0
    v_mfma_f32_16x16x32_bf16 v[32:35], v[172:175], v[0:3], v[32:35]
    v_mfma_f32_16x16x32_bf16 v[36:39], v[172:175], v[4:7], v[36:39]
    v_mfma_f32_16x16x32_bf16 v[40:43], v[172:175], v[8:11], v[40:43]
    v_mfma_f32_16x16x32_bf16 v[44:47], v[172:175], v[12:15], v[44:47]
    v_mfma_f32_16x16x32_bf16 v[48:51], v[172:175], v[16:19], v[48:51]
    v_mfma_f32_16x16x32_bf16 v[52:55], v[172:175], v[20:23], v[52:55]
    v_mfma_f32_16x16x32_bf16 v[56:59], v[172:175], v[24:27], v[56:59]
    v_mfma_f32_16x16x32_bf16 v[60:63], v[172:175], v[28:31], v[60:63]
    s_nop 7
    v_cvt_pk_bf16_f32 v240, v32, v36
    v_cvt_pk_bf16_f32 v241, v40, v44
    v_cvt_pk_bf16_f32 v242, v48, v52
    v_cvt_pk_bf16_f32 v243, v56, v60
    buffer_store_dwordx4 v[240:243], v249, s[12:15], s39 offen sc1
    s_add_u32 s39, s39, 2736128
    v_cvt_pk_bf16_f32 v244, v33, v37
    v_cvt_pk_bf16_f32 v245, v41, v45
    v_cvt_pk_bf16_f32 v246, v49, v53
    v_cvt_pk_bf16_f32 v247, v57, v61
    buffer_store_dwordx4 v[244:247], v249, s[12:15], s39 offen sc1
    s_add_u32 s39, s39, 2736128
    v_cvt_pk_bf16_f32 v240, v34, v38
    v_cvt_pk_bf16_f32 v241, v42, v46
    v_cvt_pk_bf16_f32 v242, v50, v54
    v_cvt_pk_bf16_f32 v243, v58, v62
    buffer_store_dwordx4 v[240:243], v249, s[12:15], s39 offen sc1
    s_add_u32 s39, s39, 2736128
    v_cvt_pk_bf16_f32 v244, v35, v39
    v_cvt_pk_bf16_f32 v245, v43, v47
    v_cvt_pk_bf16_f32 v246, v51, v55
    v_cvt_pk_bf16_f32 v247, v59, v63
    buffer_store_dwordx4 v[244:247], v249, s[12:15], s39 offen sc1
    s_add_u32 s39, s39, 2736128
    v_mfma_f32_16x16x32_bf16 v[32:35], v[176:179], v[64:67], 0
    v_mfma_f32_16x16x32_bf16 v[36:39], v[176:179], v[68:71], 0
    v_mfma_f32_16x16x32_bf16 v[40:43], v[176:179], v[72:75], 0
    v_mfma_f32_16x16x32_bf16 v[44:47], v[176:179], v[76:79], 0
    v_mfma_f32_16x16x32_bf16 v[48:51], v[176:179], v[80:83], 0
    v_mfma_f32_16x16x32_bf16 v[52:55], v[176:179], v[84:87], 0
    v_mfma_f32_16x16x32_bf16 v[56:59], v[176:179], v[88:91], 0
    v_mfma_f32_16x16x32_bf16 v[60:63], v[176:179], v[92:95], 0
    v_mfma_f32_16x16x32_bf16 v[32:35], v[180:183], v[0:3], v[32:35]
    v_mfma_f32_16x16x32_bf16 v[36:39], v[180:183], v[4:7], v[36:39]
    v_mfma_f32_16x16x32_bf16 v[40:43], v[180:183], v[8:11], v[40:43]
    v_mfma_f32_16x16x32_bf16 v[44:47], v[180:183], v[12:15], v[44:47]
    v_mfma_f32_16x16x32_bf16 v[48:51], v[180:183], v[16:19], v[48:51]
    v_mfma_f32_16x16x32_bf16 v[52:55], v[180:183], v[20:23], v[52:55]
    v_mfma_f32_16x16x32_bf16 v[56:59], v[180:183], v[24:27], v[56:59]
    v_mfma_f32_16x16x32_bf16 v[60:63], v[180:183], v[28:31], v[60:63]
    s_nop 7
    v_cvt_pk_bf16_f32 v240, v32, v36
    v_cvt_pk_bf16_f32 v241, v40, v44
    v_cvt_pk_bf16_f32 v242, v48, v52
    v_cvt_pk_bf16_f32 v243, v56, v60
    buffer_store_dwordx4 v[240:243], v249, s[12:15], s39 offen sc1
    s_add_u32 s39, s39, 2736128
    v_cvt_pk_bf16_f32 v244, v33, v37
    v_cvt_pk_bf16_f32 v245, v41, v45
    v_cvt_pk_bf16_f32 v246, v49, v53
    v_cvt_pk_bf16_f32 v247, v57, v61
    buffer_store_dwordx4 v[244:247], v249, s[12:15], s39 offen sc1
    s_add_u32 s39, s39, 2736128
    v_cvt_pk_bf16_f32 v240, v34, v38
    v_cvt_pk_bf16_f32 v241, v42, v46
    v_cvt_pk_bf16_f32 v242, v50, v54
    v_cvt_pk_bf16_f32 v243, v58, v62
    buffer_store_dwordx4 v[240:243], v249, s[12:15], s39 offen sc1
    s_add_u32 s39, s39, 2736128
    v_cvt_pk_bf16_f32 v244, v35, v39
    v_cvt_pk_bf16_f32 v245, v43, v47
    v_cvt_pk_bf16_f32 v246, v51, v55
    v_cvt_pk_bf16_f32 v247, v59, v63
    buffer_store_dwordx4 v[244:247], v249, s[12:15], s39 offen sc1
    s_add_u32 s39, s39, 2736128
    v_mfma_f32_16x16x32_bf16 v[32:35], v[184:187], v[64:67], 0
    v_mfma_f32_16x16x32_bf16 v[36:39], v[184:187], v[68:71], 0
    v_mfma_f32_16x16x32_bf16 v[40:43], v[184:187], v[72:75], 0
    v_mfma_f32_16x16x32_bf16 v[44:47], v[184:187], v[76:79], 0
    v_mfma_f32_16x16x32_bf16 v[48:51], v[184:187], v[80:83], 0
    v_mfma_f32_16x16x32_bf16 v[52:55], v[184:187], v[84:87], 0
    v_mfma_f32_16x16x32_bf16 v[56:59], v[184:187], v[88:91], 0
    v_mfma_f32_16x16x32_bf16 v[60:63], v[184:187], v[92:95], 0
    v_mfma_f32_16x16x32_bf16 v[32:35], v[188:191], v[0:3], v[32:35]
    v_mfma_f32_16x16x32_bf16 v[36:39], v[188:191], v[4:7], v[36:39]
    v_mfma_f32_16x16x32_bf16 v[40:43], v[188:191], v[8:11], v[40:43]
    v_mfma_f32_16x16x32_bf16 v[44:47], v[188:191], v[12:15], v[44:47]
    v_mfma_f32_16x16x32_bf16 v[48:51], v[188:191], v[16:19], v[48:51]
    v_mfma_f32_16x16x32_bf16 v[52:55], v[188:191], v[20:23], v[52:55]
    v_mfma_f32_16x16x32_bf16 v[56:59], v[188:191], v[24:27], v[56:59]
    v_mfma_f32_16x16x32_bf16 v[60:63], v[188:191], v[28:31], v[60:63]
    s_nop 7
    v_cvt_pk_bf16_f32 v240, v32, v36
    v_cvt_pk_bf16_f32 v241, v40, v44
    v_cvt_pk_bf16_f32 v242, v48, v52
    v_cvt_pk_bf16_f32 v243, v56, v60
    buffer_store_dwordx4 v[240:243], v249, s[12:15], s39 offen sc1
    s_add_u32 s39, s39, 2736128
    v_cvt_pk_bf16_f32 v244, v33, v37
    v_cvt_pk_bf16_f32 v245, v41, v45
    v_cvt_pk_bf16_f32 v246, v49, v53
    v_cvt_pk_bf16_f32 v247, v57, v61
    buffer_store_dwordx4 v[244:247], v249, s[12:15], s39 offen sc1
    s_add_u32 s39, s39, 2736128
    v_cvt_pk_bf16_f32 v240, v34, v38
    v_cvt_pk_bf16_f32 v241, v42, v46
    v_cvt_pk_bf16_f32 v242, v50, v54
    v_cvt_pk_bf16_f32 v243, v58, v62
    buffer_store_dwordx4 v[240:243], v249, s[12:15], s39 offen sc1
    s_add_u32 s39, s39, 2736128
    v_cvt_pk_bf16_f32 v244, v35, v39
    v_cvt_pk_bf16_f32 v245, v43, v47
    v_cvt_pk_bf16_f32 v246, v51, v55
    v_cvt_pk_bf16_f32 v247, v59, v63
    buffer_store_dwordx4 v[244:247], v249, s[12:15], s39 offen sc1
K12_H2:
    s_mov_b64 exec, 1
    v_mov_b32 v255, 155664
    v_mov_b32 v64, 1
    ds_add_u32 v255, v64
    s_mov_b64 exec, -1
    s_waitcnt vmcnt(0)
    s_mov_b32 s41, 0
    s_mov_b32 s34, -1
    s_cmp_ge_u32 s41, 8
    s_cbranch_scc1 K12_SG0
    s_lshl_b32 s36, s41, 2
    s_add_u32 s37, s36, 155680
    s_mov_b64 exec, 1
    v_mov_b32 v255, s37
    v_mov_b32 v240, 1
    ds_add_rtn_u32 v240, v255, v240
    s_waitcnt lgkmcnt(0)
    v_readfirstlane_b32 s37, v240
    s_nop 3
    s_cmp_eq_u32 s37, 3
    s_cbranch_scc0 K12_SH0
    s_lshl_b32 s36, s36, 8
    v_mov_b32 v255, 1
    v_mov_b32 v240, s36
    buffer_atomic_add v255, v240, s[60:63], 0 offen sc0 sc1
    s_mov_b32 s34, s41
K12_SH0:
    s_mov_b64 exec, -1
K12_SG0:
    s_waitcnt vmcnt(0)
    s_cmp_ge_u32 s34, 8
    s_cbranch_scc1 K12_PB1
    v_readfirstlane_b32 s37, v255
    s_nop 3
    s_cmp_eq_u32 s37, 255
    s_cbranch_scc0 K12_PB1
    s_lshl_b32 s36, s34, 4
    s_add_u32 s36, s36, 16384
    s_mov_b64 exec, 1
    v_mov_b32 v255, 1
    v_mov_b32 v240, s36
    buffer_store_dword v255, v240, s[60:63], 0 offen sc1
    s_mov_b64 exec, -1
K12_PB1:
    s_branch K12_CONS
K12_PROD:
    s_mov_b32 s37, 131072
K12_TW:
    v_mov_b32 v240, 155648
    ds_read_b32 v240, v240
    s_waitcnt lgkmcnt(0)
    v_cmp_gt_u32 vcc, 2, v240
    s_sub_u32 s37, s37, 1
    s_cmp_eq_u32 s37, 0
    s_cbranch_scc1 K12_TX
    s_cbranch_vccz K12_TX
    s_sleep 2
    s_branch K12_TW
K12_TX:
    v_lshrrev_b32 v128, 4, v254
    v_lshlrev_b32 v129, 11, v128
    v_lshrrev_b32 v130, 1, v128
    v_lshlrev_b32 v130, 20, v130
    v_and_b32 v131, 1, v128
    v_lshl_add_u32 v130, v131, 7, v130
    s_mov_b32 s45, s27
    s_mov_b32 s46, s30
    s_add_u32 s47, s40, 1
K12_TCH:
    s_xor_b32 s48, s47, s20
    s_and_b32 s48, s48, 1
    s_cmp_eq_u32 s48, 0
    s_cbranch_scc1 K12_TCHW
    s_mul_i32 s36, s47, 85
    s_add_u32 s36, s36, s2
    s_and_b32 s36, s36, 255
    s_mul_hi_u32 s37, s36, 0x55555556
    s_mul_i32 s38, s37, 3
    s_cmp_eq_u32 s38, s36
    s_cselect_b32 s27, 1, 0
    s_cmp_lt_u32 s37, 78
    s_cselect_b32 s27, s27, 0
    s_add_u32 s37, s37, 89
    s_cmp_eq_u32 s21, 0
    s_cselect_b32 s30, s24, s37
    s_cselect_b32 s27, 1, s27
    s_cmp_eq_u32 s27, 0
    s_cbranch_scc1 K12_TCHN
    s_lshl_b32 s36, s47, 8
    s_mul_i32 s37, s30, 98304
    s_add_u32 s36, s36, s37
    buffer_load_dword v244, v129, s[4:7], s36 offen
    buffer_load_dword v245, v129, s[4:7], s36 offen offset:128
    s_branch K12_TCHN
K12_TCHW:
    s_lshl_b32 s36, s47, 7
    s_add_u32 s36, s36, s22
    s_lshr_b32 s37, s36, 9
    s_lshl_b32 s37, s37, 19
    s_and_b32 s36, s36, 511
    s_lshl_b32 s36, s36, 10
    s_add_u32 s36, s36, s37
    s_add_u32 s36, s36, s33
    s_mov_b64 exec, 0xffffffff
    buffer_load_dword v246, v130, s[8:11], s36 offen
    s_mov_b64 exec, -1
K12_TCHN:
    s_add_u32 s47, s47, 1
    s_cmp_lt_u32 s47, 8
    s_cbranch_scc1 K12_TCH
    s_mov_b32 s27, s45
    s_mov_b32 s30, s46
    s_setprio 1
    s_cmp_eq_u32 s43, 0
    s_cbranch_scc1 K12_WENTRY
K12_XW:
    s_waitcnt vmcnt(0)
    s_mov_b32 s34, -1
    s_cmp_ge_u32 s41, 8
    s_cbranch_scc1 K12_SG2
    s_lshl_b32 s36, s41, 2
    s_add_u32 s37, s36, 155680
    s_mov_b64 exec, 1
    v_mov_b32 v255, s37
    v_mov_b32 v240, 1
    ds_add_rtn_u32 v240, v255, v240
    s_waitcnt lgkmcnt(0)
    v_readfirstlane_b32 s37, v240
    s_nop 3
    s_cmp_eq_u32 s37, 3
    s_cbranch_scc0 K12_SH2
    s_lshl_b32 s36, s36, 8
    v_mov_b32 v255, 1
    v_mov_b32 v240, s36
    buffer_atomic_add v255, v240, s[60:63], 0 offen sc0 sc1
    s_mov_b32 s34, s41
K12_SH2:
    s_mov_b64 exec, -1
K12_SG2:
    s_cmp_ge_u32 s34, 8
    s_cbranch_scc1 K12_EP3
    s_waitcnt vmcnt(0)
    s_cmp_ge_u32 s34, 8
    s_cbranch_scc1 K12_PB4
    v_readfirstlane_b32 s37, v255
    s_nop 3
    s_cmp_eq_u32 s37, 255
    s_cbranch_scc0 K12_PB4
    s_lshl_b32 s36, s34, 4
    s_add_u32 s36, s36, 16384
    s_mov_b64 exec, 1
    v_mov_b32 v255, 1
    v_mov_b32 v240, s36
    buffer_store_dword v255, v240, s[60:63], 0 offen sc1
    s_mov_b64 exec, -1
K12_PB4:
    s_mov_b32 s34, -1
K12_EP3:
    s_cmp_eq_u32 s27, 0
    s_cbranch_scc1 K12_XP_N
    v_perm_b32 v64, v4, v0, s28
    v_perm_b32 v68, v4, v0, s29
    v_perm_b32 v65, v12, v8, s28
    v_perm_b32 v69, v12, v8, s29
    v_perm_b32 v66, v20, v16, s28
    v_perm_b32 v70, v20, v16, s29
    v_perm_b32 v67, v28, v24, s28
    v_perm_b32 v71, v28, v24, s29
    v_perm_b32 v72, v5, v1, s28
    v_perm_b32 v76, v5, v1, s29
    v_perm_b32 v73, v13, v9, s28
    v_perm_b32 v77, v13, v9, s29
    v_perm_b32 v74, v21, v17, s28
    v_perm_b32 v78, v21, v17, s29
    v_perm_b32 v75, v29, v25, s28
    v_perm_b32 v79, v29, v25, s29
    v_perm_b32 v80, v6, v2, s28
    v_perm_b32 v84, v6, v2, s29
    v_perm_b32 v81, v14, v10, s28
    v_perm_b32 v85, v14, v10, s29
    v_perm_b32 v82, v22, v18, s28
    v_perm_b32 v86, v22, v18, s29
    v_perm_b32 v83, v30, v26, s28
    v_perm_b32 v87, v30, v26, s29
    v_perm_b32 v88, v7, v3, s28
    v_perm_b32 v92, v7, v3, s29
    v_perm_b32 v89, v15, v11, s28
    v_perm_b32 v93, v15, v11, s29
    v_perm_b32 v90, v23, v19, s28
    v_perm_b32 v94, v23, v19, s29
    v_perm_b32 v91, v31, v27, s28
    v_perm_b32 v95, v31, v27, s29
    v_perm_b32 v0, v36, v32, s28
    v_perm_b32 v4, v36, v32, s29
    v_perm_b32 v1, v44, v40, s28
    v_perm_b32 v5, v44, v40, s29
    v_perm_b32 v2, v52, v48, s28
    v_perm_b32 v6, v52, v48, s29
    v_perm_b32 v3, v60, v56, s28
    v_perm_b32 v7, v60, v56, s29
    v_perm_b32 v8, v37, v33, s28
    v_perm_b32 v12, v37, v33, s29
    v_perm_b32 v9, v45, v41, s28
    v_perm_b32 v13, v45, v41, s29
    v_perm_b32 v10, v53, v49, s28
    v_perm_b32 v14, v53, v49, s29
    v_perm_b32 v11, v61, v57, s28
    v_perm_b32 v15, v61, v57, s29
    v_perm_b32 v16, v38, v34, s28
    v_perm_b32 v20, v38, v34, s29
    v_perm_b32 v17, v46, v42, s28
    v_perm_b32 v21, v46, v42, s29
    v_perm_b32 v18, v54, v50, s28
    v_perm_b32 v22, v54, v50, s29
    v_perm_b32 v19, v62, v58, s28
    v_perm_b32 v23, v62, v58, s29
    v_perm_b32 v24, v39, v35, s28
    v_perm_b32 v28, v39, v35, s29
    v_perm_b32 v25, v47, v43, s28
    v_perm_b32 v29, v47, v43, s29
    v_perm_b32 v26, v55, v51, s28
    v_perm_b32 v30, v55, v51, s29
    v_perm_b32 v27, v63, v59, s28
    v_perm_b32 v31, v63, v59, s29
K12_XP_N:
    s_lshl_b32 s36, s40, 3
    s_sub_i32 s36, s36, 24
    s_max_i32 s36, s36, 1
    s_mov_b32 s37, 131072
K12_GL0:
    v_mov_b32 v240, 155648
    ds_read_b32 v240, v240
    s_waitcnt lgkmcnt(0)
    v_cmp_gt_u32 vcc, s36, v240
    s_sub_u32 s37, s37, 1
    s_cmp_eq_u32 s37, 0
    s_cbranch_scc1 K12_GT0
    s_cbranch_vccz K12_GT0
    s_sleep 2
    s_branch K12_GL0
K12_GT0:
    s_add_u32 s42, s40, 1
    s_lshl_b32 s36, s42, 7
    s_add_u32 s36, s36, s22
    s_lshr_b32 s37, s36, 9
    s_lshl_b32 s37, s37, 19
    s_and_b32 s36, s36, 511
    s_lshl_b32 s36, s36, 10
    s_add_u32 s36, s36, s37
    s_add_u32 s36, s36, s33
    buffer_load_dwordx4 v[96:99], v250, s[8:11], s36 offen
    s_add_u32 s36, s36, 0x100000
    buffer_load_dwordx4 v[100:103], v250, s[8:11], s36 offen
    s_add_u32 s36, s36, 0x100000
    buffer_load_dwordx4 v[104:107], v250, s[8:11], s36 offen
    s_add_u32 s36, s36, 0x100000
    buffer_load_dwordx4 v[108:111], v250, s[8:11], s36 offen
    s_add_u32 s36, s36, 0x100000
    buffer_load_dwordx4 v[112:115], v250, s[8:11], s36 offen
    s_add_u32 s36, s36, 0x100000
    buffer_load_dwordx4 v[116:119], v250, s[8:11], s36 offen
    s_add_u32 s36, s36, 0x100000
    buffer_load_dwordx4 v[120:123], v250, s[8:11], s36 offen
    s_add_u32 s36, s36, 0x100000
    buffer_load_dwordx4 v[124:127], v250, s[8:11], s36 offen
    s_cmp_eq_u32 s27, 0
    s_cbranch_scc1 K12_XP_E
    s_mul_i32 s39, s40, 85504
    s_add_u32 s39, s39, s31
    s_lshl_b32 s36, s30, 7
    s_add_u32 s39, s39, s36
    v_bfe_u32 v249, v254, 4, 2
    v_bfe_u32 v240, v254, 8, 1
    v_lshl_add_u32 v249, v240, 2, v249
    s_add_u32 s36, s30, 7
    s_cmp_ge_u32 s30, 160
    s_cselect_b32 s36, s36, s30
    s_cmp_eq_u32 s25, 1
    s_cselect_b32 s36, s36, s30
    s_lshr_b32 s36, s36, 1
    s_and_b32 s36, s36, 7
    v_xor_b32 v249, s36, v249
    v_lshl_add_u32 v249, v249, 4, v252
    v_mfma_f32_16x16x32_bf16 v[32:35], v[160:163], v[64:67], 0
    v_mfma_f32_16x16x32_bf16 v[36:39], v[160:163], v[68:71], 0
    v_mfma_f32_16x16x32_bf16 v[40:43], v[160:163], v[72:75], 0
    v_mfma_f32_16x16x32_bf16 v[44:47], v[160:163], v[76:79], 0
    v_mfma_f32_16x16x32_bf16 v[48:51], v[160:163], v[80:83], 0
    v_mfma_f32_16x16x32_bf16 v[52:55], v[160:163], v[84:87], 0
    v_mfma_f32_16x16x32_bf16 v[56:59], v[160:163], v[88:91], 0
    v_mfma_f32_16x16x32_bf16 v[60:63], v[160:163], v[92:95], 0
    v_mfma_f32_16x16x32_bf16 v[32:35], v[164:167], v[0:3], v[32:35]
    v_mfma_f32_16x16x32_bf16 v[36:39], v[164:167], v[4:7], v[36:39]
    v_mfma_f32_16x16x32_bf16 v[40:43], v[164:167], v[8:11], v[40:43]
    v_mfma_f32_16x16x32_bf16 v[44:47], v[164:167], v[12:15], v[44:47]
    v_mfma_f32_16x16x32_bf16 v[48:51], v[164:167], v[16:19], v[48:51]
    v_mfma_f32_16x16x32_bf16 v[52:55], v[164:167], v[20:23], v[52:55]
    v_mfma_f32_16x16x32_bf16 v[56:59], v[164:167], v[24:27], v[56:59]
    v_mfma_f32_16x16x32_bf16 v[60:63], v[164:167], v[28:31], v[60:63]
    s_nop 7
    v_cvt_pk_bf16_f32 v240, v32, v36
    v_cvt_pk_bf16_f32 v241, v40, v44
    v_cvt_pk_bf16_f32 v242, v48, v52
    v_cvt_pk_bf16_f32 v243, v56, v60
    buffer_store_dwordx4 v[240:243], v249, s[12:15], s39 offen sc1
    s_add_u32 s39, s39, 2736128
    v_cvt_pk_bf16_f32 v244, v33, v37
    v_cvt_pk_bf16_f32 v245, v41, v45
    v_cvt_pk_bf16_f32 v246, v49, v53
    v_cvt_pk_bf16_f32 v247, v57, v61
    buffer_store_dwordx4 v[244:247], v249, s[12:15], s39 offen sc1
    s_add_u32 s39, s39, 2736128
    v_cvt_pk_bf16_f32 v240, v34, v38
    v_cvt_pk_bf16_f32 v241, v42, v46
    v_cvt_pk_bf16_f32 v242, v50, v54
    v_cvt_pk_bf16_f32 v243, v58, v62
    buffer_store_dwordx4 v[240:243], v249, s[12:15], s39 offen sc1
    s_add_u32 s39, s39, 2736128
    v_cvt_pk_bf16_f32 v244, v35, v39
    v_cvt_pk_bf16_f32 v245, v43, v47
    v_cvt_pk_bf16_f32 v246, v51, v55
    v_cvt_pk_bf16_f32 v247, v59, v63
    buffer_store_dwordx4 v[244:247], v249, s[12:15], s39 offen sc1
    s_add_u32 s39, s39, 2736128
    v_mfma_f32_16x16x32_bf16 v[32:35], v[168:171], v[64:67], 0
    v_mfma_f32_16x16x32_bf16 v[36:39], v[168:171], v[68:71], 0
    v_mfma_f32_16x16x32_bf16 v[40:43], v[168:171], v[72:75], 0
    v_mfma_f32_16x16x32_bf16 v[44:47], v[168:171], v[76:79], 0
    v_mfma_f32_16x16x32_bf16 v[48:51], v[168:171], v[80:83], 0
    v_mfma_f32_16x16x32_bf16 v[52:55], v[168:171], v[84:87], 0
    v_mfma_f32_16x16x32_bf16 v[56:59], v[168:171], v[88:91], 0
    v_mfma_f32_16x16x32_bf16 v[60:63], v[168:171], v[92:95], 0
    v_mfma_f32_16x16x32_bf16 v[32:35], v[172:175], v[0:3], v[32:35]
    v_mfma_f32_16x16x32_bf16 v[36:39], v[172:175], v[4:7], v[36:39]
    v_mfma_f32_16x16x32_bf16 v[40:43], v[172:175], v[8:11], v[40:43]
    v_mfma_f32_16x16x32_bf16 v[44:47], v[172:175], v[12:15], v[44:47]
    v_mfma_f32_16x16x32_bf16 v[48:51], v[172:175], v[16:19], v[48:51]
    v_mfma_f32_16x16x32_bf16 v[52:55], v[172:175], v[20:23], v[52:55]
    v_mfma_f32_16x16x32_bf16 v[56:59], v[172:175], v[24:27], v[56:59]
    v_mfma_f32_16x16x32_bf16 v[60:63], v[172:175], v[28:31], v[60:63]
    s_nop 7
    v_cvt_pk_bf16_f32 v240, v32, v36
    v_cvt_pk_bf16_f32 v241, v40, v44
    v_cvt_pk_bf16_f32 v242, v48, v52
    v_cvt_pk_bf16_f32 v243, v56, v60
    buffer_store_dwordx4 v[240:243], v249, s[12:15], s39 offen sc1
    s_add_u32 s39, s39, 2736128
    v_cvt_pk_bf16_f32 v244, v33, v37
    v_cvt_pk_bf16_f32 v245, v41, v45
    v_cvt_pk_bf16_f32 v246, v49, v53
    v_cvt_pk_bf16_f32 v247, v57, v61
    buffer_store_dwordx4 v[244:247], v249, s[12:15], s39 offen sc1
    s_add_u32 s39, s39, 2736128
    v_cvt_pk_bf16_f32 v240, v34, v38
    v_cvt_pk_bf16_f32 v241, v42, v46
    v_cvt_pk_bf16_f32 v242, v50, v54
    v_cvt_pk_bf16_f32 v243, v58, v62
    buffer_store_dwordx4 v[240:243], v249, s[12:15], s39 offen sc1
    s_add_u32 s39, s39, 2736128
    v_cvt_pk_bf16_f32 v244, v35, v39
    v_cvt_pk_bf16_f32 v245, v43, v47
    v_cvt_pk_bf16_f32 v246, v51, v55
    v_cvt_pk_bf16_f32 v247, v59, v63
    buffer_store_dwordx4 v[244:247], v249, s[12:15], s39 offen sc1
    s_add_u32 s39, s39, 2736128
    v_mfma_f32_16x16x32_bf16 v[32:35], v[176:179], v[64:67], 0
    v_mfma_f32_16x16x32_bf16 v[36:39], v[176:179], v[68:71], 0
    v_mfma_f32_16x16x32_bf16 v[40:43], v[176:179], v[72:75], 0
    v_mfma_f32_16x16x32_bf16 v[44:47], v[176:179], v[76:79], 0
    v_mfma_f32_16x16x32_bf16 v[48:51], v[176:179], v[80:83], 0
    v_mfma_f32_16x16x32_bf16 v[52:55], v[176:179], v[84:87], 0
    v_mfma_f32_16x16x32_bf16 v[56:59], v[176:179], v[88:91], 0
    v_mfma_f32_16x16x32_bf16 v[60:63], v[176:179], v[92:95], 0
    v_mfma_f32_16x16x32_bf16 v[32:35], v[180:183], v[0:3], v[32:35]
    v_mfma_f32_16x16x32_bf16 v[36:39], v[180:183], v[4:7], v[36:39]
    v_mfma_f32_16x16x32_bf16 v[40:43], v[180:183], v[8:11], v[40:43]
    v_mfma_f32_16x16x32_bf16 v[44:47], v[180:183], v[12:15], v[44:47]
    v_mfma_f32_16x16x32_bf16 v[48:51], v[180:183], v[16:19], v[48:51]
    v_mfma_f32_16x16x32_bf16 v[52:55], v[180:183], v[20:23], v[52:55]
    v_mfma_f32_16x16x32_bf16 v[56:59], v[180:183], v[24:27], v[56:59]
    v_mfma_f32_16x16x32_bf16 v[60:63], v[180:183], v[28:31], v[60:63]
    s_nop 7
    v_cvt_pk_bf16_f32 v240, v32, v36
    v_cvt_pk_bf16_f32 v241, v40, v44
    v_cvt_pk_bf16_f32 v242, v48, v52
    v_cvt_pk_bf16_f32 v243, v56, v60
    buffer_store_dwordx4 v[240:243], v249, s[12:15], s39 offen sc1
    s_add_u32 s39, s39, 2736128
    v_cvt_pk_bf16_f32 v244, v33, v37
    v_cvt_pk_bf16_f32 v245, v41, v45
    v_cvt_pk_bf16_f32 v246, v49, v53
    v_cvt_pk_bf16_f32 v247, v57, v61
    buffer_store_dwordx4 v[244:247], v249, s[12:15], s39 offen sc1
    s_add_u32 s39, s39, 2736128
    v_cvt_pk_bf16_f32 v240, v34, v38
    v_cvt_pk_bf16_f32 v241, v42, v46
    v_cvt_pk_bf16_f32 v242, v50, v54
    v_cvt_pk_bf16_f32 v243, v58, v62
    buffer_store_dwordx4 v[240:243], v249, s[12:15], s39 offen sc1
    s_add_u32 s39, s39, 2736128
    v_cvt_pk_bf16_f32 v244, v35, v39
    v_cvt_pk_bf16_f32 v245, v43, v47
    v_cvt_pk_bf16_f32 v246, v51, v55
    v_cvt_pk_bf16_f32 v247, v59, v63
    buffer_store_dwordx4 v[244:247], v249, s[12:15], s39 offen sc1
    s_add_u32 s39, s39, 2736128
    v_mfma_f32_16x16x32_bf16 v[32:35], v[184:187], v[64:67], 0
    v_mfma_f32_16x16x32_bf16 v[36:39], v[184:187], v[68:71], 0
    v_mfma_f32_16x16x32_bf16 v[40:43], v[184:187], v[72:75], 0
    v_mfma_f32_16x16x32_bf16 v[44:47], v[184:187], v[76:79], 0
    v_mfma_f32_16x16x32_bf16 v[48:51], v[184:187], v[80:83], 0
    v_mfma_f32_16x16x32_bf16 v[52:55], v[184:187], v[84:87], 0
    v_mfma_f32_16x16x32_bf16 v[56:59], v[184:187], v[88:91], 0
    v_mfma_f32_16x16x32_bf16 v[60:63], v[184:187], v[92:95], 0
    v_mfma_f32_16x16x32_bf16 v[32:35], v[188:191], v[0:3], v[32:35]
    v_mfma_f32_16x16x32_bf16 v[36:39], v[188:191], v[4:7], v[36:39]
    v_mfma_f32_16x16x32_bf16 v[40:43], v[188:191], v[8:11], v[40:43]
    v_mfma_f32_16x16x32_bf16 v[44:47], v[188:191], v[12:15], v[44:47]
    v_mfma_f32_16x16x32_bf16 v[48:51], v[188:191], v[16:19], v[48:51]
    v_mfma_f32_16x16x32_bf16 v[52:55], v[188:191], v[20:23], v[52:55]
    v_mfma_f32_16x16x32_bf16 v[56:59], v[188:191], v[24:27], v[56:59]
    v_mfma_f32_16x16x32_bf16 v[60:63], v[188:191], v[28:31], v[60:63]
    s_nop 7
    v_cvt_pk_bf16_f32 v240, v32, v36
    v_cvt_pk_bf16_f32 v241, v40, v44
    v_cvt_pk_bf16_f32 v242, v48, v52
    v_cvt_pk_bf16_f32 v243, v56, v60
    buffer_store_dwordx4 v[240:243], v249, s[12:15], s39 offen sc1
    s_add_u32 s39, s39, 2736128
    v_cvt_pk_bf16_f32 v244, v33, v37
    v_cvt_pk_bf16_f32 v245, v41, v45
    v_cvt_pk_bf16_f32 v246, v49, v53
    v_cvt_pk_bf16_f32 v247, v57, v61
    buffer_store_dwordx4 v[244:247], v249, s[12:15], s39 offen sc1
    s_add_u32 s39, s39, 2736128
    v_cvt_pk_bf16_f32 v240, v34, v38
    v_cvt_pk_bf16_f32 v241, v42, v46
    v_cvt_pk_bf16_f32 v242, v50, v54
    v_cvt_pk_bf16_f32 v243, v58, v62
    buffer_store_dwordx4 v[240:243], v249, s[12:15], s39 offen sc1
    s_add_u32 s39, s39, 2736128
    v_cvt_pk_bf16_f32 v244, v35, v39
    v_cvt_pk_bf16_f32 v245, v43, v47
    v_cvt_pk_bf16_f32 v246, v51, v55
    v_cvt_pk_bf16_f32 v247, v59, v63
    buffer_store_dwordx4 v[244:247], v249, s[12:15], s39 offen sc1
    s_mov_b32 s41, s40
    s_add_u32 s40, s40, 1
    s_cmp_eq_u32 s41, 3
    s_cbranch_scc0 K12_ES5
    s_waitcnt vmcnt(0)
    s_mov_b32 s34, -1
    s_cmp_ge_u32 s41, 8
    s_cbranch_scc1 K12_SG6
    s_lshl_b32 s36, s41, 2
    s_add_u32 s37, s36, 155680
    s_mov_b64 exec, 1
    v_mov_b32 v255, s37
    v_mov_b32 v240, 1
    ds_add_rtn_u32 v240, v255, v240
    s_waitcnt lgkmcnt(0)
    v_readfirstlane_b32 s37, v240
    s_nop 3
    s_cmp_eq_u32 s37, 3
    s_cbranch_scc0 K12_SH6
    s_lshl_b32 s36, s36, 8
    v_mov_b32 v255, 1
    v_mov_b32 v240, s36
    buffer_atomic_add v255, v240, s[60:63], 0 offen sc0 sc1
    s_mov_b32 s34, s41
K12_SH6:
    s_mov_b64 exec, -1
K12_SG6:
    s_waitcnt vmcnt(0)
    s_cmp_ge_u32 s34, 8
    s_cbranch_scc1 K12_PB7
    v_readfirstlane_b32 s37, v255
    s_nop 3
    s_cmp_eq_u32 s37, 255
    s_cbranch_scc0 K12_PB7
    s_lshl_b32 s36, s34, 4
    s_add_u32 s36, s36, 16384
    s_mov_b64 exec, 1
    v_mov_b32 v255, 1
    v_mov_b32 v240, s36
    buffer_store_dword v255, v240, s[60:63], 0 offen sc1
    s_mov_b64 exec, -1
K12_PB7:
    s_mov_b32 s34, -1
    s_mov_b32 s41, -1
K12_ES5:
    s_waitcnt vmcnt(16)
    s_branch K12_XP_F
K12_XP_E:
    s_mov_b32 s41, s40
    s_add_u32 s40, s40, 1
    s_cmp_eq_u32 s41, 3
    s_cbranch_scc0 K12_ES8
    s_waitcnt vmcnt(0)
    s_mov_b32 s34, -1
    s_cmp_ge_u32 s41, 8
    s_cbranch_scc1 K12_SG9
    s_lshl_b32 s36, s41, 2
    s_add_u32 s37, s36, 155680
    s_mov_b64 exec, 1
    v_mov_b32 v255, s37
    v_mov_b32 v240, 1
    ds_add_rtn_u32 v240, v255, v240
    s_waitcnt lgkmcnt(0)
    v_readfirstlane_b32 s37, v240
    s_nop 3
    s_cmp_eq_u32 s37, 3
    s_cbranch_scc0 K12_SH9
    s_lshl_b32 s36, s36, 8
    v_mov_b32 v255, 1
    v_mov_b32 v240, s36
    buffer_atomic_add v255, v240, s[60:63], 0 offen sc0 sc1
    s_mov_b32 s34, s41
K12_SH9:
    s_mov_b64 exec, -1
K12_SG9:
    s_waitcnt vmcnt(0)
    s_cmp_ge_u32 s34, 8
    s_cbranch_scc1 K12_PB10
    v_readfirstlane_b32 s37, v255
    s_nop 3
    s_cmp_eq_u32 s37, 255
    s_cbranch_scc0 K12_PB10
    s_lshl_b32 s36, s34, 4
    s_add_u32 s36, s36, 16384
    s_mov_b64 exec, 1
    v_mov_b32 v255, 1
    v_mov_b32 v240, s36
    buffer_store_dword v255, v240, s[60:63], 0 offen sc1
    s_mov_b64 exec, -1
K12_PB10:
    s_mov_b32 s34, -1
    s_mov_b32 s41, -1
K12_ES8:
    s_waitcnt vmcnt(0)
K12_XP_F:
    s_cmp_ge_u32 s34, 8
    s_cbranch_scc1 K12_PB11
    v_readfirstlane_b32 s37, v255
    s_nop 3
    s_cmp_eq_u32 s37, 255
    s_cbranch_scc0 K12_PB11
    s_lshl_b32 s36, s34, 4
    s_add_u32 s36, s36, 16384
    s_mov_b64 exec, 1
    v_mov_b32 v255, 1
    v_mov_b32 v240, s36
    buffer_store_dword v255, v240, s[60:63], 0 offen sc1
    s_mov_b64 exec, -1
K12_PB11:
    s_cmp_ge_u32 s40, 8
    s_cbranch_scc1 K12_PFIN
K12_WENTRY:
    s_waitcnt vmcnt(0)
    s_mov_b32 s34, -1
    s_cmp_ge_u32 s41, 8
    s_cbranch_scc1 K12_SG12
    s_lshl_b32 s36, s41, 2
    s_add_u32 s37, s36, 155680
    s_mov_b64 exec, 1
    v_mov_b32 v255, s37
    v_mov_b32 v240, 1
    ds_add_rtn_u32 v240, v255, v240
    s_waitcnt lgkmcnt(0)
    v_readfirstlane_b32 s37, v240
    s_nop 3
    s_cmp_eq_u32 s37, 3
    s_cbranch_scc0 K12_SH12
    s_lshl_b32 s36, s36, 8
    v_mov_b32 v255, 1
    v_mov_b32 v240, s36
    buffer_atomic_add v255, v240, s[60:63], 0 offen sc0 sc1
    s_mov_b32 s34, s41
K12_SH12:
    s_mov_b64 exec, -1
K12_SG12:
    s_cmp_ge_u32 s34, 8
    s_cbranch_scc1 K12_EP13
    s_waitcnt vmcnt(0)
    s_cmp_ge_u32 s34, 8
    s_cbranch_scc1 K12_PB14
    v_readfirstlane_b32 s37, v255
    s_nop 3
    s_cmp_eq_u32 s37, 255
    s_cbranch_scc0 K12_PB14
    s_lshl_b32 s36, s34, 4
    s_add_u32 s36, s36, 16384
    s_mov_b64 exec, 1
    v_mov_b32 v255, 1
    v_mov_b32 v240, s36
    buffer_store_dword v255, v240, s[60:63], 0 offen sc1
    s_mov_b64 exec, -1
K12_PB14:
    s_mov_b32 s34, -1
K12_EP13:
    v_perm_b32 v64, v100, v96, s28
    v_perm_b32 v68, v100, v96, s29
    v_perm_b32 v65, v108, v104, s28
    v_perm_b32 v69, v108, v104, s29
    v_perm_b32 v66, v116, v112, s28
    v_perm_b32 v70, v116, v112, s29
    v_perm_b32 v67, v124, v120, s28
    v_perm_b32 v71, v124, v120, s29
    v_perm_b32 v72, v101, v97, s28
    v_perm_b32 v76, v101, v97, s29
    v_perm_b32 v73, v109, v105, s28
    v_perm_b32 v77, v109, v105, s29
    v_perm_b32 v74, v117, v113, s28
    v_perm_b32 v78, v117, v113, s29
    v_perm_b32 v75, v125, v121, s28
    v_perm_b32 v79, v125, v121, s29
    v_perm_b32 v80, v102, v98, s28
    v_perm_b32 v84, v102, v98, s29
    v_perm_b32 v81, v110, v106, s28
    v_perm_b32 v85, v110, v106, s29
    v_perm_b32 v82, v118, v114, s28
    v_perm_b32 v86, v118, v114, s29
    v_perm_b32 v83, v126, v122, s28
    v_perm_b32 v87, v126, v122, s29
    v_perm_b32 v88, v103, v99, s28
    v_perm_b32 v92, v103, v99, s29
    v_perm_b32 v89, v111, v107, s28
    v_perm_b32 v93, v111, v107, s29
    v_perm_b32 v90, v119, v115, s28
    v_perm_b32 v94, v119, v115, s29
    v_perm_b32 v91, v127, v123, s28
    v_perm_b32 v95, v127, v123, s29
    s_lshl_b32 s36, s40, 3
    s_sub_i32 s36, s36, 24
    s_max_i32 s36, s36, 1
    s_mov_b32 s37, 131072
K12_GL1:
    v_mov_b32 v240, 155648
    ds_read_b32 v240, v240
    s_waitcnt lgkmcnt(0)
    v_cmp_gt_u32 vcc, s36, v240
    s_sub_u32 s37, s37, 1
    s_cmp_eq_u32 s37, 0
    s_cbranch_scc1 K12_GT1
    s_cbranch_vccz K12_GT1
    s_sleep 2
    s_branch K12_GL1
K12_GT1:
    s_add_u32 s42, s40, 1
    s_mul_i32 s36, s42, 85
    s_add_u32 s36, s36, s2
    s_and_b32 s36, s36, 255
    s_mul_hi_u32 s37, s36, 0x55555556
    s_mul_i32 s38, s37, 3
    s_cmp_eq_u32 s38, s36
    s_cselect_b32 s27, 1, 0
    s_cmp_lt_u32 s37, 78
    s_cselect_b32 s27, s27, 0
    s_add_u32 s37, s37, 89
    s_cmp_eq_u32 s21, 0
    s_cselect_b32 s30, s24, s37
    s_cselect_b32 s27, 1, s27
    s_cmp_eq_u32 s27, 0
    s_cbranch_scc1 K12_WP_N
    s_lshl_b32 s36, s42, 8
    s_mul_i32 s37, s30, 98304
    s_add_u32 s36, s36, s37
    buffer_load_dwordx4 v[0:3], v248, s[4:7], s36 offen
    buffer_load_dwordx4 v[4:7], v248, s[4:7], s36 offen offset:2048
    s_add_u32 s36, s36, 4096
    buffer_load_dwordx4 v[8:11], v248, s[4:7], s36 offen
    buffer_load_dwordx4 v[12:15], v248, s[4:7], s36 offen offset:2048
    s_add_u32 s36, s36, 4096
    buffer_load_dwordx4 v[16:19], v248, s[4:7], s36 offen
    buffer_load_dwordx4 v[20:23], v248, s[4:7], s36 offen offset:2048
    s_add_u32 s36, s36, 4096
    buffer_load_dwordx4 v[24:27], v248, s[4:7], s36 offen
    buffer_load_dwordx4 v[28:31], v248, s[4:7], s36 offen offset:2048
    s_add_u32 s36, s36, 53248
    buffer_load_dwordx4 v[32:35], v248, s[4:7], s36 offen
    buffer_load_dwordx4 v[36:39], v248, s[4:7], s36 offen offset:2048
    s_add_u32 s36, s36, 4096
    buffer_load_dwordx4 v[40:43], v248, s[4:7], s36 offen
    buffer_load_dwordx4 v[44:47], v248, s[4:7], s36 offen offset:2048
    s_add_u32 s36, s36, 4096
    buffer_load_dwordx4 v[48:51], v248, s[4:7], s36 offen
    buffer_load_dwordx4 v[52:55], v248, s[4:7], s36 offen offset:2048
    s_add_u32 s36, s36, 4096
    buffer_load_dwordx4 v[56:59], v248, s[4:7], s36 offen
    buffer_load_dwordx4 v[60:63], v248, s[4:7], s36 offen offset:2048
    s_branch K12_WP_M
K12_WP_N:
K12_WP_M:
    s_lshl_b32 s36, s40, 7
    s_add_u32 s36, s36, s22
    s_and_b32 s37, s36, 3
    s_lshr_b32 s38, s36, 1
    s_and_b32 s38, s38, 4
    s_or_b32 s37, s37, s38
    v_bfe_u32 v253, v254, 5, 3
    v_xor_b32 v253, s37, v253
    v_lshl_add_u32 v253, v253, 5, v251
    s_lshl_b32 s36, s36, 9
    s_add_u32 s39, s36, s32
    v_mfma_f32_16x16x32_bf16 v[128:131], v[224:227], v[64:67], 0
    v_mfma_f32_16x16x32_bf16 v[132:135], v[224:227], v[68:71], 0
    v_mfma_f32_16x16x32_bf16 v[136:139], v[224:227], v[72:75], 0
    v_mfma_f32_16x16x32_bf16 v[140:143], v[224:227], v[76:79], 0
    v_mfma_f32_16x16x32_bf16 v[144:147], v[224:227], v[80:83], 0
    v_mfma_f32_16x16x32_bf16 v[148:151], v[224:227], v[84:87], 0
    v_mfma_f32_16x16x32_bf16 v[152:155], v[224:227], v[88:91], 0
    v_mfma_f32_16x16x32_bf16 v[156:159], v[224:227], v[92:95], 0
    s_nop 7
    v_cvt_pk_bf16_f32 v240, v128, v132
    v_cvt_pk_bf16_f32 v241, v136, v140
    v_cvt_pk_bf16_f32 v242, v144, v148
    v_cvt_pk_bf16_f32 v243, v152, v156
    buffer_store_dwordx4 v[240:243], v253, s[16:19], s39 offen sc1
    s_add_u32 s39, s39, 4194304
    v_cvt_pk_bf16_f32 v244, v129, v133
    v_cvt_pk_bf16_f32 v245, v137, v141
    v_cvt_pk_bf16_f32 v246, v145, v149
    v_cvt_pk_bf16_f32 v247, v153, v157
    buffer_store_dwordx4 v[244:247], v253, s[16:19], s39 offen sc1
    s_add_u32 s39, s39, 4194304
    v_cvt_pk_bf16_f32 v240, v130, v134
    v_cvt_pk_bf16_f32 v241, v138, v142
    v_cvt_pk_bf16_f32 v242, v146, v150
    v_cvt_pk_bf16_f32 v243, v154, v158
    buffer_store_dwordx4 v[240:243], v253, s[16:19], s39 offen sc1
    s_add_u32 s39, s39, 4194304
    v_cvt_pk_bf16_f32 v244, v131, v135
    v_cvt_pk_bf16_f32 v245, v139, v143
    v_cvt_pk_bf16_f32 v246, v147, v151
    v_cvt_pk_bf16_f32 v247, v155, v159
    buffer_store_dwordx4 v[244:247], v253, s[16:19], s39 offen sc1
    s_add_u32 s39, s39, 4194304
    v_mfma_f32_16x16x32_bf16 v[128:131], v[228:231], v[64:67], 0
    v_mfma_f32_16x16x32_bf16 v[132:135], v[228:231], v[68:71], 0
    v_mfma_f32_16x16x32_bf16 v[136:139], v[228:231], v[72:75], 0
    v_mfma_f32_16x16x32_bf16 v[140:143], v[228:231], v[76:79], 0
    v_mfma_f32_16x16x32_bf16 v[144:147], v[228:231], v[80:83], 0
    v_mfma_f32_16x16x32_bf16 v[148:151], v[228:231], v[84:87], 0
    v_mfma_f32_16x16x32_bf16 v[152:155], v[228:231], v[88:91], 0
    v_mfma_f32_16x16x32_bf16 v[156:159], v[228:231], v[92:95], 0
    s_nop 7
    v_cvt_pk_bf16_f32 v240, v128, v132
    v_cvt_pk_bf16_f32 v241, v136, v140
    v_cvt_pk_bf16_f32 v242, v144, v148
    v_cvt_pk_bf16_f32 v243, v152, v156
    buffer_store_dwordx4 v[240:243], v253, s[16:19], s39 offen sc1
    s_add_u32 s39, s39, 4194304
    v_cvt_pk_bf16_f32 v244, v129, v133
    v_cvt_pk_bf16_f32 v245, v137, v141
    v_cvt_pk_bf16_f32 v246, v145, v149
    v_cvt_pk_bf16_f32 v247, v153, v157
    buffer_store_dwordx4 v[244:247], v253, s[16:19], s39 offen sc1
    s_add_u32 s39, s39, 4194304
    v_cvt_pk_bf16_f32 v240, v130, v134
    v_cvt_pk_bf16_f32 v241, v138, v142
    v_cvt_pk_bf16_f32 v242, v146, v150
    v_cvt_pk_bf16_f32 v243, v154, v158
    buffer_store_dwordx4 v[240:243], v253, s[16:19], s39 offen sc1
    s_add_u32 s39, s39, 4194304
    v_cvt_pk_bf16_f32 v244, v131, v135
    v_cvt_pk_bf16_f32 v245, v139, v143
    v_cvt_pk_bf16_f32 v246, v147, v151
    v_cvt_pk_bf16_f32 v247, v155, v159
    buffer_store_dwordx4 v[244:247], v253, s[16:19], s39 offen sc1
    s_add_u32 s39, s39, 4194304
    v_mfma_f32_16x16x32_bf16 v[128:131], v[232:235], v[64:67], 0
    v_mfma_f32_16x16x32_bf16 v[132:135], v[232:235], v[68:71], 0
    v_mfma_f32_16x16x32_bf16 v[136:139], v[232:235], v[72:75], 0
    v_mfma_f32_16x16x32_bf16 v[140:143], v[232:235], v[76:79], 0
    v_mfma_f32_16x16x32_bf16 v[144:147], v[232:235], v[80:83], 0
    v_mfma_f32_16x16x32_bf16 v[148:151], v[232:235], v[84:87], 0
    v_mfma_f32_16x16x32_bf16 v[152:155], v[232:235], v[88:91], 0
    v_mfma_f32_16x16x32_bf16 v[156:159], v[232:235], v[92:95], 0
    s_nop 7
    v_cvt_pk_bf16_f32 v240, v128, v132
    v_cvt_pk_bf16_f32 v241, v136, v140
    v_cvt_pk_bf16_f32 v242, v144, v148
    v_cvt_pk_bf16_f32 v243, v152, v156
    buffer_store_dwordx4 v[240:243], v253, s[16:19], s39 offen sc1
    s_add_u32 s39, s39, 4194304
    v_cvt_pk_bf16_f32 v244, v129, v133
    v_cvt_pk_bf16_f32 v245, v137, v141
    v_cvt_pk_bf16_f32 v246, v145, v149
    v_cvt_pk_bf16_f32 v247, v153, v157
    buffer_store_dwordx4 v[244:247], v253, s[16:19], s39 offen sc1
    s_add_u32 s39, s39, 4194304
    v_cvt_pk_bf16_f32 v240, v130, v134
    v_cvt_pk_bf16_f32 v241, v138, v142
    v_cvt_pk_bf16_f32 v242, v146, v150
    v_cvt_pk_bf16_f32 v243, v154, v158
    buffer_store_dwordx4 v[240:243], v253, s[16:19], s39 offen sc1
    s_add_u32 s39, s39, 4194304
    v_cvt_pk_bf16_f32 v244, v131, v135
    v_cvt_pk_bf16_f32 v245, v139, v143
    v_cvt_pk_bf16_f32 v246, v147, v151
    v_cvt_pk_bf16_f32 v247, v155, v159
    buffer_store_dwordx4 v[244:247], v253, s[16:19], s39 offen sc1
    s_add_u32 s39, s39, 4194304
    v_mfma_f32_16x16x32_bf16 v[128:131], v[236:239], v[64:67], 0
    v_mfma_f32_16x16x32_bf16 v[132:135], v[236:239], v[68:71], 0
    v_mfma_f32_16x16x32_bf16 v[136:139], v[236:239], v[72:75], 0
    v_mfma_f32_16x16x32_bf16 v[140:143], v[236:239], v[76:79], 0
    v_mfma_f32_16x16x32_bf16 v[144:147], v[236:239], v[80:83], 0
    v_mfma_f32_16x16x32_bf16 v[148:151], v[236:239], v[84:87], 0
    v_mfma_f32_16x16x32_bf16 v[152:155], v[236:239], v[88:91], 0
    v_mfma_f32_16x16x32_bf16 v[156:159], v[236:239], v[92:95], 0
    s_nop 7
    v_cvt_pk_bf16_f32 v240, v128, v132
    v_cvt_pk_bf16_f32 v241, v136, v140
    v_cvt_pk_bf16_f32 v242, v144, v148
    v_cvt_pk_bf16_f32 v243, v152, v156
    buffer_store_dwordx4 v[240:243], v253, s[16:19], s39 offen sc1
    s_add_u32 s39, s39, 4194304
    v_cvt_pk_bf16_f32 v244, v129, v133
    v_cvt_pk_bf16_f32 v245, v137, v141
    v_cvt_pk_bf16_f32 v246, v145, v149
    v_cvt_pk_bf16_f32 v247, v153, v157
    buffer_store_dwordx4 v[244:247], v253, s[16:19], s39 offen sc1
    s_add_u32 s39, s39, 4194304
    v_cvt_pk_bf16_f32 v240, v130, v134
    v_cvt_pk_bf16_f32 v241, v138, v142
    v_cvt_pk_bf16_f32 v242, v146, v150
    v_cvt_pk_bf16_f32 v243, v154, v158
    buffer_store_dwordx4 v[240:243], v253, s[16:19], s39 offen sc1
    s_add_u32 s39, s39, 4194304
    v_cvt_pk_bf16_f32 v244, v131, v135
    v_cvt_pk_bf16_f32 v245, v139, v143
    v_cvt_pk_bf16_f32 v246, v147, v151
    v_cvt_pk_bf16_f32 v247, v155, v159
    buffer_store_dwordx4 v[244:247], v253, s[16:19], s39 offen sc1
    s_mov_b32 s41, s40
    s_add_u32 s40, s40, 1
    s_cmp_eq_u32 s41, 3
    s_cbranch_scc0 K12_ES15
    s_waitcnt vmcnt(0)
    s_mov_b32 s34, -1
    s_cmp_ge_u32 s41, 8
    s_cbranch_scc1 K12_SG16
    s_lshl_b32 s36, s41, 2
    s_add_u32 s37, s36, 155680
    s_mov_b64 exec, 1
    v_mov_b32 v255, s37
    v_mov_b32 v240, 1
    ds_add_rtn_u32 v240, v255, v240
    s_waitcnt lgkmcnt(0)
    v_readfirstlane_b32 s37, v240
    s_nop 3
    s_cmp_eq_u32 s37, 3
    s_cbranch_scc0 K12_SH16
    s_lshl_b32 s36, s36, 8
    v_mov_b32 v255, 1
    v_mov_b32 v240, s36
    buffer_atomic_add v255, v240, s[60:63], 0 offen sc0 sc1
    s_mov_b32 s34, s41
K12_SH16:
    s_mov_b64 exec, -1
K12_SG16:
    s_waitcnt vmcnt(0)
    s_cmp_ge_u32 s34, 8
    s_cbranch_scc1 K12_PB17
    v_readfirstlane_b32 s37, v255
    s_nop 3
    s_cmp_eq_u32 s37, 255
    s_cbranch_scc0 K12_PB17
    s_lshl_b32 s36, s34, 4
    s_add_u32 s36, s36, 16384
    s_mov_b64 exec, 1
    v_mov_b32 v255, 1
    v_mov_b32 v240, s36
    buffer_store_dword v255, v240, s[60:63], 0 offen sc1
    s_mov_b64 exec, -1
K12_PB17:
    s_mov_b32 s34, -1
    s_mov_b32 s41, -1
K12_ES15:
    s_waitcnt vmcnt(16)
    s_cmp_ge_u32 s34, 8
    s_cbranch_scc1 K12_PB18
    v_readfirstlane_b32 s37, v255
    s_nop 3
    s_cmp_eq_u32 s37, 255
    s_cbranch_scc0 K12_PB18
    s_lshl_b32 s36, s34, 4
    s_add_u32 s36, s36, 16384
    s_mov_b64 exec, 1
    v_mov_b32 v255, 1
    v_mov_b32 v240, s36
    buffer_store_dword v255, v240, s[60:63], 0 offen sc1
    s_mov_b64 exec, -1
K12_PB18:
    s_cmp_lt_u32 s40, 8
    s_cbranch_scc1 K12_XW
K12_PFIN:
    s_waitcnt vmcnt(0)
    s_mov_b32 s34, -1
    s_cmp_ge_u32 s41, 8
    s_cbranch_scc1 K12_SG19
    s_lshl_b32 s36, s41, 2
    s_add_u32 s37, s36, 155680
    s_mov_b64 exec, 1
    v_mov_b32 v255, s37
    v_mov_b32 v240, 1
    ds_add_rtn_u32 v240, v255, v240
    s_waitcnt lgkmcnt(0)
    v_readfirstlane_b32 s37, v240
    s_nop 3
    s_cmp_eq_u32 s37, 3
    s_cbranch_scc0 K12_SH19
    s_lshl_b32 s36, s36, 8
    v_mov_b32 v255, 1
    v_mov_b32 v240, s36
    buffer_atomic_add v255, v240, s[60:63], 0 offen sc0 sc1
    s_mov_b32 s34, s41
K12_SH19:
    s_mov_b64 exec, -1
K12_SG19:
    s_waitcnt vmcnt(0)
    s_cmp_ge_u32 s34, 8
    s_cbranch_scc1 K12_PB20
    v_readfirstlane_b32 s37, v255
    s_nop 3
    s_cmp_eq_u32 s37, 255
    s_cbranch_scc0 K12_PB20
    s_lshl_b32 s36, s34, 4
    s_add_u32 s36, s36, 16384
    s_mov_b64 exec, 1
    v_mov_b32 v255, 1
    v_mov_b32 v240, s36
    buffer_store_dword v255, v240, s[60:63], 0 offen sc1
    s_mov_b64 exec, -1
K12_PB20:
    s_endpgm
K12_CONS:
    s_and_b32 s6, s2, 7
    s_lshl_b32 s6, s6, 2
    s_lshr_b32 s7, s2, 6
    s_add_u32 s6, s6, s7
    s_mov_b32 s51, s6
    s_mov_b32 s27, s6
    s_lshr_b32 s7, s2, 3
    s_and_b32 s7, s7, 7
    s_lshr_b32 s20, s7, 2
    s_and_b32 s21, s7, 3
    s_lshl_b32 s22, s6, 1
    s_add_u32 s22, s22, s20
    s_lshl_b32 s23, s6, 2
    s_add_u32 s23, s23, s21
    s_mul_i32 s24, s22, 684032
    s_mul_i32 s25, s23, 524288
    s_add_u32 s25, s25, 50331648
    s_mul_i32 s26, s22, 342016
    s_add_u32 s26, s26, 118489088
    s_add_u32 s8, s58, s24
    s_addc_u32 s9, s59, 0
    s_and_b32 s9, s9, 0xffff
    s_mov_b32 s10, 684032
    s_mov_b32 s11, 0x00020000
    s_add_u32 s12, s58, s25
    s_addc_u32 s13, s59, 0
    s_and_b32 s13, s13, 0xffff
    s_mov_b32 s14, 524288
    s_mov_b32 s15, 0x00020000
    s_add_u32 s16, s58, s26
    s_addc_u32 s17, s59, 0
    s_and_b32 s17, s17, 0xffff
    s_mov_b32 s18, 342016
    s_mov_b32 s19, 0x00020000
    s_add_u32 s4, s58, 153108480
    s_addc_u32 s5, s59, 0
    s_and_b32 s5, s5, 0xffff
    s_cmp_eq_u32 s3, 0
    s_cselect_b32 s6, 128, 0
    s_mov_b32 s7, 0x00020000
    s_mov_b32 s46, 155712
    s_cselect_b32 s46, s46, 155776
    s_mov_b32 s47, 155712
    s_cselect_b32 s47, s47, 155744
    s_cselect_b32 s45, 4, 0
    s_mov_b32 s50, s45
    v_and_b32 v8, 15, v2
    v_lshrrev_b32 v9, 4, v2
    v_lshlrev_b32 v1, 4, v2
    s_mul_i32 s30, s3, 5120
    s_mov_b32 s36, s30
    s_lshl_b32 s31, s3, 12
    s_add_u32 s37, s31, 22528
    s_lshr_b32 s28, s3, 1
    s_and_b32 s29, s3, 1
    s_lshl_b32 s33, s29, 9
    s_add_u32 s33, s33, 20480
    s_mul_i32 s38, s28, 896
    s_add_u32 s38, s38, s33
    s_lshl_b32 s34, s51, 1
    s_add_u32 s34, s34, s28
    s_mul_i32 s34, s34, 684032
    s_add_u32 s64, s58, s34
    s_addc_u32 s65, s59, 0
    s_and_b32 s65, s65, 0xffff
    s_mov_b32 s66, 684032
    s_mov_b32 s67, 0x00020000
    s_mov_b32 s44, 0xffffff
    s_cmp_eq_u32 s29, 0
    s_cselect_b32 s44, -1, s44
    s_mov_b32 s45, 0
    v_lshrrev_b32 v10, 1, v8
    v_xor_b32 v10, v10, v9
    v_lshlrev_b32 v10, 4, v10
    v_lshl_add_u32 v2, v8, 7, v10
    v_xor_b32 v3, 64, v2
    v_lshrrev_b32 v10, 2, v8
    v_lshl_add_u32 v11, v9, 3, v10
    v_lshlrev_b32 v11, 9, v11
    v_and_b32 v12, 1, v9
    v_lshl_or_b32 v10, v12, 2, v10
    s_lshl_b32 s28, s3, 1
    v_xor_b32 v10, s28, v10
    v_lshl_add_u32 v11, v10, 5, v11
    v_and_b32 v10, 3, v8
    v_lshl_add_u32 v11, v10, 3, v11
    v_add_u32 v4, 22528, v11
    s_lshl_b32 s28, s20, 5
    v_xor_b32 v4, s28, v4
    v_and_b32 v10, 3, v8
    v_lshlrev_b32 v10, 2, v10
    v_add_u32 v5, 155648, v10
    s_lshl_b32 s28, s3, 2
    s_add_u32 s28, s28, 155648
    v_mov_b32 v7, s28
    s_mov_b32 s35, 0x80008000
    s_mov_b32 s62, 0
    s_mov_b32 s63, 0
    s_mov_b32 s39, 0
    s_add_u32 m0, s39, s36
    s_nop 0
    buffer_load_dwordx4 v1, s[8:11], s30 offen sc1 lds
    buffer_load_dwordx4 v1, s[8:11], s30 offen offset:1024 sc1 lds
    buffer_load_dwordx4 v1, s[8:11], s30 offen offset:2048 sc1 lds
    buffer_load_dwordx4 v1, s[8:11], s30 offen offset:3072 sc1 lds
    s_add_u32 m0, m0, 4096
    s_add_u32 s34, s30, 4096
    buffer_load_dwordx4 v1, s[8:11], s34 offen sc1 lds
    s_add_u32 m0, s39, s37
    s_add_u32 s30, s30, 21376
    buffer_load_dwordx4 v1, s[12:15], s31 offen sc1 lds
    buffer_load_dwordx4 v1, s[12:15], s31 offen offset:1024 sc1 lds
    buffer_load_dwordx4 v1, s[12:15], s31 offen offset:2048 sc1 lds
    buffer_load_dwordx4 v1, s[12:15], s31 offen offset:3072 sc1 lds
    s_add_u32 m0, s39, s38
    s_mov_b64 exec, s[44:45]
    buffer_load_dwordx4 v1, s[64:67], s33 offen sc1 lds
    s_mov_b64 exec, -1
    s_add_u32 s31, s31, 16384
    s_add_u32 s33, s33, 21376
    s_add_u32 s39, s39, 38912
    s_add_u32 m0, s39, s36
    s_nop 0
    buffer_load_dwordx4 v1, s[8:11], s30 offen sc1 lds
    buffer_load_dwordx4 v1, s[8:11], s30 offen offset:1024 sc1 lds
    buffer_load_dwordx4 v1, s[8:11], s30 offen offset:2048 sc1 lds
    buffer_load_dwordx4 v1, s[8:11], s30 offen offset:3072 sc1 lds
    s_add_u32 m0, m0, 4096
    s_add_u32 s34, s30, 4096
    buffer_load_dwordx4 v1, s[8:11], s34 offen sc1 lds
    s_add_u32 m0, s39, s37
    s_add_u32 s30, s30, 21376
    buffer_load_dwordx4 v1, s[12:15], s31 offen sc1 lds
    buffer_load_dwordx4 v1, s[12:15], s31 offen offset:1024 sc1 lds
    buffer_load_dwordx4 v1, s[12:15], s31 offen offset:2048 sc1 lds
    buffer_load_dwordx4 v1, s[12:15], s31 offen offset:3072 sc1 lds
    s_add_u32 m0, s39, s38
    s_mov_b64 exec, s[44:45]
    buffer_load_dwordx4 v1, s[64:67], s33 offen sc1 lds
    s_mov_b64 exec, -1
    s_add_u32 s31, s31, 16384
    s_add_u32 s33, s33, 21376
    s_add_u32 s39, s39, 38912
    s_add_u32 m0, s39, s36
    s_nop 0
    buffer_load_dwordx4 v1, s[8:11], s30 offen sc1 lds
    buffer_load_dwordx4 v1, s[8:11], s30 offen offset:1024 sc1 lds
    buffer_load_dwordx4 v1, s[8:11], s30 offen offset:2048 sc1 lds
    buffer_load_dwordx4 v1, s[8:11], s30 offen offset:3072 sc1 lds
    s_add_u32 m0, m0, 4096
    s_add_u32 s34, s30, 4096
    buffer_load_dwordx4 v1, s[8:11], s34 offen sc1 lds
    s_add_u32 m0, s39, s37
    s_add_u32 s30, s30, 21376
    buffer_load_dwordx4 v1, s[12:15], s31 offen sc1 lds
    buffer_load_dwordx4 v1, s[12:15], s31 offen offset:1024 sc1 lds
    buffer_load_dwordx4 v1, s[12:15], s31 offen offset:2048 sc1 lds
    buffer_load_dwordx4 v1, s[12:15], s31 offen offset:3072 sc1 lds
    s_add_u32 m0, s39, s38
    s_mov_b64 exec, s[44:45]
    buffer_load_dwordx4 v1, s[64:67], s33 offen sc1 lds
    s_mov_b64 exec, -1
    s_add_u32 s31, s31, 16384
    s_add_u32 s33, s33, 21376
    s_add_u32 s39, s39, 38912
    s_mov_b32 m0, s46
    s_mov_b64 exec, 0xff
    buffer_load_dword v1, s[4:7], 0 offen sc1 lds
    s_mov_b64 exec, -1
    v_lshrrev_b32 v9, 4, v1
    v_and_b32 v8, 15, v9
    v_lshrrev_b32 v9, 4, v9
    v_and_b32 v10, 3, v8
    v_lshlrev_b32 v10, 2, v10
    v_lshrrev_b32 v12, 3, v8
    v_lshl_add_u32 v10, v12, 1, v10
    s_lshl_b32 s28, s3, 4
    s_add_u32 s28, s28, 1
    v_add_u32 v10, s28, v10
    v_bfe_u32 v11, v8, 2, 1
    v_and_b32 v13, 1, v9
    v_lshlrev_b32 v13, 3, v13
    v_mul_u32_u24 v14, 96, v11
    v_mad_u32_u24 v15, v10, v13, v14
    v_mad_u32_u24 v16, v10, 0, v15
    v_mad_u32_u24 v17, v10, 1, v15
    v_mad_u32_u24 v18, v10, 2, v15
    v_mad_u32_u24 v19, v10, 3, v15
    v_mad_u32_u24 v20, v10, 4, v15
    v_mad_u32_u24 v21, v10, 5, v15
    v_mad_u32_u24 v22, v10, 6, v15
    v_mad_u32_u24 v23, v10, 7, v15
    v_and_b32 v16, 127, v16
    v_and_b32 v17, 127, v17
    v_and_b32 v18, 127, v18
    v_and_b32 v19, 127, v19
    v_and_b32 v20, 127, v20
    v_and_b32 v21, 127, v21
    v_and_b32 v22, 127, v22
    v_and_b32 v23, 127, v23
    v_cvt_f32_u32 v16, v16
    v_cvt_f32_u32 v17, v17
    v_cvt_f32_u32 v18, v18
    v_cvt_f32_u32 v19, v19
    v_cvt_f32_u32 v20, v20
    v_cvt_f32_u32 v21, v21
    v_cvt_f32_u32 v22, v22
    v_cvt_f32_u32 v23, v23
    v_mul_f32 v16, 0x3c000000, v16
    v_mul_f32 v17, 0x3c000000, v17
    v_mul_f32 v18, 0x3c000000, v18
    v_mul_f32 v19, 0x3c000000, v19
    v_mul_f32 v20, 0x3c000000, v20
    v_mul_f32 v21, 0x3c000000, v21
    v_mul_f32 v22, 0x3c000000, v22
    v_mul_f32 v23, 0x3c000000, v23
    v_cos_f32 v16, v16
    v_cos_f32 v17, v17
    v_cos_f32 v18, v18
    v_cos_f32 v19, v19
    v_cos_f32 v20, v20
    v_cos_f32 v21, v21
    v_cos_f32 v22, v22
    v_cos_f32 v23, v23
    s_nop 0
    v_cvt_pk_bf16_f32 v24, v16, v17
    v_cvt_pk_bf16_f32 v25, v18, v19
    v_cvt_pk_bf16_f32 v26, v20, v21
    v_cvt_pk_bf16_f32 v27, v22, v23
    v_lshlrev_b32 v32, 16, v24
    v_and_b32 v33, 0xffff0000, v24
    v_sub_f32 v16, v16, v32
    v_sub_f32 v17, v17, v33
    v_lshlrev_b32 v32, 16, v25
    v_and_b32 v33, 0xffff0000, v25
    v_sub_f32 v18, v18, v32
    v_sub_f32 v19, v19, v33
    v_lshlrev_b32 v32, 16, v26
    v_and_b32 v33, 0xffff0000, v26
    v_sub_f32 v20, v20, v32
    v_sub_f32 v21, v21, v33
    v_lshlrev_b32 v32, 16, v27
    v_and_b32 v33, 0xffff0000, v27
    v_sub_f32 v22, v22, v32
    v_sub_f32 v23, v23, v33
    v_cvt_pk_bf16_f32 v28, v16, v17
    v_cvt_pk_bf16_f32 v29, v18, v19
    v_cvt_pk_bf16_f32 v30, v20, v21
    v_cvt_pk_bf16_f32 v31, v22, v23
    v_cmp_lt_u32 vcc, 1, v9
    s_lshl_b32 s28, s3, 10
    s_add_u32 s28, s28, 133120
    v_add_u32 v14, s28, v1
    v_cndmask_b32 v24, v24, v28, vcc
    v_cndmask_b32 v25, v25, v29, vcc
    v_cndmask_b32 v26, v26, v30, vcc
    v_cndmask_b32 v27, v27, v31, vcc
    ds_write_b128 v14, v[24:27]
    v_mov_b32 v12, 0
    v_mov_b32 v13, 0
    v_mov_b32 v14, 0
    v_mov_b32 v15, 0
    s_mul_i32 s28, s3, 38912
    s_add_u32 s28, s28, 22272
    v_add_u32 v16, s28, v1
    s_mov_b64 exec, 0xffff
    ds_write_b128 v16, v[12:15]
    s_mov_b64 exec, -1
    s_lshl_b32 s28, s3, 2
    s_add_u32 s28, s28, 155648
    v_mov_b32 v16, s28
    ds_write_b32 v16, v12
    s_lshl_b32 s28, s3, 3
    s_add_u32 s28, s28, 155680
    v_mov_b32 v16, s28
    ds_write_b64 v16, v[12:13]
    s_lshl_b32 s28, s3, 3
    s_add_u32 s28, s28, 155712
    v_mov_b32 v16, s28
    ds_write_b64 v16, v[12:13]
    v_mov_b32 v16, 155664
    ds_write_b32 v16, v12
    v_mov_b32 v16, 155744
    v_mov_b32 v17, 1
    ds_write_b32 v16, v17
    s_waitcnt lgkmcnt(0)
    s_barrier
    v_mov_b32 v80, 0
    v_mov_b32 v81, 0
    v_mov_b32 v82, 0
    v_mov_b32 v83, 0
    v_mov_b32 v84, 0
    v_mov_b32 v85, 0
    v_mov_b32 v86, 0
    v_mov_b32 v87, 0
    v_mov_b32 v88, 0
    v_mov_b32 v89, 0
    v_mov_b32 v90, 0
    v_mov_b32 v91, 0
    v_mov_b32 v92, 0
    v_mov_b32 v93, 0
    v_mov_b32 v94, 0
    v_mov_b32 v95, 0
    v_mov_b32 v96, 0
    v_mov_b32 v97, 0
    v_mov_b32 v98, 0
    v_mov_b32 v99, 0
    v_mov_b32 v100, 0
    v_mov_b32 v101, 0
    v_mov_b32 v102, 0
    v_mov_b32 v103, 0
    v_mov_b32 v104, 0
    v_mov_b32 v105, 0
    v_mov_b32 v106, 0
    v_mov_b32 v107, 0
    v_mov_b32 v108, 0
    v_mov_b32 v109, 0
    v_mov_b32 v110, 0
    v_mov_b32 v111, 0
    v_mov_b32 v112, 0
    v_mov_b32 v113, 0
    v_mov_b32 v114, 0
    v_mov_b32 v115, 0
    v_mov_b32 v116, 0
    v_mov_b32 v117, 0
    v_mov_b32 v118, 0
    v_mov_b32 v119, 0
    v_mov_b32 v120, 0
    v_mov_b32 v121, 0
    v_mov_b32 v122, 0
    v_mov_b32 v123, 0
    v_mov_b32 v124, 0
    v_mov_b32 v125, 0
    v_mov_b32 v126, 0
    v_mov_b32 v127, 0
    v_mov_b32 v128, 0
    v_mov_b32 v129, 0
    v_mov_b32 v130, 0
    v_mov_b32 v131, 0
    v_mov_b32 v132, 0
    v_mov_b32 v133, 0
    v_mov_b32 v134, 0
    v_mov_b32 v135, 0
    v_mov_b32 v136, 0
    v_mov_b32 v137, 0
    v_mov_b32 v138, 0
    v_mov_b32 v139, 0
    v_mov_b32 v140, 0
    v_mov_b32 v141, 0
    v_mov_b32 v142, 0
    v_mov_b32 v143, 0
    v_mov_b32 v144, 0
    v_mov_b32 v145, 0
    v_mov_b32 v146, 0
    v_mov_b32 v147, 0
    v_mov_b32 v148, 0
    v_mov_b32 v149, 0
    v_mov_b32 v150, 0
    v_mov_b32 v151, 0
    v_mov_b32 v152, 0
    v_mov_b32 v153, 0
    v_mov_b32 v154, 0
    v_mov_b32 v155, 0
    v_mov_b32 v156, 0
    v_mov_b32 v157, 0
    v_mov_b32 v158, 0
    v_mov_b32 v159, 0
    v_mov_b32 v160, 0
    v_mov_b32 v161, 0
    v_mov_b32 v162, 0
    v_mov_b32 v163, 0
    v_mov_b32 v164, 0
    v_mov_b32 v165, 0
    v_mov_b32 v166, 0
    v_mov_b32 v167, 0
    v_mov_b32 v168, 0
    v_mov_b32 v169, 0
    v_mov_b32 v170, 0
    v_mov_b32 v171, 0
    v_mov_b32 v172, 0
    v_mov_b32 v173, 0
    v_mov_b32 v174, 0
    v_mov_b32 v175, 0
    v_mov_b32 v176, 0
    v_mov_b32 v177, 0
    v_mov_b32 v178, 0
    v_mov_b32 v179, 0
    v_mov_b32 v180, 0
    v_mov_b32 v181, 0
    v_mov_b32 v182, 0
    v_mov_b32 v183, 0
    v_mov_b32 v184, 0
    v_mov_b32 v185, 0
    v_mov_b32 v186, 0
    v_mov_b32 v187, 0
    v_mov_b32 v188, 0
    v_mov_b32 v189, 0
    v_mov_b32 v190, 0
    v_mov_b32 v191, 0
    v_mov_b32 v192, 0
    v_mov_b32 v193, 0
    v_mov_b32 v194, 0
    v_mov_b32 v195, 0
    v_mov_b32 v196, 0
    v_mov_b32 v197, 0
    v_mov_b32 v198, 0
    v_mov_b32 v199, 0
    v_mov_b32 v200, 0
    v_mov_b32 v201, 0
    v_mov_b32 v202, 0
    v_mov_b32 v203, 0
    v_mov_b32 v204, 0
    v_mov_b32 v205, 0
    v_mov_b32 v206, 0
    v_mov_b32 v207, 0
    v_mov_b32 v208, 0
    v_mov_b32 v209, 0
    v_mov_b32 v210, 0
    v_mov_b32 v211, 0
    v_mov_b32 v212, 0
    v_mov_b32 v213, 0
    v_mov_b32 v214, 0
    v_mov_b32 v215, 0
    v_mov_b32 v216, 0
    v_mov_b32 v217, 0
    v_mov_b32 v218, 0
    v_mov_b32 v219, 0
    v_mov_b32 v220, 0
    v_mov_b32 v221, 0
    v_mov_b32 v222, 0
    v_mov_b32 v223, 0
    v_mov_b32 v224, 0
    v_mov_b32 v225, 0
    v_mov_b32 v226, 0
    v_mov_b32 v227, 0
    v_mov_b32 v228, 0
    v_mov_b32 v229, 0
    v_mov_b32 v230, 0
    v_mov_b32 v231, 0
    v_mov_b32 v232, 0
    v_mov_b32 v233, 0
    v_mov_b32 v234, 0
    v_mov_b32 v235, 0
    v_mov_b32 v236, 0
    v_mov_b32 v237, 0
    v_mov_b32 v238, 0
    v_mov_b32 v239, 0
    v_mov_b32 v240, 0
    v_mov_b32 v241, 0
    v_mov_b32 v242, 0
    v_mov_b32 v243, 0
    v_mov_b32 v244, 0
    v_mov_b32 v245, 0
    v_mov_b32 v246, 0
    v_mov_b32 v247, 0
    v_mov_b32 v248, 0
    v_mov_b32 v249, 0
    v_mov_b32 v250, 0
    v_mov_b32 v251, 0
    v_mov_b32 v252, 0
    v_mov_b32 v253, 0
    v_mov_b32 v254, 0
    v_mov_b32 v255, 0
    s_barrier
    s_mov_b32 s40, 2
    v_mov_b32 v0, s40
    s_waitcnt vmcnt(21)
    ds_write_b32 v7, v0
    s_branch K12_S0
K12_Q0:
    ds_read_b64_tr_b16 v[40:41], v4 offset:0
    ds_read_b64_tr_b16 v[42:43], v4 offset:2048
    ds_read_b64_tr_b16 v[44:45], v4 offset:256
    ds_read_b64_tr_b16 v[46:47], v4 offset:2304
    v_xor_b32 v4, 32, v4
    ds_read_b64_tr_b16 v[48:49], v4 offset:0
    ds_read_b64_tr_b16 v[50:51], v4 offset:2048
    ds_read_b64_tr_b16 v[52:53], v4 offset:256
    ds_read_b64_tr_b16 v[54:55], v4 offset:2304
    v_xor_b32 v4, 32, v4
    ds_read_b128 v[8:11], v2 offset:0
    ds_read_b128 v[12:15], v3 offset:0
    ds_read_b128 v[16:19], v2 offset:2048
    ds_read_b128 v[20:23], v3 offset:2048
    ds_read_b128 v[32:35], v2 offset:6144
    ds_read_b128 v[36:39], v3 offset:6144
    ds_read_b32 v68, v5
    s_waitcnt lgkmcnt(7)
    v_xor_b32 v72, s35, v44
    v_xor_b32 v73, s35, v45
    v_xor_b32 v74, s35, v46
    v_xor_b32 v75, s35, v47
    v_xor_b32 v76, s35, v52
    v_xor_b32 v77, s35, v53
    v_xor_b32 v78, s35, v54
    v_xor_b32 v79, s35, v55
    s_mov_b32 s41, 0
    s_mov_b32 s42, 38912
    s_mov_b32 s39, 0
    s_mov_b32 s29, 116736
K12_LOOP:
    s_waitcnt lgkmcnt(2)
    v_mfma_f32_16x16x32_bf16 v[80:83], v[8:11], v[40:43], v[80:83]
    ds_read_b128 v[24:27], v2 offset:4096
    v_xor_b32 v72, s35, v44
    v_xor_b32 v73, s35, v45
    v_mfma_f32_16x16x32_bf16 v[84:87], v[8:11], v[44:47], v[84:87]
    ds_read_b128 v[28:31], v3 offset:4096
    v_xor_b32 v74, s35, v46
    v_xor_b32 v75, s35, v47
    v_mfma_f32_16x16x32_bf16 v[88:91], v[8:11], v[48:51], v[88:91]
    s_waitcnt lgkmcnt(2)
    v_cmp_gt_u32 vcc, s40, v68
    s_add_u32 s49, s39, 2
    s_lshr_b32 s49, s49, 1
    v_xor_b32 v76, s35, v52
    v_xor_b32 v77, s35, v53
    v_mfma_f32_16x16x32_bf16 v[92:95], v[8:11], v[52:55], v[92:95]
    s_cbranch_vccnz K12_S1
K12_Q1:
    s_mul_i32 s48, s49, s50
    s_add_u32 s48, s48, s47
    v_xor_b32 v78, s35, v54
    v_xor_b32 v79, s35, v55
    v_mfma_f32_16x16x32_bf16 v[80:83], v[12:15], v[72:75], v[80:83]
    s_add_u32 m0, s29, s36
    s_nop 0
    buffer_load_dwordx4 v1, s[8:11], s30 offen sc1 lds
    v_mfma_f32_16x16x32_bf16 v[84:87], v[12:15], v[40:43], v[84:87]
    s_cmp_lt_u32 s49, 8
    s_cselect_b32 s48, s48, 155744
    v_mfma_f32_16x16x32_bf16 v[88:91], v[12:15], v[76:79], v[88:91]
    s_cmp_ge_u32 s49, 3
    s_cselect_b32 s48, s48, 155744
    v_mfma_f32_16x16x32_bf16 v[92:95], v[12:15], v[48:51], v[92:95]
    v_mfma_f32_16x16x32_bf16 v[96:99], v[16:19], v[40:43], v[96:99]
    ds_read_b128 v[8:11], v2 offset:8192
    v_mfma_f32_16x16x32_bf16 v[100:103], v[16:19], v[44:47], v[100:103]
    ds_read_b128 v[12:15], v3 offset:8192
    v_mfma_f32_16x16x32_bf16 v[104:107], v[16:19], v[48:51], v[104:107]
    buffer_load_dwordx4 v1, s[8:11], s30 offen offset:1024 sc1 lds
    v_mfma_f32_16x16x32_bf16 v[108:111], v[16:19], v[52:55], v[108:111]
    v_mfma_f32_16x16x32_bf16 v[96:99], v[20:23], v[72:75], v[96:99]
    v_mfma_f32_16x16x32_bf16 v[100:103], v[20:23], v[40:43], v[100:103]
    v_mfma_f32_16x16x32_bf16 v[104:107], v[20:23], v[76:79], v[104:107]
    buffer_load_dwordx4 v1, s[8:11], s30 offen offset:2048 sc1 lds
    v_mfma_f32_16x16x32_bf16 v[108:111], v[20:23], v[48:51], v[108:111]
    s_waitcnt lgkmcnt(2)
    v_mfma_f32_16x16x32_bf16 v[112:115], v[24:27], v[40:43], v[112:115]
    ds_read_b128 v[16:19], v2 offset:10240
    v_mfma_f32_16x16x32_bf16 v[116:119], v[24:27], v[44:47], v[116:119]
    ds_read_b128 v[20:23], v3 offset:10240
    v_mfma_f32_16x16x32_bf16 v[120:123], v[24:27], v[48:51], v[120:123]
    v_mfma_f32_16x16x32_bf16 v[124:127], v[24:27], v[52:55], v[124:127]
    v_mfma_f32_16x16x32_bf16 v[112:115], v[28:31], v[72:75], v[112:115]
    buffer_load_dwordx4 v1, s[8:11], s30 offen offset:3072 sc1 lds
    v_mfma_f32_16x16x32_bf16 v[116:119], v[28:31], v[40:43], v[116:119]
    v_mfma_f32_16x16x32_bf16 v[120:123], v[28:31], v[76:79], v[120:123]
    v_mfma_f32_16x16x32_bf16 v[124:127], v[28:31], v[48:51], v[124:127]
    v_mfma_f32_16x16x32_bf16 v[128:131], v[32:35], v[40:43], v[128:131]
    ds_read_b128 v[24:27], v2 offset:12288
    v_mfma_f32_16x16x32_bf16 v[132:135], v[32:35], v[44:47], v[132:135]
    ds_read_b128 v[28:31], v3 offset:12288
    v_mfma_f32_16x16x32_bf16 v[136:139], v[32:35], v[48:51], v[136:139]
    s_add_u32 m0, m0, 4096
    s_add_u32 s34, s30, 4096
    buffer_load_dwordx4 v1, s[8:11], s34 offen sc1 lds
    v_mfma_f32_16x16x32_bf16 v[140:143], v[32:35], v[52:55], v[140:143]
    v_mfma_f32_16x16x32_bf16 v[128:131], v[36:39], v[72:75], v[128:131]
    v_mfma_f32_16x16x32_bf16 v[132:135], v[36:39], v[40:43], v[132:135]
    v_mfma_f32_16x16x32_bf16 v[136:139], v[36:39], v[76:79], v[136:139]
    s_add_u32 m0, s29, s37
    s_add_u32 s30, s30, 21376
    buffer_load_dwordx4 v1, s[12:15], s31 offen sc1 lds
    v_mfma_f32_16x16x32_bf16 v[140:143], v[36:39], v[48:51], v[140:143]
    s_waitcnt lgkmcnt(4)
    v_mfma_f32_16x16x32_bf16 v[144:147], v[8:11], v[40:43], v[144:147]
    ds_read_b128 v[32:35], v2 offset:14336
    v_mfma_f32_16x16x32_bf16 v[148:151], v[8:11], v[44:47], v[148:151]
    ds_read_b128 v[36:39], v3 offset:14336
    v_mfma_f32_16x16x32_bf16 v[152:155], v[8:11], v[48:51], v[152:155]
    v_mfma_f32_16x16x32_bf16 v[156:159], v[8:11], v[52:55], v[156:159]
    v_mfma_f32_16x16x32_bf16 v[144:147], v[12:15], v[72:75], v[144:147]
    buffer_load_dwordx4 v1, s[12:15], s31 offen offset:1024 sc1 lds
    v_mfma_f32_16x16x32_bf16 v[148:151], v[12:15], v[40:43], v[148:151]
    v_mfma_f32_16x16x32_bf16 v[152:155], v[12:15], v[76:79], v[152:155]
    v_mfma_f32_16x16x32_bf16 v[156:159], v[12:15], v[48:51], v[156:159]
    s_waitcnt lgkmcnt(4)
    v_mfma_f32_16x16x32_bf16 v[160:163], v[16:19], v[40:43], v[160:163]
    ds_read_b128 v[8:11], v2 offset:16384
    v_mfma_f32_16x16x32_bf16 v[164:167], v[16:19], v[44:47], v[164:167]
    ds_read_b128 v[12:15], v3 offset:16384
    v_mfma_f32_16x16x32_bf16 v[168:171], v[16:19], v[48:51], v[168:171]
    buffer_load_dwordx4 v1, s[12:15], s31 offen offset:2048 sc1 lds
    v_mfma_f32_16x16x32_bf16 v[172:175], v[16:19], v[52:55], v[172:175]
    s_add_u32 s40, s40, 1
    s_mov_b32 s51, s40
    v_mov_b32 v0, s40
    v_mfma_f32_16x16x32_bf16 v[160:163], v[20:23], v[72:75], v[160:163]
    s_waitcnt vmcnt(19)
    ds_write_b32 v7, v0
    v_mfma_f32_16x16x32_bf16 v[164:167], v[20:23], v[40:43], v[164:167]
    v_mfma_f32_16x16x32_bf16 v[168:171], v[20:23], v[76:79], v[168:171]
    buffer_load_dwordx4 v1, s[12:15], s31 offen offset:3072 sc1 lds
    v_mfma_f32_16x16x32_bf16 v[172:175], v[20:23], v[48:51], v[172:175]
    s_waitcnt lgkmcnt(5)
    v_mfma_f32_16x16x32_bf16 v[176:179], v[24:27], v[40:43], v[176:179]
    ds_read_b128 v[16:19], v2 offset:18432
    v_mfma_f32_16x16x32_bf16 v[180:183], v[24:27], v[44:47], v[180:183]
    ds_read_b128 v[20:23], v3 offset:18432
    v_mov_b32 v0, s48
    v_mfma_f32_16x16x32_bf16 v[184:187], v[24:27], v[48:51], v[184:187]
    ds_read_b32 v0, v0
    v_mfma_f32_16x16x32_bf16 v[188:191], v[24:27], v[52:55], v[188:191]
    v_mfma_f32_16x16x32_bf16 v[176:179], v[28:31], v[72:75], v[176:179]
    s_add_u32 m0, s29, s38
    s_mov_b64 exec, s[44:45]
    buffer_load_dwordx4 v1, s[64:67], s33 offen sc1 lds
    s_mov_b64 exec, -1
    s_add_u32 s31, s31, 16384
    s_add_u32 s33, s33, 21376
    v_mfma_f32_16x16x32_bf16 v[180:183], v[28:31], v[40:43], v[180:183]
    v_mfma_f32_16x16x32_bf16 v[184:187], v[28:31], v[76:79], v[184:187]
    v_mfma_f32_16x16x32_bf16 v[188:191], v[28:31], v[48:51], v[188:191]
    s_waitcnt lgkmcnt(0)
    v_cmp_eq_u32 vcc, 0, v0
    v_mfma_f32_16x16x32_bf16 v[192:195], v[32:35], v[40:43], v[192:195]
    ds_read_b128 v[24:27], v2 offset:20480
    v_mfma_f32_16x16x32_bf16 v[196:199], v[32:35], v[44:47], v[196:199]
    ds_read_b128 v[28:31], v3 offset:20480
    s_cbranch_vccnz K12_F2
K12_G2:
    v_mfma_f32_16x16x32_bf16 v[200:203], v[32:35], v[48:51], v[200:203]
    s_sub_u32 s43, s42, s41
    s_add_u32 s40, s40, 1
    v_add_u32 v2, s43, v2
    v_mfma_f32_16x16x32_bf16 v[204:207], v[32:35], v[52:55], v[204:207]
    v_add_u32 v3, s43, v3
    v_add_u32 v4, s43, v4
    v_mov_b32 v0, s40
    v_mfma_f32_16x16x32_bf16 v[192:195], v[36:39], v[72:75], v[192:195]
    ds_write_b32 v7, v0
    v_mfma_f32_16x16x32_bf16 v[196:199], v[36:39], v[40:43], v[196:199]
    v_mfma_f32_16x16x32_bf16 v[200:203], v[36:39], v[76:79], v[200:203]
    v_mfma_f32_16x16x32_bf16 v[204:207], v[36:39], v[48:51], v[204:207]
    ds_read_b32 v56, v5
    v_mfma_f32_16x16x32_bf16 v[208:211], v[8:11], v[40:43], v[208:211]
    v_mfma_f32_16x16x32_bf16 v[212:215], v[8:11], v[44:47], v[212:215]
    v_mfma_f32_16x16x32_bf16 v[216:219], v[8:11], v[48:51], v[216:219]
    v_mfma_f32_16x16x32_bf16 v[220:223], v[8:11], v[52:55], v[220:223]
    s_waitcnt lgkmcnt(0)
    v_cmp_gt_u32 vcc, s51, v56
    v_mfma_f32_16x16x32_bf16 v[208:211], v[12:15], v[72:75], v[208:211]
    v_mfma_f32_16x16x32_bf16 v[212:215], v[12:15], v[40:43], v[212:215]
    s_cbranch_vccnz K12_S3
K12_Q3:
    v_mfma_f32_16x16x32_bf16 v[216:219], v[12:15], v[76:79], v[216:219]
    ds_read_b64_tr_b16 v[56:57], v4 offset:0
    v_mfma_f32_16x16x32_bf16 v[220:223], v[12:15], v[48:51], v[220:223]
    ds_read_b64_tr_b16 v[58:59], v4 offset:2048
    v_mfma_f32_16x16x32_bf16 v[224:227], v[16:19], v[40:43], v[224:227]
    ds_read_b64_tr_b16 v[60:61], v4 offset:256
    ds_read_b128 v[8:11], v2 offset:0
    v_mfma_f32_16x16x32_bf16 v[228:231], v[16:19], v[44:47], v[228:231]
    ds_read_b64_tr_b16 v[62:63], v4 offset:2304
    ds_read_b128 v[12:15], v3 offset:0
    v_mfma_f32_16x16x32_bf16 v[232:235], v[16:19], v[48:51], v[232:235]
    v_xor_b32 v4, 32, v4
    ds_read_b128 v[32:35], v2 offset:6144
    v_mfma_f32_16x16x32_bf16 v[236:239], v[16:19], v[52:55], v[236:239]
    ds_read_b64_tr_b16 v[64:65], v4 offset:0
    ds_read_b128 v[36:39], v3 offset:6144
    v_mfma_f32_16x16x32_bf16 v[224:227], v[20:23], v[72:75], v[224:227]
    ds_read_b64_tr_b16 v[66:67], v4 offset:2048
    ds_read_b32 v52, v5
    v_mfma_f32_16x16x32_bf16 v[228:231], v[20:23], v[40:43], v[228:231]
    ds_read_b64_tr_b16 v[68:69], v4 offset:256
    ds_read_b64_tr_b16 v[70:71], v4 offset:2304
    v_xor_b32 v4, 32, v4
    v_mfma_f32_16x16x32_bf16 v[232:235], v[20:23], v[76:79], v[232:235]
    v_mfma_f32_16x16x32_bf16 v[236:239], v[20:23], v[48:51], v[236:239]
    v_mfma_f32_16x16x32_bf16 v[240:243], v[24:27], v[40:43], v[240:243]
    ds_read_b128 v[16:19], v2 offset:2048
    v_mfma_f32_16x16x32_bf16 v[244:247], v[24:27], v[44:47], v[244:247]
    ds_read_b128 v[20:23], v3 offset:2048
    v_mfma_f32_16x16x32_bf16 v[240:243], v[28:31], v[72:75], v[240:243]
    s_mov_b32 s29, s41
    s_mov_b32 s41, s42
    s_add_u32 s42, s42, 38912
    v_mfma_f32_16x16x32_bf16 v[244:247], v[28:31], v[40:43], v[244:247]
    s_cmp_eq_u32 s42, 155648
    s_cselect_b32 s42, 0, s42
    s_waitcnt lgkmcnt(2)
    v_mfma_f32_16x16x32_bf16 v[80:83], v[8:11], v[56:59], v[80:83]
    ds_read_b128 v[24:27], v2 offset:4096
    v_xor_b32 v72, s35, v60
    v_xor_b32 v73, s35, v61
    v_mfma_f32_16x16x32_bf16 v[84:87], v[8:11], v[60:63], v[84:87]
    ds_read_b128 v[28:31], v3 offset:4096
    v_xor_b32 v74, s35, v62
    v_xor_b32 v75, s35, v63
    v_mfma_f32_16x16x32_bf16 v[88:91], v[8:11], v[64:67], v[88:91]
    s_waitcnt lgkmcnt(2)
    v_cmp_gt_u32 vcc, s40, v52
    v_xor_b32 v76, s35, v68
    v_xor_b32 v77, s35, v69
    v_mfma_f32_16x16x32_bf16 v[92:95], v[8:11], v[68:71], v[92:95]
    s_cbranch_vccnz K12_S4
K12_Q4:
    v_xor_b32 v78, s35, v70
    v_xor_b32 v79, s35, v71
    v_mfma_f32_16x16x32_bf16 v[80:83], v[12:15], v[72:75], v[80:83]
    s_add_u32 m0, s29, s36
    s_nop 0
    buffer_load_dwordx4 v1, s[8:11], s30 offen sc1 lds
    v_mfma_f32_16x16x32_bf16 v[84:87], v[12:15], v[56:59], v[84:87]
    v_mfma_f32_16x16x32_bf16 v[88:91], v[12:15], v[76:79], v[88:91]
    v_mfma_f32_16x16x32_bf16 v[92:95], v[12:15], v[64:67], v[92:95]
    v_mfma_f32_16x16x32_bf16 v[96:99], v[16:19], v[56:59], v[96:99]
    ds_read_b128 v[8:11], v2 offset:8192
    v_mfma_f32_16x16x32_bf16 v[100:103], v[16:19], v[60:63], v[100:103]
    ds_read_b128 v[12:15], v3 offset:8192
    v_mfma_f32_16x16x32_bf16 v[104:107], v[16:19], v[64:67], v[104:107]
    buffer_load_dwordx4 v1, s[8:11], s30 offen offset:1024 sc1 lds
    v_mfma_f32_16x16x32_bf16 v[108:111], v[16:19], v[68:71], v[108:111]
    v_mfma_f32_16x16x32_bf16 v[96:99], v[20:23], v[72:75], v[96:99]
    v_mfma_f32_16x16x32_bf16 v[100:103], v[20:23], v[56:59], v[100:103]
    v_mfma_f32_16x16x32_bf16 v[104:107], v[20:23], v[76:79], v[104:107]
    buffer_load_dwordx4 v1, s[8:11], s30 offen offset:2048 sc1 lds
    v_mfma_f32_16x16x32_bf16 v[108:111], v[20:23], v[64:67], v[108:111]
    s_waitcnt lgkmcnt(2)
    v_mfma_f32_16x16x32_bf16 v[112:115], v[24:27], v[56:59], v[112:115]
    ds_read_b128 v[16:19], v2 offset:10240
    v_mfma_f32_16x16x32_bf16 v[116:119], v[24:27], v[60:63], v[116:119]
    ds_read_b128 v[20:23], v3 offset:10240
    v_mfma_f32_16x16x32_bf16 v[120:123], v[24:27], v[64:67], v[120:123]
    v_mfma_f32_16x16x32_bf16 v[124:127], v[24:27], v[68:71], v[124:127]
    v_mfma_f32_16x16x32_bf16 v[112:115], v[28:31], v[72:75], v[112:115]
    buffer_load_dwordx4 v1, s[8:11], s30 offen offset:3072 sc1 lds
    v_mfma_f32_16x16x32_bf16 v[116:119], v[28:31], v[56:59], v[116:119]
    v_mfma_f32_16x16x32_bf16 v[120:123], v[28:31], v[76:79], v[120:123]
    v_mfma_f32_16x16x32_bf16 v[124:127], v[28:31], v[64:67], v[124:127]
    v_mfma_f32_16x16x32_bf16 v[128:131], v[32:35], v[56:59], v[128:131]
    ds_read_b128 v[24:27], v2 offset:12288
    v_mfma_f32_16x16x32_bf16 v[132:135], v[32:35], v[60:63], v[132:135]
    ds_read_b128 v[28:31], v3 offset:12288
    v_mfma_f32_16x16x32_bf16 v[136:139], v[32:35], v[64:67], v[136:139]
    s_add_u32 m0, m0, 4096
    s_add_u32 s34, s30, 4096
    buffer_load_dwordx4 v1, s[8:11], s34 offen sc1 lds
    v_mfma_f32_16x16x32_bf16 v[140:143], v[32:35], v[68:71], v[140:143]
    v_mfma_f32_16x16x32_bf16 v[128:131], v[36:39], v[72:75], v[128:131]
    v_mfma_f32_16x16x32_bf16 v[132:135], v[36:39], v[56:59], v[132:135]
    v_mfma_f32_16x16x32_bf16 v[136:139], v[36:39], v[76:79], v[136:139]
    s_add_u32 m0, s29, s37
    s_add_u32 s30, s30, 21376
    buffer_load_dwordx4 v1, s[12:15], s31 offen sc1 lds
    v_mfma_f32_16x16x32_bf16 v[140:143], v[36:39], v[64:67], v[140:143]
    s_waitcnt lgkmcnt(4)
    v_mfma_f32_16x16x32_bf16 v[144:147], v[8:11], v[56:59], v[144:147]
    ds_read_b128 v[32:35], v2 offset:14336
    v_mfma_f32_16x16x32_bf16 v[148:151], v[8:11], v[60:63], v[148:151]
    ds_read_b128 v[36:39], v3 offset:14336
    v_mfma_f32_16x16x32_bf16 v[152:155], v[8:11], v[64:67], v[152:155]
    v_mfma_f32_16x16x32_bf16 v[156:159], v[8:11], v[68:71], v[156:159]
    v_mfma_f32_16x16x32_bf16 v[144:147], v[12:15], v[72:75], v[144:147]
    buffer_load_dwordx4 v1, s[12:15], s31 offen offset:1024 sc1 lds
    v_mfma_f32_16x16x32_bf16 v[148:151], v[12:15], v[56:59], v[148:151]
    v_mfma_f32_16x16x32_bf16 v[152:155], v[12:15], v[76:79], v[152:155]
    v_mfma_f32_16x16x32_bf16 v[156:159], v[12:15], v[64:67], v[156:159]
    s_waitcnt lgkmcnt(4)
    v_mfma_f32_16x16x32_bf16 v[160:163], v[16:19], v[56:59], v[160:163]
    ds_read_b128 v[8:11], v2 offset:16384
    v_mfma_f32_16x16x32_bf16 v[164:167], v[16:19], v[60:63], v[164:167]
    ds_read_b128 v[12:15], v3 offset:16384
    v_mfma_f32_16x16x32_bf16 v[168:171], v[16:19], v[64:67], v[168:171]
    buffer_load_dwordx4 v1, s[12:15], s31 offen offset:2048 sc1 lds
    v_mfma_f32_16x16x32_bf16 v[172:175], v[16:19], v[68:71], v[172:175]
    s_add_u32 s40, s40, 1
    s_mov_b32 s51, s40
    v_mov_b32 v0, s40
    v_mfma_f32_16x16x32_bf16 v[160:163], v[20:23], v[72:75], v[160:163]
    s_waitcnt vmcnt(19)
    ds_write_b32 v7, v0
    v_mfma_f32_16x16x32_bf16 v[164:167], v[20:23], v[56:59], v[164:167]
    v_mfma_f32_16x16x32_bf16 v[168:171], v[20:23], v[76:79], v[168:171]
    buffer_load_dwordx4 v1, s[12:15], s31 offen offset:3072 sc1 lds
    v_mfma_f32_16x16x32_bf16 v[172:175], v[20:23], v[64:67], v[172:175]
    s_waitcnt lgkmcnt(5)
    v_mfma_f32_16x16x32_bf16 v[176:179], v[24:27], v[56:59], v[176:179]
    ds_read_b128 v[16:19], v2 offset:18432
    v_mfma_f32_16x16x32_bf16 v[180:183], v[24:27], v[60:63], v[180:183]
    ds_read_b128 v[20:23], v3 offset:18432
    v_mfma_f32_16x16x32_bf16 v[184:187], v[24:27], v[64:67], v[184:187]
    v_mfma_f32_16x16x32_bf16 v[188:191], v[24:27], v[68:71], v[188:191]
    v_mfma_f32_16x16x32_bf16 v[176:179], v[28:31], v[72:75], v[176:179]
    s_add_u32 m0, s29, s38
    s_mov_b64 exec, s[44:45]
    buffer_load_dwordx4 v1, s[64:67], s33 offen sc1 lds
    s_mov_b64 exec, -1
    s_add_u32 s31, s31, 16384
    s_add_u32 s33, s33, 21376
    v_mfma_f32_16x16x32_bf16 v[180:183], v[28:31], v[56:59], v[180:183]
    v_mfma_f32_16x16x32_bf16 v[184:187], v[28:31], v[76:79], v[184:187]
    s_mov_b32 m0, s46
    s_mov_b64 exec, 0xff
    buffer_load_dword v1, s[4:7], 0 offen sc1 lds
    s_mov_b64 exec, -1
    v_mfma_f32_16x16x32_bf16 v[188:191], v[28:31], v[64:67], v[188:191]
    s_waitcnt lgkmcnt(5)
    v_mfma_f32_16x16x32_bf16 v[192:195], v[32:35], v[56:59], v[192:195]
    ds_read_b128 v[24:27], v2 offset:20480
    v_mfma_f32_16x16x32_bf16 v[196:199], v[32:35], v[60:63], v[196:199]
    ds_read_b128 v[28:31], v3 offset:20480
    v_mfma_f32_16x16x32_bf16 v[200:203], v[32:35], v[64:67], v[200:203]
    s_sub_u32 s43, s42, s41
    s_add_u32 s40, s40, 1
    v_add_u32 v2, s43, v2
    v_mfma_f32_16x16x32_bf16 v[204:207], v[32:35], v[68:71], v[204:207]
    v_add_u32 v3, s43, v3
    v_add_u32 v4, s43, v4
    v_mov_b32 v0, s40
    v_mfma_f32_16x16x32_bf16 v[192:195], v[36:39], v[72:75], v[192:195]
    ds_write_b32 v7, v0
    v_mfma_f32_16x16x32_bf16 v[196:199], v[36:39], v[56:59], v[196:199]
    v_mfma_f32_16x16x32_bf16 v[200:203], v[36:39], v[76:79], v[200:203]
    v_mfma_f32_16x16x32_bf16 v[204:207], v[36:39], v[64:67], v[204:207]
    ds_read_b32 v40, v5
    s_waitcnt lgkmcnt(7)
    v_mfma_f32_16x16x32_bf16 v[208:211], v[8:11], v[56:59], v[208:211]
    v_mfma_f32_16x16x32_bf16 v[212:215], v[8:11], v[60:63], v[212:215]
    v_mfma_f32_16x16x32_bf16 v[216:219], v[8:11], v[64:67], v[216:219]
    v_mfma_f32_16x16x32_bf16 v[220:223], v[8:11], v[68:71], v[220:223]
    s_waitcnt lgkmcnt(0)
    v_cmp_gt_u32 vcc, s51, v40
    v_mfma_f32_16x16x32_bf16 v[208:211], v[12:15], v[72:75], v[208:211]
    v_mfma_f32_16x16x32_bf16 v[212:215], v[12:15], v[56:59], v[212:215]
    s_cbranch_vccnz K12_S5
K12_Q5:
    v_mfma_f32_16x16x32_bf16 v[216:219], v[12:15], v[76:79], v[216:219]
    ds_read_b64_tr_b16 v[40:41], v4 offset:0
    v_mfma_f32_16x16x32_bf16 v[220:223], v[12:15], v[64:67], v[220:223]
    ds_read_b64_tr_b16 v[42:43], v4 offset:2048
    v_mfma_f32_16x16x32_bf16 v[224:227], v[16:19], v[56:59], v[224:227]
    ds_read_b64_tr_b16 v[44:45], v4 offset:256
    ds_read_b128 v[8:11], v2 offset:0
    v_mfma_f32_16x16x32_bf16 v[228:231], v[16:19], v[60:63], v[228:231]
    ds_read_b64_tr_b16 v[46:47], v4 offset:2304
    ds_read_b128 v[12:15], v3 offset:0
    v_mfma_f32_16x16x32_bf16 v[232:235], v[16:19], v[64:67], v[232:235]
    v_xor_b32 v4, 32, v4
    ds_read_b128 v[32:35], v2 offset:6144
    v_mfma_f32_16x16x32_bf16 v[236:239], v[16:19], v[68:71], v[236:239]
    ds_read_b64_tr_b16 v[48:49], v4 offset:0
    ds_read_b128 v[36:39], v3 offset:6144
    v_mfma_f32_16x16x32_bf16 v[224:227], v[20:23], v[72:75], v[224:227]
    ds_read_b64_tr_b16 v[50:51], v4 offset:2048
    ds_read_b32 v68, v5
    v_mfma_f32_16x16x32_bf16 v[228:231], v[20:23], v[56:59], v[228:231]
    ds_read_b64_tr_b16 v[52:53], v4 offset:256
    ds_read_b64_tr_b16 v[54:55], v4 offset:2304
    v_xor_b32 v4, 32, v4
    v_mfma_f32_16x16x32_bf16 v[232:235], v[20:23], v[76:79], v[232:235]
    v_mfma_f32_16x16x32_bf16 v[236:239], v[20:23], v[64:67], v[236:239]
    v_mfma_f32_16x16x32_bf16 v[240:243], v[24:27], v[56:59], v[240:243]
    ds_read_b128 v[16:19], v2 offset:2048
    v_mfma_f32_16x16x32_bf16 v[244:247], v[24:27], v[60:63], v[244:247]
    ds_read_b128 v[20:23], v3 offset:2048
    v_mfma_f32_16x16x32_bf16 v[240:243], v[28:31], v[72:75], v[240:243]
    s_mov_b32 s29, s41
    s_mov_b32 s41, s42
    s_add_u32 s42, s42, 38912
    v_mfma_f32_16x16x32_bf16 v[244:247], v[28:31], v[56:59], v[244:247]
    s_cmp_eq_u32 s42, 155648
    s_cselect_b32 s42, 0, s42
    s_add_u32 s39, s39, 1
    s_cmp_lt_u32 s39, 15
    s_cbranch_scc1 K12_LOOP
    s_waitcnt lgkmcnt(2)
    v_mfma_f32_16x16x32_bf16 v[80:83], v[8:11], v[40:43], v[80:83]
    ds_read_b128 v[24:27], v2 offset:4096
    v_xor_b32 v72, s35, v44
    v_xor_b32 v73, s35, v45
    v_mfma_f32_16x16x32_bf16 v[84:87], v[8:11], v[44:47], v[84:87]
    ds_read_b128 v[28:31], v3 offset:4096
    v_xor_b32 v74, s35, v46
    v_xor_b32 v75, s35, v47
    v_mfma_f32_16x16x32_bf16 v[88:91], v[8:11], v[48:51], v[88:91]
    s_waitcnt lgkmcnt(2)
    v_cmp_gt_u32 vcc, s40, v68
    s_add_u32 s49, s39, 2
    s_lshr_b32 s49, s49, 1
    v_xor_b32 v76, s35, v52
    v_xor_b32 v77, s35, v53
    v_mfma_f32_16x16x32_bf16 v[92:95], v[8:11], v[52:55], v[92:95]
    s_cbranch_vccnz K12_S6
K12_Q6:
    s_mul_i32 s48, s49, s50
    s_add_u32 s48, s48, s47
    v_xor_b32 v78, s35, v54
    v_xor_b32 v79, s35, v55
    v_mfma_f32_16x16x32_bf16 v[80:83], v[12:15], v[72:75], v[80:83]
    s_add_u32 m0, s29, s36
    s_nop 0
    buffer_load_dwordx4 v1, s[8:11], s30 offen sc1 lds
    v_mfma_f32_16x16x32_bf16 v[84:87], v[12:15], v[40:43], v[84:87]
    s_cmp_lt_u32 s49, 8
    s_cselect_b32 s48, s48, 155744
    v_mfma_f32_16x16x32_bf16 v[88:91], v[12:15], v[76:79], v[88:91]
    s_cmp_ge_u32 s49, 3
    s_cselect_b32 s48, s48, 155744
    v_mfma_f32_16x16x32_bf16 v[92:95], v[12:15], v[48:51], v[92:95]
    v_mfma_f32_16x16x32_bf16 v[96:99], v[16:19], v[40:43], v[96:99]
    ds_read_b128 v[8:11], v2 offset:8192
    v_mfma_f32_16x16x32_bf16 v[100:103], v[16:19], v[44:47], v[100:103]
    ds_read_b128 v[12:15], v3 offset:8192
    v_mfma_f32_16x16x32_bf16 v[104:107], v[16:19], v[48:51], v[104:107]
    buffer_load_dwordx4 v1, s[8:11], s30 offen offset:1024 sc1 lds
    v_mfma_f32_16x16x32_bf16 v[108:111], v[16:19], v[52:55], v[108:111]
    v_mfma_f32_16x16x32_bf16 v[96:99], v[20:23], v[72:75], v[96:99]
    v_mfma_f32_16x16x32_bf16 v[100:103], v[20:23], v[40:43], v[100:103]
    v_mfma_f32_16x16x32_bf16 v[104:107], v[20:23], v[76:79], v[104:107]
    buffer_load_dwordx4 v1, s[8:11], s30 offen offset:2048 sc1 lds
    v_mfma_f32_16x16x32_bf16 v[108:111], v[20:23], v[48:51], v[108:111]
    s_waitcnt lgkmcnt(2)
    v_mfma_f32_16x16x32_bf16 v[112:115], v[24:27], v[40:43], v[112:115]
    ds_read_b128 v[16:19], v2 offset:10240
    v_mfma_f32_16x16x32_bf16 v[116:119], v[24:27], v[44:47], v[116:119]
    ds_read_b128 v[20:23], v3 offset:10240
    v_mfma_f32_16x16x32_bf16 v[120:123], v[24:27], v[48:51], v[120:123]
    v_mfma_f32_16x16x32_bf16 v[124:127], v[24:27], v[52:55], v[124:127]
    v_mfma_f32_16x16x32_bf16 v[112:115], v[28:31], v[72:75], v[112:115]
    buffer_load_dwordx4 v1, s[8:11], s30 offen offset:3072 sc1 lds
    v_mfma_f32_16x16x32_bf16 v[116:119], v[28:31], v[40:43], v[116:119]
    v_mfma_f32_16x16x32_bf16 v[120:123], v[28:31], v[76:79], v[120:123]
    v_mfma_f32_16x16x32_bf16 v[124:127], v[28:31], v[48:51], v[124:127]
    v_mfma_f32_16x16x32_bf16 v[128:131], v[32:35], v[40:43], v[128:131]
    ds_read_b128 v[24:27], v2 offset:12288
    v_mfma_f32_16x16x32_bf16 v[132:135], v[32:35], v[44:47], v[132:135]
    ds_read_b128 v[28:31], v3 offset:12288
    v_mfma_f32_16x16x32_bf16 v[136:139], v[32:35], v[48:51], v[136:139]
    s_add_u32 m0, m0, 4096
    s_add_u32 s34, s30, 4096
    buffer_load_dwordx4 v1, s[8:11], s34 offen sc1 lds
    v_mfma_f32_16x16x32_bf16 v[140:143], v[32:35], v[52:55], v[140:143]
    v_mfma_f32_16x16x32_bf16 v[128:131], v[36:39], v[72:75], v[128:131]
    v_mfma_f32_16x16x32_bf16 v[132:135], v[36:39], v[40:43], v[132:135]
    v_mfma_f32_16x16x32_bf16 v[136:139], v[36:39], v[76:79], v[136:139]
    s_add_u32 m0, s29, s37
    s_add_u32 s30, s30, 21376
    buffer_load_dwordx4 v1, s[12:15], s31 offen sc1 lds
    v_mfma_f32_16x16x32_bf16 v[140:143], v[36:39], v[48:51], v[140:143]
    s_waitcnt lgkmcnt(4)
    v_mfma_f32_16x16x32_bf16 v[144:147], v[8:11], v[40:43], v[144:147]
    ds_read_b128 v[32:35], v2 offset:14336
    v_mfma_f32_16x16x32_bf16 v[148:151], v[8:11], v[44:47], v[148:151]
    ds_read_b128 v[36:39], v3 offset:14336
    v_mfma_f32_16x16x32_bf16 v[152:155], v[8:11], v[48:51], v[152:155]
    v_mfma_f32_16x16x32_bf16 v[156:159], v[8:11], v[52:55], v[156:159]
    v_mfma_f32_16x16x32_bf16 v[144:147], v[12:15], v[72:75], v[144:147]
    buffer_load_dwordx4 v1, s[12:15], s31 offen offset:1024 sc1 lds
    v_mfma_f32_16x16x32_bf16 v[148:151], v[12:15], v[40:43], v[148:151]
    v_mfma_f32_16x16x32_bf16 v[152:155], v[12:15], v[76:79], v[152:155]
    v_mfma_f32_16x16x32_bf16 v[156:159], v[12:15], v[48:51], v[156:159]
    s_waitcnt lgkmcnt(4)
    v_mfma_f32_16x16x32_bf16 v[160:163], v[16:19], v[40:43], v[160:163]
    ds_read_b128 v[8:11], v2 offset:16384
    v_mfma_f32_16x16x32_bf16 v[164:167], v[16:19], v[44:47], v[164:167]
    ds_read_b128 v[12:15], v3 offset:16384
    v_mfma_f32_16x16x32_bf16 v[168:171], v[16:19], v[48:51], v[168:171]
    buffer_load_dwordx4 v1, s[12:15], s31 offen offset:2048 sc1 lds
    v_mfma_f32_16x16x32_bf16 v[172:175], v[16:19], v[52:55], v[172:175]
    s_add_u32 s40, s40, 1
    s_mov_b32 s51, s40
    v_mov_b32 v0, s40
    v_mfma_f32_16x16x32_bf16 v[160:163], v[20:23], v[72:75], v[160:163]
    s_waitcnt vmcnt(19)
    ds_write_b32 v7, v0
    v_mfma_f32_16x16x32_bf16 v[164:167], v[20:23], v[40:43], v[164:167]
    v_mfma_f32_16x16x32_bf16 v[168:171], v[20:23], v[76:79], v[168:171]
    buffer_load_dwordx4 v1, s[12:15], s31 offen offset:3072 sc1 lds
    v_mfma_f32_16x16x32_bf16 v[172:175], v[20:23], v[48:51], v[172:175]
    s_waitcnt lgkmcnt(5)
    v_mfma_f32_16x16x32_bf16 v[176:179], v[24:27], v[40:43], v[176:179]
    ds_read_b128 v[16:19], v2 offset:18432
    v_mfma_f32_16x16x32_bf16 v[180:183], v[24:27], v[44:47], v[180:183]
    ds_read_b128 v[20:23], v3 offset:18432
    v_mov_b32 v0, s48
    v_mfma_f32_16x16x32_bf16 v[184:187], v[24:27], v[48:51], v[184:187]
    ds_read_b32 v0, v0
    v_mfma_f32_16x16x32_bf16 v[188:191], v[24:27], v[52:55], v[188:191]
    v_mfma_f32_16x16x32_bf16 v[176:179], v[28:31], v[72:75], v[176:179]
    s_add_u32 m0, s29, s38
    s_mov_b64 exec, s[44:45]
    buffer_load_dwordx4 v1, s[64:67], s33 offen sc1 lds
    s_mov_b64 exec, -1
    s_add_u32 s31, s31, 16384
    s_add_u32 s33, s33, 21376
    v_mfma_f32_16x16x32_bf16 v[180:183], v[28:31], v[40:43], v[180:183]
    v_mfma_f32_16x16x32_bf16 v[184:187], v[28:31], v[76:79], v[184:187]
    v_mfma_f32_16x16x32_bf16 v[188:191], v[28:31], v[48:51], v[188:191]
    s_waitcnt lgkmcnt(0)
    v_cmp_eq_u32 vcc, 0, v0
    v_mfma_f32_16x16x32_bf16 v[192:195], v[32:35], v[40:43], v[192:195]
    ds_read_b128 v[24:27], v2 offset:20480
    v_mfma_f32_16x16x32_bf16 v[196:199], v[32:35], v[44:47], v[196:199]
    ds_read_b128 v[28:31], v3 offset:20480
    s_cbranch_vccnz K12_F7
K12_G7:
    v_mfma_f32_16x16x32_bf16 v[200:203], v[32:35], v[48:51], v[200:203]
    s_sub_u32 s43, s42, s41
    s_add_u32 s40, s40, 1
    v_add_u32 v2, s43, v2
    v_mfma_f32_16x16x32_bf16 v[204:207], v[32:35], v[52:55], v[204:207]
    v_add_u32 v3, s43, v3
    v_add_u32 v4, s43, v4
    v_mov_b32 v0, s40
    v_mfma_f32_16x16x32_bf16 v[192:195], v[36:39], v[72:75], v[192:195]
    ds_write_b32 v7, v0
    v_mfma_f32_16x16x32_bf16 v[196:199], v[36:39], v[40:43], v[196:199]
    v_mfma_f32_16x16x32_bf16 v[200:203], v[36:39], v[76:79], v[200:203]
    v_mfma_f32_16x16x32_bf16 v[204:207], v[36:39], v[48:51], v[204:207]
    ds_read_b32 v56, v5
    v_mfma_f32_16x16x32_bf16 v[208:211], v[8:11], v[40:43], v[208:211]
    v_mfma_f32_16x16x32_bf16 v[212:215], v[8:11], v[44:47], v[212:215]
    v_mfma_f32_16x16x32_bf16 v[216:219], v[8:11], v[48:51], v[216:219]
    v_mfma_f32_16x16x32_bf16 v[220:223], v[8:11], v[52:55], v[220:223]
    s_waitcnt lgkmcnt(0)
    v_cmp_gt_u32 vcc, s51, v56
    v_mfma_f32_16x16x32_bf16 v[208:211], v[12:15], v[72:75], v[208:211]
    v_mfma_f32_16x16x32_bf16 v[212:215], v[12:15], v[40:43], v[212:215]
    s_cbranch_vccnz K12_S8
K12_Q8:
    v_mfma_f32_16x16x32_bf16 v[216:219], v[12:15], v[76:79], v[216:219]
    ds_read_b64_tr_b16 v[56:57], v4 offset:0
    v_mfma_f32_16x16x32_bf16 v[220:223], v[12:15], v[48:51], v[220:223]
    ds_read_b64_tr_b16 v[58:59], v4 offset:2048
    v_mfma_f32_16x16x32_bf16 v[224:227], v[16:19], v[40:43], v[224:227]
    ds_read_b64_tr_b16 v[60:61], v4 offset:256
    ds_read_b128 v[8:11], v2 offset:0
    v_mfma_f32_16x16x32_bf16 v[228:231], v[16:19], v[44:47], v[228:231]
    ds_read_b64_tr_b16 v[62:63], v4 offset:2304
    ds_read_b128 v[12:15], v3 offset:0
    v_mfma_f32_16x16x32_bf16 v[232:235], v[16:19], v[48:51], v[232:235]
    v_xor_b32 v4, 32, v4
    ds_read_b128 v[32:35], v2 offset:6144
    v_mfma_f32_16x16x32_bf16 v[236:239], v[16:19], v[52:55], v[236:239]
    ds_read_b64_tr_b16 v[64:65], v4 offset:0
    ds_read_b128 v[36:39], v3 offset:6144
    v_mfma_f32_16x16x32_bf16 v[224:227], v[20:23], v[72:75], v[224:227]
    ds_read_b64_tr_b16 v[66:67], v4 offset:2048
    ds_read_b32 v52, v5
    v_mfma_f32_16x16x32_bf16 v[228:231], v[20:23], v[40:43], v[228:231]
    ds_read_b64_tr_b16 v[68:69], v4 offset:256
    ds_read_b64_tr_b16 v[70:71], v4 offset:2304
    v_xor_b32 v4, 32, v4
    v_mfma_f32_16x16x32_bf16 v[232:235], v[20:23], v[76:79], v[232:235]
    v_mfma_f32_16x16x32_bf16 v[236:239], v[20:23], v[48:51], v[236:239]
    v_mfma_f32_16x16x32_bf16 v[240:243], v[24:27], v[40:43], v[240:243]
    ds_read_b128 v[16:19], v2 offset:2048
    v_mfma_f32_16x16x32_bf16 v[244:247], v[24:27], v[44:47], v[244:247]
    ds_read_b128 v[20:23], v3 offset:2048
    v_mfma_f32_16x16x32_bf16 v[240:243], v[28:31], v[72:75], v[240:243]
    s_mov_b32 s29, s41
    s_mov_b32 s41, s42
    s_add_u32 s42, s42, 38912
    v_mfma_f32_16x16x32_bf16 v[244:247], v[28:31], v[40:43], v[244:247]
    s_cmp_eq_u32 s42, 155648
    s_cselect_b32 s42, 0, s42
    s_waitcnt lgkmcnt(2)
    v_mfma_f32_16x16x32_bf16 v[80:83], v[8:11], v[56:59], v[80:83]
    ds_read_b128 v[24:27], v2 offset:4096
    v_xor_b32 v72, s35, v60
    v_xor_b32 v73, s35, v61
    v_mfma_f32_16x16x32_bf16 v[84:87], v[8:11], v[60:63], v[84:87]
    ds_read_b128 v[28:31], v3 offset:4096
    v_xor_b32 v74, s35, v62
    v_xor_b32 v75, s35, v63
    v_mfma_f32_16x16x32_bf16 v[88:91], v[8:11], v[64:67], v[88:91]
    v_xor_b32 v76, s35, v68
    v_xor_b32 v77, s35, v69
    v_mfma_f32_16x16x32_bf16 v[92:95], v[8:11], v[68:71], v[92:95]
    v_xor_b32 v78, s35, v70
    v_xor_b32 v79, s35, v71
    v_mfma_f32_16x16x32_bf16 v[80:83], v[12:15], v[72:75], v[80:83]
    v_lshrrev_b32 v0, 4, v1
    v_and_b32 v5, 15, v0
    v_mfma_f32_16x16x32_bf16 v[84:87], v[12:15], v[56:59], v[84:87]
    v_lshrrev_b32 v0, 4, v0
    s_lshl_b32 s28, s21, 7
    v_mfma_f32_16x16x32_bf16 v[88:91], v[12:15], v[76:79], v[88:91]
    s_lshl_b32 s29, s3, 5
    s_add_u32 s28, s28, s29
    v_mfma_f32_16x16x32_bf16 v[92:95], v[12:15], v[64:67], v[92:95]
    v_add_u32 v5, s28, v5
    v_lshlrev_b32 v5, 2, v5
    s_waitcnt lgkmcnt(2)
    v_mfma_f32_16x16x32_bf16 v[96:99], v[16:19], v[56:59], v[96:99]
    ds_read_b128 v[8:11], v2 offset:8192
    v_lshl_add_u32 v5, v0, 13, v5
    s_lshl_b32 s28, s20, 6
    v_mfma_f32_16x16x32_bf16 v[100:103], v[16:19], v[60:63], v[100:103]
    ds_read_b128 v[12:15], v3 offset:8192
    v_xor_b32 v5, s28, v5
    v_xor_b32 v7, 64, v5
    v_mfma_f32_16x16x32_bf16 v[104:107], v[16:19], v[64:67], v[104:107]
    v_mfma_f32_16x16x32_bf16 v[108:111], v[16:19], v[68:71], v[108:111]
    s_mov_b32 s38, 0
    v_cvt_pk_bf16_f32 v48, v80, v84
    buffer_store_dword v48, v5, s[16:19], s38 offen offset:0 sc1
    v_cvt_pk_bf16_f32 v49, v88, v92
    buffer_store_dword v49, v7, s[16:19], s38 offen offset:0 sc1
    v_mfma_f32_16x16x32_bf16 v[96:99], v[20:23], v[72:75], v[96:99]
    v_cvt_pk_bf16_f32 v50, v81, v85
    buffer_store_dword v50, v5, s[16:19], s38 offen offset:2048 sc1
    v_mfma_f32_16x16x32_bf16 v[100:103], v[20:23], v[56:59], v[100:103]
    v_cvt_pk_bf16_f32 v51, v89, v93
    buffer_store_dword v51, v7, s[16:19], s38 offen offset:2048 sc1
    v_mfma_f32_16x16x32_bf16 v[104:107], v[20:23], v[76:79], v[104:107]
    s_mov_b32 s38, 4096
    v_cvt_pk_bf16_f32 v52, v82, v86
    buffer_store_dword v52, v5, s[16:19], s38 offen offset:0 sc1
    v_cvt_pk_bf16_f32 v53, v90, v94
    buffer_store_dword v53, v7, s[16:19], s38 offen offset:0 sc1
    v_mfma_f32_16x16x32_bf16 v[108:111], v[20:23], v[64:67], v[108:111]
    v_cvt_pk_bf16_f32 v54, v83, v87
    buffer_store_dword v54, v5, s[16:19], s38 offen offset:2048 sc1
    s_waitcnt lgkmcnt(2)
    v_mfma_f32_16x16x32_bf16 v[112:115], v[24:27], v[56:59], v[112:115]
    ds_read_b128 v[16:19], v2 offset:10240
    v_cvt_pk_bf16_f32 v55, v91, v95
    buffer_store_dword v55, v7, s[16:19], s38 offen offset:2048 sc1
    v_mfma_f32_16x16x32_bf16 v[116:119], v[24:27], v[60:63], v[116:119]
    ds_read_b128 v[20:23], v3 offset:10240
    v_mfma_f32_16x16x32_bf16 v[120:123], v[24:27], v[64:67], v[120:123]
    v_mfma_f32_16x16x32_bf16 v[124:127], v[24:27], v[68:71], v[124:127]
    s_mov_b32 s38, 32768
    v_cvt_pk_bf16_f32 v40, v96, v100
    buffer_store_dword v40, v5, s[16:19], s38 offen offset:0 sc1
    v_cvt_pk_bf16_f32 v41, v104, v108
    buffer_store_dword v41, v7, s[16:19], s38 offen offset:0 sc1
    v_mfma_f32_16x16x32_bf16 v[112:115], v[28:31], v[72:75], v[112:115]
    v_cvt_pk_bf16_f32 v42, v97, v101
    buffer_store_dword v42, v5, s[16:19], s38 offen offset:2048 sc1
    v_mfma_f32_16x16x32_bf16 v[116:119], v[28:31], v[56:59], v[116:119]
    v_cvt_pk_bf16_f32 v43, v105, v109
    buffer_store_dword v43, v7, s[16:19], s38 offen offset:2048 sc1
    v_mfma_f32_16x16x32_bf16 v[120:123], v[28:31], v[76:79], v[120:123]
    s_mov_b32 s38, 36864
    v_cvt_pk_bf16_f32 v44, v98, v102
    buffer_store_dword v44, v5, s[16:19], s38 offen offset:0 sc1
    v_cvt_pk_bf16_f32 v45, v106, v110
    buffer_store_dword v45, v7, s[16:19], s38 offen offset:0 sc1
    v_mfma_f32_16x16x32_bf16 v[124:127], v[28:31], v[64:67], v[124:127]
    v_cvt_pk_bf16_f32 v46, v99, v103
    buffer_store_dword v46, v5, s[16:19], s38 offen offset:2048 sc1
    v_mfma_f32_16x16x32_bf16 v[128:131], v[32:35], v[56:59], v[128:131]
    ds_read_b128 v[24:27], v2 offset:12288
    v_cvt_pk_bf16_f32 v47, v107, v111
    buffer_store_dword v47, v7, s[16:19], s38 offen offset:2048 sc1
    v_mfma_f32_16x16x32_bf16 v[132:135], v[32:35], v[60:63], v[132:135]
    ds_read_b128 v[28:31], v3 offset:12288
    v_mfma_f32_16x16x32_bf16 v[136:139], v[32:35], v[64:67], v[136:139]
    v_mfma_f32_16x16x32_bf16 v[140:143], v[32:35], v[68:71], v[140:143]
    s_mov_b32 s38, 65536
    v_cvt_pk_bf16_f32 v48, v112, v116
    buffer_store_dword v48, v5, s[16:19], s38 offen offset:0 sc1
    v_cvt_pk_bf16_f32 v49, v120, v124
    buffer_store_dword v49, v7, s[16:19], s38 offen offset:0 sc1
    v_mfma_f32_16x16x32_bf16 v[128:131], v[36:39], v[72:75], v[128:131]
    v_cvt_pk_bf16_f32 v50, v113, v117
    buffer_store_dword v50, v5, s[16:19], s38 offen offset:2048 sc1
    v_mfma_f32_16x16x32_bf16 v[132:135], v[36:39], v[56:59], v[132:135]
    v_cvt_pk_bf16_f32 v51, v121, v125
    buffer_store_dword v51, v7, s[16:19], s38 offen offset:2048 sc1
    v_mfma_f32_16x16x32_bf16 v[136:139], v[36:39], v[76:79], v[136:139]
    s_mov_b32 s38, 69632
    v_cvt_pk_bf16_f32 v52, v114, v118
    buffer_store_dword v52, v5, s[16:19], s38 offen offset:0 sc1
    v_cvt_pk_bf16_f32 v53, v122, v126
    buffer_store_dword v53, v7, s[16:19], s38 offen offset:0 sc1
    v_mfma_f32_16x16x32_bf16 v[140:143], v[36:39], v[64:67], v[140:143]
    v_cvt_pk_bf16_f32 v54, v115, v119
    buffer_store_dword v54, v5, s[16:19], s38 offen offset:2048 sc1
    s_waitcnt lgkmcnt(4)
    v_mfma_f32_16x16x32_bf16 v[144:147], v[8:11], v[56:59], v[144:147]
    ds_read_b128 v[32:35], v2 offset:14336
    v_cvt_pk_bf16_f32 v55, v123, v127
    buffer_store_dword v55, v7, s[16:19], s38 offen offset:2048 sc1
    v_mfma_f32_16x16x32_bf16 v[148:151], v[8:11], v[60:63], v[148:151]
    ds_read_b128 v[36:39], v3 offset:14336
    v_mfma_f32_16x16x32_bf16 v[152:155], v[8:11], v[64:67], v[152:155]
    v_mfma_f32_16x16x32_bf16 v[156:159], v[8:11], v[68:71], v[156:159]
    s_mov_b32 s38, 98304
    v_cvt_pk_bf16_f32 v40, v128, v132
    buffer_store_dword v40, v5, s[16:19], s38 offen offset:0 sc1
    v_cvt_pk_bf16_f32 v41, v136, v140
    buffer_store_dword v41, v7, s[16:19], s38 offen offset:0 sc1
    v_mfma_f32_16x16x32_bf16 v[144:147], v[12:15], v[72:75], v[144:147]
    v_cvt_pk_bf16_f32 v42, v129, v133
    buffer_store_dword v42, v5, s[16:19], s38 offen offset:2048 sc1
    v_mfma_f32_16x16x32_bf16 v[148:151], v[12:15], v[56:59], v[148:151]
    v_cvt_pk_bf16_f32 v43, v137, v141
    buffer_store_dword v43, v7, s[16:19], s38 offen offset:2048 sc1
    v_mfma_f32_16x16x32_bf16 v[152:155], v[12:15], v[76:79], v[152:155]
    s_mov_b32 s38, 102400
    v_cvt_pk_bf16_f32 v44, v130, v134
    buffer_store_dword v44, v5, s[16:19], s38 offen offset:0 sc1
    v_cvt_pk_bf16_f32 v45, v138, v142
    buffer_store_dword v45, v7, s[16:19], s38 offen offset:0 sc1
    v_mfma_f32_16x16x32_bf16 v[156:159], v[12:15], v[64:67], v[156:159]
    v_cvt_pk_bf16_f32 v46, v131, v135
    buffer_store_dword v46, v5, s[16:19], s38 offen offset:2048 sc1
    s_waitcnt lgkmcnt(4)
    v_mfma_f32_16x16x32_bf16 v[160:163], v[16:19], v[56:59], v[160:163]
    ds_read_b128 v[8:11], v2 offset:16384
    v_cvt_pk_bf16_f32 v47, v139, v143
    buffer_store_dword v47, v7, s[16:19], s38 offen offset:2048 sc1
    v_mfma_f32_16x16x32_bf16 v[164:167], v[16:19], v[60:63], v[164:167]
    ds_read_b128 v[12:15], v3 offset:16384
    v_mfma_f32_16x16x32_bf16 v[168:171], v[16:19], v[64:67], v[168:171]
    v_mfma_f32_16x16x32_bf16 v[172:175], v[16:19], v[68:71], v[172:175]
    s_mov_b32 s38, 131072
    v_cvt_pk_bf16_f32 v48, v144, v148
    buffer_store_dword v48, v5, s[16:19], s38 offen offset:0 sc1
    v_cvt_pk_bf16_f32 v49, v152, v156
    buffer_store_dword v49, v7, s[16:19], s38 offen offset:0 sc1
    v_mfma_f32_16x16x32_bf16 v[160:163], v[20:23], v[72:75], v[160:163]
    v_cvt_pk_bf16_f32 v50, v145, v149
    buffer_store_dword v50, v5, s[16:19], s38 offen offset:2048 sc1
    v_mfma_f32_16x16x32_bf16 v[164:167], v[20:23], v[56:59], v[164:167]
    v_cvt_pk_bf16_f32 v51, v153, v157
    buffer_store_dword v51, v7, s[16:19], s38 offen offset:2048 sc1
    v_mfma_f32_16x16x32_bf16 v[168:171], v[20:23], v[76:79], v[168:171]
    s_mov_b32 s38, 135168
    v_cvt_pk_bf16_f32 v52, v146, v150
    buffer_store_dword v52, v5, s[16:19], s38 offen offset:0 sc1
    v_cvt_pk_bf16_f32 v53, v154, v158
    buffer_store_dword v53, v7, s[16:19], s38 offen offset:0 sc1
    v_mfma_f32_16x16x32_bf16 v[172:175], v[20:23], v[64:67], v[172:175]
    v_cvt_pk_bf16_f32 v54, v147, v151
    buffer_store_dword v54, v5, s[16:19], s38 offen offset:2048 sc1
    s_waitcnt lgkmcnt(4)
    v_mfma_f32_16x16x32_bf16 v[176:179], v[24:27], v[56:59], v[176:179]
    ds_read_b128 v[16:19], v2 offset:18432
    v_cvt_pk_bf16_f32 v55, v155, v159
    buffer_store_dword v55, v7, s[16:19], s38 offen offset:2048 sc1
    v_mfma_f32_16x16x32_bf16 v[180:183], v[24:27], v[60:63], v[180:183]
    ds_read_b128 v[20:23], v3 offset:18432
    v_mfma_f32_16x16x32_bf16 v[184:187], v[24:27], v[64:67], v[184:187]
    v_mfma_f32_16x16x32_bf16 v[188:191], v[24:27], v[68:71], v[188:191]
    s_mov_b32 s38, 163840
    v_cvt_pk_bf16_f32 v40, v160, v164
    buffer_store_dword v40, v5, s[16:19], s38 offen offset:0 sc1
    v_cvt_pk_bf16_f32 v41, v168, v172
    buffer_store_dword v41, v7, s[16:19], s38 offen offset:0 sc1
    v_mfma_f32_16x16x32_bf16 v[176:179], v[28:31], v[72:75], v[176:179]
    v_cvt_pk_bf16_f32 v42, v161, v165
    buffer_store_dword v42, v5, s[16:19], s38 offen offset:2048 sc1
    v_mfma_f32_16x16x32_bf16 v[180:183], v[28:31], v[56:59], v[180:183]
    v_cvt_pk_bf16_f32 v43, v169, v173
    buffer_store_dword v43, v7, s[16:19], s38 offen offset:2048 sc1
    v_mfma_f32_16x16x32_bf16 v[184:187], v[28:31], v[76:79], v[184:187]
    s_mov_b32 s38, 167936
    v_cvt_pk_bf16_f32 v44, v162, v166
    buffer_store_dword v44, v5, s[16:19], s38 offen offset:0 sc1
    v_cvt_pk_bf16_f32 v45, v170, v174
    buffer_store_dword v45, v7, s[16:19], s38 offen offset:0 sc1
    v_mfma_f32_16x16x32_bf16 v[188:191], v[28:31], v[64:67], v[188:191]
    v_cvt_pk_bf16_f32 v46, v163, v167
    buffer_store_dword v46, v5, s[16:19], s38 offen offset:2048 sc1
    s_waitcnt lgkmcnt(4)
    v_mfma_f32_16x16x32_bf16 v[192:195], v[32:35], v[56:59], v[192:195]
    ds_read_b128 v[24:27], v2 offset:20480
    v_cvt_pk_bf16_f32 v47, v171, v175
    buffer_store_dword v47, v7, s[16:19], s38 offen offset:2048 sc1
    v_mfma_f32_16x16x32_bf16 v[196:199], v[32:35], v[60:63], v[196:199]
    ds_read_b128 v[28:31], v3 offset:20480
    v_mfma_f32_16x16x32_bf16 v[200:203], v[32:35], v[64:67], v[200:203]
    v_mfma_f32_16x16x32_bf16 v[204:207], v[32:35], v[68:71], v[204:207]
    s_mov_b32 s38, 196608
    v_cvt_pk_bf16_f32 v48, v176, v180
    buffer_store_dword v48, v5, s[16:19], s38 offen offset:0 sc1
    v_cvt_pk_bf16_f32 v49, v184, v188
    buffer_store_dword v49, v7, s[16:19], s38 offen offset:0 sc1
    v_mfma_f32_16x16x32_bf16 v[192:195], v[36:39], v[72:75], v[192:195]
    v_cvt_pk_bf16_f32 v50, v177, v181
    buffer_store_dword v50, v5, s[16:19], s38 offen offset:2048 sc1
    v_mfma_f32_16x16x32_bf16 v[196:199], v[36:39], v[56:59], v[196:199]
    v_cvt_pk_bf16_f32 v51, v185, v189
    buffer_store_dword v51, v7, s[16:19], s38 offen offset:2048 sc1
    v_mfma_f32_16x16x32_bf16 v[200:203], v[36:39], v[76:79], v[200:203]
    s_mov_b32 s38, 200704
    v_cvt_pk_bf16_f32 v52, v178, v182
    buffer_store_dword v52, v5, s[16:19], s38 offen offset:0 sc1
    v_cvt_pk_bf16_f32 v53, v186, v190
    buffer_store_dword v53, v7, s[16:19], s38 offen offset:0 sc1
    v_mfma_f32_16x16x32_bf16 v[204:207], v[36:39], v[64:67], v[204:207]
    v_cvt_pk_bf16_f32 v54, v179, v183
    buffer_store_dword v54, v5, s[16:19], s38 offen offset:2048 sc1
    s_waitcnt lgkmcnt(4)
    v_mfma_f32_16x16x32_bf16 v[208:211], v[8:11], v[56:59], v[208:211]
    v_cvt_pk_bf16_f32 v55, v187, v191
    buffer_store_dword v55, v7, s[16:19], s38 offen offset:2048 sc1
    v_mfma_f32_16x16x32_bf16 v[212:215], v[8:11], v[60:63], v[212:215]
    v_mfma_f32_16x16x32_bf16 v[216:219], v[8:11], v[64:67], v[216:219]
    v_mfma_f32_16x16x32_bf16 v[220:223], v[8:11], v[68:71], v[220:223]
    s_mov_b32 s38, 229376
    v_cvt_pk_bf16_f32 v40, v192, v196
    buffer_store_dword v40, v5, s[16:19], s38 offen offset:0 sc1
    v_cvt_pk_bf16_f32 v41, v200, v204
    buffer_store_dword v41, v7, s[16:19], s38 offen offset:0 sc1
    v_mfma_f32_16x16x32_bf16 v[208:211], v[12:15], v[72:75], v[208:211]
    v_cvt_pk_bf16_f32 v42, v193, v197
    buffer_store_dword v42, v5, s[16:19], s38 offen offset:2048 sc1
    v_mfma_f32_16x16x32_bf16 v[212:215], v[12:15], v[56:59], v[212:215]
    v_cvt_pk_bf16_f32 v43, v201, v205
    buffer_store_dword v43, v7, s[16:19], s38 offen offset:2048 sc1
    v_mfma_f32_16x16x32_bf16 v[216:219], v[12:15], v[76:79], v[216:219]
    s_mov_b32 s38, 233472
    v_cvt_pk_bf16_f32 v44, v194, v198
    buffer_store_dword v44, v5, s[16:19], s38 offen offset:0 sc1
    v_cvt_pk_bf16_f32 v45, v202, v206
    buffer_store_dword v45, v7, s[16:19], s38 offen offset:0 sc1
    v_mfma_f32_16x16x32_bf16 v[220:223], v[12:15], v[64:67], v[220:223]
    v_cvt_pk_bf16_f32 v46, v195, v199
    buffer_store_dword v46, v5, s[16:19], s38 offen offset:2048 sc1
    s_waitcnt lgkmcnt(2)
    v_mfma_f32_16x16x32_bf16 v[224:227], v[16:19], v[56:59], v[224:227]
    v_cvt_pk_bf16_f32 v47, v203, v207
    buffer_store_dword v47, v7, s[16:19], s38 offen offset:2048 sc1
    v_mfma_f32_16x16x32_bf16 v[228:231], v[16:19], v[60:63], v[228:231]
    v_mfma_f32_16x16x32_bf16 v[232:235], v[16:19], v[64:67], v[232:235]
    v_mfma_f32_16x16x32_bf16 v[236:239], v[16:19], v[68:71], v[236:239]
    s_mov_b32 s38, 262144
    v_cvt_pk_bf16_f32 v48, v208, v212
    buffer_store_dword v48, v5, s[16:19], s38 offen offset:0 sc1
    v_cvt_pk_bf16_f32 v49, v216, v220
    buffer_store_dword v49, v7, s[16:19], s38 offen offset:0 sc1
    v_mfma_f32_16x16x32_bf16 v[224:227], v[20:23], v[72:75], v[224:227]
    v_cvt_pk_bf16_f32 v50, v209, v213
    buffer_store_dword v50, v5, s[16:19], s38 offen offset:2048 sc1
    v_mfma_f32_16x16x32_bf16 v[228:231], v[20:23], v[56:59], v[228:231]
    v_cvt_pk_bf16_f32 v51, v217, v221
    buffer_store_dword v51, v7, s[16:19], s38 offen offset:2048 sc1
    v_mfma_f32_16x16x32_bf16 v[232:235], v[20:23], v[76:79], v[232:235]
    s_mov_b32 s38, 266240
    v_cvt_pk_bf16_f32 v52, v210, v214
    buffer_store_dword v52, v5, s[16:19], s38 offen offset:0 sc1
    v_cvt_pk_bf16_f32 v53, v218, v222
    buffer_store_dword v53, v7, s[16:19], s38 offen offset:0 sc1
    v_mfma_f32_16x16x32_bf16 v[236:239], v[20:23], v[64:67], v[236:239]
    v_cvt_pk_bf16_f32 v54, v211, v215
    buffer_store_dword v54, v5, s[16:19], s38 offen offset:2048 sc1
    s_waitcnt lgkmcnt(0)
    v_mfma_f32_16x16x32_bf16 v[240:243], v[24:27], v[56:59], v[240:243]
    v_cvt_pk_bf16_f32 v55, v219, v223
    buffer_store_dword v55, v7, s[16:19], s38 offen offset:2048 sc1
    v_mfma_f32_16x16x32_bf16 v[244:247], v[24:27], v[60:63], v[244:247]
    v_mfma_f32_16x16x32_bf16 v[240:243], v[28:31], v[72:75], v[240:243]
    v_mfma_f32_16x16x32_bf16 v[244:247], v[28:31], v[56:59], v[244:247]
    s_mov_b32 s38, 294912
    v_cvt_pk_bf16_f32 v40, v224, v228
    buffer_store_dword v40, v5, s[16:19], s38 offen offset:0 sc1
    v_cvt_pk_bf16_f32 v41, v232, v236
    buffer_store_dword v41, v7, s[16:19], s38 offen offset:0 sc1
    v_cvt_pk_bf16_f32 v42, v225, v229
    buffer_store_dword v42, v5, s[16:19], s38 offen offset:2048 sc1
    v_cvt_pk_bf16_f32 v43, v233, v237
    buffer_store_dword v43, v7, s[16:19], s38 offen offset:2048 sc1
    s_mov_b32 s38, 299008
    v_cvt_pk_bf16_f32 v44, v226, v230
    buffer_store_dword v44, v5, s[16:19], s38 offen offset:0 sc1
    v_cvt_pk_bf16_f32 v45, v234, v238
    buffer_store_dword v45, v7, s[16:19], s38 offen offset:0 sc1
    v_cvt_pk_bf16_f32 v46, v227, v231
    buffer_store_dword v46, v5, s[16:19], s38 offen offset:2048 sc1
    v_cvt_pk_bf16_f32 v47, v235, v239
    buffer_store_dword v47, v7, s[16:19], s38 offen offset:2048 sc1
    s_nop 7
    s_lshl_b32 s34, s27, 1
    s_mul_i32 s34, s34, 342016
    s_add_u32 s34, s34, 118489088
    s_add_u32 s64, s58, s34
    s_addc_u32 s65, s59, 0
    s_and_b32 s65, s65, 0xffff
    s_mov_b32 s66, 684032
    s_mov_b32 s67, 0x00020000
    v_lshrrev_b32 v8, 8, v1
    v_lshlrev_b32 v9, 13, v8
    v_sub_u32 v9, v5, v9
    v_lshlrev_b32 v8, 2, v8
    v_add_u32 v8, 160, v8
    v_add_u32 v10, 0, v8
    v_add_u32 v11, 160, v10
    v_cmp_gt_u32 vcc, 167, v10
    s_nop 1
    v_cndmask_b32 v11, v11, v10, vcc
    v_cmp_gt_u32 vcc, 174, v10
    v_mov_b32 v12, 0x7ffff
    s_nop 0
    v_cndmask_b32 v11, v12, v11, vcc
    v_lshl_add_u32 v16, v11, 11, v9
    v_add_u32 v10, 1, v8
    v_add_u32 v11, 160, v10
    v_cmp_gt_u32 vcc, 167, v10
    s_nop 1
    v_cndmask_b32 v11, v11, v10, vcc
    v_cmp_gt_u32 vcc, 174, v10
    v_mov_b32 v12, 0x7ffff
    s_nop 0
    v_cndmask_b32 v11, v12, v11, vcc
    v_lshl_add_u32 v17, v11, 11, v9
    v_add_u32 v10, 2, v8
    v_add_u32 v11, 160, v10
    v_cmp_gt_u32 vcc, 167, v10
    s_nop 1
    v_cndmask_b32 v11, v11, v10, vcc
    v_cmp_gt_u32 vcc, 174, v10
    v_mov_b32 v12, 0x7ffff
    s_nop 0
    v_cndmask_b32 v11, v12, v11, vcc
    v_lshl_add_u32 v18, v11, 11, v9
    v_add_u32 v10, 3, v8
    v_add_u32 v11, 160, v10
    v_cmp_gt_u32 vcc, 167, v10
    s_nop 1
    v_cndmask_b32 v11, v11, v10, vcc
    v_cmp_gt_u32 vcc, 174, v10
    v_mov_b32 v12, 0x7ffff
    s_nop 0
    v_cndmask_b32 v11, v12, v11, vcc
    v_lshl_add_u32 v19, v11, 11, v9
    v_cvt_pk_bf16_f32 v20, v240, v244
    buffer_store_dword v20, v16, s[64:67], 0 offen sc1
    v_cvt_pk_bf16_f32 v21, v241, v245
    buffer_store_dword v21, v17, s[64:67], 0 offen sc1
    v_cvt_pk_bf16_f32 v22, v242, v246
    buffer_store_dword v22, v18, s[64:67], 0 offen sc1
    v_cvt_pk_bf16_f32 v23, v243, v247
    buffer_store_dword v23, v19, s[64:67], 0 offen sc1
    s_endpgm
K12_S0:
    s_mov_b32 s61, 16384
    s_add_u32 s62, s62, 1
K12_S0_L:
    ds_read_b32 v56, v5
    s_waitcnt lgkmcnt(0)
    v_cmp_gt_u32 vcc, s40, v56
    s_sub_u32 s61, s61, 1
    s_cmp_eq_u32 s61, 0
    s_cbranch_scc1 K12_Q0
    s_cbranch_vccz K12_Q0
    s_branch K12_S0_L
K12_S1:
    s_mov_b32 s61, 16384
    s_add_u32 s62, s62, 1
K12_S1_L:
    ds_read_b32 v68, v5
    s_waitcnt lgkmcnt(0)
    v_cmp_gt_u32 vcc, s40, v68
    s_sub_u32 s61, s61, 1
    s_cmp_eq_u32 s61, 0
    s_cbranch_scc1 K12_Q1
    s_cbranch_vccz K12_Q1
    s_branch K12_S1_L
K12_F2:
    s_mov_b32 s61, 16384
    s_add_u32 s63, s63, 1
K12_F2_L:
    s_mov_b32 m0, s46
    s_mov_b64 exec, 0xff
    buffer_load_dword v1, s[4:7], 0 offen sc1 lds
    s_mov_b64 exec, -1
    s_waitcnt vmcnt(0)
    v_mov_b32 v0, s48
    ds_read_b32 v0, v0
    s_waitcnt lgkmcnt(0)
    v_cmp_eq_u32 vcc, 0, v0
    s_sub_u32 s61, s61, 1
    s_cmp_eq_u32 s61, 0
    s_cbranch_scc1 K12_F2_X
    s_cbranch_vccz K12_F2_X
    s_sleep 2
    s_branch K12_F2_L
K12_F2_X:
    s_branch K12_G2
K12_S3:
    s_mov_b32 s61, 16384
    s_add_u32 s62, s62, 1
K12_S3_L:
    ds_read_b32 v56, v5
    s_waitcnt lgkmcnt(0)
    v_cmp_gt_u32 vcc, s51, v56
    s_sub_u32 s61, s61, 1
    s_cmp_eq_u32 s61, 0
    s_cbranch_scc1 K12_Q3
    s_cbranch_vccz K12_Q3
    s_branch K12_S3_L
K12_S4:
    s_mov_b32 s61, 16384
    s_add_u32 s62, s62, 1
K12_S4_L:
    ds_read_b32 v52, v5
    s_waitcnt lgkmcnt(0)
    v_cmp_gt_u32 vcc, s40, v52
    s_sub_u32 s61, s61, 1
    s_cmp_eq_u32 s61, 0
    s_cbranch_scc1 K12_Q4
    s_cbranch_vccz K12_Q4
    s_branch K12_S4_L
K12_S5:
    s_mov_b32 s61, 16384
    s_add_u32 s62, s62, 1
K12_S5_L:
    ds_read_b32 v40, v5
    s_waitcnt lgkmcnt(0)
    v_cmp_gt_u32 vcc, s51, v40
    s_sub_u32 s61, s61, 1
    s_cmp_eq_u32 s61, 0
    s_cbranch_scc1 K12_Q5
    s_cbranch_vccz K12_Q5
    s_branch K12_S5_L
K12_S6:
    s_mov_b32 s61, 16384
    s_add_u32 s62, s62, 1
K12_S6_L:
    ds_read_b32 v68, v5
    s_waitcnt lgkmcnt(0)
    v_cmp_gt_u32 vcc, s40, v68
    s_sub_u32 s61, s61, 1
    s_cmp_eq_u32 s61, 0
    s_cbranch_scc1 K12_Q6
    s_cbranch_vccz K12_Q6
    s_branch K12_S6_L
K12_F7:
    s_mov_b32 s61, 16384
    s_add_u32 s63, s63, 1
K12_F7_L:
    s_mov_b32 m0, s46
    s_mov_b64 exec, 0xff
    buffer_load_dword v1, s[4:7], 0 offen sc1 lds
    s_mov_b64 exec, -1
    s_waitcnt vmcnt(0)
    v_mov_b32 v0, s48
    ds_read_b32 v0, v0
    s_waitcnt lgkmcnt(0)
    v_cmp_eq_u32 vcc, 0, v0
    s_sub_u32 s61, s61, 1
    s_cmp_eq_u32 s61, 0
    s_cbranch_scc1 K12_F7_X
    s_cbranch_vccz K12_F7_X
    s_sleep 2
    s_branch K12_F7_L
K12_F7_X:
    s_branch K12_G7
K12_S8:
    s_mov_b32 s61, 16384
    s_add_u32 s62, s62, 1
K12_S8_L:
    ds_read_b32 v56, v5
    s_waitcnt lgkmcnt(0)
    v_cmp_gt_u32 vcc, s51, v56
    s_sub_u32 s61, s61, 1
    s_cmp_eq_u32 s61, 0
    s_cbranch_scc1 K12_Q8
    s_cbranch_vccz K12_Q8
    s_branch K12_S8_L
K12_END:
    s_endpgm
.p2align 8
.type k34_out_kernel,@function
k34_out_kernel:
    s_cmp_ge_u32 s2, 256
    s_cbranch_scc1 K34_END
    s_load_dwordx2 s[4:5], s[0:1], 48
    s_load_dwordx4 s[40:43], s[0:1], 16
    s_load_dwordx2 s[44:45], s[0:1], 32
    v_lshrrev_b32 v1, 6, v0
    v_and_b32 v2, 63, v0
    v_readfirstlane_b32 s3, v1
    s_and_b32 s6, s2, 15
    s_lshr_b32 s7, s2, 4
    s_lshr_b32 s20, s6, 3
    s_and_b32 s21, s6, 7
    s_mul_i32 s22, s7, 11
    s_mul_i32 s23, s7, 10
    s_add_u32 s23, s23, 7
    s_cmp_lt_u32 s7, 7
    s_cselect_b32 s22, s22, s23
    s_cselect_b32 s23, 11, 10
    s_add_u32 s22, s22, s3
    v_and_b32 v3, 15, v2
    v_lshrrev_b32 v4, 4, v2
    v_lshlrev_b32 v5, 4, v2
    s_mov_b32 s24, 2736128
    v_mul_lo_u32 v6, v4, s24
    v_lshl_add_u32 v6, v3, 4, v6
    s_mul_i32 s25, s20, 167
    s_add_u32 s25, s25, s22
    s_lshl_b32 s25, s25, 11
    s_lshl_b32 s24, s21, 8
    s_add_u32 s25, s25, s24
    s_waitcnt lgkmcnt(0)
    s_add_u32 s8, s4, 118489088
    s_addc_u32 s9, s5, 0
    s_and_b32 s9, s9, 0xffff
    s_mov_b32 s10, 21889024
    s_mov_b32 s11, 0x00020000
    s_add_u32 s12, s4, 153616384
    s_addc_u32 s13, s5, 0
    s_and_b32 s13, s13, 0xffff
    s_mov_b32 s14, 131072
    s_mov_b32 s15, 0x00020000
    s_cmp_lt_u32 s3, s23
    s_cbranch_scc0 K34_NOLOAD
    buffer_load_dwordx4 v[16:19], v6, s[8:11], s25 offen
    s_add_u32 s25, s25, 684032
    buffer_load_dwordx4 v[20:23], v6, s[8:11], s25 offen
    s_add_u32 s25, s25, 684032
    buffer_load_dwordx4 v[24:27], v6, s[8:11], s25 offen
    s_add_u32 s25, s25, 684032
    buffer_load_dwordx4 v[28:31], v6, s[8:11], s25 offen
    s_add_u32 s25, s25, 8892416
    buffer_load_dwordx4 v[32:35], v6, s[8:11], s25 offen
    s_add_u32 s25, s25, 684032
    buffer_load_dwordx4 v[36:39], v6, s[8:11], s25 offen
    s_add_u32 s25, s25, 684032
    buffer_load_dwordx4 v[40:43], v6, s[8:11], s25 offen
    s_add_u32 s25, s25, 684032
    buffer_load_dwordx4 v[44:47], v6, s[8:11], s25 offen
K34_NOLOAD:
    s_cmp_lg_u32 s3, 0
    s_cbranch_scc1 K34_TAB
    s_mov_b32 s16, s40
    s_mov_b32 s17, s41
    s_and_b32 s17, s17, 0xffff
    s_mov_b32 s18, 1024
    s_mov_b32 s19, 0x00020000
    s_mov_b32 s28, s42
    s_mov_b32 s29, s43
    s_and_b32 s29, s29, 0xffff
    s_mov_b32 s30, 1024
    s_mov_b32 s31, 0x00020000
    s_lshl_b32 s24, s21, 7
    v_lshlrev_b32 v8, 1, v2
    buffer_load_ushort v152, v8, s[16:19], s24 offen
    buffer_load_ushort v153, v8, s[28:31], s24 offen
    s_branch K34_TABDONE
K34_TAB:
    s_cmp_ge_u32 s3, 7
    s_cbranch_scc1 K34_TABDONE
    s_sub_u32 s27, s3, 1
    s_lshr_b32 s28, s27, 1
    s_and_b32 s29, s27, 1
    s_lshl_b32 s30, s28, 4
    v_add_u32 v8, s30, v3
    s_lshl_b32 s30, s29, 5
    s_add_u32 s30, s30, 1
    v_lshlrev_b32 v9, 3, v4
    v_add_u32 v9, s30, v9
    v_mul_u32_u24 v9, v8, v9
    v_lshlrev_b32 v8, 1, v8
    v_mad_u32_u24 v48, v8, 0, v9
    v_mad_u32_u24 v49, v8, 0, v9
    v_add_u32 v49, 32, v49
    v_mad_u32_u24 v50, v8, 1, v9
    v_mad_u32_u24 v51, v8, 1, v9
    v_add_u32 v51, 32, v51
    v_mad_u32_u24 v52, v8, 2, v9
    v_mad_u32_u24 v53, v8, 2, v9
    v_add_u32 v53, 32, v53
    v_mad_u32_u24 v54, v8, 3, v9
    v_mad_u32_u24 v55, v8, 3, v9
    v_add_u32 v55, 32, v55
    v_and_b32 v48, 127, v48
    v_and_b32 v49, 127, v49
    v_and_b32 v50, 127, v50
    v_and_b32 v51, 127, v51
    v_and_b32 v52, 127, v52
    v_and_b32 v53, 127, v53
    v_and_b32 v54, 127, v54
    v_and_b32 v55, 127, v55
    v_cvt_f32_u32 v48, v48
    v_cvt_f32_u32 v49, v49
    v_cvt_f32_u32 v50, v50
    v_cvt_f32_u32 v51, v51
    v_cvt_f32_u32 v52, v52
    v_cvt_f32_u32 v53, v53
    v_cvt_f32_u32 v54, v54
    v_cvt_f32_u32 v55, v55
    v_mul_f32 v48, 0x3c000000, v48
    v_mul_f32 v49, 0x3c000000, v49
    v_mul_f32 v50, 0x3c000000, v50
    v_mul_f32 v51, 0x3c000000, v51
    v_mul_f32 v52, 0x3c000000, v52
    v_mul_f32 v53, 0x3c000000, v53
    v_mul_f32 v54, 0x3c000000, v54
    v_mul_f32 v55, 0x3c000000, v55
    v_cos_f32 v48, v48
    v_cos_f32 v49, v49
    v_cos_f32 v50, v50
    v_cos_f32 v51, v51
    v_cos_f32 v52, v52
    v_cos_f32 v53, v53
    v_cos_f32 v54, v54
    v_cos_f32 v55, v55
    s_nop 0
    v_mul_f32 v48, 0x3d000000, v48
    v_mul_f32 v49, 0x3d000000, v49
    v_mul_f32 v50, 0x3d000000, v50
    v_mul_f32 v51, 0x3d000000, v51
    v_mul_f32 v52, 0x3d000000, v52
    v_mul_f32 v53, 0x3d000000, v53
    v_mul_f32 v54, 0x3d000000, v54
    v_mul_f32 v55, 0x3d000000, v55
    v_cvt_pk_bf16_f32 v56, v48, v49
    v_cvt_pk_bf16_f32 v57, v50, v51
    v_cvt_pk_bf16_f32 v58, v52, v53
    v_cvt_pk_bf16_f32 v59, v54, v55
    v_lshlrev_b32 v64, 16, v56
    v_and_b32 v65, 0xffff0000, v56
    v_sub_f32 v48, v48, v64
    v_sub_f32 v49, v49, v65
    v_lshlrev_b32 v64, 16, v57
    v_and_b32 v65, 0xffff0000, v57
    v_sub_f32 v50, v50, v64
    v_sub_f32 v51, v51, v65
    v_lshlrev_b32 v64, 16, v58
    v_and_b32 v65, 0xffff0000, v58
    v_sub_f32 v52, v52, v64
    v_sub_f32 v53, v53, v65
    v_lshlrev_b32 v64, 16, v59
    v_and_b32 v65, 0xffff0000, v59
    v_sub_f32 v54, v54, v64
    v_sub_f32 v55, v55, v65
    v_cvt_pk_bf16_f32 v60, v48, v49
    v_cvt_pk_bf16_f32 v61, v50, v51
    v_cvt_pk_bf16_f32 v62, v52, v53
    v_cvt_pk_bf16_f32 v63, v54, v55
    s_lshl_b32 s30, s27, 11
    v_add_u32 v10, s30, v5
    ds_write_b128 v10, v[56:59]
    ds_write_b128 v10, v[60:63] offset:1024
K34_TABDONE:
    s_waitcnt lgkmcnt(0)
    s_barrier
    s_cmp_lt_u32 s3, s23
    s_cbranch_scc0 K34_IDLE
    ds_read_b128 v[48:51], v5 offset:0
    ds_read_b128 v[52:55], v5 offset:1024
    ds_read_b128 v[56:59], v5 offset:2048
    ds_read_b128 v[60:63], v5 offset:3072
    ds_read_b128 v[64:67], v5 offset:4096
    ds_read_b128 v[68:71], v5 offset:5120
    ds_read_b128 v[72:75], v5 offset:6144
    ds_read_b128 v[76:79], v5 offset:7168
    ds_read_b128 v[80:83], v5 offset:8192
    ds_read_b128 v[84:87], v5 offset:9216
    ds_read_b128 v[88:91], v5 offset:10240
    ds_read_b128 v[92:95], v5 offset:11264
    s_waitcnt vmcnt(0)
    v_swap_b32 v17, v20
    v_swap_b32 v18, v24
    v_swap_b32 v19, v28
    v_swap_b32 v22, v25
    v_swap_b32 v23, v29
    v_swap_b32 v27, v30
    v_swap_b32 v33, v36
    v_swap_b32 v34, v40
    v_swap_b32 v35, v44
    v_swap_b32 v38, v41
    v_swap_b32 v39, v45
    v_swap_b32 v43, v46
    s_waitcnt lgkmcnt(0)
    s_mul_i32 s24, s22, 48
    s_sub_u32 s24, 7985, s24
    s_cmp_ge_u32 s24, 48
    s_cbranch_scc1 K34_FULL
    v_add_u32 v7, 0, v3
    v_cmp_gt_u32 vcc, s24, v7
    s_nop 1
    v_cndmask_b32 v48, 0, v48, vcc
    v_cndmask_b32 v49, 0, v49, vcc
    v_cndmask_b32 v50, 0, v50, vcc
    v_cndmask_b32 v51, 0, v51, vcc
    v_cndmask_b32 v52, 0, v52, vcc
    v_cndmask_b32 v53, 0, v53, vcc
    v_cndmask_b32 v54, 0, v54, vcc
    v_cndmask_b32 v55, 0, v55, vcc
    v_cndmask_b32 v56, 0, v56, vcc
    v_cndmask_b32 v57, 0, v57, vcc
    v_cndmask_b32 v58, 0, v58, vcc
    v_cndmask_b32 v59, 0, v59, vcc
    v_cndmask_b32 v60, 0, v60, vcc
    v_cndmask_b32 v61, 0, v61, vcc
    v_cndmask_b32 v62, 0, v62, vcc
    v_cndmask_b32 v63, 0, v63, vcc
    v_add_u32 v7, 16, v3
    v_cmp_gt_u32 vcc, s24, v7
    s_nop 1
    v_cndmask_b32 v64, 0, v64, vcc
    v_cndmask_b32 v65, 0, v65, vcc
    v_cndmask_b32 v66, 0, v66, vcc
    v_cndmask_b32 v67, 0, v67, vcc
    v_cndmask_b32 v68, 0, v68, vcc
    v_cndmask_b32 v69, 0, v69, vcc
    v_cndmask_b32 v70, 0, v70, vcc
    v_cndmask_b32 v71, 0, v71, vcc
    v_cndmask_b32 v72, 0, v72, vcc
    v_cndmask_b32 v73, 0, v73, vcc
    v_cndmask_b32 v74, 0, v74, vcc
    v_cndmask_b32 v75, 0, v75, vcc
    v_cndmask_b32 v76, 0, v76, vcc
    v_cndmask_b32 v77, 0, v77, vcc
    v_cndmask_b32 v78, 0, v78, vcc
    v_cndmask_b32 v79, 0, v79, vcc
    v_add_u32 v7, 32, v3
    v_cmp_gt_u32 vcc, s24, v7
    s_nop 1
    v_cndmask_b32 v80, 0, v80, vcc
    v_cndmask_b32 v81, 0, v81, vcc
    v_cndmask_b32 v82, 0, v82, vcc
    v_cndmask_b32 v83, 0, v83, vcc
    v_cndmask_b32 v84, 0, v84, vcc
    v_cndmask_b32 v85, 0, v85, vcc
    v_cndmask_b32 v86, 0, v86, vcc
    v_cndmask_b32 v87, 0, v87, vcc
    v_cndmask_b32 v88, 0, v88, vcc
    v_cndmask_b32 v89, 0, v89, vcc
    v_cndmask_b32 v90, 0, v90, vcc
    v_cndmask_b32 v91, 0, v91, vcc
    v_cndmask_b32 v92, 0, v92, vcc
    v_cndmask_b32 v93, 0, v93, vcc
    v_cndmask_b32 v94, 0, v94, vcc
    v_cndmask_b32 v95, 0, v95, vcc
K34_FULL:
    s_nop 1
    v_mfma_f32_16x16x32_bf16 v[96:99], v[48:51], v[16:19], 0
    v_mfma_f32_16x16x32_bf16 v[100:103], v[48:51], v[20:23], 0
    v_mfma_f32_16x16x32_bf16 v[104:107], v[48:51], v[24:27], 0
    v_mfma_f32_16x16x32_bf16 v[108:111], v[48:51], v[28:31], 0
    v_mfma_f32_16x16x32_bf16 v[96:99], v[52:55], v[16:19], v[96:99]
    v_mfma_f32_16x16x32_bf16 v[100:103], v[52:55], v[20:23], v[100:103]
    v_mfma_f32_16x16x32_bf16 v[104:107], v[52:55], v[24:27], v[104:107]
    v_mfma_f32_16x16x32_bf16 v[108:111], v[52:55], v[28:31], v[108:111]
    v_mfma_f32_16x16x32_bf16 v[96:99], v[56:59], v[32:35], v[96:99]
    v_mfma_f32_16x16x32_bf16 v[100:103], v[56:59], v[36:39], v[100:103]
    v_mfma_f32_16x16x32_bf16 v[104:107], v[56:59], v[40:43], v[104:107]
    v_mfma_f32_16x16x32_bf16 v[108:111], v[56:59], v[44:47], v[108:111]
    v_mfma_f32_16x16x32_bf16 v[96:99], v[60:63], v[32:35], v[96:99]
    v_mfma_f32_16x16x32_bf16 v[100:103], v[60:63], v[36:39], v[100:103]
    v_mfma_f32_16x16x32_bf16 v[104:107], v[60:63], v[40:43], v[104:107]
    v_mfma_f32_16x16x32_bf16 v[108:111], v[60:63], v[44:47], v[108:111]
    v_mfma_f32_16x16x32_bf16 v[112:115], v[64:67], v[16:19], 0
    v_mfma_f32_16x16x32_bf16 v[116:119], v[64:67], v[20:23], 0
    v_mfma_f32_16x16x32_bf16 v[120:123], v[64:67], v[24:27], 0
    v_mfma_f32_16x16x32_bf16 v[124:127], v[64:67], v[28:31], 0
    v_mfma_f32_16x16x32_bf16 v[112:115], v[68:71], v[16:19], v[112:115]
    v_mfma_f32_16x16x32_bf16 v[116:119], v[68:71], v[20:23], v[116:119]
    v_mfma_f32_16x16x32_bf16 v[120:123], v[68:71], v[24:27], v[120:123]
    v_mfma_f32_16x16x32_bf16 v[124:127], v[68:71], v[28:31], v[124:127]
    v_mfma_f32_16x16x32_bf16 v[112:115], v[72:75], v[32:35], v[112:115]
    v_mfma_f32_16x16x32_bf16 v[116:119], v[72:75], v[36:39], v[116:119]
    v_mfma_f32_16x16x32_bf16 v[120:123], v[72:75], v[40:43], v[120:123]
    v_mfma_f32_16x16x32_bf16 v[124:127], v[72:75], v[44:47], v[124:127]
    v_mfma_f32_16x16x32_bf16 v[112:115], v[76:79], v[32:35], v[112:115]
    v_mfma_f32_16x16x32_bf16 v[116:119], v[76:79], v[36:39], v[116:119]
    v_mfma_f32_16x16x32_bf16 v[120:123], v[76:79], v[40:43], v[120:123]
    v_mfma_f32_16x16x32_bf16 v[124:127], v[76:79], v[44:47], v[124:127]
    v_mfma_f32_16x16x32_bf16 v[128:131], v[80:83], v[16:19], 0
    v_mfma_f32_16x16x32_bf16 v[132:135], v[80:83], v[20:23], 0
    v_mfma_f32_16x16x32_bf16 v[136:139], v[80:83], v[24:27], 0
    v_mfma_f32_16x16x32_bf16 v[140:143], v[80:83], v[28:31], 0
    v_mfma_f32_16x16x32_bf16 v[128:131], v[84:87], v[16:19], v[128:131]
    v_mfma_f32_16x16x32_bf16 v[132:135], v[84:87], v[20:23], v[132:135]
    v_mfma_f32_16x16x32_bf16 v[136:139], v[84:87], v[24:27], v[136:139]
    v_mfma_f32_16x16x32_bf16 v[140:143], v[84:87], v[28:31], v[140:143]
    v_mfma_f32_16x16x32_bf16 v[128:131], v[88:91], v[32:35], v[128:131]
    v_mfma_f32_16x16x32_bf16 v[132:135], v[88:91], v[36:39], v[132:135]
    v_mfma_f32_16x16x32_bf16 v[136:139], v[88:91], v[40:43], v[136:139]
    v_mfma_f32_16x16x32_bf16 v[140:143], v[88:91], v[44:47], v[140:143]
    v_mfma_f32_16x16x32_bf16 v[128:131], v[92:95], v[32:35], v[128:131]
    v_mfma_f32_16x16x32_bf16 v[132:135], v[92:95], v[36:39], v[132:135]
    v_mfma_f32_16x16x32_bf16 v[136:139], v[92:95], v[40:43], v[136:139]
    v_mfma_f32_16x16x32_bf16 v[140:143], v[92:95], v[44:47], v[140:143]
    s_nop 7
    v_mov_b32 v16, v96
    v_mul_f32 v20, v96, v96
    v_mov_b32 v17, v100
    v_mul_f32 v21, v100, v100
    v_mov_b32 v18, v104
    v_mul_f32 v22, v104, v104
    v_mov_b32 v19, v108
    v_mul_f32 v23, v108, v108
    v_add_f32 v16, v16, v97
    v_fmac_f32 v20, v97, v97
    v_add_f32 v17, v17, v101
    v_fmac_f32 v21, v101, v101
    v_add_f32 v18, v18, v105
    v_fmac_f32 v22, v105, v105
    v_add_f32 v19, v19, v109
    v_fmac_f32 v23, v109, v109
    v_add_f32 v16, v16, v98
    v_fmac_f32 v20, v98, v98
    v_add_f32 v17, v17, v102
    v_fmac_f32 v21, v102, v102
    v_add_f32 v18, v18, v106
    v_fmac_f32 v22, v106, v106
    v_add_f32 v19, v19, v110
    v_fmac_f32 v23, v110, v110
    v_add_f32 v16, v16, v99
    v_fmac_f32 v20, v99, v99
    v_add_f32 v17, v17, v103
    v_fmac_f32 v21, v103, v103
    v_add_f32 v18, v18, v107
    v_fmac_f32 v22, v107, v107
    v_add_f32 v19, v19, v111
    v_fmac_f32 v23, v111, v111
    v_add_f32 v16, v16, v112
    v_fmac_f32 v20, v112, v112
    v_add_f32 v17, v17, v116
    v_fmac_f32 v21, v116, v116
    v_add_f32 v18, v18, v120
    v_fmac_f32 v22, v120, v120
    v_add_f32 v19, v19, v124
    v_fmac_f32 v23, v124, v124
    v_add_f32 v16, v16, v113
    v_fmac_f32 v20, v113, v113
    v_add_f32 v17, v17, v117
    v_fmac_f32 v21, v117, v117
    v_add_f32 v18, v18, v121
    v_fmac_f32 v22, v121, v121
    v_add_f32 v19, v19, v125
    v_fmac_f32 v23, v125, v125
    v_add_f32 v16, v16, v114
    v_fmac_f32 v20, v114, v114
    v_add_f32 v17, v17, v118
    v_fmac_f32 v21, v118, v118
    v_add_f32 v18, v18, v122
    v_fmac_f32 v22, v122, v122
    v_add_f32 v19, v19, v126
    v_fmac_f32 v23, v126, v126
    v_add_f32 v16, v16, v115
    v_fmac_f32 v20, v115, v115
    v_add_f32 v17, v17, v119
    v_fmac_f32 v21, v119, v119
    v_add_f32 v18, v18, v123
    v_fmac_f32 v22, v123, v123
    v_add_f32 v19, v19, v127
    v_fmac_f32 v23, v127, v127
    v_add_f32 v16, v16, v128
    v_fmac_f32 v20, v128, v128
    v_add_f32 v17, v17, v132
    v_fmac_f32 v21, v132, v132
    v_add_f32 v18, v18, v136
    v_fmac_f32 v22, v136, v136
    v_add_f32 v19, v19, v140
    v_fmac_f32 v23, v140, v140
    v_add_f32 v16, v16, v129
    v_fmac_f32 v20, v129, v129
    v_add_f32 v17, v17, v133
    v_fmac_f32 v21, v133, v133
    v_add_f32 v18, v18, v137
    v_fmac_f32 v22, v137, v137
    v_add_f32 v19, v19, v141
    v_fmac_f32 v23, v141, v141
    v_add_f32 v16, v16, v130
    v_fmac_f32 v20, v130, v130
    v_add_f32 v17, v17, v134
    v_fmac_f32 v21, v134, v134
    v_add_f32 v18, v18, v138
    v_fmac_f32 v22, v138, v138
    v_add_f32 v19, v19, v142
    v_fmac_f32 v23, v142, v142
    v_add_f32 v16, v16, v131
    v_fmac_f32 v20, v131, v131
    v_add_f32 v17, v17, v135
    v_fmac_f32 v21, v135, v135
    v_add_f32 v18, v18, v139
    v_fmac_f32 v22, v139, v139
    v_add_f32 v19, v19, v143
    v_fmac_f32 v23, v143, v143
    v_mov_b32 v24, v16
    v_mov_b32 v25, v17
    v_mov_b32 v26, v18
    v_mov_b32 v27, v19
    v_mov_b32 v28, v20
    v_mov_b32 v29, v21
    v_mov_b32 v30, v22
    v_mov_b32 v31, v23
    s_nop 0
    v_permlane32_swap_b32 v16, v24
    v_permlane32_swap_b32 v17, v25
    v_permlane32_swap_b32 v18, v26
    v_permlane32_swap_b32 v19, v27
    v_permlane32_swap_b32 v20, v28
    v_permlane32_swap_b32 v21, v29
    v_permlane32_swap_b32 v22, v30
    v_permlane32_swap_b32 v23, v31
    v_add_f32 v16, v16, v24
    v_add_f32 v17, v17, v25
    v_add_f32 v18, v18, v26
    v_add_f32 v19, v19, v27
    v_add_f32 v20, v20, v28
    v_add_f32 v21, v21, v29
    v_add_f32 v22, v22, v30
    v_add_f32 v23, v23, v31
    v_mov_b32 v24, v16
    v_mov_b32 v25, v17
    v_mov_b32 v26, v18
    v_mov_b32 v27, v19
    v_mov_b32 v28, v20
    v_mov_b32 v29, v21
    v_mov_b32 v30, v22
    v_mov_b32 v31, v23
    s_nop 0
    v_permlane16_swap_b32 v16, v24
    v_permlane16_swap_b32 v17, v25
    v_permlane16_swap_b32 v18, v26
    v_permlane16_swap_b32 v19, v27
    v_permlane16_swap_b32 v20, v28
    v_permlane16_swap_b32 v21, v29
    v_permlane16_swap_b32 v22, v30
    v_permlane16_swap_b32 v23, v31
    v_add_f32 v16, v16, v24
    v_add_f32 v17, v17, v25
    v_add_f32 v18, v18, v26
    v_add_f32 v19, v19, v27
    v_add_f32 v20, v20, v28
    v_add_f32 v21, v21, v29
    v_add_f32 v22, v22, v30
    v_add_f32 v23, v23, v31
    s_branch K34_WR
K34_IDLE:
    v_mov_b32 v16, 0
    v_mov_b32 v17, 0
    v_mov_b32 v18, 0
    v_mov_b32 v19, 0
    v_mov_b32 v20, 0
    v_mov_b32 v21, 0
    v_mov_b32 v22, 0
    v_mov_b32 v23, 0
K34_WR:
    s_lshl_b32 s24, s3, 9
    v_lshlrev_b32 v7, 4, v3
    v_add_u32 v7, s24, v7
    ds_write_b128 v7, v[16:19] offset:12288
    ds_write_b128 v7, v[20:23] offset:12544
    s_waitcnt lgkmcnt(0)
    s_barrier
    s_cmp_lg_u32 s3, 0
    s_cbranch_scc1 K34_WAIT
    v_lshlrev_b32 v7, 2, v2
    ds_read_b32 v16, v7 offset:12288
    ds_read_b32 v17, v7 offset:12800
    ds_read_b32 v18, v7 offset:13312
    ds_read_b32 v19, v7 offset:13824
    ds_read_b32 v20, v7 offset:14336
    ds_read_b32 v21, v7 offset:14848
    ds_read_b32 v22, v7 offset:15360
    ds_read_b32 v23, v7 offset:15872
    ds_read_b32 v24, v7 offset:16384
    ds_read_b32 v25, v7 offset:16896
    ds_read_b32 v26, v7 offset:17408
    ds_read_b32 v27, v7 offset:17920
    s_waitcnt lgkmcnt(0)
    ds_read_b32 v32, v7 offset:12544
    ds_read_b32 v33, v7 offset:13056
    ds_read_b32 v34, v7 offset:13568
    ds_read_b32 v35, v7 offset:14080
    ds_read_b32 v36, v7 offset:14592
    ds_read_b32 v37, v7 offset:15104
    ds_read_b32 v38, v7 offset:15616
    ds_read_b32 v39, v7 offset:16128
    ds_read_b32 v40, v7 offset:16640
    ds_read_b32 v41, v7 offset:17152
    ds_read_b32 v42, v7 offset:17664
    ds_read_b32 v43, v7 offset:18176
    v_add_f32 v16, v16, v17
    v_add_f32 v16, v16, v18
    v_add_f32 v16, v16, v19
    v_add_f32 v16, v16, v20
    v_add_f32 v16, v16, v21
    v_add_f32 v16, v16, v22
    v_add_f32 v16, v16, v23
    v_add_f32 v16, v16, v24
    v_add_f32 v16, v16, v25
    v_add_f32 v16, v16, v26
    v_add_f32 v16, v16, v27
    s_waitcnt lgkmcnt(0)
    v_add_f32 v32, v32, v33
    v_add_f32 v32, v32, v34
    v_add_f32 v32, v32, v35
    v_add_f32 v32, v32, v36
    v_add_f32 v32, v32, v37
    v_add_f32 v32, v32, v38
    v_add_f32 v32, v32, v39
    v_add_f32 v32, v32, v40
    v_add_f32 v32, v32, v41
    v_add_f32 v32, v32, v42
    v_add_f32 v32, v32, v43
    s_lshl_b32 s24, s6, 4
    s_add_u32 s24, s24, s7
    s_lshl_b32 s24, s24, 9
    buffer_store_dword v16, v7, s[12:15], s24 offen sc1
    buffer_store_dword v32, v7, s[12:15], s24 offen offset:256 sc1
    s_mov_b32 s26, 20000
K34_POLL:
    s_lshl_b32 s24, s6, 13
    buffer_load_dword v16, v7, s[12:15], s24 offen offset:0 sc1
    buffer_load_dword v32, v7, s[12:15], s24 offen offset:256 sc1
    buffer_load_dword v17, v7, s[12:15], s24 offen offset:512 sc1
    buffer_load_dword v33, v7, s[12:15], s24 offen offset:768 sc1
    buffer_load_dword v18, v7, s[12:15], s24 offen offset:1024 sc1
    buffer_load_dword v34, v7, s[12:15], s24 offen offset:1280 sc1
    buffer_load_dword v19, v7, s[12:15], s24 offen offset:1536 sc1
    buffer_load_dword v35, v7, s[12:15], s24 offen offset:1792 sc1
    buffer_load_dword v20, v7, s[12:15], s24 offen offset:2048 sc1
    buffer_load_dword v36, v7, s[12:15], s24 offen offset:2304 sc1
    buffer_load_dword v21, v7, s[12:15], s24 offen offset:2560 sc1
    buffer_load_dword v37, v7, s[12:15], s24 offen offset:2816 sc1
    buffer_load_dword v22, v7, s[12:15], s24 offen offset:3072 sc1
    buffer_load_dword v38, v7, s[12:15], s24 offen offset:3328 sc1
    buffer_load_dword v23, v7, s[12:15], s24 offen offset:3584 sc1
    buffer_load_dword v39, v7, s[12:15], s24 offen offset:3840 sc1
    s_add_u32 s24, s24, 4096
    buffer_load_dword v24, v7, s[12:15], s24 offen offset:0 sc1
    buffer_load_dword v40, v7, s[12:15], s24 offen offset:256 sc1
    buffer_load_dword v25, v7, s[12:15], s24 offen offset:512 sc1
    buffer_load_dword v41, v7, s[12:15], s24 offen offset:768 sc1
    buffer_load_dword v26, v7, s[12:15], s24 offen offset:1024 sc1
    buffer_load_dword v42, v7, s[12:15], s24 offen offset:1280 sc1
    buffer_load_dword v27, v7, s[12:15], s24 offen offset:1536 sc1
    buffer_load_dword v43, v7, s[12:15], s24 offen offset:1792 sc1
    buffer_load_dword v28, v7, s[12:15], s24 offen offset:2048 sc1
    buffer_load_dword v44, v7, s[12:15], s24 offen offset:2304 sc1
    buffer_load_dword v29, v7, s[12:15], s24 offen offset:2560 sc1
    buffer_load_dword v45, v7, s[12:15], s24 offen offset:2816 sc1
    buffer_load_dword v30, v7, s[12:15], s24 offen offset:3072 sc1
    buffer_load_dword v46, v7, s[12:15], s24 offen offset:3328 sc1
    buffer_load_dword v31, v7, s[12:15], s24 offen offset:3584 sc1
    buffer_load_dword v47, v7, s[12:15], s24 offen offset:3840 sc1
    s_waitcnt vmcnt(0)
    v_max3_u32 v48, v16, v17, v18
    v_max3_u32 v48, v48, v19, v20
    v_max3_u32 v48, v48, v21, v22
    v_max3_u32 v48, v48, v23, v24
    v_max3_u32 v48, v48, v25, v26
    v_max3_u32 v48, v48, v27, v28
    v_max3_u32 v48, v48, v29, v30
    v_max3_u32 v48, v48, v31, v32
    v_max3_u32 v48, v48, v33, v34
    v_max3_u32 v48, v48, v35, v36
    v_max3_u32 v48, v48, v37, v38
    v_max3_u32 v48, v48, v39, v40
    v_max3_u32 v48, v48, v41, v42
    v_max3_u32 v48, v48, v43, v44
    v_max3_u32 v48, v48, v45, v46
    v_max_u32 v48, v48, v47
    v_cmp_eq_u32 vcc, -1, v48
    s_sub_u32 s26, s26, 1
    s_cmp_eq_u32 s26, 0
    s_cbranch_scc1 K34_GOT
    s_cbranch_vccz K34_GOT
    s_sleep 1
    s_branch K34_POLL
K34_GOT:
    v_add_f32 v16, v16, v24
    v_add_f32 v32, v32, v40
    v_add_f32 v17, v17, v25
    v_add_f32 v33, v33, v41
    v_add_f32 v18, v18, v26
    v_add_f32 v34, v34, v42
    v_add_f32 v19, v19, v27
    v_add_f32 v35, v35, v43
    v_add_f32 v20, v20, v28
    v_add_f32 v36, v36, v44
    v_add_f32 v21, v21, v29
    v_add_f32 v37, v37, v45
    v_add_f32 v22, v22, v30
    v_add_f32 v38, v38, v46
    v_add_f32 v23, v23, v31
    v_add_f32 v39, v39, v47
    v_add_f32 v16, v16, v20
    v_add_f32 v32, v32, v36
    v_add_f32 v17, v17, v21
    v_add_f32 v33, v33, v37
    v_add_f32 v18, v18, v22
    v_add_f32 v34, v34, v38
    v_add_f32 v19, v19, v23
    v_add_f32 v35, v35, v39
    v_add_f32 v16, v16, v18
    v_add_f32 v32, v32, v34
    v_add_f32 v17, v17, v19
    v_add_f32 v33, v33, v35
    v_add_f32 v16, v16, v17
    v_add_f32 v32, v32, v33
    v_mul_f32 v11, 0x39035177, v16
    v_mul_f32 v12, 0x39035177, v32
    v_fma_f32 v12, -v11, v11, v12
    v_max_f32 v12, 0, v12
    v_add_f32 v12, 0x3727c5ac, v12
    v_sqrt_f32 v12, v12
    v_lshlrev_b32 v9, 16, v152
    v_rcp_f32 v12, v12
    v_lshlrev_b32 v10, 16, v153
    v_mul_f32 v9, v9, v12
    v_fma_f32 v10, -v11, v9, v10
    ds_write_b32 v7, v9 offset:18432
    ds_write_b32 v7, v10 offset:18688
    s_waitcnt lgkmcnt(0)
K34_WAIT:
    s_barrier
    s_cmp_lt_u32 s3, s23
    s_cbranch_scc0 K34_END
    v_lshlrev_b32 v7, 4, v3
    ds_read_b128 v[144:147], v7 offset:18432
    ds_read_b128 v[148:151], v7 offset:18688
    s_mul_i32 s24, s20, 8176640
    s_add_u32 s16, s44, s24
    s_addc_u32 s17, s45, 0
    s_and_b32 s17, s17, 0xffff
    s_mov_b32 s18, 8176640
    s_mov_b32 s19, 0x00020000
    v_lshlrev_b32 v7, 12, v4
    v_lshl_add_u32 v7, v3, 3, v7
    s_lshl_b32 s24, s21, 7
    v_add_u32 v7, s24, v7
    s_mul_i32 s25, s22, 49152
    s_mov_b32 s30, 0xc0135761
    s_mov_b32 s31, 0xbdd2d3e8
    v_mov_b32 v15, s30
    s_waitcnt lgkmcnt(0)
    v_fma_f32 v16, v96, v144, v148
    v_fma_f32 v17, v100, v145, v149
    v_fma_f32 v18, v104, v146, v150
    v_fma_f32 v19, v108, v147, v151
    v_fma_f32 v20, v97, v144, v148
    v_fma_f32 v21, v101, v145, v149
    v_fma_f32 v22, v105, v146, v150
    v_fma_f32 v23, v109, v147, v151
    v_mul_f32 v24, v16, v16
    v_mul_f32 v25, v17, v17
    v_mul_f32 v26, v18, v18
    v_mul_f32 v27, v19, v19
    v_mul_f32 v28, v20, v20
    v_mul_f32 v29, v21, v21
    v_mul_f32 v30, v22, v22
    v_mul_f32 v31, v23, v23
    v_fma_f32 v24, v24, s31, v15
    v_fma_f32 v25, v25, s31, v15
    v_fma_f32 v26, v26, s31, v15
    v_fma_f32 v27, v27, s31, v15
    v_fma_f32 v28, v28, s31, v15
    v_fma_f32 v29, v29, s31, v15
    v_fma_f32 v30, v30, s31, v15
    v_fma_f32 v31, v31, s31, v15
    v_mul_f32 v24, v24, v16
    v_mul_f32 v25, v25, v17
    v_mul_f32 v26, v26, v18
    v_mul_f32 v27, v27, v19
    v_mul_f32 v28, v28, v20
    v_mul_f32 v29, v29, v21
    v_mul_f32 v30, v30, v22
    v_mul_f32 v31, v31, v23
    v_exp_f32 v24, v24
    v_exp_f32 v25, v25
    v_exp_f32 v26, v26
    v_exp_f32 v27, v27
    v_exp_f32 v28, v28
    v_exp_f32 v29, v29
    v_exp_f32 v30, v30
    v_exp_f32 v31, v31
    v_add_f32 v24, 1.0, v24
    v_add_f32 v25, 1.0, v25
    v_add_f32 v26, 1.0, v26
    v_add_f32 v27, 1.0, v27
    v_add_f32 v28, 1.0, v28
    v_add_f32 v29, 1.0, v29
    v_add_f32 v30, 1.0, v30
    v_add_f32 v31, 1.0, v31
    v_rcp_f32 v24, v24
    v_rcp_f32 v25, v25
    v_rcp_f32 v26, v26
    v_rcp_f32 v27, v27
    v_rcp_f32 v28, v28
    v_rcp_f32 v29, v29
    v_rcp_f32 v30, v30
    v_rcp_f32 v31, v31
    v_mul_f32 v16, v16, v24
    v_mul_f32 v17, v17, v25
    v_mul_f32 v18, v18, v26
    v_mul_f32 v19, v19, v27
    v_mul_f32 v20, v20, v28
    v_mul_f32 v21, v21, v29
    v_mul_f32 v22, v22, v30
    v_mul_f32 v23, v23, v31
    v_cvt_pk_bf16_f32 v32, v16, v17
    v_cvt_pk_bf16_f32 v33, v18, v19
    buffer_store_dwordx2 v[32:33], v7, s[16:19], s25 offen offset:0 sc1
    v_cvt_pk_bf16_f32 v34, v20, v21
    v_cvt_pk_bf16_f32 v35, v22, v23
    buffer_store_dwordx2 v[34:35], v7, s[16:19], s25 offen offset:1024 sc1
    s_add_u32 s25, s25, 2048
    v_fma_f32 v36, v98, v144, v148
    v_fma_f32 v37, v102, v145, v149
    v_fma_f32 v38, v106, v146, v150
    v_fma_f32 v39, v110, v147, v151
    v_fma_f32 v40, v99, v144, v148
    v_fma_f32 v41, v103, v145, v149
    v_fma_f32 v42, v107, v146, v150
    v_fma_f32 v43, v111, v147, v151
    v_mul_f32 v44, v36, v36
    v_mul_f32 v45, v37, v37
    v_mul_f32 v46, v38, v38
    v_mul_f32 v47, v39, v39
    v_mul_f32 v48, v40, v40
    v_mul_f32 v49, v41, v41
    v_mul_f32 v50, v42, v42
    v_mul_f32 v51, v43, v43
    v_fma_f32 v44, v44, s31, v15
    v_fma_f32 v45, v45, s31, v15
    v_fma_f32 v46, v46, s31, v15
    v_fma_f32 v47, v47, s31, v15
    v_fma_f32 v48, v48, s31, v15
    v_fma_f32 v49, v49, s31, v15
    v_fma_f32 v50, v50, s31, v15
    v_fma_f32 v51, v51, s31, v15
    v_mul_f32 v44, v44, v36
    v_mul_f32 v45, v45, v37
    v_mul_f32 v46, v46, v38
    v_mul_f32 v47, v47, v39
    v_mul_f32 v48, v48, v40
    v_mul_f32 v49, v49, v41
    v_mul_f32 v50, v50, v42
    v_mul_f32 v51, v51, v43
    v_exp_f32 v44, v44
    v_exp_f32 v45, v45
    v_exp_f32 v46, v46
    v_exp_f32 v47, v47
    v_exp_f32 v48, v48
    v_exp_f32 v49, v49
    v_exp_f32 v50, v50
    v_exp_f32 v51, v51
    v_add_f32 v44, 1.0, v44
    v_add_f32 v45, 1.0, v45
    v_add_f32 v46, 1.0, v46
    v_add_f32 v47, 1.0, v47
    v_add_f32 v48, 1.0, v48
    v_add_f32 v49, 1.0, v49
    v_add_f32 v50, 1.0, v50
    v_add_f32 v51, 1.0, v51
    v_rcp_f32 v44, v44
    v_rcp_f32 v45, v45
    v_rcp_f32 v46, v46
    v_rcp_f32 v47, v47
    v_rcp_f32 v48, v48
    v_rcp_f32 v49, v49
    v_rcp_f32 v50, v50
    v_rcp_f32 v51, v51
    v_mul_f32 v36, v36, v44
    v_mul_f32 v37, v37, v45
    v_mul_f32 v38, v38, v46
    v_mul_f32 v39, v39, v47
    v_mul_f32 v40, v40, v48
    v_mul_f32 v41, v41, v49
    v_mul_f32 v42, v42, v50
    v_mul_f32 v43, v43, v51
    v_cvt_pk_bf16_f32 v52, v36, v37
    v_cvt_pk_bf16_f32 v53, v38, v39
    buffer_store_dwordx2 v[52:53], v7, s[16:19], s25 offen offset:0 sc1
    v_cvt_pk_bf16_f32 v54, v40, v41
    v_cvt_pk_bf16_f32 v55, v42, v43
    buffer_store_dwordx2 v[54:55], v7, s[16:19], s25 offen offset:1024 sc1
    s_add_u32 s25, s25, 2048
    s_add_u32 s25, s25, 12288
    v_fma_f32 v16, v112, v144, v148
    v_fma_f32 v17, v116, v145, v149
    v_fma_f32 v18, v120, v146, v150
    v_fma_f32 v19, v124, v147, v151
    v_fma_f32 v20, v113, v144, v148
    v_fma_f32 v21, v117, v145, v149
    v_fma_f32 v22, v121, v146, v150
    v_fma_f32 v23, v125, v147, v151
    v_mul_f32 v24, v16, v16
    v_mul_f32 v25, v17, v17
    v_mul_f32 v26, v18, v18
    v_mul_f32 v27, v19, v19
    v_mul_f32 v28, v20, v20
    v_mul_f32 v29, v21, v21
    v_mul_f32 v30, v22, v22
    v_mul_f32 v31, v23, v23
    v_fma_f32 v24, v24, s31, v15
    v_fma_f32 v25, v25, s31, v15
    v_fma_f32 v26, v26, s31, v15
    v_fma_f32 v27, v27, s31, v15
    v_fma_f32 v28, v28, s31, v15
    v_fma_f32 v29, v29, s31, v15
    v_fma_f32 v30, v30, s31, v15
    v_fma_f32 v31, v31, s31, v15
    v_mul_f32 v24, v24, v16
    v_mul_f32 v25, v25, v17
    v_mul_f32 v26, v26, v18
    v_mul_f32 v27, v27, v19
    v_mul_f32 v28, v28, v20
    v_mul_f32 v29, v29, v21
    v_mul_f32 v30, v30, v22
    v_mul_f32 v31, v31, v23
    v_exp_f32 v24, v24
    v_exp_f32 v25, v25
    v_exp_f32 v26, v26
    v_exp_f32 v27, v27
    v_exp_f32 v28, v28
    v_exp_f32 v29, v29
    v_exp_f32 v30, v30
    v_exp_f32 v31, v31
    v_add_f32 v24, 1.0, v24
    v_add_f32 v25, 1.0, v25
    v_add_f32 v26, 1.0, v26
    v_add_f32 v27, 1.0, v27
    v_add_f32 v28, 1.0, v28
    v_add_f32 v29, 1.0, v29
    v_add_f32 v30, 1.0, v30
    v_add_f32 v31, 1.0, v31
    v_rcp_f32 v24, v24
    v_rcp_f32 v25, v25
    v_rcp_f32 v26, v26
    v_rcp_f32 v27, v27
    v_rcp_f32 v28, v28
    v_rcp_f32 v29, v29
    v_rcp_f32 v30, v30
    v_rcp_f32 v31, v31
    v_mul_f32 v16, v16, v24
    v_mul_f32 v17, v17, v25
    v_mul_f32 v18, v18, v26
    v_mul_f32 v19, v19, v27
    v_mul_f32 v20, v20, v28
    v_mul_f32 v21, v21, v29
    v_mul_f32 v22, v22, v30
    v_mul_f32 v23, v23, v31
    v_cvt_pk_bf16_f32 v32, v16, v17
    v_cvt_pk_bf16_f32 v33, v18, v19
    buffer_store_dwordx2 v[32:33], v7, s[16:19], s25 offen offset:0 sc1
    v_cvt_pk_bf16_f32 v34, v20, v21
    v_cvt_pk_bf16_f32 v35, v22, v23
    buffer_store_dwordx2 v[34:35], v7, s[16:19], s25 offen offset:1024 sc1
    s_add_u32 s25, s25, 2048
    v_fma_f32 v36, v114, v144, v148
    v_fma_f32 v37, v118, v145, v149
    v_fma_f32 v38, v122, v146, v150
    v_fma_f32 v39, v126, v147, v151
    v_fma_f32 v40, v115, v144, v148
    v_fma_f32 v41, v119, v145, v149
    v_fma_f32 v42, v123, v146, v150
    v_fma_f32 v43, v127, v147, v151
    v_mul_f32 v44, v36, v36
    v_mul_f32 v45, v37, v37
    v_mul_f32 v46, v38, v38
    v_mul_f32 v47, v39, v39
    v_mul_f32 v48, v40, v40
    v_mul_f32 v49, v41, v41
    v_mul_f32 v50, v42, v42
    v_mul_f32 v51, v43, v43
    v_fma_f32 v44, v44, s31, v15
    v_fma_f32 v45, v45, s31, v15
    v_fma_f32 v46, v46, s31, v15
    v_fma_f32 v47, v47, s31, v15
    v_fma_f32 v48, v48, s31, v15
    v_fma_f32 v49, v49, s31, v15
    v_fma_f32 v50, v50, s31, v15
    v_fma_f32 v51, v51, s31, v15
    v_mul_f32 v44, v44, v36
    v_mul_f32 v45, v45, v37
    v_mul_f32 v46, v46, v38
    v_mul_f32 v47, v47, v39
    v_mul_f32 v48, v48, v40
    v_mul_f32 v49, v49, v41
    v_mul_f32 v50, v50, v42
    v_mul_f32 v51, v51, v43
    v_exp_f32 v44, v44
    v_exp_f32 v45, v45
    v_exp_f32 v46, v46
    v_exp_f32 v47, v47
    v_exp_f32 v48, v48
    v_exp_f32 v49, v49
    v_exp_f32 v50, v50
    v_exp_f32 v51, v51
    v_add_f32 v44, 1.0, v44
    v_add_f32 v45, 1.0, v45
    v_add_f32 v46, 1.0, v46
    v_add_f32 v47, 1.0, v47
    v_add_f32 v48, 1.0, v48
    v_add_f32 v49, 1.0, v49
    v_add_f32 v50, 1.0, v50
    v_add_f32 v51, 1.0, v51
    v_rcp_f32 v44, v44
    v_rcp_f32 v45, v45
    v_rcp_f32 v46, v46
    v_rcp_f32 v47, v47
    v_rcp_f32 v48, v48
    v_rcp_f32 v49, v49
    v_rcp_f32 v50, v50
    v_rcp_f32 v51, v51
    v_mul_f32 v36, v36, v44
    v_mul_f32 v37, v37, v45
    v_mul_f32 v38, v38, v46
    v_mul_f32 v39, v39, v47
    v_mul_f32 v40, v40, v48
    v_mul_f32 v41, v41, v49
    v_mul_f32 v42, v42, v50
    v_mul_f32 v43, v43, v51
    v_cvt_pk_bf16_f32 v52, v36, v37
    v_cvt_pk_bf16_f32 v53, v38, v39
    buffer_store_dwordx2 v[52:53], v7, s[16:19], s25 offen offset:0 sc1
    v_cvt_pk_bf16_f32 v54, v40, v41
    v_cvt_pk_bf16_f32 v55, v42, v43
    buffer_store_dwordx2 v[54:55], v7, s[16:19], s25 offen offset:1024 sc1
    s_add_u32 s25, s25, 2048
    s_add_u32 s25, s25, 12288
    v_fma_f32 v16, v128, v144, v148
    v_fma_f32 v17, v132, v145, v149
    v_fma_f32 v18, v136, v146, v150
    v_fma_f32 v19, v140, v147, v151
    v_fma_f32 v20, v129, v144, v148
    v_fma_f32 v21, v133, v145, v149
    v_fma_f32 v22, v137, v146, v150
    v_fma_f32 v23, v141, v147, v151
    v_mul_f32 v24, v16, v16
    v_mul_f32 v25, v17, v17
    v_mul_f32 v26, v18, v18
    v_mul_f32 v27, v19, v19
    v_mul_f32 v28, v20, v20
    v_mul_f32 v29, v21, v21
    v_mul_f32 v30, v22, v22
    v_mul_f32 v31, v23, v23
    v_fma_f32 v24, v24, s31, v15
    v_fma_f32 v25, v25, s31, v15
    v_fma_f32 v26, v26, s31, v15
    v_fma_f32 v27, v27, s31, v15
    v_fma_f32 v28, v28, s31, v15
    v_fma_f32 v29, v29, s31, v15
    v_fma_f32 v30, v30, s31, v15
    v_fma_f32 v31, v31, s31, v15
    v_mul_f32 v24, v24, v16
    v_mul_f32 v25, v25, v17
    v_mul_f32 v26, v26, v18
    v_mul_f32 v27, v27, v19
    v_mul_f32 v28, v28, v20
    v_mul_f32 v29, v29, v21
    v_mul_f32 v30, v30, v22
    v_mul_f32 v31, v31, v23
    v_exp_f32 v24, v24
    v_exp_f32 v25, v25
    v_exp_f32 v26, v26
    v_exp_f32 v27, v27
    v_exp_f32 v28, v28
    v_exp_f32 v29, v29
    v_exp_f32 v30, v30
    v_exp_f32 v31, v31
    v_add_f32 v24, 1.0, v24
    v_add_f32 v25, 1.0, v25
    v_add_f32 v26, 1.0, v26
    v_add_f32 v27, 1.0, v27
    v_add_f32 v28, 1.0, v28
    v_add_f32 v29, 1.0, v29
    v_add_f32 v30, 1.0, v30
    v_add_f32 v31, 1.0, v31
    v_rcp_f32 v24, v24
    v_rcp_f32 v25, v25
    v_rcp_f32 v26, v26
    v_rcp_f32 v27, v27
    v_rcp_f32 v28, v28
    v_rcp_f32 v29, v29
    v_rcp_f32 v30, v30
    v_rcp_f32 v31, v31
    v_mul_f32 v16, v16, v24
    v_mul_f32 v17, v17, v25
    v_mul_f32 v18, v18, v26
    v_mul_f32 v19, v19, v27
    v_mul_f32 v20, v20, v28
    v_mul_f32 v21, v21, v29
    v_mul_f32 v22, v22, v30
    v_mul_f32 v23, v23, v31
    v_cvt_pk_bf16_f32 v32, v16, v17
    v_cvt_pk_bf16_f32 v33, v18, v19
    buffer_store_dwordx2 v[32:33], v7, s[16:19], s25 offen offset:0 sc1
    v_cvt_pk_bf16_f32 v34, v20, v21
    v_cvt_pk_bf16_f32 v35, v22, v23
    buffer_store_dwordx2 v[34:35], v7, s[16:19], s25 offen offset:1024 sc1
    s_add_u32 s25, s25, 2048
    v_fma_f32 v36, v130, v144, v148
    v_fma_f32 v37, v134, v145, v149
    v_fma_f32 v38, v138, v146, v150
    v_fma_f32 v39, v142, v147, v151
    v_fma_f32 v40, v131, v144, v148
    v_fma_f32 v41, v135, v145, v149
    v_fma_f32 v42, v139, v146, v150
    v_fma_f32 v43, v143, v147, v151
    v_mul_f32 v44, v36, v36
    v_mul_f32 v45, v37, v37
    v_mul_f32 v46, v38, v38
    v_mul_f32 v47, v39, v39
    v_mul_f32 v48, v40, v40
    v_mul_f32 v49, v41, v41
    v_mul_f32 v50, v42, v42
    v_mul_f32 v51, v43, v43
    v_fma_f32 v44, v44, s31, v15
    v_fma_f32 v45, v45, s31, v15
    v_fma_f32 v46, v46, s31, v15
    v_fma_f32 v47, v47, s31, v15
    v_fma_f32 v48, v48, s31, v15
    v_fma_f32 v49, v49, s31, v15
    v_fma_f32 v50, v50, s31, v15
    v_fma_f32 v51, v51, s31, v15
    v_mul_f32 v44, v44, v36
    v_mul_f32 v45, v45, v37
    v_mul_f32 v46, v46, v38
    v_mul_f32 v47, v47, v39
    v_mul_f32 v48, v48, v40
    v_mul_f32 v49, v49, v41
    v_mul_f32 v50, v50, v42
    v_mul_f32 v51, v51, v43
    v_exp_f32 v44, v44
    v_exp_f32 v45, v45
    v_exp_f32 v46, v46
    v_exp_f32 v47, v47
    v_exp_f32 v48, v48
    v_exp_f32 v49, v49
    v_exp_f32 v50, v50
    v_exp_f32 v51, v51
    v_add_f32 v44, 1.0, v44
    v_add_f32 v45, 1.0, v45
    v_add_f32 v46, 1.0, v46
    v_add_f32 v47, 1.0, v47
    v_add_f32 v48, 1.0, v48
    v_add_f32 v49, 1.0, v49
    v_add_f32 v50, 1.0, v50
    v_add_f32 v51, 1.0, v51
    v_rcp_f32 v44, v44
    v_rcp_f32 v45, v45
    v_rcp_f32 v46, v46
    v_rcp_f32 v47, v47
    v_rcp_f32 v48, v48
    v_rcp_f32 v49, v49
    v_rcp_f32 v50, v50
    v_rcp_f32 v51, v51
    v_mul_f32 v36, v36, v44
    v_mul_f32 v37, v37, v45
    v_mul_f32 v38, v38, v46
    v_mul_f32 v39, v39, v47
    v_mul_f32 v40, v40, v48
    v_mul_f32 v41, v41, v49
    v_mul_f32 v42, v42, v50
    v_mul_f32 v43, v43, v51
    v_cvt_pk_bf16_f32 v52, v36, v37
    v_cvt_pk_bf16_f32 v53, v38, v39
    buffer_store_dwordx2 v[52:53], v7, s[16:19], s25 offen offset:0 sc1
    v_cvt_pk_bf16_f32 v54, v40, v41
    v_cvt_pk_bf16_f32 v55, v42, v43
    buffer_store_dwordx2 v[54:55], v7, s[16:19], s25 offen offset:1024 sc1
    s_add_u32 s25, s25, 2048
    s_add_u32 s25, s25, 12288
K34_END:
    s_endpgm
TEXT_END:
.section .rodata,"a"
.p2align 6
.amdhsa_kernel k1_xform_kernel
  .amdhsa_next_free_vgpr 128
  .amdhsa_next_free_sgpr 96
  .amdhsa_accum_offset 128
  .amdhsa_group_segment_fixed_size 0
  .amdhsa_kernarg_size 56
  .amdhsa_user_sgpr_count 2
  .amdhsa_user_sgpr_kernarg_segment_ptr 1
  .amdhsa_system_sgpr_workgroup_id_x 1
.end_amdhsa_kernel
.p2align 6
.amdhsa_kernel k12_fused_kernel
  .amdhsa_next_free_vgpr 256
  .amdhsa_next_free_sgpr 96
  .amdhsa_accum_offset 256
  .amdhsa_group_segment_fixed_size 0
  .amdhsa_kernarg_size 56
  .amdhsa_user_sgpr_count 2
  .amdhsa_user_sgpr_kernarg_segment_ptr 1
  .amdhsa_system_sgpr_workgroup_id_x 1
.end_amdhsa_kernel
.p2align 6
.amdhsa_kernel k34_out_kernel
  .amdhsa_next_free_vgpr 168
  .amdhsa_next_free_sgpr 96
  .amdhsa_accum_offset 168
  .amdhsa_group_segment_fixed_size 0
  .amdhsa_kernarg_size 56
  .amdhsa_user_sgpr_count 2
  .amdhsa_user_sgpr_kernarg_segment_ptr 1
  .amdhsa_system_sgpr_workgroup_id_x 1
.end_amdhsa_kernel
```

```asm
; @launch kernel=k1_xform_kernel grid=(636,1,1) block=(256,1,1) lds=16384
; @launch kernel=k12_fused_kernel grid=(256,1,1) block=(512,1,1) lds=155872
; @launch kernel=k34_out_kernel grid=(256,1,1) block=(768,1,1) lds=18944
.amdgcn_target "amdgcn-amd-amdhsa--gfx950"
.text
.globl k1_xform_kernel
.globl k12_fused_kernel
.globl k34_out_kernel
.p2align 8
.type k1_xform_kernel,@function
k1_xform_kernel:
    s_cmp_ge_u32 s2, 636
    s_cbranch_scc1 K1_END
    s_load_dwordx4 s[4:7], s[0:1], 0
    s_load_dwordx2 s[8:9], s[0:1], 48
    v_lshrrev_b32 v120, 6, v0
    v_and_b32 v121, 63, v0
    v_readfirstlane_b32 s3, v120
    v_and_b32 v122, 15, v121
    v_lshrrev_b32 v123, 4, v121
    s_mov_b32 s28, 0x05040100
    s_mov_b32 s29, 0x07060302
    v_and_b32 v124, 3, v122
    v_lshlrev_b32 v124, 2, v124
    v_lshrrev_b32 v125, 3, v122
    v_lshl_add_u32 v124, v125, 1, v124
    s_lshl_b32 s10, s3, 4
    s_add_u32 s10, s10, 1
    v_add_u32 v124, s10, v124
    v_bfe_u32 v125, v122, 2, 1
    v_lshlrev_b32 v121, 4, v121
    s_waitcnt lgkmcnt(0)
    s_or_b32 s10, s2, s3
    s_cmp_eq_u32 s10, 0
    s_cbranch_scc0 K1_NOCLR
    s_add_u32 s12, s8, 153092096
    s_addc_u32 s13, s9, 0
    s_and_b32 s13, s13, 0xffff
    s_mov_b32 s14, 32768
    s_mov_b32 s15, 0x00020000
    v_lshrrev_b32 v118, 4, v121
    v_lshlrev_b32 v119, 10, v118
    v_mov_b32 v117, 0
    s_mov_b64 exec, 0xffff
    buffer_store_dword v117, v119, s[12:15], 0 offen
    v_lshlrev_b32 v119, 4, v118
    v_add_u32 v119, 16384, v119
    buffer_store_dword v117, v119, s[12:15], 0 offen
    s_mov_b64 exec, -1
K1_NOCLR:
    s_cmp_lt_u32 s2, 32
    s_cbranch_scc0 K1_NOFILL
    s_add_u32 s12, s8, 153616384
    s_addc_u32 s13, s9, 0
    s_and_b32 s13, s13, 0xffff
    s_mov_b32 s14, 131072
    s_mov_b32 s15, 0x00020000
    s_lshl_b32 s10, s2, 2
    s_add_u32 s10, s10, s3
    s_lshl_b32 s10, s10, 10
    v_mov_b32 v112, -1
    v_mov_b32 v113, -1
    v_mov_b32 v114, -1
    v_mov_b32 v115, -1
    buffer_store_dwordx4 v[112:115], v121, s[12:15], s10 offen
K1_NOFILL:
    s_add_u32 s10, s2, 384
    s_sub_u32 s11, s2, 252
    s_cmp_lt_u32 s2, 252
    s_cselect_b32 s2, s10, s11
    s_cmp_lt_u32 s2, 384
    s_cbranch_scc1 K1_W
    s_sub_u32 s11, s2, 384
    s_mul_hi_u32 s13, s11, 1431655766
    s_mul_i32 s12, s13, 3
    s_sub_u32 s12, s11, s12
    s_mov_b32 s11, s13
    s_cmp_ge_u32 s11, 42
    s_cselect_b32 s13, 1, 0
    s_mul_i32 s14, s13, 42
    s_sub_u32 s11, s11, s14
    s_lshl_b32 s11, s11, 2
    s_add_u32 s11, s11, s3
    s_mul_i32 s14, s13, 16384000
    s_add_u32 s16, s4, s14
    s_addc_u32 s17, s5, 0
    s_and_b32 s17, s17, 0xffff
    s_mov_b32 s18, 16384000
    s_mov_b32 s19, 0x00020000
    s_mov_b32 s20, s8
    s_mov_b32 s21, s9
    s_and_b32 s21, s21, 0xffff
    s_mov_b32 s22, 43778048
    s_mov_b32 s23, 0x00020000
    v_lshlrev_b32 v126, 14, v123
    v_lshl_add_u32 v126, v122, 4, v126
    s_mul_i32 s15, s11, 98304
    s_lshl_b32 s24, s12, 8
    s_add_u32 s15, s15, s24
    buffer_load_dwordx4 v[0:3], v126, s[16:19], s15 offen
    buffer_load_dwordx4 v[4:7], v126, s[16:19], s15 offen offset:2048
    s_add_u32 s15, s15, 4096
    buffer_load_dwordx4 v[8:11], v126, s[16:19], s15 offen
    buffer_load_dwordx4 v[12:15], v126, s[16:19], s15 offen offset:2048
    s_add_u32 s15, s15, 4096
    buffer_load_dwordx4 v[16:19], v126, s[16:19], s15 offen
    buffer_load_dwordx4 v[20:23], v126, s[16:19], s15 offen offset:2048
    s_add_u32 s15, s15, 4096
    buffer_load_dwordx4 v[24:27], v126, s[16:19], s15 offen
    buffer_load_dwordx4 v[28:31], v126, s[16:19], s15 offen offset:2048
    s_add_u32 s15, s15, 53248
    buffer_load_dwordx4 v[32:35], v126, s[16:19], s15 offen
    buffer_load_dwordx4 v[36:39], v126, s[16:19], s15 offen offset:2048
    s_add_u32 s15, s15, 4096
    buffer_load_dwordx4 v[40:43], v126, s[16:19], s15 offen
    buffer_load_dwordx4 v[44:47], v126, s[16:19], s15 offen offset:2048
    s_add_u32 s15, s15, 4096
    buffer_load_dwordx4 v[48:51], v126, s[16:19], s15 offen
    buffer_load_dwordx4 v[52:55], v126, s[16:19], s15 offen offset:2048
    s_add_u32 s15, s15, 4096
    buffer_load_dwordx4 v[56:59], v126, s[16:19], s15 offen
    buffer_load_dwordx4 v[60:63], v126, s[16:19], s15 offen offset:2048
    v_lshlrev_b32 v127, 3, v123
    v_lshlrev_b32 v112, 5, v125
    v_mad_u32_u24 v113, v124, v127, v112
    v_mad_u32_u24 v64, v124, 0, v113
    v_mad_u32_u24 v65, v124, 1, v113
    v_mad_u32_u24 v66, v124, 2, v113
    v_mad_u32_u24 v67, v124, 3, v113
    v_mad_u32_u24 v68, v124, 4, v113
    v_mad_u32_u24 v69, v124, 5, v113
    v_mad_u32_u24 v70, v124, 6, v113
    v_mad_u32_u24 v71, v124, 7, v113
    v_and_b32 v64, 127, v64
    v_and_b32 v65, 127, v65
    v_and_b32 v66, 127, v66
    v_and_b32 v67, 127, v67
    v_and_b32 v68, 127, v68
    v_and_b32 v69, 127, v69
    v_and_b32 v70, 127, v70
    v_and_b32 v71, 127, v71
    v_cvt_f32_u32 v64, v64
    v_cvt_f32_u32 v65, v65
    v_cvt_f32_u32 v66, v66
    v_cvt_f32_u32 v67, v67
    v_cvt_f32_u32 v68, v68
    v_cvt_f32_u32 v69, v69
    v_cvt_f32_u32 v70, v70
    v_cvt_f32_u32 v71, v71
    v_mul_f32 v64, 0x3c000000, v64
    v_mul_f32 v65, 0x3c000000, v65
    v_mul_f32 v66, 0x3c000000, v66
    v_mul_f32 v67, 0x3c000000, v67
    v_mul_f32 v68, 0x3c000000, v68
    v_mul_f32 v69, 0x3c000000, v69
    v_mul_f32 v70, 0x3c000000, v70
    v_mul_f32 v71, 0x3c000000, v71
    v_cos_f32 v64, v64
    v_cos_f32 v65, v65
    v_cos_f32 v66, v66
    v_cos_f32 v67, v67
    v_cos_f32 v68, v68
    v_cos_f32 v69, v69
    v_cos_f32 v70, v70
    v_cos_f32 v71, v71
    s_nop 0
    v_cvt_pk_bf16_f32 v72, v64, v65
    v_cvt_pk_bf16_f32 v73, v66, v67
    v_cvt_pk_bf16_f32 v74, v68, v69
    v_cvt_pk_bf16_f32 v75, v70, v71
    v_lshlrev_b32 v80, 16, v72
    v_and_b32 v81, 0xffff0000, v72
    v_sub_f32 v64, v64, v80
    v_sub_f32 v65, v65, v81
    v_lshlrev_b32 v80, 16, v73
    v_and_b32 v81, 0xffff0000, v73
    v_sub_f32 v66, v66, v80
    v_sub_f32 v67, v67, v81
    v_lshlrev_b32 v80, 16, v74
    v_and_b32 v81, 0xffff0000, v74
    v_sub_f32 v68, v68, v80
    v_sub_f32 v69, v69, v81
    v_lshlrev_b32 v80, 16, v75
    v_and_b32 v81, 0xffff0000, v75
    v_sub_f32 v70, v70, v80
    v_sub_f32 v71, v71, v81
    v_cvt_pk_bf16_f32 v76, v64, v65
    v_cvt_pk_bf16_f32 v77, v66, v67
    v_cvt_pk_bf16_f32 v78, v68, v69
    v_cvt_pk_bf16_f32 v79, v70, v71
    s_lshl_b32 s24, s3, 12
    v_add_u32 v114, s24, v121
    ds_write_b128 v114, v[72:75] offset:0
    ds_write_b128 v114, v[76:79] offset:1024
    v_add_u32 v127, 32, v127
    v_lshlrev_b32 v112, 5, v125
    v_mad_u32_u24 v113, v124, v127, v112
    v_mad_u32_u24 v64, v124, 0, v113
    v_mad_u32_u24 v65, v124, 1, v113
    v_mad_u32_u24 v66, v124, 2, v113
    v_mad_u32_u24 v67, v124, 3, v113
    v_mad_u32_u24 v68, v124, 4, v113
    v_mad_u32_u24 v69, v124, 5, v113
    v_mad_u32_u24 v70, v124, 6, v113
    v_mad_u32_u24 v71, v124, 7, v113
    v_and_b32 v64, 127, v64
    v_and_b32 v65, 127, v65
    v_and_b32 v66, 127, v66
    v_and_b32 v67, 127, v67
    v_and_b32 v68, 127, v68
    v_and_b32 v69, 127, v69
    v_and_b32 v70, 127, v70
    v_and_b32 v71, 127, v71
    v_cvt_f32_u32 v64, v64
    v_cvt_f32_u32 v65, v65
    v_cvt_f32_u32 v66, v66
    v_cvt_f32_u32 v67, v67
    v_cvt_f32_u32 v68, v68
    v_cvt_f32_u32 v69, v69
    v_cvt_f32_u32 v70, v70
    v_cvt_f32_u32 v71, v71
    v_mul_f32 v64, 0x3c000000, v64
    v_mul_f32 v65, 0x3c000000, v65
    v_mul_f32 v66, 0x3c000000, v66
    v_mul_f32 v67, 0x3c000000, v67
    v_mul_f32 v68, 0x3c000000, v68
    v_mul_f32 v69, 0x3c000000, v69
    v_mul_f32 v70, 0x3c000000, v70
    v_mul_f32 v71, 0x3c000000, v71
    v_cos_f32 v64, v64
    v_cos_f32 v65, v65
    v_cos_f32 v66, v66
    v_cos_f32 v67, v67
    v_cos_f32 v68, v68
    v_cos_f32 v69, v69
    v_cos_f32 v70, v70
    v_cos_f32 v71, v71
    s_nop 0
    v_cvt_pk_bf16_f32 v72, v64, v65
    v_cvt_pk_bf16_f32 v73, v66, v67
    v_cvt_pk_bf16_f32 v74, v68, v69
    v_cvt_pk_bf16_f32 v75, v70, v71
    v_lshlrev_b32 v80, 16, v72
    v_and_b32 v81, 0xffff0000, v72
    v_sub_f32 v64, v64, v80
    v_sub_f32 v65, v65, v81
    v_lshlrev_b32 v80, 16, v73
    v_and_b32 v81, 0xffff0000, v73
    v_sub_f32 v66, v66, v80
    v_sub_f32 v67, v67, v81
    v_lshlrev_b32 v80, 16, v74
    v_and_b32 v81, 0xffff0000, v74
    v_sub_f32 v68, v68, v80
    v_sub_f32 v69, v69, v81
    v_lshlrev_b32 v80, 16, v75
    v_and_b32 v81, 0xffff0000, v75
    v_sub_f32 v70, v70, v80
    v_sub_f32 v71, v71, v81
    v_cvt_pk_bf16_f32 v76, v64, v65
    v_cvt_pk_bf16_f32 v77, v66, v67
    v_cvt_pk_bf16_f32 v78, v68, v69
    v_cvt_pk_bf16_f32 v79, v70, v71
    s_lshl_b32 s24, s3, 12
    v_add_u32 v114, s24, v121
    ds_write_b128 v114, v[72:75] offset:2048
    ds_write_b128 v114, v[76:79] offset:3072
    v_lshrrev_b32 v112, 1, v123
    s_mov_b32 s24, 1368064
    v_mul_lo_u32 v112, v112, s24
    v_lshrrev_b32 v113, 2, v122
    s_mov_b32 s24, 21376
    v_mul_lo_u32 v113, v113, s24
    v_add_u32 v112, v112, v113
    v_and_b32 v113, 3, v122
    v_and_b32 v114, 1, v123
    v_lshl_add_u32 v113, v114, 2, v113
    s_add_u32 s24, s11, 7
    s_cmp_ge_u32 s11, 160
    s_cselect_b32 s24, s24, s11
    s_cmp_eq_u32 s13, 1
    s_cselect_b32 s24, s24, s11
    s_lshr_b32 s24, s24, 1
    s_and_b32 s24, s24, 7
    v_xor_b32 v113, s24, v113
    v_lshl_add_u32 v120, v113, 4, v112
    s_mul_i32 s25, s13, 684032
    s_mul_i32 s24, s12, 85504
    s_add_u32 s25, s25, s24
    s_lshl_b32 s24, s11, 7
    s_add_u32 s25, s25, s24
    s_waitcnt lgkmcnt(0)
    s_barrier
    s_cmp_ge_u32 s11, 167
    s_cbranch_scc1 K1_END
    s_waitcnt vmcnt(8)
    v_perm_b32 v64, v4, v0, s28
    v_perm_b32 v68, v4, v0, s29
    v_perm_b32 v65, v12, v8, s28
    v_perm_b32 v69, v12, v8, s29
    v_perm_b32 v66, v20, v16, s28
    v_perm_b32 v70, v20, v16, s29
    v_perm_b32 v67, v28, v24, s28
    v_perm_b32 v71, v28, v24, s29
    v_perm_b32 v72, v5, v1, s28
    v_perm_b32 v76, v5, v1, s29
    v_perm_b32 v73, v13, v9, s28
    v_perm_b32 v77, v13, v9, s29
    v_perm_b32 v74, v21, v17, s28
    v_perm_b32 v78, v21, v17, s29
    v_perm_b32 v75, v29, v25, s28
    v_perm_b32 v79, v29, v25, s29
    v_perm_b32 v80, v6, v2, s28
    v_perm_b32 v84, v6, v2, s29
    v_perm_b32 v81, v14, v10, s28
    v_perm_b32 v85, v14, v10, s29
    v_perm_b32 v82, v22, v18, s28
    v_perm_b32 v86, v22, v18, s29
    v_perm_b32 v83, v30, v26, s28
    v_perm_b32 v87, v30, v26, s29
    v_perm_b32 v88, v7, v3, s28
    v_perm_b32 v92, v7, v3, s29
    v_perm_b32 v89, v15, v11, s28
    v_perm_b32 v93, v15, v11, s29
    v_perm_b32 v90, v23, v19, s28
    v_perm_b32 v94, v23, v19, s29
    v_perm_b32 v91, v31, v27, s28
    v_perm_b32 v95, v31, v27, s29
    s_waitcnt vmcnt(0)
    v_perm_b32 v0, v36, v32, s28
    v_perm_b32 v4, v36, v32, s29
    v_perm_b32 v1, v44, v40, s28
    v_perm_b32 v5, v44, v40, s29
    v_perm_b32 v2, v52, v48, s28
    v_perm_b32 v6, v52, v48, s29
    v_perm_b32 v3, v60, v56, s28
    v_perm_b32 v7, v60, v56, s29
    v_perm_b32 v8, v37, v33, s28
    v_perm_b32 v12, v37, v33, s29
    v_perm_b32 v9, v45, v41, s28
    v_perm_b32 v13, v45, v41, s29
    v_perm_b32 v10, v53, v49, s28
    v_perm_b32 v14, v53, v49, s29
    v_perm_b32 v11, v61, v57, s28
    v_perm_b32 v15, v61, v57, s29
    v_perm_b32 v16, v38, v34, s28
    v_perm_b32 v20, v38, v34, s29
    v_perm_b32 v17, v46, v42, s28
    v_perm_b32 v21, v46, v42, s29
    v_perm_b32 v18, v54, v50, s28
    v_perm_b32 v22, v54, v50, s29
    v_perm_b32 v19, v62, v58, s28
    v_perm_b32 v23, v62, v58, s29
    v_perm_b32 v24, v39, v35, s28
    v_perm_b32 v28, v39, v35, s29
    v_perm_b32 v25, v47, v43, s28
    v_perm_b32 v29, v47, v43, s29
    v_perm_b32 v26, v55, v51, s28
    v_perm_b32 v30, v55, v51, s29
    v_perm_b32 v27, v63, v59, s28
    v_perm_b32 v31, v63, v59, s29
    ds_read_b128 v[96:99], v121 offset:0
    ds_read_b128 v[100:103], v121 offset:1024
    ds_read_b128 v[104:107], v121 offset:2048
    ds_read_b128 v[108:111], v121 offset:3072
    s_waitcnt lgkmcnt(3)
    v_mfma_f32_16x16x32_bf16 v[32:35], v[96:99], v[64:67], 0
    v_mfma_f32_16x16x32_bf16 v[36:39], v[96:99], v[68:71], 0
    v_mfma_f32_16x16x32_bf16 v[40:43], v[96:99], v[72:75], 0
    v_mfma_f32_16x16x32_bf16 v[44:47], v[96:99], v[76:79], 0
    v_mfma_f32_16x16x32_bf16 v[48:51], v[96:99], v[80:83], 0
    v_mfma_f32_16x16x32_bf16 v[52:55], v[96:99], v[84:87], 0
    v_mfma_f32_16x16x32_bf16 v[56:59], v[96:99], v[88:91], 0
    v_mfma_f32_16x16x32_bf16 v[60:63], v[96:99], v[92:95], 0
    s_waitcnt lgkmcnt(2)
    v_mfma_f32_16x16x32_bf16 v[32:35], v[100:103], v[64:67], v[32:35]
    v_mfma_f32_16x16x32_bf16 v[36:39], v[100:103], v[68:71], v[36:39]
    v_mfma_f32_16x16x32_bf16 v[40:43], v[100:103], v[72:75], v[40:43]
    v_mfma_f32_16x16x32_bf16 v[44:47], v[100:103], v[76:79], v[44:47]
    v_mfma_f32_16x16x32_bf16 v[48:51], v[100:103], v[80:83], v[48:51]
    v_mfma_f32_16x16x32_bf16 v[52:55], v[100:103], v[84:87], v[52:55]
    v_mfma_f32_16x16x32_bf16 v[56:59], v[100:103], v[88:91], v[56:59]
    v_mfma_f32_16x16x32_bf16 v[60:63], v[100:103], v[92:95], v[60:63]
    s_waitcnt lgkmcnt(1)
    v_mfma_f32_16x16x32_bf16 v[32:35], v[104:107], v[0:3], v[32:35]
    v_mfma_f32_16x16x32_bf16 v[36:39], v[104:107], v[4:7], v[36:39]
    v_mfma_f32_16x16x32_bf16 v[40:43], v[104:107], v[8:11], v[40:43]
    v_mfma_f32_16x16x32_bf16 v[44:47], v[104:107], v[12:15], v[44:47]
    v_mfma_f32_16x16x32_bf16 v[48:51], v[104:107], v[16:19], v[48:51]
    v_mfma_f32_16x16x32_bf16 v[52:55], v[104:107], v[20:23], v[52:55]
    v_mfma_f32_16x16x32_bf16 v[56:59], v[104:107], v[24:27], v[56:59]
    v_mfma_f32_16x16x32_bf16 v[60:63], v[104:107], v[28:31], v[60:63]
    s_waitcnt lgkmcnt(0)
    v_mfma_f32_16x16x32_bf16 v[32:35], v[108:111], v[0:3], v[32:35]
    v_mfma_f32_16x16x32_bf16 v[36:39], v[108:111], v[4:7], v[36:39]
    v_mfma_f32_16x16x32_bf16 v[40:43], v[108:111], v[8:11], v[40:43]
    v_mfma_f32_16x16x32_bf16 v[44:47], v[108:111], v[12:15], v[44:47]
    v_mfma_f32_16x16x32_bf16 v[48:51], v[108:111], v[16:19], v[48:51]
    v_mfma_f32_16x16x32_bf16 v[52:55], v[108:111], v[20:23], v[52:55]
    v_mfma_f32_16x16x32_bf16 v[56:59], v[108:111], v[24:27], v[56:59]
    v_mfma_f32_16x16x32_bf16 v[60:63], v[108:111], v[28:31], v[60:63]
    s_nop 7
    v_cvt_pk_bf16_f32 v112, v32, v36
    v_cvt_pk_bf16_f32 v113, v40, v44
    v_cvt_pk_bf16_f32 v114, v48, v52
    v_cvt_pk_bf16_f32 v115, v56, v60
    buffer_store_dwordx4 v[112:115], v120, s[20:23], s25 offen
    s_add_u32 s25, s25, 2736128
    v_cvt_pk_bf16_f32 v116, v33, v37
    v_cvt_pk_bf16_f32 v117, v41, v45
    v_cvt_pk_bf16_f32 v118, v49, v53
    v_cvt_pk_bf16_f32 v119, v57, v61
    buffer_store_dwordx4 v[116:119], v120, s[20:23], s25 offen
    s_add_u32 s25, s25, 2736128
    v_cvt_pk_bf16_f32 v112, v34, v38
    v_cvt_pk_bf16_f32 v113, v42, v46
    v_cvt_pk_bf16_f32 v114, v50, v54
    v_cvt_pk_bf16_f32 v115, v58, v62
    buffer_store_dwordx4 v[112:115], v120, s[20:23], s25 offen
    s_add_u32 s25, s25, 2736128
    v_cvt_pk_bf16_f32 v116, v35, v39
    v_cvt_pk_bf16_f32 v117, v43, v47
    v_cvt_pk_bf16_f32 v118, v51, v55
    v_cvt_pk_bf16_f32 v119, v59, v63
    buffer_store_dwordx4 v[116:119], v120, s[20:23], s25 offen
    s_add_u32 s25, s25, 2736128
    ds_read_b128 v[96:99], v121 offset:4096
    ds_read_b128 v[100:103], v121 offset:5120
    ds_read_b128 v[104:107], v121 offset:6144
    ds_read_b128 v[108:111], v121 offset:7168
    s_waitcnt lgkmcnt(3)
    v_mfma_f32_16x16x32_bf16 v[32:35], v[96:99], v[64:67], 0
    v_mfma_f32_16x16x32_bf16 v[36:39], v[96:99], v[68:71], 0
    v_mfma_f32_16x16x32_bf16 v[40:43], v[96:99], v[72:75], 0
    v_mfma_f32_16x16x32_bf16 v[44:47], v[96:99], v[76:79], 0
    v_mfma_f32_16x16x32_bf16 v[48:51], v[96:99], v[80:83], 0
    v_mfma_f32_16x16x32_bf16 v[52:55], v[96:99], v[84:87], 0
    v_mfma_f32_16x16x32_bf16 v[56:59], v[96:99], v[88:91], 0
    v_mfma_f32_16x16x32_bf16 v[60:63], v[96:99], v[92:95], 0
    s_waitcnt lgkmcnt(2)
    v_mfma_f32_16x16x32_bf16 v[32:35], v[100:103], v[64:67], v[32:35]
    v_mfma_f32_16x16x32_bf16 v[36:39], v[100:103], v[68:71], v[36:39]
    v_mfma_f32_16x16x32_bf16 v[40:43], v[100:103], v[72:75], v[40:43]
    v_mfma_f32_16x16x32_bf16 v[44:47], v[100:103], v[76:79], v[44:47]
    v_mfma_f32_16x16x32_bf16 v[48:51], v[100:103], v[80:83], v[48:51]
    v_mfma_f32_16x16x32_bf16 v[52:55], v[100:103], v[84:87], v[52:55]
    v_mfma_f32_16x16x32_bf16 v[56:59], v[100:103], v[88:91], v[56:59]
    v_mfma_f32_16x16x32_bf16 v[60:63], v[100:103], v[92:95], v[60:63]
    s_waitcnt lgkmcnt(1)
    v_mfma_f32_16x16x32_bf16 v[32:35], v[104:107], v[0:3], v[32:35]
    v_mfma_f32_16x16x32_bf16 v[36:39], v[104:107], v[4:7], v[36:39]
    v_mfma_f32_16x16x32_bf16 v[40:43], v[104:107], v[8:11], v[40:43]
    v_mfma_f32_16x16x32_bf16 v[44:47], v[104:107], v[12:15], v[44:47]
    v_mfma_f32_16x16x32_bf16 v[48:51], v[104:107], v[16:19], v[48:51]
    v_mfma_f32_16x16x32_bf16 v[52:55], v[104:107], v[20:23], v[52:55]
    v_mfma_f32_16x16x32_bf16 v[56:59], v[104:107], v[24:27], v[56:59]
    v_mfma_f32_16x16x32_bf16 v[60:63], v[104:107], v[28:31], v[60:63]
    s_waitcnt lgkmcnt(0)
    v_mfma_f32_16x16x32_bf16 v[32:35], v[108:111], v[0:3], v[32:35]
    v_mfma_f32_16x16x32_bf16 v[36:39], v[108:111], v[4:7], v[36:39]
    v_mfma_f32_16x16x32_bf16 v[40:43], v[108:111], v[8:11], v[40:43]
    v_mfma_f32_16x16x32_bf16 v[44:47], v[108:111], v[12:15], v[44:47]
    v_mfma_f32_16x16x32_bf16 v[48:51], v[108:111], v[16:19], v[48:51]
    v_mfma_f32_16x16x32_bf16 v[52:55], v[108:111], v[20:23], v[52:55]
    v_mfma_f32_16x16x32_bf16 v[56:59], v[108:111], v[24:27], v[56:59]
    v_mfma_f32_16x16x32_bf16 v[60:63], v[108:111], v[28:31], v[60:63]
    s_nop 7
    v_cvt_pk_bf16_f32 v112, v32, v36
    v_cvt_pk_bf16_f32 v113, v40, v44
    v_cvt_pk_bf16_f32 v114, v48, v52
    v_cvt_pk_bf16_f32 v115, v56, v60
    buffer_store_dwordx4 v[112:115], v120, s[20:23], s25 offen
    s_add_u32 s25, s25, 2736128
    v_cvt_pk_bf16_f32 v116, v33, v37
    v_cvt_pk_bf16_f32 v117, v41, v45
    v_cvt_pk_bf16_f32 v118, v49, v53
    v_cvt_pk_bf16_f32 v119, v57, v61
    buffer_store_dwordx4 v[116:119], v120, s[20:23], s25 offen
    s_add_u32 s25, s25, 2736128
    v_cvt_pk_bf16_f32 v112, v34, v38
    v_cvt_pk_bf16_f32 v113, v42, v46
    v_cvt_pk_bf16_f32 v114, v50, v54
    v_cvt_pk_bf16_f32 v115, v58, v62
    buffer_store_dwordx4 v[112:115], v120, s[20:23], s25 offen
    s_add_u32 s25, s25, 2736128
    v_cvt_pk_bf16_f32 v116, v35, v39
    v_cvt_pk_bf16_f32 v117, v43, v47
    v_cvt_pk_bf16_f32 v118, v51, v55
    v_cvt_pk_bf16_f32 v119, v59, v63
    buffer_store_dwordx4 v[116:119], v120, s[20:23], s25 offen
    s_add_u32 s25, s25, 2736128
    ds_read_b128 v[96:99], v121 offset:8192
    ds_read_b128 v[100:103], v121 offset:9216
    ds_read_b128 v[104:107], v121 offset:10240
    ds_read_b128 v[108:111], v121 offset:11264
    s_waitcnt lgkmcnt(3)
    v_mfma_f32_16x16x32_bf16 v[32:35], v[96:99], v[64:67], 0
    v_mfma_f32_16x16x32_bf16 v[36:39], v[96:99], v[68:71], 0
    v_mfma_f32_16x16x32_bf16 v[40:43], v[96:99], v[72:75], 0
    v_mfma_f32_16x16x32_bf16 v[44:47], v[96:99], v[76:79], 0
    v_mfma_f32_16x16x32_bf16 v[48:51], v[96:99], v[80:83], 0
    v_mfma_f32_16x16x32_bf16 v[52:55], v[96:99], v[84:87], 0
    v_mfma_f32_16x16x32_bf16 v[56:59], v[96:99], v[88:91], 0
    v_mfma_f32_16x16x32_bf16 v[60:63], v[96:99], v[92:95], 0
    s_waitcnt lgkmcnt(2)
    v_mfma_f32_16x16x32_bf16 v[32:35], v[100:103], v[64:67], v[32:35]
    v_mfma_f32_16x16x32_bf16 v[36:39], v[100:103], v[68:71], v[36:39]
    v_mfma_f32_16x16x32_bf16 v[40:43], v[100:103], v[72:75], v[40:43]
    v_mfma_f32_16x16x32_bf16 v[44:47], v[100:103], v[76:79], v[44:47]
    v_mfma_f32_16x16x32_bf16 v[48:51], v[100:103], v[80:83], v[48:51]
    v_mfma_f32_16x16x32_bf16 v[52:55], v[100:103], v[84:87], v[52:55]
    v_mfma_f32_16x16x32_bf16 v[56:59], v[100:103], v[88:91], v[56:59]
    v_mfma_f32_16x16x32_bf16 v[60:63], v[100:103], v[92:95], v[60:63]
    s_waitcnt lgkmcnt(1)
    v_mfma_f32_16x16x32_bf16 v[32:35], v[104:107], v[0:3], v[32:35]
    v_mfma_f32_16x16x32_bf16 v[36:39], v[104:107], v[4:7], v[36:39]
    v_mfma_f32_16x16x32_bf16 v[40:43], v[104:107], v[8:11], v[40:43]
    v_mfma_f32_16x16x32_bf16 v[44:47], v[104:107], v[12:15], v[44:47]
    v_mfma_f32_16x16x32_bf16 v[48:51], v[104:107], v[16:19], v[48:51]
    v_mfma_f32_16x16x32_bf16 v[52:55], v[104:107], v[20:23], v[52:55]
    v_mfma_f32_16x16x32_bf16 v[56:59], v[104:107], v[24:27], v[56:59]
    v_mfma_f32_16x16x32_bf16 v[60:63], v[104:107], v[28:31], v[60:63]
    s_waitcnt lgkmcnt(0)
    v_mfma_f32_16x16x32_bf16 v[32:35], v[108:111], v[0:3], v[32:35]
    v_mfma_f32_16x16x32_bf16 v[36:39], v[108:111], v[4:7], v[36:39]
    v_mfma_f32_16x16x32_bf16 v[40:43], v[108:111], v[8:11], v[40:43]
    v_mfma_f32_16x16x32_bf16 v[44:47], v[108:111], v[12:15], v[44:47]
    v_mfma_f32_16x16x32_bf16 v[48:51], v[108:111], v[16:19], v[48:51]
    v_mfma_f32_16x16x32_bf16 v[52:55], v[108:111], v[20:23], v[52:55]
    v_mfma_f32_16x16x32_bf16 v[56:59], v[108:111], v[24:27], v[56:59]
    v_mfma_f32_16x16x32_bf16 v[60:63], v[108:111], v[28:31], v[60:63]
    s_nop 7
    v_cvt_pk_bf16_f32 v112, v32, v36
    v_cvt_pk_bf16_f32 v113, v40, v44
    v_cvt_pk_bf16_f32 v114, v48, v52
    v_cvt_pk_bf16_f32 v115, v56, v60
    buffer_store_dwordx4 v[112:115], v120, s[20:23], s25 offen
    s_add_u32 s25, s25, 2736128
    v_cvt_pk_bf16_f32 v116, v33, v37
    v_cvt_pk_bf16_f32 v117, v41, v45
    v_cvt_pk_bf16_f32 v118, v49, v53
    v_cvt_pk_bf16_f32 v119, v57, v61
    buffer_store_dwordx4 v[116:119], v120, s[20:23], s25 offen
    s_add_u32 s25, s25, 2736128
    v_cvt_pk_bf16_f32 v112, v34, v38
    v_cvt_pk_bf16_f32 v113, v42, v46
    v_cvt_pk_bf16_f32 v114, v50, v54
    v_cvt_pk_bf16_f32 v115, v58, v62
    buffer_store_dwordx4 v[112:115], v120, s[20:23], s25 offen
    s_add_u32 s25, s25, 2736128
    v_cvt_pk_bf16_f32 v116, v35, v39
    v_cvt_pk_bf16_f32 v117, v43, v47
    v_cvt_pk_bf16_f32 v118, v51, v55
    v_cvt_pk_bf16_f32 v119, v59, v63
    buffer_store_dwordx4 v[116:119], v120, s[20:23], s25 offen
    s_add_u32 s25, s25, 2736128
    ds_read_b128 v[96:99], v121 offset:12288
    ds_read_b128 v[100:103], v121 offset:13312
    ds_read_b128 v[104:107], v121 offset:14336
    ds_read_b128 v[108:111], v121 offset:15360
    s_waitcnt lgkmcnt(3)
    v_mfma_f32_16x16x32_bf16 v[32:35], v[96:99], v[64:67], 0
    v_mfma_f32_16x16x32_bf16 v[36:39], v[96:99], v[68:71], 0
    v_mfma_f32_16x16x32_bf16 v[40:43], v[96:99], v[72:75], 0
    v_mfma_f32_16x16x32_bf16 v[44:47], v[96:99], v[76:79], 0
    v_mfma_f32_16x16x32_bf16 v[48:51], v[96:99], v[80:83], 0
    v_mfma_f32_16x16x32_bf16 v[52:55], v[96:99], v[84:87], 0
    v_mfma_f32_16x16x32_bf16 v[56:59], v[96:99], v[88:91], 0
    v_mfma_f32_16x16x32_bf16 v[60:63], v[96:99], v[92:95], 0
    s_waitcnt lgkmcnt(2)
    v_mfma_f32_16x16x32_bf16 v[32:35], v[100:103], v[64:67], v[32:35]
    v_mfma_f32_16x16x32_bf16 v[36:39], v[100:103], v[68:71], v[36:39]
    v_mfma_f32_16x16x32_bf16 v[40:43], v[100:103], v[72:75], v[40:43]
    v_mfma_f32_16x16x32_bf16 v[44:47], v[100:103], v[76:79], v[44:47]
    v_mfma_f32_16x16x32_bf16 v[48:51], v[100:103], v[80:83], v[48:51]
    v_mfma_f32_16x16x32_bf16 v[52:55], v[100:103], v[84:87], v[52:55]
    v_mfma_f32_16x16x32_bf16 v[56:59], v[100:103], v[88:91], v[56:59]
    v_mfma_f32_16x16x32_bf16 v[60:63], v[100:103], v[92:95], v[60:63]
    s_waitcnt lgkmcnt(1)
    v_mfma_f32_16x16x32_bf16 v[32:35], v[104:107], v[0:3], v[32:35]
    v_mfma_f32_16x16x32_bf16 v[36:39], v[104:107], v[4:7], v[36:39]
    v_mfma_f32_16x16x32_bf16 v[40:43], v[104:107], v[8:11], v[40:43]
    v_mfma_f32_16x16x32_bf16 v[44:47], v[104:107], v[12:15], v[44:47]
    v_mfma_f32_16x16x32_bf16 v[48:51], v[104:107], v[16:19], v[48:51]
    v_mfma_f32_16x16x32_bf16 v[52:55], v[104:107], v[20:23], v[52:55]
    v_mfma_f32_16x16x32_bf16 v[56:59], v[104:107], v[24:27], v[56:59]
    v_mfma_f32_16x16x32_bf16 v[60:63], v[104:107], v[28:31], v[60:63]
    s_waitcnt lgkmcnt(0)
    v_mfma_f32_16x16x32_bf16 v[32:35], v[108:111], v[0:3], v[32:35]
    v_mfma_f32_16x16x32_bf16 v[36:39], v[108:111], v[4:7], v[36:39]
    v_mfma_f32_16x16x32_bf16 v[40:43], v[108:111], v[8:11], v[40:43]
    v_mfma_f32_16x16x32_bf16 v[44:47], v[108:111], v[12:15], v[44:47]
    v_mfma_f32_16x16x32_bf16 v[48:51], v[108:111], v[16:19], v[48:51]
    v_mfma_f32_16x16x32_bf16 v[52:55], v[108:111], v[20:23], v[52:55]
    v_mfma_f32_16x16x32_bf16 v[56:59], v[108:111], v[24:27], v[56:59]
    v_mfma_f32_16x16x32_bf16 v[60:63], v[108:111], v[28:31], v[60:63]
    s_nop 7
    v_cvt_pk_bf16_f32 v112, v32, v36
    v_cvt_pk_bf16_f32 v113, v40, v44
    v_cvt_pk_bf16_f32 v114, v48, v52
    v_cvt_pk_bf16_f32 v115, v56, v60
    buffer_store_dwordx4 v[112:115], v120, s[20:23], s25 offen
    s_add_u32 s25, s25, 2736128
    v_cvt_pk_bf16_f32 v116, v33, v37
    v_cvt_pk_bf16_f32 v117, v41, v45
    v_cvt_pk_bf16_f32 v118, v49, v53
    v_cvt_pk_bf16_f32 v119, v57, v61
    buffer_store_dwordx4 v[116:119], v120, s[20:23], s25 offen
    s_add_u32 s25, s25, 2736128
    v_cvt_pk_bf16_f32 v112, v34, v38
    v_cvt_pk_bf16_f32 v113, v42, v46
    v_cvt_pk_bf16_f32 v114, v50, v54
    v_cvt_pk_bf16_f32 v115, v58, v62
    buffer_store_dwordx4 v[112:115], v120, s[20:23], s25 offen
    s_add_u32 s25, s25, 2736128
    v_cvt_pk_bf16_f32 v116, v35, v39
    v_cvt_pk_bf16_f32 v117, v43, v47
    v_cvt_pk_bf16_f32 v118, v51, v55
    v_cvt_pk_bf16_f32 v119, v59, v63
    buffer_store_dwordx4 v[116:119], v120, s[20:23], s25 offen
    s_endpgm
K1_W:
    s_mov_b32 s16, s6
    s_mov_b32 s17, s7
    s_and_b32 s17, s17, 0xffff
    s_mov_b32 s18, 16252928
    s_mov_b32 s19, 0x00020000
    s_add_u32 s20, s8, 50331648
    s_addc_u32 s21, s9, 0
    s_and_b32 s21, s21, 0xffff
    s_mov_b32 s22, 67108864
    s_mov_b32 s23, 0x00020000
    s_mul_i32 s11, s2, 1
    s_lshr_b32 s12, s11, 9
    s_and_b32 s13, s11, 511
    s_lshl_b32 s14, s12, 19
    s_lshl_b32 s15, s13, 10
    s_add_u32 s14, s14, s15
    s_lshl_b32 s15, s3, 8
    s_add_u32 s14, s14, s15
    v_and_b32 v126, 1, v123
    v_lshlrev_b32 v126, 23, v126
    v_lshl_add_u32 v126, v122, 4, v126
    s_mov_b32 s15, s14
    buffer_load_dwordx4 v[0:3], v126, s[16:19], s15 offen
    s_add_u32 s15, s15, 0x100000
    buffer_load_dwordx4 v[4:7], v126, s[16:19], s15 offen
    s_add_u32 s15, s15, 0x100000
    buffer_load_dwordx4 v[8:11], v126, s[16:19], s15 offen
    s_add_u32 s15, s15, 0x100000
    buffer_load_dwordx4 v[12:15], v126, s[16:19], s15 offen
    s_add_u32 s15, s15, 0x100000
    buffer_load_dwordx4 v[16:19], v126, s[16:19], s15 offen
    s_add_u32 s15, s15, 0x100000
    buffer_load_dwordx4 v[20:23], v126, s[16:19], s15 offen
    s_add_u32 s15, s15, 0x100000
    buffer_load_dwordx4 v[24:27], v126, s[16:19], s15 offen
    s_add_u32 s15, s15, 0x100000
    buffer_load_dwordx4 v[28:31], v126, s[16:19], s15 offen
    v_and_b32 v127, 1, v123
    v_lshlrev_b32 v127, 3, v127
    v_mul_u32_u24 v112, 96, v125
    v_mad_u32_u24 v113, v124, v127, v112
    v_mad_u32_u24 v64, v124, 0, v113
    v_mad_u32_u24 v65, v124, 1, v113
    v_mad_u32_u24 v66, v124, 2, v113
    v_mad_u32_u24 v67, v124, 3, v113
    v_mad_u32_u24 v68, v124, 4, v113
    v_mad_u32_u24 v69, v124, 5, v113
    v_mad_u32_u24 v70, v124, 6, v113
    v_mad_u32_u24 v71, v124, 7, v113
    v_and_b32 v64, 127, v64
    v_and_b32 v65, 127, v65
    v_and_b32 v66, 127, v66
    v_and_b32 v67, 127, v67
    v_and_b32 v68, 127, v68
    v_and_b32 v69, 127, v69
    v_and_b32 v70, 127, v70
    v_and_b32 v71, 127, v71
    v_cvt_f32_u32 v64, v64
    v_cvt_f32_u32 v65, v65
    v_cvt_f32_u32 v66, v66
    v_cvt_f32_u32 v67, v67
    v_cvt_f32_u32 v68, v68
    v_cvt_f32_u32 v69, v69
    v_cvt_f32_u32 v70, v70
    v_cvt_f32_u32 v71, v71
    v_mul_f32 v64, 0x3c000000, v64
    v_mul_f32 v65, 0x3c000000, v65
    v_mul_f32 v66, 0x3c000000, v66
    v_mul_f32 v67, 0x3c000000, v67
    v_mul_f32 v68, 0x3c000000, v68
    v_mul_f32 v69, 0x3c000000, v69
    v_mul_f32 v70, 0x3c000000, v70
    v_mul_f32 v71, 0x3c000000, v71
    v_cos_f32 v64, v64
    v_cos_f32 v65, v65
    v_cos_f32 v66, v66
    v_cos_f32 v67, v67
    v_cos_f32 v68, v68
    v_cos_f32 v69, v69
    v_cos_f32 v70, v70
    v_cos_f32 v71, v71
    s_nop 0
    v_cvt_pk_bf16_f32 v72, v64, v65
    v_cvt_pk_bf16_f32 v73, v66, v67
    v_cvt_pk_bf16_f32 v74, v68, v69
    v_cvt_pk_bf16_f32 v75, v70, v71
    v_lshlrev_b32 v80, 16, v72
    v_and_b32 v81, 0xffff0000, v72
    v_sub_f32 v64, v64, v80
    v_sub_f32 v65, v65, v81
    v_lshlrev_b32 v80, 16, v73
    v_and_b32 v81, 0xffff0000, v73
    v_sub_f32 v66, v66, v80
    v_sub_f32 v67, v67, v81
    v_lshlrev_b32 v80, 16, v74
    v_and_b32 v81, 0xffff0000, v74
    v_sub_f32 v68, v68, v80
    v_sub_f32 v69, v69, v81
    v_lshlrev_b32 v80, 16, v75
    v_and_b32 v81, 0xffff0000, v75
    v_sub_f32 v70, v70, v80
    v_sub_f32 v71, v71, v81
    v_cvt_pk_bf16_f32 v76, v64, v65
    v_cvt_pk_bf16_f32 v77, v66, v67
    v_cvt_pk_bf16_f32 v78, v68, v69
    v_cvt_pk_bf16_f32 v79, v70, v71
    v_cmp_lt_u32 vcc, 1, v123
    s_lshl_b32 s24, s3, 10
    v_add_u32 v114, s24, v121
    v_cndmask_b32 v72, v72, v76, vcc
    v_cndmask_b32 v73, v73, v77, vcc
    v_cndmask_b32 v74, v74, v78, vcc
    v_cndmask_b32 v75, v75, v79, vcc
    ds_write_b128 v114, v[72:75]
    v_lshrrev_b32 v112, 1, v123
    s_mov_b32 s24, 2097152
    v_mul_lo_u32 v112, v112, s24
    v_and_b32 v113, 1, v123
    v_lshl_add_u32 v112, v113, 8, v112
    v_and_b32 v113, 1, v122
    v_lshl_add_u32 v124, v113, 4, v112
    v_lshrrev_b32 v125, 1, v122
    s_mul_i32 s26, s3, 524288
    s_lshl_b32 s24, s11, 9
    s_add_u32 s26, s26, s24
    s_waitcnt lgkmcnt(0)
    s_barrier
    ds_read_b128 v[96:99], v121 offset:0
    ds_read_b128 v[100:103], v121 offset:1024
    ds_read_b128 v[104:107], v121 offset:2048
    ds_read_b128 v[108:111], v121 offset:3072
    s_mov_b32 s27, 0
    s_waitcnt vmcnt(0) lgkmcnt(0)
K1_W_LOOP:
    s_add_u32 s24, s11, s27
    s_and_b32 s30, s24, 3
    s_lshr_b32 s24, s24, 1
    s_and_b32 s24, s24, 4
    s_or_b32 s30, s30, s24
    v_xor_b32 v112, s30, v125
    v_lshl_add_u32 v120, v112, 5, v124
    s_lshl_b32 s25, s27, 9
    s_add_u32 s25, s25, s26
    v_perm_b32 v32, v4, v0, s28
    v_perm_b32 v36, v4, v0, s29
    v_perm_b32 v33, v12, v8, s28
    v_perm_b32 v37, v12, v8, s29
    v_perm_b32 v34, v20, v16, s28
    v_perm_b32 v38, v20, v16, s29
    v_perm_b32 v35, v28, v24, s28
    v_perm_b32 v39, v28, v24, s29
    v_perm_b32 v40, v5, v1, s28
    v_perm_b32 v44, v5, v1, s29
    v_perm_b32 v41, v13, v9, s28
    v_perm_b32 v45, v13, v9, s29
    v_perm_b32 v42, v21, v17, s28
    v_perm_b32 v46, v21, v17, s29
    v_perm_b32 v43, v29, v25, s28
    v_perm_b32 v47, v29, v25, s29
    v_perm_b32 v48, v6, v2, s28
    v_perm_b32 v52, v6, v2, s29
    v_perm_b32 v49, v14, v10, s28
    v_perm_b32 v53, v14, v10, s29
    v_perm_b32 v50, v22, v18, s28
    v_perm_b32 v54, v22, v18, s29
    v_perm_b32 v51, v30, v26, s28
    v_perm_b32 v55, v30, v26, s29
    v_perm_b32 v56, v7, v3, s28
    v_perm_b32 v60, v7, v3, s29
    v_perm_b32 v57, v15, v11, s28
    v_perm_b32 v61, v15, v11, s29
    v_perm_b32 v58, v23, v19, s28
    v_perm_b32 v62, v23, v19, s29
    v_perm_b32 v59, v31, v27, s28
    v_perm_b32 v63, v31, v27, s29
    s_add_u32 s27, s27, 1
    s_add_u32 s14, s14, 1024
    s_cmp_ge_u32 s27, 1
    s_cbranch_scc1 K1_W_NOLOAD
    s_mov_b32 s15, s14
    buffer_load_dwordx4 v[0:3], v126, s[16:19], s15 offen
    s_add_u32 s15, s15, 0x100000
    buffer_load_dwordx4 v[4:7], v126, s[16:19], s15 offen
    s_add_u32 s15, s15, 0x100000
    buffer_load_dwordx4 v[8:11], v126, s[16:19], s15 offen
    s_add_u32 s15, s15, 0x100000
    buffer_load_dwordx4 v[12:15], v126, s[16:19], s15 offen
    s_add_u32 s15, s15, 0x100000
    buffer_load_dwordx4 v[16:19], v126, s[16:19], s15 offen
    s_add_u32 s15, s15, 0x100000
    buffer_load_dwordx4 v[20:23], v126, s[16:19], s15 offen
    s_add_u32 s15, s15, 0x100000
    buffer_load_dwordx4 v[24:27], v126, s[16:19], s15 offen
    s_add_u32 s15, s15, 0x100000
    buffer_load_dwordx4 v[28:31], v126, s[16:19], s15 offen
K1_W_NOLOAD:
    v_mfma_f32_16x16x32_bf16 v[64:67], v[96:99], v[32:35], 0
    v_mfma_f32_16x16x32_bf16 v[68:71], v[96:99], v[36:39], 0
    v_mfma_f32_16x16x32_bf16 v[72:75], v[96:99], v[40:43], 0
    v_mfma_f32_16x16x32_bf16 v[76:79], v[96:99], v[44:47], 0
    v_mfma_f32_16x16x32_bf16 v[80:83], v[96:99], v[48:51], 0
    v_mfma_f32_16x16x32_bf16 v[84:87], v[96:99], v[52:55], 0
    v_mfma_f32_16x16x32_bf16 v[88:91], v[96:99], v[56:59], 0
    v_mfma_f32_16x16x32_bf16 v[92:95], v[96:99], v[60:63], 0
    s_nop 7
    v_cvt_pk_bf16_f32 v112, v64, v68
    v_cvt_pk_bf16_f32 v113, v72, v76
    v_cvt_pk_bf16_f32 v114, v80, v84
    v_cvt_pk_bf16_f32 v115, v88, v92
    buffer_store_dwordx4 v[112:115], v120, s[20:23], s25 offen
    s_add_u32 s25, s25, 4194304
    v_cvt_pk_bf16_f32 v116, v65, v69
    v_cvt_pk_bf16_f32 v117, v73, v77
    v_cvt_pk_bf16_f32 v118, v81, v85
    v_cvt_pk_bf16_f32 v119, v89, v93
    buffer_store_dwordx4 v[116:119], v120, s[20:23], s25 offen
    s_add_u32 s25, s25, 4194304
    v_cvt_pk_bf16_f32 v112, v66, v70
    v_cvt_pk_bf16_f32 v113, v74, v78
    v_cvt_pk_bf16_f32 v114, v82, v86
    v_cvt_pk_bf16_f32 v115, v90, v94
    buffer_store_dwordx4 v[112:115], v120, s[20:23], s25 offen
    s_add_u32 s25, s25, 4194304
    v_cvt_pk_bf16_f32 v116, v67, v71
    v_cvt_pk_bf16_f32 v117, v75, v79
    v_cvt_pk_bf16_f32 v118, v83, v87
    v_cvt_pk_bf16_f32 v119, v91, v95
    buffer_store_dwordx4 v[116:119], v120, s[20:23], s25 offen
    s_add_u32 s25, s25, 4194304
    v_mfma_f32_16x16x32_bf16 v[64:67], v[100:103], v[32:35], 0
    v_mfma_f32_16x16x32_bf16 v[68:71], v[100:103], v[36:39], 0
    v_mfma_f32_16x16x32_bf16 v[72:75], v[100:103], v[40:43], 0
    v_mfma_f32_16x16x32_bf16 v[76:79], v[100:103], v[44:47], 0
    v_mfma_f32_16x16x32_bf16 v[80:83], v[100:103], v[48:51], 0
    v_mfma_f32_16x16x32_bf16 v[84:87], v[100:103], v[52:55], 0
    v_mfma_f32_16x16x32_bf16 v[88:91], v[100:103], v[56:59], 0
    v_mfma_f32_16x16x32_bf16 v[92:95], v[100:103], v[60:63], 0
    s_nop 7
    v_cvt_pk_bf16_f32 v112, v64, v68
    v_cvt_pk_bf16_f32 v113, v72, v76
    v_cvt_pk_bf16_f32 v114, v80, v84
    v_cvt_pk_bf16_f32 v115, v88, v92
    buffer_store_dwordx4 v[112:115], v120, s[20:23], s25 offen
    s_add_u32 s25, s25, 4194304
    v_cvt_pk_bf16_f32 v116, v65, v69
    v_cvt_pk_bf16_f32 v117, v73, v77
    v_cvt_pk_bf16_f32 v118, v81, v85
    v_cvt_pk_bf16_f32 v119, v89, v93
    buffer_store_dwordx4 v[116:119], v120, s[20:23], s25 offen
    s_add_u32 s25, s25, 4194304
    v_cvt_pk_bf16_f32 v112, v66, v70
    v_cvt_pk_bf16_f32 v113, v74, v78
    v_cvt_pk_bf16_f32 v114, v82, v86
    v_cvt_pk_bf16_f32 v115, v90, v94
    buffer_store_dwordx4 v[112:115], v120, s[20:23], s25 offen
    s_add_u32 s25, s25, 4194304
    v_cvt_pk_bf16_f32 v116, v67, v71
    v_cvt_pk_bf16_f32 v117, v75, v79
    v_cvt_pk_bf16_f32 v118, v83, v87
    v_cvt_pk_bf16_f32 v119, v91, v95
    buffer_store_dwordx4 v[116:119], v120, s[20:23], s25 offen
    s_add_u32 s25, s25, 4194304
    v_mfma_f32_16x16x32_bf16 v[64:67], v[104:107], v[32:35], 0
    v_mfma_f32_16x16x32_bf16 v[68:71], v[104:107], v[36:39], 0
    v_mfma_f32_16x16x32_bf16 v[72:75], v[104:107], v[40:43], 0
    v_mfma_f32_16x16x32_bf16 v[76:79], v[104:107], v[44:47], 0
    v_mfma_f32_16x16x32_bf16 v[80:83], v[104:107], v[48:51], 0
    v_mfma_f32_16x16x32_bf16 v[84:87], v[104:107], v[52:55], 0
    v_mfma_f32_16x16x32_bf16 v[88:91], v[104:107], v[56:59], 0
    v_mfma_f32_16x16x32_bf16 v[92:95], v[104:107], v[60:63], 0
    s_nop 7
    v_cvt_pk_bf16_f32 v112, v64, v68
    v_cvt_pk_bf16_f32 v113, v72, v76
    v_cvt_pk_bf16_f32 v114, v80, v84
    v_cvt_pk_bf16_f32 v115, v88, v92
    buffer_store_dwordx4 v[112:115], v120, s[20:23], s25 offen
    s_add_u32 s25, s25, 4194304
    v_cvt_pk_bf16_f32 v116, v65, v69
    v_cvt_pk_bf16_f32 v117, v73, v77
    v_cvt_pk_bf16_f32 v118, v81, v85
    v_cvt_pk_bf16_f32 v119, v89, v93
    buffer_store_dwordx4 v[116:119], v120, s[20:23], s25 offen
    s_add_u32 s25, s25, 4194304
    v_cvt_pk_bf16_f32 v112, v66, v70
    v_cvt_pk_bf16_f32 v113, v74, v78
    v_cvt_pk_bf16_f32 v114, v82, v86
    v_cvt_pk_bf16_f32 v115, v90, v94
    buffer_store_dwordx4 v[112:115], v120, s[20:23], s25 offen
    s_add_u32 s25, s25, 4194304
    v_cvt_pk_bf16_f32 v116, v67, v71
    v_cvt_pk_bf16_f32 v117, v75, v79
    v_cvt_pk_bf16_f32 v118, v83, v87
    v_cvt_pk_bf16_f32 v119, v91, v95
    buffer_store_dwordx4 v[116:119], v120, s[20:23], s25 offen
    s_add_u32 s25, s25, 4194304
    v_mfma_f32_16x16x32_bf16 v[64:67], v[108:111], v[32:35], 0
    v_mfma_f32_16x16x32_bf16 v[68:71], v[108:111], v[36:39], 0
    v_mfma_f32_16x16x32_bf16 v[72:75], v[108:111], v[40:43], 0
    v_mfma_f32_16x16x32_bf16 v[76:79], v[108:111], v[44:47], 0
    v_mfma_f32_16x16x32_bf16 v[80:83], v[108:111], v[48:51], 0
    v_mfma_f32_16x16x32_bf16 v[84:87], v[108:111], v[52:55], 0
    v_mfma_f32_16x16x32_bf16 v[88:91], v[108:111], v[56:59], 0
    v_mfma_f32_16x16x32_bf16 v[92:95], v[108:111], v[60:63], 0
    s_nop 7
    v_cvt_pk_bf16_f32 v112, v64, v68
    v_cvt_pk_bf16_f32 v113, v72, v76
    v_cvt_pk_bf16_f32 v114, v80, v84
    v_cvt_pk_bf16_f32 v115, v88, v92
    buffer_store_dwordx4 v[112:115], v120, s[20:23], s25 offen
    s_add_u32 s25, s25, 4194304
    v_cvt_pk_bf16_f32 v116, v65, v69
    v_cvt_pk_bf16_f32 v117, v73, v77
    v_cvt_pk_bf16_f32 v118, v81, v85
    v_cvt_pk_bf16_f32 v119, v89, v93
    buffer_store_dwordx4 v[116:119], v120, s[20:23], s25 offen
    s_add_u32 s25, s25, 4194304
    v_cvt_pk_bf16_f32 v112, v66, v70
    v_cvt_pk_bf16_f32 v113, v74, v78
    v_cvt_pk_bf16_f32 v114, v82, v86
    v_cvt_pk_bf16_f32 v115, v90, v94
    buffer_store_dwordx4 v[112:115], v120, s[20:23], s25 offen
    s_add_u32 s25, s25, 4194304
    v_cvt_pk_bf16_f32 v116, v67, v71
    v_cvt_pk_bf16_f32 v117, v75, v79
    v_cvt_pk_bf16_f32 v118, v83, v87
    v_cvt_pk_bf16_f32 v119, v91, v95
    buffer_store_dwordx4 v[116:119], v120, s[20:23], s25 offen
    s_waitcnt vmcnt(16)
    s_cmp_lt_u32 s27, 1
    s_cbranch_scc1 K1_W_LOOP
K1_END:
    s_endpgm
.p2align 8
.type k12_fused_kernel,@function
k12_fused_kernel:
    s_cmp_ge_u32 s2, 256
    s_cbranch_scc1 K12_END
    s_load_dwordx4 s[52:55], s[0:1], 0
    s_load_dwordx4 s[56:59], s[0:1], 40
    s_getpc_b64 s[90:91]
CPF_K12:
    s_sub_u32 s90, s90, CPF_K12-k12_fused_kernel
    s_subb_u32 s91, s91, 0
    v_lshlrev_b32 v8, 7, v0
    v_mov_b32 v11, s91
    v_min_u32 v9, TEXT_END-k12_fused_kernel-4, v8
    v_add_co_u32 v10, vcc, s90, v9
    v_addc_co_u32 v11, vcc, 0, v11, vcc
    global_load_dword v63, v[10:11], off
    v_lshrrev_b32 v1, 6, v0
    v_and_b32 v2, 63, v0
    v_readfirstlane_b32 s3, v1
    s_waitcnt lgkmcnt(0)
    s_cmp_lt_u32 s3, 4
    s_cbranch_scc1 K12_CONS
    v_and_b32 v64, 15, v2
    v_lshrrev_b32 v65, 4, v2
    v_lshlrev_b32 v254, 4, v2
    s_and_b32 s44, s3, 3
    s_and_b32 s20, s44, 1
    s_lshr_b32 s21, s44, 1
    s_lshl_b32 s22, s2, 1
    s_add_u32 s22, s22, s21
    s_and_b32 s23, s22, 3
    s_lshr_b32 s22, s22, 2
    s_and_b32 s24, s2, 7
    s_lshl_b32 s24, s24, 5
    s_lshr_b32 s25, s2, 3
    s_add_u32 s24, s24, s25
    s_cmp_ge_u32 s24, 167
    s_cselect_b32 s25, 1, 0
    s_mul_i32 s26, s25, 167
    s_sub_u32 s24, s24, s26
    s_cmp_eq_u32 s21, 0
    s_cselect_b32 s25, s25, 1
    s_mul_i32 s26, s25, 16384000
    s_add_u32 s4, s52, s26
    s_addc_u32 s5, s53, 0
    s_and_b32 s5, s5, 0xffff
    s_mov_b32 s6, 16384000
    s_mov_b32 s7, 0x00020000
    s_mov_b32 s8, s54
    s_mov_b32 s9, s55
    s_and_b32 s9, s9, 0xffff
    s_mov_b32 s10, 16252928
    s_mov_b32 s11, 0x00020000
    s_mov_b32 s12, s58
    s_mov_b32 s13, s59
    s_and_b32 s13, s13, 0xffff
    s_mov_b32 s14, 43778048
    s_mov_b32 s15, 0x00020000
    s_add_u32 s16, s58, 50331648
    s_addc_u32 s17, s59, 0
    s_and_b32 s17, s17, 0xffff
    s_mov_b32 s18, 67108864
    s_mov_b32 s19, 0x00020000
    s_add_u32 s60, s58, 153092096
    s_addc_u32 s61, s59, 0
    s_and_b32 s61, s61, 0xffff
    s_mov_b32 s62, 32768
    s_mov_b32 s63, 0x00020000
    s_mov_b32 s28, 0x05040100
    s_mov_b32 s29, 0x07060302
    v_lshlrev_b32 v248, 14, v65
    v_lshl_add_u32 v248, v64, 4, v248
    v_and_b32 v250, 1, v65
    v_lshlrev_b32 v250, 23, v250
    v_lshl_add_u32 v250, v64, 4, v250
    v_lshrrev_b32 v66, 1, v65
    s_mov_b32 s26, 1368064
    v_mul_lo_u32 v66, v66, s26
    v_lshrrev_b32 v67, 2, v64
    s_mov_b32 s26, 21376
    v_mul_lo_u32 v67, v67, s26
    v_add_u32 v66, v66, v67
    v_mov_b32 v252, v66
    v_lshrrev_b32 v66, 1, v65
    s_mov_b32 s26, 2097152
    v_mul_lo_u32 v66, v66, s26
    v_and_b32 v67, 1, v65
    v_lshl_add_u32 v66, v67, 8, v66
    v_and_b32 v67, 1, v64
    v_lshl_add_u32 v251, v67, 4, v66
    s_mul_i32 s31, s25, 684032
    s_mul_i32 s32, s23, 524288
    s_lshl_b32 s33, s23, 8
    s_mov_b32 s40, 3
    s_xor_b32 s43, s40, s20
    s_and_b32 s43, s43, 1
    s_mul_i32 s36, s40, 85
    s_add_u32 s36, s36, s2
    s_and_b32 s36, s36, 255
    s_mul_hi_u32 s37, s36, 0x55555556
    s_mul_i32 s38, s37, 3
    s_cmp_eq_u32 s38, s36
    s_cselect_b32 s27, 1, 0
    s_cmp_lt_u32 s37, 78
    s_cselect_b32 s27, s27, 0
    s_add_u32 s37, s37, 89
    s_cmp_eq_u32 s21, 0
    s_cselect_b32 s30, s24, s37
    s_cselect_b32 s27, 1, s27
    s_cmp_eq_u32 s43, 0
    s_cbranch_scc0 K12_PL1
    s_lshl_b32 s36, s40, 7
    s_add_u32 s36, s36, s22
    s_lshr_b32 s37, s36, 9
    s_lshl_b32 s37, s37, 19
    s_and_b32 s36, s36, 511
    s_lshl_b32 s36, s36, 10
    s_add_u32 s36, s36, s37
    s_add_u32 s36, s36, s33
    buffer_load_dwordx4 v[96:99], v250, s[8:11], s36 offen
    s_add_u32 s36, s36, 0x100000
    buffer_load_dwordx4 v[100:103], v250, s[8:11], s36 offen
    s_add_u32 s36, s36, 0x100000
    buffer_load_dwordx4 v[104:107], v250, s[8:11], s36 offen
    s_add_u32 s36, s36, 0x100000
    buffer_load_dwordx4 v[108:111], v250, s[8:11], s36 offen
    s_add_u32 s36, s36, 0x100000
    buffer_load_dwordx4 v[112:115], v250, s[8:11], s36 offen
    s_add_u32 s36, s36, 0x100000
    buffer_load_dwordx4 v[116:119], v250, s[8:11], s36 offen
    s_add_u32 s36, s36, 0x100000
    buffer_load_dwordx4 v[120:123], v250, s[8:11], s36 offen
    s_add_u32 s36, s36, 0x100000
    buffer_load_dwordx4 v[124:127], v250, s[8:11], s36 offen
    s_branch K12_PL2
K12_PL1:
    s_cmp_eq_u32 s27, 0
    s_cbranch_scc1 K12_PL2
    s_lshl_b32 s36, s40, 8
    s_mul_i32 s37, s30, 98304
    s_add_u32 s36, s36, s37
    buffer_load_dwordx4 v[0:3], v248, s[4:7], s36 offen
    buffer_load_dwordx4 v[4:7], v248, s[4:7], s36 offen offset:2048
    s_add_u32 s36, s36, 4096
    buffer_load_dwordx4 v[8:11], v248, s[4:7], s36 offen
    buffer_load_dwordx4 v[12:15], v248, s[4:7], s36 offen offset:2048
    s_add_u32 s36, s36, 4096
    buffer_load_dwordx4 v[16:19], v248, s[4:7], s36 offen
    buffer_load_dwordx4 v[20:23], v248, s[4:7], s36 offen offset:2048
    s_add_u32 s36, s36, 4096
    buffer_load_dwordx4 v[24:27], v248, s[4:7], s36 offen
    buffer_load_dwordx4 v[28:31], v248, s[4:7], s36 offen offset:2048
    s_add_u32 s36, s36, 53248
    buffer_load_dwordx4 v[32:35], v248, s[4:7], s36 offen
    buffer_load_dwordx4 v[36:39], v248, s[4:7], s36 offen offset:2048
    s_add_u32 s36, s36, 4096
    buffer_load_dwordx4 v[40:43], v248, s[4:7], s36 offen
    buffer_load_dwordx4 v[44:47], v248, s[4:7], s36 offen offset:2048
    s_add_u32 s36, s36, 4096
    buffer_load_dwordx4 v[48:51], v248, s[4:7], s36 offen
    buffer_load_dwordx4 v[52:55], v248, s[4:7], s36 offen offset:2048
    s_add_u32 s36, s36, 4096
    buffer_load_dwordx4 v[56:59], v248, s[4:7], s36 offen
    buffer_load_dwordx4 v[60:63], v248, s[4:7], s36 offen offset:2048
K12_PL2:
    v_and_b32 v128, 3, v64
    v_lshlrev_b32 v128, 2, v128
    v_lshrrev_b32 v130, 3, v64
    v_lshl_add_u32 v128, v130, 1, v128
    s_lshl_b32 s36, s44, 4
    s_add_u32 s36, s36, 1
    v_add_u32 v128, s36, v128
    v_bfe_u32 v129, v64, 2, 1
    v_lshlrev_b32 v131, 3, v65
    v_lshlrev_b32 v132, 5, v129
    v_mad_u32_u24 v133, v128, v131, v132
    v_mad_u32_u24 v136, v128, 0, v133
    v_mad_u32_u24 v137, v128, 1, v133
    v_mad_u32_u24 v138, v128, 2, v133
    v_mad_u32_u24 v139, v128, 3, v133
    v_mad_u32_u24 v140, v128, 4, v133
    v_mad_u32_u24 v141, v128, 5, v133
    v_mad_u32_u24 v142, v128, 6, v133
    v_mad_u32_u24 v143, v128, 7, v133
    v_and_b32 v136, 127, v136
    v_and_b32 v137, 127, v137
    v_and_b32 v138, 127, v138
    v_and_b32 v139, 127, v139
    v_and_b32 v140, 127, v140
    v_and_b32 v141, 127, v141
    v_and_b32 v142, 127, v142
    v_and_b32 v143, 127, v143
    v_cvt_f32_u32 v136, v136
    v_cvt_f32_u32 v137, v137
    v_cvt_f32_u32 v138, v138
    v_cvt_f32_u32 v139, v139
    v_cvt_f32_u32 v140, v140
    v_cvt_f32_u32 v141, v141
    v_cvt_f32_u32 v142, v142
    v_cvt_f32_u32 v143, v143
    v_mul_f32 v136, 0x3c000000, v136
    v_mul_f32 v137, 0x3c000000, v137
    v_mul_f32 v138, 0x3c000000, v138
    v_mul_f32 v139, 0x3c000000, v139
    v_mul_f32 v140, 0x3c000000, v140
    v_mul_f32 v141, 0x3c000000, v141
    v_mul_f32 v142, 0x3c000000, v142
    v_mul_f32 v143, 0x3c000000, v143
    v_cos_f32 v136, v136
    v_cos_f32 v137, v137
    v_cos_f32 v138, v138
    v_cos_f32 v139, v139
    v_cos_f32 v140, v140
    v_cos_f32 v141, v141
    v_cos_f32 v142, v142
    v_cos_f32 v143, v143
    s_nop 0
    v_cvt_pk_bf16_f32 v144, v136, v137
    v_cvt_pk_bf16_f32 v145, v138, v139
    v_cvt_pk_bf16_f32 v146, v140, v141
    v_cvt_pk_bf16_f32 v147, v142, v143
    v_lshlrev_b32 v152, 16, v144
    v_and_b32 v153, 0xffff0000, v144
    v_sub_f32 v136, v136, v152
    v_sub_f32 v137, v137, v153
    v_lshlrev_b32 v152, 16, v145
    v_and_b32 v153, 0xffff0000, v145
    v_sub_f32 v138, v138, v152
    v_sub_f32 v139, v139, v153
    v_lshlrev_b32 v152, 16, v146
    v_and_b32 v153, 0xffff0000, v146
    v_sub_f32 v140, v140, v152
    v_sub_f32 v141, v141, v153
    v_lshlrev_b32 v152, 16, v147
    v_and_b32 v153, 0xffff0000, v147
    v_sub_f32 v142, v142, v152
    v_sub_f32 v143, v143, v153
    v_cvt_pk_bf16_f32 v148, v136, v137
    v_cvt_pk_bf16_f32 v149, v138, v139
    v_cvt_pk_bf16_f32 v150, v140, v141
    v_cvt_pk_bf16_f32 v151, v142, v143
    s_lshl_b32 s37, s44, 12
    s_add_u32 s37, s37, 116736
    v_add_u32 v132, s37, v254
    ds_write_b128 v132, v[144:147]
    ds_write_b128 v132, v[148:151] offset:1024
    v_add_u32 v131, 32, v131
    v_lshlrev_b32 v132, 5, v129
    v_mad_u32_u24 v133, v128, v131, v132
    v_mad_u32_u24 v136, v128, 0, v133
    v_mad_u32_u24 v137, v128, 1, v133
    v_mad_u32_u24 v138, v128, 2, v133
    v_mad_u32_u24 v139, v128, 3, v133
    v_mad_u32_u24 v140, v128, 4, v133
    v_mad_u32_u24 v141, v128, 5, v133
    v_mad_u32_u24 v142, v128, 6, v133
    v_mad_u32_u24 v143, v128, 7, v133
    v_and_b32 v136, 127, v136
    v_and_b32 v137, 127, v137
    v_and_b32 v138, 127, v138
    v_and_b32 v139, 127, v139
    v_and_b32 v140, 127, v140
    v_and_b32 v141, 127, v141
    v_and_b32 v142, 127, v142
    v_and_b32 v143, 127, v143
    v_cvt_f32_u32 v136, v136
    v_cvt_f32_u32 v137, v137
    v_cvt_f32_u32 v138, v138
    v_cvt_f32_u32 v139, v139
    v_cvt_f32_u32 v140, v140
    v_cvt_f32_u32 v141, v141
    v_cvt_f32_u32 v142, v142
    v_cvt_f32_u32 v143, v143
    v_mul_f32 v136, 0x3c000000, v136
    v_mul_f32 v137, 0x3c000000, v137
    v_mul_f32 v138, 0x3c000000, v138
    v_mul_f32 v139, 0x3c000000, v139
    v_mul_f32 v140, 0x3c000000, v140
    v_mul_f32 v141, 0x3c000000, v141
    v_mul_f32 v142, 0x3c000000, v142
    v_mul_f32 v143, 0x3c000000, v143
    v_cos_f32 v136, v136
    v_cos_f32 v137, v137
    v_cos_f32 v138, v138
    v_cos_f32 v139, v139
    v_cos_f32 v140, v140
    v_cos_f32 v141, v141
    v_cos_f32 v142, v142
    v_cos_f32 v143, v143
    s_nop 0
    v_cvt_pk_bf16_f32 v144, v136, v137
    v_cvt_pk_bf16_f32 v145, v138, v139
    v_cvt_pk_bf16_f32 v146, v140, v141
    v_cvt_pk_bf16_f32 v147, v142, v143
    v_lshlrev_b32 v152, 16, v144
    v_and_b32 v153, 0xffff0000, v144
    v_sub_f32 v136, v136, v152
    v_sub_f32 v137, v137, v153
    v_lshlrev_b32 v152, 16, v145
    v_and_b32 v153, 0xffff0000, v145
    v_sub_f32 v138, v138, v152
    v_sub_f32 v139, v139, v153
    v_lshlrev_b32 v152, 16, v146
    v_and_b32 v153, 0xffff0000, v146
    v_sub_f32 v140, v140, v152
    v_sub_f32 v141, v141, v153
    v_lshlrev_b32 v152, 16, v147
    v_and_b32 v153, 0xffff0000, v147
    v_sub_f32 v142, v142, v152
    v_sub_f32 v143, v143, v153
    v_cvt_pk_bf16_f32 v148, v136, v137
    v_cvt_pk_bf16_f32 v149, v138, v139
    v_cvt_pk_bf16_f32 v150, v140, v141
    v_cvt_pk_bf16_f32 v151, v142, v143
    s_lshl_b32 s37, s44, 12
    s_add_u32 s37, s37, 118784
    v_add_u32 v132, s37, v254
    ds_write_b128 v132, v[144:147]
    ds_write_b128 v132, v[148:151] offset:1024
K12_TB:
    s_waitcnt lgkmcnt(0)
    s_barrier
    v_add_u32 v255, 116736, v254
    ds_read_b128 v[160:163], v255 offset:0
    ds_read_b128 v[192:195], v255 offset:1024
    ds_read_b128 v[164:167], v255 offset:2048
    ds_read_b128 v[196:199], v255 offset:3072
    ds_read_b128 v[168:171], v255 offset:4096
    ds_read_b128 v[200:203], v255 offset:5120
    ds_read_b128 v[172:175], v255 offset:6144
    ds_read_b128 v[204:207], v255 offset:7168
    s_waitcnt lgkmcnt(0)
    ds_read_b128 v[176:179], v255 offset:8192
    ds_read_b128 v[208:211], v255 offset:9216
    ds_read_b128 v[180:183], v255 offset:10240
    ds_read_b128 v[212:215], v255 offset:11264
    ds_read_b128 v[184:187], v255 offset:12288
    ds_read_b128 v[216:219], v255 offset:13312
    ds_read_b128 v[188:191], v255 offset:14336
    ds_read_b128 v[220:223], v255 offset:15360
    ds_read_b128 v[224:227], v255 offset:16384
    ds_read_b128 v[228:231], v255 offset:17408
    ds_read_b128 v[232:235], v255 offset:18432
    ds_read_b128 v[236:239], v255 offset:19456
    s_waitcnt lgkmcnt(0)
    s_barrier
    s_waitcnt vmcnt(0) lgkmcnt(0)
    s_mov_b32 s41, -1
    s_mov_b32 s34, -1
    s_branch K12_PROD
    s_cmp_lt_u32 s3, 4
    s_cbranch_scc0 K12_PROD
    s_cmp_eq_u32 s43, 0
    s_cbranch_scc0 K12_H1
    v_perm_b32 v64, v100, v96, s28
    v_perm_b32 v68, v100, v96, s29
    v_perm_b32 v65, v108, v104, s28
    v_perm_b32 v69, v108, v104, s29
    v_perm_b32 v66, v116, v112, s28
    v_perm_b32 v70, v116, v112, s29
    v_perm_b32 v67, v124, v120, s28
    v_perm_b32 v71, v124, v120, s29
    v_perm_b32 v72, v101, v97, s28
    v_perm_b32 v76, v101, v97, s29
    v_perm_b32 v73, v109, v105, s28
    v_perm_b32 v77, v109, v105, s29
    v_perm_b32 v74, v117, v113, s28
    v_perm_b32 v78, v117, v113, s29
    v_perm_b32 v75, v125, v121, s28
    v_perm_b32 v79, v125, v121, s29
    v_perm_b32 v80, v102, v98, s28
    v_perm_b32 v84, v102, v98, s29
    v_perm_b32 v81, v110, v106, s28
    v_perm_b32 v85, v110, v106, s29
    v_perm_b32 v82, v118, v114, s28
    v_perm_b32 v86, v118, v114, s29
    v_perm_b32 v83, v126, v122, s28
    v_perm_b32 v87, v126, v122, s29
    v_perm_b32 v88, v103, v99, s28
    v_perm_b32 v92, v103, v99, s29
    v_perm_b32 v89, v111, v107, s28
    v_perm_b32 v93, v111, v107, s29
    v_perm_b32 v90, v119, v115, s28
    v_perm_b32 v94, v119, v115, s29
    v_perm_b32 v91, v127, v123, s28
    v_perm_b32 v95, v127, v123, s29
    s_lshl_b32 s36, s40, 7
    s_add_u32 s36, s36, s22
    s_and_b32 s37, s36, 3
    s_lshr_b32 s38, s36, 1
    s_and_b32 s38, s38, 4
    s_or_b32 s37, s37, s38
    v_bfe_u32 v253, v254, 5, 3
    v_xor_b32 v253, s37, v253
    v_lshl_add_u32 v253, v253, 5, v251
    s_lshl_b32 s36, s36, 9
    s_add_u32 s39, s36, s32
    s_setprio 1
    v_mfma_f32_16x16x32_bf16 v[128:131], v[224:227], v[64:67], 0
    v_mfma_f32_16x16x32_bf16 v[132:135], v[224:227], v[68:71], 0
    v_mfma_f32_16x16x32_bf16 v[136:139], v[224:227], v[72:75], 0
    v_mfma_f32_16x16x32_bf16 v[140:143], v[224:227], v[76:79], 0
    v_mfma_f32_16x16x32_bf16 v[144:147], v[224:227], v[80:83], 0
    v_mfma_f32_16x16x32_bf16 v[148:151], v[224:227], v[84:87], 0
    v_mfma_f32_16x16x32_bf16 v[152:155], v[224:227], v[88:91], 0
    v_mfma_f32_16x16x32_bf16 v[156:159], v[224:227], v[92:95], 0
    s_setprio 0
    s_nop 7
    v_cvt_pk_bf16_f32 v240, v128, v132
    v_cvt_pk_bf16_f32 v241, v136, v140
    v_cvt_pk_bf16_f32 v242, v144, v148
    v_cvt_pk_bf16_f32 v243, v152, v156
    buffer_store_dwordx4 v[240:243], v253, s[16:19], s39 offen sc1
    s_add_u32 s39, s39, 4194304
    v_cvt_pk_bf16_f32 v244, v129, v133
    v_cvt_pk_bf16_f32 v245, v137, v141
    v_cvt_pk_bf16_f32 v246, v145, v149
    v_cvt_pk_bf16_f32 v247, v153, v157
    buffer_store_dwordx4 v[244:247], v253, s[16:19], s39 offen sc1
    s_add_u32 s39, s39, 4194304
    v_cvt_pk_bf16_f32 v240, v130, v134
    v_cvt_pk_bf16_f32 v241, v138, v142
    v_cvt_pk_bf16_f32 v242, v146, v150
    v_cvt_pk_bf16_f32 v243, v154, v158
    buffer_store_dwordx4 v[240:243], v253, s[16:19], s39 offen sc1
    s_add_u32 s39, s39, 4194304
    v_cvt_pk_bf16_f32 v244, v131, v135
    v_cvt_pk_bf16_f32 v245, v139, v143
    v_cvt_pk_bf16_f32 v246, v147, v151
    v_cvt_pk_bf16_f32 v247, v155, v159
    buffer_store_dwordx4 v[244:247], v253, s[16:19], s39 offen sc1
    s_add_u32 s39, s39, 4194304
    s_setprio 1
    v_mfma_f32_16x16x32_bf16 v[128:131], v[228:231], v[64:67], 0
    v_mfma_f32_16x16x32_bf16 v[132:135], v[228:231], v[68:71], 0
    v_mfma_f32_16x16x32_bf16 v[136:139], v[228:231], v[72:75], 0
    v_mfma_f32_16x16x32_bf16 v[140:143], v[228:231], v[76:79], 0
    v_mfma_f32_16x16x32_bf16 v[144:147], v[228:231], v[80:83], 0
    v_mfma_f32_16x16x32_bf16 v[148:151], v[228:231], v[84:87], 0
    v_mfma_f32_16x16x32_bf16 v[152:155], v[228:231], v[88:91], 0
    v_mfma_f32_16x16x32_bf16 v[156:159], v[228:231], v[92:95], 0
    s_setprio 0
    s_nop 7
    v_cvt_pk_bf16_f32 v240, v128, v132
    v_cvt_pk_bf16_f32 v241, v136, v140
    v_cvt_pk_bf16_f32 v242, v144, v148
    v_cvt_pk_bf16_f32 v243, v152, v156
    buffer_store_dwordx4 v[240:243], v253, s[16:19], s39 offen sc1
    s_add_u32 s39, s39, 4194304
    v_cvt_pk_bf16_f32 v244, v129, v133
    v_cvt_pk_bf16_f32 v245, v137, v141
    v_cvt_pk_bf16_f32 v246, v145, v149
    v_cvt_pk_bf16_f32 v247, v153, v157
    buffer_store_dwordx4 v[244:247], v253, s[16:19], s39 offen sc1
    s_add_u32 s39, s39, 4194304
    v_cvt_pk_bf16_f32 v240, v130, v134
    v_cvt_pk_bf16_f32 v241, v138, v142
    v_cvt_pk_bf16_f32 v242, v146, v150
    v_cvt_pk_bf16_f32 v243, v154, v158
    buffer_store_dwordx4 v[240:243], v253, s[16:19], s39 offen sc1
    s_add_u32 s39, s39, 4194304
    v_cvt_pk_bf16_f32 v244, v131, v135
    v_cvt_pk_bf16_f32 v245, v139, v143
    v_cvt_pk_bf16_f32 v246, v147, v151
    v_cvt_pk_bf16_f32 v247, v155, v159
    buffer_store_dwordx4 v[244:247], v253, s[16:19], s39 offen sc1
    s_add_u32 s39, s39, 4194304
    s_setprio 1
    v_mfma_f32_16x16x32_bf16 v[128:131], v[232:235], v[64:67], 0
    v_mfma_f32_16x16x32_bf16 v[132:135], v[232:235], v[68:71], 0
    v_mfma_f32_16x16x32_bf16 v[136:139], v[232:235], v[72:75], 0
    v_mfma_f32_16x16x32_bf16 v[140:143], v[232:235], v[76:79], 0
    v_mfma_f32_16x16x32_bf16 v[144:147], v[232:235], v[80:83], 0
    v_mfma_f32_16x16x32_bf16 v[148:151], v[232:235], v[84:87], 0
    v_mfma_f32_16x16x32_bf16 v[152:155], v[232:235], v[88:91], 0
    v_mfma_f32_16x16x32_bf16 v[156:159], v[232:235], v[92:95], 0
    s_setprio 0
    s_nop 7
    v_cvt_pk_bf16_f32 v240, v128, v132
    v_cvt_pk_bf16_f32 v241, v136, v140
    v_cvt_pk_bf16_f32 v242, v144, v148
    v_cvt_pk_bf16_f32 v243, v152, v156
    buffer_store_dwordx4 v[240:243], v253, s[16:19], s39 offen sc1
    s_add_u32 s39, s39, 4194304
    v_cvt_pk_bf16_f32 v244, v129, v133
    v_cvt_pk_bf16_f32 v245, v137, v141
    v_cvt_pk_bf16_f32 v246, v145, v149
    v_cvt_pk_bf16_f32 v247, v153, v157
    buffer_store_dwordx4 v[244:247], v253, s[16:19], s39 offen sc1
    s_add_u32 s39, s39, 4194304
    v_cvt_pk_bf16_f32 v240, v130, v134
    v_cvt_pk_bf16_f32 v241, v138, v142
    v_cvt_pk_bf16_f32 v242, v146, v150
    v_cvt_pk_bf16_f32 v243, v154, v158
    buffer_store_dwordx4 v[240:243], v253, s[16:19], s39 offen sc1
    s_add_u32 s39, s39, 4194304
    v_cvt_pk_bf16_f32 v244, v131, v135
    v_cvt_pk_bf16_f32 v245, v139, v143
    v_cvt_pk_bf16_f32 v246, v147, v151
    v_cvt_pk_bf16_f32 v247, v155, v159
    buffer_store_dwordx4 v[244:247], v253, s[16:19], s39 offen sc1
    s_add_u32 s39, s39, 4194304
    s_setprio 1
    v_mfma_f32_16x16x32_bf16 v[128:131], v[236:239], v[64:67], 0
    v_mfma_f32_16x16x32_bf16 v[132:135], v[236:239], v[68:71], 0
    v_mfma_f32_16x16x32_bf16 v[136:139], v[236:239], v[72:75], 0
    v_mfma_f32_16x16x32_bf16 v[140:143], v[236:239], v[76:79], 0
    v_mfma_f32_16x16x32_bf16 v[144:147], v[236:239], v[80:83], 0
    v_mfma_f32_16x16x32_bf16 v[148:151], v[236:239], v[84:87], 0
    v_mfma_f32_16x16x32_bf16 v[152:155], v[236:239], v[88:91], 0
    v_mfma_f32_16x16x32_bf16 v[156:159], v[236:239], v[92:95], 0
    s_setprio 0
    s_nop 7
    v_cvt_pk_bf16_f32 v240, v128, v132
    v_cvt_pk_bf16_f32 v241, v136, v140
    v_cvt_pk_bf16_f32 v242, v144, v148
    v_cvt_pk_bf16_f32 v243, v152, v156
    buffer_store_dwordx4 v[240:243], v253, s[16:19], s39 offen sc1
    s_add_u32 s39, s39, 4194304
    v_cvt_pk_bf16_f32 v244, v129, v133
    v_cvt_pk_bf16_f32 v245, v137, v141
    v_cvt_pk_bf16_f32 v246, v145, v149
    v_cvt_pk_bf16_f32 v247, v153, v157
    buffer_store_dwordx4 v[244:247], v253, s[16:19], s39 offen sc1
    s_add_u32 s39, s39, 4194304
    v_cvt_pk_bf16_f32 v240, v130, v134
    v_cvt_pk_bf16_f32 v241, v138, v142
    v_cvt_pk_bf16_f32 v242, v146, v150
    v_cvt_pk_bf16_f32 v243, v154, v158
    buffer_store_dwordx4 v[240:243], v253, s[16:19], s39 offen sc1
    s_add_u32 s39, s39, 4194304
    v_cvt_pk_bf16_f32 v244, v131, v135
    v_cvt_pk_bf16_f32 v245, v139, v143
    v_cvt_pk_bf16_f32 v246, v147, v151
    v_cvt_pk_bf16_f32 v247, v155, v159
    buffer_store_dwordx4 v[244:247], v253, s[16:19], s39 offen sc1
    s_branch K12_H2
K12_H1:
    s_cmp_eq_u32 s27, 0
    s_cbranch_scc1 K12_H2
    v_perm_b32 v64, v4, v0, s28
    v_perm_b32 v68, v4, v0, s29
    v_perm_b32 v65, v12, v8, s28
    v_perm_b32 v69, v12, v8, s29
    v_perm_b32 v66, v20, v16, s28
    v_perm_b32 v70, v20, v16, s29
    v_perm_b32 v67, v28, v24, s28
    v_perm_b32 v71, v28, v24, s29
    v_perm_b32 v72, v5, v1, s28
    v_perm_b32 v76, v5, v1, s29
    v_perm_b32 v73, v13, v9, s28
    v_perm_b32 v77, v13, v9, s29
    v_perm_b32 v74, v21, v17, s28
    v_perm_b32 v78, v21, v17, s29
    v_perm_b32 v75, v29, v25, s28
    v_perm_b32 v79, v29, v25, s29
    v_perm_b32 v80, v6, v2, s28
    v_perm_b32 v84, v6, v2, s29
    v_perm_b32 v81, v14, v10, s28
    v_perm_b32 v85, v14, v10, s29
    v_perm_b32 v82, v22, v18, s28
    v_perm_b32 v86, v22, v18, s29
    v_perm_b32 v83, v30, v26, s28
    v_perm_b32 v87, v30, v26, s29
    v_perm_b32 v88, v7, v3, s28
    v_perm_b32 v92, v7, v3, s29
    v_perm_b32 v89, v15, v11, s28
    v_perm_b32 v93, v15, v11, s29
    v_perm_b32 v90, v23, v19, s28
    v_perm_b32 v94, v23, v19, s29
    v_perm_b32 v91, v31, v27, s28
    v_perm_b32 v95, v31, v27, s29
    v_perm_b32 v0, v36, v32, s28
    v_perm_b32 v4, v36, v32, s29
    v_perm_b32 v1, v44, v40, s28
    v_perm_b32 v5, v44, v40, s29
    v_perm_b32 v2, v52, v48, s28
    v_perm_b32 v6, v52, v48, s29
    v_perm_b32 v3, v60, v56, s28
    v_perm_b32 v7, v60, v56, s29
    v_perm_b32 v8, v37, v33, s28
    v_perm_b32 v12, v37, v33, s29
    v_perm_b32 v9, v45, v41, s28
    v_perm_b32 v13, v45, v41, s29
    v_perm_b32 v10, v53, v49, s28
    v_perm_b32 v14, v53, v49, s29
    v_perm_b32 v11, v61, v57, s28
    v_perm_b32 v15, v61, v57, s29
    v_perm_b32 v16, v38, v34, s28
    v_perm_b32 v20, v38, v34, s29
    v_perm_b32 v17, v46, v42, s28
    v_perm_b32 v21, v46, v42, s29
    v_perm_b32 v18, v54, v50, s28
    v_perm_b32 v22, v54, v50, s29
    v_perm_b32 v19, v62, v58, s28
    v_perm_b32 v23, v62, v58, s29
    v_perm_b32 v24, v39, v35, s28
    v_perm_b32 v28, v39, v35, s29
    v_perm_b32 v25, v47, v43, s28
    v_perm_b32 v29, v47, v43, s29
    v_perm_b32 v26, v55, v51, s28
    v_perm_b32 v30, v55, v51, s29
    v_perm_b32 v27, v63, v59, s28
    v_perm_b32 v31, v63, v59, s29
    s_mul_i32 s39, s40, 85504
    s_add_u32 s39, s39, s31
    s_lshl_b32 s36, s30, 7
    s_add_u32 s39, s39, s36
    v_bfe_u32 v249, v254, 4, 2
    v_bfe_u32 v240, v254, 8, 1
    v_lshl_add_u32 v249, v240, 2, v249
    s_add_u32 s36, s30, 7
    s_cmp_ge_u32 s30, 160
    s_cselect_b32 s36, s36, s30
    s_cmp_eq_u32 s25, 1
    s_cselect_b32 s36, s36, s30
    s_lshr_b32 s36, s36, 1
    s_and_b32 s36, s36, 7
    v_xor_b32 v249, s36, v249
    v_lshl_add_u32 v249, v249, 4, v252
    s_setprio 1
    v_mfma_f32_16x16x32_bf16 v[32:35], v[160:163], v[64:67], 0
    v_mfma_f32_16x16x32_bf16 v[36:39], v[160:163], v[68:71], 0
    v_mfma_f32_16x16x32_bf16 v[40:43], v[160:163], v[72:75], 0
    v_mfma_f32_16x16x32_bf16 v[44:47], v[160:163], v[76:79], 0
    v_mfma_f32_16x16x32_bf16 v[48:51], v[160:163], v[80:83], 0
    v_mfma_f32_16x16x32_bf16 v[52:55], v[160:163], v[84:87], 0
    v_mfma_f32_16x16x32_bf16 v[56:59], v[160:163], v[88:91], 0
    v_mfma_f32_16x16x32_bf16 v[60:63], v[160:163], v[92:95], 0
    v_mfma_f32_16x16x32_bf16 v[32:35], v[164:167], v[0:3], v[32:35]
    v_mfma_f32_16x16x32_bf16 v[36:39], v[164:167], v[4:7], v[36:39]
    v_mfma_f32_16x16x32_bf16 v[40:43], v[164:167], v[8:11], v[40:43]
    v_mfma_f32_16x16x32_bf16 v[44:47], v[164:167], v[12:15], v[44:47]
    v_mfma_f32_16x16x32_bf16 v[48:51], v[164:167], v[16:19], v[48:51]
    v_mfma_f32_16x16x32_bf16 v[52:55], v[164:167], v[20:23], v[52:55]
    v_mfma_f32_16x16x32_bf16 v[56:59], v[164:167], v[24:27], v[56:59]
    v_mfma_f32_16x16x32_bf16 v[60:63], v[164:167], v[28:31], v[60:63]
    s_setprio 0
    s_nop 7
    v_cvt_pk_bf16_f32 v240, v32, v36
    v_cvt_pk_bf16_f32 v241, v40, v44
    v_cvt_pk_bf16_f32 v242, v48, v52
    v_cvt_pk_bf16_f32 v243, v56, v60
    buffer_store_dwordx4 v[240:243], v249, s[12:15], s39 offen sc1
    s_add_u32 s39, s39, 2736128
    v_cvt_pk_bf16_f32 v244, v33, v37
    v_cvt_pk_bf16_f32 v245, v41, v45
    v_cvt_pk_bf16_f32 v246, v49, v53
    v_cvt_pk_bf16_f32 v247, v57, v61
    buffer_store_dwordx4 v[244:247], v249, s[12:15], s39 offen sc1
    s_add_u32 s39, s39, 2736128
    v_cvt_pk_bf16_f32 v240, v34, v38
    v_cvt_pk_bf16_f32 v241, v42, v46
    v_cvt_pk_bf16_f32 v242, v50, v54
    v_cvt_pk_bf16_f32 v243, v58, v62
    buffer_store_dwordx4 v[240:243], v249, s[12:15], s39 offen sc1
    s_add_u32 s39, s39, 2736128
    v_cvt_pk_bf16_f32 v244, v35, v39
    v_cvt_pk_bf16_f32 v245, v43, v47
    v_cvt_pk_bf16_f32 v246, v51, v55
    v_cvt_pk_bf16_f32 v247, v59, v63
    buffer_store_dwordx4 v[244:247], v249, s[12:15], s39 offen sc1
    s_add_u32 s39, s39, 2736128
    s_setprio 1
    v_mfma_f32_16x16x32_bf16 v[32:35], v[168:171], v[64:67], 0
    v_mfma_f32_16x16x32_bf16 v[36:39], v[168:171], v[68:71], 0
    v_mfma_f32_16x16x32_bf16 v[40:43], v[168:171], v[72:75], 0
    v_mfma_f32_16x16x32_bf16 v[44:47], v[168:171], v[76:79], 0
    v_mfma_f32_16x16x32_bf16 v[48:51], v[168:171], v[80:83], 0
    v_mfma_f32_16x16x32_bf16 v[52:55], v[168:171], v[84:87], 0
    v_mfma_f32_16x16x32_bf16 v[56:59], v[168:171], v[88:91], 0
    v_mfma_f32_16x16x32_bf16 v[60:63], v[168:171], v[92:95], 0
    v_mfma_f32_16x16x32_bf16 v[32:35], v[172:175], v[0:3], v[32:35]
    v_mfma_f32_16x16x32_bf16 v[36:39], v[172:175], v[4:7], v[36:39]
    v_mfma_f32_16x16x32_bf16 v[40:43], v[172:175], v[8:11], v[40:43]
    v_mfma_f32_16x16x32_bf16 v[44:47], v[172:175], v[12:15], v[44:47]
    v_mfma_f32_16x16x32_bf16 v[48:51], v[172:175], v[16:19], v[48:51]
    v_mfma_f32_16x16x32_bf16 v[52:55], v[172:175], v[20:23], v[52:55]
    v_mfma_f32_16x16x32_bf16 v[56:59], v[172:175], v[24:27], v[56:59]
    v_mfma_f32_16x16x32_bf16 v[60:63], v[172:175], v[28:31], v[60:63]
    s_setprio 0
    s_nop 7
    v_cvt_pk_bf16_f32 v240, v32, v36
    v_cvt_pk_bf16_f32 v241, v40, v44
    v_cvt_pk_bf16_f32 v242, v48, v52
    v_cvt_pk_bf16_f32 v243, v56, v60
    buffer_store_dwordx4 v[240:243], v249, s[12:15], s39 offen sc1
    s_add_u32 s39, s39, 2736128
    v_cvt_pk_bf16_f32 v244, v33, v37
    v_cvt_pk_bf16_f32 v245, v41, v45
    v_cvt_pk_bf16_f32 v246, v49, v53
    v_cvt_pk_bf16_f32 v247, v57, v61
    buffer_store_dwordx4 v[244:247], v249, s[12:15], s39 offen sc1
    s_add_u32 s39, s39, 2736128
    v_cvt_pk_bf16_f32 v240, v34, v38
    v_cvt_pk_bf16_f32 v241, v42, v46
    v_cvt_pk_bf16_f32 v242, v50, v54
    v_cvt_pk_bf16_f32 v243, v58, v62
    buffer_store_dwordx4 v[240:243], v249, s[12:15], s39 offen sc1
    s_add_u32 s39, s39, 2736128
    v_cvt_pk_bf16_f32 v244, v35, v39
    v_cvt_pk_bf16_f32 v245, v43, v47
    v_cvt_pk_bf16_f32 v246, v51, v55
    v_cvt_pk_bf16_f32 v247, v59, v63
    buffer_store_dwordx4 v[244:247], v249, s[12:15], s39 offen sc1
    s_add_u32 s39, s39, 2736128
    s_setprio 1
    v_mfma_f32_16x16x32_bf16 v[32:35], v[176:179], v[64:67], 0
    v_mfma_f32_16x16x32_bf16 v[36:39], v[176:179], v[68:71], 0
    v_mfma_f32_16x16x32_bf16 v[40:43], v[176:179], v[72:75], 0
    v_mfma_f32_16x16x32_bf16 v[44:47], v[176:179], v[76:79], 0
    v_mfma_f32_16x16x32_bf16 v[48:51], v[176:179], v[80:83], 0
    v_mfma_f32_16x16x32_bf16 v[52:55], v[176:179], v[84:87], 0
    v_mfma_f32_16x16x32_bf16 v[56:59], v[176:179], v[88:91], 0
    v_mfma_f32_16x16x32_bf16 v[60:63], v[176:179], v[92:95], 0
    v_mfma_f32_16x16x32_bf16 v[32:35], v[180:183], v[0:3], v[32:35]
    v_mfma_f32_16x16x32_bf16 v[36:39], v[180:183], v[4:7], v[36:39]
    v_mfma_f32_16x16x32_bf16 v[40:43], v[180:183], v[8:11], v[40:43]
    v_mfma_f32_16x16x32_bf16 v[44:47], v[180:183], v[12:15], v[44:47]
    v_mfma_f32_16x16x32_bf16 v[48:51], v[180:183], v[16:19], v[48:51]
    v_mfma_f32_16x16x32_bf16 v[52:55], v[180:183], v[20:23], v[52:55]
    v_mfma_f32_16x16x32_bf16 v[56:59], v[180:183], v[24:27], v[56:59]
    v_mfma_f32_16x16x32_bf16 v[60:63], v[180:183], v[28:31], v[60:63]
    s_setprio 0
    s_nop 7
    v_cvt_pk_bf16_f32 v240, v32, v36
    v_cvt_pk_bf16_f32 v241, v40, v44
    v_cvt_pk_bf16_f32 v242, v48, v52
    v_cvt_pk_bf16_f32 v243, v56, v60
    buffer_store_dwordx4 v[240:243], v249, s[12:15], s39 offen sc1
    s_add_u32 s39, s39, 2736128
    v_cvt_pk_bf16_f32 v244, v33, v37
    v_cvt_pk_bf16_f32 v245, v41, v45
    v_cvt_pk_bf16_f32 v246, v49, v53
    v_cvt_pk_bf16_f32 v247, v57, v61
    buffer_store_dwordx4 v[244:247], v249, s[12:15], s39 offen sc1
    s_add_u32 s39, s39, 2736128
    v_cvt_pk_bf16_f32 v240, v34, v38
    v_cvt_pk_bf16_f32 v241, v42, v46
    v_cvt_pk_bf16_f32 v242, v50, v54
    v_cvt_pk_bf16_f32 v243, v58, v62
    buffer_store_dwordx4 v[240:243], v249, s[12:15], s39 offen sc1
    s_add_u32 s39, s39, 2736128
    v_cvt_pk_bf16_f32 v244, v35, v39
    v_cvt_pk_bf16_f32 v245, v43, v47
    v_cvt_pk_bf16_f32 v246, v51, v55
    v_cvt_pk_bf16_f32 v247, v59, v63
    buffer_store_dwordx4 v[244:247], v249, s[12:15], s39 offen sc1
    s_add_u32 s39, s39, 2736128
    s_setprio 1
    v_mfma_f32_16x16x32_bf16 v[32:35], v[184:187], v[64:67], 0
    v_mfma_f32_16x16x32_bf16 v[36:39], v[184:187], v[68:71], 0
    v_mfma_f32_16x16x32_bf16 v[40:43], v[184:187], v[72:75], 0
    v_mfma_f32_16x16x32_bf16 v[44:47], v[184:187], v[76:79], 0
    v_mfma_f32_16x16x32_bf16 v[48:51], v[184:187], v[80:83], 0
    v_mfma_f32_16x16x32_bf16 v[52:55], v[184:187], v[84:87], 0
    v_mfma_f32_16x16x32_bf16 v[56:59], v[184:187], v[88:91], 0
    v_mfma_f32_16x16x32_bf16 v[60:63], v[184:187], v[92:95], 0
    v_mfma_f32_16x16x32_bf16 v[32:35], v[188:191], v[0:3], v[32:35]
    v_mfma_f32_16x16x32_bf16 v[36:39], v[188:191], v[4:7], v[36:39]
    v_mfma_f32_16x16x32_bf16 v[40:43], v[188:191], v[8:11], v[40:43]
    v_mfma_f32_16x16x32_bf16 v[44:47], v[188:191], v[12:15], v[44:47]
    v_mfma_f32_16x16x32_bf16 v[48:51], v[188:191], v[16:19], v[48:51]
    v_mfma_f32_16x16x32_bf16 v[52:55], v[188:191], v[20:23], v[52:55]
    v_mfma_f32_16x16x32_bf16 v[56:59], v[188:191], v[24:27], v[56:59]
    v_mfma_f32_16x16x32_bf16 v[60:63], v[188:191], v[28:31], v[60:63]
    s_setprio 0
    s_nop 7
    v_cvt_pk_bf16_f32 v240, v32, v36
    v_cvt_pk_bf16_f32 v241, v40, v44
    v_cvt_pk_bf16_f32 v242, v48, v52
    v_cvt_pk_bf16_f32 v243, v56, v60
    buffer_store_dwordx4 v[240:243], v249, s[12:15], s39 offen sc1
    s_add_u32 s39, s39, 2736128
    v_cvt_pk_bf16_f32 v244, v33, v37
    v_cvt_pk_bf16_f32 v245, v41, v45
    v_cvt_pk_bf16_f32 v246, v49, v53
    v_cvt_pk_bf16_f32 v247, v57, v61
    buffer_store_dwordx4 v[244:247], v249, s[12:15], s39 offen sc1
    s_add_u32 s39, s39, 2736128
    v_cvt_pk_bf16_f32 v240, v34, v38
    v_cvt_pk_bf16_f32 v241, v42, v46
    v_cvt_pk_bf16_f32 v242, v50, v54
    v_cvt_pk_bf16_f32 v243, v58, v62
    buffer_store_dwordx4 v[240:243], v249, s[12:15], s39 offen sc1
    s_add_u32 s39, s39, 2736128
    v_cvt_pk_bf16_f32 v244, v35, v39
    v_cvt_pk_bf16_f32 v245, v43, v47
    v_cvt_pk_bf16_f32 v246, v51, v55
    v_cvt_pk_bf16_f32 v247, v59, v63
    buffer_store_dwordx4 v[244:247], v249, s[12:15], s39 offen sc1
K12_H2:
    s_mov_b64 exec, 1
    v_mov_b32 v255, 155664
    v_mov_b32 v64, 1
    ds_add_u32 v255, v64
    s_mov_b64 exec, -1
    s_waitcnt vmcnt(0)
    s_mov_b32 s41, 0
    s_mov_b32 s34, -1
    s_cmp_ge_u32 s41, 8
    s_cbranch_scc1 K12_SG0
    s_lshl_b32 s36, s41, 2
    s_add_u32 s37, s36, 155680
    s_mov_b64 exec, 1
    v_mov_b32 v255, s37
    v_mov_b32 v240, 1
    ds_add_rtn_u32 v240, v255, v240
    s_waitcnt lgkmcnt(0)
    v_readfirstlane_b32 s37, v240
    s_nop 3
    s_cmp_eq_u32 s37, 3
    s_cbranch_scc0 K12_SH0
    s_lshl_b32 s36, s36, 8
    v_mov_b32 v255, 1
    v_mov_b32 v240, s36
    buffer_atomic_add v255, v240, s[60:63], 0 offen sc0 sc1
    s_mov_b32 s34, s41
K12_SH0:
    s_mov_b64 exec, -1
K12_SG0:
    s_waitcnt vmcnt(0)
    s_cmp_ge_u32 s34, 8
    s_cbranch_scc1 K12_PB1
    v_readfirstlane_b32 s37, v255
    s_nop 3
    s_cmp_eq_u32 s37, 255
    s_cbranch_scc0 K12_PB1
    s_lshl_b32 s36, s34, 4
    s_add_u32 s36, s36, 16384
    s_mov_b64 exec, 1
    v_mov_b32 v255, 1
    v_mov_b32 v240, s36
    buffer_store_dword v255, v240, s[60:63], 0 offen sc1
    s_mov_b64 exec, -1
K12_PB1:
    s_branch K12_CONS
K12_PROD:
    s_mov_b32 s37, 131072
K12_TW:
    v_mov_b32 v240, 155648
    ds_read_b32 v240, v240
    s_waitcnt lgkmcnt(0)
    v_cmp_gt_u32 vcc, 2, v240
    s_sub_u32 s37, s37, 1
    s_cmp_eq_u32 s37, 0
    s_cbranch_scc1 K12_TX
    s_cbranch_vccz K12_TX
    s_sleep 2
    s_branch K12_TW
K12_TX:
    v_lshrrev_b32 v128, 4, v254
    v_lshlrev_b32 v129, 11, v128
    v_lshrrev_b32 v130, 1, v128
    v_lshlrev_b32 v130, 20, v130
    v_and_b32 v131, 1, v128
    v_lshl_add_u32 v130, v131, 7, v130
    s_mov_b32 s45, s27
    s_mov_b32 s46, s30
    s_add_u32 s47, s40, 1
K12_TCH0:
    s_xor_b32 s48, s47, s20
    s_and_b32 s48, s48, 1
    s_cmp_eq_u32 s48, 0
    s_cbranch_scc1 K12_TCHW0
    s_mul_i32 s36, s47, 85
    s_add_u32 s36, s36, s2
    s_and_b32 s36, s36, 255
    s_mul_hi_u32 s37, s36, 0x55555556
    s_mul_i32 s38, s37, 3
    s_cmp_eq_u32 s38, s36
    s_cselect_b32 s27, 1, 0
    s_cmp_lt_u32 s37, 78
    s_cselect_b32 s27, s27, 0
    s_add_u32 s37, s37, 89
    s_cmp_eq_u32 s21, 0
    s_cselect_b32 s30, s24, s37
    s_cselect_b32 s27, 1, s27
    s_cmp_eq_u32 s27, 0
    s_cbranch_scc1 K12_TCHN0
    s_lshl_b32 s36, s47, 8
    s_mul_i32 s37, s30, 98304
    s_add_u32 s36, s36, s37
    buffer_load_dword v244, v129, s[4:7], s36 offen
    buffer_load_dword v245, v129, s[4:7], s36 offen offset:128
    s_branch K12_TCHN0
K12_TCHW0:
    s_lshl_b32 s36, s47, 7
    s_add_u32 s36, s36, s22
    s_lshr_b32 s37, s36, 9
    s_lshl_b32 s37, s37, 19
    s_and_b32 s36, s36, 511
    s_lshl_b32 s36, s36, 10
    s_add_u32 s36, s36, s37
    s_add_u32 s36, s36, s33
    s_mov_b64 exec, 0xffffffff
    buffer_load_dword v246, v130, s[8:11], s36 offen
    s_mov_b64 exec, -1
K12_TCHN0:
    s_add_u32 s47, s47, 1
    s_cmp_lt_u32 s47, 8
    s_cbranch_scc1 K12_TCH0
    s_mov_b32 s27, s45
    s_mov_b32 s30, s46
    s_cmp_eq_u32 s43, 0
    s_cbranch_scc1 K12_WENTRY
K12_XW:
    s_waitcnt vmcnt(0)
    s_mov_b32 s34, -1
    s_cmp_ge_u32 s41, 8
    s_cbranch_scc1 K12_SG2
    s_lshl_b32 s36, s41, 2
    s_add_u32 s37, s36, 155680
    s_mov_b64 exec, 1
    v_mov_b32 v255, s37
    v_mov_b32 v240, 1
    ds_add_rtn_u32 v240, v255, v240
    s_waitcnt lgkmcnt(0)
    v_readfirstlane_b32 s37, v240
    s_nop 3
    s_cmp_eq_u32 s37, 3
    s_cbranch_scc0 K12_SH2
    s_lshl_b32 s36, s36, 8
    v_mov_b32 v255, 1
    v_mov_b32 v240, s36
    buffer_atomic_add v255, v240, s[60:63], 0 offen sc0 sc1
    s_mov_b32 s34, s41
K12_SH2:
    s_mov_b64 exec, -1
K12_SG2:
    s_cmp_ge_u32 s34, 8
    s_cbranch_scc1 K12_EP3
    s_waitcnt vmcnt(0)
    s_cmp_ge_u32 s34, 8
    s_cbranch_scc1 K12_PB4
    v_readfirstlane_b32 s37, v255
    s_nop 3
    s_cmp_eq_u32 s37, 255
    s_cbranch_scc0 K12_PB4
    s_lshl_b32 s36, s34, 4
    s_add_u32 s36, s36, 16384
    s_mov_b64 exec, 1
    v_mov_b32 v255, 1
    v_mov_b32 v240, s36
    buffer_store_dword v255, v240, s[60:63], 0 offen sc1
    s_mov_b64 exec, -1
K12_PB4:
    s_mov_b32 s34, -1
K12_EP3:
    s_cmp_eq_u32 s27, 0
    s_cbranch_scc1 K12_XP_N
    v_perm_b32 v64, v4, v0, s28
    v_perm_b32 v68, v4, v0, s29
    v_perm_b32 v65, v12, v8, s28
    v_perm_b32 v69, v12, v8, s29
    v_perm_b32 v66, v20, v16, s28
    v_perm_b32 v70, v20, v16, s29
    v_perm_b32 v67, v28, v24, s28
    v_perm_b32 v71, v28, v24, s29
    v_perm_b32 v72, v5, v1, s28
    v_perm_b32 v76, v5, v1, s29
    v_perm_b32 v73, v13, v9, s28
    v_perm_b32 v77, v13, v9, s29
    v_perm_b32 v74, v21, v17, s28
    v_perm_b32 v78, v21, v17, s29
    v_perm_b32 v75, v29, v25, s28
    v_perm_b32 v79, v29, v25, s29
    v_perm_b32 v80, v6, v2, s28
    v_perm_b32 v84, v6, v2, s29
    v_perm_b32 v81, v14, v10, s28
    v_perm_b32 v85, v14, v10, s29
    v_perm_b32 v82, v22, v18, s28
    v_perm_b32 v86, v22, v18, s29
    v_perm_b32 v83, v30, v26, s28
    v_perm_b32 v87, v30, v26, s29
    v_perm_b32 v88, v7, v3, s28
    v_perm_b32 v92, v7, v3, s29
    v_perm_b32 v89, v15, v11, s28
    v_perm_b32 v93, v15, v11, s29
    v_perm_b32 v90, v23, v19, s28
    v_perm_b32 v94, v23, v19, s29
    v_perm_b32 v91, v31, v27, s28
    v_perm_b32 v95, v31, v27, s29
    v_perm_b32 v0, v36, v32, s28
    v_perm_b32 v4, v36, v32, s29
    v_perm_b32 v1, v44, v40, s28
    v_perm_b32 v5, v44, v40, s29
    v_perm_b32 v2, v52, v48, s28
    v_perm_b32 v6, v52, v48, s29
    v_perm_b32 v3, v60, v56, s28
    v_perm_b32 v7, v60, v56, s29
    v_perm_b32 v8, v37, v33, s28
    v_perm_b32 v12, v37, v33, s29
    v_perm_b32 v9, v45, v41, s28
    v_perm_b32 v13, v45, v41, s29
    v_perm_b32 v10, v53, v49, s28
    v_perm_b32 v14, v53, v49, s29
    v_perm_b32 v11, v61, v57, s28
    v_perm_b32 v15, v61, v57, s29
    v_perm_b32 v16, v38, v34, s28
    v_perm_b32 v20, v38, v34, s29
    v_perm_b32 v17, v46, v42, s28
    v_perm_b32 v21, v46, v42, s29
    v_perm_b32 v18, v54, v50, s28
    v_perm_b32 v22, v54, v50, s29
    v_perm_b32 v19, v62, v58, s28
    v_perm_b32 v23, v62, v58, s29
    v_perm_b32 v24, v39, v35, s28
    v_perm_b32 v28, v39, v35, s29
    v_perm_b32 v25, v47, v43, s28
    v_perm_b32 v29, v47, v43, s29
    v_perm_b32 v26, v55, v51, s28
    v_perm_b32 v30, v55, v51, s29
    v_perm_b32 v27, v63, v59, s28
    v_perm_b32 v31, v63, v59, s29
K12_XP_N:
    s_lshl_b32 s36, s40, 3
    s_sub_i32 s36, s36, 24
    s_max_i32 s36, s36, 1
    s_mov_b32 s37, 131072
K12_GL0:
    v_mov_b32 v240, 155648
    ds_read_b32 v240, v240
    s_waitcnt lgkmcnt(0)
    v_cmp_gt_u32 vcc, s36, v240
    s_sub_u32 s37, s37, 1
    s_cmp_eq_u32 s37, 0
    s_cbranch_scc1 K12_GT0
    s_cbranch_vccz K12_GT0
    s_sleep 2
    s_branch K12_GL0
K12_GT0:
    s_lshl_b32 s36, s40, 2
    s_add_u32 s36, s36, 155840
    s_mov_b64 exec, 1
    v_mov_b32 v240, s36
    v_mov_b32 v241, 1
    ds_add_u32 v240, v241
    s_mov_b64 exec, -1
    s_mov_b32 s37, 131072
K12_BL0:
    v_mov_b32 v240, s36
    ds_read_b32 v240, v240
    s_waitcnt lgkmcnt(0)
    v_cmp_gt_u32 vcc, 4, v240
    s_sub_u32 s37, s37, 1
    s_cmp_eq_u32 s37, 0
    s_cbranch_scc1 K12_BT0
    s_cbranch_vccz K12_BT0
    s_sleep 1
    s_branch K12_BL0
K12_BT0:
    s_add_u32 s42, s40, 1
    s_lshl_b32 s36, s42, 7
    s_add_u32 s36, s36, s22
    s_lshr_b32 s37, s36, 9
    s_lshl_b32 s37, s37, 19
    s_and_b32 s36, s36, 511
    s_lshl_b32 s36, s36, 10
    s_add_u32 s36, s36, s37
    s_add_u32 s36, s36, s33
    buffer_load_dwordx4 v[96:99], v250, s[8:11], s36 offen
    s_add_u32 s36, s36, 0x100000
    buffer_load_dwordx4 v[100:103], v250, s[8:11], s36 offen
    s_add_u32 s36, s36, 0x100000
    buffer_load_dwordx4 v[104:107], v250, s[8:11], s36 offen
    s_add_u32 s36, s36, 0x100000
    buffer_load_dwordx4 v[108:111], v250, s[8:11], s36 offen
    s_add_u32 s36, s36, 0x100000
    buffer_load_dwordx4 v[112:115], v250, s[8:11], s36 offen
    s_add_u32 s36, s36, 0x100000
    buffer_load_dwordx4 v[116:119], v250, s[8:11], s36 offen
    s_add_u32 s36, s36, 0x100000
    buffer_load_dwordx4 v[120:123], v250, s[8:11], s36 offen
    s_add_u32 s36, s36, 0x100000
    buffer_load_dwordx4 v[124:127], v250, s[8:11], s36 offen
    s_cmp_eq_u32 s27, 0
    s_cbranch_scc1 K12_XP_E
    s_mul_i32 s39, s40, 85504
    s_add_u32 s39, s39, s31
    s_lshl_b32 s36, s30, 7
    s_add_u32 s39, s39, s36
    v_bfe_u32 v249, v254, 4, 2
    v_bfe_u32 v240, v254, 8, 1
    v_lshl_add_u32 v249, v240, 2, v249
    s_add_u32 s36, s30, 7
    s_cmp_ge_u32 s30, 160
    s_cselect_b32 s36, s36, s30
    s_cmp_eq_u32 s25, 1
    s_cselect_b32 s36, s36, s30
    s_lshr_b32 s36, s36, 1
    s_and_b32 s36, s36, 7
    v_xor_b32 v249, s36, v249
    v_lshl_add_u32 v249, v249, 4, v252
    s_setprio 1
    v_mfma_f32_16x16x32_bf16 v[32:35], v[160:163], v[64:67], 0
    v_mfma_f32_16x16x32_bf16 v[36:39], v[160:163], v[68:71], 0
    v_mfma_f32_16x16x32_bf16 v[40:43], v[160:163], v[72:75], 0
    v_mfma_f32_16x16x32_bf16 v[44:47], v[160:163], v[76:79], 0
    v_mfma_f32_16x16x32_bf16 v[48:51], v[160:163], v[80:83], 0
    v_mfma_f32_16x16x32_bf16 v[52:55], v[160:163], v[84:87], 0
    v_mfma_f32_16x16x32_bf16 v[56:59], v[160:163], v[88:91], 0
    v_mfma_f32_16x16x32_bf16 v[60:63], v[160:163], v[92:95], 0
    v_mfma_f32_16x16x32_bf16 v[32:35], v[164:167], v[0:3], v[32:35]
    v_mfma_f32_16x16x32_bf16 v[36:39], v[164:167], v[4:7], v[36:39]
    v_mfma_f32_16x16x32_bf16 v[40:43], v[164:167], v[8:11], v[40:43]
    v_mfma_f32_16x16x32_bf16 v[44:47], v[164:167], v[12:15], v[44:47]
    v_mfma_f32_16x16x32_bf16 v[48:51], v[164:167], v[16:19], v[48:51]
    v_mfma_f32_16x16x32_bf16 v[52:55], v[164:167], v[20:23], v[52:55]
    v_mfma_f32_16x16x32_bf16 v[56:59], v[164:167], v[24:27], v[56:59]
    v_mfma_f32_16x16x32_bf16 v[60:63], v[164:167], v[28:31], v[60:63]
    s_setprio 0
    s_nop 7
    v_cvt_pk_bf16_f32 v240, v32, v36
    v_cvt_pk_bf16_f32 v241, v40, v44
    v_cvt_pk_bf16_f32 v242, v48, v52
    v_cvt_pk_bf16_f32 v243, v56, v60
    buffer_store_dwordx4 v[240:243], v249, s[12:15], s39 offen sc1
    s_add_u32 s39, s39, 2736128
    v_cvt_pk_bf16_f32 v244, v33, v37
    v_cvt_pk_bf16_f32 v245, v41, v45
    v_cvt_pk_bf16_f32 v246, v49, v53
    v_cvt_pk_bf16_f32 v247, v57, v61
    buffer_store_dwordx4 v[244:247], v249, s[12:15], s39 offen sc1
    s_add_u32 s39, s39, 2736128
    v_cvt_pk_bf16_f32 v240, v34, v38
    v_cvt_pk_bf16_f32 v241, v42, v46
    v_cvt_pk_bf16_f32 v242, v50, v54
    v_cvt_pk_bf16_f32 v243, v58, v62
    buffer_store_dwordx4 v[240:243], v249, s[12:15], s39 offen sc1
    s_add_u32 s39, s39, 2736128
    v_cvt_pk_bf16_f32 v244, v35, v39
    v_cvt_pk_bf16_f32 v245, v43, v47
    v_cvt_pk_bf16_f32 v246, v51, v55
    v_cvt_pk_bf16_f32 v247, v59, v63
    buffer_store_dwordx4 v[244:247], v249, s[12:15], s39 offen sc1
    s_add_u32 s39, s39, 2736128
    s_setprio 1
    v_mfma_f32_16x16x32_bf16 v[32:35], v[168:171], v[64:67], 0
    v_mfma_f32_16x16x32_bf16 v[36:39], v[168:171], v[68:71], 0
    v_mfma_f32_16x16x32_bf16 v[40:43], v[168:171], v[72:75], 0
    v_mfma_f32_16x16x32_bf16 v[44:47], v[168:171], v[76:79], 0
    v_mfma_f32_16x16x32_bf16 v[48:51], v[168:171], v[80:83], 0
    v_mfma_f32_16x16x32_bf16 v[52:55], v[168:171], v[84:87], 0
    v_mfma_f32_16x16x32_bf16 v[56:59], v[168:171], v[88:91], 0
    v_mfma_f32_16x16x32_bf16 v[60:63], v[168:171], v[92:95], 0
    v_mfma_f32_16x16x32_bf16 v[32:35], v[172:175], v[0:3], v[32:35]
    v_mfma_f32_16x16x32_bf16 v[36:39], v[172:175], v[4:7], v[36:39]
    v_mfma_f32_16x16x32_bf16 v[40:43], v[172:175], v[8:11], v[40:43]
    v_mfma_f32_16x16x32_bf16 v[44:47], v[172:175], v[12:15], v[44:47]
    v_mfma_f32_16x16x32_bf16 v[48:51], v[172:175], v[16:19], v[48:51]
    v_mfma_f32_16x16x32_bf16 v[52:55], v[172:175], v[20:23], v[52:55]
    v_mfma_f32_16x16x32_bf16 v[56:59], v[172:175], v[24:27], v[56:59]
    v_mfma_f32_16x16x32_bf16 v[60:63], v[172:175], v[28:31], v[60:63]
    s_setprio 0
    s_nop 7
    v_cvt_pk_bf16_f32 v240, v32, v36
    v_cvt_pk_bf16_f32 v241, v40, v44
    v_cvt_pk_bf16_f32 v242, v48, v52
    v_cvt_pk_bf16_f32 v243, v56, v60
    buffer_store_dwordx4 v[240:243], v249, s[12:15], s39 offen sc1
    s_add_u32 s39, s39, 2736128
    v_cvt_pk_bf16_f32 v244, v33, v37
    v_cvt_pk_bf16_f32 v245, v41, v45
    v_cvt_pk_bf16_f32 v246, v49, v53
    v_cvt_pk_bf16_f32 v247, v57, v61
    buffer_store_dwordx4 v[244:247], v249, s[12:15], s39 offen sc1
    s_add_u32 s39, s39, 2736128
    v_cvt_pk_bf16_f32 v240, v34, v38
    v_cvt_pk_bf16_f32 v241, v42, v46
    v_cvt_pk_bf16_f32 v242, v50, v54
    v_cvt_pk_bf16_f32 v243, v58, v62
    buffer_store_dwordx4 v[240:243], v249, s[12:15], s39 offen sc1
    s_add_u32 s39, s39, 2736128
    v_cvt_pk_bf16_f32 v244, v35, v39
    v_cvt_pk_bf16_f32 v245, v43, v47
    v_cvt_pk_bf16_f32 v246, v51, v55
    v_cvt_pk_bf16_f32 v247, v59, v63
    buffer_store_dwordx4 v[244:247], v249, s[12:15], s39 offen sc1
    s_add_u32 s39, s39, 2736128
    s_setprio 1
    v_mfma_f32_16x16x32_bf16 v[32:35], v[176:179], v[64:67], 0
    v_mfma_f32_16x16x32_bf16 v[36:39], v[176:179], v[68:71], 0
    v_mfma_f32_16x16x32_bf16 v[40:43], v[176:179], v[72:75], 0
    v_mfma_f32_16x16x32_bf16 v[44:47], v[176:179], v[76:79], 0
    v_mfma_f32_16x16x32_bf16 v[48:51], v[176:179], v[80:83], 0
    v_mfma_f32_16x16x32_bf16 v[52:55], v[176:179], v[84:87], 0
    v_mfma_f32_16x16x32_bf16 v[56:59], v[176:179], v[88:91], 0
    v_mfma_f32_16x16x32_bf16 v[60:63], v[176:179], v[92:95], 0
    v_mfma_f32_16x16x32_bf16 v[32:35], v[180:183], v[0:3], v[32:35]
    v_mfma_f32_16x16x32_bf16 v[36:39], v[180:183], v[4:7], v[36:39]
    v_mfma_f32_16x16x32_bf16 v[40:43], v[180:183], v[8:11], v[40:43]
    v_mfma_f32_16x16x32_bf16 v[44:47], v[180:183], v[12:15], v[44:47]
    v_mfma_f32_16x16x32_bf16 v[48:51], v[180:183], v[16:19], v[48:51]
    v_mfma_f32_16x16x32_bf16 v[52:55], v[180:183], v[20:23], v[52:55]
    v_mfma_f32_16x16x32_bf16 v[56:59], v[180:183], v[24:27], v[56:59]
    v_mfma_f32_16x16x32_bf16 v[60:63], v[180:183], v[28:31], v[60:63]
    s_setprio 0
    s_nop 7
    v_cvt_pk_bf16_f32 v240, v32, v36
    v_cvt_pk_bf16_f32 v241, v40, v44
    v_cvt_pk_bf16_f32 v242, v48, v52
    v_cvt_pk_bf16_f32 v243, v56, v60
    buffer_store_dwordx4 v[240:243], v249, s[12:15], s39 offen sc1
    s_add_u32 s39, s39, 2736128
    v_cvt_pk_bf16_f32 v244, v33, v37
    v_cvt_pk_bf16_f32 v245, v41, v45
    v_cvt_pk_bf16_f32 v246, v49, v53
    v_cvt_pk_bf16_f32 v247, v57, v61
    buffer_store_dwordx4 v[244:247], v249, s[12:15], s39 offen sc1
    s_add_u32 s39, s39, 2736128
    v_cvt_pk_bf16_f32 v240, v34, v38
    v_cvt_pk_bf16_f32 v241, v42, v46
    v_cvt_pk_bf16_f32 v242, v50, v54
    v_cvt_pk_bf16_f32 v243, v58, v62
    buffer_store_dwordx4 v[240:243], v249, s[12:15], s39 offen sc1
    s_add_u32 s39, s39, 2736128
    v_cvt_pk_bf16_f32 v244, v35, v39
    v_cvt_pk_bf16_f32 v245, v43, v47
    v_cvt_pk_bf16_f32 v246, v51, v55
    v_cvt_pk_bf16_f32 v247, v59, v63
    buffer_store_dwordx4 v[244:247], v249, s[12:15], s39 offen sc1
    s_add_u32 s39, s39, 2736128
    s_setprio 1
    v_mfma_f32_16x16x32_bf16 v[32:35], v[184:187], v[64:67], 0
    v_mfma_f32_16x16x32_bf16 v[36:39], v[184:187], v[68:71], 0
    v_mfma_f32_16x16x32_bf16 v[40:43], v[184:187], v[72:75], 0
    v_mfma_f32_16x16x32_bf16 v[44:47], v[184:187], v[76:79], 0
    v_mfma_f32_16x16x32_bf16 v[48:51], v[184:187], v[80:83], 0
    v_mfma_f32_16x16x32_bf16 v[52:55], v[184:187], v[84:87], 0
    v_mfma_f32_16x16x32_bf16 v[56:59], v[184:187], v[88:91], 0
    v_mfma_f32_16x16x32_bf16 v[60:63], v[184:187], v[92:95], 0
    v_mfma_f32_16x16x32_bf16 v[32:35], v[188:191], v[0:3], v[32:35]
    v_mfma_f32_16x16x32_bf16 v[36:39], v[188:191], v[4:7], v[36:39]
    v_mfma_f32_16x16x32_bf16 v[40:43], v[188:191], v[8:11], v[40:43]
    v_mfma_f32_16x16x32_bf16 v[44:47], v[188:191], v[12:15], v[44:47]
    v_mfma_f32_16x16x32_bf16 v[48:51], v[188:191], v[16:19], v[48:51]
    v_mfma_f32_16x16x32_bf16 v[52:55], v[188:191], v[20:23], v[52:55]
    v_mfma_f32_16x16x32_bf16 v[56:59], v[188:191], v[24:27], v[56:59]
    v_mfma_f32_16x16x32_bf16 v[60:63], v[188:191], v[28:31], v[60:63]
    s_setprio 0
    s_nop 7
    v_cvt_pk_bf16_f32 v240, v32, v36
    v_cvt_pk_bf16_f32 v241, v40, v44
    v_cvt_pk_bf16_f32 v242, v48, v52
    v_cvt_pk_bf16_f32 v243, v56, v60
    buffer_store_dwordx4 v[240:243], v249, s[12:15], s39 offen sc1
    s_add_u32 s39, s39, 2736128
    v_cvt_pk_bf16_f32 v244, v33, v37
    v_cvt_pk_bf16_f32 v245, v41, v45
    v_cvt_pk_bf16_f32 v246, v49, v53
    v_cvt_pk_bf16_f32 v247, v57, v61
    buffer_store_dwordx4 v[244:247], v249, s[12:15], s39 offen sc1
    s_add_u32 s39, s39, 2736128
    v_cvt_pk_bf16_f32 v240, v34, v38
    v_cvt_pk_bf16_f32 v241, v42, v46
    v_cvt_pk_bf16_f32 v242, v50, v54
    v_cvt_pk_bf16_f32 v243, v58, v62
    buffer_store_dwordx4 v[240:243], v249, s[12:15], s39 offen sc1
    s_add_u32 s39, s39, 2736128
    v_cvt_pk_bf16_f32 v244, v35, v39
    v_cvt_pk_bf16_f32 v245, v43, v47
    v_cvt_pk_bf16_f32 v246, v51, v55
    v_cvt_pk_bf16_f32 v247, v59, v63
    buffer_store_dwordx4 v[244:247], v249, s[12:15], s39 offen sc1
    s_mov_b32 s41, s40
    s_add_u32 s40, s40, 1
    s_cmp_eq_u32 s41, 3
    s_cbranch_scc0 K12_ES5
    s_waitcnt vmcnt(0)
    s_mov_b32 s34, -1
    s_cmp_ge_u32 s41, 8
    s_cbranch_scc1 K12_SG6
    s_lshl_b32 s36, s41, 2
    s_add_u32 s37, s36, 155680
    s_mov_b64 exec, 1
    v_mov_b32 v255, s37
    v_mov_b32 v240, 1
    ds_add_rtn_u32 v240, v255, v240
    s_waitcnt lgkmcnt(0)
    v_readfirstlane_b32 s37, v240
    s_nop 3
    s_cmp_eq_u32 s37, 3
    s_cbranch_scc0 K12_SH6
    s_lshl_b32 s36, s36, 8
    v_mov_b32 v255, 1
    v_mov_b32 v240, s36
    buffer_atomic_add v255, v240, s[60:63], 0 offen sc0 sc1
    s_mov_b32 s34, s41
K12_SH6:
    s_mov_b64 exec, -1
K12_SG6:
    s_waitcnt vmcnt(0)
    s_cmp_ge_u32 s34, 8
    s_cbranch_scc1 K12_PB7
    v_readfirstlane_b32 s37, v255
    s_nop 3
    s_cmp_eq_u32 s37, 255
    s_cbranch_scc0 K12_PB7
    s_lshl_b32 s36, s34, 4
    s_add_u32 s36, s36, 16384
    s_mov_b64 exec, 1
    v_mov_b32 v255, 1
    v_mov_b32 v240, s36
    buffer_store_dword v255, v240, s[60:63], 0 offen sc1
    s_mov_b64 exec, -1
K12_PB7:
    s_mov_b32 s34, -1
    s_mov_b32 s41, -1
K12_ES5:
    s_waitcnt vmcnt(16)
    s_branch K12_XP_F
K12_XP_E:
    s_mov_b32 s41, s40
    s_add_u32 s40, s40, 1
    s_cmp_eq_u32 s41, 3
    s_cbranch_scc0 K12_ES8
    s_waitcnt vmcnt(0)
    s_mov_b32 s34, -1
    s_cmp_ge_u32 s41, 8
    s_cbranch_scc1 K12_SG9
    s_lshl_b32 s36, s41, 2
    s_add_u32 s37, s36, 155680
    s_mov_b64 exec, 1
    v_mov_b32 v255, s37
    v_mov_b32 v240, 1
    ds_add_rtn_u32 v240, v255, v240
    s_waitcnt lgkmcnt(0)
    v_readfirstlane_b32 s37, v240
    s_nop 3
    s_cmp_eq_u32 s37, 3
    s_cbranch_scc0 K12_SH9
    s_lshl_b32 s36, s36, 8
    v_mov_b32 v255, 1
    v_mov_b32 v240, s36
    buffer_atomic_add v255, v240, s[60:63], 0 offen sc0 sc1
    s_mov_b32 s34, s41
K12_SH9:
    s_mov_b64 exec, -1
K12_SG9:
    s_waitcnt vmcnt(0)
    s_cmp_ge_u32 s34, 8
    s_cbranch_scc1 K12_PB10
    v_readfirstlane_b32 s37, v255
    s_nop 3
    s_cmp_eq_u32 s37, 255
    s_cbranch_scc0 K12_PB10
    s_lshl_b32 s36, s34, 4
    s_add_u32 s36, s36, 16384
    s_mov_b64 exec, 1
    v_mov_b32 v255, 1
    v_mov_b32 v240, s36
    buffer_store_dword v255, v240, s[60:63], 0 offen sc1
    s_mov_b64 exec, -1
K12_PB10:
    s_mov_b32 s34, -1
    s_mov_b32 s41, -1
K12_ES8:
    s_waitcnt vmcnt(0)
K12_XP_F:
    s_cmp_ge_u32 s34, 8
    s_cbranch_scc1 K12_PB11
    v_readfirstlane_b32 s37, v255
    s_nop 3
    s_cmp_eq_u32 s37, 255
    s_cbranch_scc0 K12_PB11
    s_lshl_b32 s36, s34, 4
    s_add_u32 s36, s36, 16384
    s_mov_b64 exec, 1
    v_mov_b32 v255, 1
    v_mov_b32 v240, s36
    buffer_store_dword v255, v240, s[60:63], 0 offen sc1
    s_mov_b64 exec, -1
K12_PB11:
    s_cmp_ge_u32 s40, 8
    s_cbranch_scc1 K12_PFIN
K12_WENTRY:
    s_waitcnt vmcnt(0)
    s_mov_b32 s34, -1
    s_cmp_ge_u32 s41, 8
    s_cbranch_scc1 K12_SG12
    s_lshl_b32 s36, s41, 2
    s_add_u32 s37, s36, 155680
    s_mov_b64 exec, 1
    v_mov_b32 v255, s37
    v_mov_b32 v240, 1
    ds_add_rtn_u32 v240, v255, v240
    s_waitcnt lgkmcnt(0)
    v_readfirstlane_b32 s37, v240
    s_nop 3
    s_cmp_eq_u32 s37, 3
    s_cbranch_scc0 K12_SH12
    s_lshl_b32 s36, s36, 8
    v_mov_b32 v255, 1
    v_mov_b32 v240, s36
    buffer_atomic_add v255, v240, s[60:63], 0 offen sc0 sc1
    s_mov_b32 s34, s41
K12_SH12:
    s_mov_b64 exec, -1
K12_SG12:
    s_cmp_ge_u32 s34, 8
    s_cbranch_scc1 K12_EP13
    s_waitcnt vmcnt(0)
    s_cmp_ge_u32 s34, 8
    s_cbranch_scc1 K12_PB14
    v_readfirstlane_b32 s37, v255
    s_nop 3
    s_cmp_eq_u32 s37, 255
    s_cbranch_scc0 K12_PB14
    s_lshl_b32 s36, s34, 4
    s_add_u32 s36, s36, 16384
    s_mov_b64 exec, 1
    v_mov_b32 v255, 1
    v_mov_b32 v240, s36
    buffer_store_dword v255, v240, s[60:63], 0 offen sc1
    s_mov_b64 exec, -1
K12_PB14:
    s_mov_b32 s34, -1
K12_EP13:
    v_perm_b32 v64, v100, v96, s28
    v_perm_b32 v68, v100, v96, s29
    v_perm_b32 v65, v108, v104, s28
    v_perm_b32 v69, v108, v104, s29
    v_perm_b32 v66, v116, v112, s28
    v_perm_b32 v70, v116, v112, s29
    v_perm_b32 v67, v124, v120, s28
    v_perm_b32 v71, v124, v120, s29
    v_perm_b32 v72, v101, v97, s28
    v_perm_b32 v76, v101, v97, s29
    v_perm_b32 v73, v109, v105, s28
    v_perm_b32 v77, v109, v105, s29
    v_perm_b32 v74, v117, v113, s28
    v_perm_b32 v78, v117, v113, s29
    v_perm_b32 v75, v125, v121, s28
    v_perm_b32 v79, v125, v121, s29
    v_perm_b32 v80, v102, v98, s28
    v_perm_b32 v84, v102, v98, s29
    v_perm_b32 v81, v110, v106, s28
    v_perm_b32 v85, v110, v106, s29
    v_perm_b32 v82, v118, v114, s28
    v_perm_b32 v86, v118, v114, s29
    v_perm_b32 v83, v126, v122, s28
    v_perm_b32 v87, v126, v122, s29
    v_perm_b32 v88, v103, v99, s28
    v_perm_b32 v92, v103, v99, s29
    v_perm_b32 v89, v111, v107, s28
    v_perm_b32 v93, v111, v107, s29
    v_perm_b32 v90, v119, v115, s28
    v_perm_b32 v94, v119, v115, s29
    v_perm_b32 v91, v127, v123, s28
    v_perm_b32 v95, v127, v123, s29
    s_lshl_b32 s36, s40, 3
    s_sub_i32 s36, s36, 24
    s_max_i32 s36, s36, 1
    s_mov_b32 s37, 131072
K12_GL1:
    v_mov_b32 v240, 155648
    ds_read_b32 v240, v240
    s_waitcnt lgkmcnt(0)
    v_cmp_gt_u32 vcc, s36, v240
    s_sub_u32 s37, s37, 1
    s_cmp_eq_u32 s37, 0
    s_cbranch_scc1 K12_GT1
    s_cbranch_vccz K12_GT1
    s_sleep 2
    s_branch K12_GL1
K12_GT1:
    s_lshl_b32 s36, s40, 2
    s_add_u32 s36, s36, 155840
    s_mov_b64 exec, 1
    v_mov_b32 v240, s36
    v_mov_b32 v241, 1
    ds_add_u32 v240, v241
    s_mov_b64 exec, -1
    s_mov_b32 s37, 131072
K12_BL1:
    v_mov_b32 v240, s36
    ds_read_b32 v240, v240
    s_waitcnt lgkmcnt(0)
    v_cmp_gt_u32 vcc, 4, v240
    s_sub_u32 s37, s37, 1
    s_cmp_eq_u32 s37, 0
    s_cbranch_scc1 K12_BT1
    s_cbranch_vccz K12_BT1
    s_sleep 1
    s_branch K12_BL1
K12_BT1:
    s_add_u32 s42, s40, 1
    s_mul_i32 s36, s42, 85
    s_add_u32 s36, s36, s2
    s_and_b32 s36, s36, 255
    s_mul_hi_u32 s37, s36, 0x55555556
    s_mul_i32 s38, s37, 3
    s_cmp_eq_u32 s38, s36
    s_cselect_b32 s27, 1, 0
    s_cmp_lt_u32 s37, 78
    s_cselect_b32 s27, s27, 0
    s_add_u32 s37, s37, 89
    s_cmp_eq_u32 s21, 0
    s_cselect_b32 s30, s24, s37
    s_cselect_b32 s27, 1, s27
    s_cmp_eq_u32 s27, 0
    s_cbranch_scc1 K12_WP_N
    s_lshl_b32 s36, s42, 8
    s_mul_i32 s37, s30, 98304
    s_add_u32 s36, s36, s37
    buffer_load_dwordx4 v[0:3], v248, s[4:7], s36 offen
    buffer_load_dwordx4 v[4:7], v248, s[4:7], s36 offen offset:2048
    s_add_u32 s36, s36, 4096
    buffer_load_dwordx4 v[8:11], v248, s[4:7], s36 offen
    buffer_load_dwordx4 v[12:15], v248, s[4:7], s36 offen offset:2048
    s_add_u32 s36, s36, 4096
    buffer_load_dwordx4 v[16:19], v248, s[4:7], s36 offen
    buffer_load_dwordx4 v[20:23], v248, s[4:7], s36 offen offset:2048
    s_add_u32 s36, s36, 4096
    buffer_load_dwordx4 v[24:27], v248, s[4:7], s36 offen
    buffer_load_dwordx4 v[28:31], v248, s[4:7], s36 offen offset:2048
    s_add_u32 s36, s36, 53248
    buffer_load_dwordx4 v[32:35], v248, s[4:7], s36 offen
    buffer_load_dwordx4 v[36:39], v248, s[4:7], s36 offen offset:2048
    s_add_u32 s36, s36, 4096
    buffer_load_dwordx4 v[40:43], v248, s[4:7], s36 offen
    buffer_load_dwordx4 v[44:47], v248, s[4:7], s36 offen offset:2048
    s_add_u32 s36, s36, 4096
    buffer_load_dwordx4 v[48:51], v248, s[4:7], s36 offen
    buffer_load_dwordx4 v[52:55], v248, s[4:7], s36 offen offset:2048
    s_add_u32 s36, s36, 4096
    buffer_load_dwordx4 v[56:59], v248, s[4:7], s36 offen
    buffer_load_dwordx4 v[60:63], v248, s[4:7], s36 offen offset:2048
    s_branch K12_WP_M
K12_WP_N:
K12_WP_M:
    s_lshl_b32 s36, s40, 7
    s_add_u32 s36, s36, s22
    s_and_b32 s37, s36, 3
    s_lshr_b32 s38, s36, 1
    s_and_b32 s38, s38, 4
    s_or_b32 s37, s37, s38
    v_bfe_u32 v253, v254, 5, 3
    v_xor_b32 v253, s37, v253
    v_lshl_add_u32 v253, v253, 5, v251
    s_lshl_b32 s36, s36, 9
    s_add_u32 s39, s36, s32
    s_setprio 1
    v_mfma_f32_16x16x32_bf16 v[128:131], v[224:227], v[64:67], 0
    v_mfma_f32_16x16x32_bf16 v[132:135], v[224:227], v[68:71], 0
    v_mfma_f32_16x16x32_bf16 v[136:139], v[224:227], v[72:75], 0
    v_mfma_f32_16x16x32_bf16 v[140:143], v[224:227], v[76:79], 0
    v_mfma_f32_16x16x32_bf16 v[144:147], v[224:227], v[80:83], 0
    v_mfma_f32_16x16x32_bf16 v[148:151], v[224:227], v[84:87], 0
    v_mfma_f32_16x16x32_bf16 v[152:155], v[224:227], v[88:91], 0
    v_mfma_f32_16x16x32_bf16 v[156:159], v[224:227], v[92:95], 0
    s_setprio 0
    s_nop 7
    v_cvt_pk_bf16_f32 v240, v128, v132
    v_cvt_pk_bf16_f32 v241, v136, v140
    v_cvt_pk_bf16_f32 v242, v144, v148
    v_cvt_pk_bf16_f32 v243, v152, v156
    buffer_store_dwordx4 v[240:243], v253, s[16:19], s39 offen sc1
    s_add_u32 s39, s39, 4194304
    v_cvt_pk_bf16_f32 v244, v129, v133
    v_cvt_pk_bf16_f32 v245, v137, v141
    v_cvt_pk_bf16_f32 v246, v145, v149
    v_cvt_pk_bf16_f32 v247, v153, v157
    buffer_store_dwordx4 v[244:247], v253, s[16:19], s39 offen sc1
    s_add_u32 s39, s39, 4194304
    v_cvt_pk_bf16_f32 v240, v130, v134
    v_cvt_pk_bf16_f32 v241, v138, v142
    v_cvt_pk_bf16_f32 v242, v146, v150
    v_cvt_pk_bf16_f32 v243, v154, v158
    buffer_store_dwordx4 v[240:243], v253, s[16:19], s39 offen sc1
    s_add_u32 s39, s39, 4194304
    v_cvt_pk_bf16_f32 v244, v131, v135
    v_cvt_pk_bf16_f32 v245, v139, v143
    v_cvt_pk_bf16_f32 v246, v147, v151
    v_cvt_pk_bf16_f32 v247, v155, v159
    buffer_store_dwordx4 v[244:247], v253, s[16:19], s39 offen sc1
    s_add_u32 s39, s39, 4194304
    s_setprio 1
    v_mfma_f32_16x16x32_bf16 v[128:131], v[228:231], v[64:67], 0
    v_mfma_f32_16x16x32_bf16 v[132:135], v[228:231], v[68:71], 0
    v_mfma_f32_16x16x32_bf16 v[136:139], v[228:231], v[72:75], 0
    v_mfma_f32_16x16x32_bf16 v[140:143], v[228:231], v[76:79], 0
    v_mfma_f32_16x16x32_bf16 v[144:147], v[228:231], v[80:83], 0
    v_mfma_f32_16x16x32_bf16 v[148:151], v[228:231], v[84:87], 0
    v_mfma_f32_16x16x32_bf16 v[152:155], v[228:231], v[88:91], 0
    v_mfma_f32_16x16x32_bf16 v[156:159], v[228:231], v[92:95], 0
    s_setprio 0
    s_nop 7
    v_cvt_pk_bf16_f32 v240, v128, v132
    v_cvt_pk_bf16_f32 v241, v136, v140
    v_cvt_pk_bf16_f32 v242, v144, v148
    v_cvt_pk_bf16_f32 v243, v152, v156
    buffer_store_dwordx4 v[240:243], v253, s[16:19], s39 offen sc1
    s_add_u32 s39, s39, 4194304
    v_cvt_pk_bf16_f32 v244, v129, v133
    v_cvt_pk_bf16_f32 v245, v137, v141
    v_cvt_pk_bf16_f32 v246, v145, v149
    v_cvt_pk_bf16_f32 v247, v153, v157
    buffer_store_dwordx4 v[244:247], v253, s[16:19], s39 offen sc1
    s_add_u32 s39, s39, 4194304
    v_cvt_pk_bf16_f32 v240, v130, v134
    v_cvt_pk_bf16_f32 v241, v138, v142
    v_cvt_pk_bf16_f32 v242, v146, v150
    v_cvt_pk_bf16_f32 v243, v154, v158
    buffer_store_dwordx4 v[240:243], v253, s[16:19], s39 offen sc1
    s_add_u32 s39, s39, 4194304
    v_cvt_pk_bf16_f32 v244, v131, v135
    v_cvt_pk_bf16_f32 v245, v139, v143
    v_cvt_pk_bf16_f32 v246, v147, v151
    v_cvt_pk_bf16_f32 v247, v155, v159
    buffer_store_dwordx4 v[244:247], v253, s[16:19], s39 offen sc1
    s_add_u32 s39, s39, 4194304
    s_setprio 1
    v_mfma_f32_16x16x32_bf16 v[128:131], v[232:235], v[64:67], 0
    v_mfma_f32_16x16x32_bf16 v[132:135], v[232:235], v[68:71], 0
    v_mfma_f32_16x16x32_bf16 v[136:139], v[232:235], v[72:75], 0
    v_mfma_f32_16x16x32_bf16 v[140:143], v[232:235], v[76:79], 0
    v_mfma_f32_16x16x32_bf16 v[144:147], v[232:235], v[80:83], 0
    v_mfma_f32_16x16x32_bf16 v[148:151], v[232:235], v[84:87], 0
    v_mfma_f32_16x16x32_bf16 v[152:155], v[232:235], v[88:91], 0
    v_mfma_f32_16x16x32_bf16 v[156:159], v[232:235], v[92:95], 0
    s_setprio 0
    s_nop 7
    v_cvt_pk_bf16_f32 v240, v128, v132
    v_cvt_pk_bf16_f32 v241, v136, v140
    v_cvt_pk_bf16_f32 v242, v144, v148
    v_cvt_pk_bf16_f32 v243, v152, v156
    buffer_store_dwordx4 v[240:243], v253, s[16:19], s39 offen sc1
    s_add_u32 s39, s39, 4194304
    v_cvt_pk_bf16_f32 v244, v129, v133
    v_cvt_pk_bf16_f32 v245, v137, v141
    v_cvt_pk_bf16_f32 v246, v145, v149
    v_cvt_pk_bf16_f32 v247, v153, v157
    buffer_store_dwordx4 v[244:247], v253, s[16:19], s39 offen sc1
    s_add_u32 s39, s39, 4194304
    v_cvt_pk_bf16_f32 v240, v130, v134
    v_cvt_pk_bf16_f32 v241, v138, v142
    v_cvt_pk_bf16_f32 v242, v146, v150
    v_cvt_pk_bf16_f32 v243, v154, v158
    buffer_store_dwordx4 v[240:243], v253, s[16:19], s39 offen sc1
    s_add_u32 s39, s39, 4194304
    v_cvt_pk_bf16_f32 v244, v131, v135
    v_cvt_pk_bf16_f32 v245, v139, v143
    v_cvt_pk_bf16_f32 v246, v147, v151
    v_cvt_pk_bf16_f32 v247, v155, v159
    buffer_store_dwordx4 v[244:247], v253, s[16:19], s39 offen sc1
    s_add_u32 s39, s39, 4194304
    s_setprio 1
    v_mfma_f32_16x16x32_bf16 v[128:131], v[236:239], v[64:67], 0
    v_mfma_f32_16x16x32_bf16 v[132:135], v[236:239], v[68:71], 0
    v_mfma_f32_16x16x32_bf16 v[136:139], v[236:239], v[72:75], 0
    v_mfma_f32_16x16x32_bf16 v[140:143], v[236:239], v[76:79], 0
    v_mfma_f32_16x16x32_bf16 v[144:147], v[236:239], v[80:83], 0
    v_mfma_f32_16x16x32_bf16 v[148:151], v[236:239], v[84:87], 0
    v_mfma_f32_16x16x32_bf16 v[152:155], v[236:239], v[88:91], 0
    v_mfma_f32_16x16x32_bf16 v[156:159], v[236:239], v[92:95], 0
    s_setprio 0
    s_nop 7
    v_cvt_pk_bf16_f32 v240, v128, v132
    v_cvt_pk_bf16_f32 v241, v136, v140
    v_cvt_pk_bf16_f32 v242, v144, v148
    v_cvt_pk_bf16_f32 v243, v152, v156
    buffer_store_dwordx4 v[240:243], v253, s[16:19], s39 offen sc1
    s_add_u32 s39, s39, 4194304
    v_cvt_pk_bf16_f32 v244, v129, v133
    v_cvt_pk_bf16_f32 v245, v137, v141
    v_cvt_pk_bf16_f32 v246, v145, v149
    v_cvt_pk_bf16_f32 v247, v153, v157
    buffer_store_dwordx4 v[244:247], v253, s[16:19], s39 offen sc1
    s_add_u32 s39, s39, 4194304
    v_cvt_pk_bf16_f32 v240, v130, v134
    v_cvt_pk_bf16_f32 v241, v138, v142
    v_cvt_pk_bf16_f32 v242, v146, v150
    v_cvt_pk_bf16_f32 v243, v154, v158
    buffer_store_dwordx4 v[240:243], v253, s[16:19], s39 offen sc1
    s_add_u32 s39, s39, 4194304
    v_cvt_pk_bf16_f32 v244, v131, v135
    v_cvt_pk_bf16_f32 v245, v139, v143
    v_cvt_pk_bf16_f32 v246, v147, v151
    v_cvt_pk_bf16_f32 v247, v155, v159
    buffer_store_dwordx4 v[244:247], v253, s[16:19], s39 offen sc1
    s_mov_b32 s41, s40
    s_add_u32 s40, s40, 1
    s_cmp_eq_u32 s41, 3
    s_cbranch_scc0 K12_ES15
    s_waitcnt vmcnt(0)
    s_mov_b32 s34, -1
    s_cmp_ge_u32 s41, 8
    s_cbranch_scc1 K12_SG16
    s_lshl_b32 s36, s41, 2
    s_add_u32 s37, s36, 155680
    s_mov_b64 exec, 1
    v_mov_b32 v255, s37
    v_mov_b32 v240, 1
    ds_add_rtn_u32 v240, v255, v240
    s_waitcnt lgkmcnt(0)
    v_readfirstlane_b32 s37, v240
    s_nop 3
    s_cmp_eq_u32 s37, 3
    s_cbranch_scc0 K12_SH16
    s_lshl_b32 s36, s36, 8
    v_mov_b32 v255, 1
    v_mov_b32 v240, s36
    buffer_atomic_add v255, v240, s[60:63], 0 offen sc0 sc1
    s_mov_b32 s34, s41
K12_SH16:
    s_mov_b64 exec, -1
K12_SG16:
    s_waitcnt vmcnt(0)
    s_cmp_ge_u32 s34, 8
    s_cbranch_scc1 K12_PB17
    v_readfirstlane_b32 s37, v255
    s_nop 3
    s_cmp_eq_u32 s37, 255
    s_cbranch_scc0 K12_PB17
    s_lshl_b32 s36, s34, 4
    s_add_u32 s36, s36, 16384
    s_mov_b64 exec, 1
    v_mov_b32 v255, 1
    v_mov_b32 v240, s36
    buffer_store_dword v255, v240, s[60:63], 0 offen sc1
    s_mov_b64 exec, -1
K12_PB17:
    s_mov_b32 s34, -1
    s_mov_b32 s41, -1
K12_ES15:
    s_waitcnt vmcnt(16)
    s_cmp_ge_u32 s34, 8
    s_cbranch_scc1 K12_PB18
    v_readfirstlane_b32 s37, v255
    s_nop 3
    s_cmp_eq_u32 s37, 255
    s_cbranch_scc0 K12_PB18
    s_lshl_b32 s36, s34, 4
    s_add_u32 s36, s36, 16384
    s_mov_b64 exec, 1
    v_mov_b32 v255, 1
    v_mov_b32 v240, s36
    buffer_store_dword v255, v240, s[60:63], 0 offen sc1
    s_mov_b64 exec, -1
K12_PB18:
    s_cmp_lt_u32 s40, 8
    s_cbranch_scc1 K12_XW
K12_PFIN:
    s_waitcnt vmcnt(0)
    s_mov_b32 s34, -1
    s_cmp_ge_u32 s41, 8
    s_cbranch_scc1 K12_SG19
    s_lshl_b32 s36, s41, 2
    s_add_u32 s37, s36, 155680
    s_mov_b64 exec, 1
    v_mov_b32 v255, s37
    v_mov_b32 v240, 1
    ds_add_rtn_u32 v240, v255, v240
    s_waitcnt lgkmcnt(0)
    v_readfirstlane_b32 s37, v240
    s_nop 3
    s_cmp_eq_u32 s37, 3
    s_cbranch_scc0 K12_SH19
    s_lshl_b32 s36, s36, 8
    v_mov_b32 v255, 1
    v_mov_b32 v240, s36
    buffer_atomic_add v255, v240, s[60:63], 0 offen sc0 sc1
    s_mov_b32 s34, s41
K12_SH19:
    s_mov_b64 exec, -1
K12_SG19:
    s_waitcnt vmcnt(0)
    s_cmp_ge_u32 s34, 8
    s_cbranch_scc1 K12_PB20
    v_readfirstlane_b32 s37, v255
    s_nop 3
    s_cmp_eq_u32 s37, 255
    s_cbranch_scc0 K12_PB20
    s_lshl_b32 s36, s34, 4
    s_add_u32 s36, s36, 16384
    s_mov_b64 exec, 1
    v_mov_b32 v255, 1
    v_mov_b32 v240, s36
    buffer_store_dword v255, v240, s[60:63], 0 offen sc1
    s_mov_b64 exec, -1
K12_PB20:
    s_endpgm
K12_CONS:
    s_and_b32 s6, s2, 7
    s_lshl_b32 s6, s6, 2
    s_lshr_b32 s7, s2, 6
    s_add_u32 s6, s6, s7
    s_mov_b32 s51, s6
    s_mov_b32 s27, s6
    s_lshr_b32 s7, s2, 3
    s_and_b32 s7, s7, 7
    s_lshr_b32 s20, s7, 2
    s_and_b32 s21, s7, 3
    s_lshl_b32 s22, s6, 1
    s_add_u32 s22, s22, s20
    s_lshl_b32 s23, s6, 2
    s_add_u32 s23, s23, s21
    s_mul_i32 s24, s22, 684032
    s_mul_i32 s25, s23, 524288
    s_add_u32 s25, s25, 50331648
    s_mul_i32 s26, s22, 342016
    s_add_u32 s26, s26, 118489088
    s_add_u32 s8, s58, s24
    s_addc_u32 s9, s59, 0
    s_and_b32 s9, s9, 0xffff
    s_mov_b32 s10, 684032
    s_mov_b32 s11, 0x00020000
    s_add_u32 s12, s58, s25
    s_addc_u32 s13, s59, 0
    s_and_b32 s13, s13, 0xffff
    s_mov_b32 s14, 524288
    s_mov_b32 s15, 0x00020000
    s_add_u32 s16, s58, s26
    s_addc_u32 s17, s59, 0
    s_and_b32 s17, s17, 0xffff
    s_mov_b32 s18, 342016
    s_mov_b32 s19, 0x00020000
    s_add_u32 s4, s58, 153108480
    s_addc_u32 s5, s59, 0
    s_and_b32 s5, s5, 0xffff
    s_cmp_eq_u32 s3, 0
    s_cselect_b32 s6, 128, 0
    s_mov_b32 s7, 0x00020000
    s_mov_b32 s46, 155712
    s_cselect_b32 s46, s46, 155776
    s_mov_b32 s47, 155712
    s_cselect_b32 s47, s47, 155744
    s_cselect_b32 s45, 4, 0
    s_mov_b32 s50, s45
    v_and_b32 v8, 15, v2
    v_lshrrev_b32 v9, 4, v2
    v_lshlrev_b32 v1, 4, v2
    s_mul_i32 s30, s3, 5120
    s_mov_b32 s36, s30
    s_lshl_b32 s31, s3, 12
    s_add_u32 s37, s31, 22528
    s_lshr_b32 s28, s3, 1
    s_and_b32 s29, s3, 1
    s_lshl_b32 s33, s29, 9
    s_add_u32 s33, s33, 20480
    s_mul_i32 s38, s28, 896
    s_add_u32 s38, s38, s33
    s_lshl_b32 s34, s51, 1
    s_add_u32 s34, s34, s28
    s_mul_i32 s34, s34, 684032
    s_add_u32 s64, s58, s34
    s_addc_u32 s65, s59, 0
    s_and_b32 s65, s65, 0xffff
    s_mov_b32 s66, 684032
    s_mov_b32 s67, 0x00020000
    s_mov_b32 s44, 0xffffff
    s_cmp_eq_u32 s29, 0
    s_cselect_b32 s44, -1, s44
    s_mov_b32 s45, 0
    v_lshrrev_b32 v10, 1, v8
    v_xor_b32 v10, v10, v9
    v_lshlrev_b32 v10, 4, v10
    v_lshl_add_u32 v2, v8, 7, v10
    v_xor_b32 v3, 64, v2
    v_lshrrev_b32 v10, 2, v8
    v_lshl_add_u32 v11, v9, 3, v10
    v_lshlrev_b32 v11, 9, v11
    v_and_b32 v12, 1, v9
    v_lshl_or_b32 v10, v12, 2, v10
    s_lshl_b32 s28, s3, 1
    v_xor_b32 v10, s28, v10
    v_lshl_add_u32 v11, v10, 5, v11
    v_and_b32 v10, 3, v8
    v_lshl_add_u32 v11, v10, 3, v11
    v_add_u32 v4, 22528, v11
    s_lshl_b32 s28, s20, 5
    v_xor_b32 v4, s28, v4
    v_and_b32 v10, 3, v8
    v_lshlrev_b32 v10, 2, v10
    v_add_u32 v5, 155648, v10
    s_lshl_b32 s28, s3, 2
    s_add_u32 s28, s28, 155648
    v_mov_b32 v7, s28
    s_mov_b32 s35, 0x80008000
    s_mov_b32 s62, 0
    s_mov_b32 s63, 0
    s_mov_b32 s39, 0
    s_add_u32 m0, s39, s36
    s_nop 0
    buffer_load_dwordx4 v1, s[8:11], s30 offen sc1 lds
    buffer_load_dwordx4 v1, s[8:11], s30 offen offset:1024 sc1 lds
    buffer_load_dwordx4 v1, s[8:11], s30 offen offset:2048 sc1 lds
    buffer_load_dwordx4 v1, s[8:11], s30 offen offset:3072 sc1 lds
    s_add_u32 m0, m0, 4096
    s_add_u32 s34, s30, 4096
    buffer_load_dwordx4 v1, s[8:11], s34 offen sc1 lds
    s_add_u32 m0, s39, s37
    s_add_u32 s30, s30, 21376
    buffer_load_dwordx4 v1, s[12:15], s31 offen sc1 lds
    buffer_load_dwordx4 v1, s[12:15], s31 offen offset:1024 sc1 lds
    buffer_load_dwordx4 v1, s[12:15], s31 offen offset:2048 sc1 lds
    buffer_load_dwordx4 v1, s[12:15], s31 offen offset:3072 sc1 lds
    s_add_u32 m0, s39, s38
    s_mov_b64 exec, s[44:45]
    buffer_load_dwordx4 v1, s[64:67], s33 offen sc1 lds
    s_mov_b64 exec, -1
    s_add_u32 s31, s31, 16384
    s_add_u32 s33, s33, 21376
    s_add_u32 s39, s39, 38912
    s_add_u32 m0, s39, s36
    s_nop 0
    buffer_load_dwordx4 v1, s[8:11], s30 offen sc1 lds
    buffer_load_dwordx4 v1, s[8:11], s30 offen offset:1024 sc1 lds
    buffer_load_dwordx4 v1, s[8:11], s30 offen offset:2048 sc1 lds
    buffer_load_dwordx4 v1, s[8:11], s30 offen offset:3072 sc1 lds
    s_add_u32 m0, m0, 4096
    s_add_u32 s34, s30, 4096
    buffer_load_dwordx4 v1, s[8:11], s34 offen sc1 lds
    s_add_u32 m0, s39, s37
    s_add_u32 s30, s30, 21376
    buffer_load_dwordx4 v1, s[12:15], s31 offen sc1 lds
    buffer_load_dwordx4 v1, s[12:15], s31 offen offset:1024 sc1 lds
    buffer_load_dwordx4 v1, s[12:15], s31 offen offset:2048 sc1 lds
    buffer_load_dwordx4 v1, s[12:15], s31 offen offset:3072 sc1 lds
    s_add_u32 m0, s39, s38
    s_mov_b64 exec, s[44:45]
    buffer_load_dwordx4 v1, s[64:67], s33 offen sc1 lds
    s_mov_b64 exec, -1
    s_add_u32 s31, s31, 16384
    s_add_u32 s33, s33, 21376
    s_add_u32 s39, s39, 38912
    s_add_u32 m0, s39, s36
    s_nop 0
    buffer_load_dwordx4 v1, s[8:11], s30 offen sc1 lds
    buffer_load_dwordx4 v1, s[8:11], s30 offen offset:1024 sc1 lds
    buffer_load_dwordx4 v1, s[8:11], s30 offen offset:2048 sc1 lds
    buffer_load_dwordx4 v1, s[8:11], s30 offen offset:3072 sc1 lds
    s_add_u32 m0, m0, 4096
    s_add_u32 s34, s30, 4096
    buffer_load_dwordx4 v1, s[8:11], s34 offen sc1 lds
    s_add_u32 m0, s39, s37
    s_add_u32 s30, s30, 21376
    buffer_load_dwordx4 v1, s[12:15], s31 offen sc1 lds
    buffer_load_dwordx4 v1, s[12:15], s31 offen offset:1024 sc1 lds
    buffer_load_dwordx4 v1, s[12:15], s31 offen offset:2048 sc1 lds
    buffer_load_dwordx4 v1, s[12:15], s31 offen offset:3072 sc1 lds
    s_add_u32 m0, s39, s38
    s_mov_b64 exec, s[44:45]
    buffer_load_dwordx4 v1, s[64:67], s33 offen sc1 lds
    s_mov_b64 exec, -1
    s_add_u32 s31, s31, 16384
    s_add_u32 s33, s33, 21376
    s_add_u32 s39, s39, 38912
    s_mov_b32 m0, s46
    s_mov_b64 exec, 0xff
    buffer_load_dword v1, s[4:7], 0 offen sc1 lds
    s_mov_b64 exec, -1
    v_lshrrev_b32 v9, 4, v1
    v_and_b32 v8, 15, v9
    v_lshrrev_b32 v9, 4, v9
    v_and_b32 v10, 3, v8
    v_lshlrev_b32 v10, 2, v10
    v_lshrrev_b32 v12, 3, v8
    v_lshl_add_u32 v10, v12, 1, v10
    s_lshl_b32 s28, s3, 4
    s_add_u32 s28, s28, 1
    v_add_u32 v10, s28, v10
    v_bfe_u32 v11, v8, 2, 1
    v_and_b32 v13, 1, v9
    v_lshlrev_b32 v13, 3, v13
    v_mul_u32_u24 v14, 96, v11
    v_mad_u32_u24 v15, v10, v13, v14
    v_mad_u32_u24 v16, v10, 0, v15
    v_mad_u32_u24 v17, v10, 1, v15
    v_mad_u32_u24 v18, v10, 2, v15
    v_mad_u32_u24 v19, v10, 3, v15
    v_mad_u32_u24 v20, v10, 4, v15
    v_mad_u32_u24 v21, v10, 5, v15
    v_mad_u32_u24 v22, v10, 6, v15
    v_mad_u32_u24 v23, v10, 7, v15
    v_and_b32 v16, 127, v16
    v_and_b32 v17, 127, v17
    v_and_b32 v18, 127, v18
    v_and_b32 v19, 127, v19
    v_and_b32 v20, 127, v20
    v_and_b32 v21, 127, v21
    v_and_b32 v22, 127, v22
    v_and_b32 v23, 127, v23
    v_cvt_f32_u32 v16, v16
    v_cvt_f32_u32 v17, v17
    v_cvt_f32_u32 v18, v18
    v_cvt_f32_u32 v19, v19
    v_cvt_f32_u32 v20, v20
    v_cvt_f32_u32 v21, v21
    v_cvt_f32_u32 v22, v22
    v_cvt_f32_u32 v23, v23
    v_mul_f32 v16, 0x3c000000, v16
    v_mul_f32 v17, 0x3c000000, v17
    v_mul_f32 v18, 0x3c000000, v18
    v_mul_f32 v19, 0x3c000000, v19
    v_mul_f32 v20, 0x3c000000, v20
    v_mul_f32 v21, 0x3c000000, v21
    v_mul_f32 v22, 0x3c000000, v22
    v_mul_f32 v23, 0x3c000000, v23
    v_cos_f32 v16, v16
    v_cos_f32 v17, v17
    v_cos_f32 v18, v18
    v_cos_f32 v19, v19
    v_cos_f32 v20, v20
    v_cos_f32 v21, v21
    v_cos_f32 v22, v22
    v_cos_f32 v23, v23
    s_nop 0
    v_cvt_pk_bf16_f32 v24, v16, v17
    v_cvt_pk_bf16_f32 v25, v18, v19
    v_cvt_pk_bf16_f32 v26, v20, v21
    v_cvt_pk_bf16_f32 v27, v22, v23
    v_lshlrev_b32 v32, 16, v24
    v_and_b32 v33, 0xffff0000, v24
    v_sub_f32 v16, v16, v32
    v_sub_f32 v17, v17, v33
    v_lshlrev_b32 v32, 16, v25
    v_and_b32 v33, 0xffff0000, v25
    v_sub_f32 v18, v18, v32
    v_sub_f32 v19, v19, v33
    v_lshlrev_b32 v32, 16, v26
    v_and_b32 v33, 0xffff0000, v26
    v_sub_f32 v20, v20, v32
    v_sub_f32 v21, v21, v33
    v_lshlrev_b32 v32, 16, v27
    v_and_b32 v33, 0xffff0000, v27
    v_sub_f32 v22, v22, v32
    v_sub_f32 v23, v23, v33
    v_cvt_pk_bf16_f32 v28, v16, v17
    v_cvt_pk_bf16_f32 v29, v18, v19
    v_cvt_pk_bf16_f32 v30, v20, v21
    v_cvt_pk_bf16_f32 v31, v22, v23
    v_cmp_lt_u32 vcc, 1, v9
    s_lshl_b32 s28, s3, 10
    s_add_u32 s28, s28, 133120
    v_add_u32 v14, s28, v1
    v_cndmask_b32 v24, v24, v28, vcc
    v_cndmask_b32 v25, v25, v29, vcc
    v_cndmask_b32 v26, v26, v30, vcc
    v_cndmask_b32 v27, v27, v31, vcc
    ds_write_b128 v14, v[24:27]
    v_mov_b32 v12, 0
    v_mov_b32 v13, 0
    v_mov_b32 v14, 0
    v_mov_b32 v15, 0
    s_mul_i32 s28, s3, 38912
    s_add_u32 s28, s28, 22272
    v_add_u32 v16, s28, v1
    s_mov_b64 exec, 0xffff
    ds_write_b128 v16, v[12:15]
    s_mov_b64 exec, -1
    s_lshl_b32 s28, s3, 2
    s_add_u32 s28, s28, 155648
    v_mov_b32 v16, s28
    ds_write_b32 v16, v12
    s_lshl_b32 s28, s3, 3
    s_add_u32 s28, s28, 155680
    v_mov_b32 v16, s28
    ds_write_b64 v16, v[12:13]
    s_lshl_b32 s28, s3, 3
    s_add_u32 s28, s28, 155712
    v_mov_b32 v16, s28
    ds_write_b64 v16, v[12:13]
    s_lshl_b32 s28, s3, 3
    s_add_u32 s28, s28, 155840
    v_mov_b32 v16, s28
    ds_write_b64 v16, v[12:13]
    v_mov_b32 v16, 155664
    ds_write_b32 v16, v12
    v_mov_b32 v16, 155744
    v_mov_b32 v17, 1
    ds_write_b32 v16, v17
    s_waitcnt lgkmcnt(0)
    s_barrier
    v_mov_b32 v80, 0
    v_mov_b32 v81, 0
    v_mov_b32 v82, 0
    v_mov_b32 v83, 0
    v_mov_b32 v84, 0
    v_mov_b32 v85, 0
    v_mov_b32 v86, 0
    v_mov_b32 v87, 0
    v_mov_b32 v88, 0
    v_mov_b32 v89, 0
    v_mov_b32 v90, 0
    v_mov_b32 v91, 0
    v_mov_b32 v92, 0
    v_mov_b32 v93, 0
    v_mov_b32 v94, 0
    v_mov_b32 v95, 0
    v_mov_b32 v96, 0
    v_mov_b32 v97, 0
    v_mov_b32 v98, 0
    v_mov_b32 v99, 0
    v_mov_b32 v100, 0
    v_mov_b32 v101, 0
    v_mov_b32 v102, 0
    v_mov_b32 v103, 0
    v_mov_b32 v104, 0
    v_mov_b32 v105, 0
    v_mov_b32 v106, 0
    v_mov_b32 v107, 0
    v_mov_b32 v108, 0
    v_mov_b32 v109, 0
    v_mov_b32 v110, 0
    v_mov_b32 v111, 0
    v_mov_b32 v112, 0
    v_mov_b32 v113, 0
    v_mov_b32 v114, 0
    v_mov_b32 v115, 0
    v_mov_b32 v116, 0
    v_mov_b32 v117, 0
    v_mov_b32 v118, 0
    v_mov_b32 v119, 0
    v_mov_b32 v120, 0
    v_mov_b32 v121, 0
    v_mov_b32 v122, 0
    v_mov_b32 v123, 0
    v_mov_b32 v124, 0
    v_mov_b32 v125, 0
    v_mov_b32 v126, 0
    v_mov_b32 v127, 0
    v_mov_b32 v128, 0
    v_mov_b32 v129, 0
    v_mov_b32 v130, 0
    v_mov_b32 v131, 0
    v_mov_b32 v132, 0
    v_mov_b32 v133, 0
    v_mov_b32 v134, 0
    v_mov_b32 v135, 0
    v_mov_b32 v136, 0
    v_mov_b32 v137, 0
    v_mov_b32 v138, 0
    v_mov_b32 v139, 0
    v_mov_b32 v140, 0
    v_mov_b32 v141, 0
    v_mov_b32 v142, 0
    v_mov_b32 v143, 0
    v_mov_b32 v144, 0
    v_mov_b32 v145, 0
    v_mov_b32 v146, 0
    v_mov_b32 v147, 0
    v_mov_b32 v148, 0
    v_mov_b32 v149, 0
    v_mov_b32 v150, 0
    v_mov_b32 v151, 0
    v_mov_b32 v152, 0
    v_mov_b32 v153, 0
    v_mov_b32 v154, 0
    v_mov_b32 v155, 0
    v_mov_b32 v156, 0
    v_mov_b32 v157, 0
    v_mov_b32 v158, 0
    v_mov_b32 v159, 0
    v_mov_b32 v160, 0
    v_mov_b32 v161, 0
    v_mov_b32 v162, 0
    v_mov_b32 v163, 0
    v_mov_b32 v164, 0
    v_mov_b32 v165, 0
    v_mov_b32 v166, 0
    v_mov_b32 v167, 0
    v_mov_b32 v168, 0
    v_mov_b32 v169, 0
    v_mov_b32 v170, 0
    v_mov_b32 v171, 0
    v_mov_b32 v172, 0
    v_mov_b32 v173, 0
    v_mov_b32 v174, 0
    v_mov_b32 v175, 0
    v_mov_b32 v176, 0
    v_mov_b32 v177, 0
    v_mov_b32 v178, 0
    v_mov_b32 v179, 0
    v_mov_b32 v180, 0
    v_mov_b32 v181, 0
    v_mov_b32 v182, 0
    v_mov_b32 v183, 0
    v_mov_b32 v184, 0
    v_mov_b32 v185, 0
    v_mov_b32 v186, 0
    v_mov_b32 v187, 0
    v_mov_b32 v188, 0
    v_mov_b32 v189, 0
    v_mov_b32 v190, 0
    v_mov_b32 v191, 0
    v_mov_b32 v192, 0
    v_mov_b32 v193, 0
    v_mov_b32 v194, 0
    v_mov_b32 v195, 0
    v_mov_b32 v196, 0
    v_mov_b32 v197, 0
    v_mov_b32 v198, 0
    v_mov_b32 v199, 0
    v_mov_b32 v200, 0
    v_mov_b32 v201, 0
    v_mov_b32 v202, 0
    v_mov_b32 v203, 0
    v_mov_b32 v204, 0
    v_mov_b32 v205, 0
    v_mov_b32 v206, 0
    v_mov_b32 v207, 0
    v_mov_b32 v208, 0
    v_mov_b32 v209, 0
    v_mov_b32 v210, 0
    v_mov_b32 v211, 0
    v_mov_b32 v212, 0
    v_mov_b32 v213, 0
    v_mov_b32 v214, 0
    v_mov_b32 v215, 0
    v_mov_b32 v216, 0
    v_mov_b32 v217, 0
    v_mov_b32 v218, 0
    v_mov_b32 v219, 0
    v_mov_b32 v220, 0
    v_mov_b32 v221, 0
    v_mov_b32 v222, 0
    v_mov_b32 v223, 0
    v_mov_b32 v224, 0
    v_mov_b32 v225, 0
    v_mov_b32 v226, 0
    v_mov_b32 v227, 0
    v_mov_b32 v228, 0
    v_mov_b32 v229, 0
    v_mov_b32 v230, 0
    v_mov_b32 v231, 0
    v_mov_b32 v232, 0
    v_mov_b32 v233, 0
    v_mov_b32 v234, 0
    v_mov_b32 v235, 0
    v_mov_b32 v236, 0
    v_mov_b32 v237, 0
    v_mov_b32 v238, 0
    v_mov_b32 v239, 0
    v_mov_b32 v240, 0
    v_mov_b32 v241, 0
    v_mov_b32 v242, 0
    v_mov_b32 v243, 0
    v_mov_b32 v244, 0
    v_mov_b32 v245, 0
    v_mov_b32 v246, 0
    v_mov_b32 v247, 0
    v_mov_b32 v248, 0
    v_mov_b32 v249, 0
    v_mov_b32 v250, 0
    v_mov_b32 v251, 0
    v_mov_b32 v252, 0
    v_mov_b32 v253, 0
    v_mov_b32 v254, 0
    v_mov_b32 v255, 0
    s_barrier
    s_mov_b32 s40, 2
    v_mov_b32 v0, s40
    s_waitcnt vmcnt(21)
    ds_write_b32 v7, v0
    s_branch K12_S0
K12_Q0:
    ds_read_b64_tr_b16 v[40:41], v4 offset:0
    ds_read_b64_tr_b16 v[42:43], v4 offset:2048
    ds_read_b64_tr_b16 v[44:45], v4 offset:256
    ds_read_b64_tr_b16 v[46:47], v4 offset:2304
    v_xor_b32 v4, 32, v4
    ds_read_b64_tr_b16 v[48:49], v4 offset:0
    ds_read_b64_tr_b16 v[50:51], v4 offset:2048
    ds_read_b64_tr_b16 v[52:53], v4 offset:256
    ds_read_b64_tr_b16 v[54:55], v4 offset:2304
    v_xor_b32 v4, 32, v4
    ds_read_b128 v[8:11], v2 offset:0
    ds_read_b128 v[12:15], v3 offset:0
    ds_read_b128 v[16:19], v2 offset:2048
    ds_read_b128 v[20:23], v3 offset:2048
    ds_read_b128 v[32:35], v2 offset:6144
    ds_read_b128 v[36:39], v3 offset:6144
    ds_read_b32 v68, v5
    s_waitcnt lgkmcnt(7)
    v_xor_b32 v72, s35, v44
    v_xor_b32 v73, s35, v45
    v_xor_b32 v74, s35, v46
    v_xor_b32 v75, s35, v47
    v_xor_b32 v76, s35, v52
    v_xor_b32 v77, s35, v53
    v_xor_b32 v78, s35, v54
    v_xor_b32 v79, s35, v55
    s_mov_b32 s41, 0
    s_mov_b32 s42, 38912
    s_mov_b32 s39, 0
    s_mov_b32 s29, 116736
K12_LOOP:
    s_waitcnt lgkmcnt(2)
    v_mfma_f32_16x16x32_bf16 v[80:83], v[8:11], v[40:43], v[80:83]
    ds_read_b128 v[24:27], v2 offset:4096
    v_xor_b32 v72, s35, v44
    v_xor_b32 v73, s35, v45
    v_mfma_f32_16x16x32_bf16 v[84:87], v[8:11], v[44:47], v[84:87]
    ds_read_b128 v[28:31], v3 offset:4096
    v_xor_b32 v74, s35, v46
    v_xor_b32 v75, s35, v47
    v_mfma_f32_16x16x32_bf16 v[88:91], v[8:11], v[48:51], v[88:91]
    s_waitcnt lgkmcnt(2)
    v_cmp_gt_u32 vcc, s40, v68
    s_add_u32 s49, s39, 2
    s_lshr_b32 s49, s49, 1
    v_xor_b32 v76, s35, v52
    v_xor_b32 v77, s35, v53
    v_mfma_f32_16x16x32_bf16 v[92:95], v[8:11], v[52:55], v[92:95]
    s_cbranch_vccnz K12_S1
K12_Q1:
    s_mul_i32 s48, s49, s50
    s_add_u32 s48, s48, s47
    v_xor_b32 v78, s35, v54
    v_xor_b32 v79, s35, v55
    v_mfma_f32_16x16x32_bf16 v[80:83], v[12:15], v[72:75], v[80:83]
    s_add_u32 m0, s29, s36
    s_nop 0
    buffer_load_dwordx4 v1, s[8:11], s30 offen sc1 lds
    v_mfma_f32_16x16x32_bf16 v[84:87], v[12:15], v[40:43], v[84:87]
    s_cmp_lt_u32 s49, 8
    s_cselect_b32 s48, s48, 155744
    v_mfma_f32_16x16x32_bf16 v[88:91], v[12:15], v[76:79], v[88:91]
    s_cmp_ge_u32 s49, 3
    s_cselect_b32 s48, s48, 155744
    v_mfma_f32_16x16x32_bf16 v[92:95], v[12:15], v[48:51], v[92:95]
    v_mfma_f32_16x16x32_bf16 v[96:99], v[16:19], v[40:43], v[96:99]
    ds_read_b128 v[8:11], v2 offset:8192
    v_mfma_f32_16x16x32_bf16 v[100:103], v[16:19], v[44:47], v[100:103]
    ds_read_b128 v[12:15], v3 offset:8192
    v_mfma_f32_16x16x32_bf16 v[104:107], v[16:19], v[48:51], v[104:107]
    buffer_load_dwordx4 v1, s[8:11], s30 offen offset:1024 sc1 lds
    v_mfma_f32_16x16x32_bf16 v[108:111], v[16:19], v[52:55], v[108:111]
    v_mfma_f32_16x16x32_bf16 v[96:99], v[20:23], v[72:75], v[96:99]
    v_mfma_f32_16x16x32_bf16 v[100:103], v[20:23], v[40:43], v[100:103]
    v_mfma_f32_16x16x32_bf16 v[104:107], v[20:23], v[76:79], v[104:107]
    buffer_load_dwordx4 v1, s[8:11], s30 offen offset:2048 sc1 lds
    v_mfma_f32_16x16x32_bf16 v[108:111], v[20:23], v[48:51], v[108:111]
    s_waitcnt lgkmcnt(2)
    v_mfma_f32_16x16x32_bf16 v[112:115], v[24:27], v[40:43], v[112:115]
    ds_read_b128 v[16:19], v2 offset:10240
    v_mfma_f32_16x16x32_bf16 v[116:119], v[24:27], v[44:47], v[116:119]
    ds_read_b128 v[20:23], v3 offset:10240
    v_mfma_f32_16x16x32_bf16 v[120:123], v[24:27], v[48:51], v[120:123]
    v_mfma_f32_16x16x32_bf16 v[124:127], v[24:27], v[52:55], v[124:127]
    v_mfma_f32_16x16x32_bf16 v[112:115], v[28:31], v[72:75], v[112:115]
    buffer_load_dwordx4 v1, s[8:11], s30 offen offset:3072 sc1 lds
    v_mfma_f32_16x16x32_bf16 v[116:119], v[28:31], v[40:43], v[116:119]
    v_mfma_f32_16x16x32_bf16 v[120:123], v[28:31], v[76:79], v[120:123]
    v_mfma_f32_16x16x32_bf16 v[124:127], v[28:31], v[48:51], v[124:127]
    v_mfma_f32_16x16x32_bf16 v[128:131], v[32:35], v[40:43], v[128:131]
    ds_read_b128 v[24:27], v2 offset:12288
    v_mfma_f32_16x16x32_bf16 v[132:135], v[32:35], v[44:47], v[132:135]
    ds_read_b128 v[28:31], v3 offset:12288
    v_mfma_f32_16x16x32_bf16 v[136:139], v[32:35], v[48:51], v[136:139]
    s_add_u32 m0, m0, 4096
    s_add_u32 s34, s30, 4096
    buffer_load_dwordx4 v1, s[8:11], s34 offen sc1 lds
    v_mfma_f32_16x16x32_bf16 v[140:143], v[32:35], v[52:55], v[140:143]
    v_mfma_f32_16x16x32_bf16 v[128:131], v[36:39], v[72:75], v[128:131]
    v_mfma_f32_16x16x32_bf16 v[132:135], v[36:39], v[40:43], v[132:135]
    v_mfma_f32_16x16x32_bf16 v[136:139], v[36:39], v[76:79], v[136:139]
    s_add_u32 m0, s29, s37
    s_add_u32 s30, s30, 21376
    buffer_load_dwordx4 v1, s[12:15], s31 offen sc1 lds
    v_mfma_f32_16x16x32_bf16 v[140:143], v[36:39], v[48:51], v[140:143]
    s_waitcnt lgkmcnt(4)
    v_mfma_f32_16x16x32_bf16 v[144:147], v[8:11], v[40:43], v[144:147]
    ds_read_b128 v[32:35], v2 offset:14336
    v_mfma_f32_16x16x32_bf16 v[148:151], v[8:11], v[44:47], v[148:151]
    ds_read_b128 v[36:39], v3 offset:14336
    v_mfma_f32_16x16x32_bf16 v[152:155], v[8:11], v[48:51], v[152:155]
    v_mfma_f32_16x16x32_bf16 v[156:159], v[8:11], v[52:55], v[156:159]
    v_mfma_f32_16x16x32_bf16 v[144:147], v[12:15], v[72:75], v[144:147]
    buffer_load_dwordx4 v1, s[12:15], s31 offen offset:1024 sc1 lds
    v_mfma_f32_16x16x32_bf16 v[148:151], v[12:15], v[40:43], v[148:151]
    v_mfma_f32_16x16x32_bf16 v[152:155], v[12:15], v[76:79], v[152:155]
    v_mfma_f32_16x16x32_bf16 v[156:159], v[12:15], v[48:51], v[156:159]
    s_waitcnt lgkmcnt(4)
    v_mfma_f32_16x16x32_bf16 v[160:163], v[16:19], v[40:43], v[160:163]
    ds_read_b128 v[8:11], v2 offset:16384
    v_mfma_f32_16x16x32_bf16 v[164:167], v[16:19], v[44:47], v[164:167]
    ds_read_b128 v[12:15], v3 offset:16384
    v_mfma_f32_16x16x32_bf16 v[168:171], v[16:19], v[48:51], v[168:171]
    buffer_load_dwordx4 v1, s[12:15], s31 offen offset:2048 sc1 lds
    v_mfma_f32_16x16x32_bf16 v[172:175], v[16:19], v[52:55], v[172:175]
    s_add_u32 s40, s40, 1
    s_mov_b32 s51, s40
    v_mov_b32 v0, s40
    v_mfma_f32_16x16x32_bf16 v[160:163], v[20:23], v[72:75], v[160:163]
    s_waitcnt vmcnt(19)
    ds_write_b32 v7, v0
    v_mfma_f32_16x16x32_bf16 v[164:167], v[20:23], v[40:43], v[164:167]
    v_mfma_f32_16x16x32_bf16 v[168:171], v[20:23], v[76:79], v[168:171]
    buffer_load_dwordx4 v1, s[12:15], s31 offen offset:3072 sc1 lds
    v_mfma_f32_16x16x32_bf16 v[172:175], v[20:23], v[48:51], v[172:175]
    s_waitcnt lgkmcnt(5)
    v_mfma_f32_16x16x32_bf16 v[176:179], v[24:27], v[40:43], v[176:179]
    ds_read_b128 v[16:19], v2 offset:18432
    v_mfma_f32_16x16x32_bf16 v[180:183], v[24:27], v[44:47], v[180:183]
    ds_read_b128 v[20:23], v3 offset:18432
    v_mov_b32 v0, s48
    v_mfma_f32_16x16x32_bf16 v[184:187], v[24:27], v[48:51], v[184:187]
    ds_read_b32 v0, v0
    v_mfma_f32_16x16x32_bf16 v[188:191], v[24:27], v[52:55], v[188:191]
    v_mfma_f32_16x16x32_bf16 v[176:179], v[28:31], v[72:75], v[176:179]
    s_add_u32 m0, s29, s38
    s_mov_b64 exec, s[44:45]
    buffer_load_dwordx4 v1, s[64:67], s33 offen sc1 lds
    s_mov_b64 exec, -1
    s_add_u32 s31, s31, 16384
    s_add_u32 s33, s33, 21376
    v_mfma_f32_16x16x32_bf16 v[180:183], v[28:31], v[40:43], v[180:183]
    v_mfma_f32_16x16x32_bf16 v[184:187], v[28:31], v[76:79], v[184:187]
    v_mfma_f32_16x16x32_bf16 v[188:191], v[28:31], v[48:51], v[188:191]
    s_waitcnt lgkmcnt(0)
    v_cmp_eq_u32 vcc, 0, v0
    v_mfma_f32_16x16x32_bf16 v[192:195], v[32:35], v[40:43], v[192:195]
    ds_read_b128 v[24:27], v2 offset:20480
    v_mfma_f32_16x16x32_bf16 v[196:199], v[32:35], v[44:47], v[196:199]
    ds_read_b128 v[28:31], v3 offset:20480
    s_cbranch_vccnz K12_F2
K12_G2:
    v_mfma_f32_16x16x32_bf16 v[200:203], v[32:35], v[48:51], v[200:203]
    s_sub_u32 s43, s42, s41
    s_add_u32 s40, s40, 1
    v_add_u32 v2, s43, v2
    v_mfma_f32_16x16x32_bf16 v[204:207], v[32:35], v[52:55], v[204:207]
    v_add_u32 v3, s43, v3
    v_add_u32 v4, s43, v4
    v_mov_b32 v0, s40
    v_mfma_f32_16x16x32_bf16 v[192:195], v[36:39], v[72:75], v[192:195]
    ds_write_b32 v7, v0
    v_mfma_f32_16x16x32_bf16 v[196:199], v[36:39], v[40:43], v[196:199]
    v_mfma_f32_16x16x32_bf16 v[200:203], v[36:39], v[76:79], v[200:203]
    v_mfma_f32_16x16x32_bf16 v[204:207], v[36:39], v[48:51], v[204:207]
    ds_read_b32 v56, v5
    v_mfma_f32_16x16x32_bf16 v[208:211], v[8:11], v[40:43], v[208:211]
    v_mfma_f32_16x16x32_bf16 v[212:215], v[8:11], v[44:47], v[212:215]
    v_mfma_f32_16x16x32_bf16 v[216:219], v[8:11], v[48:51], v[216:219]
    v_mfma_f32_16x16x32_bf16 v[220:223], v[8:11], v[52:55], v[220:223]
    s_waitcnt lgkmcnt(0)
    v_cmp_gt_u32 vcc, s51, v56
    v_mfma_f32_16x16x32_bf16 v[208:211], v[12:15], v[72:75], v[208:211]
    v_mfma_f32_16x16x32_bf16 v[212:215], v[12:15], v[40:43], v[212:215]
    s_cbranch_vccnz K12_S3
K12_Q3:
    v_mfma_f32_16x16x32_bf16 v[216:219], v[12:15], v[76:79], v[216:219]
    ds_read_b64_tr_b16 v[56:57], v4 offset:0
    v_mfma_f32_16x16x32_bf16 v[220:223], v[12:15], v[48:51], v[220:223]
    ds_read_b64_tr_b16 v[58:59], v4 offset:2048
    v_mfma_f32_16x16x32_bf16 v[224:227], v[16:19], v[40:43], v[224:227]
    ds_read_b64_tr_b16 v[60:61], v4 offset:256
    ds_read_b128 v[8:11], v2 offset:0
    v_mfma_f32_16x16x32_bf16 v[228:231], v[16:19], v[44:47], v[228:231]
    ds_read_b64_tr_b16 v[62:63], v4 offset:2304
    ds_read_b128 v[12:15], v3 offset:0
    v_mfma_f32_16x16x32_bf16 v[232:235], v[16:19], v[48:51], v[232:235]
    v_xor_b32 v4, 32, v4
    ds_read_b128 v[32:35], v2 offset:6144
    v_mfma_f32_16x16x32_bf16 v[236:239], v[16:19], v[52:55], v[236:239]
    ds_read_b64_tr_b16 v[64:65], v4 offset:0
    ds_read_b128 v[36:39], v3 offset:6144
    v_mfma_f32_16x16x32_bf16 v[224:227], v[20:23], v[72:75], v[224:227]
    ds_read_b64_tr_b16 v[66:67], v4 offset:2048
    ds_read_b32 v52, v5
    v_mfma_f32_16x16x32_bf16 v[228:231], v[20:23], v[40:43], v[228:231]
    ds_read_b64_tr_b16 v[68:69], v4 offset:256
    ds_read_b64_tr_b16 v[70:71], v4 offset:2304
    v_xor_b32 v4, 32, v4
    v_mfma_f32_16x16x32_bf16 v[232:235], v[20:23], v[76:79], v[232:235]
    v_mfma_f32_16x16x32_bf16 v[236:239], v[20:23], v[48:51], v[236:239]
    v_mfma_f32_16x16x32_bf16 v[240:243], v[24:27], v[40:43], v[240:243]
    ds_read_b128 v[16:19], v2 offset:2048
    v_mfma_f32_16x16x32_bf16 v[244:247], v[24:27], v[44:47], v[244:247]
    ds_read_b128 v[20:23], v3 offset:2048
    v_mfma_f32_16x16x32_bf16 v[240:243], v[28:31], v[72:75], v[240:243]
    s_mov_b32 s29, s41
    s_mov_b32 s41, s42
    s_add_u32 s42, s42, 38912
    v_mfma_f32_16x16x32_bf16 v[244:247], v[28:31], v[40:43], v[244:247]
    s_cmp_eq_u32 s42, 155648
    s_cselect_b32 s42, 0, s42
    s_waitcnt lgkmcnt(2)
    v_mfma_f32_16x16x32_bf16 v[80:83], v[8:11], v[56:59], v[80:83]
    ds_read_b128 v[24:27], v2 offset:4096
    v_xor_b32 v72, s35, v60
    v_xor_b32 v73, s35, v61
    v_mfma_f32_16x16x32_bf16 v[84:87], v[8:11], v[60:63], v[84:87]
    ds_read_b128 v[28:31], v3 offset:4096
    v_xor_b32 v74, s35, v62
    v_xor_b32 v75, s35, v63
    v_mfma_f32_16x16x32_bf16 v[88:91], v[8:11], v[64:67], v[88:91]
    s_waitcnt lgkmcnt(2)
    v_cmp_gt_u32 vcc, s40, v52
    v_xor_b32 v76, s35, v68
    v_xor_b32 v77, s35, v69
    v_mfma_f32_16x16x32_bf16 v[92:95], v[8:11], v[68:71], v[92:95]
    s_cbranch_vccnz K12_S4
K12_Q4:
    v_xor_b32 v78, s35, v70
    v_xor_b32 v79, s35, v71
    v_mfma_f32_16x16x32_bf16 v[80:83], v[12:15], v[72:75], v[80:83]
    s_add_u32 m0, s29, s36
    s_nop 0
    buffer_load_dwordx4 v1, s[8:11], s30 offen sc1 lds
    v_mfma_f32_16x16x32_bf16 v[84:87], v[12:15], v[56:59], v[84:87]
    v_mfma_f32_16x16x32_bf16 v[88:91], v[12:15], v[76:79], v[88:91]
    v_mfma_f32_16x16x32_bf16 v[92:95], v[12:15], v[64:67], v[92:95]
    v_mfma_f32_16x16x32_bf16 v[96:99], v[16:19], v[56:59], v[96:99]
    ds_read_b128 v[8:11], v2 offset:8192
    v_mfma_f32_16x16x32_bf16 v[100:103], v[16:19], v[60:63], v[100:103]
    ds_read_b128 v[12:15], v3 offset:8192
    v_mfma_f32_16x16x32_bf16 v[104:107], v[16:19], v[64:67], v[104:107]
    buffer_load_dwordx4 v1, s[8:11], s30 offen offset:1024 sc1 lds
    v_mfma_f32_16x16x32_bf16 v[108:111], v[16:19], v[68:71], v[108:111]
    v_mfma_f32_16x16x32_bf16 v[96:99], v[20:23], v[72:75], v[96:99]
    v_mfma_f32_16x16x32_bf16 v[100:103], v[20:23], v[56:59], v[100:103]
    v_mfma_f32_16x16x32_bf16 v[104:107], v[20:23], v[76:79], v[104:107]
    buffer_load_dwordx4 v1, s[8:11], s30 offen offset:2048 sc1 lds
    v_mfma_f32_16x16x32_bf16 v[108:111], v[20:23], v[64:67], v[108:111]
    s_waitcnt lgkmcnt(2)
    v_mfma_f32_16x16x32_bf16 v[112:115], v[24:27], v[56:59], v[112:115]
    ds_read_b128 v[16:19], v2 offset:10240
    v_mfma_f32_16x16x32_bf16 v[116:119], v[24:27], v[60:63], v[116:119]
    ds_read_b128 v[20:23], v3 offset:10240
    v_mfma_f32_16x16x32_bf16 v[120:123], v[24:27], v[64:67], v[120:123]
    v_mfma_f32_16x16x32_bf16 v[124:127], v[24:27], v[68:71], v[124:127]
    v_mfma_f32_16x16x32_bf16 v[112:115], v[28:31], v[72:75], v[112:115]
    buffer_load_dwordx4 v1, s[8:11], s30 offen offset:3072 sc1 lds
    v_mfma_f32_16x16x32_bf16 v[116:119], v[28:31], v[56:59], v[116:119]
    v_mfma_f32_16x16x32_bf16 v[120:123], v[28:31], v[76:79], v[120:123]
    v_mfma_f32_16x16x32_bf16 v[124:127], v[28:31], v[64:67], v[124:127]
    v_mfma_f32_16x16x32_bf16 v[128:131], v[32:35], v[56:59], v[128:131]
    ds_read_b128 v[24:27], v2 offset:12288
    v_mfma_f32_16x16x32_bf16 v[132:135], v[32:35], v[60:63], v[132:135]
    ds_read_b128 v[28:31], v3 offset:12288
    v_mfma_f32_16x16x32_bf16 v[136:139], v[32:35], v[64:67], v[136:139]
    s_add_u32 m0, m0, 4096
    s_add_u32 s34, s30, 4096
    buffer_load_dwordx4 v1, s[8:11], s34 offen sc1 lds
    v_mfma_f32_16x16x32_bf16 v[140:143], v[32:35], v[68:71], v[140:143]
    v_mfma_f32_16x16x32_bf16 v[128:131], v[36:39], v[72:75], v[128:131]
    v_mfma_f32_16x16x32_bf16 v[132:135], v[36:39], v[56:59], v[132:135]
    v_mfma_f32_16x16x32_bf16 v[136:139], v[36:39], v[76:79], v[136:139]
    s_add_u32 m0, s29, s37
    s_add_u32 s30, s30, 21376
    buffer_load_dwordx4 v1, s[12:15], s31 offen sc1 lds
    v_mfma_f32_16x16x32_bf16 v[140:143], v[36:39], v[64:67], v[140:143]
    s_waitcnt lgkmcnt(4)
    v_mfma_f32_16x16x32_bf16 v[144:147], v[8:11], v[56:59], v[144:147]
    ds_read_b128 v[32:35], v2 offset:14336
    v_mfma_f32_16x16x32_bf16 v[148:151], v[8:11], v[60:63], v[148:151]
    ds_read_b128 v[36:39], v3 offset:14336
    v_mfma_f32_16x16x32_bf16 v[152:155], v[8:11], v[64:67], v[152:155]
    v_mfma_f32_16x16x32_bf16 v[156:159], v[8:11], v[68:71], v[156:159]
    v_mfma_f32_16x16x32_bf16 v[144:147], v[12:15], v[72:75], v[144:147]
    buffer_load_dwordx4 v1, s[12:15], s31 offen offset:1024 sc1 lds
    v_mfma_f32_16x16x32_bf16 v[148:151], v[12:15], v[56:59], v[148:151]
    v_mfma_f32_16x16x32_bf16 v[152:155], v[12:15], v[76:79], v[152:155]
    v_mfma_f32_16x16x32_bf16 v[156:159], v[12:15], v[64:67], v[156:159]
    s_waitcnt lgkmcnt(4)
    v_mfma_f32_16x16x32_bf16 v[160:163], v[16:19], v[56:59], v[160:163]
    ds_read_b128 v[8:11], v2 offset:16384
    v_mfma_f32_16x16x32_bf16 v[164:167], v[16:19], v[60:63], v[164:167]
    ds_read_b128 v[12:15], v3 offset:16384
    v_mfma_f32_16x16x32_bf16 v[168:171], v[16:19], v[64:67], v[168:171]
    buffer_load_dwordx4 v1, s[12:15], s31 offen offset:2048 sc1 lds
    v_mfma_f32_16x16x32_bf16 v[172:175], v[16:19], v[68:71], v[172:175]
    s_add_u32 s40, s40, 1
    s_mov_b32 s51, s40
    v_mov_b32 v0, s40
    v_mfma_f32_16x16x32_bf16 v[160:163], v[20:23], v[72:75], v[160:163]
    s_waitcnt vmcnt(19)
    ds_write_b32 v7, v0
    v_mfma_f32_16x16x32_bf16 v[164:167], v[20:23], v[56:59], v[164:167]
    v_mfma_f32_16x16x32_bf16 v[168:171], v[20:23], v[76:79], v[168:171]
    buffer_load_dwordx4 v1, s[12:15], s31 offen offset:3072 sc1 lds
    v_mfma_f32_16x16x32_bf16 v[172:175], v[20:23], v[64:67], v[172:175]
    s_waitcnt lgkmcnt(5)
    v_mfma_f32_16x16x32_bf16 v[176:179], v[24:27], v[56:59], v[176:179]
    ds_read_b128 v[16:19], v2 offset:18432
    v_mfma_f32_16x16x32_bf16 v[180:183], v[24:27], v[60:63], v[180:183]
    ds_read_b128 v[20:23], v3 offset:18432
    v_mfma_f32_16x16x32_bf16 v[184:187], v[24:27], v[64:67], v[184:187]
    v_mfma_f32_16x16x32_bf16 v[188:191], v[24:27], v[68:71], v[188:191]
    v_mfma_f32_16x16x32_bf16 v[176:179], v[28:31], v[72:75], v[176:179]
    s_add_u32 m0, s29, s38
    s_mov_b64 exec, s[44:45]
    buffer_load_dwordx4 v1, s[64:67], s33 offen sc1 lds
    s_mov_b64 exec, -1
    s_add_u32 s31, s31, 16384
    s_add_u32 s33, s33, 21376
    v_mfma_f32_16x16x32_bf16 v[180:183], v[28:31], v[56:59], v[180:183]
    v_mfma_f32_16x16x32_bf16 v[184:187], v[28:31], v[76:79], v[184:187]
    s_mov_b32 m0, s46
    s_mov_b64 exec, 0xff
    buffer_load_dword v1, s[4:7], 0 offen sc1 lds
    s_mov_b64 exec, -1
    v_mfma_f32_16x16x32_bf16 v[188:191], v[28:31], v[64:67], v[188:191]
    s_waitcnt lgkmcnt(5)
    v_mfma_f32_16x16x32_bf16 v[192:195], v[32:35], v[56:59], v[192:195]
    ds_read_b128 v[24:27], v2 offset:20480
    v_mfma_f32_16x16x32_bf16 v[196:199], v[32:35], v[60:63], v[196:199]
    ds_read_b128 v[28:31], v3 offset:20480
    v_mfma_f32_16x16x32_bf16 v[200:203], v[32:35], v[64:67], v[200:203]
    s_sub_u32 s43, s42, s41
    s_add_u32 s40, s40, 1
    v_add_u32 v2, s43, v2
    v_mfma_f32_16x16x32_bf16 v[204:207], v[32:35], v[68:71], v[204:207]
    v_add_u32 v3, s43, v3
    v_add_u32 v4, s43, v4
    v_mov_b32 v0, s40
    v_mfma_f32_16x16x32_bf16 v[192:195], v[36:39], v[72:75], v[192:195]
    ds_write_b32 v7, v0
    v_mfma_f32_16x16x32_bf16 v[196:199], v[36:39], v[56:59], v[196:199]
    v_mfma_f32_16x16x32_bf16 v[200:203], v[36:39], v[76:79], v[200:203]
    v_mfma_f32_16x16x32_bf16 v[204:207], v[36:39], v[64:67], v[204:207]
    ds_read_b32 v40, v5
    s_waitcnt lgkmcnt(7)
    v_mfma_f32_16x16x32_bf16 v[208:211], v[8:11], v[56:59], v[208:211]
    v_mfma_f32_16x16x32_bf16 v[212:215], v[8:11], v[60:63], v[212:215]
    v_mfma_f32_16x16x32_bf16 v[216:219], v[8:11], v[64:67], v[216:219]
    v_mfma_f32_16x16x32_bf16 v[220:223], v[8:11], v[68:71], v[220:223]
    s_waitcnt lgkmcnt(0)
    v_cmp_gt_u32 vcc, s51, v40
    v_mfma_f32_16x16x32_bf16 v[208:211], v[12:15], v[72:75], v[208:211]
    v_mfma_f32_16x16x32_bf16 v[212:215], v[12:15], v[56:59], v[212:215]
    s_cbranch_vccnz K12_S5
K12_Q5:
    v_mfma_f32_16x16x32_bf16 v[216:219], v[12:15], v[76:79], v[216:219]
    ds_read_b64_tr_b16 v[40:41], v4 offset:0
    v_mfma_f32_16x16x32_bf16 v[220:223], v[12:15], v[64:67], v[220:223]
    ds_read_b64_tr_b16 v[42:43], v4 offset:2048
    v_mfma_f32_16x16x32_bf16 v[224:227], v[16:19], v[56:59], v[224:227]
    ds_read_b64_tr_b16 v[44:45], v4 offset:256
    ds_read_b128 v[8:11], v2 offset:0
    v_mfma_f32_16x16x32_bf16 v[228:231], v[16:19], v[60:63], v[228:231]
    ds_read_b64_tr_b16 v[46:47], v4 offset:2304
    ds_read_b128 v[12:15], v3 offset:0
    v_mfma_f32_16x16x32_bf16 v[232:235], v[16:19], v[64:67], v[232:235]
    v_xor_b32 v4, 32, v4
    ds_read_b128 v[32:35], v2 offset:6144
    v_mfma_f32_16x16x32_bf16 v[236:239], v[16:19], v[68:71], v[236:239]
    ds_read_b64_tr_b16 v[48:49], v4 offset:0
    ds_read_b128 v[36:39], v3 offset:6144
    v_mfma_f32_16x16x32_bf16 v[224:227], v[20:23], v[72:75], v[224:227]
    ds_read_b64_tr_b16 v[50:51], v4 offset:2048
    ds_read_b32 v68, v5
    v_mfma_f32_16x16x32_bf16 v[228:231], v[20:23], v[56:59], v[228:231]
    ds_read_b64_tr_b16 v[52:53], v4 offset:256
    ds_read_b64_tr_b16 v[54:55], v4 offset:2304
    v_xor_b32 v4, 32, v4
    v_mfma_f32_16x16x32_bf16 v[232:235], v[20:23], v[76:79], v[232:235]
    v_mfma_f32_16x16x32_bf16 v[236:239], v[20:23], v[64:67], v[236:239]
    v_mfma_f32_16x16x32_bf16 v[240:243], v[24:27], v[56:59], v[240:243]
    ds_read_b128 v[16:19], v2 offset:2048
    v_mfma_f32_16x16x32_bf16 v[244:247], v[24:27], v[60:63], v[244:247]
    ds_read_b128 v[20:23], v3 offset:2048
    v_mfma_f32_16x16x32_bf16 v[240:243], v[28:31], v[72:75], v[240:243]
    s_mov_b32 s29, s41
    s_mov_b32 s41, s42
    s_add_u32 s42, s42, 38912
    v_mfma_f32_16x16x32_bf16 v[244:247], v[28:31], v[56:59], v[244:247]
    s_cmp_eq_u32 s42, 155648
    s_cselect_b32 s42, 0, s42
    s_add_u32 s39, s39, 1
    s_cmp_lt_u32 s39, 15
    s_cbranch_scc1 K12_LOOP
    s_waitcnt lgkmcnt(2)
    v_mfma_f32_16x16x32_bf16 v[80:83], v[8:11], v[40:43], v[80:83]
    ds_read_b128 v[24:27], v2 offset:4096
    v_xor_b32 v72, s35, v44
    v_xor_b32 v73, s35, v45
    v_mfma_f32_16x16x32_bf16 v[84:87], v[8:11], v[44:47], v[84:87]
    ds_read_b128 v[28:31], v3 offset:4096
    v_xor_b32 v74, s35, v46
    v_xor_b32 v75, s35, v47
    v_mfma_f32_16x16x32_bf16 v[88:91], v[8:11], v[48:51], v[88:91]
    s_waitcnt lgkmcnt(2)
    v_cmp_gt_u32 vcc, s40, v68
    s_add_u32 s49, s39, 2
    s_lshr_b32 s49, s49, 1
    v_xor_b32 v76, s35, v52
    v_xor_b32 v77, s35, v53
    v_mfma_f32_16x16x32_bf16 v[92:95], v[8:11], v[52:55], v[92:95]
    s_cbranch_vccnz K12_S6
K12_Q6:
    s_mul_i32 s48, s49, s50
    s_add_u32 s48, s48, s47
    v_xor_b32 v78, s35, v54
    v_xor_b32 v79, s35, v55
    v_mfma_f32_16x16x32_bf16 v[80:83], v[12:15], v[72:75], v[80:83]
    s_add_u32 m0, s29, s36
    s_nop 0
    buffer_load_dwordx4 v1, s[8:11], s30 offen sc1 lds
    v_mfma_f32_16x16x32_bf16 v[84:87], v[12:15], v[40:43], v[84:87]
    s_cmp_lt_u32 s49, 8
    s_cselect_b32 s48, s48, 155744
    v_mfma_f32_16x16x32_bf16 v[88:91], v[12:15], v[76:79], v[88:91]
    s_cmp_ge_u32 s49, 3
    s_cselect_b32 s48, s48, 155744
    v_mfma_f32_16x16x32_bf16 v[92:95], v[12:15], v[48:51], v[92:95]
    v_mfma_f32_16x16x32_bf16 v[96:99], v[16:19], v[40:43], v[96:99]
    ds_read_b128 v[8:11], v2 offset:8192
    v_mfma_f32_16x16x32_bf16 v[100:103], v[16:19], v[44:47], v[100:103]
    ds_read_b128 v[12:15], v3 offset:8192
    v_mfma_f32_16x16x32_bf16 v[104:107], v[16:19], v[48:51], v[104:107]
    buffer_load_dwordx4 v1, s[8:11], s30 offen offset:1024 sc1 lds
    v_mfma_f32_16x16x32_bf16 v[108:111], v[16:19], v[52:55], v[108:111]
    v_mfma_f32_16x16x32_bf16 v[96:99], v[20:23], v[72:75], v[96:99]
    v_mfma_f32_16x16x32_bf16 v[100:103], v[20:23], v[40:43], v[100:103]
    v_mfma_f32_16x16x32_bf16 v[104:107], v[20:23], v[76:79], v[104:107]
    buffer_load_dwordx4 v1, s[8:11], s30 offen offset:2048 sc1 lds
    v_mfma_f32_16x16x32_bf16 v[108:111], v[20:23], v[48:51], v[108:111]
    s_waitcnt lgkmcnt(2)
    v_mfma_f32_16x16x32_bf16 v[112:115], v[24:27], v[40:43], v[112:115]
    ds_read_b128 v[16:19], v2 offset:10240
    v_mfma_f32_16x16x32_bf16 v[116:119], v[24:27], v[44:47], v[116:119]
    ds_read_b128 v[20:23], v3 offset:10240
    v_mfma_f32_16x16x32_bf16 v[120:123], v[24:27], v[48:51], v[120:123]
    v_mfma_f32_16x16x32_bf16 v[124:127], v[24:27], v[52:55], v[124:127]
    v_mfma_f32_16x16x32_bf16 v[112:115], v[28:31], v[72:75], v[112:115]
    buffer_load_dwordx4 v1, s[8:11], s30 offen offset:3072 sc1 lds
    v_mfma_f32_16x16x32_bf16 v[116:119], v[28:31], v[40:43], v[116:119]
    v_mfma_f32_16x16x32_bf16 v[120:123], v[28:31], v[76:79], v[120:123]
    v_mfma_f32_16x16x32_bf16 v[124:127], v[28:31], v[48:51], v[124:127]
    v_mfma_f32_16x16x32_bf16 v[128:131], v[32:35], v[40:43], v[128:131]
    ds_read_b128 v[24:27], v2 offset:12288
    v_mfma_f32_16x16x32_bf16 v[132:135], v[32:35], v[44:47], v[132:135]
    ds_read_b128 v[28:31], v3 offset:12288
    v_mfma_f32_16x16x32_bf16 v[136:139], v[32:35], v[48:51], v[136:139]
    s_add_u32 m0, m0, 4096
    s_add_u32 s34, s30, 4096
    buffer_load_dwordx4 v1, s[8:11], s34 offen sc1 lds
    v_mfma_f32_16x16x32_bf16 v[140:143], v[32:35], v[52:55], v[140:143]
    v_mfma_f32_16x16x32_bf16 v[128:131], v[36:39], v[72:75], v[128:131]
    v_mfma_f32_16x16x32_bf16 v[132:135], v[36:39], v[40:43], v[132:135]
    v_mfma_f32_16x16x32_bf16 v[136:139], v[36:39], v[76:79], v[136:139]
    s_add_u32 m0, s29, s37
    s_add_u32 s30, s30, 21376
    buffer_load_dwordx4 v1, s[12:15], s31 offen sc1 lds
    v_mfma_f32_16x16x32_bf16 v[140:143], v[36:39], v[48:51], v[140:143]
    s_waitcnt lgkmcnt(4)
    v_mfma_f32_16x16x32_bf16 v[144:147], v[8:11], v[40:43], v[144:147]
    ds_read_b128 v[32:35], v2 offset:14336
    v_mfma_f32_16x16x32_bf16 v[148:151], v[8:11], v[44:47], v[148:151]
    ds_read_b128 v[36:39], v3 offset:14336
    v_mfma_f32_16x16x32_bf16 v[152:155], v[8:11], v[48:51], v[152:155]
    v_mfma_f32_16x16x32_bf16 v[156:159], v[8:11], v[52:55], v[156:159]
    v_mfma_f32_16x16x32_bf16 v[144:147], v[12:15], v[72:75], v[144:147]
    buffer_load_dwordx4 v1, s[12:15], s31 offen offset:1024 sc1 lds
    v_mfma_f32_16x16x32_bf16 v[148:151], v[12:15], v[40:43], v[148:151]
    v_mfma_f32_16x16x32_bf16 v[152:155], v[12:15], v[76:79], v[152:155]
    v_mfma_f32_16x16x32_bf16 v[156:159], v[12:15], v[48:51], v[156:159]
    s_waitcnt lgkmcnt(4)
    v_mfma_f32_16x16x32_bf16 v[160:163], v[16:19], v[40:43], v[160:163]
    ds_read_b128 v[8:11], v2 offset:16384
    v_mfma_f32_16x16x32_bf16 v[164:167], v[16:19], v[44:47], v[164:167]
    ds_read_b128 v[12:15], v3 offset:16384
    v_mfma_f32_16x16x32_bf16 v[168:171], v[16:19], v[48:51], v[168:171]
    buffer_load_dwordx4 v1, s[12:15], s31 offen offset:2048 sc1 lds
    v_mfma_f32_16x16x32_bf16 v[172:175], v[16:19], v[52:55], v[172:175]
    s_add_u32 s40, s40, 1
    s_mov_b32 s51, s40
    v_mov_b32 v0, s40
    v_mfma_f32_16x16x32_bf16 v[160:163], v[20:23], v[72:75], v[160:163]
    s_waitcnt vmcnt(19)
    ds_write_b32 v7, v0
    v_mfma_f32_16x16x32_bf16 v[164:167], v[20:23], v[40:43], v[164:167]
    v_mfma_f32_16x16x32_bf16 v[168:171], v[20:23], v[76:79], v[168:171]
    buffer_load_dwordx4 v1, s[12:15], s31 offen offset:3072 sc1 lds
    v_mfma_f32_16x16x32_bf16 v[172:175], v[20:23], v[48:51], v[172:175]
    s_waitcnt lgkmcnt(5)
    v_mfma_f32_16x16x32_bf16 v[176:179], v[24:27], v[40:43], v[176:179]
    ds_read_b128 v[16:19], v2 offset:18432
    v_mfma_f32_16x16x32_bf16 v[180:183], v[24:27], v[44:47], v[180:183]
    ds_read_b128 v[20:23], v3 offset:18432
    v_mov_b32 v0, s48
    v_mfma_f32_16x16x32_bf16 v[184:187], v[24:27], v[48:51], v[184:187]
    ds_read_b32 v0, v0
    v_mfma_f32_16x16x32_bf16 v[188:191], v[24:27], v[52:55], v[188:191]
    v_mfma_f32_16x16x32_bf16 v[176:179], v[28:31], v[72:75], v[176:179]
    s_add_u32 m0, s29, s38
    s_mov_b64 exec, s[44:45]
    buffer_load_dwordx4 v1, s[64:67], s33 offen sc1 lds
    s_mov_b64 exec, -1
    s_add_u32 s31, s31, 16384
    s_add_u32 s33, s33, 21376
    v_mfma_f32_16x16x32_bf16 v[180:183], v[28:31], v[40:43], v[180:183]
    v_mfma_f32_16x16x32_bf16 v[184:187], v[28:31], v[76:79], v[184:187]
    v_mfma_f32_16x16x32_bf16 v[188:191], v[28:31], v[48:51], v[188:191]
    s_waitcnt lgkmcnt(0)
    v_cmp_eq_u32 vcc, 0, v0
    v_mfma_f32_16x16x32_bf16 v[192:195], v[32:35], v[40:43], v[192:195]
    ds_read_b128 v[24:27], v2 offset:20480
    v_mfma_f32_16x16x32_bf16 v[196:199], v[32:35], v[44:47], v[196:199]
    ds_read_b128 v[28:31], v3 offset:20480
    s_cbranch_vccnz K12_F7
K12_G7:
    v_mfma_f32_16x16x32_bf16 v[200:203], v[32:35], v[48:51], v[200:203]
    s_sub_u32 s43, s42, s41
    s_add_u32 s40, s40, 1
    v_add_u32 v2, s43, v2
    v_mfma_f32_16x16x32_bf16 v[204:207], v[32:35], v[52:55], v[204:207]
    v_add_u32 v3, s43, v3
    v_add_u32 v4, s43, v4
    v_mov_b32 v0, s40
    v_mfma_f32_16x16x32_bf16 v[192:195], v[36:39], v[72:75], v[192:195]
    ds_write_b32 v7, v0
    v_mfma_f32_16x16x32_bf16 v[196:199], v[36:39], v[40:43], v[196:199]
    v_mfma_f32_16x16x32_bf16 v[200:203], v[36:39], v[76:79], v[200:203]
    v_mfma_f32_16x16x32_bf16 v[204:207], v[36:39], v[48:51], v[204:207]
    ds_read_b32 v56, v5
    v_mfma_f32_16x16x32_bf16 v[208:211], v[8:11], v[40:43], v[208:211]
    v_mfma_f32_16x16x32_bf16 v[212:215], v[8:11], v[44:47], v[212:215]
    v_mfma_f32_16x16x32_bf16 v[216:219], v[8:11], v[48:51], v[216:219]
    v_mfma_f32_16x16x32_bf16 v[220:223], v[8:11], v[52:55], v[220:223]
    s_waitcnt lgkmcnt(0)
    v_cmp_gt_u32 vcc, s51, v56
    v_mfma_f32_16x16x32_bf16 v[208:211], v[12:15], v[72:75], v[208:211]
    v_mfma_f32_16x16x32_bf16 v[212:215], v[12:15], v[40:43], v[212:215]
    s_cbranch_vccnz K12_S8
K12_Q8:
    v_mfma_f32_16x16x32_bf16 v[216:219], v[12:15], v[76:79], v[216:219]
    ds_read_b64_tr_b16 v[56:57], v4 offset:0
    v_mfma_f32_16x16x32_bf16 v[220:223], v[12:15], v[48:51], v[220:223]
    ds_read_b64_tr_b16 v[58:59], v4 offset:2048
    v_mfma_f32_16x16x32_bf16 v[224:227], v[16:19], v[40:43], v[224:227]
    ds_read_b64_tr_b16 v[60:61], v4 offset:256
    ds_read_b128 v[8:11], v2 offset:0
    v_mfma_f32_16x16x32_bf16 v[228:231], v[16:19], v[44:47], v[228:231]
    ds_read_b64_tr_b16 v[62:63], v4 offset:2304
    ds_read_b128 v[12:15], v3 offset:0
    v_mfma_f32_16x16x32_bf16 v[232:235], v[16:19], v[48:51], v[232:235]
    v_xor_b32 v4, 32, v4
    ds_read_b128 v[32:35], v2 offset:6144
    v_mfma_f32_16x16x32_bf16 v[236:239], v[16:19], v[52:55], v[236:239]
    ds_read_b64_tr_b16 v[64:65], v4 offset:0
    ds_read_b128 v[36:39], v3 offset:6144
    v_mfma_f32_16x16x32_bf16 v[224:227], v[20:23], v[72:75], v[224:227]
    ds_read_b64_tr_b16 v[66:67], v4 offset:2048
    ds_read_b32 v52, v5
    v_mfma_f32_16x16x32_bf16 v[228:231], v[20:23], v[40:43], v[228:231]
    ds_read_b64_tr_b16 v[68:69], v4 offset:256
    ds_read_b64_tr_b16 v[70:71], v4 offset:2304
    v_xor_b32 v4, 32, v4
    v_mfma_f32_16x16x32_bf16 v[232:235], v[20:23], v[76:79], v[232:235]
    v_mfma_f32_16x16x32_bf16 v[236:239], v[20:23], v[48:51], v[236:239]
    v_mfma_f32_16x16x32_bf16 v[240:243], v[24:27], v[40:43], v[240:243]
    ds_read_b128 v[16:19], v2 offset:2048
    v_mfma_f32_16x16x32_bf16 v[244:247], v[24:27], v[44:47], v[244:247]
    ds_read_b128 v[20:23], v3 offset:2048
    v_mfma_f32_16x16x32_bf16 v[240:243], v[28:31], v[72:75], v[240:243]
    s_mov_b32 s29, s41
    s_mov_b32 s41, s42
    s_add_u32 s42, s42, 38912
    v_mfma_f32_16x16x32_bf16 v[244:247], v[28:31], v[40:43], v[244:247]
    s_cmp_eq_u32 s42, 155648
    s_cselect_b32 s42, 0, s42
    s_waitcnt lgkmcnt(2)
    v_mfma_f32_16x16x32_bf16 v[80:83], v[8:11], v[56:59], v[80:83]
    ds_read_b128 v[24:27], v2 offset:4096
    v_xor_b32 v72, s35, v60
    v_xor_b32 v73, s35, v61
    v_mfma_f32_16x16x32_bf16 v[84:87], v[8:11], v[60:63], v[84:87]
    ds_read_b128 v[28:31], v3 offset:4096
    v_xor_b32 v74, s35, v62
    v_xor_b32 v75, s35, v63
    v_mfma_f32_16x16x32_bf16 v[88:91], v[8:11], v[64:67], v[88:91]
    v_xor_b32 v76, s35, v68
    v_xor_b32 v77, s35, v69
    v_mfma_f32_16x16x32_bf16 v[92:95], v[8:11], v[68:71], v[92:95]
    v_xor_b32 v78, s35, v70
    v_xor_b32 v79, s35, v71
    v_mfma_f32_16x16x32_bf16 v[80:83], v[12:15], v[72:75], v[80:83]
    v_lshrrev_b32 v0, 4, v1
    v_and_b32 v5, 15, v0
    v_mfma_f32_16x16x32_bf16 v[84:87], v[12:15], v[56:59], v[84:87]
    v_lshrrev_b32 v0, 4, v0
    s_lshl_b32 s28, s21, 7
    v_mfma_f32_16x16x32_bf16 v[88:91], v[12:15], v[76:79], v[88:91]
    s_lshl_b32 s29, s3, 5
    s_add_u32 s28, s28, s29
    v_mfma_f32_16x16x32_bf16 v[92:95], v[12:15], v[64:67], v[92:95]
    v_add_u32 v5, s28, v5
    v_lshlrev_b32 v5, 2, v5
    s_waitcnt lgkmcnt(2)
    v_mfma_f32_16x16x32_bf16 v[96:99], v[16:19], v[56:59], v[96:99]
    ds_read_b128 v[8:11], v2 offset:8192
    v_lshl_add_u32 v5, v0, 13, v5
    s_lshl_b32 s28, s20, 6
    v_mfma_f32_16x16x32_bf16 v[100:103], v[16:19], v[60:63], v[100:103]
    ds_read_b128 v[12:15], v3 offset:8192
    v_xor_b32 v5, s28, v5
    v_xor_b32 v7, 64, v5
    v_mfma_f32_16x16x32_bf16 v[104:107], v[16:19], v[64:67], v[104:107]
    v_mfma_f32_16x16x32_bf16 v[108:111], v[16:19], v[68:71], v[108:111]
    s_mov_b32 s38, 0
    v_cvt_pk_bf16_f32 v48, v80, v84
    buffer_store_dword v48, v5, s[16:19], s38 offen offset:0 sc1
    v_cvt_pk_bf16_f32 v49, v88, v92
    buffer_store_dword v49, v7, s[16:19], s38 offen offset:0 sc1
    v_mfma_f32_16x16x32_bf16 v[96:99], v[20:23], v[72:75], v[96:99]
    v_cvt_pk_bf16_f32 v50, v81, v85
    buffer_store_dword v50, v5, s[16:19], s38 offen offset:2048 sc1
    v_mfma_f32_16x16x32_bf16 v[100:103], v[20:23], v[56:59], v[100:103]
    v_cvt_pk_bf16_f32 v51, v89, v93
    buffer_store_dword v51, v7, s[16:19], s38 offen offset:2048 sc1
    v_mfma_f32_16x16x32_bf16 v[104:107], v[20:23], v[76:79], v[104:107]
    s_mov_b32 s38, 4096
    v_cvt_pk_bf16_f32 v52, v82, v86
    buffer_store_dword v52, v5, s[16:19], s38 offen offset:0 sc1
    v_cvt_pk_bf16_f32 v53, v90, v94
    buffer_store_dword v53, v7, s[16:19], s38 offen offset:0 sc1
    v_mfma_f32_16x16x32_bf16 v[108:111], v[20:23], v[64:67], v[108:111]
    v_cvt_pk_bf16_f32 v54, v83, v87
    buffer_store_dword v54, v5, s[16:19], s38 offen offset:2048 sc1
    s_waitcnt lgkmcnt(2)
    v_mfma_f32_16x16x32_bf16 v[112:115], v[24:27], v[56:59], v[112:115]
    ds_read_b128 v[16:19], v2 offset:10240
    v_cvt_pk_bf16_f32 v55, v91, v95
    buffer_store_dword v55, v7, s[16:19], s38 offen offset:2048 sc1
    v_mfma_f32_16x16x32_bf16 v[116:119], v[24:27], v[60:63], v[116:119]
    ds_read_b128 v[20:23], v3 offset:10240
    v_mfma_f32_16x16x32_bf16 v[120:123], v[24:27], v[64:67], v[120:123]
    v_mfma_f32_16x16x32_bf16 v[124:127], v[24:27], v[68:71], v[124:127]
    s_mov_b32 s38, 32768
    v_cvt_pk_bf16_f32 v40, v96, v100
    buffer_store_dword v40, v5, s[16:19], s38 offen offset:0 sc1
    v_cvt_pk_bf16_f32 v41, v104, v108
    buffer_store_dword v41, v7, s[16:19], s38 offen offset:0 sc1
    v_mfma_f32_16x16x32_bf16 v[112:115], v[28:31], v[72:75], v[112:115]
    v_cvt_pk_bf16_f32 v42, v97, v101
    buffer_store_dword v42, v5, s[16:19], s38 offen offset:2048 sc1
    v_mfma_f32_16x16x32_bf16 v[116:119], v[28:31], v[56:59], v[116:119]
    v_cvt_pk_bf16_f32 v43, v105, v109
    buffer_store_dword v43, v7, s[16:19], s38 offen offset:2048 sc1
    v_mfma_f32_16x16x32_bf16 v[120:123], v[28:31], v[76:79], v[120:123]
    s_mov_b32 s38, 36864
    v_cvt_pk_bf16_f32 v44, v98, v102
    buffer_store_dword v44, v5, s[16:19], s38 offen offset:0 sc1
    v_cvt_pk_bf16_f32 v45, v106, v110
    buffer_store_dword v45, v7, s[16:19], s38 offen offset:0 sc1
    v_mfma_f32_16x16x32_bf16 v[124:127], v[28:31], v[64:67], v[124:127]
    v_cvt_pk_bf16_f32 v46, v99, v103
    buffer_store_dword v46, v5, s[16:19], s38 offen offset:2048 sc1
    v_mfma_f32_16x16x32_bf16 v[128:131], v[32:35], v[56:59], v[128:131]
    ds_read_b128 v[24:27], v2 offset:12288
    v_cvt_pk_bf16_f32 v47, v107, v111
    buffer_store_dword v47, v7, s[16:19], s38 offen offset:2048 sc1
    v_mfma_f32_16x16x32_bf16 v[132:135], v[32:35], v[60:63], v[132:135]
    ds_read_b128 v[28:31], v3 offset:12288
    v_mfma_f32_16x16x32_bf16 v[136:139], v[32:35], v[64:67], v[136:139]
    v_mfma_f32_16x16x32_bf16 v[140:143], v[32:35], v[68:71], v[140:143]
    s_mov_b32 s38, 65536
    v_cvt_pk_bf16_f32 v48, v112, v116
    buffer_store_dword v48, v5, s[16:19], s38 offen offset:0 sc1
    v_cvt_pk_bf16_f32 v49, v120, v124
    buffer_store_dword v49, v7, s[16:19], s38 offen offset:0 sc1
    v_mfma_f32_16x16x32_bf16 v[128:131], v[36:39], v[72:75], v[128:131]
    v_cvt_pk_bf16_f32 v50, v113, v117
    buffer_store_dword v50, v5, s[16:19], s38 offen offset:2048 sc1
    v_mfma_f32_16x16x32_bf16 v[132:135], v[36:39], v[56:59], v[132:135]
    v_cvt_pk_bf16_f32 v51, v121, v125
    buffer_store_dword v51, v7, s[16:19], s38 offen offset:2048 sc1
    v_mfma_f32_16x16x32_bf16 v[136:139], v[36:39], v[76:79], v[136:139]
    s_mov_b32 s38, 69632
    v_cvt_pk_bf16_f32 v52, v114, v118
    buffer_store_dword v52, v5, s[16:19], s38 offen offset:0 sc1
    v_cvt_pk_bf16_f32 v53, v122, v126
    buffer_store_dword v53, v7, s[16:19], s38 offen offset:0 sc1
    v_mfma_f32_16x16x32_bf16 v[140:143], v[36:39], v[64:67], v[140:143]
    v_cvt_pk_bf16_f32 v54, v115, v119
    buffer_store_dword v54, v5, s[16:19], s38 offen offset:2048 sc1
    s_waitcnt lgkmcnt(4)
    v_mfma_f32_16x16x32_bf16 v[144:147], v[8:11], v[56:59], v[144:147]
    ds_read_b128 v[32:35], v2 offset:14336
    v_cvt_pk_bf16_f32 v55, v123, v127
    buffer_store_dword v55, v7, s[16:19], s38 offen offset:2048 sc1
    v_mfma_f32_16x16x32_bf16 v[148:151], v[8:11], v[60:63], v[148:151]
    ds_read_b128 v[36:39], v3 offset:14336
    v_mfma_f32_16x16x32_bf16 v[152:155], v[8:11], v[64:67], v[152:155]
    v_mfma_f32_16x16x32_bf16 v[156:159], v[8:11], v[68:71], v[156:159]
    s_mov_b32 s38, 98304
    v_cvt_pk_bf16_f32 v40, v128, v132
    buffer_store_dword v40, v5, s[16:19], s38 offen offset:0 sc1
    v_cvt_pk_bf16_f32 v41, v136, v140
    buffer_store_dword v41, v7, s[16:19], s38 offen offset:0 sc1
    v_mfma_f32_16x16x32_bf16 v[144:147], v[12:15], v[72:75], v[144:147]
    v_cvt_pk_bf16_f32 v42, v129, v133
    buffer_store_dword v42, v5, s[16:19], s38 offen offset:2048 sc1
    v_mfma_f32_16x16x32_bf16 v[148:151], v[12:15], v[56:59], v[148:151]
    v_cvt_pk_bf16_f32 v43, v137, v141
    buffer_store_dword v43, v7, s[16:19], s38 offen offset:2048 sc1
    v_mfma_f32_16x16x32_bf16 v[152:155], v[12:15], v[76:79], v[152:155]
    s_mov_b32 s38, 102400
    v_cvt_pk_bf16_f32 v44, v130, v134
    buffer_store_dword v44, v5, s[16:19], s38 offen offset:0 sc1
    v_cvt_pk_bf16_f32 v45, v138, v142
    buffer_store_dword v45, v7, s[16:19], s38 offen offset:0 sc1
    v_mfma_f32_16x16x32_bf16 v[156:159], v[12:15], v[64:67], v[156:159]
    v_cvt_pk_bf16_f32 v46, v131, v135
    buffer_store_dword v46, v5, s[16:19], s38 offen offset:2048 sc1
    s_waitcnt lgkmcnt(4)
    v_mfma_f32_16x16x32_bf16 v[160:163], v[16:19], v[56:59], v[160:163]
    ds_read_b128 v[8:11], v2 offset:16384
    v_cvt_pk_bf16_f32 v47, v139, v143
    buffer_store_dword v47, v7, s[16:19], s38 offen offset:2048 sc1
    v_mfma_f32_16x16x32_bf16 v[164:167], v[16:19], v[60:63], v[164:167]
    ds_read_b128 v[12:15], v3 offset:16384
    v_mfma_f32_16x16x32_bf16 v[168:171], v[16:19], v[64:67], v[168:171]
    v_mfma_f32_16x16x32_bf16 v[172:175], v[16:19], v[68:71], v[172:175]
    s_mov_b32 s38, 131072
    v_cvt_pk_bf16_f32 v48, v144, v148
    buffer_store_dword v48, v5, s[16:19], s38 offen offset:0 sc1
    v_cvt_pk_bf16_f32 v49, v152, v156
    buffer_store_dword v49, v7, s[16:19], s38 offen offset:0 sc1
    v_mfma_f32_16x16x32_bf16 v[160:163], v[20:23], v[72:75], v[160:163]
    v_cvt_pk_bf16_f32 v50, v145, v149
    buffer_store_dword v50, v5, s[16:19], s38 offen offset:2048 sc1
    v_mfma_f32_16x16x32_bf16 v[164:167], v[20:23], v[56:59], v[164:167]
    v_cvt_pk_bf16_f32 v51, v153, v157
    buffer_store_dword v51, v7, s[16:19], s38 offen offset:2048 sc1
    v_mfma_f32_16x16x32_bf16 v[168:171], v[20:23], v[76:79], v[168:171]
    s_mov_b32 s38, 135168
    v_cvt_pk_bf16_f32 v52, v146, v150
    buffer_store_dword v52, v5, s[16:19], s38 offen offset:0 sc1
    v_cvt_pk_bf16_f32 v53, v154, v158
    buffer_store_dword v53, v7, s[16:19], s38 offen offset:0 sc1
    v_mfma_f32_16x16x32_bf16 v[172:175], v[20:23], v[64:67], v[172:175]
    v_cvt_pk_bf16_f32 v54, v147, v151
    buffer_store_dword v54, v5, s[16:19], s38 offen offset:2048 sc1
    s_waitcnt lgkmcnt(4)
    v_mfma_f32_16x16x32_bf16 v[176:179], v[24:27], v[56:59], v[176:179]
    ds_read_b128 v[16:19], v2 offset:18432
    v_cvt_pk_bf16_f32 v55, v155, v159
    buffer_store_dword v55, v7, s[16:19], s38 offen offset:2048 sc1
    v_mfma_f32_16x16x32_bf16 v[180:183], v[24:27], v[60:63], v[180:183]
    ds_read_b128 v[20:23], v3 offset:18432
    v_mfma_f32_16x16x32_bf16 v[184:187], v[24:27], v[64:67], v[184:187]
    v_mfma_f32_16x16x32_bf16 v[188:191], v[24:27], v[68:71], v[188:191]
    s_mov_b32 s38, 163840
    v_cvt_pk_bf16_f32 v40, v160, v164
    buffer_store_dword v40, v5, s[16:19], s38 offen offset:0 sc1
    v_cvt_pk_bf16_f32 v41, v168, v172
    buffer_store_dword v41, v7, s[16:19], s38 offen offset:0 sc1
    v_mfma_f32_16x16x32_bf16 v[176:179], v[28:31], v[72:75], v[176:179]
    v_cvt_pk_bf16_f32 v42, v161, v165
    buffer_store_dword v42, v5, s[16:19], s38 offen offset:2048 sc1
    v_mfma_f32_16x16x32_bf16 v[180:183], v[28:31], v[56:59], v[180:183]
    v_cvt_pk_bf16_f32 v43, v169, v173
    buffer_store_dword v43, v7, s[16:19], s38 offen offset:2048 sc1
    v_mfma_f32_16x16x32_bf16 v[184:187], v[28:31], v[76:79], v[184:187]
    s_mov_b32 s38, 167936
    v_cvt_pk_bf16_f32 v44, v162, v166
    buffer_store_dword v44, v5, s[16:19], s38 offen offset:0 sc1
    v_cvt_pk_bf16_f32 v45, v170, v174
    buffer_store_dword v45, v7, s[16:19], s38 offen offset:0 sc1
    v_mfma_f32_16x16x32_bf16 v[188:191], v[28:31], v[64:67], v[188:191]
    v_cvt_pk_bf16_f32 v46, v163, v167
    buffer_store_dword v46, v5, s[16:19], s38 offen offset:2048 sc1
    s_waitcnt lgkmcnt(4)
    v_mfma_f32_16x16x32_bf16 v[192:195], v[32:35], v[56:59], v[192:195]
    ds_read_b128 v[24:27], v2 offset:20480
    v_cvt_pk_bf16_f32 v47, v171, v175
    buffer_store_dword v47, v7, s[16:19], s38 offen offset:2048 sc1
    v_mfma_f32_16x16x32_bf16 v[196:199], v[32:35], v[60:63], v[196:199]
    ds_read_b128 v[28:31], v3 offset:20480
    v_mfma_f32_16x16x32_bf16 v[200:203], v[32:35], v[64:67], v[200:203]
    v_mfma_f32_16x16x32_bf16 v[204:207], v[32:35], v[68:71], v[204:207]
    s_mov_b32 s38, 196608
    v_cvt_pk_bf16_f32 v48, v176, v180
    buffer_store_dword v48, v5, s[16:19], s38 offen offset:0 sc1
    v_cvt_pk_bf16_f32 v49, v184, v188
    buffer_store_dword v49, v7, s[16:19], s38 offen offset:0 sc1
    v_mfma_f32_16x16x32_bf16 v[192:195], v[36:39], v[72:75], v[192:195]
    v_cvt_pk_bf16_f32 v50, v177, v181
    buffer_store_dword v50, v5, s[16:19], s38 offen offset:2048 sc1
    v_mfma_f32_16x16x32_bf16 v[196:199], v[36:39], v[56:59], v[196:199]
    v_cvt_pk_bf16_f32 v51, v185, v189
    buffer_store_dword v51, v7, s[16:19], s38 offen offset:2048 sc1
    v_mfma_f32_16x16x32_bf16 v[200:203], v[36:39], v[76:79], v[200:203]
    s_mov_b32 s38, 200704
    v_cvt_pk_bf16_f32 v52, v178, v182
    buffer_store_dword v52, v5, s[16:19], s38 offen offset:0 sc1
    v_cvt_pk_bf16_f32 v53, v186, v190
    buffer_store_dword v53, v7, s[16:19], s38 offen offset:0 sc1
    v_mfma_f32_16x16x32_bf16 v[204:207], v[36:39], v[64:67], v[204:207]
    v_cvt_pk_bf16_f32 v54, v179, v183
    buffer_store_dword v54, v5, s[16:19], s38 offen offset:2048 sc1
    s_waitcnt lgkmcnt(4)
    v_mfma_f32_16x16x32_bf16 v[208:211], v[8:11], v[56:59], v[208:211]
    v_cvt_pk_bf16_f32 v55, v187, v191
    buffer_store_dword v55, v7, s[16:19], s38 offen offset:2048 sc1
    v_mfma_f32_16x16x32_bf16 v[212:215], v[8:11], v[60:63], v[212:215]
    v_mfma_f32_16x16x32_bf16 v[216:219], v[8:11], v[64:67], v[216:219]
    v_mfma_f32_16x16x32_bf16 v[220:223], v[8:11], v[68:71], v[220:223]
    s_mov_b32 s38, 229376
    v_cvt_pk_bf16_f32 v40, v192, v196
    buffer_store_dword v40, v5, s[16:19], s38 offen offset:0 sc1
    v_cvt_pk_bf16_f32 v41, v200, v204
    buffer_store_dword v41, v7, s[16:19], s38 offen offset:0 sc1
    v_mfma_f32_16x16x32_bf16 v[208:211], v[12:15], v[72:75], v[208:211]
    v_cvt_pk_bf16_f32 v42, v193, v197
    buffer_store_dword v42, v5, s[16:19], s38 offen offset:2048 sc1
    v_mfma_f32_16x16x32_bf16 v[212:215], v[12:15], v[56:59], v[212:215]
    v_cvt_pk_bf16_f32 v43, v201, v205
    buffer_store_dword v43, v7, s[16:19], s38 offen offset:2048 sc1
    v_mfma_f32_16x16x32_bf16 v[216:219], v[12:15], v[76:79], v[216:219]
    s_mov_b32 s38, 233472
    v_cvt_pk_bf16_f32 v44, v194, v198
    buffer_store_dword v44, v5, s[16:19], s38 offen offset:0 sc1
    v_cvt_pk_bf16_f32 v45, v202, v206
    buffer_store_dword v45, v7, s[16:19], s38 offen offset:0 sc1
    v_mfma_f32_16x16x32_bf16 v[220:223], v[12:15], v[64:67], v[220:223]
    v_cvt_pk_bf16_f32 v46, v195, v199
    buffer_store_dword v46, v5, s[16:19], s38 offen offset:2048 sc1
    s_waitcnt lgkmcnt(2)
    v_mfma_f32_16x16x32_bf16 v[224:227], v[16:19], v[56:59], v[224:227]
    v_cvt_pk_bf16_f32 v47, v203, v207
    buffer_store_dword v47, v7, s[16:19], s38 offen offset:2048 sc1
    v_mfma_f32_16x16x32_bf16 v[228:231], v[16:19], v[60:63], v[228:231]
    v_mfma_f32_16x16x32_bf16 v[232:235], v[16:19], v[64:67], v[232:235]
    v_mfma_f32_16x16x32_bf16 v[236:239], v[16:19], v[68:71], v[236:239]
    s_mov_b32 s38, 262144
    v_cvt_pk_bf16_f32 v48, v208, v212
    buffer_store_dword v48, v5, s[16:19], s38 offen offset:0 sc1
    v_cvt_pk_bf16_f32 v49, v216, v220
    buffer_store_dword v49, v7, s[16:19], s38 offen offset:0 sc1
    v_mfma_f32_16x16x32_bf16 v[224:227], v[20:23], v[72:75], v[224:227]
    v_cvt_pk_bf16_f32 v50, v209, v213
    buffer_store_dword v50, v5, s[16:19], s38 offen offset:2048 sc1
    v_mfma_f32_16x16x32_bf16 v[228:231], v[20:23], v[56:59], v[228:231]
    v_cvt_pk_bf16_f32 v51, v217, v221
    buffer_store_dword v51, v7, s[16:19], s38 offen offset:2048 sc1
    v_mfma_f32_16x16x32_bf16 v[232:235], v[20:23], v[76:79], v[232:235]
    s_mov_b32 s38, 266240
    v_cvt_pk_bf16_f32 v52, v210, v214
    buffer_store_dword v52, v5, s[16:19], s38 offen offset:0 sc1
    v_cvt_pk_bf16_f32 v53, v218, v222
    buffer_store_dword v53, v7, s[16:19], s38 offen offset:0 sc1
    v_mfma_f32_16x16x32_bf16 v[236:239], v[20:23], v[64:67], v[236:239]
    v_cvt_pk_bf16_f32 v54, v211, v215
    buffer_store_dword v54, v5, s[16:19], s38 offen offset:2048 sc1
    s_waitcnt lgkmcnt(0)
    v_mfma_f32_16x16x32_bf16 v[240:243], v[24:27], v[56:59], v[240:243]
    v_cvt_pk_bf16_f32 v55, v219, v223
    buffer_store_dword v55, v7, s[16:19], s38 offen offset:2048 sc1
    v_mfma_f32_16x16x32_bf16 v[244:247], v[24:27], v[60:63], v[244:247]
    v_mfma_f32_16x16x32_bf16 v[240:243], v[28:31], v[72:75], v[240:243]
    v_mfma_f32_16x16x32_bf16 v[244:247], v[28:31], v[56:59], v[244:247]
    s_mov_b32 s38, 294912
    v_cvt_pk_bf16_f32 v40, v224, v228
    buffer_store_dword v40, v5, s[16:19], s38 offen offset:0 sc1
    v_cvt_pk_bf16_f32 v41, v232, v236
    buffer_store_dword v41, v7, s[16:19], s38 offen offset:0 sc1
    v_cvt_pk_bf16_f32 v42, v225, v229
    buffer_store_dword v42, v5, s[16:19], s38 offen offset:2048 sc1
    v_cvt_pk_bf16_f32 v43, v233, v237
    buffer_store_dword v43, v7, s[16:19], s38 offen offset:2048 sc1
    s_mov_b32 s38, 299008
    v_cvt_pk_bf16_f32 v44, v226, v230
    buffer_store_dword v44, v5, s[16:19], s38 offen offset:0 sc1
    v_cvt_pk_bf16_f32 v45, v234, v238
    buffer_store_dword v45, v7, s[16:19], s38 offen offset:0 sc1
    v_cvt_pk_bf16_f32 v46, v227, v231
    buffer_store_dword v46, v5, s[16:19], s38 offen offset:2048 sc1
    v_cvt_pk_bf16_f32 v47, v235, v239
    buffer_store_dword v47, v7, s[16:19], s38 offen offset:2048 sc1
    s_nop 7
    s_lshl_b32 s34, s27, 1
    s_mul_i32 s34, s34, 342016
    s_add_u32 s34, s34, 118489088
    s_add_u32 s64, s58, s34
    s_addc_u32 s65, s59, 0
    s_and_b32 s65, s65, 0xffff
    s_mov_b32 s66, 684032
    s_mov_b32 s67, 0x00020000
    v_lshrrev_b32 v8, 8, v1
    v_lshlrev_b32 v9, 13, v8
    v_sub_u32 v9, v5, v9
    v_lshlrev_b32 v8, 2, v8
    v_add_u32 v8, 160, v8
    v_add_u32 v10, 0, v8
    v_add_u32 v11, 160, v10
    v_cmp_gt_u32 vcc, 167, v10
    s_nop 1
    v_cndmask_b32 v11, v11, v10, vcc
    v_cmp_gt_u32 vcc, 174, v10
    v_mov_b32 v12, 0x7ffff
    s_nop 0
    v_cndmask_b32 v11, v12, v11, vcc
    v_lshl_add_u32 v16, v11, 11, v9
    v_add_u32 v10, 1, v8
    v_add_u32 v11, 160, v10
    v_cmp_gt_u32 vcc, 167, v10
    s_nop 1
    v_cndmask_b32 v11, v11, v10, vcc
    v_cmp_gt_u32 vcc, 174, v10
    v_mov_b32 v12, 0x7ffff
    s_nop 0
    v_cndmask_b32 v11, v12, v11, vcc
    v_lshl_add_u32 v17, v11, 11, v9
    v_add_u32 v10, 2, v8
    v_add_u32 v11, 160, v10
    v_cmp_gt_u32 vcc, 167, v10
    s_nop 1
    v_cndmask_b32 v11, v11, v10, vcc
    v_cmp_gt_u32 vcc, 174, v10
    v_mov_b32 v12, 0x7ffff
    s_nop 0
    v_cndmask_b32 v11, v12, v11, vcc
    v_lshl_add_u32 v18, v11, 11, v9
    v_add_u32 v10, 3, v8
    v_add_u32 v11, 160, v10
    v_cmp_gt_u32 vcc, 167, v10
    s_nop 1
    v_cndmask_b32 v11, v11, v10, vcc
    v_cmp_gt_u32 vcc, 174, v10
    v_mov_b32 v12, 0x7ffff
    s_nop 0
    v_cndmask_b32 v11, v12, v11, vcc
    v_lshl_add_u32 v19, v11, 11, v9
    v_cvt_pk_bf16_f32 v20, v240, v244
    buffer_store_dword v20, v16, s[64:67], 0 offen sc1
    v_cvt_pk_bf16_f32 v21, v241, v245
    buffer_store_dword v21, v17, s[64:67], 0 offen sc1
    v_cvt_pk_bf16_f32 v22, v242, v246
    buffer_store_dword v22, v18, s[64:67], 0 offen sc1
    v_cvt_pk_bf16_f32 v23, v243, v247
    buffer_store_dword v23, v19, s[64:67], 0 offen sc1
    s_endpgm
K12_S0:
    s_mov_b32 s61, 16384
    s_add_u32 s62, s62, 1
K12_S0_L:
    ds_read_b32 v56, v5
    s_waitcnt lgkmcnt(0)
    v_cmp_gt_u32 vcc, s40, v56
    s_sub_u32 s61, s61, 1
    s_cmp_eq_u32 s61, 0
    s_cbranch_scc1 K12_Q0
    s_cbranch_vccz K12_Q0
    s_branch K12_S0_L
K12_S1:
    s_mov_b32 s61, 16384
    s_add_u32 s62, s62, 1
K12_S1_L:
    ds_read_b32 v68, v5
    s_waitcnt lgkmcnt(0)
    v_cmp_gt_u32 vcc, s40, v68
    s_sub_u32 s61, s61, 1
    s_cmp_eq_u32 s61, 0
    s_cbranch_scc1 K12_Q1
    s_cbranch_vccz K12_Q1
    s_branch K12_S1_L
K12_F2:
    s_mov_b32 s61, 16384
    s_add_u32 s63, s63, 1
K12_F2_L:
    s_mov_b32 m0, s46
    s_mov_b64 exec, 0xff
    buffer_load_dword v1, s[4:7], 0 offen sc1 lds
    s_mov_b64 exec, -1
    s_waitcnt vmcnt(0)
    v_mov_b32 v0, s48
    ds_read_b32 v0, v0
    s_waitcnt lgkmcnt(0)
    v_cmp_eq_u32 vcc, 0, v0
    s_sub_u32 s61, s61, 1
    s_cmp_eq_u32 s61, 0
    s_cbranch_scc1 K12_F2_X
    s_cbranch_vccz K12_F2_X
    s_sleep 2
    s_branch K12_F2_L
K12_F2_X:
    s_branch K12_G2
K12_S3:
    s_mov_b32 s61, 16384
    s_add_u32 s62, s62, 1
K12_S3_L:
    ds_read_b32 v56, v5
    s_waitcnt lgkmcnt(0)
    v_cmp_gt_u32 vcc, s51, v56
    s_sub_u32 s61, s61, 1
    s_cmp_eq_u32 s61, 0
    s_cbranch_scc1 K12_Q3
    s_cbranch_vccz K12_Q3
    s_branch K12_S3_L
K12_S4:
    s_mov_b32 s61, 16384
    s_add_u32 s62, s62, 1
K12_S4_L:
    ds_read_b32 v52, v5
    s_waitcnt lgkmcnt(0)
    v_cmp_gt_u32 vcc, s40, v52
    s_sub_u32 s61, s61, 1
    s_cmp_eq_u32 s61, 0
    s_cbranch_scc1 K12_Q4
    s_cbranch_vccz K12_Q4
    s_branch K12_S4_L
K12_S5:
    s_mov_b32 s61, 16384
    s_add_u32 s62, s62, 1
K12_S5_L:
    ds_read_b32 v40, v5
    s_waitcnt lgkmcnt(0)
    v_cmp_gt_u32 vcc, s51, v40
    s_sub_u32 s61, s61, 1
    s_cmp_eq_u32 s61, 0
    s_cbranch_scc1 K12_Q5
    s_cbranch_vccz K12_Q5
    s_branch K12_S5_L
K12_S6:
    s_mov_b32 s61, 16384
    s_add_u32 s62, s62, 1
K12_S6_L:
    ds_read_b32 v68, v5
    s_waitcnt lgkmcnt(0)
    v_cmp_gt_u32 vcc, s40, v68
    s_sub_u32 s61, s61, 1
    s_cmp_eq_u32 s61, 0
    s_cbranch_scc1 K12_Q6
    s_cbranch_vccz K12_Q6
    s_branch K12_S6_L
K12_F7:
    s_mov_b32 s61, 16384
    s_add_u32 s63, s63, 1
K12_F7_L:
    s_mov_b32 m0, s46
    s_mov_b64 exec, 0xff
    buffer_load_dword v1, s[4:7], 0 offen sc1 lds
    s_mov_b64 exec, -1
    s_waitcnt vmcnt(0)
    v_mov_b32 v0, s48
    ds_read_b32 v0, v0
    s_waitcnt lgkmcnt(0)
    v_cmp_eq_u32 vcc, 0, v0
    s_sub_u32 s61, s61, 1
    s_cmp_eq_u32 s61, 0
    s_cbranch_scc1 K12_F7_X
    s_cbranch_vccz K12_F7_X
    s_sleep 2
    s_branch K12_F7_L
K12_F7_X:
    s_branch K12_G7
K12_S8:
    s_mov_b32 s61, 16384
    s_add_u32 s62, s62, 1
K12_S8_L:
    ds_read_b32 v56, v5
    s_waitcnt lgkmcnt(0)
    v_cmp_gt_u32 vcc, s51, v56
    s_sub_u32 s61, s61, 1
    s_cmp_eq_u32 s61, 0
    s_cbranch_scc1 K12_Q8
    s_cbranch_vccz K12_Q8
    s_branch K12_S8_L
K12_END:
    s_endpgm
.p2align 8
.type k34_out_kernel,@function
k34_out_kernel:
    s_cmp_ge_u32 s2, 256
    s_cbranch_scc1 K34_END
    s_load_dwordx2 s[4:5], s[0:1], 48
    s_load_dwordx4 s[40:43], s[0:1], 16
    s_load_dwordx2 s[44:45], s[0:1], 32
    v_lshrrev_b32 v1, 6, v0
    v_and_b32 v2, 63, v0
    v_readfirstlane_b32 s3, v1
    s_and_b32 s6, s2, 15
    s_lshr_b32 s7, s2, 4
    s_lshr_b32 s20, s6, 3
    s_and_b32 s21, s6, 7
    s_mul_i32 s22, s7, 11
    s_mul_i32 s23, s7, 10
    s_add_u32 s23, s23, 7
    s_cmp_lt_u32 s7, 7
    s_cselect_b32 s22, s22, s23
    s_cselect_b32 s23, 11, 10
    s_add_u32 s22, s22, s3
    v_and_b32 v3, 15, v2
    v_lshrrev_b32 v4, 4, v2
    v_lshlrev_b32 v5, 4, v2
    s_mov_b32 s24, 2736128
    v_mul_lo_u32 v6, v4, s24
    v_lshl_add_u32 v6, v3, 4, v6
    s_mul_i32 s25, s20, 167
    s_add_u32 s25, s25, s22
    s_lshl_b32 s25, s25, 11
    s_lshl_b32 s24, s21, 8
    s_add_u32 s25, s25, s24
    s_waitcnt lgkmcnt(0)
    s_add_u32 s8, s4, 118489088
    s_addc_u32 s9, s5, 0
    s_and_b32 s9, s9, 0xffff
    s_mov_b32 s10, 21889024
    s_mov_b32 s11, 0x00020000
    s_add_u32 s12, s4, 153616384
    s_addc_u32 s13, s5, 0
    s_and_b32 s13, s13, 0xffff
    s_mov_b32 s14, 131072
    s_mov_b32 s15, 0x00020000
    s_cmp_lt_u32 s3, s23
    s_cbranch_scc0 K34_NOLOAD
    buffer_load_dwordx4 v[16:19], v6, s[8:11], s25 offen
    s_add_u32 s25, s25, 684032
    buffer_load_dwordx4 v[20:23], v6, s[8:11], s25 offen
    s_add_u32 s25, s25, 684032
    buffer_load_dwordx4 v[24:27], v6, s[8:11], s25 offen
    s_add_u32 s25, s25, 684032
    buffer_load_dwordx4 v[28:31], v6, s[8:11], s25 offen
    s_add_u32 s25, s25, 8892416
    buffer_load_dwordx4 v[32:35], v6, s[8:11], s25 offen
    s_add_u32 s25, s25, 684032
    buffer_load_dwordx4 v[36:39], v6, s[8:11], s25 offen
    s_add_u32 s25, s25, 684032
    buffer_load_dwordx4 v[40:43], v6, s[8:11], s25 offen
    s_add_u32 s25, s25, 684032
    buffer_load_dwordx4 v[44:47], v6, s[8:11], s25 offen
K34_NOLOAD:
    s_cmp_lg_u32 s3, 0
    s_cbranch_scc1 K34_TAB
    s_mov_b32 s16, s40
    s_mov_b32 s17, s41
    s_and_b32 s17, s17, 0xffff
    s_mov_b32 s18, 1024
    s_mov_b32 s19, 0x00020000
    s_mov_b32 s28, s42
    s_mov_b32 s29, s43
    s_and_b32 s29, s29, 0xffff
    s_mov_b32 s30, 1024
    s_mov_b32 s31, 0x00020000
    s_lshl_b32 s24, s21, 7
    v_lshlrev_b32 v8, 1, v2
    buffer_load_ushort v152, v8, s[16:19], s24 offen
    buffer_load_ushort v153, v8, s[28:31], s24 offen
    s_branch K34_TABDONE
K34_TAB:
    s_cmp_ge_u32 s3, 7
    s_cbranch_scc1 K34_TABDONE
    s_sub_u32 s27, s3, 1
    s_lshr_b32 s28, s27, 1
    s_and_b32 s29, s27, 1
    s_lshl_b32 s30, s28, 4
    v_add_u32 v8, s30, v3
    s_lshl_b32 s30, s29, 5
    s_add_u32 s30, s30, 1
    v_lshlrev_b32 v9, 3, v4
    v_add_u32 v9, s30, v9
    v_mul_u32_u24 v9, v8, v9
    v_lshlrev_b32 v8, 1, v8
    v_mad_u32_u24 v48, v8, 0, v9
    v_mad_u32_u24 v49, v8, 0, v9
    v_add_u32 v49, 32, v49
    v_mad_u32_u24 v50, v8, 1, v9
    v_mad_u32_u24 v51, v8, 1, v9
    v_add_u32 v51, 32, v51
    v_mad_u32_u24 v52, v8, 2, v9
    v_mad_u32_u24 v53, v8, 2, v9
    v_add_u32 v53, 32, v53
    v_mad_u32_u24 v54, v8, 3, v9
    v_mad_u32_u24 v55, v8, 3, v9
    v_add_u32 v55, 32, v55
    v_and_b32 v48, 127, v48
    v_and_b32 v49, 127, v49
    v_and_b32 v50, 127, v50
    v_and_b32 v51, 127, v51
    v_and_b32 v52, 127, v52
    v_and_b32 v53, 127, v53
    v_and_b32 v54, 127, v54
    v_and_b32 v55, 127, v55
    v_cvt_f32_u32 v48, v48
    v_cvt_f32_u32 v49, v49
    v_cvt_f32_u32 v50, v50
    v_cvt_f32_u32 v51, v51
    v_cvt_f32_u32 v52, v52
    v_cvt_f32_u32 v53, v53
    v_cvt_f32_u32 v54, v54
    v_cvt_f32_u32 v55, v55
    v_mul_f32 v48, 0x3c000000, v48
    v_mul_f32 v49, 0x3c000000, v49
    v_mul_f32 v50, 0x3c000000, v50
    v_mul_f32 v51, 0x3c000000, v51
    v_mul_f32 v52, 0x3c000000, v52
    v_mul_f32 v53, 0x3c000000, v53
    v_mul_f32 v54, 0x3c000000, v54
    v_mul_f32 v55, 0x3c000000, v55
    v_cos_f32 v48, v48
    v_cos_f32 v49, v49
    v_cos_f32 v50, v50
    v_cos_f32 v51, v51
    v_cos_f32 v52, v52
    v_cos_f32 v53, v53
    v_cos_f32 v54, v54
    v_cos_f32 v55, v55
    s_nop 0
    v_mul_f32 v48, 0x3d000000, v48
    v_mul_f32 v49, 0x3d000000, v49
    v_mul_f32 v50, 0x3d000000, v50
    v_mul_f32 v51, 0x3d000000, v51
    v_mul_f32 v52, 0x3d000000, v52
    v_mul_f32 v53, 0x3d000000, v53
    v_mul_f32 v54, 0x3d000000, v54
    v_mul_f32 v55, 0x3d000000, v55
    v_cvt_pk_bf16_f32 v56, v48, v49
    v_cvt_pk_bf16_f32 v57, v50, v51
    v_cvt_pk_bf16_f32 v58, v52, v53
    v_cvt_pk_bf16_f32 v59, v54, v55
    v_lshlrev_b32 v64, 16, v56
    v_and_b32 v65, 0xffff0000, v56
    v_sub_f32 v48, v48, v64
    v_sub_f32 v49, v49, v65
    v_lshlrev_b32 v64, 16, v57
    v_and_b32 v65, 0xffff0000, v57
    v_sub_f32 v50, v50, v64
    v_sub_f32 v51, v51, v65
    v_lshlrev_b32 v64, 16, v58
    v_and_b32 v65, 0xffff0000, v58
    v_sub_f32 v52, v52, v64
    v_sub_f32 v53, v53, v65
    v_lshlrev_b32 v64, 16, v59
    v_and_b32 v65, 0xffff0000, v59
    v_sub_f32 v54, v54, v64
    v_sub_f32 v55, v55, v65
    v_cvt_pk_bf16_f32 v60, v48, v49
    v_cvt_pk_bf16_f32 v61, v50, v51
    v_cvt_pk_bf16_f32 v62, v52, v53
    v_cvt_pk_bf16_f32 v63, v54, v55
    s_lshl_b32 s30, s27, 11
    v_add_u32 v10, s30, v5
    ds_write_b128 v10, v[56:59]
    ds_write_b128 v10, v[60:63] offset:1024
K34_TABDONE:
    s_waitcnt lgkmcnt(0)
    s_barrier
    s_cmp_lt_u32 s3, s23
    s_cbranch_scc0 K34_IDLE
    ds_read_b128 v[48:51], v5 offset:0
    ds_read_b128 v[52:55], v5 offset:1024
    ds_read_b128 v[56:59], v5 offset:2048
    ds_read_b128 v[60:63], v5 offset:3072
    ds_read_b128 v[64:67], v5 offset:4096
    ds_read_b128 v[68:71], v5 offset:5120
    ds_read_b128 v[72:75], v5 offset:6144
    ds_read_b128 v[76:79], v5 offset:7168
    ds_read_b128 v[80:83], v5 offset:8192
    ds_read_b128 v[84:87], v5 offset:9216
    ds_read_b128 v[88:91], v5 offset:10240
    ds_read_b128 v[92:95], v5 offset:11264
    s_waitcnt vmcnt(0)
    v_swap_b32 v17, v20
    v_swap_b32 v18, v24
    v_swap_b32 v19, v28
    v_swap_b32 v22, v25
    v_swap_b32 v23, v29
    v_swap_b32 v27, v30
    v_swap_b32 v33, v36
    v_swap_b32 v34, v40
    v_swap_b32 v35, v44
    v_swap_b32 v38, v41
    v_swap_b32 v39, v45
    v_swap_b32 v43, v46
    s_waitcnt lgkmcnt(0)
    s_mul_i32 s24, s22, 48
    s_sub_u32 s24, 7985, s24
    s_cmp_ge_u32 s24, 48
    s_cbranch_scc1 K34_FULL
    v_add_u32 v7, 0, v3
    v_cmp_gt_u32 vcc, s24, v7
    s_nop 1
    v_cndmask_b32 v48, 0, v48, vcc
    v_cndmask_b32 v49, 0, v49, vcc
    v_cndmask_b32 v50, 0, v50, vcc
    v_cndmask_b32 v51, 0, v51, vcc
    v_cndmask_b32 v52, 0, v52, vcc
    v_cndmask_b32 v53, 0, v53, vcc
    v_cndmask_b32 v54, 0, v54, vcc
    v_cndmask_b32 v55, 0, v55, vcc
    v_cndmask_b32 v56, 0, v56, vcc
    v_cndmask_b32 v57, 0, v57, vcc
    v_cndmask_b32 v58, 0, v58, vcc
    v_cndmask_b32 v59, 0, v59, vcc
    v_cndmask_b32 v60, 0, v60, vcc
    v_cndmask_b32 v61, 0, v61, vcc
    v_cndmask_b32 v62, 0, v62, vcc
    v_cndmask_b32 v63, 0, v63, vcc
    v_add_u32 v7, 16, v3
    v_cmp_gt_u32 vcc, s24, v7
    s_nop 1
    v_cndmask_b32 v64, 0, v64, vcc
    v_cndmask_b32 v65, 0, v65, vcc
    v_cndmask_b32 v66, 0, v66, vcc
    v_cndmask_b32 v67, 0, v67, vcc
    v_cndmask_b32 v68, 0, v68, vcc
    v_cndmask_b32 v69, 0, v69, vcc
    v_cndmask_b32 v70, 0, v70, vcc
    v_cndmask_b32 v71, 0, v71, vcc
    v_cndmask_b32 v72, 0, v72, vcc
    v_cndmask_b32 v73, 0, v73, vcc
    v_cndmask_b32 v74, 0, v74, vcc
    v_cndmask_b32 v75, 0, v75, vcc
    v_cndmask_b32 v76, 0, v76, vcc
    v_cndmask_b32 v77, 0, v77, vcc
    v_cndmask_b32 v78, 0, v78, vcc
    v_cndmask_b32 v79, 0, v79, vcc
    v_add_u32 v7, 32, v3
    v_cmp_gt_u32 vcc, s24, v7
    s_nop 1
    v_cndmask_b32 v80, 0, v80, vcc
    v_cndmask_b32 v81, 0, v81, vcc
    v_cndmask_b32 v82, 0, v82, vcc
    v_cndmask_b32 v83, 0, v83, vcc
    v_cndmask_b32 v84, 0, v84, vcc
    v_cndmask_b32 v85, 0, v85, vcc
    v_cndmask_b32 v86, 0, v86, vcc
    v_cndmask_b32 v87, 0, v87, vcc
    v_cndmask_b32 v88, 0, v88, vcc
    v_cndmask_b32 v89, 0, v89, vcc
    v_cndmask_b32 v90, 0, v90, vcc
    v_cndmask_b32 v91, 0, v91, vcc
    v_cndmask_b32 v92, 0, v92, vcc
    v_cndmask_b32 v93, 0, v93, vcc
    v_cndmask_b32 v94, 0, v94, vcc
    v_cndmask_b32 v95, 0, v95, vcc
K34_FULL:
    s_nop 1
    v_mfma_f32_16x16x32_bf16 v[96:99], v[48:51], v[16:19], 0
    v_mfma_f32_16x16x32_bf16 v[100:103], v[48:51], v[20:23], 0
    v_mfma_f32_16x16x32_bf16 v[104:107], v[48:51], v[24:27], 0
    v_mfma_f32_16x16x32_bf16 v[108:111], v[48:51], v[28:31], 0
    v_mfma_f32_16x16x32_bf16 v[96:99], v[52:55], v[16:19], v[96:99]
    v_mfma_f32_16x16x32_bf16 v[100:103], v[52:55], v[20:23], v[100:103]
    v_mfma_f32_16x16x32_bf16 v[104:107], v[52:55], v[24:27], v[104:107]
    v_mfma_f32_16x16x32_bf16 v[108:111], v[52:55], v[28:31], v[108:111]
    v_mfma_f32_16x16x32_bf16 v[96:99], v[56:59], v[32:35], v[96:99]
    v_mfma_f32_16x16x32_bf16 v[100:103], v[56:59], v[36:39], v[100:103]
    v_mfma_f32_16x16x32_bf16 v[104:107], v[56:59], v[40:43], v[104:107]
    v_mfma_f32_16x16x32_bf16 v[108:111], v[56:59], v[44:47], v[108:111]
    v_mfma_f32_16x16x32_bf16 v[96:99], v[60:63], v[32:35], v[96:99]
    v_mfma_f32_16x16x32_bf16 v[100:103], v[60:63], v[36:39], v[100:103]
    v_mfma_f32_16x16x32_bf16 v[104:107], v[60:63], v[40:43], v[104:107]
    v_mfma_f32_16x16x32_bf16 v[108:111], v[60:63], v[44:47], v[108:111]
    v_mfma_f32_16x16x32_bf16 v[112:115], v[64:67], v[16:19], 0
    v_mfma_f32_16x16x32_bf16 v[116:119], v[64:67], v[20:23], 0
    v_mfma_f32_16x16x32_bf16 v[120:123], v[64:67], v[24:27], 0
    v_mfma_f32_16x16x32_bf16 v[124:127], v[64:67], v[28:31], 0
    v_mfma_f32_16x16x32_bf16 v[112:115], v[68:71], v[16:19], v[112:115]
    v_mfma_f32_16x16x32_bf16 v[116:119], v[68:71], v[20:23], v[116:119]
    v_mfma_f32_16x16x32_bf16 v[120:123], v[68:71], v[24:27], v[120:123]
    v_mfma_f32_16x16x32_bf16 v[124:127], v[68:71], v[28:31], v[124:127]
    v_mfma_f32_16x16x32_bf16 v[112:115], v[72:75], v[32:35], v[112:115]
    v_mfma_f32_16x16x32_bf16 v[116:119], v[72:75], v[36:39], v[116:119]
    v_mfma_f32_16x16x32_bf16 v[120:123], v[72:75], v[40:43], v[120:123]
    v_mfma_f32_16x16x32_bf16 v[124:127], v[72:75], v[44:47], v[124:127]
    v_mfma_f32_16x16x32_bf16 v[112:115], v[76:79], v[32:35], v[112:115]
    v_mfma_f32_16x16x32_bf16 v[116:119], v[76:79], v[36:39], v[116:119]
    v_mfma_f32_16x16x32_bf16 v[120:123], v[76:79], v[40:43], v[120:123]
    v_mfma_f32_16x16x32_bf16 v[124:127], v[76:79], v[44:47], v[124:127]
    v_mfma_f32_16x16x32_bf16 v[128:131], v[80:83], v[16:19], 0
    v_mfma_f32_16x16x32_bf16 v[132:135], v[80:83], v[20:23], 0
    v_mfma_f32_16x16x32_bf16 v[136:139], v[80:83], v[24:27], 0
    v_mfma_f32_16x16x32_bf16 v[140:143], v[80:83], v[28:31], 0
    v_mfma_f32_16x16x32_bf16 v[128:131], v[84:87], v[16:19], v[128:131]
    v_mfma_f32_16x16x32_bf16 v[132:135], v[84:87], v[20:23], v[132:135]
    v_mfma_f32_16x16x32_bf16 v[136:139], v[84:87], v[24:27], v[136:139]
    v_mfma_f32_16x16x32_bf16 v[140:143], v[84:87], v[28:31], v[140:143]
    v_mfma_f32_16x16x32_bf16 v[128:131], v[88:91], v[32:35], v[128:131]
    v_mfma_f32_16x16x32_bf16 v[132:135], v[88:91], v[36:39], v[132:135]
    v_mfma_f32_16x16x32_bf16 v[136:139], v[88:91], v[40:43], v[136:139]
    v_mfma_f32_16x16x32_bf16 v[140:143], v[88:91], v[44:47], v[140:143]
    v_mfma_f32_16x16x32_bf16 v[128:131], v[92:95], v[32:35], v[128:131]
    v_mfma_f32_16x16x32_bf16 v[132:135], v[92:95], v[36:39], v[132:135]
    v_mfma_f32_16x16x32_bf16 v[136:139], v[92:95], v[40:43], v[136:139]
    v_mfma_f32_16x16x32_bf16 v[140:143], v[92:95], v[44:47], v[140:143]
    s_nop 7
    v_mov_b32 v16, v96
    v_mul_f32 v20, v96, v96
    v_mov_b32 v17, v100
    v_mul_f32 v21, v100, v100
    v_mov_b32 v18, v104
    v_mul_f32 v22, v104, v104
    v_mov_b32 v19, v108
    v_mul_f32 v23, v108, v108
    v_add_f32 v16, v16, v97
    v_fmac_f32 v20, v97, v97
    v_add_f32 v17, v17, v101
    v_fmac_f32 v21, v101, v101
    v_add_f32 v18, v18, v105
    v_fmac_f32 v22, v105, v105
    v_add_f32 v19, v19, v109
    v_fmac_f32 v23, v109, v109
    v_add_f32 v16, v16, v98
    v_fmac_f32 v20, v98, v98
    v_add_f32 v17, v17, v102
    v_fmac_f32 v21, v102, v102
    v_add_f32 v18, v18, v106
    v_fmac_f32 v22, v106, v106
    v_add_f32 v19, v19, v110
    v_fmac_f32 v23, v110, v110
    v_add_f32 v16, v16, v99
    v_fmac_f32 v20, v99, v99
    v_add_f32 v17, v17, v103
    v_fmac_f32 v21, v103, v103
    v_add_f32 v18, v18, v107
    v_fmac_f32 v22, v107, v107
    v_add_f32 v19, v19, v111
    v_fmac_f32 v23, v111, v111
    v_add_f32 v16, v16, v112
    v_fmac_f32 v20, v112, v112
    v_add_f32 v17, v17, v116
    v_fmac_f32 v21, v116, v116
    v_add_f32 v18, v18, v120
    v_fmac_f32 v22, v120, v120
    v_add_f32 v19, v19, v124
    v_fmac_f32 v23, v124, v124
    v_add_f32 v16, v16, v113
    v_fmac_f32 v20, v113, v113
    v_add_f32 v17, v17, v117
    v_fmac_f32 v21, v117, v117
    v_add_f32 v18, v18, v121
    v_fmac_f32 v22, v121, v121
    v_add_f32 v19, v19, v125
    v_fmac_f32 v23, v125, v125
    v_add_f32 v16, v16, v114
    v_fmac_f32 v20, v114, v114
    v_add_f32 v17, v17, v118
    v_fmac_f32 v21, v118, v118
    v_add_f32 v18, v18, v122
    v_fmac_f32 v22, v122, v122
    v_add_f32 v19, v19, v126
    v_fmac_f32 v23, v126, v126
    v_add_f32 v16, v16, v115
    v_fmac_f32 v20, v115, v115
    v_add_f32 v17, v17, v119
    v_fmac_f32 v21, v119, v119
    v_add_f32 v18, v18, v123
    v_fmac_f32 v22, v123, v123
    v_add_f32 v19, v19, v127
    v_fmac_f32 v23, v127, v127
    v_add_f32 v16, v16, v128
    v_fmac_f32 v20, v128, v128
    v_add_f32 v17, v17, v132
    v_fmac_f32 v21, v132, v132
    v_add_f32 v18, v18, v136
    v_fmac_f32 v22, v136, v136
    v_add_f32 v19, v19, v140
    v_fmac_f32 v23, v140, v140
    v_add_f32 v16, v16, v129
    v_fmac_f32 v20, v129, v129
    v_add_f32 v17, v17, v133
    v_fmac_f32 v21, v133, v133
    v_add_f32 v18, v18, v137
    v_fmac_f32 v22, v137, v137
    v_add_f32 v19, v19, v141
    v_fmac_f32 v23, v141, v141
    v_add_f32 v16, v16, v130
    v_fmac_f32 v20, v130, v130
    v_add_f32 v17, v17, v134
    v_fmac_f32 v21, v134, v134
    v_add_f32 v18, v18, v138
    v_fmac_f32 v22, v138, v138
    v_add_f32 v19, v19, v142
    v_fmac_f32 v23, v142, v142
    v_add_f32 v16, v16, v131
    v_fmac_f32 v20, v131, v131
    v_add_f32 v17, v17, v135
    v_fmac_f32 v21, v135, v135
    v_add_f32 v18, v18, v139
    v_fmac_f32 v22, v139, v139
    v_add_f32 v19, v19, v143
    v_fmac_f32 v23, v143, v143
    v_mov_b32 v24, v16
    v_mov_b32 v25, v17
    v_mov_b32 v26, v18
    v_mov_b32 v27, v19
    v_mov_b32 v28, v20
    v_mov_b32 v29, v21
    v_mov_b32 v30, v22
    v_mov_b32 v31, v23
    s_nop 0
    v_permlane32_swap_b32 v16, v24
    v_permlane32_swap_b32 v17, v25
    v_permlane32_swap_b32 v18, v26
    v_permlane32_swap_b32 v19, v27
    v_permlane32_swap_b32 v20, v28
    v_permlane32_swap_b32 v21, v29
    v_permlane32_swap_b32 v22, v30
    v_permlane32_swap_b32 v23, v31
    v_add_f32 v16, v16, v24
    v_add_f32 v17, v17, v25
    v_add_f32 v18, v18, v26
    v_add_f32 v19, v19, v27
    v_add_f32 v20, v20, v28
    v_add_f32 v21, v21, v29
    v_add_f32 v22, v22, v30
    v_add_f32 v23, v23, v31
    v_mov_b32 v24, v16
    v_mov_b32 v25, v17
    v_mov_b32 v26, v18
    v_mov_b32 v27, v19
    v_mov_b32 v28, v20
    v_mov_b32 v29, v21
    v_mov_b32 v30, v22
    v_mov_b32 v31, v23
    s_nop 0
    v_permlane16_swap_b32 v16, v24
    v_permlane16_swap_b32 v17, v25
    v_permlane16_swap_b32 v18, v26
    v_permlane16_swap_b32 v19, v27
    v_permlane16_swap_b32 v20, v28
    v_permlane16_swap_b32 v21, v29
    v_permlane16_swap_b32 v22, v30
    v_permlane16_swap_b32 v23, v31
    v_add_f32 v16, v16, v24
    v_add_f32 v17, v17, v25
    v_add_f32 v18, v18, v26
    v_add_f32 v19, v19, v27
    v_add_f32 v20, v20, v28
    v_add_f32 v21, v21, v29
    v_add_f32 v22, v22, v30
    v_add_f32 v23, v23, v31
    s_branch K34_WR
K34_IDLE:
    v_mov_b32 v16, 0
    v_mov_b32 v17, 0
    v_mov_b32 v18, 0
    v_mov_b32 v19, 0
    v_mov_b32 v20, 0
    v_mov_b32 v21, 0
    v_mov_b32 v22, 0
    v_mov_b32 v23, 0
K34_WR:
    s_lshl_b32 s24, s3, 9
    v_lshlrev_b32 v7, 4, v3
    v_add_u32 v7, s24, v7
    ds_write_b128 v7, v[16:19] offset:12288
    ds_write_b128 v7, v[20:23] offset:12544
    s_waitcnt lgkmcnt(0)
    s_barrier
    s_cmp_lg_u32 s3, 0
    s_cbranch_scc1 K34_WAIT
    v_lshlrev_b32 v7, 2, v2
    ds_read_b32 v16, v7 offset:12288
    ds_read_b32 v17, v7 offset:12800
    ds_read_b32 v18, v7 offset:13312
    ds_read_b32 v19, v7 offset:13824
    ds_read_b32 v20, v7 offset:14336
    ds_read_b32 v21, v7 offset:14848
    ds_read_b32 v22, v7 offset:15360
    ds_read_b32 v23, v7 offset:15872
    ds_read_b32 v24, v7 offset:16384
    ds_read_b32 v25, v7 offset:16896
    ds_read_b32 v26, v7 offset:17408
    ds_read_b32 v27, v7 offset:17920
    s_waitcnt lgkmcnt(0)
    ds_read_b32 v32, v7 offset:12544
    ds_read_b32 v33, v7 offset:13056
    ds_read_b32 v34, v7 offset:13568
    ds_read_b32 v35, v7 offset:14080
    ds_read_b32 v36, v7 offset:14592
    ds_read_b32 v37, v7 offset:15104
    ds_read_b32 v38, v7 offset:15616
    ds_read_b32 v39, v7 offset:16128
    ds_read_b32 v40, v7 offset:16640
    ds_read_b32 v41, v7 offset:17152
    ds_read_b32 v42, v7 offset:17664
    ds_read_b32 v43, v7 offset:18176
    v_add_f32 v16, v16, v17
    v_add_f32 v16, v16, v18
    v_add_f32 v16, v16, v19
    v_add_f32 v16, v16, v20
    v_add_f32 v16, v16, v21
    v_add_f32 v16, v16, v22
    v_add_f32 v16, v16, v23
    v_add_f32 v16, v16, v24
    v_add_f32 v16, v16, v25
    v_add_f32 v16, v16, v26
    v_add_f32 v16, v16, v27
    s_waitcnt lgkmcnt(0)
    v_add_f32 v32, v32, v33
    v_add_f32 v32, v32, v34
    v_add_f32 v32, v32, v35
    v_add_f32 v32, v32, v36
    v_add_f32 v32, v32, v37
    v_add_f32 v32, v32, v38
    v_add_f32 v32, v32, v39
    v_add_f32 v32, v32, v40
    v_add_f32 v32, v32, v41
    v_add_f32 v32, v32, v42
    v_add_f32 v32, v32, v43
    s_lshl_b32 s24, s6, 4
    s_add_u32 s24, s24, s7
    s_lshl_b32 s24, s24, 9
    buffer_store_dword v16, v7, s[12:15], s24 offen sc1
    buffer_store_dword v32, v7, s[12:15], s24 offen offset:256 sc1
    s_mov_b32 s26, 20000
K34_POLL:
    s_lshl_b32 s24, s6, 13
    buffer_load_dword v16, v7, s[12:15], s24 offen offset:0 sc1
    buffer_load_dword v32, v7, s[12:15], s24 offen offset:256 sc1
    buffer_load_dword v17, v7, s[12:15], s24 offen offset:512 sc1
    buffer_load_dword v33, v7, s[12:15], s24 offen offset:768 sc1
    buffer_load_dword v18, v7, s[12:15], s24 offen offset:1024 sc1
    buffer_load_dword v34, v7, s[12:15], s24 offen offset:1280 sc1
    buffer_load_dword v19, v7, s[12:15], s24 offen offset:1536 sc1
    buffer_load_dword v35, v7, s[12:15], s24 offen offset:1792 sc1
    buffer_load_dword v20, v7, s[12:15], s24 offen offset:2048 sc1
    buffer_load_dword v36, v7, s[12:15], s24 offen offset:2304 sc1
    buffer_load_dword v21, v7, s[12:15], s24 offen offset:2560 sc1
    buffer_load_dword v37, v7, s[12:15], s24 offen offset:2816 sc1
    buffer_load_dword v22, v7, s[12:15], s24 offen offset:3072 sc1
    buffer_load_dword v38, v7, s[12:15], s24 offen offset:3328 sc1
    buffer_load_dword v23, v7, s[12:15], s24 offen offset:3584 sc1
    buffer_load_dword v39, v7, s[12:15], s24 offen offset:3840 sc1
    s_add_u32 s24, s24, 4096
    buffer_load_dword v24, v7, s[12:15], s24 offen offset:0 sc1
    buffer_load_dword v40, v7, s[12:15], s24 offen offset:256 sc1
    buffer_load_dword v25, v7, s[12:15], s24 offen offset:512 sc1
    buffer_load_dword v41, v7, s[12:15], s24 offen offset:768 sc1
    buffer_load_dword v26, v7, s[12:15], s24 offen offset:1024 sc1
    buffer_load_dword v42, v7, s[12:15], s24 offen offset:1280 sc1
    buffer_load_dword v27, v7, s[12:15], s24 offen offset:1536 sc1
    buffer_load_dword v43, v7, s[12:15], s24 offen offset:1792 sc1
    buffer_load_dword v28, v7, s[12:15], s24 offen offset:2048 sc1
    buffer_load_dword v44, v7, s[12:15], s24 offen offset:2304 sc1
    buffer_load_dword v29, v7, s[12:15], s24 offen offset:2560 sc1
    buffer_load_dword v45, v7, s[12:15], s24 offen offset:2816 sc1
    buffer_load_dword v30, v7, s[12:15], s24 offen offset:3072 sc1
    buffer_load_dword v46, v7, s[12:15], s24 offen offset:3328 sc1
    buffer_load_dword v31, v7, s[12:15], s24 offen offset:3584 sc1
    buffer_load_dword v47, v7, s[12:15], s24 offen offset:3840 sc1
    s_waitcnt vmcnt(0)
    v_max3_u32 v48, v16, v17, v18
    v_max3_u32 v48, v48, v19, v20
    v_max3_u32 v48, v48, v21, v22
    v_max3_u32 v48, v48, v23, v24
    v_max3_u32 v48, v48, v25, v26
    v_max3_u32 v48, v48, v27, v28
    v_max3_u32 v48, v48, v29, v30
    v_max3_u32 v48, v48, v31, v32
    v_max3_u32 v48, v48, v33, v34
    v_max3_u32 v48, v48, v35, v36
    v_max3_u32 v48, v48, v37, v38
    v_max3_u32 v48, v48, v39, v40
    v_max3_u32 v48, v48, v41, v42
    v_max3_u32 v48, v48, v43, v44
    v_max3_u32 v48, v48, v45, v46
    v_max_u32 v48, v48, v47
    v_cmp_eq_u32 vcc, -1, v48
    s_sub_u32 s26, s26, 1
    s_cmp_eq_u32 s26, 0
    s_cbranch_scc1 K34_GOT
    s_cbranch_vccz K34_GOT
    s_sleep 1
    s_branch K34_POLL
K34_GOT:
    v_add_f32 v16, v16, v24
    v_add_f32 v32, v32, v40
    v_add_f32 v17, v17, v25
    v_add_f32 v33, v33, v41
    v_add_f32 v18, v18, v26
    v_add_f32 v34, v34, v42
    v_add_f32 v19, v19, v27
    v_add_f32 v35, v35, v43
    v_add_f32 v20, v20, v28
    v_add_f32 v36, v36, v44
    v_add_f32 v21, v21, v29
    v_add_f32 v37, v37, v45
    v_add_f32 v22, v22, v30
    v_add_f32 v38, v38, v46
    v_add_f32 v23, v23, v31
    v_add_f32 v39, v39, v47
    v_add_f32 v16, v16, v20
    v_add_f32 v32, v32, v36
    v_add_f32 v17, v17, v21
    v_add_f32 v33, v33, v37
    v_add_f32 v18, v18, v22
    v_add_f32 v34, v34, v38
    v_add_f32 v19, v19, v23
    v_add_f32 v35, v35, v39
    v_add_f32 v16, v16, v18
    v_add_f32 v32, v32, v34
    v_add_f32 v17, v17, v19
    v_add_f32 v33, v33, v35
    v_add_f32 v16, v16, v17
    v_add_f32 v32, v32, v33
    v_mul_f32 v11, 0x39035177, v16
    v_mul_f32 v12, 0x39035177, v32
    v_fma_f32 v12, -v11, v11, v12
    v_max_f32 v12, 0, v12
    v_add_f32 v12, 0x3727c5ac, v12
    v_sqrt_f32 v12, v12
    v_lshlrev_b32 v9, 16, v152
    v_rcp_f32 v12, v12
    v_lshlrev_b32 v10, 16, v153
    v_mul_f32 v9, v9, v12
    v_fma_f32 v10, -v11, v9, v10
    ds_write_b32 v7, v9 offset:18432
    ds_write_b32 v7, v10 offset:18688
    s_waitcnt lgkmcnt(0)
K34_WAIT:
    s_barrier
    s_cmp_lt_u32 s3, s23
    s_cbranch_scc0 K34_END
    v_lshlrev_b32 v7, 4, v3
    ds_read_b128 v[144:147], v7 offset:18432
    ds_read_b128 v[148:151], v7 offset:18688
    s_mul_i32 s24, s20, 8176640
    s_add_u32 s16, s44, s24
    s_addc_u32 s17, s45, 0
    s_and_b32 s17, s17, 0xffff
    s_mov_b32 s18, 8176640
    s_mov_b32 s19, 0x00020000
    v_lshlrev_b32 v7, 12, v4
    v_lshl_add_u32 v7, v3, 3, v7
    s_lshl_b32 s24, s21, 7
    v_add_u32 v7, s24, v7
    s_mul_i32 s25, s22, 49152
    s_mov_b32 s30, 0xc0135761
    s_mov_b32 s31, 0xbdd2d3e8
    v_mov_b32 v15, s30
    s_waitcnt lgkmcnt(0)
    v_fma_f32 v16, v96, v144, v148
    v_fma_f32 v17, v100, v145, v149
    v_fma_f32 v18, v104, v146, v150
    v_fma_f32 v19, v108, v147, v151
    v_fma_f32 v20, v97, v144, v148
    v_fma_f32 v21, v101, v145, v149
    v_fma_f32 v22, v105, v146, v150
    v_fma_f32 v23, v109, v147, v151
    v_mul_f32 v24, v16, v16
    v_mul_f32 v25, v17, v17
    v_mul_f32 v26, v18, v18
    v_mul_f32 v27, v19, v19
    v_mul_f32 v28, v20, v20
    v_mul_f32 v29, v21, v21
    v_mul_f32 v30, v22, v22
    v_mul_f32 v31, v23, v23
    v_fma_f32 v24, v24, s31, v15
    v_fma_f32 v25, v25, s31, v15
    v_fma_f32 v26, v26, s31, v15
    v_fma_f32 v27, v27, s31, v15
    v_fma_f32 v28, v28, s31, v15
    v_fma_f32 v29, v29, s31, v15
    v_fma_f32 v30, v30, s31, v15
    v_fma_f32 v31, v31, s31, v15
    v_mul_f32 v24, v24, v16
    v_mul_f32 v25, v25, v17
    v_mul_f32 v26, v26, v18
    v_mul_f32 v27, v27, v19
    v_mul_f32 v28, v28, v20
    v_mul_f32 v29, v29, v21
    v_mul_f32 v30, v30, v22
    v_mul_f32 v31, v31, v23
    v_exp_f32 v24, v24
    v_exp_f32 v25, v25
    v_exp_f32 v26, v26
    v_exp_f32 v27, v27
    v_exp_f32 v28, v28
    v_exp_f32 v29, v29
    v_exp_f32 v30, v30
    v_exp_f32 v31, v31
    v_add_f32 v24, 1.0, v24
    v_add_f32 v25, 1.0, v25
    v_add_f32 v26, 1.0, v26
    v_add_f32 v27, 1.0, v27
    v_add_f32 v28, 1.0, v28
    v_add_f32 v29, 1.0, v29
    v_add_f32 v30, 1.0, v30
    v_add_f32 v31, 1.0, v31
    v_rcp_f32 v24, v24
    v_rcp_f32 v25, v25
    v_rcp_f32 v26, v26
    v_rcp_f32 v27, v27
    v_rcp_f32 v28, v28
    v_rcp_f32 v29, v29
    v_rcp_f32 v30, v30
    v_rcp_f32 v31, v31
    v_mul_f32 v16, v16, v24
    v_mul_f32 v17, v17, v25
    v_mul_f32 v18, v18, v26
    v_mul_f32 v19, v19, v27
    v_mul_f32 v20, v20, v28
    v_mul_f32 v21, v21, v29
    v_mul_f32 v22, v22, v30
    v_mul_f32 v23, v23, v31
    v_cvt_pk_bf16_f32 v32, v16, v17
    v_cvt_pk_bf16_f32 v33, v18, v19
    buffer_store_dwordx2 v[32:33], v7, s[16:19], s25 offen offset:0 sc1
    v_cvt_pk_bf16_f32 v34, v20, v21
    v_cvt_pk_bf16_f32 v35, v22, v23
    buffer_store_dwordx2 v[34:35], v7, s[16:19], s25 offen offset:1024 sc1
    s_add_u32 s25, s25, 2048
    v_fma_f32 v36, v98, v144, v148
    v_fma_f32 v37, v102, v145, v149
    v_fma_f32 v38, v106, v146, v150
    v_fma_f32 v39, v110, v147, v151
    v_fma_f32 v40, v99, v144, v148
    v_fma_f32 v41, v103, v145, v149
    v_fma_f32 v42, v107, v146, v150
    v_fma_f32 v43, v111, v147, v151
    v_mul_f32 v44, v36, v36
    v_mul_f32 v45, v37, v37
    v_mul_f32 v46, v38, v38
    v_mul_f32 v47, v39, v39
    v_mul_f32 v48, v40, v40
    v_mul_f32 v49, v41, v41
    v_mul_f32 v50, v42, v42
    v_mul_f32 v51, v43, v43
    v_fma_f32 v44, v44, s31, v15
    v_fma_f32 v45, v45, s31, v15
    v_fma_f32 v46, v46, s31, v15
    v_fma_f32 v47, v47, s31, v15
    v_fma_f32 v48, v48, s31, v15
    v_fma_f32 v49, v49, s31, v15
    v_fma_f32 v50, v50, s31, v15
    v_fma_f32 v51, v51, s31, v15
    v_mul_f32 v44, v44, v36
    v_mul_f32 v45, v45, v37
    v_mul_f32 v46, v46, v38
    v_mul_f32 v47, v47, v39
    v_mul_f32 v48, v48, v40
    v_mul_f32 v49, v49, v41
    v_mul_f32 v50, v50, v42
    v_mul_f32 v51, v51, v43
    v_exp_f32 v44, v44
    v_exp_f32 v45, v45
    v_exp_f32 v46, v46
    v_exp_f32 v47, v47
    v_exp_f32 v48, v48
    v_exp_f32 v49, v49
    v_exp_f32 v50, v50
    v_exp_f32 v51, v51
    v_add_f32 v44, 1.0, v44
    v_add_f32 v45, 1.0, v45
    v_add_f32 v46, 1.0, v46
    v_add_f32 v47, 1.0, v47
    v_add_f32 v48, 1.0, v48
    v_add_f32 v49, 1.0, v49
    v_add_f32 v50, 1.0, v50
    v_add_f32 v51, 1.0, v51
    v_rcp_f32 v44, v44
    v_rcp_f32 v45, v45
    v_rcp_f32 v46, v46
    v_rcp_f32 v47, v47
    v_rcp_f32 v48, v48
    v_rcp_f32 v49, v49
    v_rcp_f32 v50, v50
    v_rcp_f32 v51, v51
    v_mul_f32 v36, v36, v44
    v_mul_f32 v37, v37, v45
    v_mul_f32 v38, v38, v46
    v_mul_f32 v39, v39, v47
    v_mul_f32 v40, v40, v48
    v_mul_f32 v41, v41, v49
    v_mul_f32 v42, v42, v50
    v_mul_f32 v43, v43, v51
    v_cvt_pk_bf16_f32 v52, v36, v37
    v_cvt_pk_bf16_f32 v53, v38, v39
    buffer_store_dwordx2 v[52:53], v7, s[16:19], s25 offen offset:0 sc1
    v_cvt_pk_bf16_f32 v54, v40, v41
    v_cvt_pk_bf16_f32 v55, v42, v43
    buffer_store_dwordx2 v[54:55], v7, s[16:19], s25 offen offset:1024 sc1
    s_add_u32 s25, s25, 2048
    s_add_u32 s25, s25, 12288
    v_fma_f32 v16, v112, v144, v148
    v_fma_f32 v17, v116, v145, v149
    v_fma_f32 v18, v120, v146, v150
    v_fma_f32 v19, v124, v147, v151
    v_fma_f32 v20, v113, v144, v148
    v_fma_f32 v21, v117, v145, v149
    v_fma_f32 v22, v121, v146, v150
    v_fma_f32 v23, v125, v147, v151
    v_mul_f32 v24, v16, v16
    v_mul_f32 v25, v17, v17
    v_mul_f32 v26, v18, v18
    v_mul_f32 v27, v19, v19
    v_mul_f32 v28, v20, v20
    v_mul_f32 v29, v21, v21
    v_mul_f32 v30, v22, v22
    v_mul_f32 v31, v23, v23
    v_fma_f32 v24, v24, s31, v15
    v_fma_f32 v25, v25, s31, v15
    v_fma_f32 v26, v26, s31, v15
    v_fma_f32 v27, v27, s31, v15
    v_fma_f32 v28, v28, s31, v15
    v_fma_f32 v29, v29, s31, v15
    v_fma_f32 v30, v30, s31, v15
    v_fma_f32 v31, v31, s31, v15
    v_mul_f32 v24, v24, v16
    v_mul_f32 v25, v25, v17
    v_mul_f32 v26, v26, v18
    v_mul_f32 v27, v27, v19
    v_mul_f32 v28, v28, v20
    v_mul_f32 v29, v29, v21
    v_mul_f32 v30, v30, v22
    v_mul_f32 v31, v31, v23
    v_exp_f32 v24, v24
    v_exp_f32 v25, v25
    v_exp_f32 v26, v26
    v_exp_f32 v27, v27
    v_exp_f32 v28, v28
    v_exp_f32 v29, v29
    v_exp_f32 v30, v30
    v_exp_f32 v31, v31
    v_add_f32 v24, 1.0, v24
    v_add_f32 v25, 1.0, v25
    v_add_f32 v26, 1.0, v26
    v_add_f32 v27, 1.0, v27
    v_add_f32 v28, 1.0, v28
    v_add_f32 v29, 1.0, v29
    v_add_f32 v30, 1.0, v30
    v_add_f32 v31, 1.0, v31
    v_rcp_f32 v24, v24
    v_rcp_f32 v25, v25
    v_rcp_f32 v26, v26
    v_rcp_f32 v27, v27
    v_rcp_f32 v28, v28
    v_rcp_f32 v29, v29
    v_rcp_f32 v30, v30
    v_rcp_f32 v31, v31
    v_mul_f32 v16, v16, v24
    v_mul_f32 v17, v17, v25
    v_mul_f32 v18, v18, v26
    v_mul_f32 v19, v19, v27
    v_mul_f32 v20, v20, v28
    v_mul_f32 v21, v21, v29
    v_mul_f32 v22, v22, v30
    v_mul_f32 v23, v23, v31
    v_cvt_pk_bf16_f32 v32, v16, v17
    v_cvt_pk_bf16_f32 v33, v18, v19
    buffer_store_dwordx2 v[32:33], v7, s[16:19], s25 offen offset:0 sc1
    v_cvt_pk_bf16_f32 v34, v20, v21
    v_cvt_pk_bf16_f32 v35, v22, v23
    buffer_store_dwordx2 v[34:35], v7, s[16:19], s25 offen offset:1024 sc1
    s_add_u32 s25, s25, 2048
    v_fma_f32 v36, v114, v144, v148
    v_fma_f32 v37, v118, v145, v149
    v_fma_f32 v38, v122, v146, v150
    v_fma_f32 v39, v126, v147, v151
    v_fma_f32 v40, v115, v144, v148
    v_fma_f32 v41, v119, v145, v149
    v_fma_f32 v42, v123, v146, v150
    v_fma_f32 v43, v127, v147, v151
    v_mul_f32 v44, v36, v36
    v_mul_f32 v45, v37, v37
    v_mul_f32 v46, v38, v38
    v_mul_f32 v47, v39, v39
    v_mul_f32 v48, v40, v40
    v_mul_f32 v49, v41, v41
    v_mul_f32 v50, v42, v42
    v_mul_f32 v51, v43, v43
    v_fma_f32 v44, v44, s31, v15
    v_fma_f32 v45, v45, s31, v15
    v_fma_f32 v46, v46, s31, v15
    v_fma_f32 v47, v47, s31, v15
    v_fma_f32 v48, v48, s31, v15
    v_fma_f32 v49, v49, s31, v15
    v_fma_f32 v50, v50, s31, v15
    v_fma_f32 v51, v51, s31, v15
    v_mul_f32 v44, v44, v36
    v_mul_f32 v45, v45, v37
    v_mul_f32 v46, v46, v38
    v_mul_f32 v47, v47, v39
    v_mul_f32 v48, v48, v40
    v_mul_f32 v49, v49, v41
    v_mul_f32 v50, v50, v42
    v_mul_f32 v51, v51, v43
    v_exp_f32 v44, v44
    v_exp_f32 v45, v45
    v_exp_f32 v46, v46
    v_exp_f32 v47, v47
    v_exp_f32 v48, v48
    v_exp_f32 v49, v49
    v_exp_f32 v50, v50
    v_exp_f32 v51, v51
    v_add_f32 v44, 1.0, v44
    v_add_f32 v45, 1.0, v45
    v_add_f32 v46, 1.0, v46
    v_add_f32 v47, 1.0, v47
    v_add_f32 v48, 1.0, v48
    v_add_f32 v49, 1.0, v49
    v_add_f32 v50, 1.0, v50
    v_add_f32 v51, 1.0, v51
    v_rcp_f32 v44, v44
    v_rcp_f32 v45, v45
    v_rcp_f32 v46, v46
    v_rcp_f32 v47, v47
    v_rcp_f32 v48, v48
    v_rcp_f32 v49, v49
    v_rcp_f32 v50, v50
    v_rcp_f32 v51, v51
    v_mul_f32 v36, v36, v44
    v_mul_f32 v37, v37, v45
    v_mul_f32 v38, v38, v46
    v_mul_f32 v39, v39, v47
    v_mul_f32 v40, v40, v48
    v_mul_f32 v41, v41, v49
    v_mul_f32 v42, v42, v50
    v_mul_f32 v43, v43, v51
    v_cvt_pk_bf16_f32 v52, v36, v37
    v_cvt_pk_bf16_f32 v53, v38, v39
    buffer_store_dwordx2 v[52:53], v7, s[16:19], s25 offen offset:0 sc1
    v_cvt_pk_bf16_f32 v54, v40, v41
    v_cvt_pk_bf16_f32 v55, v42, v43
    buffer_store_dwordx2 v[54:55], v7, s[16:19], s25 offen offset:1024 sc1
    s_add_u32 s25, s25, 2048
    s_add_u32 s25, s25, 12288
    v_fma_f32 v16, v128, v144, v148
    v_fma_f32 v17, v132, v145, v149
    v_fma_f32 v18, v136, v146, v150
    v_fma_f32 v19, v140, v147, v151
    v_fma_f32 v20, v129, v144, v148
    v_fma_f32 v21, v133, v145, v149
    v_fma_f32 v22, v137, v146, v150
    v_fma_f32 v23, v141, v147, v151
    v_mul_f32 v24, v16, v16
    v_mul_f32 v25, v17, v17
    v_mul_f32 v26, v18, v18
    v_mul_f32 v27, v19, v19
    v_mul_f32 v28, v20, v20
    v_mul_f32 v29, v21, v21
    v_mul_f32 v30, v22, v22
    v_mul_f32 v31, v23, v23
    v_fma_f32 v24, v24, s31, v15
    v_fma_f32 v25, v25, s31, v15
    v_fma_f32 v26, v26, s31, v15
    v_fma_f32 v27, v27, s31, v15
    v_fma_f32 v28, v28, s31, v15
    v_fma_f32 v29, v29, s31, v15
    v_fma_f32 v30, v30, s31, v15
    v_fma_f32 v31, v31, s31, v15
    v_mul_f32 v24, v24, v16
    v_mul_f32 v25, v25, v17
    v_mul_f32 v26, v26, v18
    v_mul_f32 v27, v27, v19
    v_mul_f32 v28, v28, v20
    v_mul_f32 v29, v29, v21
    v_mul_f32 v30, v30, v22
    v_mul_f32 v31, v31, v23
    v_exp_f32 v24, v24
    v_exp_f32 v25, v25
    v_exp_f32 v26, v26
    v_exp_f32 v27, v27
    v_exp_f32 v28, v28
    v_exp_f32 v29, v29
    v_exp_f32 v30, v30
    v_exp_f32 v31, v31
    v_add_f32 v24, 1.0, v24
    v_add_f32 v25, 1.0, v25
    v_add_f32 v26, 1.0, v26
    v_add_f32 v27, 1.0, v27
    v_add_f32 v28, 1.0, v28
    v_add_f32 v29, 1.0, v29
    v_add_f32 v30, 1.0, v30
    v_add_f32 v31, 1.0, v31
    v_rcp_f32 v24, v24
    v_rcp_f32 v25, v25
    v_rcp_f32 v26, v26
    v_rcp_f32 v27, v27
    v_rcp_f32 v28, v28
    v_rcp_f32 v29, v29
    v_rcp_f32 v30, v30
    v_rcp_f32 v31, v31
    v_mul_f32 v16, v16, v24
    v_mul_f32 v17, v17, v25
    v_mul_f32 v18, v18, v26
    v_mul_f32 v19, v19, v27
    v_mul_f32 v20, v20, v28
    v_mul_f32 v21, v21, v29
    v_mul_f32 v22, v22, v30
    v_mul_f32 v23, v23, v31
    v_cvt_pk_bf16_f32 v32, v16, v17
    v_cvt_pk_bf16_f32 v33, v18, v19
    buffer_store_dwordx2 v[32:33], v7, s[16:19], s25 offen offset:0 sc1
    v_cvt_pk_bf16_f32 v34, v20, v21
    v_cvt_pk_bf16_f32 v35, v22, v23
    buffer_store_dwordx2 v[34:35], v7, s[16:19], s25 offen offset:1024 sc1
    s_add_u32 s25, s25, 2048
    v_fma_f32 v36, v130, v144, v148
    v_fma_f32 v37, v134, v145, v149
    v_fma_f32 v38, v138, v146, v150
    v_fma_f32 v39, v142, v147, v151
    v_fma_f32 v40, v131, v144, v148
    v_fma_f32 v41, v135, v145, v149
    v_fma_f32 v42, v139, v146, v150
    v_fma_f32 v43, v143, v147, v151
    v_mul_f32 v44, v36, v36
    v_mul_f32 v45, v37, v37
    v_mul_f32 v46, v38, v38
    v_mul_f32 v47, v39, v39
    v_mul_f32 v48, v40, v40
    v_mul_f32 v49, v41, v41
    v_mul_f32 v50, v42, v42
    v_mul_f32 v51, v43, v43
    v_fma_f32 v44, v44, s31, v15
    v_fma_f32 v45, v45, s31, v15
    v_fma_f32 v46, v46, s31, v15
    v_fma_f32 v47, v47, s31, v15
    v_fma_f32 v48, v48, s31, v15
    v_fma_f32 v49, v49, s31, v15
    v_fma_f32 v50, v50, s31, v15
    v_fma_f32 v51, v51, s31, v15
    v_mul_f32 v44, v44, v36
    v_mul_f32 v45, v45, v37
    v_mul_f32 v46, v46, v38
    v_mul_f32 v47, v47, v39
    v_mul_f32 v48, v48, v40
    v_mul_f32 v49, v49, v41
    v_mul_f32 v50, v50, v42
    v_mul_f32 v51, v51, v43
    v_exp_f32 v44, v44
    v_exp_f32 v45, v45
    v_exp_f32 v46, v46
    v_exp_f32 v47, v47
    v_exp_f32 v48, v48
    v_exp_f32 v49, v49
    v_exp_f32 v50, v50
    v_exp_f32 v51, v51
    v_add_f32 v44, 1.0, v44
    v_add_f32 v45, 1.0, v45
    v_add_f32 v46, 1.0, v46
    v_add_f32 v47, 1.0, v47
    v_add_f32 v48, 1.0, v48
    v_add_f32 v49, 1.0, v49
    v_add_f32 v50, 1.0, v50
    v_add_f32 v51, 1.0, v51
    v_rcp_f32 v44, v44
    v_rcp_f32 v45, v45
    v_rcp_f32 v46, v46
    v_rcp_f32 v47, v47
    v_rcp_f32 v48, v48
    v_rcp_f32 v49, v49
    v_rcp_f32 v50, v50
    v_rcp_f32 v51, v51
    v_mul_f32 v36, v36, v44
    v_mul_f32 v37, v37, v45
    v_mul_f32 v38, v38, v46
    v_mul_f32 v39, v39, v47
    v_mul_f32 v40, v40, v48
    v_mul_f32 v41, v41, v49
    v_mul_f32 v42, v42, v50
    v_mul_f32 v43, v43, v51
    v_cvt_pk_bf16_f32 v52, v36, v37
    v_cvt_pk_bf16_f32 v53, v38, v39
    buffer_store_dwordx2 v[52:53], v7, s[16:19], s25 offen offset:0 sc1
    v_cvt_pk_bf16_f32 v54, v40, v41
    v_cvt_pk_bf16_f32 v55, v42, v43
    buffer_store_dwordx2 v[54:55], v7, s[16:19], s25 offen offset:1024 sc1
    s_add_u32 s25, s25, 2048
    s_add_u32 s25, s25, 12288
K34_END:
    s_endpgm
TEXT_END:
.section .rodata,"a"
.p2align 6
.amdhsa_kernel k1_xform_kernel
  .amdhsa_next_free_vgpr 128
  .amdhsa_next_free_sgpr 96
  .amdhsa_accum_offset 128
  .amdhsa_group_segment_fixed_size 0
  .amdhsa_kernarg_size 56
  .amdhsa_user_sgpr_count 2
  .amdhsa_user_sgpr_kernarg_segment_ptr 1
  .amdhsa_system_sgpr_workgroup_id_x 1
.end_amdhsa_kernel
.p2align 6
.amdhsa_kernel k12_fused_kernel
  .amdhsa_next_free_vgpr 256
  .amdhsa_next_free_sgpr 96
  .amdhsa_accum_offset 256
  .amdhsa_group_segment_fixed_size 0
  .amdhsa_kernarg_size 56
  .amdhsa_user_sgpr_count 2
  .amdhsa_user_sgpr_kernarg_segment_ptr 1
  .amdhsa_system_sgpr_workgroup_id_x 1
.end_amdhsa_kernel
.p2align 6
.amdhsa_kernel k34_out_kernel
  .amdhsa_next_free_vgpr 168
  .amdhsa_next_free_sgpr 96
  .amdhsa_accum_offset 168
  .amdhsa_group_segment_fixed_size 0
  .amdhsa_kernarg_size 56
  .amdhsa_user_sgpr_count 2
  .amdhsa_user_sgpr_kernarg_segment_ptr 1
  .amdhsa_system_sgpr_workgroup_id_x 1
.end_amdhsa_kernel
```

```asm
; @launch kernel=k1_xform_kernel grid=(636,1,1) block=(256,1,1) lds=16384
; @launch kernel=k12_fused_kernel grid=(256,1,1) block=(512,1,1) lds=155872
; @launch kernel=k34_out_kernel grid=(256,1,1) block=(768,1,1) lds=18944
.amdgcn_target "amdgcn-amd-amdhsa--gfx950"
.text
.globl k1_xform_kernel
.globl k12_fused_kernel
.globl k34_out_kernel
.p2align 8
.type k1_xform_kernel,@function
k1_xform_kernel:
    s_cmp_ge_u32 s2, 636
    s_cbranch_scc1 K1_END
    s_load_dwordx4 s[4:7], s[0:1], 0
    s_load_dwordx2 s[8:9], s[0:1], 48
    v_lshrrev_b32 v120, 6, v0
    v_and_b32 v121, 63, v0
    v_readfirstlane_b32 s3, v120
    v_and_b32 v122, 15, v121
    v_lshrrev_b32 v123, 4, v121
    s_mov_b32 s28, 0x05040100
    s_mov_b32 s29, 0x07060302
    v_and_b32 v124, 3, v122
    v_lshlrev_b32 v124, 2, v124
    v_lshrrev_b32 v125, 3, v122
    v_lshl_add_u32 v124, v125, 1, v124
    s_lshl_b32 s10, s3, 4
    s_add_u32 s10, s10, 1
    v_add_u32 v124, s10, v124
    v_bfe_u32 v125, v122, 2, 1
    v_lshlrev_b32 v121, 4, v121
    s_waitcnt lgkmcnt(0)
    s_or_b32 s10, s2, s3
    s_cmp_eq_u32 s10, 0
    s_cbranch_scc0 K1_NOCLR
    s_add_u32 s12, s8, 153092096
    s_addc_u32 s13, s9, 0
    s_and_b32 s13, s13, 0xffff
    s_mov_b32 s14, 32768
    s_mov_b32 s15, 0x00020000
    v_lshrrev_b32 v118, 4, v121
    v_lshlrev_b32 v119, 10, v118
    v_mov_b32 v117, 0
    s_mov_b64 exec, 0xffff
    buffer_store_dword v117, v119, s[12:15], 0 offen
    v_lshlrev_b32 v119, 4, v118
    v_add_u32 v119, 16384, v119
    buffer_store_dword v117, v119, s[12:15], 0 offen
    s_mov_b64 exec, -1
K1_NOCLR:
    s_cmp_lt_u32 s2, 32
    s_cbranch_scc0 K1_NOFILL
    s_add_u32 s12, s8, 153616384
    s_addc_u32 s13, s9, 0
    s_and_b32 s13, s13, 0xffff
    s_mov_b32 s14, 131072
    s_mov_b32 s15, 0x00020000
    s_lshl_b32 s10, s2, 2
    s_add_u32 s10, s10, s3
    s_lshl_b32 s10, s10, 10
    v_mov_b32 v112, -1
    v_mov_b32 v113, -1
    v_mov_b32 v114, -1
    v_mov_b32 v115, -1
    buffer_store_dwordx4 v[112:115], v121, s[12:15], s10 offen
K1_NOFILL:
    s_add_u32 s10, s2, 384
    s_sub_u32 s11, s2, 252
    s_cmp_lt_u32 s2, 252
    s_cselect_b32 s2, s10, s11
    s_cmp_lt_u32 s2, 384
    s_cbranch_scc1 K1_W
    s_sub_u32 s11, s2, 384
    s_mul_hi_u32 s13, s11, 1431655766
    s_mul_i32 s12, s13, 3
    s_sub_u32 s12, s11, s12
    s_mov_b32 s11, s13
    s_cmp_ge_u32 s11, 42
    s_cselect_b32 s13, 1, 0
    s_mul_i32 s14, s13, 42
    s_sub_u32 s11, s11, s14
    s_lshl_b32 s11, s11, 2
    s_add_u32 s11, s11, s3
    s_mul_i32 s14, s13, 16384000
    s_add_u32 s16, s4, s14
    s_addc_u32 s17, s5, 0
    s_and_b32 s17, s17, 0xffff
    s_mov_b32 s18, 16384000
    s_mov_b32 s19, 0x00020000
    s_mov_b32 s20, s8
    s_mov_b32 s21, s9
    s_and_b32 s21, s21, 0xffff
    s_mov_b32 s22, 43778048
    s_mov_b32 s23, 0x00020000
    v_lshlrev_b32 v126, 14, v123
    v_lshl_add_u32 v126, v122, 4, v126
    s_mul_i32 s15, s11, 98304
    s_lshl_b32 s24, s12, 8
    s_add_u32 s15, s15, s24
    buffer_load_dwordx4 v[0:3], v126, s[16:19], s15 offen
    buffer_load_dwordx4 v[4:7], v126, s[16:19], s15 offen offset:2048
    s_add_u32 s15, s15, 4096
    buffer_load_dwordx4 v[8:11], v126, s[16:19], s15 offen
    buffer_load_dwordx4 v[12:15], v126, s[16:19], s15 offen offset:2048
    s_add_u32 s15, s15, 4096
    buffer_load_dwordx4 v[16:19], v126, s[16:19], s15 offen
    buffer_load_dwordx4 v[20:23], v126, s[16:19], s15 offen offset:2048
    s_add_u32 s15, s15, 4096
    buffer_load_dwordx4 v[24:27], v126, s[16:19], s15 offen
    buffer_load_dwordx4 v[28:31], v126, s[16:19], s15 offen offset:2048
    s_add_u32 s15, s15, 53248
    buffer_load_dwordx4 v[32:35], v126, s[16:19], s15 offen
    buffer_load_dwordx4 v[36:39], v126, s[16:19], s15 offen offset:2048
    s_add_u32 s15, s15, 4096
    buffer_load_dwordx4 v[40:43], v126, s[16:19], s15 offen
    buffer_load_dwordx4 v[44:47], v126, s[16:19], s15 offen offset:2048
    s_add_u32 s15, s15, 4096
    buffer_load_dwordx4 v[48:51], v126, s[16:19], s15 offen
    buffer_load_dwordx4 v[52:55], v126, s[16:19], s15 offen offset:2048
    s_add_u32 s15, s15, 4096
    buffer_load_dwordx4 v[56:59], v126, s[16:19], s15 offen
    buffer_load_dwordx4 v[60:63], v126, s[16:19], s15 offen offset:2048
    v_lshlrev_b32 v127, 3, v123
    v_lshlrev_b32 v112, 5, v125
    v_mad_u32_u24 v113, v124, v127, v112
    v_mad_u32_u24 v64, v124, 0, v113
    v_mad_u32_u24 v65, v124, 1, v113
    v_mad_u32_u24 v66, v124, 2, v113
    v_mad_u32_u24 v67, v124, 3, v113
    v_mad_u32_u24 v68, v124, 4, v113
    v_mad_u32_u24 v69, v124, 5, v113
    v_mad_u32_u24 v70, v124, 6, v113
    v_mad_u32_u24 v71, v124, 7, v113
    v_and_b32 v64, 127, v64
    v_and_b32 v65, 127, v65
    v_and_b32 v66, 127, v66
    v_and_b32 v67, 127, v67
    v_and_b32 v68, 127, v68
    v_and_b32 v69, 127, v69
    v_and_b32 v70, 127, v70
    v_and_b32 v71, 127, v71
    v_cvt_f32_u32 v64, v64
    v_cvt_f32_u32 v65, v65
    v_cvt_f32_u32 v66, v66
    v_cvt_f32_u32 v67, v67
    v_cvt_f32_u32 v68, v68
    v_cvt_f32_u32 v69, v69
    v_cvt_f32_u32 v70, v70
    v_cvt_f32_u32 v71, v71
    v_mul_f32 v64, 0x3c000000, v64
    v_mul_f32 v65, 0x3c000000, v65
    v_mul_f32 v66, 0x3c000000, v66
    v_mul_f32 v67, 0x3c000000, v67
    v_mul_f32 v68, 0x3c000000, v68
    v_mul_f32 v69, 0x3c000000, v69
    v_mul_f32 v70, 0x3c000000, v70
    v_mul_f32 v71, 0x3c000000, v71
    v_cos_f32 v64, v64
    v_cos_f32 v65, v65
    v_cos_f32 v66, v66
    v_cos_f32 v67, v67
    v_cos_f32 v68, v68
    v_cos_f32 v69, v69
    v_cos_f32 v70, v70
    v_cos_f32 v71, v71
    s_nop 0
    v_cvt_pk_bf16_f32 v72, v64, v65
    v_cvt_pk_bf16_f32 v73, v66, v67
    v_cvt_pk_bf16_f32 v74, v68, v69
    v_cvt_pk_bf16_f32 v75, v70, v71
    v_lshlrev_b32 v80, 16, v72
    v_and_b32 v81, 0xffff0000, v72
    v_sub_f32 v64, v64, v80
    v_sub_f32 v65, v65, v81
    v_lshlrev_b32 v80, 16, v73
    v_and_b32 v81, 0xffff0000, v73
    v_sub_f32 v66, v66, v80
    v_sub_f32 v67, v67, v81
    v_lshlrev_b32 v80, 16, v74
    v_and_b32 v81, 0xffff0000, v74
    v_sub_f32 v68, v68, v80
    v_sub_f32 v69, v69, v81
    v_lshlrev_b32 v80, 16, v75
    v_and_b32 v81, 0xffff0000, v75
    v_sub_f32 v70, v70, v80
    v_sub_f32 v71, v71, v81
    v_cvt_pk_bf16_f32 v76, v64, v65
    v_cvt_pk_bf16_f32 v77, v66, v67
    v_cvt_pk_bf16_f32 v78, v68, v69
    v_cvt_pk_bf16_f32 v79, v70, v71
    s_lshl_b32 s24, s3, 12
    v_add_u32 v114, s24, v121
    ds_write_b128 v114, v[72:75] offset:0
    ds_write_b128 v114, v[76:79] offset:1024
    v_add_u32 v127, 32, v127
    v_lshlrev_b32 v112, 5, v125
    v_mad_u32_u24 v113, v124, v127, v112
    v_mad_u32_u24 v64, v124, 0, v113
    v_mad_u32_u24 v65, v124, 1, v113
    v_mad_u32_u24 v66, v124, 2, v113
    v_mad_u32_u24 v67, v124, 3, v113
    v_mad_u32_u24 v68, v124, 4, v113
    v_mad_u32_u24 v69, v124, 5, v113
    v_mad_u32_u24 v70, v124, 6, v113
    v_mad_u32_u24 v71, v124, 7, v113
    v_and_b32 v64, 127, v64
    v_and_b32 v65, 127, v65
    v_and_b32 v66, 127, v66
    v_and_b32 v67, 127, v67
    v_and_b32 v68, 127, v68
    v_and_b32 v69, 127, v69
    v_and_b32 v70, 127, v70
    v_and_b32 v71, 127, v71
    v_cvt_f32_u32 v64, v64
    v_cvt_f32_u32 v65, v65
    v_cvt_f32_u32 v66, v66
    v_cvt_f32_u32 v67, v67
    v_cvt_f32_u32 v68, v68
    v_cvt_f32_u32 v69, v69
    v_cvt_f32_u32 v70, v70
    v_cvt_f32_u32 v71, v71
    v_mul_f32 v64, 0x3c000000, v64
    v_mul_f32 v65, 0x3c000000, v65
    v_mul_f32 v66, 0x3c000000, v66
    v_mul_f32 v67, 0x3c000000, v67
    v_mul_f32 v68, 0x3c000000, v68
    v_mul_f32 v69, 0x3c000000, v69
    v_mul_f32 v70, 0x3c000000, v70
    v_mul_f32 v71, 0x3c000000, v71
    v_cos_f32 v64, v64
    v_cos_f32 v65, v65
    v_cos_f32 v66, v66
    v_cos_f32 v67, v67
    v_cos_f32 v68, v68
    v_cos_f32 v69, v69
    v_cos_f32 v70, v70
    v_cos_f32 v71, v71
    s_nop 0
    v_cvt_pk_bf16_f32 v72, v64, v65
    v_cvt_pk_bf16_f32 v73, v66, v67
    v_cvt_pk_bf16_f32 v74, v68, v69
    v_cvt_pk_bf16_f32 v75, v70, v71
    v_lshlrev_b32 v80, 16, v72
    v_and_b32 v81, 0xffff0000, v72
    v_sub_f32 v64, v64, v80
    v_sub_f32 v65, v65, v81
    v_lshlrev_b32 v80, 16, v73
    v_and_b32 v81, 0xffff0000, v73
    v_sub_f32 v66, v66, v80
    v_sub_f32 v67, v67, v81
    v_lshlrev_b32 v80, 16, v74
    v_and_b32 v81, 0xffff0000, v74
    v_sub_f32 v68, v68, v80
    v_sub_f32 v69, v69, v81
    v_lshlrev_b32 v80, 16, v75
    v_and_b32 v81, 0xffff0000, v75
    v_sub_f32 v70, v70, v80
    v_sub_f32 v71, v71, v81
    v_cvt_pk_bf16_f32 v76, v64, v65
    v_cvt_pk_bf16_f32 v77, v66, v67
    v_cvt_pk_bf16_f32 v78, v68, v69
    v_cvt_pk_bf16_f32 v79, v70, v71
    s_lshl_b32 s24, s3, 12
    v_add_u32 v114, s24, v121
    ds_write_b128 v114, v[72:75] offset:2048
    ds_write_b128 v114, v[76:79] offset:3072
    v_lshrrev_b32 v112, 1, v123
    s_mov_b32 s24, 1368064
    v_mul_lo_u32 v112, v112, s24
    v_lshrrev_b32 v113, 2, v122
    s_mov_b32 s24, 21376
    v_mul_lo_u32 v113, v113, s24
    v_add_u32 v112, v112, v113
    v_and_b32 v113, 3, v122
    v_and_b32 v114, 1, v123
    v_lshl_add_u32 v113, v114, 2, v113
    s_add_u32 s24, s11, 7
    s_cmp_ge_u32 s11, 160
    s_cselect_b32 s24, s24, s11
    s_cmp_eq_u32 s13, 1
    s_cselect_b32 s24, s24, s11
    s_lshr_b32 s24, s24, 1
    s_and_b32 s24, s24, 7
    v_xor_b32 v113, s24, v113
    v_lshl_add_u32 v120, v113, 4, v112
    s_mul_i32 s25, s13, 684032
    s_mul_i32 s24, s12, 85504
    s_add_u32 s25, s25, s24
    s_lshl_b32 s24, s11, 7
    s_add_u32 s25, s25, s24
    s_waitcnt lgkmcnt(0)
    s_barrier
    s_cmp_ge_u32 s11, 167
    s_cbranch_scc1 K1_END
    s_waitcnt vmcnt(8)
    v_perm_b32 v64, v4, v0, s28
    v_perm_b32 v68, v4, v0, s29
    v_perm_b32 v65, v12, v8, s28
    v_perm_b32 v69, v12, v8, s29
    v_perm_b32 v66, v20, v16, s28
    v_perm_b32 v70, v20, v16, s29
    v_perm_b32 v67, v28, v24, s28
    v_perm_b32 v71, v28, v24, s29
    v_perm_b32 v72, v5, v1, s28
    v_perm_b32 v76, v5, v1, s29
    v_perm_b32 v73, v13, v9, s28
    v_perm_b32 v77, v13, v9, s29
    v_perm_b32 v74, v21, v17, s28
    v_perm_b32 v78, v21, v17, s29
    v_perm_b32 v75, v29, v25, s28
    v_perm_b32 v79, v29, v25, s29
    v_perm_b32 v80, v6, v2, s28
    v_perm_b32 v84, v6, v2, s29
    v_perm_b32 v81, v14, v10, s28
    v_perm_b32 v85, v14, v10, s29
    v_perm_b32 v82, v22, v18, s28
    v_perm_b32 v86, v22, v18, s29
    v_perm_b32 v83, v30, v26, s28
    v_perm_b32 v87, v30, v26, s29
    v_perm_b32 v88, v7, v3, s28
    v_perm_b32 v92, v7, v3, s29
    v_perm_b32 v89, v15, v11, s28
    v_perm_b32 v93, v15, v11, s29
    v_perm_b32 v90, v23, v19, s28
    v_perm_b32 v94, v23, v19, s29
    v_perm_b32 v91, v31, v27, s28
    v_perm_b32 v95, v31, v27, s29
    s_waitcnt vmcnt(0)
    v_perm_b32 v0, v36, v32, s28
    v_perm_b32 v4, v36, v32, s29
    v_perm_b32 v1, v44, v40, s28
    v_perm_b32 v5, v44, v40, s29
    v_perm_b32 v2, v52, v48, s28
    v_perm_b32 v6, v52, v48, s29
    v_perm_b32 v3, v60, v56, s28
    v_perm_b32 v7, v60, v56, s29
    v_perm_b32 v8, v37, v33, s28
    v_perm_b32 v12, v37, v33, s29
    v_perm_b32 v9, v45, v41, s28
    v_perm_b32 v13, v45, v41, s29
    v_perm_b32 v10, v53, v49, s28
    v_perm_b32 v14, v53, v49, s29
    v_perm_b32 v11, v61, v57, s28
    v_perm_b32 v15, v61, v57, s29
    v_perm_b32 v16, v38, v34, s28
    v_perm_b32 v20, v38, v34, s29
    v_perm_b32 v17, v46, v42, s28
    v_perm_b32 v21, v46, v42, s29
    v_perm_b32 v18, v54, v50, s28
    v_perm_b32 v22, v54, v50, s29
    v_perm_b32 v19, v62, v58, s28
    v_perm_b32 v23, v62, v58, s29
    v_perm_b32 v24, v39, v35, s28
    v_perm_b32 v28, v39, v35, s29
    v_perm_b32 v25, v47, v43, s28
    v_perm_b32 v29, v47, v43, s29
    v_perm_b32 v26, v55, v51, s28
    v_perm_b32 v30, v55, v51, s29
    v_perm_b32 v27, v63, v59, s28
    v_perm_b32 v31, v63, v59, s29
    ds_read_b128 v[96:99], v121 offset:0
    ds_read_b128 v[100:103], v121 offset:1024
    ds_read_b128 v[104:107], v121 offset:2048
    ds_read_b128 v[108:111], v121 offset:3072
    s_waitcnt lgkmcnt(3)
    v_mfma_f32_16x16x32_bf16 v[32:35], v[96:99], v[64:67], 0
    v_mfma_f32_16x16x32_bf16 v[36:39], v[96:99], v[68:71], 0
    v_mfma_f32_16x16x32_bf16 v[40:43], v[96:99], v[72:75], 0
    v_mfma_f32_16x16x32_bf16 v[44:47], v[96:99], v[76:79], 0
    v_mfma_f32_16x16x32_bf16 v[48:51], v[96:99], v[80:83], 0
    v_mfma_f32_16x16x32_bf16 v[52:55], v[96:99], v[84:87], 0
    v_mfma_f32_16x16x32_bf16 v[56:59], v[96:99], v[88:91], 0
    v_mfma_f32_16x16x32_bf16 v[60:63], v[96:99], v[92:95], 0
    s_waitcnt lgkmcnt(2)
    v_mfma_f32_16x16x32_bf16 v[32:35], v[100:103], v[64:67], v[32:35]
    v_mfma_f32_16x16x32_bf16 v[36:39], v[100:103], v[68:71], v[36:39]
    v_mfma_f32_16x16x32_bf16 v[40:43], v[100:103], v[72:75], v[40:43]
    v_mfma_f32_16x16x32_bf16 v[44:47], v[100:103], v[76:79], v[44:47]
    v_mfma_f32_16x16x32_bf16 v[48:51], v[100:103], v[80:83], v[48:51]
    v_mfma_f32_16x16x32_bf16 v[52:55], v[100:103], v[84:87], v[52:55]
    v_mfma_f32_16x16x32_bf16 v[56:59], v[100:103], v[88:91], v[56:59]
    v_mfma_f32_16x16x32_bf16 v[60:63], v[100:103], v[92:95], v[60:63]
    s_waitcnt lgkmcnt(1)
    v_mfma_f32_16x16x32_bf16 v[32:35], v[104:107], v[0:3], v[32:35]
    v_mfma_f32_16x16x32_bf16 v[36:39], v[104:107], v[4:7], v[36:39]
    v_mfma_f32_16x16x32_bf16 v[40:43], v[104:107], v[8:11], v[40:43]
    v_mfma_f32_16x16x32_bf16 v[44:47], v[104:107], v[12:15], v[44:47]
    v_mfma_f32_16x16x32_bf16 v[48:51], v[104:107], v[16:19], v[48:51]
    v_mfma_f32_16x16x32_bf16 v[52:55], v[104:107], v[20:23], v[52:55]
    v_mfma_f32_16x16x32_bf16 v[56:59], v[104:107], v[24:27], v[56:59]
    v_mfma_f32_16x16x32_bf16 v[60:63], v[104:107], v[28:31], v[60:63]
    s_waitcnt lgkmcnt(0)
    v_mfma_f32_16x16x32_bf16 v[32:35], v[108:111], v[0:3], v[32:35]
    v_mfma_f32_16x16x32_bf16 v[36:39], v[108:111], v[4:7], v[36:39]
    v_mfma_f32_16x16x32_bf16 v[40:43], v[108:111], v[8:11], v[40:43]
    v_mfma_f32_16x16x32_bf16 v[44:47], v[108:111], v[12:15], v[44:47]
    v_mfma_f32_16x16x32_bf16 v[48:51], v[108:111], v[16:19], v[48:51]
    v_mfma_f32_16x16x32_bf16 v[52:55], v[108:111], v[20:23], v[52:55]
    v_mfma_f32_16x16x32_bf16 v[56:59], v[108:111], v[24:27], v[56:59]
    v_mfma_f32_16x16x32_bf16 v[60:63], v[108:111], v[28:31], v[60:63]
    s_nop 7
    v_cvt_pk_bf16_f32 v112, v32, v36
    v_cvt_pk_bf16_f32 v113, v40, v44
    v_cvt_pk_bf16_f32 v114, v48, v52
    v_cvt_pk_bf16_f32 v115, v56, v60
    buffer_store_dwordx4 v[112:115], v120, s[20:23], s25 offen
    s_add_u32 s25, s25, 2736128
    v_cvt_pk_bf16_f32 v116, v33, v37
    v_cvt_pk_bf16_f32 v117, v41, v45
    v_cvt_pk_bf16_f32 v118, v49, v53
    v_cvt_pk_bf16_f32 v119, v57, v61
    buffer_store_dwordx4 v[116:119], v120, s[20:23], s25 offen
    s_add_u32 s25, s25, 2736128
    v_cvt_pk_bf16_f32 v112, v34, v38
    v_cvt_pk_bf16_f32 v113, v42, v46
    v_cvt_pk_bf16_f32 v114, v50, v54
    v_cvt_pk_bf16_f32 v115, v58, v62
    buffer_store_dwordx4 v[112:115], v120, s[20:23], s25 offen
    s_add_u32 s25, s25, 2736128
    v_cvt_pk_bf16_f32 v116, v35, v39
    v_cvt_pk_bf16_f32 v117, v43, v47
    v_cvt_pk_bf16_f32 v118, v51, v55
    v_cvt_pk_bf16_f32 v119, v59, v63
    buffer_store_dwordx4 v[116:119], v120, s[20:23], s25 offen
    s_add_u32 s25, s25, 2736128
    ds_read_b128 v[96:99], v121 offset:4096
    ds_read_b128 v[100:103], v121 offset:5120
    ds_read_b128 v[104:107], v121 offset:6144
    ds_read_b128 v[108:111], v121 offset:7168
    s_waitcnt lgkmcnt(3)
    v_mfma_f32_16x16x32_bf16 v[32:35], v[96:99], v[64:67], 0
    v_mfma_f32_16x16x32_bf16 v[36:39], v[96:99], v[68:71], 0
    v_mfma_f32_16x16x32_bf16 v[40:43], v[96:99], v[72:75], 0
    v_mfma_f32_16x16x32_bf16 v[44:47], v[96:99], v[76:79], 0
    v_mfma_f32_16x16x32_bf16 v[48:51], v[96:99], v[80:83], 0
    v_mfma_f32_16x16x32_bf16 v[52:55], v[96:99], v[84:87], 0
    v_mfma_f32_16x16x32_bf16 v[56:59], v[96:99], v[88:91], 0
    v_mfma_f32_16x16x32_bf16 v[60:63], v[96:99], v[92:95], 0
    s_waitcnt lgkmcnt(2)
    v_mfma_f32_16x16x32_bf16 v[32:35], v[100:103], v[64:67], v[32:35]
    v_mfma_f32_16x16x32_bf16 v[36:39], v[100:103], v[68:71], v[36:39]
    v_mfma_f32_16x16x32_bf16 v[40:43], v[100:103], v[72:75], v[40:43]
    v_mfma_f32_16x16x32_bf16 v[44:47], v[100:103], v[76:79], v[44:47]
    v_mfma_f32_16x16x32_bf16 v[48:51], v[100:103], v[80:83], v[48:51]
    v_mfma_f32_16x16x32_bf16 v[52:55], v[100:103], v[84:87], v[52:55]
    v_mfma_f32_16x16x32_bf16 v[56:59], v[100:103], v[88:91], v[56:59]
    v_mfma_f32_16x16x32_bf16 v[60:63], v[100:103], v[92:95], v[60:63]
    s_waitcnt lgkmcnt(1)
    v_mfma_f32_16x16x32_bf16 v[32:35], v[104:107], v[0:3], v[32:35]
    v_mfma_f32_16x16x32_bf16 v[36:39], v[104:107], v[4:7], v[36:39]
    v_mfma_f32_16x16x32_bf16 v[40:43], v[104:107], v[8:11], v[40:43]
    v_mfma_f32_16x16x32_bf16 v[44:47], v[104:107], v[12:15], v[44:47]
    v_mfma_f32_16x16x32_bf16 v[48:51], v[104:107], v[16:19], v[48:51]
    v_mfma_f32_16x16x32_bf16 v[52:55], v[104:107], v[20:23], v[52:55]
    v_mfma_f32_16x16x32_bf16 v[56:59], v[104:107], v[24:27], v[56:59]
    v_mfma_f32_16x16x32_bf16 v[60:63], v[104:107], v[28:31], v[60:63]
    s_waitcnt lgkmcnt(0)
    v_mfma_f32_16x16x32_bf16 v[32:35], v[108:111], v[0:3], v[32:35]
    v_mfma_f32_16x16x32_bf16 v[36:39], v[108:111], v[4:7], v[36:39]
    v_mfma_f32_16x16x32_bf16 v[40:43], v[108:111], v[8:11], v[40:43]
    v_mfma_f32_16x16x32_bf16 v[44:47], v[108:111], v[12:15], v[44:47]
    v_mfma_f32_16x16x32_bf16 v[48:51], v[108:111], v[16:19], v[48:51]
    v_mfma_f32_16x16x32_bf16 v[52:55], v[108:111], v[20:23], v[52:55]
    v_mfma_f32_16x16x32_bf16 v[56:59], v[108:111], v[24:27], v[56:59]
    v_mfma_f32_16x16x32_bf16 v[60:63], v[108:111], v[28:31], v[60:63]
    s_nop 7
    v_cvt_pk_bf16_f32 v112, v32, v36
    v_cvt_pk_bf16_f32 v113, v40, v44
    v_cvt_pk_bf16_f32 v114, v48, v52
    v_cvt_pk_bf16_f32 v115, v56, v60
    buffer_store_dwordx4 v[112:115], v120, s[20:23], s25 offen
    s_add_u32 s25, s25, 2736128
    v_cvt_pk_bf16_f32 v116, v33, v37
    v_cvt_pk_bf16_f32 v117, v41, v45
    v_cvt_pk_bf16_f32 v118, v49, v53
    v_cvt_pk_bf16_f32 v119, v57, v61
    buffer_store_dwordx4 v[116:119], v120, s[20:23], s25 offen
    s_add_u32 s25, s25, 2736128
    v_cvt_pk_bf16_f32 v112, v34, v38
    v_cvt_pk_bf16_f32 v113, v42, v46
    v_cvt_pk_bf16_f32 v114, v50, v54
    v_cvt_pk_bf16_f32 v115, v58, v62
    buffer_store_dwordx4 v[112:115], v120, s[20:23], s25 offen
    s_add_u32 s25, s25, 2736128
    v_cvt_pk_bf16_f32 v116, v35, v39
    v_cvt_pk_bf16_f32 v117, v43, v47
    v_cvt_pk_bf16_f32 v118, v51, v55
    v_cvt_pk_bf16_f32 v119, v59, v63
    buffer_store_dwordx4 v[116:119], v120, s[20:23], s25 offen
    s_add_u32 s25, s25, 2736128
    ds_read_b128 v[96:99], v121 offset:8192
    ds_read_b128 v[100:103], v121 offset:9216
    ds_read_b128 v[104:107], v121 offset:10240
    ds_read_b128 v[108:111], v121 offset:11264
    s_waitcnt lgkmcnt(3)
    v_mfma_f32_16x16x32_bf16 v[32:35], v[96:99], v[64:67], 0
    v_mfma_f32_16x16x32_bf16 v[36:39], v[96:99], v[68:71], 0
    v_mfma_f32_16x16x32_bf16 v[40:43], v[96:99], v[72:75], 0
    v_mfma_f32_16x16x32_bf16 v[44:47], v[96:99], v[76:79], 0
    v_mfma_f32_16x16x32_bf16 v[48:51], v[96:99], v[80:83], 0
    v_mfma_f32_16x16x32_bf16 v[52:55], v[96:99], v[84:87], 0
    v_mfma_f32_16x16x32_bf16 v[56:59], v[96:99], v[88:91], 0
    v_mfma_f32_16x16x32_bf16 v[60:63], v[96:99], v[92:95], 0
    s_waitcnt lgkmcnt(2)
    v_mfma_f32_16x16x32_bf16 v[32:35], v[100:103], v[64:67], v[32:35]
    v_mfma_f32_16x16x32_bf16 v[36:39], v[100:103], v[68:71], v[36:39]
    v_mfma_f32_16x16x32_bf16 v[40:43], v[100:103], v[72:75], v[40:43]
    v_mfma_f32_16x16x32_bf16 v[44:47], v[100:103], v[76:79], v[44:47]
    v_mfma_f32_16x16x32_bf16 v[48:51], v[100:103], v[80:83], v[48:51]
    v_mfma_f32_16x16x32_bf16 v[52:55], v[100:103], v[84:87], v[52:55]
    v_mfma_f32_16x16x32_bf16 v[56:59], v[100:103], v[88:91], v[56:59]
    v_mfma_f32_16x16x32_bf16 v[60:63], v[100:103], v[92:95], v[60:63]
    s_waitcnt lgkmcnt(1)
    v_mfma_f32_16x16x32_bf16 v[32:35], v[104:107], v[0:3], v[32:35]
    v_mfma_f32_16x16x32_bf16 v[36:39], v[104:107], v[4:7], v[36:39]
    v_mfma_f32_16x16x32_bf16 v[40:43], v[104:107], v[8:11], v[40:43]
    v_mfma_f32_16x16x32_bf16 v[44:47], v[104:107], v[12:15], v[44:47]
    v_mfma_f32_16x16x32_bf16 v[48:51], v[104:107], v[16:19], v[48:51]
    v_mfma_f32_16x16x32_bf16 v[52:55], v[104:107], v[20:23], v[52:55]
    v_mfma_f32_16x16x32_bf16 v[56:59], v[104:107], v[24:27], v[56:59]
    v_mfma_f32_16x16x32_bf16 v[60:63], v[104:107], v[28:31], v[60:63]
    s_waitcnt lgkmcnt(0)
    v_mfma_f32_16x16x32_bf16 v[32:35], v[108:111], v[0:3], v[32:35]
    v_mfma_f32_16x16x32_bf16 v[36:39], v[108:111], v[4:7], v[36:39]
    v_mfma_f32_16x16x32_bf16 v[40:43], v[108:111], v[8:11], v[40:43]
    v_mfma_f32_16x16x32_bf16 v[44:47], v[108:111], v[12:15], v[44:47]
    v_mfma_f32_16x16x32_bf16 v[48:51], v[108:111], v[16:19], v[48:51]
    v_mfma_f32_16x16x32_bf16 v[52:55], v[108:111], v[20:23], v[52:55]
    v_mfma_f32_16x16x32_bf16 v[56:59], v[108:111], v[24:27], v[56:59]
    v_mfma_f32_16x16x32_bf16 v[60:63], v[108:111], v[28:31], v[60:63]
    s_nop 7
    v_cvt_pk_bf16_f32 v112, v32, v36
    v_cvt_pk_bf16_f32 v113, v40, v44
    v_cvt_pk_bf16_f32 v114, v48, v52
    v_cvt_pk_bf16_f32 v115, v56, v60
    buffer_store_dwordx4 v[112:115], v120, s[20:23], s25 offen
    s_add_u32 s25, s25, 2736128
    v_cvt_pk_bf16_f32 v116, v33, v37
    v_cvt_pk_bf16_f32 v117, v41, v45
    v_cvt_pk_bf16_f32 v118, v49, v53
    v_cvt_pk_bf16_f32 v119, v57, v61
    buffer_store_dwordx4 v[116:119], v120, s[20:23], s25 offen
    s_add_u32 s25, s25, 2736128
    v_cvt_pk_bf16_f32 v112, v34, v38
    v_cvt_pk_bf16_f32 v113, v42, v46
    v_cvt_pk_bf16_f32 v114, v50, v54
    v_cvt_pk_bf16_f32 v115, v58, v62
    buffer_store_dwordx4 v[112:115], v120, s[20:23], s25 offen
    s_add_u32 s25, s25, 2736128
    v_cvt_pk_bf16_f32 v116, v35, v39
    v_cvt_pk_bf16_f32 v117, v43, v47
    v_cvt_pk_bf16_f32 v118, v51, v55
    v_cvt_pk_bf16_f32 v119, v59, v63
    buffer_store_dwordx4 v[116:119], v120, s[20:23], s25 offen
    s_add_u32 s25, s25, 2736128
    ds_read_b128 v[96:99], v121 offset:12288
    ds_read_b128 v[100:103], v121 offset:13312
    ds_read_b128 v[104:107], v121 offset:14336
    ds_read_b128 v[108:111], v121 offset:15360
    s_waitcnt lgkmcnt(3)
    v_mfma_f32_16x16x32_bf16 v[32:35], v[96:99], v[64:67], 0
    v_mfma_f32_16x16x32_bf16 v[36:39], v[96:99], v[68:71], 0
    v_mfma_f32_16x16x32_bf16 v[40:43], v[96:99], v[72:75], 0
    v_mfma_f32_16x16x32_bf16 v[44:47], v[96:99], v[76:79], 0
    v_mfma_f32_16x16x32_bf16 v[48:51], v[96:99], v[80:83], 0
    v_mfma_f32_16x16x32_bf16 v[52:55], v[96:99], v[84:87], 0
    v_mfma_f32_16x16x32_bf16 v[56:59], v[96:99], v[88:91], 0
    v_mfma_f32_16x16x32_bf16 v[60:63], v[96:99], v[92:95], 0
    s_waitcnt lgkmcnt(2)
    v_mfma_f32_16x16x32_bf16 v[32:35], v[100:103], v[64:67], v[32:35]
    v_mfma_f32_16x16x32_bf16 v[36:39], v[100:103], v[68:71], v[36:39]
    v_mfma_f32_16x16x32_bf16 v[40:43], v[100:103], v[72:75], v[40:43]
    v_mfma_f32_16x16x32_bf16 v[44:47], v[100:103], v[76:79], v[44:47]
    v_mfma_f32_16x16x32_bf16 v[48:51], v[100:103], v[80:83], v[48:51]
    v_mfma_f32_16x16x32_bf16 v[52:55], v[100:103], v[84:87], v[52:55]
    v_mfma_f32_16x16x32_bf16 v[56:59], v[100:103], v[88:91], v[56:59]
    v_mfma_f32_16x16x32_bf16 v[60:63], v[100:103], v[92:95], v[60:63]
    s_waitcnt lgkmcnt(1)
    v_mfma_f32_16x16x32_bf16 v[32:35], v[104:107], v[0:3], v[32:35]
    v_mfma_f32_16x16x32_bf16 v[36:39], v[104:107], v[4:7], v[36:39]
    v_mfma_f32_16x16x32_bf16 v[40:43], v[104:107], v[8:11], v[40:43]
    v_mfma_f32_16x16x32_bf16 v[44:47], v[104:107], v[12:15], v[44:47]
    v_mfma_f32_16x16x32_bf16 v[48:51], v[104:107], v[16:19], v[48:51]
    v_mfma_f32_16x16x32_bf16 v[52:55], v[104:107], v[20:23], v[52:55]
    v_mfma_f32_16x16x32_bf16 v[56:59], v[104:107], v[24:27], v[56:59]
    v_mfma_f32_16x16x32_bf16 v[60:63], v[104:107], v[28:31], v[60:63]
    s_waitcnt lgkmcnt(0)
    v_mfma_f32_16x16x32_bf16 v[32:35], v[108:111], v[0:3], v[32:35]
    v_mfma_f32_16x16x32_bf16 v[36:39], v[108:111], v[4:7], v[36:39]
    v_mfma_f32_16x16x32_bf16 v[40:43], v[108:111], v[8:11], v[40:43]
    v_mfma_f32_16x16x32_bf16 v[44:47], v[108:111], v[12:15], v[44:47]
    v_mfma_f32_16x16x32_bf16 v[48:51], v[108:111], v[16:19], v[48:51]
    v_mfma_f32_16x16x32_bf16 v[52:55], v[108:111], v[20:23], v[52:55]
    v_mfma_f32_16x16x32_bf16 v[56:59], v[108:111], v[24:27], v[56:59]
    v_mfma_f32_16x16x32_bf16 v[60:63], v[108:111], v[28:31], v[60:63]
    s_nop 7
    v_cvt_pk_bf16_f32 v112, v32, v36
    v_cvt_pk_bf16_f32 v113, v40, v44
    v_cvt_pk_bf16_f32 v114, v48, v52
    v_cvt_pk_bf16_f32 v115, v56, v60
    buffer_store_dwordx4 v[112:115], v120, s[20:23], s25 offen
    s_add_u32 s25, s25, 2736128
    v_cvt_pk_bf16_f32 v116, v33, v37
    v_cvt_pk_bf16_f32 v117, v41, v45
    v_cvt_pk_bf16_f32 v118, v49, v53
    v_cvt_pk_bf16_f32 v119, v57, v61
    buffer_store_dwordx4 v[116:119], v120, s[20:23], s25 offen
    s_add_u32 s25, s25, 2736128
    v_cvt_pk_bf16_f32 v112, v34, v38
    v_cvt_pk_bf16_f32 v113, v42, v46
    v_cvt_pk_bf16_f32 v114, v50, v54
    v_cvt_pk_bf16_f32 v115, v58, v62
    buffer_store_dwordx4 v[112:115], v120, s[20:23], s25 offen
    s_add_u32 s25, s25, 2736128
    v_cvt_pk_bf16_f32 v116, v35, v39
    v_cvt_pk_bf16_f32 v117, v43, v47
    v_cvt_pk_bf16_f32 v118, v51, v55
    v_cvt_pk_bf16_f32 v119, v59, v63
    buffer_store_dwordx4 v[116:119], v120, s[20:23], s25 offen
    s_endpgm
K1_W:
    s_mov_b32 s16, s6
    s_mov_b32 s17, s7
    s_and_b32 s17, s17, 0xffff
    s_mov_b32 s18, 16252928
    s_mov_b32 s19, 0x00020000
    s_add_u32 s20, s8, 50331648
    s_addc_u32 s21, s9, 0
    s_and_b32 s21, s21, 0xffff
    s_mov_b32 s22, 67108864
    s_mov_b32 s23, 0x00020000
    s_mul_i32 s11, s2, 1
    s_lshr_b32 s12, s11, 9
    s_and_b32 s13, s11, 511
    s_lshl_b32 s14, s12, 19
    s_lshl_b32 s15, s13, 10
    s_add_u32 s14, s14, s15
    s_lshl_b32 s15, s3, 8
    s_add_u32 s14, s14, s15
    v_and_b32 v126, 1, v123
    v_lshlrev_b32 v126, 23, v126
    v_lshl_add_u32 v126, v122, 4, v126
    s_mov_b32 s15, s14
    buffer_load_dwordx4 v[0:3], v126, s[16:19], s15 offen
    s_add_u32 s15, s15, 0x100000
    buffer_load_dwordx4 v[4:7], v126, s[16:19], s15 offen
    s_add_u32 s15, s15, 0x100000
    buffer_load_dwordx4 v[8:11], v126, s[16:19], s15 offen
    s_add_u32 s15, s15, 0x100000
    buffer_load_dwordx4 v[12:15], v126, s[16:19], s15 offen
    s_add_u32 s15, s15, 0x100000
    buffer_load_dwordx4 v[16:19], v126, s[16:19], s15 offen
    s_add_u32 s15, s15, 0x100000
    buffer_load_dwordx4 v[20:23], v126, s[16:19], s15 offen
    s_add_u32 s15, s15, 0x100000
    buffer_load_dwordx4 v[24:27], v126, s[16:19], s15 offen
    s_add_u32 s15, s15, 0x100000
    buffer_load_dwordx4 v[28:31], v126, s[16:19], s15 offen
    v_and_b32 v127, 1, v123
    v_lshlrev_b32 v127, 3, v127
    v_mul_u32_u24 v112, 96, v125
    v_mad_u32_u24 v113, v124, v127, v112
    v_mad_u32_u24 v64, v124, 0, v113
    v_mad_u32_u24 v65, v124, 1, v113
    v_mad_u32_u24 v66, v124, 2, v113
    v_mad_u32_u24 v67, v124, 3, v113
    v_mad_u32_u24 v68, v124, 4, v113
    v_mad_u32_u24 v69, v124, 5, v113
    v_mad_u32_u24 v70, v124, 6, v113
    v_mad_u32_u24 v71, v124, 7, v113
    v_and_b32 v64, 127, v64
    v_and_b32 v65, 127, v65
    v_and_b32 v66, 127, v66
    v_and_b32 v67, 127, v67
    v_and_b32 v68, 127, v68
    v_and_b32 v69, 127, v69
    v_and_b32 v70, 127, v70
    v_and_b32 v71, 127, v71
    v_cvt_f32_u32 v64, v64
    v_cvt_f32_u32 v65, v65
    v_cvt_f32_u32 v66, v66
    v_cvt_f32_u32 v67, v67
    v_cvt_f32_u32 v68, v68
    v_cvt_f32_u32 v69, v69
    v_cvt_f32_u32 v70, v70
    v_cvt_f32_u32 v71, v71
    v_mul_f32 v64, 0x3c000000, v64
    v_mul_f32 v65, 0x3c000000, v65
    v_mul_f32 v66, 0x3c000000, v66
    v_mul_f32 v67, 0x3c000000, v67
    v_mul_f32 v68, 0x3c000000, v68
    v_mul_f32 v69, 0x3c000000, v69
    v_mul_f32 v70, 0x3c000000, v70
    v_mul_f32 v71, 0x3c000000, v71
    v_cos_f32 v64, v64
    v_cos_f32 v65, v65
    v_cos_f32 v66, v66
    v_cos_f32 v67, v67
    v_cos_f32 v68, v68
    v_cos_f32 v69, v69
    v_cos_f32 v70, v70
    v_cos_f32 v71, v71
    s_nop 0
    v_cvt_pk_bf16_f32 v72, v64, v65
    v_cvt_pk_bf16_f32 v73, v66, v67
    v_cvt_pk_bf16_f32 v74, v68, v69
    v_cvt_pk_bf16_f32 v75, v70, v71
    v_lshlrev_b32 v80, 16, v72
    v_and_b32 v81, 0xffff0000, v72
    v_sub_f32 v64, v64, v80
    v_sub_f32 v65, v65, v81
    v_lshlrev_b32 v80, 16, v73
    v_and_b32 v81, 0xffff0000, v73
    v_sub_f32 v66, v66, v80
    v_sub_f32 v67, v67, v81
    v_lshlrev_b32 v80, 16, v74
    v_and_b32 v81, 0xffff0000, v74
    v_sub_f32 v68, v68, v80
    v_sub_f32 v69, v69, v81
    v_lshlrev_b32 v80, 16, v75
    v_and_b32 v81, 0xffff0000, v75
    v_sub_f32 v70, v70, v80
    v_sub_f32 v71, v71, v81
    v_cvt_pk_bf16_f32 v76, v64, v65
    v_cvt_pk_bf16_f32 v77, v66, v67
    v_cvt_pk_bf16_f32 v78, v68, v69
    v_cvt_pk_bf16_f32 v79, v70, v71
    v_cmp_lt_u32 vcc, 1, v123
    s_lshl_b32 s24, s3, 10
    v_add_u32 v114, s24, v121
    v_cndmask_b32 v72, v72, v76, vcc
    v_cndmask_b32 v73, v73, v77, vcc
    v_cndmask_b32 v74, v74, v78, vcc
    v_cndmask_b32 v75, v75, v79, vcc
    ds_write_b128 v114, v[72:75]
    v_lshrrev_b32 v112, 1, v123
    s_mov_b32 s24, 2097152
    v_mul_lo_u32 v112, v112, s24
    v_and_b32 v113, 1, v123
    v_lshl_add_u32 v112, v113, 8, v112
    v_and_b32 v113, 1, v122
    v_lshl_add_u32 v124, v113, 4, v112
    v_lshrrev_b32 v125, 1, v122
    s_mul_i32 s26, s3, 524288
    s_lshl_b32 s24, s11, 9
    s_add_u32 s26, s26, s24
    s_waitcnt lgkmcnt(0)
    s_barrier
    ds_read_b128 v[96:99], v121 offset:0
    ds_read_b128 v[100:103], v121 offset:1024
    ds_read_b128 v[104:107], v121 offset:2048
    ds_read_b128 v[108:111], v121 offset:3072
    s_mov_b32 s27, 0
    s_waitcnt vmcnt(0) lgkmcnt(0)
K1_W_LOOP:
    s_add_u32 s24, s11, s27
    s_and_b32 s30, s24, 3
    s_lshr_b32 s24, s24, 1
    s_and_b32 s24, s24, 4
    s_or_b32 s30, s30, s24
    v_xor_b32 v112, s30, v125
    v_lshl_add_u32 v120, v112, 5, v124
    s_lshl_b32 s25, s27, 9
    s_add_u32 s25, s25, s26
    v_perm_b32 v32, v4, v0, s28
    v_perm_b32 v36, v4, v0, s29
    v_perm_b32 v33, v12, v8, s28
    v_perm_b32 v37, v12, v8, s29
    v_perm_b32 v34, v20, v16, s28
    v_perm_b32 v38, v20, v16, s29
    v_perm_b32 v35, v28, v24, s28
    v_perm_b32 v39, v28, v24, s29
    v_perm_b32 v40, v5, v1, s28
    v_perm_b32 v44, v5, v1, s29
    v_perm_b32 v41, v13, v9, s28
    v_perm_b32 v45, v13, v9, s29
    v_perm_b32 v42, v21, v17, s28
    v_perm_b32 v46, v21, v17, s29
    v_perm_b32 v43, v29, v25, s28
    v_perm_b32 v47, v29, v25, s29
    v_perm_b32 v48, v6, v2, s28
    v_perm_b32 v52, v6, v2, s29
    v_perm_b32 v49, v14, v10, s28
    v_perm_b32 v53, v14, v10, s29
    v_perm_b32 v50, v22, v18, s28
    v_perm_b32 v54, v22, v18, s29
    v_perm_b32 v51, v30, v26, s28
    v_perm_b32 v55, v30, v26, s29
    v_perm_b32 v56, v7, v3, s28
    v_perm_b32 v60, v7, v3, s29
    v_perm_b32 v57, v15, v11, s28
    v_perm_b32 v61, v15, v11, s29
    v_perm_b32 v58, v23, v19, s28
    v_perm_b32 v62, v23, v19, s29
    v_perm_b32 v59, v31, v27, s28
    v_perm_b32 v63, v31, v27, s29
    s_add_u32 s27, s27, 1
    s_add_u32 s14, s14, 1024
    s_cmp_ge_u32 s27, 1
    s_cbranch_scc1 K1_W_NOLOAD
    s_mov_b32 s15, s14
    buffer_load_dwordx4 v[0:3], v126, s[16:19], s15 offen
    s_add_u32 s15, s15, 0x100000
    buffer_load_dwordx4 v[4:7], v126, s[16:19], s15 offen
    s_add_u32 s15, s15, 0x100000
    buffer_load_dwordx4 v[8:11], v126, s[16:19], s15 offen
    s_add_u32 s15, s15, 0x100000
    buffer_load_dwordx4 v[12:15], v126, s[16:19], s15 offen
    s_add_u32 s15, s15, 0x100000
    buffer_load_dwordx4 v[16:19], v126, s[16:19], s15 offen
    s_add_u32 s15, s15, 0x100000
    buffer_load_dwordx4 v[20:23], v126, s[16:19], s15 offen
    s_add_u32 s15, s15, 0x100000
    buffer_load_dwordx4 v[24:27], v126, s[16:19], s15 offen
    s_add_u32 s15, s15, 0x100000
    buffer_load_dwordx4 v[28:31], v126, s[16:19], s15 offen
K1_W_NOLOAD:
    v_mfma_f32_16x16x32_bf16 v[64:67], v[96:99], v[32:35], 0
    v_mfma_f32_16x16x32_bf16 v[68:71], v[96:99], v[36:39], 0
    v_mfma_f32_16x16x32_bf16 v[72:75], v[96:99], v[40:43], 0
    v_mfma_f32_16x16x32_bf16 v[76:79], v[96:99], v[44:47], 0
    v_mfma_f32_16x16x32_bf16 v[80:83], v[96:99], v[48:51], 0
    v_mfma_f32_16x16x32_bf16 v[84:87], v[96:99], v[52:55], 0
    v_mfma_f32_16x16x32_bf16 v[88:91], v[96:99], v[56:59], 0
    v_mfma_f32_16x16x32_bf16 v[92:95], v[96:99], v[60:63], 0
    s_nop 7
    v_cvt_pk_bf16_f32 v112, v64, v68
    v_cvt_pk_bf16_f32 v113, v72, v76
    v_cvt_pk_bf16_f32 v114, v80, v84
    v_cvt_pk_bf16_f32 v115, v88, v92
    buffer_store_dwordx4 v[112:115], v120, s[20:23], s25 offen
    s_add_u32 s25, s25, 4194304
    v_cvt_pk_bf16_f32 v116, v65, v69
    v_cvt_pk_bf16_f32 v117, v73, v77
    v_cvt_pk_bf16_f32 v118, v81, v85
    v_cvt_pk_bf16_f32 v119, v89, v93
    buffer_store_dwordx4 v[116:119], v120, s[20:23], s25 offen
    s_add_u32 s25, s25, 4194304
    v_cvt_pk_bf16_f32 v112, v66, v70
    v_cvt_pk_bf16_f32 v113, v74, v78
    v_cvt_pk_bf16_f32 v114, v82, v86
    v_cvt_pk_bf16_f32 v115, v90, v94
    buffer_store_dwordx4 v[112:115], v120, s[20:23], s25 offen
    s_add_u32 s25, s25, 4194304
    v_cvt_pk_bf16_f32 v116, v67, v71
    v_cvt_pk_bf16_f32 v117, v75, v79
    v_cvt_pk_bf16_f32 v118, v83, v87
    v_cvt_pk_bf16_f32 v119, v91, v95
    buffer_store_dwordx4 v[116:119], v120, s[20:23], s25 offen
    s_add_u32 s25, s25, 4194304
    v_mfma_f32_16x16x32_bf16 v[64:67], v[100:103], v[32:35], 0
    v_mfma_f32_16x16x32_bf16 v[68:71], v[100:103], v[36:39], 0
    v_mfma_f32_16x16x32_bf16 v[72:75], v[100:103], v[40:43], 0
    v_mfma_f32_16x16x32_bf16 v[76:79], v[100:103], v[44:47], 0
    v_mfma_f32_16x16x32_bf16 v[80:83], v[100:103], v[48:51], 0
    v_mfma_f32_16x16x32_bf16 v[84:87], v[100:103], v[52:55], 0
    v_mfma_f32_16x16x32_bf16 v[88:91], v[100:103], v[56:59], 0
    v_mfma_f32_16x16x32_bf16 v[92:95], v[100:103], v[60:63], 0
    s_nop 7
    v_cvt_pk_bf16_f32 v112, v64, v68
    v_cvt_pk_bf16_f32 v113, v72, v76
    v_cvt_pk_bf16_f32 v114, v80, v84
    v_cvt_pk_bf16_f32 v115, v88, v92
    buffer_store_dwordx4 v[112:115], v120, s[20:23], s25 offen
    s_add_u32 s25, s25, 4194304
    v_cvt_pk_bf16_f32 v116, v65, v69
    v_cvt_pk_bf16_f32 v117, v73, v77
    v_cvt_pk_bf16_f32 v118, v81, v85
    v_cvt_pk_bf16_f32 v119, v89, v93
    buffer_store_dwordx4 v[116:119], v120, s[20:23], s25 offen
    s_add_u32 s25, s25, 4194304
    v_cvt_pk_bf16_f32 v112, v66, v70
    v_cvt_pk_bf16_f32 v113, v74, v78
    v_cvt_pk_bf16_f32 v114, v82, v86
    v_cvt_pk_bf16_f32 v115, v90, v94
    buffer_store_dwordx4 v[112:115], v120, s[20:23], s25 offen
    s_add_u32 s25, s25, 4194304
    v_cvt_pk_bf16_f32 v116, v67, v71
    v_cvt_pk_bf16_f32 v117, v75, v79
    v_cvt_pk_bf16_f32 v118, v83, v87
    v_cvt_pk_bf16_f32 v119, v91, v95
    buffer_store_dwordx4 v[116:119], v120, s[20:23], s25 offen
    s_add_u32 s25, s25, 4194304
    v_mfma_f32_16x16x32_bf16 v[64:67], v[104:107], v[32:35], 0
    v_mfma_f32_16x16x32_bf16 v[68:71], v[104:107], v[36:39], 0
    v_mfma_f32_16x16x32_bf16 v[72:75], v[104:107], v[40:43], 0
    v_mfma_f32_16x16x32_bf16 v[76:79], v[104:107], v[44:47], 0
    v_mfma_f32_16x16x32_bf16 v[80:83], v[104:107], v[48:51], 0
    v_mfma_f32_16x16x32_bf16 v[84:87], v[104:107], v[52:55], 0
    v_mfma_f32_16x16x32_bf16 v[88:91], v[104:107], v[56:59], 0
    v_mfma_f32_16x16x32_bf16 v[92:95], v[104:107], v[60:63], 0
    s_nop 7
    v_cvt_pk_bf16_f32 v112, v64, v68
    v_cvt_pk_bf16_f32 v113, v72, v76
    v_cvt_pk_bf16_f32 v114, v80, v84
    v_cvt_pk_bf16_f32 v115, v88, v92
    buffer_store_dwordx4 v[112:115], v120, s[20:23], s25 offen
    s_add_u32 s25, s25, 4194304
    v_cvt_pk_bf16_f32 v116, v65, v69
    v_cvt_pk_bf16_f32 v117, v73, v77
    v_cvt_pk_bf16_f32 v118, v81, v85
    v_cvt_pk_bf16_f32 v119, v89, v93
    buffer_store_dwordx4 v[116:119], v120, s[20:23], s25 offen
    s_add_u32 s25, s25, 4194304
    v_cvt_pk_bf16_f32 v112, v66, v70
    v_cvt_pk_bf16_f32 v113, v74, v78
    v_cvt_pk_bf16_f32 v114, v82, v86
    v_cvt_pk_bf16_f32 v115, v90, v94
    buffer_store_dwordx4 v[112:115], v120, s[20:23], s25 offen
    s_add_u32 s25, s25, 4194304
    v_cvt_pk_bf16_f32 v116, v67, v71
    v_cvt_pk_bf16_f32 v117, v75, v79
    v_cvt_pk_bf16_f32 v118, v83, v87
    v_cvt_pk_bf16_f32 v119, v91, v95
    buffer_store_dwordx4 v[116:119], v120, s[20:23], s25 offen
    s_add_u32 s25, s25, 4194304
    v_mfma_f32_16x16x32_bf16 v[64:67], v[108:111], v[32:35], 0
    v_mfma_f32_16x16x32_bf16 v[68:71], v[108:111], v[36:39], 0
    v_mfma_f32_16x16x32_bf16 v[72:75], v[108:111], v[40:43], 0
    v_mfma_f32_16x16x32_bf16 v[76:79], v[108:111], v[44:47], 0
    v_mfma_f32_16x16x32_bf16 v[80:83], v[108:111], v[48:51], 0
    v_mfma_f32_16x16x32_bf16 v[84:87], v[108:111], v[52:55], 0
    v_mfma_f32_16x16x32_bf16 v[88:91], v[108:111], v[56:59], 0
    v_mfma_f32_16x16x32_bf16 v[92:95], v[108:111], v[60:63], 0
    s_nop 7
    v_cvt_pk_bf16_f32 v112, v64, v68
    v_cvt_pk_bf16_f32 v113, v72, v76
    v_cvt_pk_bf16_f32 v114, v80, v84
    v_cvt_pk_bf16_f32 v115, v88, v92
    buffer_store_dwordx4 v[112:115], v120, s[20:23], s25 offen
    s_add_u32 s25, s25, 4194304
    v_cvt_pk_bf16_f32 v116, v65, v69
    v_cvt_pk_bf16_f32 v117, v73, v77
    v_cvt_pk_bf16_f32 v118, v81, v85
    v_cvt_pk_bf16_f32 v119, v89, v93
    buffer_store_dwordx4 v[116:119], v120, s[20:23], s25 offen
    s_add_u32 s25, s25, 4194304
    v_cvt_pk_bf16_f32 v112, v66, v70
    v_cvt_pk_bf16_f32 v113, v74, v78
    v_cvt_pk_bf16_f32 v114, v82, v86
    v_cvt_pk_bf16_f32 v115, v90, v94
    buffer_store_dwordx4 v[112:115], v120, s[20:23], s25 offen
    s_add_u32 s25, s25, 4194304
    v_cvt_pk_bf16_f32 v116, v67, v71
    v_cvt_pk_bf16_f32 v117, v75, v79
    v_cvt_pk_bf16_f32 v118, v83, v87
    v_cvt_pk_bf16_f32 v119, v91, v95
    buffer_store_dwordx4 v[116:119], v120, s[20:23], s25 offen
    s_waitcnt vmcnt(16)
    s_cmp_lt_u32 s27, 1
    s_cbranch_scc1 K1_W_LOOP
K1_END:
    s_endpgm
.p2align 8
.type k12_fused_kernel,@function
k12_fused_kernel:
    s_cmp_ge_u32 s2, 256
    s_cbranch_scc1 K12_END
    s_load_dwordx4 s[52:55], s[0:1], 0
    s_load_dwordx4 s[56:59], s[0:1], 40
    s_getpc_b64 s[90:91]
CPF_K12:
    s_sub_u32 s90, s90, CPF_K12-k12_fused_kernel
    s_subb_u32 s91, s91, 0
    v_lshlrev_b32 v8, 7, v0
    v_mov_b32 v11, s91
    v_min_u32 v9, TEXT_END-k12_fused_kernel-4, v8
    v_add_co_u32 v10, vcc, s90, v9
    v_addc_co_u32 v11, vcc, 0, v11, vcc
    global_load_dword v63, v[10:11], off
    v_lshrrev_b32 v1, 6, v0
    v_and_b32 v2, 63, v0
    v_readfirstlane_b32 s3, v1
    s_waitcnt lgkmcnt(0)
    s_cmp_lt_u32 s3, 4
    s_cbranch_scc1 K12_CONS
    v_and_b32 v64, 15, v2
    v_lshrrev_b32 v65, 4, v2
    v_lshlrev_b32 v254, 4, v2
    s_and_b32 s44, s3, 3
    s_and_b32 s20, s44, 1
    s_lshr_b32 s21, s44, 1
    s_lshl_b32 s22, s2, 1
    s_add_u32 s22, s22, s21
    s_and_b32 s23, s22, 3
    s_lshr_b32 s22, s22, 2
    s_and_b32 s24, s2, 7
    s_lshl_b32 s24, s24, 5
    s_lshr_b32 s25, s2, 3
    s_add_u32 s24, s24, s25
    s_cmp_ge_u32 s24, 167
    s_cselect_b32 s25, 1, 0
    s_mul_i32 s26, s25, 167
    s_sub_u32 s24, s24, s26
    s_cmp_eq_u32 s21, 0
    s_cselect_b32 s25, s25, 1
    s_mul_i32 s26, s25, 16384000
    s_add_u32 s4, s52, s26
    s_addc_u32 s5, s53, 0
    s_and_b32 s5, s5, 0xffff
    s_mov_b32 s6, 16384000
    s_mov_b32 s7, 0x00020000
    s_mov_b32 s8, s54
    s_mov_b32 s9, s55
    s_and_b32 s9, s9, 0xffff
    s_mov_b32 s10, 16252928
    s_mov_b32 s11, 0x00020000
    s_mov_b32 s12, s58
    s_mov_b32 s13, s59
    s_and_b32 s13, s13, 0xffff
    s_mov_b32 s14, 43778048
    s_mov_b32 s15, 0x00020000
    s_add_u32 s16, s58, 50331648
    s_addc_u32 s17, s59, 0
    s_and_b32 s17, s17, 0xffff
    s_mov_b32 s18, 67108864
    s_mov_b32 s19, 0x00020000
    s_add_u32 s60, s58, 153092096
    s_addc_u32 s61, s59, 0
    s_and_b32 s61, s61, 0xffff
    s_mov_b32 s62, 32768
    s_mov_b32 s63, 0x00020000
    s_mov_b32 s28, 0x05040100
    s_mov_b32 s29, 0x07060302
    v_lshlrev_b32 v248, 14, v65
    v_lshl_add_u32 v248, v64, 4, v248
    v_and_b32 v250, 1, v65
    v_lshlrev_b32 v250, 23, v250
    v_lshl_add_u32 v250, v64, 4, v250
    v_lshrrev_b32 v66, 1, v65
    s_mov_b32 s26, 1368064
    v_mul_lo_u32 v66, v66, s26
    v_lshrrev_b32 v67, 2, v64
    s_mov_b32 s26, 21376
    v_mul_lo_u32 v67, v67, s26
    v_add_u32 v66, v66, v67
    v_mov_b32 v252, v66
    v_lshrrev_b32 v66, 1, v65
    s_mov_b32 s26, 2097152
    v_mul_lo_u32 v66, v66, s26
    v_and_b32 v67, 1, v65
    v_lshl_add_u32 v66, v67, 8, v66
    v_and_b32 v67, 1, v64
    v_lshl_add_u32 v251, v67, 4, v66
    s_mul_i32 s31, s25, 684032
    s_mul_i32 s32, s23, 524288
    s_lshl_b32 s33, s23, 8
    s_mov_b32 s40, 3
    s_xor_b32 s43, s40, s20
    s_and_b32 s43, s43, 1
    s_mul_i32 s36, s40, 85
    s_add_u32 s36, s36, s2
    s_and_b32 s36, s36, 255
    s_mul_hi_u32 s37, s36, 0x55555556
    s_mul_i32 s38, s37, 3
    s_cmp_eq_u32 s38, s36
    s_cselect_b32 s27, 1, 0
    s_cmp_lt_u32 s37, 78
    s_cselect_b32 s27, s27, 0
    s_add_u32 s37, s37, 89
    s_cmp_eq_u32 s21, 0
    s_cselect_b32 s30, s24, s37
    s_cselect_b32 s27, 1, s27
    s_cmp_eq_u32 s43, 0
    s_cbranch_scc0 K12_PL1
    s_lshl_b32 s36, s40, 7
    s_add_u32 s36, s36, s22
    s_lshr_b32 s37, s36, 9
    s_lshl_b32 s37, s37, 19
    s_and_b32 s36, s36, 511
    s_lshl_b32 s36, s36, 10
    s_add_u32 s36, s36, s37
    s_add_u32 s36, s36, s33
    buffer_load_dwordx4 v[96:99], v250, s[8:11], s36 offen
    s_add_u32 s36, s36, 0x100000
    buffer_load_dwordx4 v[100:103], v250, s[8:11], s36 offen
    s_add_u32 s36, s36, 0x100000
    buffer_load_dwordx4 v[104:107], v250, s[8:11], s36 offen
    s_add_u32 s36, s36, 0x100000
    buffer_load_dwordx4 v[108:111], v250, s[8:11], s36 offen
    s_add_u32 s36, s36, 0x100000
    buffer_load_dwordx4 v[112:115], v250, s[8:11], s36 offen
    s_add_u32 s36, s36, 0x100000
    buffer_load_dwordx4 v[116:119], v250, s[8:11], s36 offen
    s_add_u32 s36, s36, 0x100000
    buffer_load_dwordx4 v[120:123], v250, s[8:11], s36 offen
    s_add_u32 s36, s36, 0x100000
    buffer_load_dwordx4 v[124:127], v250, s[8:11], s36 offen
    s_branch K12_PL2
K12_PL1:
    s_cmp_eq_u32 s27, 0
    s_cbranch_scc1 K12_PL2
    s_lshl_b32 s36, s40, 8
    s_mul_i32 s37, s30, 98304
    s_add_u32 s36, s36, s37
    buffer_load_dwordx4 v[0:3], v248, s[4:7], s36 offen
    buffer_load_dwordx4 v[4:7], v248, s[4:7], s36 offen offset:2048
    s_add_u32 s36, s36, 4096
    buffer_load_dwordx4 v[8:11], v248, s[4:7], s36 offen
    buffer_load_dwordx4 v[12:15], v248, s[4:7], s36 offen offset:2048
    s_add_u32 s36, s36, 4096
    buffer_load_dwordx4 v[16:19], v248, s[4:7], s36 offen
    buffer_load_dwordx4 v[20:23], v248, s[4:7], s36 offen offset:2048
    s_add_u32 s36, s36, 4096
    buffer_load_dwordx4 v[24:27], v248, s[4:7], s36 offen
    buffer_load_dwordx4 v[28:31], v248, s[4:7], s36 offen offset:2048
    s_add_u32 s36, s36, 53248
    buffer_load_dwordx4 v[32:35], v248, s[4:7], s36 offen
    buffer_load_dwordx4 v[36:39], v248, s[4:7], s36 offen offset:2048
    s_add_u32 s36, s36, 4096
    buffer_load_dwordx4 v[40:43], v248, s[4:7], s36 offen
    buffer_load_dwordx4 v[44:47], v248, s[4:7], s36 offen offset:2048
    s_add_u32 s36, s36, 4096
    buffer_load_dwordx4 v[48:51], v248, s[4:7], s36 offen
    buffer_load_dwordx4 v[52:55], v248, s[4:7], s36 offen offset:2048
    s_add_u32 s36, s36, 4096
    buffer_load_dwordx4 v[56:59], v248, s[4:7], s36 offen
    buffer_load_dwordx4 v[60:63], v248, s[4:7], s36 offen offset:2048
K12_PL2:
    v_and_b32 v128, 3, v64
    v_lshlrev_b32 v128, 2, v128
    v_lshrrev_b32 v130, 3, v64
    v_lshl_add_u32 v128, v130, 1, v128
    s_lshl_b32 s36, s44, 4
    s_add_u32 s36, s36, 1
    v_add_u32 v128, s36, v128
    v_bfe_u32 v129, v64, 2, 1
    v_lshlrev_b32 v131, 3, v65
    v_lshlrev_b32 v132, 5, v129
    v_mad_u32_u24 v133, v128, v131, v132
    v_mad_u32_u24 v136, v128, 0, v133
    v_mad_u32_u24 v137, v128, 1, v133
    v_mad_u32_u24 v138, v128, 2, v133
    v_mad_u32_u24 v139, v128, 3, v133
    v_mad_u32_u24 v140, v128, 4, v133
    v_mad_u32_u24 v141, v128, 5, v133
    v_mad_u32_u24 v142, v128, 6, v133
    v_mad_u32_u24 v143, v128, 7, v133
    v_and_b32 v136, 127, v136
    v_and_b32 v137, 127, v137
    v_and_b32 v138, 127, v138
    v_and_b32 v139, 127, v139
    v_and_b32 v140, 127, v140
    v_and_b32 v141, 127, v141
    v_and_b32 v142, 127, v142
    v_and_b32 v143, 127, v143
    v_cvt_f32_u32 v136, v136
    v_cvt_f32_u32 v137, v137
    v_cvt_f32_u32 v138, v138
    v_cvt_f32_u32 v139, v139
    v_cvt_f32_u32 v140, v140
    v_cvt_f32_u32 v141, v141
    v_cvt_f32_u32 v142, v142
    v_cvt_f32_u32 v143, v143
    v_mul_f32 v136, 0x3c000000, v136
    v_mul_f32 v137, 0x3c000000, v137
    v_mul_f32 v138, 0x3c000000, v138
    v_mul_f32 v139, 0x3c000000, v139
    v_mul_f32 v140, 0x3c000000, v140
    v_mul_f32 v141, 0x3c000000, v141
    v_mul_f32 v142, 0x3c000000, v142
    v_mul_f32 v143, 0x3c000000, v143
    v_cos_f32 v136, v136
    v_cos_f32 v137, v137
    v_cos_f32 v138, v138
    v_cos_f32 v139, v139
    v_cos_f32 v140, v140
    v_cos_f32 v141, v141
    v_cos_f32 v142, v142
    v_cos_f32 v143, v143
    s_nop 0
    v_cvt_pk_bf16_f32 v144, v136, v137
    v_cvt_pk_bf16_f32 v145, v138, v139
    v_cvt_pk_bf16_f32 v146, v140, v141
    v_cvt_pk_bf16_f32 v147, v142, v143
    v_lshlrev_b32 v152, 16, v144
    v_and_b32 v153, 0xffff0000, v144
    v_sub_f32 v136, v136, v152
    v_sub_f32 v137, v137, v153
    v_lshlrev_b32 v152, 16, v145
    v_and_b32 v153, 0xffff0000, v145
    v_sub_f32 v138, v138, v152
    v_sub_f32 v139, v139, v153
    v_lshlrev_b32 v152, 16, v146
    v_and_b32 v153, 0xffff0000, v146
    v_sub_f32 v140, v140, v152
    v_sub_f32 v141, v141, v153
    v_lshlrev_b32 v152, 16, v147
    v_and_b32 v153, 0xffff0000, v147
    v_sub_f32 v142, v142, v152
    v_sub_f32 v143, v143, v153
    v_cvt_pk_bf16_f32 v148, v136, v137
    v_cvt_pk_bf16_f32 v149, v138, v139
    v_cvt_pk_bf16_f32 v150, v140, v141
    v_cvt_pk_bf16_f32 v151, v142, v143
    s_lshl_b32 s37, s44, 12
    s_add_u32 s37, s37, 116736
    v_add_u32 v132, s37, v254
    ds_write_b128 v132, v[144:147]
    ds_write_b128 v132, v[148:151] offset:1024
    v_add_u32 v131, 32, v131
    v_lshlrev_b32 v132, 5, v129
    v_mad_u32_u24 v133, v128, v131, v132
    v_mad_u32_u24 v136, v128, 0, v133
    v_mad_u32_u24 v137, v128, 1, v133
    v_mad_u32_u24 v138, v128, 2, v133
    v_mad_u32_u24 v139, v128, 3, v133
    v_mad_u32_u24 v140, v128, 4, v133
    v_mad_u32_u24 v141, v128, 5, v133
    v_mad_u32_u24 v142, v128, 6, v133
    v_mad_u32_u24 v143, v128, 7, v133
    v_and_b32 v136, 127, v136
    v_and_b32 v137, 127, v137
    v_and_b32 v138, 127, v138
    v_and_b32 v139, 127, v139
    v_and_b32 v140, 127, v140
    v_and_b32 v141, 127, v141
    v_and_b32 v142, 127, v142
    v_and_b32 v143, 127, v143
    v_cvt_f32_u32 v136, v136
    v_cvt_f32_u32 v137, v137
    v_cvt_f32_u32 v138, v138
    v_cvt_f32_u32 v139, v139
    v_cvt_f32_u32 v140, v140
    v_cvt_f32_u32 v141, v141
    v_cvt_f32_u32 v142, v142
    v_cvt_f32_u32 v143, v143
    v_mul_f32 v136, 0x3c000000, v136
    v_mul_f32 v137, 0x3c000000, v137
    v_mul_f32 v138, 0x3c000000, v138
    v_mul_f32 v139, 0x3c000000, v139
    v_mul_f32 v140, 0x3c000000, v140
    v_mul_f32 v141, 0x3c000000, v141
    v_mul_f32 v142, 0x3c000000, v142
    v_mul_f32 v143, 0x3c000000, v143
    v_cos_f32 v136, v136
    v_cos_f32 v137, v137
    v_cos_f32 v138, v138
    v_cos_f32 v139, v139
    v_cos_f32 v140, v140
    v_cos_f32 v141, v141
    v_cos_f32 v142, v142
    v_cos_f32 v143, v143
    s_nop 0
    v_cvt_pk_bf16_f32 v144, v136, v137
    v_cvt_pk_bf16_f32 v145, v138, v139
    v_cvt_pk_bf16_f32 v146, v140, v141
    v_cvt_pk_bf16_f32 v147, v142, v143
    v_lshlrev_b32 v152, 16, v144
    v_and_b32 v153, 0xffff0000, v144
    v_sub_f32 v136, v136, v152
    v_sub_f32 v137, v137, v153
    v_lshlrev_b32 v152, 16, v145
    v_and_b32 v153, 0xffff0000, v145
    v_sub_f32 v138, v138, v152
    v_sub_f32 v139, v139, v153
    v_lshlrev_b32 v152, 16, v146
    v_and_b32 v153, 0xffff0000, v146
    v_sub_f32 v140, v140, v152
    v_sub_f32 v141, v141, v153
    v_lshlrev_b32 v152, 16, v147
    v_and_b32 v153, 0xffff0000, v147
    v_sub_f32 v142, v142, v152
    v_sub_f32 v143, v143, v153
    v_cvt_pk_bf16_f32 v148, v136, v137
    v_cvt_pk_bf16_f32 v149, v138, v139
    v_cvt_pk_bf16_f32 v150, v140, v141
    v_cvt_pk_bf16_f32 v151, v142, v143
    s_lshl_b32 s37, s44, 12
    s_add_u32 s37, s37, 118784
    v_add_u32 v132, s37, v254
    ds_write_b128 v132, v[144:147]
    ds_write_b128 v132, v[148:151] offset:1024
K12_TB:
    s_waitcnt lgkmcnt(0)
    s_barrier
    v_add_u32 v255, 116736, v254
    ds_read_b128 v[160:163], v255 offset:0
    ds_read_b128 v[192:195], v255 offset:1024
    ds_read_b128 v[164:167], v255 offset:2048
    ds_read_b128 v[196:199], v255 offset:3072
    ds_read_b128 v[168:171], v255 offset:4096
    ds_read_b128 v[200:203], v255 offset:5120
    ds_read_b128 v[172:175], v255 offset:6144
    ds_read_b128 v[204:207], v255 offset:7168
    s_waitcnt lgkmcnt(0)
    ds_read_b128 v[176:179], v255 offset:8192
    ds_read_b128 v[208:211], v255 offset:9216
    ds_read_b128 v[180:183], v255 offset:10240
    ds_read_b128 v[212:215], v255 offset:11264
    ds_read_b128 v[184:187], v255 offset:12288
    ds_read_b128 v[216:219], v255 offset:13312
    ds_read_b128 v[188:191], v255 offset:14336
    ds_read_b128 v[220:223], v255 offset:15360
    ds_read_b128 v[224:227], v255 offset:16384
    ds_read_b128 v[228:231], v255 offset:17408
    ds_read_b128 v[232:235], v255 offset:18432
    ds_read_b128 v[236:239], v255 offset:19456
    s_waitcnt lgkmcnt(0)
    s_barrier
    s_waitcnt vmcnt(0) lgkmcnt(0)
    s_mov_b32 s41, -1
    s_mov_b32 s34, -1
    s_branch K12_PROD
    s_cmp_lt_u32 s3, 4
    s_cbranch_scc0 K12_PROD
    s_cmp_eq_u32 s43, 0
    s_cbranch_scc0 K12_H1
    v_perm_b32 v64, v100, v96, s28
    v_perm_b32 v68, v100, v96, s29
    v_perm_b32 v65, v108, v104, s28
    v_perm_b32 v69, v108, v104, s29
    v_perm_b32 v66, v116, v112, s28
    v_perm_b32 v70, v116, v112, s29
    v_perm_b32 v67, v124, v120, s28
    v_perm_b32 v71, v124, v120, s29
    v_perm_b32 v72, v101, v97, s28
    v_perm_b32 v76, v101, v97, s29
    v_perm_b32 v73, v109, v105, s28
    v_perm_b32 v77, v109, v105, s29
    v_perm_b32 v74, v117, v113, s28
    v_perm_b32 v78, v117, v113, s29
    v_perm_b32 v75, v125, v121, s28
    v_perm_b32 v79, v125, v121, s29
    v_perm_b32 v80, v102, v98, s28
    v_perm_b32 v84, v102, v98, s29
    v_perm_b32 v81, v110, v106, s28
    v_perm_b32 v85, v110, v106, s29
    v_perm_b32 v82, v118, v114, s28
    v_perm_b32 v86, v118, v114, s29
    v_perm_b32 v83, v126, v122, s28
    v_perm_b32 v87, v126, v122, s29
    v_perm_b32 v88, v103, v99, s28
    v_perm_b32 v92, v103, v99, s29
    v_perm_b32 v89, v111, v107, s28
    v_perm_b32 v93, v111, v107, s29
    v_perm_b32 v90, v119, v115, s28
    v_perm_b32 v94, v119, v115, s29
    v_perm_b32 v91, v127, v123, s28
    v_perm_b32 v95, v127, v123, s29
    s_lshl_b32 s36, s40, 7
    s_add_u32 s36, s36, s22
    s_and_b32 s37, s36, 3
    s_lshr_b32 s38, s36, 1
    s_and_b32 s38, s38, 4
    s_or_b32 s37, s37, s38
    v_bfe_u32 v253, v254, 5, 3
    v_xor_b32 v253, s37, v253
    v_lshl_add_u32 v253, v253, 5, v251
    s_lshl_b32 s36, s36, 9
    s_add_u32 s39, s36, s32
    s_setprio 1
    v_mfma_f32_16x16x32_bf16 v[128:131], v[224:227], v[64:67], 0
    v_mfma_f32_16x16x32_bf16 v[132:135], v[224:227], v[68:71], 0
    v_mfma_f32_16x16x32_bf16 v[136:139], v[224:227], v[72:75], 0
    v_mfma_f32_16x16x32_bf16 v[140:143], v[224:227], v[76:79], 0
    v_mfma_f32_16x16x32_bf16 v[144:147], v[224:227], v[80:83], 0
    v_mfma_f32_16x16x32_bf16 v[148:151], v[224:227], v[84:87], 0
    v_mfma_f32_16x16x32_bf16 v[152:155], v[224:227], v[88:91], 0
    v_mfma_f32_16x16x32_bf16 v[156:159], v[224:227], v[92:95], 0
    s_setprio 0
    s_nop 7
    v_cvt_pk_bf16_f32 v240, v128, v132
    v_cvt_pk_bf16_f32 v241, v136, v140
    v_cvt_pk_bf16_f32 v242, v144, v148
    v_cvt_pk_bf16_f32 v243, v152, v156
    buffer_store_dwordx4 v[240:243], v253, s[16:19], s39 offen sc1
    s_add_u32 s39, s39, 4194304
    v_cvt_pk_bf16_f32 v244, v129, v133
    v_cvt_pk_bf16_f32 v245, v137, v141
    v_cvt_pk_bf16_f32 v246, v145, v149
    v_cvt_pk_bf16_f32 v247, v153, v157
    buffer_store_dwordx4 v[244:247], v253, s[16:19], s39 offen sc1
    s_add_u32 s39, s39, 4194304
    v_cvt_pk_bf16_f32 v240, v130, v134
    v_cvt_pk_bf16_f32 v241, v138, v142
    v_cvt_pk_bf16_f32 v242, v146, v150
    v_cvt_pk_bf16_f32 v243, v154, v158
    buffer_store_dwordx4 v[240:243], v253, s[16:19], s39 offen sc1
    s_add_u32 s39, s39, 4194304
    v_cvt_pk_bf16_f32 v244, v131, v135
    v_cvt_pk_bf16_f32 v245, v139, v143
    v_cvt_pk_bf16_f32 v246, v147, v151
    v_cvt_pk_bf16_f32 v247, v155, v159
    buffer_store_dwordx4 v[244:247], v253, s[16:19], s39 offen sc1
    s_add_u32 s39, s39, 4194304
    s_setprio 1
    v_mfma_f32_16x16x32_bf16 v[128:131], v[228:231], v[64:67], 0
    v_mfma_f32_16x16x32_bf16 v[132:135], v[228:231], v[68:71], 0
    v_mfma_f32_16x16x32_bf16 v[136:139], v[228:231], v[72:75], 0
    v_mfma_f32_16x16x32_bf16 v[140:143], v[228:231], v[76:79], 0
    v_mfma_f32_16x16x32_bf16 v[144:147], v[228:231], v[80:83], 0
    v_mfma_f32_16x16x32_bf16 v[148:151], v[228:231], v[84:87], 0
    v_mfma_f32_16x16x32_bf16 v[152:155], v[228:231], v[88:91], 0
    v_mfma_f32_16x16x32_bf16 v[156:159], v[228:231], v[92:95], 0
    s_setprio 0
    s_nop 7
    v_cvt_pk_bf16_f32 v240, v128, v132
    v_cvt_pk_bf16_f32 v241, v136, v140
    v_cvt_pk_bf16_f32 v242, v144, v148
    v_cvt_pk_bf16_f32 v243, v152, v156
    buffer_store_dwordx4 v[240:243], v253, s[16:19], s39 offen sc1
    s_add_u32 s39, s39, 4194304
    v_cvt_pk_bf16_f32 v244, v129, v133
    v_cvt_pk_bf16_f32 v245, v137, v141
    v_cvt_pk_bf16_f32 v246, v145, v149
    v_cvt_pk_bf16_f32 v247, v153, v157
    buffer_store_dwordx4 v[244:247], v253, s[16:19], s39 offen sc1
    s_add_u32 s39, s39, 4194304
    v_cvt_pk_bf16_f32 v240, v130, v134
    v_cvt_pk_bf16_f32 v241, v138, v142
    v_cvt_pk_bf16_f32 v242, v146, v150
    v_cvt_pk_bf16_f32 v243, v154, v158
    buffer_store_dwordx4 v[240:243], v253, s[16:19], s39 offen sc1
    s_add_u32 s39, s39, 4194304
    v_cvt_pk_bf16_f32 v244, v131, v135
    v_cvt_pk_bf16_f32 v245, v139, v143
    v_cvt_pk_bf16_f32 v246, v147, v151
    v_cvt_pk_bf16_f32 v247, v155, v159
    buffer_store_dwordx4 v[244:247], v253, s[16:19], s39 offen sc1
    s_add_u32 s39, s39, 4194304
    s_setprio 1
    v_mfma_f32_16x16x32_bf16 v[128:131], v[232:235], v[64:67], 0
    v_mfma_f32_16x16x32_bf16 v[132:135], v[232:235], v[68:71], 0
    v_mfma_f32_16x16x32_bf16 v[136:139], v[232:235], v[72:75], 0
    v_mfma_f32_16x16x32_bf16 v[140:143], v[232:235], v[76:79], 0
    v_mfma_f32_16x16x32_bf16 v[144:147], v[232:235], v[80:83], 0
    v_mfma_f32_16x16x32_bf16 v[148:151], v[232:235], v[84:87], 0
    v_mfma_f32_16x16x32_bf16 v[152:155], v[232:235], v[88:91], 0
    v_mfma_f32_16x16x32_bf16 v[156:159], v[232:235], v[92:95], 0
    s_setprio 0
    s_nop 7
    v_cvt_pk_bf16_f32 v240, v128, v132
    v_cvt_pk_bf16_f32 v241, v136, v140
    v_cvt_pk_bf16_f32 v242, v144, v148
    v_cvt_pk_bf16_f32 v243, v152, v156
    buffer_store_dwordx4 v[240:243], v253, s[16:19], s39 offen sc1
    s_add_u32 s39, s39, 4194304
    v_cvt_pk_bf16_f32 v244, v129, v133
    v_cvt_pk_bf16_f32 v245, v137, v141
    v_cvt_pk_bf16_f32 v246, v145, v149
    v_cvt_pk_bf16_f32 v247, v153, v157
    buffer_store_dwordx4 v[244:247], v253, s[16:19], s39 offen sc1
    s_add_u32 s39, s39, 4194304
    v_cvt_pk_bf16_f32 v240, v130, v134
    v_cvt_pk_bf16_f32 v241, v138, v142
    v_cvt_pk_bf16_f32 v242, v146, v150
    v_cvt_pk_bf16_f32 v243, v154, v158
    buffer_store_dwordx4 v[240:243], v253, s[16:19], s39 offen sc1
    s_add_u32 s39, s39, 4194304
    v_cvt_pk_bf16_f32 v244, v131, v135
    v_cvt_pk_bf16_f32 v245, v139, v143
    v_cvt_pk_bf16_f32 v246, v147, v151
    v_cvt_pk_bf16_f32 v247, v155, v159
    buffer_store_dwordx4 v[244:247], v253, s[16:19], s39 offen sc1
    s_add_u32 s39, s39, 4194304
    s_setprio 1
    v_mfma_f32_16x16x32_bf16 v[128:131], v[236:239], v[64:67], 0
    v_mfma_f32_16x16x32_bf16 v[132:135], v[236:239], v[68:71], 0
    v_mfma_f32_16x16x32_bf16 v[136:139], v[236:239], v[72:75], 0
    v_mfma_f32_16x16x32_bf16 v[140:143], v[236:239], v[76:79], 0
    v_mfma_f32_16x16x32_bf16 v[144:147], v[236:239], v[80:83], 0
    v_mfma_f32_16x16x32_bf16 v[148:151], v[236:239], v[84:87], 0
    v_mfma_f32_16x16x32_bf16 v[152:155], v[236:239], v[88:91], 0
    v_mfma_f32_16x16x32_bf16 v[156:159], v[236:239], v[92:95], 0
    s_setprio 0
    s_nop 7
    v_cvt_pk_bf16_f32 v240, v128, v132
    v_cvt_pk_bf16_f32 v241, v136, v140
    v_cvt_pk_bf16_f32 v242, v144, v148
    v_cvt_pk_bf16_f32 v243, v152, v156
    buffer_store_dwordx4 v[240:243], v253, s[16:19], s39 offen sc1
    s_add_u32 s39, s39, 4194304
    v_cvt_pk_bf16_f32 v244, v129, v133
    v_cvt_pk_bf16_f32 v245, v137, v141
    v_cvt_pk_bf16_f32 v246, v145, v149
    v_cvt_pk_bf16_f32 v247, v153, v157
    buffer_store_dwordx4 v[244:247], v253, s[16:19], s39 offen sc1
    s_add_u32 s39, s39, 4194304
    v_cvt_pk_bf16_f32 v240, v130, v134
    v_cvt_pk_bf16_f32 v241, v138, v142
    v_cvt_pk_bf16_f32 v242, v146, v150
    v_cvt_pk_bf16_f32 v243, v154, v158
    buffer_store_dwordx4 v[240:243], v253, s[16:19], s39 offen sc1
    s_add_u32 s39, s39, 4194304
    v_cvt_pk_bf16_f32 v244, v131, v135
    v_cvt_pk_bf16_f32 v245, v139, v143
    v_cvt_pk_bf16_f32 v246, v147, v151
    v_cvt_pk_bf16_f32 v247, v155, v159
    buffer_store_dwordx4 v[244:247], v253, s[16:19], s39 offen sc1
    s_branch K12_H2
K12_H1:
    s_cmp_eq_u32 s27, 0
    s_cbranch_scc1 K12_H2
    v_perm_b32 v64, v4, v0, s28
    v_perm_b32 v68, v4, v0, s29
    v_perm_b32 v65, v12, v8, s28
    v_perm_b32 v69, v12, v8, s29
    v_perm_b32 v66, v20, v16, s28
    v_perm_b32 v70, v20, v16, s29
    v_perm_b32 v67, v28, v24, s28
    v_perm_b32 v71, v28, v24, s29
    v_perm_b32 v72, v5, v1, s28
    v_perm_b32 v76, v5, v1, s29
    v_perm_b32 v73, v13, v9, s28
    v_perm_b32 v77, v13, v9, s29
    v_perm_b32 v74, v21, v17, s28
    v_perm_b32 v78, v21, v17, s29
    v_perm_b32 v75, v29, v25, s28
    v_perm_b32 v79, v29, v25, s29
    v_perm_b32 v80, v6, v2, s28
    v_perm_b32 v84, v6, v2, s29
    v_perm_b32 v81, v14, v10, s28
    v_perm_b32 v85, v14, v10, s29
    v_perm_b32 v82, v22, v18, s28
    v_perm_b32 v86, v22, v18, s29
    v_perm_b32 v83, v30, v26, s28
    v_perm_b32 v87, v30, v26, s29
    v_perm_b32 v88, v7, v3, s28
    v_perm_b32 v92, v7, v3, s29
    v_perm_b32 v89, v15, v11, s28
    v_perm_b32 v93, v15, v11, s29
    v_perm_b32 v90, v23, v19, s28
    v_perm_b32 v94, v23, v19, s29
    v_perm_b32 v91, v31, v27, s28
    v_perm_b32 v95, v31, v27, s29
    v_perm_b32 v0, v36, v32, s28
    v_perm_b32 v4, v36, v32, s29
    v_perm_b32 v1, v44, v40, s28
    v_perm_b32 v5, v44, v40, s29
    v_perm_b32 v2, v52, v48, s28
    v_perm_b32 v6, v52, v48, s29
    v_perm_b32 v3, v60, v56, s28
    v_perm_b32 v7, v60, v56, s29
    v_perm_b32 v8, v37, v33, s28
    v_perm_b32 v12, v37, v33, s29
    v_perm_b32 v9, v45, v41, s28
    v_perm_b32 v13, v45, v41, s29
    v_perm_b32 v10, v53, v49, s28
    v_perm_b32 v14, v53, v49, s29
    v_perm_b32 v11, v61, v57, s28
    v_perm_b32 v15, v61, v57, s29
    v_perm_b32 v16, v38, v34, s28
    v_perm_b32 v20, v38, v34, s29
    v_perm_b32 v17, v46, v42, s28
    v_perm_b32 v21, v46, v42, s29
    v_perm_b32 v18, v54, v50, s28
    v_perm_b32 v22, v54, v50, s29
    v_perm_b32 v19, v62, v58, s28
    v_perm_b32 v23, v62, v58, s29
    v_perm_b32 v24, v39, v35, s28
    v_perm_b32 v28, v39, v35, s29
    v_perm_b32 v25, v47, v43, s28
    v_perm_b32 v29, v47, v43, s29
    v_perm_b32 v26, v55, v51, s28
    v_perm_b32 v30, v55, v51, s29
    v_perm_b32 v27, v63, v59, s28
    v_perm_b32 v31, v63, v59, s29
    s_mul_i32 s39, s40, 85504
    s_add_u32 s39, s39, s31
    s_lshl_b32 s36, s30, 7
    s_add_u32 s39, s39, s36
    v_bfe_u32 v249, v254, 4, 2
    v_bfe_u32 v240, v254, 8, 1
    v_lshl_add_u32 v249, v240, 2, v249
    s_add_u32 s36, s30, 7
    s_cmp_ge_u32 s30, 160
    s_cselect_b32 s36, s36, s30
    s_cmp_eq_u32 s25, 1
    s_cselect_b32 s36, s36, s30
    s_lshr_b32 s36, s36, 1
    s_and_b32 s36, s36, 7
    v_xor_b32 v249, s36, v249
    v_lshl_add_u32 v249, v249, 4, v252
    s_setprio 1
    v_mfma_f32_16x16x32_bf16 v[32:35], v[160:163], v[64:67], 0
    v_mfma_f32_16x16x32_bf16 v[36:39], v[160:163], v[68:71], 0
    v_mfma_f32_16x16x32_bf16 v[40:43], v[160:163], v[72:75], 0
    v_mfma_f32_16x16x32_bf16 v[44:47], v[160:163], v[76:79], 0
    v_mfma_f32_16x16x32_bf16 v[48:51], v[160:163], v[80:83], 0
    v_mfma_f32_16x16x32_bf16 v[52:55], v[160:163], v[84:87], 0
    v_mfma_f32_16x16x32_bf16 v[56:59], v[160:163], v[88:91], 0
    v_mfma_f32_16x16x32_bf16 v[60:63], v[160:163], v[92:95], 0
    v_mfma_f32_16x16x32_bf16 v[32:35], v[192:195], v[64:67], v[32:35]
    v_mfma_f32_16x16x32_bf16 v[36:39], v[192:195], v[68:71], v[36:39]
    v_mfma_f32_16x16x32_bf16 v[40:43], v[192:195], v[72:75], v[40:43]
    v_mfma_f32_16x16x32_bf16 v[44:47], v[192:195], v[76:79], v[44:47]
    v_mfma_f32_16x16x32_bf16 v[48:51], v[192:195], v[80:83], v[48:51]
    v_mfma_f32_16x16x32_bf16 v[52:55], v[192:195], v[84:87], v[52:55]
    v_mfma_f32_16x16x32_bf16 v[56:59], v[192:195], v[88:91], v[56:59]
    v_mfma_f32_16x16x32_bf16 v[60:63], v[192:195], v[92:95], v[60:63]
    v_mfma_f32_16x16x32_bf16 v[32:35], v[164:167], v[0:3], v[32:35]
    v_mfma_f32_16x16x32_bf16 v[36:39], v[164:167], v[4:7], v[36:39]
    v_mfma_f32_16x16x32_bf16 v[40:43], v[164:167], v[8:11], v[40:43]
    v_mfma_f32_16x16x32_bf16 v[44:47], v[164:167], v[12:15], v[44:47]
    v_mfma_f32_16x16x32_bf16 v[48:51], v[164:167], v[16:19], v[48:51]
    v_mfma_f32_16x16x32_bf16 v[52:55], v[164:167], v[20:23], v[52:55]
    v_mfma_f32_16x16x32_bf16 v[56:59], v[164:167], v[24:27], v[56:59]
    v_mfma_f32_16x16x32_bf16 v[60:63], v[164:167], v[28:31], v[60:63]
    v_mfma_f32_16x16x32_bf16 v[32:35], v[196:199], v[0:3], v[32:35]
    v_mfma_f32_16x16x32_bf16 v[36:39], v[196:199], v[4:7], v[36:39]
    v_mfma_f32_16x16x32_bf16 v[40:43], v[196:199], v[8:11], v[40:43]
    v_mfma_f32_16x16x32_bf16 v[44:47], v[196:199], v[12:15], v[44:47]
    v_mfma_f32_16x16x32_bf16 v[48:51], v[196:199], v[16:19], v[48:51]
    v_mfma_f32_16x16x32_bf16 v[52:55], v[196:199], v[20:23], v[52:55]
    v_mfma_f32_16x16x32_bf16 v[56:59], v[196:199], v[24:27], v[56:59]
    v_mfma_f32_16x16x32_bf16 v[60:63], v[196:199], v[28:31], v[60:63]
    s_setprio 0
    s_nop 7
    v_cvt_pk_bf16_f32 v240, v32, v36
    v_cvt_pk_bf16_f32 v241, v40, v44
    v_cvt_pk_bf16_f32 v242, v48, v52
    v_cvt_pk_bf16_f32 v243, v56, v60
    buffer_store_dwordx4 v[240:243], v249, s[12:15], s39 offen sc1
    s_add_u32 s39, s39, 2736128
    v_cvt_pk_bf16_f32 v244, v33, v37
    v_cvt_pk_bf16_f32 v245, v41, v45
    v_cvt_pk_bf16_f32 v246, v49, v53
    v_cvt_pk_bf16_f32 v247, v57, v61
    buffer_store_dwordx4 v[244:247], v249, s[12:15], s39 offen sc1
    s_add_u32 s39, s39, 2736128
    v_cvt_pk_bf16_f32 v240, v34, v38
    v_cvt_pk_bf16_f32 v241, v42, v46
    v_cvt_pk_bf16_f32 v242, v50, v54
    v_cvt_pk_bf16_f32 v243, v58, v62
    buffer_store_dwordx4 v[240:243], v249, s[12:15], s39 offen sc1
    s_add_u32 s39, s39, 2736128
    v_cvt_pk_bf16_f32 v244, v35, v39
    v_cvt_pk_bf16_f32 v245, v43, v47
    v_cvt_pk_bf16_f32 v246, v51, v55
    v_cvt_pk_bf16_f32 v247, v59, v63
    buffer_store_dwordx4 v[244:247], v249, s[12:15], s39 offen sc1
    s_add_u32 s39, s39, 2736128
    s_setprio 1
    v_mfma_f32_16x16x32_bf16 v[32:35], v[168:171], v[64:67], 0
    v_mfma_f32_16x16x32_bf16 v[36:39], v[168:171], v[68:71], 0
    v_mfma_f32_16x16x32_bf16 v[40:43], v[168:171], v[72:75], 0
    v_mfma_f32_16x16x32_bf16 v[44:47], v[168:171], v[76:79], 0
    v_mfma_f32_16x16x32_bf16 v[48:51], v[168:171], v[80:83], 0
    v_mfma_f32_16x16x32_bf16 v[52:55], v[168:171], v[84:87], 0
    v_mfma_f32_16x16x32_bf16 v[56:59], v[168:171], v[88:91], 0
    v_mfma_f32_16x16x32_bf16 v[60:63], v[168:171], v[92:95], 0
    v_mfma_f32_16x16x32_bf16 v[32:35], v[200:203], v[64:67], v[32:35]
    v_mfma_f32_16x16x32_bf16 v[36:39], v[200:203], v[68:71], v[36:39]
    v_mfma_f32_16x16x32_bf16 v[40:43], v[200:203], v[72:75], v[40:43]
    v_mfma_f32_16x16x32_bf16 v[44:47], v[200:203], v[76:79], v[44:47]
    v_mfma_f32_16x16x32_bf16 v[48:51], v[200:203], v[80:83], v[48:51]
    v_mfma_f32_16x16x32_bf16 v[52:55], v[200:203], v[84:87], v[52:55]
    v_mfma_f32_16x16x32_bf16 v[56:59], v[200:203], v[88:91], v[56:59]
    v_mfma_f32_16x16x32_bf16 v[60:63], v[200:203], v[92:95], v[60:63]
    v_mfma_f32_16x16x32_bf16 v[32:35], v[172:175], v[0:3], v[32:35]
    v_mfma_f32_16x16x32_bf16 v[36:39], v[172:175], v[4:7], v[36:39]
    v_mfma_f32_16x16x32_bf16 v[40:43], v[172:175], v[8:11], v[40:43]
    v_mfma_f32_16x16x32_bf16 v[44:47], v[172:175], v[12:15], v[44:47]
    v_mfma_f32_16x16x32_bf16 v[48:51], v[172:175], v[16:19], v[48:51]
    v_mfma_f32_16x16x32_bf16 v[52:55], v[172:175], v[20:23], v[52:55]
    v_mfma_f32_16x16x32_bf16 v[56:59], v[172:175], v[24:27], v[56:59]
    v_mfma_f32_16x16x32_bf16 v[60:63], v[172:175], v[28:31], v[60:63]
    v_mfma_f32_16x16x32_bf16 v[32:35], v[204:207], v[0:3], v[32:35]
    v_mfma_f32_16x16x32_bf16 v[36:39], v[204:207], v[4:7], v[36:39]
    v_mfma_f32_16x16x32_bf16 v[40:43], v[204:207], v[8:11], v[40:43]
    v_mfma_f32_16x16x32_bf16 v[44:47], v[204:207], v[12:15], v[44:47]
    v_mfma_f32_16x16x32_bf16 v[48:51], v[204:207], v[16:19], v[48:51]
    v_mfma_f32_16x16x32_bf16 v[52:55], v[204:207], v[20:23], v[52:55]
    v_mfma_f32_16x16x32_bf16 v[56:59], v[204:207], v[24:27], v[56:59]
    v_mfma_f32_16x16x32_bf16 v[60:63], v[204:207], v[28:31], v[60:63]
    s_setprio 0
    s_nop 7
    v_cvt_pk_bf16_f32 v240, v32, v36
    v_cvt_pk_bf16_f32 v241, v40, v44
    v_cvt_pk_bf16_f32 v242, v48, v52
    v_cvt_pk_bf16_f32 v243, v56, v60
    buffer_store_dwordx4 v[240:243], v249, s[12:15], s39 offen sc1
    s_add_u32 s39, s39, 2736128
    v_cvt_pk_bf16_f32 v244, v33, v37
    v_cvt_pk_bf16_f32 v245, v41, v45
    v_cvt_pk_bf16_f32 v246, v49, v53
    v_cvt_pk_bf16_f32 v247, v57, v61
    buffer_store_dwordx4 v[244:247], v249, s[12:15], s39 offen sc1
    s_add_u32 s39, s39, 2736128
    v_cvt_pk_bf16_f32 v240, v34, v38
    v_cvt_pk_bf16_f32 v241, v42, v46
    v_cvt_pk_bf16_f32 v242, v50, v54
    v_cvt_pk_bf16_f32 v243, v58, v62
    buffer_store_dwordx4 v[240:243], v249, s[12:15], s39 offen sc1
    s_add_u32 s39, s39, 2736128
    v_cvt_pk_bf16_f32 v244, v35, v39
    v_cvt_pk_bf16_f32 v245, v43, v47
    v_cvt_pk_bf16_f32 v246, v51, v55
    v_cvt_pk_bf16_f32 v247, v59, v63
    buffer_store_dwordx4 v[244:247], v249, s[12:15], s39 offen sc1
    s_add_u32 s39, s39, 2736128
    s_setprio 1
    v_mfma_f32_16x16x32_bf16 v[32:35], v[176:179], v[64:67], 0
    v_mfma_f32_16x16x32_bf16 v[36:39], v[176:179], v[68:71], 0
    v_mfma_f32_16x16x32_bf16 v[40:43], v[176:179], v[72:75], 0
    v_mfma_f32_16x16x32_bf16 v[44:47], v[176:179], v[76:79], 0
    v_mfma_f32_16x16x32_bf16 v[48:51], v[176:179], v[80:83], 0
    v_mfma_f32_16x16x32_bf16 v[52:55], v[176:179], v[84:87], 0
    v_mfma_f32_16x16x32_bf16 v[56:59], v[176:179], v[88:91], 0
    v_mfma_f32_16x16x32_bf16 v[60:63], v[176:179], v[92:95], 0
    v_mfma_f32_16x16x32_bf16 v[32:35], v[208:211], v[64:67], v[32:35]
    v_mfma_f32_16x16x32_bf16 v[36:39], v[208:211], v[68:71], v[36:39]
    v_mfma_f32_16x16x32_bf16 v[40:43], v[208:211], v[72:75], v[40:43]
    v_mfma_f32_16x16x32_bf16 v[44:47], v[208:211], v[76:79], v[44:47]
    v_mfma_f32_16x16x32_bf16 v[48:51], v[208:211], v[80:83], v[48:51]
    v_mfma_f32_16x16x32_bf16 v[52:55], v[208:211], v[84:87], v[52:55]
    v_mfma_f32_16x16x32_bf16 v[56:59], v[208:211], v[88:91], v[56:59]
    v_mfma_f32_16x16x32_bf16 v[60:63], v[208:211], v[92:95], v[60:63]
    v_mfma_f32_16x16x32_bf16 v[32:35], v[180:183], v[0:3], v[32:35]
    v_mfma_f32_16x16x32_bf16 v[36:39], v[180:183], v[4:7], v[36:39]
    v_mfma_f32_16x16x32_bf16 v[40:43], v[180:183], v[8:11], v[40:43]
    v_mfma_f32_16x16x32_bf16 v[44:47], v[180:183], v[12:15], v[44:47]
    v_mfma_f32_16x16x32_bf16 v[48:51], v[180:183], v[16:19], v[48:51]
    v_mfma_f32_16x16x32_bf16 v[52:55], v[180:183], v[20:23], v[52:55]
    v_mfma_f32_16x16x32_bf16 v[56:59], v[180:183], v[24:27], v[56:59]
    v_mfma_f32_16x16x32_bf16 v[60:63], v[180:183], v[28:31], v[60:63]
    v_mfma_f32_16x16x32_bf16 v[32:35], v[212:215], v[0:3], v[32:35]
    v_mfma_f32_16x16x32_bf16 v[36:39], v[212:215], v[4:7], v[36:39]
    v_mfma_f32_16x16x32_bf16 v[40:43], v[212:215], v[8:11], v[40:43]
    v_mfma_f32_16x16x32_bf16 v[44:47], v[212:215], v[12:15], v[44:47]
    v_mfma_f32_16x16x32_bf16 v[48:51], v[212:215], v[16:19], v[48:51]
    v_mfma_f32_16x16x32_bf16 v[52:55], v[212:215], v[20:23], v[52:55]
    v_mfma_f32_16x16x32_bf16 v[56:59], v[212:215], v[24:27], v[56:59]
    v_mfma_f32_16x16x32_bf16 v[60:63], v[212:215], v[28:31], v[60:63]
    s_setprio 0
    s_nop 7
    v_cvt_pk_bf16_f32 v240, v32, v36
    v_cvt_pk_bf16_f32 v241, v40, v44
    v_cvt_pk_bf16_f32 v242, v48, v52
    v_cvt_pk_bf16_f32 v243, v56, v60
    buffer_store_dwordx4 v[240:243], v249, s[12:15], s39 offen sc1
    s_add_u32 s39, s39, 2736128
    v_cvt_pk_bf16_f32 v244, v33, v37
    v_cvt_pk_bf16_f32 v245, v41, v45
    v_cvt_pk_bf16_f32 v246, v49, v53
    v_cvt_pk_bf16_f32 v247, v57, v61
    buffer_store_dwordx4 v[244:247], v249, s[12:15], s39 offen sc1
    s_add_u32 s39, s39, 2736128
    v_cvt_pk_bf16_f32 v240, v34, v38
    v_cvt_pk_bf16_f32 v241, v42, v46
    v_cvt_pk_bf16_f32 v242, v50, v54
    v_cvt_pk_bf16_f32 v243, v58, v62
    buffer_store_dwordx4 v[240:243], v249, s[12:15], s39 offen sc1
    s_add_u32 s39, s39, 2736128
    v_cvt_pk_bf16_f32 v244, v35, v39
    v_cvt_pk_bf16_f32 v245, v43, v47
    v_cvt_pk_bf16_f32 v246, v51, v55
    v_cvt_pk_bf16_f32 v247, v59, v63
    buffer_store_dwordx4 v[244:247], v249, s[12:15], s39 offen sc1
    s_add_u32 s39, s39, 2736128
    s_setprio 1
    v_mfma_f32_16x16x32_bf16 v[32:35], v[184:187], v[64:67], 0
    v_mfma_f32_16x16x32_bf16 v[36:39], v[184:187], v[68:71], 0
    v_mfma_f32_16x16x32_bf16 v[40:43], v[184:187], v[72:75], 0
    v_mfma_f32_16x16x32_bf16 v[44:47], v[184:187], v[76:79], 0
    v_mfma_f32_16x16x32_bf16 v[48:51], v[184:187], v[80:83], 0
    v_mfma_f32_16x16x32_bf16 v[52:55], v[184:187], v[84:87], 0
    v_mfma_f32_16x16x32_bf16 v[56:59], v[184:187], v[88:91], 0
    v_mfma_f32_16x16x32_bf16 v[60:63], v[184:187], v[92:95], 0
    v_mfma_f32_16x16x32_bf16 v[32:35], v[216:219], v[64:67], v[32:35]
    v_mfma_f32_16x16x32_bf16 v[36:39], v[216:219], v[68:71], v[36:39]
    v_mfma_f32_16x16x32_bf16 v[40:43], v[216:219], v[72:75], v[40:43]
    v_mfma_f32_16x16x32_bf16 v[44:47], v[216:219], v[76:79], v[44:47]
    v_mfma_f32_16x16x32_bf16 v[48:51], v[216:219], v[80:83], v[48:51]
    v_mfma_f32_16x16x32_bf16 v[52:55], v[216:219], v[84:87], v[52:55]
    v_mfma_f32_16x16x32_bf16 v[56:59], v[216:219], v[88:91], v[56:59]
    v_mfma_f32_16x16x32_bf16 v[60:63], v[216:219], v[92:95], v[60:63]
    v_mfma_f32_16x16x32_bf16 v[32:35], v[188:191], v[0:3], v[32:35]
    v_mfma_f32_16x16x32_bf16 v[36:39], v[188:191], v[4:7], v[36:39]
    v_mfma_f32_16x16x32_bf16 v[40:43], v[188:191], v[8:11], v[40:43]
    v_mfma_f32_16x16x32_bf16 v[44:47], v[188:191], v[12:15], v[44:47]
    v_mfma_f32_16x16x32_bf16 v[48:51], v[188:191], v[16:19], v[48:51]
    v_mfma_f32_16x16x32_bf16 v[52:55], v[188:191], v[20:23], v[52:55]
    v_mfma_f32_16x16x32_bf16 v[56:59], v[188:191], v[24:27], v[56:59]
    v_mfma_f32_16x16x32_bf16 v[60:63], v[188:191], v[28:31], v[60:63]
    v_mfma_f32_16x16x32_bf16 v[32:35], v[220:223], v[0:3], v[32:35]
    v_mfma_f32_16x16x32_bf16 v[36:39], v[220:223], v[4:7], v[36:39]
    v_mfma_f32_16x16x32_bf16 v[40:43], v[220:223], v[8:11], v[40:43]
    v_mfma_f32_16x16x32_bf16 v[44:47], v[220:223], v[12:15], v[44:47]
    v_mfma_f32_16x16x32_bf16 v[48:51], v[220:223], v[16:19], v[48:51]
    v_mfma_f32_16x16x32_bf16 v[52:55], v[220:223], v[20:23], v[52:55]
    v_mfma_f32_16x16x32_bf16 v[56:59], v[220:223], v[24:27], v[56:59]
    v_mfma_f32_16x16x32_bf16 v[60:63], v[220:223], v[28:31], v[60:63]
    s_setprio 0
    s_nop 7
    v_cvt_pk_bf16_f32 v240, v32, v36
    v_cvt_pk_bf16_f32 v241, v40, v44
    v_cvt_pk_bf16_f32 v242, v48, v52
    v_cvt_pk_bf16_f32 v243, v56, v60
    buffer_store_dwordx4 v[240:243], v249, s[12:15], s39 offen sc1
    s_add_u32 s39, s39, 2736128
    v_cvt_pk_bf16_f32 v244, v33, v37
    v_cvt_pk_bf16_f32 v245, v41, v45
    v_cvt_pk_bf16_f32 v246, v49, v53
    v_cvt_pk_bf16_f32 v247, v57, v61
    buffer_store_dwordx4 v[244:247], v249, s[12:15], s39 offen sc1
    s_add_u32 s39, s39, 2736128
    v_cvt_pk_bf16_f32 v240, v34, v38
    v_cvt_pk_bf16_f32 v241, v42, v46
    v_cvt_pk_bf16_f32 v242, v50, v54
    v_cvt_pk_bf16_f32 v243, v58, v62
    buffer_store_dwordx4 v[240:243], v249, s[12:15], s39 offen sc1
    s_add_u32 s39, s39, 2736128
    v_cvt_pk_bf16_f32 v244, v35, v39
    v_cvt_pk_bf16_f32 v245, v43, v47
    v_cvt_pk_bf16_f32 v246, v51, v55
    v_cvt_pk_bf16_f32 v247, v59, v63
    buffer_store_dwordx4 v[244:247], v249, s[12:15], s39 offen sc1
K12_H2:
    s_mov_b64 exec, 1
    v_mov_b32 v255, 155664
    v_mov_b32 v64, 1
    ds_add_u32 v255, v64
    s_mov_b64 exec, -1
    s_waitcnt vmcnt(0)
    s_mov_b32 s41, 0
    s_mov_b32 s34, -1
    s_cmp_ge_u32 s41, 8
    s_cbranch_scc1 K12_SG0
    s_lshl_b32 s36, s41, 2
    s_add_u32 s37, s36, 155680
    s_mov_b64 exec, 1
    v_mov_b32 v255, s37
    v_mov_b32 v240, 1
    ds_add_rtn_u32 v240, v255, v240
    s_waitcnt lgkmcnt(0)
    v_readfirstlane_b32 s37, v240
    s_nop 3
    s_cmp_eq_u32 s37, 3
    s_cbranch_scc0 K12_SH0
    s_lshl_b32 s36, s36, 8
    v_mov_b32 v255, 1
    v_mov_b32 v240, s36
    buffer_atomic_add v255, v240, s[60:63], 0 offen sc0 sc1
    s_mov_b32 s34, s41
K12_SH0:
    s_mov_b64 exec, -1
K12_SG0:
    s_waitcnt vmcnt(0)
    s_cmp_ge_u32 s34, 8
    s_cbranch_scc1 K12_PB1
    v_readfirstlane_b32 s37, v255
    s_nop 3
    s_cmp_eq_u32 s37, 255
    s_cbranch_scc0 K12_PB1
    s_lshl_b32 s36, s34, 4
    s_add_u32 s36, s36, 16384
    s_mov_b64 exec, 1
    v_mov_b32 v255, 1
    v_mov_b32 v240, s36
    buffer_store_dword v255, v240, s[60:63], 0 offen sc1
    s_mov_b64 exec, -1
K12_PB1:
    s_branch K12_CONS
K12_PROD:
    s_mov_b32 s37, 131072
K12_TW:
    v_mov_b32 v240, 155648
    ds_read_b32 v240, v240
    s_waitcnt lgkmcnt(0)
    v_cmp_gt_u32 vcc, 2, v240
    s_sub_u32 s37, s37, 1
    s_cmp_eq_u32 s37, 0
    s_cbranch_scc1 K12_TX
    s_cbranch_vccz K12_TX
    s_sleep 2
    s_branch K12_TW
K12_TX:
    v_lshrrev_b32 v128, 4, v254
    v_lshlrev_b32 v129, 11, v128
    v_lshrrev_b32 v130, 1, v128
    v_lshlrev_b32 v130, 20, v130
    v_and_b32 v131, 1, v128
    v_lshl_add_u32 v130, v131, 7, v130
    s_mov_b32 s45, s27
    s_mov_b32 s46, s30
    s_add_u32 s47, s40, 1
K12_TCH0:
    s_xor_b32 s48, s47, s20
    s_and_b32 s48, s48, 1
    s_cmp_eq_u32 s48, 0
    s_cbranch_scc1 K12_TCHW0
    s_mul_i32 s36, s47, 85
    s_add_u32 s36, s36, s2
    s_and_b32 s36, s36, 255
    s_mul_hi_u32 s37, s36, 0x55555556
    s_mul_i32 s38, s37, 3
    s_cmp_eq_u32 s38, s36
    s_cselect_b32 s27, 1, 0
    s_cmp_lt_u32 s37, 78
    s_cselect_b32 s27, s27, 0
    s_add_u32 s37, s37, 89
    s_cmp_eq_u32 s21, 0
    s_cselect_b32 s30, s24, s37
    s_cselect_b32 s27, 1, s27
    s_cmp_eq_u32 s27, 0
    s_cbranch_scc1 K12_TCHN0
    s_lshl_b32 s36, s47, 8
    s_mul_i32 s37, s30, 98304
    s_add_u32 s36, s36, s37
    buffer_load_dword v244, v129, s[4:7], s36 offen
    buffer_load_dword v245, v129, s[4:7], s36 offen offset:128
    s_branch K12_TCHN0
K12_TCHW0:
    s_lshl_b32 s36, s47, 7
    s_add_u32 s36, s36, s22
    s_lshr_b32 s37, s36, 9
    s_lshl_b32 s37, s37, 19
    s_and_b32 s36, s36, 511
    s_lshl_b32 s36, s36, 10
    s_add_u32 s36, s36, s37
    s_add_u32 s36, s36, s33
    s_mov_b64 exec, 0xffffffff
    buffer_load_dword v246, v130, s[8:11], s36 offen
    s_mov_b64 exec, -1
K12_TCHN0:
    s_add_u32 s47, s47, 1
    s_cmp_lt_u32 s47, 8
    s_cbranch_scc1 K12_TCH0
    s_mov_b32 s27, s45
    s_mov_b32 s30, s46
    s_cmp_eq_u32 s43, 0
    s_cbranch_scc1 K12_WENTRY
K12_XW:
    s_waitcnt vmcnt(0)
    s_mov_b32 s34, -1
    s_cmp_ge_u32 s41, 8
    s_cbranch_scc1 K12_SG2
    s_lshl_b32 s36, s41, 2
    s_add_u32 s37, s36, 155680
    s_mov_b64 exec, 1
    v_mov_b32 v255, s37
    v_mov_b32 v240, 1
    ds_add_rtn_u32 v240, v255, v240
    s_waitcnt lgkmcnt(0)
    v_readfirstlane_b32 s37, v240
    s_nop 3
    s_cmp_eq_u32 s37, 3
    s_cbranch_scc0 K12_SH2
    s_lshl_b32 s36, s36, 8
    v_mov_b32 v255, 1
    v_mov_b32 v240, s36
    buffer_atomic_add v255, v240, s[60:63], 0 offen sc0 sc1
    s_mov_b32 s34, s41
K12_SH2:
    s_mov_b64 exec, -1
K12_SG2:
    s_cmp_ge_u32 s34, 8
    s_cbranch_scc1 K12_EP3
    s_waitcnt vmcnt(0)
    s_cmp_ge_u32 s34, 8
    s_cbranch_scc1 K12_PB4
    v_readfirstlane_b32 s37, v255
    s_nop 3
    s_cmp_eq_u32 s37, 255
    s_cbranch_scc0 K12_PB4
    s_lshl_b32 s36, s34, 4
    s_add_u32 s36, s36, 16384
    s_mov_b64 exec, 1
    v_mov_b32 v255, 1
    v_mov_b32 v240, s36
    buffer_store_dword v255, v240, s[60:63], 0 offen sc1
    s_mov_b64 exec, -1
K12_PB4:
    s_mov_b32 s34, -1
K12_EP3:
    s_cmp_eq_u32 s27, 0
    s_cbranch_scc1 K12_XP_N
    v_perm_b32 v64, v4, v0, s28
    v_perm_b32 v68, v4, v0, s29
    v_perm_b32 v65, v12, v8, s28
    v_perm_b32 v69, v12, v8, s29
    v_perm_b32 v66, v20, v16, s28
    v_perm_b32 v70, v20, v16, s29
    v_perm_b32 v67, v28, v24, s28
    v_perm_b32 v71, v28, v24, s29
    v_perm_b32 v72, v5, v1, s28
    v_perm_b32 v76, v5, v1, s29
    v_perm_b32 v73, v13, v9, s28
    v_perm_b32 v77, v13, v9, s29
    v_perm_b32 v74, v21, v17, s28
    v_perm_b32 v78, v21, v17, s29
    v_perm_b32 v75, v29, v25, s28
    v_perm_b32 v79, v29, v25, s29
    v_perm_b32 v80, v6, v2, s28
    v_perm_b32 v84, v6, v2, s29
    v_perm_b32 v81, v14, v10, s28
    v_perm_b32 v85, v14, v10, s29
    v_perm_b32 v82, v22, v18, s28
    v_perm_b32 v86, v22, v18, s29
    v_perm_b32 v83, v30, v26, s28
    v_perm_b32 v87, v30, v26, s29
    v_perm_b32 v88, v7, v3, s28
    v_perm_b32 v92, v7, v3, s29
    v_perm_b32 v89, v15, v11, s28
    v_perm_b32 v93, v15, v11, s29
    v_perm_b32 v90, v23, v19, s28
    v_perm_b32 v94, v23, v19, s29
    v_perm_b32 v91, v31, v27, s28
    v_perm_b32 v95, v31, v27, s29
    v_perm_b32 v0, v36, v32, s28
    v_perm_b32 v4, v36, v32, s29
    v_perm_b32 v1, v44, v40, s28
    v_perm_b32 v5, v44, v40, s29
    v_perm_b32 v2, v52, v48, s28
    v_perm_b32 v6, v52, v48, s29
    v_perm_b32 v3, v60, v56, s28
    v_perm_b32 v7, v60, v56, s29
    v_perm_b32 v8, v37, v33, s28
    v_perm_b32 v12, v37, v33, s29
    v_perm_b32 v9, v45, v41, s28
    v_perm_b32 v13, v45, v41, s29
    v_perm_b32 v10, v53, v49, s28
    v_perm_b32 v14, v53, v49, s29
    v_perm_b32 v11, v61, v57, s28
    v_perm_b32 v15, v61, v57, s29
    v_perm_b32 v16, v38, v34, s28
    v_perm_b32 v20, v38, v34, s29
    v_perm_b32 v17, v46, v42, s28
    v_perm_b32 v21, v46, v42, s29
    v_perm_b32 v18, v54, v50, s28
    v_perm_b32 v22, v54, v50, s29
    v_perm_b32 v19, v62, v58, s28
    v_perm_b32 v23, v62, v58, s29
    v_perm_b32 v24, v39, v35, s28
    v_perm_b32 v28, v39, v35, s29
    v_perm_b32 v25, v47, v43, s28
    v_perm_b32 v29, v47, v43, s29
    v_perm_b32 v26, v55, v51, s28
    v_perm_b32 v30, v55, v51, s29
    v_perm_b32 v27, v63, v59, s28
    v_perm_b32 v31, v63, v59, s29
K12_XP_N:
    s_lshl_b32 s36, s40, 3
    s_sub_i32 s36, s36, 24
    s_max_i32 s36, s36, 1
    s_mov_b32 s37, 131072
K12_GL0:
    v_mov_b32 v240, 155648
    ds_read_b32 v240, v240
    s_waitcnt lgkmcnt(0)
    v_cmp_gt_u32 vcc, s36, v240
    s_sub_u32 s37, s37, 1
    s_cmp_eq_u32 s37, 0
    s_cbranch_scc1 K12_GT0
    s_cbranch_vccz K12_GT0
    s_sleep 2
    s_branch K12_GL0
K12_GT0:
    s_lshl_b32 s36, s40, 2
    s_add_u32 s36, s36, 155840
    s_mov_b64 exec, 1
    v_mov_b32 v240, s36
    v_mov_b32 v241, 1
    ds_add_u32 v240, v241
    s_mov_b64 exec, -1
    s_mov_b32 s37, 131072
K12_BL0:
    v_mov_b32 v240, s36
    ds_read_b32 v240, v240
    s_waitcnt lgkmcnt(0)
    v_cmp_gt_u32 vcc, 4, v240
    s_sub_u32 s37, s37, 1
    s_cmp_eq_u32 s37, 0
    s_cbranch_scc1 K12_BT0
    s_cbranch_vccz K12_BT0
    s_sleep 1
    s_branch K12_BL0
K12_BT0:
    s_add_u32 s42, s40, 1
    s_lshl_b32 s36, s42, 7
    s_add_u32 s36, s36, s22
    s_lshr_b32 s37, s36, 9
    s_lshl_b32 s37, s37, 19
    s_and_b32 s36, s36, 511
    s_lshl_b32 s36, s36, 10
    s_add_u32 s36, s36, s37
    s_add_u32 s36, s36, s33
    buffer_load_dwordx4 v[96:99], v250, s[8:11], s36 offen
    s_add_u32 s36, s36, 0x100000
    buffer_load_dwordx4 v[100:103], v250, s[8:11], s36 offen
    s_add_u32 s36, s36, 0x100000
    buffer_load_dwordx4 v[104:107], v250, s[8:11], s36 offen
    s_add_u32 s36, s36, 0x100000
    buffer_load_dwordx4 v[108:111], v250, s[8:11], s36 offen
    s_add_u32 s36, s36, 0x100000
    buffer_load_dwordx4 v[112:115], v250, s[8:11], s36 offen
    s_add_u32 s36, s36, 0x100000
    buffer_load_dwordx4 v[116:119], v250, s[8:11], s36 offen
    s_add_u32 s36, s36, 0x100000
    buffer_load_dwordx4 v[120:123], v250, s[8:11], s36 offen
    s_add_u32 s36, s36, 0x100000
    buffer_load_dwordx4 v[124:127], v250, s[8:11], s36 offen
    s_cmp_eq_u32 s27, 0
    s_cbranch_scc1 K12_XP_E
    s_mul_i32 s39, s40, 85504
    s_add_u32 s39, s39, s31
    s_lshl_b32 s36, s30, 7
    s_add_u32 s39, s39, s36
    v_bfe_u32 v249, v254, 4, 2
    v_bfe_u32 v240, v254, 8, 1
    v_lshl_add_u32 v249, v240, 2, v249
    s_add_u32 s36, s30, 7
    s_cmp_ge_u32 s30, 160
    s_cselect_b32 s36, s36, s30
    s_cmp_eq_u32 s25, 1
    s_cselect_b32 s36, s36, s30
    s_lshr_b32 s36, s36, 1
    s_and_b32 s36, s36, 7
    v_xor_b32 v249, s36, v249
    v_lshl_add_u32 v249, v249, 4, v252
    s_setprio 1
    v_mfma_f32_16x16x32_bf16 v[32:35], v[160:163], v[64:67], 0
    v_mfma_f32_16x16x32_bf16 v[36:39], v[160:163], v[68:71], 0
    v_mfma_f32_16x16x32_bf16 v[40:43], v[160:163], v[72:75], 0
    v_mfma_f32_16x16x32_bf16 v[44:47], v[160:163], v[76:79], 0
    v_mfma_f32_16x16x32_bf16 v[48:51], v[160:163], v[80:83], 0
    v_mfma_f32_16x16x32_bf16 v[52:55], v[160:163], v[84:87], 0
    v_mfma_f32_16x16x32_bf16 v[56:59], v[160:163], v[88:91], 0
    v_mfma_f32_16x16x32_bf16 v[60:63], v[160:163], v[92:95], 0
    v_mfma_f32_16x16x32_bf16 v[32:35], v[192:195], v[64:67], v[32:35]
    v_mfma_f32_16x16x32_bf16 v[36:39], v[192:195], v[68:71], v[36:39]
    v_mfma_f32_16x16x32_bf16 v[40:43], v[192:195], v[72:75], v[40:43]
    v_mfma_f32_16x16x32_bf16 v[44:47], v[192:195], v[76:79], v[44:47]
    v_mfma_f32_16x16x32_bf16 v[48:51], v[192:195], v[80:83], v[48:51]
    v_mfma_f32_16x16x32_bf16 v[52:55], v[192:195], v[84:87], v[52:55]
    v_mfma_f32_16x16x32_bf16 v[56:59], v[192:195], v[88:91], v[56:59]
    v_mfma_f32_16x16x32_bf16 v[60:63], v[192:195], v[92:95], v[60:63]
    v_mfma_f32_16x16x32_bf16 v[32:35], v[164:167], v[0:3], v[32:35]
    v_mfma_f32_16x16x32_bf16 v[36:39], v[164:167], v[4:7], v[36:39]
    v_mfma_f32_16x16x32_bf16 v[40:43], v[164:167], v[8:11], v[40:43]
    v_mfma_f32_16x16x32_bf16 v[44:47], v[164:167], v[12:15], v[44:47]
    v_mfma_f32_16x16x32_bf16 v[48:51], v[164:167], v[16:19], v[48:51]
    v_mfma_f32_16x16x32_bf16 v[52:55], v[164:167], v[20:23], v[52:55]
    v_mfma_f32_16x16x32_bf16 v[56:59], v[164:167], v[24:27], v[56:59]
    v_mfma_f32_16x16x32_bf16 v[60:63], v[164:167], v[28:31], v[60:63]
    v_mfma_f32_16x16x32_bf16 v[32:35], v[196:199], v[0:3], v[32:35]
    v_mfma_f32_16x16x32_bf16 v[36:39], v[196:199], v[4:7], v[36:39]
    v_mfma_f32_16x16x32_bf16 v[40:43], v[196:199], v[8:11], v[40:43]
    v_mfma_f32_16x16x32_bf16 v[44:47], v[196:199], v[12:15], v[44:47]
    v_mfma_f32_16x16x32_bf16 v[48:51], v[196:199], v[16:19], v[48:51]
    v_mfma_f32_16x16x32_bf16 v[52:55], v[196:199], v[20:23], v[52:55]
    v_mfma_f32_16x16x32_bf16 v[56:59], v[196:199], v[24:27], v[56:59]
    v_mfma_f32_16x16x32_bf16 v[60:63], v[196:199], v[28:31], v[60:63]
    s_setprio 0
    s_nop 7
    v_cvt_pk_bf16_f32 v240, v32, v36
    v_cvt_pk_bf16_f32 v241, v40, v44
    v_cvt_pk_bf16_f32 v242, v48, v52
    v_cvt_pk_bf16_f32 v243, v56, v60
    buffer_store_dwordx4 v[240:243], v249, s[12:15], s39 offen sc1
    s_add_u32 s39, s39, 2736128
    v_cvt_pk_bf16_f32 v244, v33, v37
    v_cvt_pk_bf16_f32 v245, v41, v45
    v_cvt_pk_bf16_f32 v246, v49, v53
    v_cvt_pk_bf16_f32 v247, v57, v61
    buffer_store_dwordx4 v[244:247], v249, s[12:15], s39 offen sc1
    s_add_u32 s39, s39, 2736128
    v_cvt_pk_bf16_f32 v240, v34, v38
    v_cvt_pk_bf16_f32 v241, v42, v46
    v_cvt_pk_bf16_f32 v242, v50, v54
    v_cvt_pk_bf16_f32 v243, v58, v62
    buffer_store_dwordx4 v[240:243], v249, s[12:15], s39 offen sc1
    s_add_u32 s39, s39, 2736128
    v_cvt_pk_bf16_f32 v244, v35, v39
    v_cvt_pk_bf16_f32 v245, v43, v47
    v_cvt_pk_bf16_f32 v246, v51, v55
    v_cvt_pk_bf16_f32 v247, v59, v63
    buffer_store_dwordx4 v[244:247], v249, s[12:15], s39 offen sc1
    s_add_u32 s39, s39, 2736128
    s_setprio 1
    v_mfma_f32_16x16x32_bf16 v[32:35], v[168:171], v[64:67], 0
    v_mfma_f32_16x16x32_bf16 v[36:39], v[168:171], v[68:71], 0
    v_mfma_f32_16x16x32_bf16 v[40:43], v[168:171], v[72:75], 0
    v_mfma_f32_16x16x32_bf16 v[44:47], v[168:171], v[76:79], 0
    v_mfma_f32_16x16x32_bf16 v[48:51], v[168:171], v[80:83], 0
    v_mfma_f32_16x16x32_bf16 v[52:55], v[168:171], v[84:87], 0
    v_mfma_f32_16x16x32_bf16 v[56:59], v[168:171], v[88:91], 0
    v_mfma_f32_16x16x32_bf16 v[60:63], v[168:171], v[92:95], 0
    v_mfma_f32_16x16x32_bf16 v[32:35], v[200:203], v[64:67], v[32:35]
    v_mfma_f32_16x16x32_bf16 v[36:39], v[200:203], v[68:71], v[36:39]
    v_mfma_f32_16x16x32_bf16 v[40:43], v[200:203], v[72:75], v[40:43]
    v_mfma_f32_16x16x32_bf16 v[44:47], v[200:203], v[76:79], v[44:47]
    v_mfma_f32_16x16x32_bf16 v[48:51], v[200:203], v[80:83], v[48:51]
    v_mfma_f32_16x16x32_bf16 v[52:55], v[200:203], v[84:87], v[52:55]
    v_mfma_f32_16x16x32_bf16 v[56:59], v[200:203], v[88:91], v[56:59]
    v_mfma_f32_16x16x32_bf16 v[60:63], v[200:203], v[92:95], v[60:63]
    v_mfma_f32_16x16x32_bf16 v[32:35], v[172:175], v[0:3], v[32:35]
    v_mfma_f32_16x16x32_bf16 v[36:39], v[172:175], v[4:7], v[36:39]
    v_mfma_f32_16x16x32_bf16 v[40:43], v[172:175], v[8:11], v[40:43]
    v_mfma_f32_16x16x32_bf16 v[44:47], v[172:175], v[12:15], v[44:47]
    v_mfma_f32_16x16x32_bf16 v[48:51], v[172:175], v[16:19], v[48:51]
    v_mfma_f32_16x16x32_bf16 v[52:55], v[172:175], v[20:23], v[52:55]
    v_mfma_f32_16x16x32_bf16 v[56:59], v[172:175], v[24:27], v[56:59]
    v_mfma_f32_16x16x32_bf16 v[60:63], v[172:175], v[28:31], v[60:63]
    v_mfma_f32_16x16x32_bf16 v[32:35], v[204:207], v[0:3], v[32:35]
    v_mfma_f32_16x16x32_bf16 v[36:39], v[204:207], v[4:7], v[36:39]
    v_mfma_f32_16x16x32_bf16 v[40:43], v[204:207], v[8:11], v[40:43]
    v_mfma_f32_16x16x32_bf16 v[44:47], v[204:207], v[12:15], v[44:47]
    v_mfma_f32_16x16x32_bf16 v[48:51], v[204:207], v[16:19], v[48:51]
    v_mfma_f32_16x16x32_bf16 v[52:55], v[204:207], v[20:23], v[52:55]
    v_mfma_f32_16x16x32_bf16 v[56:59], v[204:207], v[24:27], v[56:59]
    v_mfma_f32_16x16x32_bf16 v[60:63], v[204:207], v[28:31], v[60:63]
    s_setprio 0
    s_nop 7
    v_cvt_pk_bf16_f32 v240, v32, v36
    v_cvt_pk_bf16_f32 v241, v40, v44
    v_cvt_pk_bf16_f32 v242, v48, v52
    v_cvt_pk_bf16_f32 v243, v56, v60
    buffer_store_dwordx4 v[240:243], v249, s[12:15], s39 offen sc1
    s_add_u32 s39, s39, 2736128
    v_cvt_pk_bf16_f32 v244, v33, v37
    v_cvt_pk_bf16_f32 v245, v41, v45
    v_cvt_pk_bf16_f32 v246, v49, v53
    v_cvt_pk_bf16_f32 v247, v57, v61
    buffer_store_dwordx4 v[244:247], v249, s[12:15], s39 offen sc1
    s_add_u32 s39, s39, 2736128
    v_cvt_pk_bf16_f32 v240, v34, v38
    v_cvt_pk_bf16_f32 v241, v42, v46
    v_cvt_pk_bf16_f32 v242, v50, v54
    v_cvt_pk_bf16_f32 v243, v58, v62
    buffer_store_dwordx4 v[240:243], v249, s[12:15], s39 offen sc1
    s_add_u32 s39, s39, 2736128
    v_cvt_pk_bf16_f32 v244, v35, v39
    v_cvt_pk_bf16_f32 v245, v43, v47
    v_cvt_pk_bf16_f32 v246, v51, v55
    v_cvt_pk_bf16_f32 v247, v59, v63
    buffer_store_dwordx4 v[244:247], v249, s[12:15], s39 offen sc1
    s_add_u32 s39, s39, 2736128
    s_setprio 1
    v_mfma_f32_16x16x32_bf16 v[32:35], v[176:179], v[64:67], 0
    v_mfma_f32_16x16x32_bf16 v[36:39], v[176:179], v[68:71], 0
    v_mfma_f32_16x16x32_bf16 v[40:43], v[176:179], v[72:75], 0
    v_mfma_f32_16x16x32_bf16 v[44:47], v[176:179], v[76:79], 0
    v_mfma_f32_16x16x32_bf16 v[48:51], v[176:179], v[80:83], 0
    v_mfma_f32_16x16x32_bf16 v[52:55], v[176:179], v[84:87], 0
    v_mfma_f32_16x16x32_bf16 v[56:59], v[176:179], v[88:91], 0
    v_mfma_f32_16x16x32_bf16 v[60:63], v[176:179], v[92:95], 0
    v_mfma_f32_16x16x32_bf16 v[32:35], v[208:211], v[64:67], v[32:35]
    v_mfma_f32_16x16x32_bf16 v[36:39], v[208:211], v[68:71], v[36:39]
    v_mfma_f32_16x16x32_bf16 v[40:43], v[208:211], v[72:75], v[40:43]
    v_mfma_f32_16x16x32_bf16 v[44:47], v[208:211], v[76:79], v[44:47]
    v_mfma_f32_16x16x32_bf16 v[48:51], v[208:211], v[80:83], v[48:51]
    v_mfma_f32_16x16x32_bf16 v[52:55], v[208:211], v[84:87], v[52:55]
    v_mfma_f32_16x16x32_bf16 v[56:59], v[208:211], v[88:91], v[56:59]
    v_mfma_f32_16x16x32_bf16 v[60:63], v[208:211], v[92:95], v[60:63]
    v_mfma_f32_16x16x32_bf16 v[32:35], v[180:183], v[0:3], v[32:35]
    v_mfma_f32_16x16x32_bf16 v[36:39], v[180:183], v[4:7], v[36:39]
    v_mfma_f32_16x16x32_bf16 v[40:43], v[180:183], v[8:11], v[40:43]
    v_mfma_f32_16x16x32_bf16 v[44:47], v[180:183], v[12:15], v[44:47]
    v_mfma_f32_16x16x32_bf16 v[48:51], v[180:183], v[16:19], v[48:51]
    v_mfma_f32_16x16x32_bf16 v[52:55], v[180:183], v[20:23], v[52:55]
    v_mfma_f32_16x16x32_bf16 v[56:59], v[180:183], v[24:27], v[56:59]
    v_mfma_f32_16x16x32_bf16 v[60:63], v[180:183], v[28:31], v[60:63]
    v_mfma_f32_16x16x32_bf16 v[32:35], v[212:215], v[0:3], v[32:35]
    v_mfma_f32_16x16x32_bf16 v[36:39], v[212:215], v[4:7], v[36:39]
    v_mfma_f32_16x16x32_bf16 v[40:43], v[212:215], v[8:11], v[40:43]
    v_mfma_f32_16x16x32_bf16 v[44:47], v[212:215], v[12:15], v[44:47]
    v_mfma_f32_16x16x32_bf16 v[48:51], v[212:215], v[16:19], v[48:51]
    v_mfma_f32_16x16x32_bf16 v[52:55], v[212:215], v[20:23], v[52:55]
    v_mfma_f32_16x16x32_bf16 v[56:59], v[212:215], v[24:27], v[56:59]
    v_mfma_f32_16x16x32_bf16 v[60:63], v[212:215], v[28:31], v[60:63]
    s_setprio 0
    s_nop 7
    v_cvt_pk_bf16_f32 v240, v32, v36
    v_cvt_pk_bf16_f32 v241, v40, v44
    v_cvt_pk_bf16_f32 v242, v48, v52
    v_cvt_pk_bf16_f32 v243, v56, v60
    buffer_store_dwordx4 v[240:243], v249, s[12:15], s39 offen sc1
    s_add_u32 s39, s39, 2736128
    v_cvt_pk_bf16_f32 v244, v33, v37
    v_cvt_pk_bf16_f32 v245, v41, v45
    v_cvt_pk_bf16_f32 v246, v49, v53
    v_cvt_pk_bf16_f32 v247, v57, v61
    buffer_store_dwordx4 v[244:247], v249, s[12:15], s39 offen sc1
    s_add_u32 s39, s39, 2736128
    v_cvt_pk_bf16_f32 v240, v34, v38
    v_cvt_pk_bf16_f32 v241, v42, v46
    v_cvt_pk_bf16_f32 v242, v50, v54
    v_cvt_pk_bf16_f32 v243, v58, v62
    buffer_store_dwordx4 v[240:243], v249, s[12:15], s39 offen sc1
    s_add_u32 s39, s39, 2736128
    v_cvt_pk_bf16_f32 v244, v35, v39
    v_cvt_pk_bf16_f32 v245, v43, v47
    v_cvt_pk_bf16_f32 v246, v51, v55
    v_cvt_pk_bf16_f32 v247, v59, v63
    buffer_store_dwordx4 v[244:247], v249, s[12:15], s39 offen sc1
    s_add_u32 s39, s39, 2736128
    s_setprio 1
    v_mfma_f32_16x16x32_bf16 v[32:35], v[184:187], v[64:67], 0
    v_mfma_f32_16x16x32_bf16 v[36:39], v[184:187], v[68:71], 0
    v_mfma_f32_16x16x32_bf16 v[40:43], v[184:187], v[72:75], 0
    v_mfma_f32_16x16x32_bf16 v[44:47], v[184:187], v[76:79], 0
    v_mfma_f32_16x16x32_bf16 v[48:51], v[184:187], v[80:83], 0
    v_mfma_f32_16x16x32_bf16 v[52:55], v[184:187], v[84:87], 0
    v_mfma_f32_16x16x32_bf16 v[56:59], v[184:187], v[88:91], 0
    v_mfma_f32_16x16x32_bf16 v[60:63], v[184:187], v[92:95], 0
    v_mfma_f32_16x16x32_bf16 v[32:35], v[216:219], v[64:67], v[32:35]
    v_mfma_f32_16x16x32_bf16 v[36:39], v[216:219], v[68:71], v[36:39]
    v_mfma_f32_16x16x32_bf16 v[40:43], v[216:219], v[72:75], v[40:43]
    v_mfma_f32_16x16x32_bf16 v[44:47], v[216:219], v[76:79], v[44:47]
    v_mfma_f32_16x16x32_bf16 v[48:51], v[216:219], v[80:83], v[48:51]
    v_mfma_f32_16x16x32_bf16 v[52:55], v[216:219], v[84:87], v[52:55]
    v_mfma_f32_16x16x32_bf16 v[56:59], v[216:219], v[88:91], v[56:59]
    v_mfma_f32_16x16x32_bf16 v[60:63], v[216:219], v[92:95], v[60:63]
    v_mfma_f32_16x16x32_bf16 v[32:35], v[188:191], v[0:3], v[32:35]
    v_mfma_f32_16x16x32_bf16 v[36:39], v[188:191], v[4:7], v[36:39]
    v_mfma_f32_16x16x32_bf16 v[40:43], v[188:191], v[8:11], v[40:43]
    v_mfma_f32_16x16x32_bf16 v[44:47], v[188:191], v[12:15], v[44:47]
    v_mfma_f32_16x16x32_bf16 v[48:51], v[188:191], v[16:19], v[48:51]
    v_mfma_f32_16x16x32_bf16 v[52:55], v[188:191], v[20:23], v[52:55]
    v_mfma_f32_16x16x32_bf16 v[56:59], v[188:191], v[24:27], v[56:59]
    v_mfma_f32_16x16x32_bf16 v[60:63], v[188:191], v[28:31], v[60:63]
    v_mfma_f32_16x16x32_bf16 v[32:35], v[220:223], v[0:3], v[32:35]
    v_mfma_f32_16x16x32_bf16 v[36:39], v[220:223], v[4:7], v[36:39]
    v_mfma_f32_16x16x32_bf16 v[40:43], v[220:223], v[8:11], v[40:43]
    v_mfma_f32_16x16x32_bf16 v[44:47], v[220:223], v[12:15], v[44:47]
    v_mfma_f32_16x16x32_bf16 v[48:51], v[220:223], v[16:19], v[48:51]
    v_mfma_f32_16x16x32_bf16 v[52:55], v[220:223], v[20:23], v[52:55]
    v_mfma_f32_16x16x32_bf16 v[56:59], v[220:223], v[24:27], v[56:59]
    v_mfma_f32_16x16x32_bf16 v[60:63], v[220:223], v[28:31], v[60:63]
    s_setprio 0
    s_nop 7
    v_cvt_pk_bf16_f32 v240, v32, v36
    v_cvt_pk_bf16_f32 v241, v40, v44
    v_cvt_pk_bf16_f32 v242, v48, v52
    v_cvt_pk_bf16_f32 v243, v56, v60
    buffer_store_dwordx4 v[240:243], v249, s[12:15], s39 offen sc1
    s_add_u32 s39, s39, 2736128
    v_cvt_pk_bf16_f32 v244, v33, v37
    v_cvt_pk_bf16_f32 v245, v41, v45
    v_cvt_pk_bf16_f32 v246, v49, v53
    v_cvt_pk_bf16_f32 v247, v57, v61
    buffer_store_dwordx4 v[244:247], v249, s[12:15], s39 offen sc1
    s_add_u32 s39, s39, 2736128
    v_cvt_pk_bf16_f32 v240, v34, v38
    v_cvt_pk_bf16_f32 v241, v42, v46
    v_cvt_pk_bf16_f32 v242, v50, v54
    v_cvt_pk_bf16_f32 v243, v58, v62
    buffer_store_dwordx4 v[240:243], v249, s[12:15], s39 offen sc1
    s_add_u32 s39, s39, 2736128
    v_cvt_pk_bf16_f32 v244, v35, v39
    v_cvt_pk_bf16_f32 v245, v43, v47
    v_cvt_pk_bf16_f32 v246, v51, v55
    v_cvt_pk_bf16_f32 v247, v59, v63
    buffer_store_dwordx4 v[244:247], v249, s[12:15], s39 offen sc1
    s_mov_b32 s41, s40
    s_add_u32 s40, s40, 1
    s_cmp_eq_u32 s41, 3
    s_cbranch_scc0 K12_ES5
    s_waitcnt vmcnt(0)
    s_mov_b32 s34, -1
    s_cmp_ge_u32 s41, 8
    s_cbranch_scc1 K12_SG6
    s_lshl_b32 s36, s41, 2
    s_add_u32 s37, s36, 155680
    s_mov_b64 exec, 1
    v_mov_b32 v255, s37
    v_mov_b32 v240, 1
    ds_add_rtn_u32 v240, v255, v240
    s_waitcnt lgkmcnt(0)
    v_readfirstlane_b32 s37, v240
    s_nop 3
    s_cmp_eq_u32 s37, 3
    s_cbranch_scc0 K12_SH6
    s_lshl_b32 s36, s36, 8
    v_mov_b32 v255, 1
    v_mov_b32 v240, s36
    buffer_atomic_add v255, v240, s[60:63], 0 offen sc0 sc1
    s_mov_b32 s34, s41
K12_SH6:
    s_mov_b64 exec, -1
K12_SG6:
    s_waitcnt vmcnt(0)
    s_cmp_ge_u32 s34, 8
    s_cbranch_scc1 K12_PB7
    v_readfirstlane_b32 s37, v255
    s_nop 3
    s_cmp_eq_u32 s37, 255
    s_cbranch_scc0 K12_PB7
    s_lshl_b32 s36, s34, 4
    s_add_u32 s36, s36, 16384
    s_mov_b64 exec, 1
    v_mov_b32 v255, 1
    v_mov_b32 v240, s36
    buffer_store_dword v255, v240, s[60:63], 0 offen sc1
    s_mov_b64 exec, -1
K12_PB7:
    s_mov_b32 s34, -1
    s_mov_b32 s41, -1
K12_ES5:
    s_waitcnt vmcnt(16)
    s_branch K12_XP_F
K12_XP_E:
    s_mov_b32 s41, s40
    s_add_u32 s40, s40, 1
    s_cmp_eq_u32 s41, 3
    s_cbranch_scc0 K12_ES8
    s_waitcnt vmcnt(0)
    s_mov_b32 s34, -1
    s_cmp_ge_u32 s41, 8
    s_cbranch_scc1 K12_SG9
    s_lshl_b32 s36, s41, 2
    s_add_u32 s37, s36, 155680
    s_mov_b64 exec, 1
    v_mov_b32 v255, s37
    v_mov_b32 v240, 1
    ds_add_rtn_u32 v240, v255, v240
    s_waitcnt lgkmcnt(0)
    v_readfirstlane_b32 s37, v240
    s_nop 3
    s_cmp_eq_u32 s37, 3
    s_cbranch_scc0 K12_SH9
    s_lshl_b32 s36, s36, 8
    v_mov_b32 v255, 1
    v_mov_b32 v240, s36
    buffer_atomic_add v255, v240, s[60:63], 0 offen sc0 sc1
    s_mov_b32 s34, s41
K12_SH9:
    s_mov_b64 exec, -1
K12_SG9:
    s_waitcnt vmcnt(0)
    s_cmp_ge_u32 s34, 8
    s_cbranch_scc1 K12_PB10
    v_readfirstlane_b32 s37, v255
    s_nop 3
    s_cmp_eq_u32 s37, 255
    s_cbranch_scc0 K12_PB10
    s_lshl_b32 s36, s34, 4
    s_add_u32 s36, s36, 16384
    s_mov_b64 exec, 1
    v_mov_b32 v255, 1
    v_mov_b32 v240, s36
    buffer_store_dword v255, v240, s[60:63], 0 offen sc1
    s_mov_b64 exec, -1
K12_PB10:
    s_mov_b32 s34, -1
    s_mov_b32 s41, -1
K12_ES8:
    s_waitcnt vmcnt(0)
K12_XP_F:
    s_cmp_ge_u32 s34, 8
    s_cbranch_scc1 K12_PB11
    v_readfirstlane_b32 s37, v255
    s_nop 3
    s_cmp_eq_u32 s37, 255
    s_cbranch_scc0 K12_PB11
    s_lshl_b32 s36, s34, 4
    s_add_u32 s36, s36, 16384
    s_mov_b64 exec, 1
    v_mov_b32 v255, 1
    v_mov_b32 v240, s36
    buffer_store_dword v255, v240, s[60:63], 0 offen sc1
    s_mov_b64 exec, -1
K12_PB11:
    s_cmp_ge_u32 s40, 8
    s_cbranch_scc1 K12_PFIN
K12_WENTRY:
    s_waitcnt vmcnt(0)
    s_mov_b32 s34, -1
    s_cmp_ge_u32 s41, 8
    s_cbranch_scc1 K12_SG12
    s_lshl_b32 s36, s41, 2
    s_add_u32 s37, s36, 155680
    s_mov_b64 exec, 1
    v_mov_b32 v255, s37
    v_mov_b32 v240, 1
    ds_add_rtn_u32 v240, v255, v240
    s_waitcnt lgkmcnt(0)
    v_readfirstlane_b32 s37, v240
    s_nop 3
    s_cmp_eq_u32 s37, 3
    s_cbranch_scc0 K12_SH12
    s_lshl_b32 s36, s36, 8
    v_mov_b32 v255, 1
    v_mov_b32 v240, s36
    buffer_atomic_add v255, v240, s[60:63], 0 offen sc0 sc1
    s_mov_b32 s34, s41
K12_SH12:
    s_mov_b64 exec, -1
K12_SG12:
    s_cmp_ge_u32 s34, 8
    s_cbranch_scc1 K12_EP13
    s_waitcnt vmcnt(0)
    s_cmp_ge_u32 s34, 8
    s_cbranch_scc1 K12_PB14
    v_readfirstlane_b32 s37, v255
    s_nop 3
    s_cmp_eq_u32 s37, 255
    s_cbranch_scc0 K12_PB14
    s_lshl_b32 s36, s34, 4
    s_add_u32 s36, s36, 16384
    s_mov_b64 exec, 1
    v_mov_b32 v255, 1
    v_mov_b32 v240, s36
    buffer_store_dword v255, v240, s[60:63], 0 offen sc1
    s_mov_b64 exec, -1
K12_PB14:
    s_mov_b32 s34, -1
K12_EP13:
    v_perm_b32 v64, v100, v96, s28
    v_perm_b32 v68, v100, v96, s29
    v_perm_b32 v65, v108, v104, s28
    v_perm_b32 v69, v108, v104, s29
    v_perm_b32 v66, v116, v112, s28
    v_perm_b32 v70, v116, v112, s29
    v_perm_b32 v67, v124, v120, s28
    v_perm_b32 v71, v124, v120, s29
    v_perm_b32 v72, v101, v97, s28
    v_perm_b32 v76, v101, v97, s29
    v_perm_b32 v73, v109, v105, s28
    v_perm_b32 v77, v109, v105, s29
    v_perm_b32 v74, v117, v113, s28
    v_perm_b32 v78, v117, v113, s29
    v_perm_b32 v75, v125, v121, s28
    v_perm_b32 v79, v125, v121, s29
    v_perm_b32 v80, v102, v98, s28
    v_perm_b32 v84, v102, v98, s29
    v_perm_b32 v81, v110, v106, s28
    v_perm_b32 v85, v110, v106, s29
    v_perm_b32 v82, v118, v114, s28
    v_perm_b32 v86, v118, v114, s29
    v_perm_b32 v83, v126, v122, s28
    v_perm_b32 v87, v126, v122, s29
    v_perm_b32 v88, v103, v99, s28
    v_perm_b32 v92, v103, v99, s29
    v_perm_b32 v89, v111, v107, s28
    v_perm_b32 v93, v111, v107, s29
    v_perm_b32 v90, v119, v115, s28
    v_perm_b32 v94, v119, v115, s29
    v_perm_b32 v91, v127, v123, s28
    v_perm_b32 v95, v127, v123, s29
    s_lshl_b32 s36, s40, 3
    s_sub_i32 s36, s36, 24
    s_max_i32 s36, s36, 1
    s_mov_b32 s37, 131072
K12_GL1:
    v_mov_b32 v240, 155648
    ds_read_b32 v240, v240
    s_waitcnt lgkmcnt(0)
    v_cmp_gt_u32 vcc, s36, v240
    s_sub_u32 s37, s37, 1
    s_cmp_eq_u32 s37, 0
    s_cbranch_scc1 K12_GT1
    s_cbranch_vccz K12_GT1
    s_sleep 2
    s_branch K12_GL1
K12_GT1:
    s_lshl_b32 s36, s40, 2
    s_add_u32 s36, s36, 155840
    s_mov_b64 exec, 1
    v_mov_b32 v240, s36
    v_mov_b32 v241, 1
    ds_add_u32 v240, v241
    s_mov_b64 exec, -1
    s_mov_b32 s37, 131072
K12_BL1:
    v_mov_b32 v240, s36
    ds_read_b32 v240, v240
    s_waitcnt lgkmcnt(0)
    v_cmp_gt_u32 vcc, 4, v240
    s_sub_u32 s37, s37, 1
    s_cmp_eq_u32 s37, 0
    s_cbranch_scc1 K12_BT1
    s_cbranch_vccz K12_BT1
    s_sleep 1
    s_branch K12_BL1
K12_BT1:
    s_add_u32 s42, s40, 1
    s_mul_i32 s36, s42, 85
    s_add_u32 s36, s36, s2
    s_and_b32 s36, s36, 255
    s_mul_hi_u32 s37, s36, 0x55555556
    s_mul_i32 s38, s37, 3
    s_cmp_eq_u32 s38, s36
    s_cselect_b32 s27, 1, 0
    s_cmp_lt_u32 s37, 78
    s_cselect_b32 s27, s27, 0
    s_add_u32 s37, s37, 89
    s_cmp_eq_u32 s21, 0
    s_cselect_b32 s30, s24, s37
    s_cselect_b32 s27, 1, s27
    s_cmp_eq_u32 s27, 0
    s_cbranch_scc1 K12_WP_N
    s_lshl_b32 s36, s42, 8
    s_mul_i32 s37, s30, 98304
    s_add_u32 s36, s36, s37
    buffer_load_dwordx4 v[0:3], v248, s[4:7], s36 offen
    buffer_load_dwordx4 v[4:7], v248, s[4:7], s36 offen offset:2048
    s_add_u32 s36, s36, 4096
    buffer_load_dwordx4 v[8:11], v248, s[4:7], s36 offen
    buffer_load_dwordx4 v[12:15], v248, s[4:7], s36 offen offset:2048
    s_add_u32 s36, s36, 4096
    buffer_load_dwordx4 v[16:19], v248, s[4:7], s36 offen
    buffer_load_dwordx4 v[20:23], v248, s[4:7], s36 offen offset:2048
    s_add_u32 s36, s36, 4096
    buffer_load_dwordx4 v[24:27], v248, s[4:7], s36 offen
    buffer_load_dwordx4 v[28:31], v248, s[4:7], s36 offen offset:2048
    s_add_u32 s36, s36, 53248
    buffer_load_dwordx4 v[32:35], v248, s[4:7], s36 offen
    buffer_load_dwordx4 v[36:39], v248, s[4:7], s36 offen offset:2048
    s_add_u32 s36, s36, 4096
    buffer_load_dwordx4 v[40:43], v248, s[4:7], s36 offen
    buffer_load_dwordx4 v[44:47], v248, s[4:7], s36 offen offset:2048
    s_add_u32 s36, s36, 4096
    buffer_load_dwordx4 v[48:51], v248, s[4:7], s36 offen
    buffer_load_dwordx4 v[52:55], v248, s[4:7], s36 offen offset:2048
    s_add_u32 s36, s36, 4096
    buffer_load_dwordx4 v[56:59], v248, s[4:7], s36 offen
    buffer_load_dwordx4 v[60:63], v248, s[4:7], s36 offen offset:2048
    s_branch K12_WP_M
K12_WP_N:
K12_WP_M:
    s_lshl_b32 s36, s40, 7
    s_add_u32 s36, s36, s22
    s_and_b32 s37, s36, 3
    s_lshr_b32 s38, s36, 1
    s_and_b32 s38, s38, 4
    s_or_b32 s37, s37, s38
    v_bfe_u32 v253, v254, 5, 3
    v_xor_b32 v253, s37, v253
    v_lshl_add_u32 v253, v253, 5, v251
    s_lshl_b32 s36, s36, 9
    s_add_u32 s39, s36, s32
    s_setprio 1
    v_mfma_f32_16x16x32_bf16 v[128:131], v[224:227], v[64:67], 0
    v_mfma_f32_16x16x32_bf16 v[132:135], v[224:227], v[68:71], 0
    v_mfma_f32_16x16x32_bf16 v[136:139], v[224:227], v[72:75], 0
    v_mfma_f32_16x16x32_bf16 v[140:143], v[224:227], v[76:79], 0
    v_mfma_f32_16x16x32_bf16 v[144:147], v[224:227], v[80:83], 0
    v_mfma_f32_16x16x32_bf16 v[148:151], v[224:227], v[84:87], 0
    v_mfma_f32_16x16x32_bf16 v[152:155], v[224:227], v[88:91], 0
    v_mfma_f32_16x16x32_bf16 v[156:159], v[224:227], v[92:95], 0
    s_setprio 0
    s_nop 7
    v_cvt_pk_bf16_f32 v240, v128, v132
    v_cvt_pk_bf16_f32 v241, v136, v140
    v_cvt_pk_bf16_f32 v242, v144, v148
    v_cvt_pk_bf16_f32 v243, v152, v156
    buffer_store_dwordx4 v[240:243], v253, s[16:19], s39 offen sc1
    s_add_u32 s39, s39, 4194304
    v_cvt_pk_bf16_f32 v244, v129, v133
    v_cvt_pk_bf16_f32 v245, v137, v141
    v_cvt_pk_bf16_f32 v246, v145, v149
    v_cvt_pk_bf16_f32 v247, v153, v157
    buffer_store_dwordx4 v[244:247], v253, s[16:19], s39 offen sc1
    s_add_u32 s39, s39, 4194304
    v_cvt_pk_bf16_f32 v240, v130, v134
    v_cvt_pk_bf16_f32 v241, v138, v142
    v_cvt_pk_bf16_f32 v242, v146, v150
    v_cvt_pk_bf16_f32 v243, v154, v158
    buffer_store_dwordx4 v[240:243], v253, s[16:19], s39 offen sc1
    s_add_u32 s39, s39, 4194304
    v_cvt_pk_bf16_f32 v244, v131, v135
    v_cvt_pk_bf16_f32 v245, v139, v143
    v_cvt_pk_bf16_f32 v246, v147, v151
    v_cvt_pk_bf16_f32 v247, v155, v159
    buffer_store_dwordx4 v[244:247], v253, s[16:19], s39 offen sc1
    s_add_u32 s39, s39, 4194304
    s_setprio 1
    v_mfma_f32_16x16x32_bf16 v[128:131], v[228:231], v[64:67], 0
    v_mfma_f32_16x16x32_bf16 v[132:135], v[228:231], v[68:71], 0
    v_mfma_f32_16x16x32_bf16 v[136:139], v[228:231], v[72:75], 0
    v_mfma_f32_16x16x32_bf16 v[140:143], v[228:231], v[76:79], 0
    v_mfma_f32_16x16x32_bf16 v[144:147], v[228:231], v[80:83], 0
    v_mfma_f32_16x16x32_bf16 v[148:151], v[228:231], v[84:87], 0
    v_mfma_f32_16x16x32_bf16 v[152:155], v[228:231], v[88:91], 0
    v_mfma_f32_16x16x32_bf16 v[156:159], v[228:231], v[92:95], 0
    s_setprio 0
    s_nop 7
    v_cvt_pk_bf16_f32 v240, v128, v132
    v_cvt_pk_bf16_f32 v241, v136, v140
    v_cvt_pk_bf16_f32 v242, v144, v148
    v_cvt_pk_bf16_f32 v243, v152, v156
    buffer_store_dwordx4 v[240:243], v253, s[16:19], s39 offen sc1
    s_add_u32 s39, s39, 4194304
    v_cvt_pk_bf16_f32 v244, v129, v133
    v_cvt_pk_bf16_f32 v245, v137, v141
    v_cvt_pk_bf16_f32 v246, v145, v149
    v_cvt_pk_bf16_f32 v247, v153, v157
    buffer_store_dwordx4 v[244:247], v253, s[16:19], s39 offen sc1
    s_add_u32 s39, s39, 4194304
    v_cvt_pk_bf16_f32 v240, v130, v134
    v_cvt_pk_bf16_f32 v241, v138, v142
    v_cvt_pk_bf16_f32 v242, v146, v150
    v_cvt_pk_bf16_f32 v243, v154, v158
    buffer_store_dwordx4 v[240:243], v253, s[16:19], s39 offen sc1
    s_add_u32 s39, s39, 4194304
    v_cvt_pk_bf16_f32 v244, v131, v135
    v_cvt_pk_bf16_f32 v245, v139, v143
    v_cvt_pk_bf16_f32 v246, v147, v151
    v_cvt_pk_bf16_f32 v247, v155, v159
    buffer_store_dwordx4 v[244:247], v253, s[16:19], s39 offen sc1
    s_add_u32 s39, s39, 4194304
    s_setprio 1
    v_mfma_f32_16x16x32_bf16 v[128:131], v[232:235], v[64:67], 0
    v_mfma_f32_16x16x32_bf16 v[132:135], v[232:235], v[68:71], 0
    v_mfma_f32_16x16x32_bf16 v[136:139], v[232:235], v[72:75], 0
    v_mfma_f32_16x16x32_bf16 v[140:143], v[232:235], v[76:79], 0
    v_mfma_f32_16x16x32_bf16 v[144:147], v[232:235], v[80:83], 0
    v_mfma_f32_16x16x32_bf16 v[148:151], v[232:235], v[84:87], 0
    v_mfma_f32_16x16x32_bf16 v[152:155], v[232:235], v[88:91], 0
    v_mfma_f32_16x16x32_bf16 v[156:159], v[232:235], v[92:95], 0
    s_setprio 0
    s_nop 7
    v_cvt_pk_bf16_f32 v240, v128, v132
    v_cvt_pk_bf16_f32 v241, v136, v140
    v_cvt_pk_bf16_f32 v242, v144, v148
    v_cvt_pk_bf16_f32 v243, v152, v156
    buffer_store_dwordx4 v[240:243], v253, s[16:19], s39 offen sc1
    s_add_u32 s39, s39, 4194304
    v_cvt_pk_bf16_f32 v244, v129, v133
    v_cvt_pk_bf16_f32 v245, v137, v141
    v_cvt_pk_bf16_f32 v246, v145, v149
    v_cvt_pk_bf16_f32 v247, v153, v157
    buffer_store_dwordx4 v[244:247], v253, s[16:19], s39 offen sc1
    s_add_u32 s39, s39, 4194304
    v_cvt_pk_bf16_f32 v240, v130, v134
    v_cvt_pk_bf16_f32 v241, v138, v142
    v_cvt_pk_bf16_f32 v242, v146, v150
    v_cvt_pk_bf16_f32 v243, v154, v158
    buffer_store_dwordx4 v[240:243], v253, s[16:19], s39 offen sc1
    s_add_u32 s39, s39, 4194304
    v_cvt_pk_bf16_f32 v244, v131, v135
    v_cvt_pk_bf16_f32 v245, v139, v143
    v_cvt_pk_bf16_f32 v246, v147, v151
    v_cvt_pk_bf16_f32 v247, v155, v159
    buffer_store_dwordx4 v[244:247], v253, s[16:19], s39 offen sc1
    s_add_u32 s39, s39, 4194304
    s_setprio 1
    v_mfma_f32_16x16x32_bf16 v[128:131], v[236:239], v[64:67], 0
    v_mfma_f32_16x16x32_bf16 v[132:135], v[236:239], v[68:71], 0
    v_mfma_f32_16x16x32_bf16 v[136:139], v[236:239], v[72:75], 0
    v_mfma_f32_16x16x32_bf16 v[140:143], v[236:239], v[76:79], 0
    v_mfma_f32_16x16x32_bf16 v[144:147], v[236:239], v[80:83], 0
    v_mfma_f32_16x16x32_bf16 v[148:151], v[236:239], v[84:87], 0
    v_mfma_f32_16x16x32_bf16 v[152:155], v[236:239], v[88:91], 0
    v_mfma_f32_16x16x32_bf16 v[156:159], v[236:239], v[92:95], 0
    s_setprio 0
    s_nop 7
    v_cvt_pk_bf16_f32 v240, v128, v132
    v_cvt_pk_bf16_f32 v241, v136, v140
    v_cvt_pk_bf16_f32 v242, v144, v148
    v_cvt_pk_bf16_f32 v243, v152, v156
    buffer_store_dwordx4 v[240:243], v253, s[16:19], s39 offen sc1
    s_add_u32 s39, s39, 4194304
    v_cvt_pk_bf16_f32 v244, v129, v133
    v_cvt_pk_bf16_f32 v245, v137, v141
    v_cvt_pk_bf16_f32 v246, v145, v149
    v_cvt_pk_bf16_f32 v247, v153, v157
    buffer_store_dwordx4 v[244:247], v253, s[16:19], s39 offen sc1
    s_add_u32 s39, s39, 4194304
    v_cvt_pk_bf16_f32 v240, v130, v134
    v_cvt_pk_bf16_f32 v241, v138, v142
    v_cvt_pk_bf16_f32 v242, v146, v150
    v_cvt_pk_bf16_f32 v243, v154, v158
    buffer_store_dwordx4 v[240:243], v253, s[16:19], s39 offen sc1
    s_add_u32 s39, s39, 4194304
    v_cvt_pk_bf16_f32 v244, v131, v135
    v_cvt_pk_bf16_f32 v245, v139, v143
    v_cvt_pk_bf16_f32 v246, v147, v151
    v_cvt_pk_bf16_f32 v247, v155, v159
    buffer_store_dwordx4 v[244:247], v253, s[16:19], s39 offen sc1
    s_mov_b32 s41, s40
    s_add_u32 s40, s40, 1
    s_cmp_eq_u32 s41, 3
    s_cbranch_scc0 K12_ES15
    s_waitcnt vmcnt(0)
    s_mov_b32 s34, -1
    s_cmp_ge_u32 s41, 8
    s_cbranch_scc1 K12_SG16
    s_lshl_b32 s36, s41, 2
    s_add_u32 s37, s36, 155680
    s_mov_b64 exec, 1
    v_mov_b32 v255, s37
    v_mov_b32 v240, 1
    ds_add_rtn_u32 v240, v255, v240
    s_waitcnt lgkmcnt(0)
    v_readfirstlane_b32 s37, v240
    s_nop 3
    s_cmp_eq_u32 s37, 3
    s_cbranch_scc0 K12_SH16
    s_lshl_b32 s36, s36, 8
    v_mov_b32 v255, 1
    v_mov_b32 v240, s36
    buffer_atomic_add v255, v240, s[60:63], 0 offen sc0 sc1
    s_mov_b32 s34, s41
K12_SH16:
    s_mov_b64 exec, -1
K12_SG16:
    s_waitcnt vmcnt(0)
    s_cmp_ge_u32 s34, 8
    s_cbranch_scc1 K12_PB17
    v_readfirstlane_b32 s37, v255
    s_nop 3
    s_cmp_eq_u32 s37, 255
    s_cbranch_scc0 K12_PB17
    s_lshl_b32 s36, s34, 4
    s_add_u32 s36, s36, 16384
    s_mov_b64 exec, 1
    v_mov_b32 v255, 1
    v_mov_b32 v240, s36
    buffer_store_dword v255, v240, s[60:63], 0 offen sc1
    s_mov_b64 exec, -1
K12_PB17:
    s_mov_b32 s34, -1
    s_mov_b32 s41, -1
K12_ES15:
    s_waitcnt vmcnt(16)
    s_cmp_ge_u32 s34, 8
    s_cbranch_scc1 K12_PB18
    v_readfirstlane_b32 s37, v255
    s_nop 3
    s_cmp_eq_u32 s37, 255
    s_cbranch_scc0 K12_PB18
    s_lshl_b32 s36, s34, 4
    s_add_u32 s36, s36, 16384
    s_mov_b64 exec, 1
    v_mov_b32 v255, 1
    v_mov_b32 v240, s36
    buffer_store_dword v255, v240, s[60:63], 0 offen sc1
    s_mov_b64 exec, -1
K12_PB18:
    s_cmp_lt_u32 s40, 8
    s_cbranch_scc1 K12_XW
K12_PFIN:
    s_waitcnt vmcnt(0)
    s_mov_b32 s34, -1
    s_cmp_ge_u32 s41, 8
    s_cbranch_scc1 K12_SG19
    s_lshl_b32 s36, s41, 2
    s_add_u32 s37, s36, 155680
    s_mov_b64 exec, 1
    v_mov_b32 v255, s37
    v_mov_b32 v240, 1
    ds_add_rtn_u32 v240, v255, v240
    s_waitcnt lgkmcnt(0)
    v_readfirstlane_b32 s37, v240
    s_nop 3
    s_cmp_eq_u32 s37, 3
    s_cbranch_scc0 K12_SH19
    s_lshl_b32 s36, s36, 8
    v_mov_b32 v255, 1
    v_mov_b32 v240, s36
    buffer_atomic_add v255, v240, s[60:63], 0 offen sc0 sc1
    s_mov_b32 s34, s41
K12_SH19:
    s_mov_b64 exec, -1
K12_SG19:
    s_waitcnt vmcnt(0)
    s_cmp_ge_u32 s34, 8
    s_cbranch_scc1 K12_PB20
    v_readfirstlane_b32 s37, v255
    s_nop 3
    s_cmp_eq_u32 s37, 255
    s_cbranch_scc0 K12_PB20
    s_lshl_b32 s36, s34, 4
    s_add_u32 s36, s36, 16384
    s_mov_b64 exec, 1
    v_mov_b32 v255, 1
    v_mov_b32 v240, s36
    buffer_store_dword v255, v240, s[60:63], 0 offen sc1
    s_mov_b64 exec, -1
K12_PB20:
    s_endpgm
K12_CONS:
    s_and_b32 s6, s2, 7
    s_lshl_b32 s6, s6, 2
    s_lshr_b32 s7, s2, 6
    s_add_u32 s6, s6, s7
    s_mov_b32 s51, s6
    s_mov_b32 s27, s6
    s_lshr_b32 s7, s2, 3
    s_and_b32 s7, s7, 7
    s_lshr_b32 s20, s7, 2
    s_and_b32 s21, s7, 3
    s_lshl_b32 s22, s6, 1
    s_add_u32 s22, s22, s20
    s_lshl_b32 s23, s6, 2
    s_add_u32 s23, s23, s21
    s_mul_i32 s24, s22, 684032
    s_mul_i32 s25, s23, 524288
    s_add_u32 s25, s25, 50331648
    s_mul_i32 s26, s22, 342016
    s_add_u32 s26, s26, 118489088
    s_add_u32 s8, s58, s24
    s_addc_u32 s9, s59, 0
    s_and_b32 s9, s9, 0xffff
    s_mov_b32 s10, 684032
    s_mov_b32 s11, 0x00020000
    s_add_u32 s12, s58, s25
    s_addc_u32 s13, s59, 0
    s_and_b32 s13, s13, 0xffff
    s_mov_b32 s14, 524288
    s_mov_b32 s15, 0x00020000
    s_add_u32 s16, s58, s26
    s_addc_u32 s17, s59, 0
    s_and_b32 s17, s17, 0xffff
    s_mov_b32 s18, 342016
    s_mov_b32 s19, 0x00020000
    s_add_u32 s4, s58, 153108480
    s_addc_u32 s5, s59, 0
    s_and_b32 s5, s5, 0xffff
    s_cmp_eq_u32 s3, 0
    s_cselect_b32 s6, 128, 0
    s_mov_b32 s7, 0x00020000
    s_mov_b32 s46, 155712
    s_cselect_b32 s46, s46, 155776
    s_mov_b32 s47, 155712
    s_cselect_b32 s47, s47, 155744
    s_cselect_b32 s45, 4, 0
    s_mov_b32 s50, s45
    v_and_b32 v8, 15, v2
    v_lshrrev_b32 v9, 4, v2
    v_lshlrev_b32 v1, 4, v2
    s_mul_i32 s30, s3, 5120
    s_mov_b32 s36, s30
    s_lshl_b32 s31, s3, 12
    s_add_u32 s37, s31, 22528
    s_lshr_b32 s28, s3, 1
    s_and_b32 s29, s3, 1
    s_lshl_b32 s33, s29, 9
    s_add_u32 s33, s33, 20480
    s_mul_i32 s38, s28, 896
    s_add_u32 s38, s38, s33
    s_lshl_b32 s34, s51, 1
    s_add_u32 s34, s34, s28
    s_mul_i32 s34, s34, 684032
    s_add_u32 s64, s58, s34
    s_addc_u32 s65, s59, 0
    s_and_b32 s65, s65, 0xffff
    s_mov_b32 s66, 684032
    s_mov_b32 s67, 0x00020000
    s_mov_b32 s44, 0xffffff
    s_cmp_eq_u32 s29, 0
    s_cselect_b32 s44, -1, s44
    s_mov_b32 s45, 0
    v_lshrrev_b32 v10, 1, v8
    v_xor_b32 v10, v10, v9
    v_lshlrev_b32 v10, 4, v10
    v_lshl_add_u32 v2, v8, 7, v10
    v_xor_b32 v3, 64, v2
    v_lshrrev_b32 v10, 2, v8
    v_lshl_add_u32 v11, v9, 3, v10
    v_lshlrev_b32 v11, 9, v11
    v_and_b32 v12, 1, v9
    v_lshl_or_b32 v10, v12, 2, v10
    s_lshl_b32 s28, s3, 1
    v_xor_b32 v10, s28, v10
    v_lshl_add_u32 v11, v10, 5, v11
    v_and_b32 v10, 3, v8
    v_lshl_add_u32 v11, v10, 3, v11
    v_add_u32 v4, 22528, v11
    s_lshl_b32 s28, s20, 5
    v_xor_b32 v4, s28, v4
    v_and_b32 v10, 3, v8
    v_lshlrev_b32 v10, 2, v10
    v_add_u32 v5, 155648, v10
    s_lshl_b32 s28, s3, 2
    s_add_u32 s28, s28, 155648
    v_mov_b32 v7, s28
    s_mov_b32 s35, 0x80008000
    s_mov_b32 s62, 0
    s_mov_b32 s63, 0
    s_mov_b32 s39, 0
    s_add_u32 m0, s39, s36
    s_nop 0
    buffer_load_dwordx4 v1, s[8:11], s30 offen sc1 lds
    buffer_load_dwordx4 v1, s[8:11], s30 offen offset:1024 sc1 lds
    buffer_load_dwordx4 v1, s[8:11], s30 offen offset:2048 sc1 lds
    buffer_load_dwordx4 v1, s[8:11], s30 offen offset:3072 sc1 lds
    s_add_u32 m0, m0, 4096
    s_add_u32 s34, s30, 4096
    buffer_load_dwordx4 v1, s[8:11], s34 offen sc1 lds
    s_add_u32 m0, s39, s37
    s_add_u32 s30, s30, 21376
    buffer_load_dwordx4 v1, s[12:15], s31 offen sc1 lds
    buffer_load_dwordx4 v1, s[12:15], s31 offen offset:1024 sc1 lds
    buffer_load_dwordx4 v1, s[12:15], s31 offen offset:2048 sc1 lds
    buffer_load_dwordx4 v1, s[12:15], s31 offen offset:3072 sc1 lds
    s_add_u32 m0, s39, s38
    s_mov_b64 exec, s[44:45]
    buffer_load_dwordx4 v1, s[64:67], s33 offen sc1 lds
    s_mov_b64 exec, -1
    s_add_u32 s31, s31, 16384
    s_add_u32 s33, s33, 21376
    s_add_u32 s39, s39, 38912
    s_add_u32 m0, s39, s36
    s_nop 0
    buffer_load_dwordx4 v1, s[8:11], s30 offen sc1 lds
    buffer_load_dwordx4 v1, s[8:11], s30 offen offset:1024 sc1 lds
    buffer_load_dwordx4 v1, s[8:11], s30 offen offset:2048 sc1 lds
    buffer_load_dwordx4 v1, s[8:11], s30 offen offset:3072 sc1 lds
    s_add_u32 m0, m0, 4096
    s_add_u32 s34, s30, 4096
    buffer_load_dwordx4 v1, s[8:11], s34 offen sc1 lds
    s_add_u32 m0, s39, s37
    s_add_u32 s30, s30, 21376
    buffer_load_dwordx4 v1, s[12:15], s31 offen sc1 lds
    buffer_load_dwordx4 v1, s[12:15], s31 offen offset:1024 sc1 lds
    buffer_load_dwordx4 v1, s[12:15], s31 offen offset:2048 sc1 lds
    buffer_load_dwordx4 v1, s[12:15], s31 offen offset:3072 sc1 lds
    s_add_u32 m0, s39, s38
    s_mov_b64 exec, s[44:45]
    buffer_load_dwordx4 v1, s[64:67], s33 offen sc1 lds
    s_mov_b64 exec, -1
    s_add_u32 s31, s31, 16384
    s_add_u32 s33, s33, 21376
    s_add_u32 s39, s39, 38912
    s_add_u32 m0, s39, s36
    s_nop 0
    buffer_load_dwordx4 v1, s[8:11], s30 offen sc1 lds
    buffer_load_dwordx4 v1, s[8:11], s30 offen offset:1024 sc1 lds
    buffer_load_dwordx4 v1, s[8:11], s30 offen offset:2048 sc1 lds
    buffer_load_dwordx4 v1, s[8:11], s30 offen offset:3072 sc1 lds
    s_add_u32 m0, m0, 4096
    s_add_u32 s34, s30, 4096
    buffer_load_dwordx4 v1, s[8:11], s34 offen sc1 lds
    s_add_u32 m0, s39, s37
    s_add_u32 s30, s30, 21376
    buffer_load_dwordx4 v1, s[12:15], s31 offen sc1 lds
    buffer_load_dwordx4 v1, s[12:15], s31 offen offset:1024 sc1 lds
    buffer_load_dwordx4 v1, s[12:15], s31 offen offset:2048 sc1 lds
    buffer_load_dwordx4 v1, s[12:15], s31 offen offset:3072 sc1 lds
    s_add_u32 m0, s39, s38
    s_mov_b64 exec, s[44:45]
    buffer_load_dwordx4 v1, s[64:67], s33 offen sc1 lds
    s_mov_b64 exec, -1
    s_add_u32 s31, s31, 16384
    s_add_u32 s33, s33, 21376
    s_add_u32 s39, s39, 38912
    s_mov_b32 m0, s46
    s_mov_b64 exec, 0xff
    buffer_load_dword v1, s[4:7], 0 offen sc1 lds
    s_mov_b64 exec, -1
    v_lshrrev_b32 v9, 4, v1
    v_and_b32 v8, 15, v9
    v_lshrrev_b32 v9, 4, v9
    v_and_b32 v10, 3, v8
    v_lshlrev_b32 v10, 2, v10
    v_lshrrev_b32 v12, 3, v8
    v_lshl_add_u32 v10, v12, 1, v10
    s_lshl_b32 s28, s3, 4
    s_add_u32 s28, s28, 1
    v_add_u32 v10, s28, v10
    v_bfe_u32 v11, v8, 2, 1
    v_and_b32 v13, 1, v9
    v_lshlrev_b32 v13, 3, v13
    v_mul_u32_u24 v14, 96, v11
    v_mad_u32_u24 v15, v10, v13, v14
    v_mad_u32_u24 v16, v10, 0, v15
    v_mad_u32_u24 v17, v10, 1, v15
    v_mad_u32_u24 v18, v10, 2, v15
    v_mad_u32_u24 v19, v10, 3, v15
    v_mad_u32_u24 v20, v10, 4, v15
    v_mad_u32_u24 v21, v10, 5, v15
    v_mad_u32_u24 v22, v10, 6, v15
    v_mad_u32_u24 v23, v10, 7, v15
    v_and_b32 v16, 127, v16
    v_and_b32 v17, 127, v17
    v_and_b32 v18, 127, v18
    v_and_b32 v19, 127, v19
    v_and_b32 v20, 127, v20
    v_and_b32 v21, 127, v21
    v_and_b32 v22, 127, v22
    v_and_b32 v23, 127, v23
    v_cvt_f32_u32 v16, v16
    v_cvt_f32_u32 v17, v17
    v_cvt_f32_u32 v18, v18
    v_cvt_f32_u32 v19, v19
    v_cvt_f32_u32 v20, v20
    v_cvt_f32_u32 v21, v21
    v_cvt_f32_u32 v22, v22
    v_cvt_f32_u32 v23, v23
    v_mul_f32 v16, 0x3c000000, v16
    v_mul_f32 v17, 0x3c000000, v17
    v_mul_f32 v18, 0x3c000000, v18
    v_mul_f32 v19, 0x3c000000, v19
    v_mul_f32 v20, 0x3c000000, v20
    v_mul_f32 v21, 0x3c000000, v21
    v_mul_f32 v22, 0x3c000000, v22
    v_mul_f32 v23, 0x3c000000, v23
    v_cos_f32 v16, v16
    v_cos_f32 v17, v17
    v_cos_f32 v18, v18
    v_cos_f32 v19, v19
    v_cos_f32 v20, v20
    v_cos_f32 v21, v21
    v_cos_f32 v22, v22
    v_cos_f32 v23, v23
    s_nop 0
    v_cvt_pk_bf16_f32 v24, v16, v17
    v_cvt_pk_bf16_f32 v25, v18, v19
    v_cvt_pk_bf16_f32 v26, v20, v21
    v_cvt_pk_bf16_f32 v27, v22, v23
    v_lshlrev_b32 v32, 16, v24
    v_and_b32 v33, 0xffff0000, v24
    v_sub_f32 v16, v16, v32
    v_sub_f32 v17, v17, v33
    v_lshlrev_b32 v32, 16, v25
    v_and_b32 v33, 0xffff0000, v25
    v_sub_f32 v18, v18, v32
    v_sub_f32 v19, v19, v33
    v_lshlrev_b32 v32, 16, v26
    v_and_b32 v33, 0xffff0000, v26
    v_sub_f32 v20, v20, v32
    v_sub_f32 v21, v21, v33
    v_lshlrev_b32 v32, 16, v27
    v_and_b32 v33, 0xffff0000, v27
    v_sub_f32 v22, v22, v32
    v_sub_f32 v23, v23, v33
    v_cvt_pk_bf16_f32 v28, v16, v17
    v_cvt_pk_bf16_f32 v29, v18, v19
    v_cvt_pk_bf16_f32 v30, v20, v21
    v_cvt_pk_bf16_f32 v31, v22, v23
    v_cmp_lt_u32 vcc, 1, v9
    s_lshl_b32 s28, s3, 10
    s_add_u32 s28, s28, 133120
    v_add_u32 v14, s28, v1
    v_cndmask_b32 v24, v24, v28, vcc
    v_cndmask_b32 v25, v25, v29, vcc
    v_cndmask_b32 v26, v26, v30, vcc
    v_cndmask_b32 v27, v27, v31, vcc
    ds_write_b128 v14, v[24:27]
    v_mov_b32 v12, 0
    v_mov_b32 v13, 0
    v_mov_b32 v14, 0
    v_mov_b32 v15, 0
    s_mul_i32 s28, s3, 38912
    s_add_u32 s28, s28, 22272
    v_add_u32 v16, s28, v1
    s_mov_b64 exec, 0xffff
    ds_write_b128 v16, v[12:15]
    s_mov_b64 exec, -1
    s_lshl_b32 s28, s3, 2
    s_add_u32 s28, s28, 155648
    v_mov_b32 v16, s28
    ds_write_b32 v16, v12
    s_lshl_b32 s28, s3, 3
    s_add_u32 s28, s28, 155680
    v_mov_b32 v16, s28
    ds_write_b64 v16, v[12:13]
    s_lshl_b32 s28, s3, 3
    s_add_u32 s28, s28, 155712
    v_mov_b32 v16, s28
    ds_write_b64 v16, v[12:13]
    s_lshl_b32 s28, s3, 3
    s_add_u32 s28, s28, 155840
    v_mov_b32 v16, s28
    ds_write_b64 v16, v[12:13]
    v_mov_b32 v16, 155664
    ds_write_b32 v16, v12
    v_mov_b32 v16, 155744
    v_mov_b32 v17, 1
    ds_write_b32 v16, v17
    s_waitcnt lgkmcnt(0)
    s_barrier
    v_mov_b32 v80, 0
    v_mov_b32 v81, 0
    v_mov_b32 v82, 0
    v_mov_b32 v83, 0
    v_mov_b32 v84, 0
    v_mov_b32 v85, 0
    v_mov_b32 v86, 0
    v_mov_b32 v87, 0
    v_mov_b32 v88, 0
    v_mov_b32 v89, 0
    v_mov_b32 v90, 0
    v_mov_b32 v91, 0
    v_mov_b32 v92, 0
    v_mov_b32 v93, 0
    v_mov_b32 v94, 0
    v_mov_b32 v95, 0
    v_mov_b32 v96, 0
    v_mov_b32 v97, 0
    v_mov_b32 v98, 0
    v_mov_b32 v99, 0
    v_mov_b32 v100, 0
    v_mov_b32 v101, 0
    v_mov_b32 v102, 0
    v_mov_b32 v103, 0
    v_mov_b32 v104, 0
    v_mov_b32 v105, 0
    v_mov_b32 v106, 0
    v_mov_b32 v107, 0
    v_mov_b32 v108, 0
    v_mov_b32 v109, 0
    v_mov_b32 v110, 0
    v_mov_b32 v111, 0
    v_mov_b32 v112, 0
    v_mov_b32 v113, 0
    v_mov_b32 v114, 0
    v_mov_b32 v115, 0
    v_mov_b32 v116, 0
    v_mov_b32 v117, 0
    v_mov_b32 v118, 0
    v_mov_b32 v119, 0
    v_mov_b32 v120, 0
    v_mov_b32 v121, 0
    v_mov_b32 v122, 0
    v_mov_b32 v123, 0
    v_mov_b32 v124, 0
    v_mov_b32 v125, 0
    v_mov_b32 v126, 0
    v_mov_b32 v127, 0
    v_mov_b32 v128, 0
    v_mov_b32 v129, 0
    v_mov_b32 v130, 0
    v_mov_b32 v131, 0
    v_mov_b32 v132, 0
    v_mov_b32 v133, 0
    v_mov_b32 v134, 0
    v_mov_b32 v135, 0
    v_mov_b32 v136, 0
    v_mov_b32 v137, 0
    v_mov_b32 v138, 0
    v_mov_b32 v139, 0
    v_mov_b32 v140, 0
    v_mov_b32 v141, 0
    v_mov_b32 v142, 0
    v_mov_b32 v143, 0
    v_mov_b32 v144, 0
    v_mov_b32 v145, 0
    v_mov_b32 v146, 0
    v_mov_b32 v147, 0
    v_mov_b32 v148, 0
    v_mov_b32 v149, 0
    v_mov_b32 v150, 0
    v_mov_b32 v151, 0
    v_mov_b32 v152, 0
    v_mov_b32 v153, 0
    v_mov_b32 v154, 0
    v_mov_b32 v155, 0
    v_mov_b32 v156, 0
    v_mov_b32 v157, 0
    v_mov_b32 v158, 0
    v_mov_b32 v159, 0
    v_mov_b32 v160, 0
    v_mov_b32 v161, 0
    v_mov_b32 v162, 0
    v_mov_b32 v163, 0
    v_mov_b32 v164, 0
    v_mov_b32 v165, 0
    v_mov_b32 v166, 0
    v_mov_b32 v167, 0
    v_mov_b32 v168, 0
    v_mov_b32 v169, 0
    v_mov_b32 v170, 0
    v_mov_b32 v171, 0
    v_mov_b32 v172, 0
    v_mov_b32 v173, 0
    v_mov_b32 v174, 0
    v_mov_b32 v175, 0
    v_mov_b32 v176, 0
    v_mov_b32 v177, 0
    v_mov_b32 v178, 0
    v_mov_b32 v179, 0
    v_mov_b32 v180, 0
    v_mov_b32 v181, 0
    v_mov_b32 v182, 0
    v_mov_b32 v183, 0
    v_mov_b32 v184, 0
    v_mov_b32 v185, 0
    v_mov_b32 v186, 0
    v_mov_b32 v187, 0
    v_mov_b32 v188, 0
    v_mov_b32 v189, 0
    v_mov_b32 v190, 0
    v_mov_b32 v191, 0
    v_mov_b32 v192, 0
    v_mov_b32 v193, 0
    v_mov_b32 v194, 0
    v_mov_b32 v195, 0
    v_mov_b32 v196, 0
    v_mov_b32 v197, 0
    v_mov_b32 v198, 0
    v_mov_b32 v199, 0
    v_mov_b32 v200, 0
    v_mov_b32 v201, 0
    v_mov_b32 v202, 0
    v_mov_b32 v203, 0
    v_mov_b32 v204, 0
    v_mov_b32 v205, 0
    v_mov_b32 v206, 0
    v_mov_b32 v207, 0
    v_mov_b32 v208, 0
    v_mov_b32 v209, 0
    v_mov_b32 v210, 0
    v_mov_b32 v211, 0
    v_mov_b32 v212, 0
    v_mov_b32 v213, 0
    v_mov_b32 v214, 0
    v_mov_b32 v215, 0
    v_mov_b32 v216, 0
    v_mov_b32 v217, 0
    v_mov_b32 v218, 0
    v_mov_b32 v219, 0
    v_mov_b32 v220, 0
    v_mov_b32 v221, 0
    v_mov_b32 v222, 0
    v_mov_b32 v223, 0
    v_mov_b32 v224, 0
    v_mov_b32 v225, 0
    v_mov_b32 v226, 0
    v_mov_b32 v227, 0
    v_mov_b32 v228, 0
    v_mov_b32 v229, 0
    v_mov_b32 v230, 0
    v_mov_b32 v231, 0
    v_mov_b32 v232, 0
    v_mov_b32 v233, 0
    v_mov_b32 v234, 0
    v_mov_b32 v235, 0
    v_mov_b32 v236, 0
    v_mov_b32 v237, 0
    v_mov_b32 v238, 0
    v_mov_b32 v239, 0
    v_mov_b32 v240, 0
    v_mov_b32 v241, 0
    v_mov_b32 v242, 0
    v_mov_b32 v243, 0
    v_mov_b32 v244, 0
    v_mov_b32 v245, 0
    v_mov_b32 v246, 0
    v_mov_b32 v247, 0
    v_mov_b32 v248, 0
    v_mov_b32 v249, 0
    v_mov_b32 v250, 0
    v_mov_b32 v251, 0
    v_mov_b32 v252, 0
    v_mov_b32 v253, 0
    v_mov_b32 v254, 0
    v_mov_b32 v255, 0
    s_barrier
    s_mov_b32 s40, 2
    v_mov_b32 v0, s40
    s_waitcnt vmcnt(21)
    ds_write_b32 v7, v0
    s_branch K12_S0
K12_Q0:
    ds_read_b64_tr_b16 v[40:41], v4 offset:0
    ds_read_b64_tr_b16 v[42:43], v4 offset:2048
    ds_read_b64_tr_b16 v[44:45], v4 offset:256
    ds_read_b64_tr_b16 v[46:47], v4 offset:2304
    v_xor_b32 v4, 32, v4
    ds_read_b64_tr_b16 v[48:49], v4 offset:0
    ds_read_b64_tr_b16 v[50:51], v4 offset:2048
    ds_read_b64_tr_b16 v[52:53], v4 offset:256
    ds_read_b64_tr_b16 v[54:55], v4 offset:2304
    v_xor_b32 v4, 32, v4
    ds_read_b128 v[8:11], v2 offset:0
    ds_read_b128 v[12:15], v3 offset:0
    ds_read_b128 v[16:19], v2 offset:2048
    ds_read_b128 v[20:23], v3 offset:2048
    ds_read_b128 v[32:35], v2 offset:6144
    ds_read_b128 v[36:39], v3 offset:6144
    ds_read_b32 v68, v5
    s_waitcnt lgkmcnt(7)
    v_xor_b32 v72, s35, v44
    v_xor_b32 v73, s35, v45
    v_xor_b32 v74, s35, v46
    v_xor_b32 v75, s35, v47
    v_xor_b32 v76, s35, v52
    v_xor_b32 v77, s35, v53
    v_xor_b32 v78, s35, v54
    v_xor_b32 v79, s35, v55
    s_mov_b32 s41, 0
    s_mov_b32 s42, 38912
    s_mov_b32 s39, 0
    s_mov_b32 s29, 116736
K12_LOOP:
    s_waitcnt lgkmcnt(2)
    v_mfma_f32_16x16x32_bf16 v[80:83], v[8:11], v[40:43], v[80:83]
    ds_read_b128 v[24:27], v2 offset:4096
    v_xor_b32 v72, s35, v44
    v_xor_b32 v73, s35, v45
    v_mfma_f32_16x16x32_bf16 v[84:87], v[8:11], v[44:47], v[84:87]
    ds_read_b128 v[28:31], v3 offset:4096
    v_xor_b32 v74, s35, v46
    v_xor_b32 v75, s35, v47
    v_mfma_f32_16x16x32_bf16 v[88:91], v[8:11], v[48:51], v[88:91]
    s_waitcnt lgkmcnt(2)
    v_cmp_gt_u32 vcc, s40, v68
    s_add_u32 s49, s39, 2
    s_lshr_b32 s49, s49, 1
    v_xor_b32 v76, s35, v52
    v_xor_b32 v77, s35, v53
    v_mfma_f32_16x16x32_bf16 v[92:95], v[8:11], v[52:55], v[92:95]
    s_cbranch_vccnz K12_S1
K12_Q1:
    s_mul_i32 s48, s49, s50
    s_add_u32 s48, s48, s47
    v_xor_b32 v78, s35, v54
    v_xor_b32 v79, s35, v55
    v_mfma_f32_16x16x32_bf16 v[80:83], v[12:15], v[72:75], v[80:83]
    s_add_u32 m0, s29, s36
    s_nop 0
    buffer_load_dwordx4 v1, s[8:11], s30 offen sc1 lds
    v_mfma_f32_16x16x32_bf16 v[84:87], v[12:15], v[40:43], v[84:87]
    s_cmp_lt_u32 s49, 8
    s_cselect_b32 s48, s48, 155744
    v_mfma_f32_16x16x32_bf16 v[88:91], v[12:15], v[76:79], v[88:91]
    s_cmp_ge_u32 s49, 3
    s_cselect_b32 s48, s48, 155744
    v_mfma_f32_16x16x32_bf16 v[92:95], v[12:15], v[48:51], v[92:95]
    v_mfma_f32_16x16x32_bf16 v[96:99], v[16:19], v[40:43], v[96:99]
    ds_read_b128 v[8:11], v2 offset:8192
    v_mfma_f32_16x16x32_bf16 v[100:103], v[16:19], v[44:47], v[100:103]
    ds_read_b128 v[12:15], v3 offset:8192
    v_mfma_f32_16x16x32_bf16 v[104:107], v[16:19], v[48:51], v[104:107]
    buffer_load_dwordx4 v1, s[8:11], s30 offen offset:1024 sc1 lds
    v_mfma_f32_16x16x32_bf16 v[108:111], v[16:19], v[52:55], v[108:111]
    v_mfma_f32_16x16x32_bf16 v[96:99], v[20:23], v[72:75], v[96:99]
    v_mfma_f32_16x16x32_bf16 v[100:103], v[20:23], v[40:43], v[100:103]
    v_mfma_f32_16x16x32_bf16 v[104:107], v[20:23], v[76:79], v[104:107]
    buffer_load_dwordx4 v1, s[8:11], s30 offen offset:2048 sc1 lds
    v_mfma_f32_16x16x32_bf16 v[108:111], v[20:23], v[48:51], v[108:111]
    s_waitcnt lgkmcnt(2)
    v_mfma_f32_16x16x32_bf16 v[112:115], v[24:27], v[40:43], v[112:115]
    ds_read_b128 v[16:19], v2 offset:10240
    v_mfma_f32_16x16x32_bf16 v[116:119], v[24:27], v[44:47], v[116:119]
    ds_read_b128 v[20:23], v3 offset:10240
    v_mfma_f32_16x16x32_bf16 v[120:123], v[24:27], v[48:51], v[120:123]
    v_mfma_f32_16x16x32_bf16 v[124:127], v[24:27], v[52:55], v[124:127]
    v_mfma_f32_16x16x32_bf16 v[112:115], v[28:31], v[72:75], v[112:115]
    buffer_load_dwordx4 v1, s[8:11], s30 offen offset:3072 sc1 lds
    v_mfma_f32_16x16x32_bf16 v[116:119], v[28:31], v[40:43], v[116:119]
    v_mfma_f32_16x16x32_bf16 v[120:123], v[28:31], v[76:79], v[120:123]
    v_mfma_f32_16x16x32_bf16 v[124:127], v[28:31], v[48:51], v[124:127]
    v_mfma_f32_16x16x32_bf16 v[128:131], v[32:35], v[40:43], v[128:131]
    ds_read_b128 v[24:27], v2 offset:12288
    v_mfma_f32_16x16x32_bf16 v[132:135], v[32:35], v[44:47], v[132:135]
    ds_read_b128 v[28:31], v3 offset:12288
    v_mfma_f32_16x16x32_bf16 v[136:139], v[32:35], v[48:51], v[136:139]
    s_add_u32 m0, m0, 4096
    s_add_u32 s34, s30, 4096
    buffer_load_dwordx4 v1, s[8:11], s34 offen sc1 lds
    v_mfma_f32_16x16x32_bf16 v[140:143], v[32:35], v[52:55], v[140:143]
    v_mfma_f32_16x16x32_bf16 v[128:131], v[36:39], v[72:75], v[128:131]
    v_mfma_f32_16x16x32_bf16 v[132:135], v[36:39], v[40:43], v[132:135]
    v_mfma_f32_16x16x32_bf16 v[136:139], v[36:39], v[76:79], v[136:139]
    s_add_u32 m0, s29, s37
    s_add_u32 s30, s30, 21376
    buffer_load_dwordx4 v1, s[12:15], s31 offen sc1 lds
    v_mfma_f32_16x16x32_bf16 v[140:143], v[36:39], v[48:51], v[140:143]
    s_waitcnt lgkmcnt(4)
    v_mfma_f32_16x16x32_bf16 v[144:147], v[8:11], v[40:43], v[144:147]
    ds_read_b128 v[32:35], v2 offset:14336
    v_mfma_f32_16x16x32_bf16 v[148:151], v[8:11], v[44:47], v[148:151]
    ds_read_b128 v[36:39], v3 offset:14336
    v_mfma_f32_16x16x32_bf16 v[152:155], v[8:11], v[48:51], v[152:155]
    v_mfma_f32_16x16x32_bf16 v[156:159], v[8:11], v[52:55], v[156:159]
    v_mfma_f32_16x16x32_bf16 v[144:147], v[12:15], v[72:75], v[144:147]
    buffer_load_dwordx4 v1, s[12:15], s31 offen offset:1024 sc1 lds
    v_mfma_f32_16x16x32_bf16 v[148:151], v[12:15], v[40:43], v[148:151]
    v_mfma_f32_16x16x32_bf16 v[152:155], v[12:15], v[76:79], v[152:155]
    v_mfma_f32_16x16x32_bf16 v[156:159], v[12:15], v[48:51], v[156:159]
    s_waitcnt lgkmcnt(4)
    v_mfma_f32_16x16x32_bf16 v[160:163], v[16:19], v[40:43], v[160:163]
    ds_read_b128 v[8:11], v2 offset:16384
    v_mfma_f32_16x16x32_bf16 v[164:167], v[16:19], v[44:47], v[164:167]
    ds_read_b128 v[12:15], v3 offset:16384
    v_mfma_f32_16x16x32_bf16 v[168:171], v[16:19], v[48:51], v[168:171]
    buffer_load_dwordx4 v1, s[12:15], s31 offen offset:2048 sc1 lds
    v_mfma_f32_16x16x32_bf16 v[172:175], v[16:19], v[52:55], v[172:175]
    s_add_u32 s40, s40, 1
    s_mov_b32 s51, s40
    v_mov_b32 v0, s40
    v_mfma_f32_16x16x32_bf16 v[160:163], v[20:23], v[72:75], v[160:163]
    s_waitcnt vmcnt(19)
    ds_write_b32 v7, v0
    v_mfma_f32_16x16x32_bf16 v[164:167], v[20:23], v[40:43], v[164:167]
    v_mfma_f32_16x16x32_bf16 v[168:171], v[20:23], v[76:79], v[168:171]
    buffer_load_dwordx4 v1, s[12:15], s31 offen offset:3072 sc1 lds
    v_mfma_f32_16x16x32_bf16 v[172:175], v[20:23], v[48:51], v[172:175]
    s_waitcnt lgkmcnt(5)
    v_mfma_f32_16x16x32_bf16 v[176:179], v[24:27], v[40:43], v[176:179]
    ds_read_b128 v[16:19], v2 offset:18432
    v_mfma_f32_16x16x32_bf16 v[180:183], v[24:27], v[44:47], v[180:183]
    ds_read_b128 v[20:23], v3 offset:18432
    v_mov_b32 v0, s48
    v_mfma_f32_16x16x32_bf16 v[184:187], v[24:27], v[48:51], v[184:187]
    ds_read_b32 v0, v0
    v_mfma_f32_16x16x32_bf16 v[188:191], v[24:27], v[52:55], v[188:191]
    v_mfma_f32_16x16x32_bf16 v[176:179], v[28:31], v[72:75], v[176:179]
    s_add_u32 m0, s29, s38
    s_mov_b64 exec, s[44:45]
    buffer_load_dwordx4 v1, s[64:67], s33 offen sc1 lds
    s_mov_b64 exec, -1
    s_add_u32 s31, s31, 16384
    s_add_u32 s33, s33, 21376
    v_mfma_f32_16x16x32_bf16 v[180:183], v[28:31], v[40:43], v[180:183]
    v_mfma_f32_16x16x32_bf16 v[184:187], v[28:31], v[76:79], v[184:187]
    v_mfma_f32_16x16x32_bf16 v[188:191], v[28:31], v[48:51], v[188:191]
    s_waitcnt lgkmcnt(0)
    v_cmp_eq_u32 vcc, 0, v0
    v_mfma_f32_16x16x32_bf16 v[192:195], v[32:35], v[40:43], v[192:195]
    ds_read_b128 v[24:27], v2 offset:20480
    v_mfma_f32_16x16x32_bf16 v[196:199], v[32:35], v[44:47], v[196:199]
    ds_read_b128 v[28:31], v3 offset:20480
    s_cbranch_vccnz K12_F2
K12_G2:
    v_mfma_f32_16x16x32_bf16 v[200:203], v[32:35], v[48:51], v[200:203]
    s_sub_u32 s43, s42, s41
    s_add_u32 s40, s40, 1
    v_add_u32 v2, s43, v2
    v_mfma_f32_16x16x32_bf16 v[204:207], v[32:35], v[52:55], v[204:207]
    v_add_u32 v3, s43, v3
    v_add_u32 v4, s43, v4
    v_mov_b32 v0, s40
    v_mfma_f32_16x16x32_bf16 v[192:195], v[36:39], v[72:75], v[192:195]
    ds_write_b32 v7, v0
    v_mfma_f32_16x16x32_bf16 v[196:199], v[36:39], v[40:43], v[196:199]
    v_mfma_f32_16x16x32_bf16 v[200:203], v[36:39], v[76:79], v[200:203]
    v_mfma_f32_16x16x32_bf16 v[204:207], v[36:39], v[48:51], v[204:207]
    ds_read_b32 v56, v5
    v_mfma_f32_16x16x32_bf16 v[208:211], v[8:11], v[40:43], v[208:211]
    v_mfma_f32_16x16x32_bf16 v[212:215], v[8:11], v[44:47], v[212:215]
    v_mfma_f32_16x16x32_bf16 v[216:219], v[8:11], v[48:51], v[216:219]
    v_mfma_f32_16x16x32_bf16 v[220:223], v[8:11], v[52:55], v[220:223]
    s_waitcnt lgkmcnt(0)
    v_cmp_gt_u32 vcc, s51, v56
    v_mfma_f32_16x16x32_bf16 v[208:211], v[12:15], v[72:75], v[208:211]
    v_mfma_f32_16x16x32_bf16 v[212:215], v[12:15], v[40:43], v[212:215]
    s_cbranch_vccnz K12_S3
K12_Q3:
    v_mfma_f32_16x16x32_bf16 v[216:219], v[12:15], v[76:79], v[216:219]
    ds_read_b64_tr_b16 v[56:57], v4 offset:0
    v_mfma_f32_16x16x32_bf16 v[220:223], v[12:15], v[48:51], v[220:223]
    ds_read_b64_tr_b16 v[58:59], v4 offset:2048
    v_mfma_f32_16x16x32_bf16 v[224:227], v[16:19], v[40:43], v[224:227]
    ds_read_b64_tr_b16 v[60:61], v4 offset:256
    ds_read_b128 v[8:11], v2 offset:0
    v_mfma_f32_16x16x32_bf16 v[228:231], v[16:19], v[44:47], v[228:231]
    ds_read_b64_tr_b16 v[62:63], v4 offset:2304
    ds_read_b128 v[12:15], v3 offset:0
    v_mfma_f32_16x16x32_bf16 v[232:235], v[16:19], v[48:51], v[232:235]
    v_xor_b32 v4, 32, v4
    ds_read_b128 v[32:35], v2 offset:6144
    v_mfma_f32_16x16x32_bf16 v[236:239], v[16:19], v[52:55], v[236:239]
    ds_read_b64_tr_b16 v[64:65], v4 offset:0
    ds_read_b128 v[36:39], v3 offset:6144
    v_mfma_f32_16x16x32_bf16 v[224:227], v[20:23], v[72:75], v[224:227]
    ds_read_b64_tr_b16 v[66:67], v4 offset:2048
    ds_read_b32 v52, v5
    v_mfma_f32_16x16x32_bf16 v[228:231], v[20:23], v[40:43], v[228:231]
    ds_read_b64_tr_b16 v[68:69], v4 offset:256
    ds_read_b64_tr_b16 v[70:71], v4 offset:2304
    v_xor_b32 v4, 32, v4
    v_mfma_f32_16x16x32_bf16 v[232:235], v[20:23], v[76:79], v[232:235]
    v_mfma_f32_16x16x32_bf16 v[236:239], v[20:23], v[48:51], v[236:239]
    v_mfma_f32_16x16x32_bf16 v[240:243], v[24:27], v[40:43], v[240:243]
    ds_read_b128 v[16:19], v2 offset:2048
    v_mfma_f32_16x16x32_bf16 v[244:247], v[24:27], v[44:47], v[244:247]
    ds_read_b128 v[20:23], v3 offset:2048
    v_mfma_f32_16x16x32_bf16 v[240:243], v[28:31], v[72:75], v[240:243]
    s_mov_b32 s29, s41
    s_mov_b32 s41, s42
    s_add_u32 s42, s42, 38912
    v_mfma_f32_16x16x32_bf16 v[244:247], v[28:31], v[40:43], v[244:247]
    s_cmp_eq_u32 s42, 155648
    s_cselect_b32 s42, 0, s42
    s_waitcnt lgkmcnt(2)
    v_mfma_f32_16x16x32_bf16 v[80:83], v[8:11], v[56:59], v[80:83]
    ds_read_b128 v[24:27], v2 offset:4096
    v_xor_b32 v72, s35, v60
    v_xor_b32 v73, s35, v61
    v_mfma_f32_16x16x32_bf16 v[84:87], v[8:11], v[60:63], v[84:87]
    ds_read_b128 v[28:31], v3 offset:4096
    v_xor_b32 v74, s35, v62
    v_xor_b32 v75, s35, v63
    v_mfma_f32_16x16x32_bf16 v[88:91], v[8:11], v[64:67], v[88:91]
    s_waitcnt lgkmcnt(2)
    v_cmp_gt_u32 vcc, s40, v52
    v_xor_b32 v76, s35, v68
    v_xor_b32 v77, s35, v69
    v_mfma_f32_16x16x32_bf16 v[92:95], v[8:11], v[68:71], v[92:95]
    s_cbranch_vccnz K12_S4
K12_Q4:
    v_xor_b32 v78, s35, v70
    v_xor_b32 v79, s35, v71
    v_mfma_f32_16x16x32_bf16 v[80:83], v[12:15], v[72:75], v[80:83]
    s_add_u32 m0, s29, s36
    s_nop 0
    buffer_load_dwordx4 v1, s[8:11], s30 offen sc1 lds
    v_mfma_f32_16x16x32_bf16 v[84:87], v[12:15], v[56:59], v[84:87]
    v_mfma_f32_16x16x32_bf16 v[88:91], v[12:15], v[76:79], v[88:91]
    v_mfma_f32_16x16x32_bf16 v[92:95], v[12:15], v[64:67], v[92:95]
    v_mfma_f32_16x16x32_bf16 v[96:99], v[16:19], v[56:59], v[96:99]
    ds_read_b128 v[8:11], v2 offset:8192
    v_mfma_f32_16x16x32_bf16 v[100:103], v[16:19], v[60:63], v[100:103]
    ds_read_b128 v[12:15], v3 offset:8192
    v_mfma_f32_16x16x32_bf16 v[104:107], v[16:19], v[64:67], v[104:107]
    buffer_load_dwordx4 v1, s[8:11], s30 offen offset:1024 sc1 lds
    v_mfma_f32_16x16x32_bf16 v[108:111], v[16:19], v[68:71], v[108:111]
    v_mfma_f32_16x16x32_bf16 v[96:99], v[20:23], v[72:75], v[96:99]
    v_mfma_f32_16x16x32_bf16 v[100:103], v[20:23], v[56:59], v[100:103]
    v_mfma_f32_16x16x32_bf16 v[104:107], v[20:23], v[76:79], v[104:107]
    buffer_load_dwordx4 v1, s[8:11], s30 offen offset:2048 sc1 lds
    v_mfma_f32_16x16x32_bf16 v[108:111], v[20:23], v[64:67], v[108:111]
    s_waitcnt lgkmcnt(2)
    v_mfma_f32_16x16x32_bf16 v[112:115], v[24:27], v[56:59], v[112:115]
    ds_read_b128 v[16:19], v2 offset:10240
    v_mfma_f32_16x16x32_bf16 v[116:119], v[24:27], v[60:63], v[116:119]
    ds_read_b128 v[20:23], v3 offset:10240
    v_mfma_f32_16x16x32_bf16 v[120:123], v[24:27], v[64:67], v[120:123]
    v_mfma_f32_16x16x32_bf16 v[124:127], v[24:27], v[68:71], v[124:127]
    v_mfma_f32_16x16x32_bf16 v[112:115], v[28:31], v[72:75], v[112:115]
    buffer_load_dwordx4 v1, s[8:11], s30 offen offset:3072 sc1 lds
    v_mfma_f32_16x16x32_bf16 v[116:119], v[28:31], v[56:59], v[116:119]
    v_mfma_f32_16x16x32_bf16 v[120:123], v[28:31], v[76:79], v[120:123]
    v_mfma_f32_16x16x32_bf16 v[124:127], v[28:31], v[64:67], v[124:127]
    v_mfma_f32_16x16x32_bf16 v[128:131], v[32:35], v[56:59], v[128:131]
    ds_read_b128 v[24:27], v2 offset:12288
    v_mfma_f32_16x16x32_bf16 v[132:135], v[32:35], v[60:63], v[132:135]
    ds_read_b128 v[28:31], v3 offset:12288
    v_mfma_f32_16x16x32_bf16 v[136:139], v[32:35], v[64:67], v[136:139]
    s_add_u32 m0, m0, 4096
    s_add_u32 s34, s30, 4096
    buffer_load_dwordx4 v1, s[8:11], s34 offen sc1 lds
    v_mfma_f32_16x16x32_bf16 v[140:143], v[32:35], v[68:71], v[140:143]
    v_mfma_f32_16x16x32_bf16 v[128:131], v[36:39], v[72:75], v[128:131]
    v_mfma_f32_16x16x32_bf16 v[132:135], v[36:39], v[56:59], v[132:135]
    v_mfma_f32_16x16x32_bf16 v[136:139], v[36:39], v[76:79], v[136:139]
    s_add_u32 m0, s29, s37
    s_add_u32 s30, s30, 21376
    buffer_load_dwordx4 v1, s[12:15], s31 offen sc1 lds
    v_mfma_f32_16x16x32_bf16 v[140:143], v[36:39], v[64:67], v[140:143]
    s_waitcnt lgkmcnt(4)
    v_mfma_f32_16x16x32_bf16 v[144:147], v[8:11], v[56:59], v[144:147]
    ds_read_b128 v[32:35], v2 offset:14336
    v_mfma_f32_16x16x32_bf16 v[148:151], v[8:11], v[60:63], v[148:151]
    ds_read_b128 v[36:39], v3 offset:14336
    v_mfma_f32_16x16x32_bf16 v[152:155], v[8:11], v[64:67], v[152:155]
    v_mfma_f32_16x16x32_bf16 v[156:159], v[8:11], v[68:71], v[156:159]
    v_mfma_f32_16x16x32_bf16 v[144:147], v[12:15], v[72:75], v[144:147]
    buffer_load_dwordx4 v1, s[12:15], s31 offen offset:1024 sc1 lds
    v_mfma_f32_16x16x32_bf16 v[148:151], v[12:15], v[56:59], v[148:151]
    v_mfma_f32_16x16x32_bf16 v[152:155], v[12:15], v[76:79], v[152:155]
    v_mfma_f32_16x16x32_bf16 v[156:159], v[12:15], v[64:67], v[156:159]
    s_waitcnt lgkmcnt(4)
    v_mfma_f32_16x16x32_bf16 v[160:163], v[16:19], v[56:59], v[160:163]
    ds_read_b128 v[8:11], v2 offset:16384
    v_mfma_f32_16x16x32_bf16 v[164:167], v[16:19], v[60:63], v[164:167]
    ds_read_b128 v[12:15], v3 offset:16384
    v_mfma_f32_16x16x32_bf16 v[168:171], v[16:19], v[64:67], v[168:171]
    buffer_load_dwordx4 v1, s[12:15], s31 offen offset:2048 sc1 lds
    v_mfma_f32_16x16x32_bf16 v[172:175], v[16:19], v[68:71], v[172:175]
    s_add_u32 s40, s40, 1
    s_mov_b32 s51, s40
    v_mov_b32 v0, s40
    v_mfma_f32_16x16x32_bf16 v[160:163], v[20:23], v[72:75], v[160:163]
    s_waitcnt vmcnt(19)
    ds_write_b32 v7, v0
    v_mfma_f32_16x16x32_bf16 v[164:167], v[20:23], v[56:59], v[164:167]
    v_mfma_f32_16x16x32_bf16 v[168:171], v[20:23], v[76:79], v[168:171]
    buffer_load_dwordx4 v1, s[12:15], s31 offen offset:3072 sc1 lds
    v_mfma_f32_16x16x32_bf16 v[172:175], v[20:23], v[64:67], v[172:175]
    s_waitcnt lgkmcnt(5)
    v_mfma_f32_16x16x32_bf16 v[176:179], v[24:27], v[56:59], v[176:179]
    ds_read_b128 v[16:19], v2 offset:18432
    v_mfma_f32_16x16x32_bf16 v[180:183], v[24:27], v[60:63], v[180:183]
    ds_read_b128 v[20:23], v3 offset:18432
    v_mfma_f32_16x16x32_bf16 v[184:187], v[24:27], v[64:67], v[184:187]
    v_mfma_f32_16x16x32_bf16 v[188:191], v[24:27], v[68:71], v[188:191]
    v_mfma_f32_16x16x32_bf16 v[176:179], v[28:31], v[72:75], v[176:179]
    s_add_u32 m0, s29, s38
    s_mov_b64 exec, s[44:45]
    buffer_load_dwordx4 v1, s[64:67], s33 offen sc1 lds
    s_mov_b64 exec, -1
    s_add_u32 s31, s31, 16384
    s_add_u32 s33, s33, 21376
    v_mfma_f32_16x16x32_bf16 v[180:183], v[28:31], v[56:59], v[180:183]
    v_mfma_f32_16x16x32_bf16 v[184:187], v[28:31], v[76:79], v[184:187]
    s_mov_b32 m0, s46
    s_mov_b64 exec, 0xff
    buffer_load_dword v1, s[4:7], 0 offen sc1 lds
    s_mov_b64 exec, -1
    v_mfma_f32_16x16x32_bf16 v[188:191], v[28:31], v[64:67], v[188:191]
    s_waitcnt lgkmcnt(5)
    v_mfma_f32_16x16x32_bf16 v[192:195], v[32:35], v[56:59], v[192:195]
    ds_read_b128 v[24:27], v2 offset:20480
    v_mfma_f32_16x16x32_bf16 v[196:199], v[32:35], v[60:63], v[196:199]
    ds_read_b128 v[28:31], v3 offset:20480
    v_mfma_f32_16x16x32_bf16 v[200:203], v[32:35], v[64:67], v[200:203]
    s_sub_u32 s43, s42, s41
    s_add_u32 s40, s40, 1
    v_add_u32 v2, s43, v2
    v_mfma_f32_16x16x32_bf16 v[204:207], v[32:35], v[68:71], v[204:207]
    v_add_u32 v3, s43, v3
    v_add_u32 v4, s43, v4
    v_mov_b32 v0, s40
    v_mfma_f32_16x16x32_bf16 v[192:195], v[36:39], v[72:75], v[192:195]
    ds_write_b32 v7, v0
    v_mfma_f32_16x16x32_bf16 v[196:199], v[36:39], v[56:59], v[196:199]
    v_mfma_f32_16x16x32_bf16 v[200:203], v[36:39], v[76:79], v[200:203]
    v_mfma_f32_16x16x32_bf16 v[204:207], v[36:39], v[64:67], v[204:207]
    ds_read_b32 v40, v5
    s_waitcnt lgkmcnt(7)
    v_mfma_f32_16x16x32_bf16 v[208:211], v[8:11], v[56:59], v[208:211]
    v_mfma_f32_16x16x32_bf16 v[212:215], v[8:11], v[60:63], v[212:215]
    v_mfma_f32_16x16x32_bf16 v[216:219], v[8:11], v[64:67], v[216:219]
    v_mfma_f32_16x16x32_bf16 v[220:223], v[8:11], v[68:71], v[220:223]
    s_waitcnt lgkmcnt(0)
    v_cmp_gt_u32 vcc, s51, v40
    v_mfma_f32_16x16x32_bf16 v[208:211], v[12:15], v[72:75], v[208:211]
    v_mfma_f32_16x16x32_bf16 v[212:215], v[12:15], v[56:59], v[212:215]
    s_cbranch_vccnz K12_S5
K12_Q5:
    v_mfma_f32_16x16x32_bf16 v[216:219], v[12:15], v[76:79], v[216:219]
    ds_read_b64_tr_b16 v[40:41], v4 offset:0
    v_mfma_f32_16x16x32_bf16 v[220:223], v[12:15], v[64:67], v[220:223]
    ds_read_b64_tr_b16 v[42:43], v4 offset:2048
    v_mfma_f32_16x16x32_bf16 v[224:227], v[16:19], v[56:59], v[224:227]
    ds_read_b64_tr_b16 v[44:45], v4 offset:256
    ds_read_b128 v[8:11], v2 offset:0
    v_mfma_f32_16x16x32_bf16 v[228:231], v[16:19], v[60:63], v[228:231]
    ds_read_b64_tr_b16 v[46:47], v4 offset:2304
    ds_read_b128 v[12:15], v3 offset:0
    v_mfma_f32_16x16x32_bf16 v[232:235], v[16:19], v[64:67], v[232:235]
    v_xor_b32 v4, 32, v4
    ds_read_b128 v[32:35], v2 offset:6144
    v_mfma_f32_16x16x32_bf16 v[236:239], v[16:19], v[68:71], v[236:239]
    ds_read_b64_tr_b16 v[48:49], v4 offset:0
    ds_read_b128 v[36:39], v3 offset:6144
    v_mfma_f32_16x16x32_bf16 v[224:227], v[20:23], v[72:75], v[224:227]
    ds_read_b64_tr_b16 v[50:51], v4 offset:2048
    ds_read_b32 v68, v5
    v_mfma_f32_16x16x32_bf16 v[228:231], v[20:23], v[56:59], v[228:231]
    ds_read_b64_tr_b16 v[52:53], v4 offset:256
    ds_read_b64_tr_b16 v[54:55], v4 offset:2304
    v_xor_b32 v4, 32, v4
    v_mfma_f32_16x16x32_bf16 v[232:235], v[20:23], v[76:79], v[232:235]
    v_mfma_f32_16x16x32_bf16 v[236:239], v[20:23], v[64:67], v[236:239]
    v_mfma_f32_16x16x32_bf16 v[240:243], v[24:27], v[56:59], v[240:243]
    ds_read_b128 v[16:19], v2 offset:2048
    v_mfma_f32_16x16x32_bf16 v[244:247], v[24:27], v[60:63], v[244:247]
    ds_read_b128 v[20:23], v3 offset:2048
    v_mfma_f32_16x16x32_bf16 v[240:243], v[28:31], v[72:75], v[240:243]
    s_mov_b32 s29, s41
    s_mov_b32 s41, s42
    s_add_u32 s42, s42, 38912
    v_mfma_f32_16x16x32_bf16 v[244:247], v[28:31], v[56:59], v[244:247]
    s_cmp_eq_u32 s42, 155648
    s_cselect_b32 s42, 0, s42
    s_add_u32 s39, s39, 1
    s_cmp_lt_u32 s39, 15
    s_cbranch_scc1 K12_LOOP
    s_waitcnt lgkmcnt(2)
    v_mfma_f32_16x16x32_bf16 v[80:83], v[8:11], v[40:43], v[80:83]
    ds_read_b128 v[24:27], v2 offset:4096
    v_xor_b32 v72, s35, v44
    v_xor_b32 v73, s35, v45
    v_mfma_f32_16x16x32_bf16 v[84:87], v[8:11], v[44:47], v[84:87]
    ds_read_b128 v[28:31], v3 offset:4096
    v_xor_b32 v74, s35, v46
    v_xor_b32 v75, s35, v47
    v_mfma_f32_16x16x32_bf16 v[88:91], v[8:11], v[48:51], v[88:91]
    s_waitcnt lgkmcnt(2)
    v_cmp_gt_u32 vcc, s40, v68
    s_add_u32 s49, s39, 2
    s_lshr_b32 s49, s49, 1
    v_xor_b32 v76, s35, v52
    v_xor_b32 v77, s35, v53
    v_mfma_f32_16x16x32_bf16 v[92:95], v[8:11], v[52:55], v[92:95]
    s_cbranch_vccnz K12_S6
K12_Q6:
    s_mul_i32 s48, s49, s50
    s_add_u32 s48, s48, s47
    v_xor_b32 v78, s35, v54
    v_xor_b32 v79, s35, v55
    v_mfma_f32_16x16x32_bf16 v[80:83], v[12:15], v[72:75], v[80:83]
    s_add_u32 m0, s29, s36
    s_nop 0
    buffer_load_dwordx4 v1, s[8:11], s30 offen sc1 lds
    v_mfma_f32_16x16x32_bf16 v[84:87], v[12:15], v[40:43], v[84:87]
    s_cmp_lt_u32 s49, 8
    s_cselect_b32 s48, s48, 155744
    v_mfma_f32_16x16x32_bf16 v[88:91], v[12:15], v[76:79], v[88:91]
    s_cmp_ge_u32 s49, 3
    s_cselect_b32 s48, s48, 155744
    v_mfma_f32_16x16x32_bf16 v[92:95], v[12:15], v[48:51], v[92:95]
    v_mfma_f32_16x16x32_bf16 v[96:99], v[16:19], v[40:43], v[96:99]
    ds_read_b128 v[8:11], v2 offset:8192
    v_mfma_f32_16x16x32_bf16 v[100:103], v[16:19], v[44:47], v[100:103]
    ds_read_b128 v[12:15], v3 offset:8192
    v_mfma_f32_16x16x32_bf16 v[104:107], v[16:19], v[48:51], v[104:107]
    buffer_load_dwordx4 v1, s[8:11], s30 offen offset:1024 sc1 lds
    v_mfma_f32_16x16x32_bf16 v[108:111], v[16:19], v[52:55], v[108:111]
    v_mfma_f32_16x16x32_bf16 v[96:99], v[20:23], v[72:75], v[96:99]
    v_mfma_f32_16x16x32_bf16 v[100:103], v[20:23], v[40:43], v[100:103]
    v_mfma_f32_16x16x32_bf16 v[104:107], v[20:23], v[76:79], v[104:107]
    buffer_load_dwordx4 v1, s[8:11], s30 offen offset:2048 sc1 lds
    v_mfma_f32_16x16x32_bf16 v[108:111], v[20:23], v[48:51], v[108:111]
    s_waitcnt lgkmcnt(2)
    v_mfma_f32_16x16x32_bf16 v[112:115], v[24:27], v[40:43], v[112:115]
    ds_read_b128 v[16:19], v2 offset:10240
    v_mfma_f32_16x16x32_bf16 v[116:119], v[24:27], v[44:47], v[116:119]
    ds_read_b128 v[20:23], v3 offset:10240
    v_mfma_f32_16x16x32_bf16 v[120:123], v[24:27], v[48:51], v[120:123]
    v_mfma_f32_16x16x32_bf16 v[124:127], v[24:27], v[52:55], v[124:127]
    v_mfma_f32_16x16x32_bf16 v[112:115], v[28:31], v[72:75], v[112:115]
    buffer_load_dwordx4 v1, s[8:11], s30 offen offset:3072 sc1 lds
    v_mfma_f32_16x16x32_bf16 v[116:119], v[28:31], v[40:43], v[116:119]
    v_mfma_f32_16x16x32_bf16 v[120:123], v[28:31], v[76:79], v[120:123]
    v_mfma_f32_16x16x32_bf16 v[124:127], v[28:31], v[48:51], v[124:127]
    v_mfma_f32_16x16x32_bf16 v[128:131], v[32:35], v[40:43], v[128:131]
    ds_read_b128 v[24:27], v2 offset:12288
    v_mfma_f32_16x16x32_bf16 v[132:135], v[32:35], v[44:47], v[132:135]
    ds_read_b128 v[28:31], v3 offset:12288
    v_mfma_f32_16x16x32_bf16 v[136:139], v[32:35], v[48:51], v[136:139]
    s_add_u32 m0, m0, 4096
    s_add_u32 s34, s30, 4096
    buffer_load_dwordx4 v1, s[8:11], s34 offen sc1 lds
    v_mfma_f32_16x16x32_bf16 v[140:143], v[32:35], v[52:55], v[140:143]
    v_mfma_f32_16x16x32_bf16 v[128:131], v[36:39], v[72:75], v[128:131]
    v_mfma_f32_16x16x32_bf16 v[132:135], v[36:39], v[40:43], v[132:135]
    v_mfma_f32_16x16x32_bf16 v[136:139], v[36:39], v[76:79], v[136:139]
    s_add_u32 m0, s29, s37
    s_add_u32 s30, s30, 21376
    buffer_load_dwordx4 v1, s[12:15], s31 offen sc1 lds
    v_mfma_f32_16x16x32_bf16 v[140:143], v[36:39], v[48:51], v[140:143]
    s_waitcnt lgkmcnt(4)
    v_mfma_f32_16x16x32_bf16 v[144:147], v[8:11], v[40:43], v[144:147]
    ds_read_b128 v[32:35], v2 offset:14336
    v_mfma_f32_16x16x32_bf16 v[148:151], v[8:11], v[44:47], v[148:151]
    ds_read_b128 v[36:39], v3 offset:14336
    v_mfma_f32_16x16x32_bf16 v[152:155], v[8:11], v[48:51], v[152:155]
    v_mfma_f32_16x16x32_bf16 v[156:159], v[8:11], v[52:55], v[156:159]
    v_mfma_f32_16x16x32_bf16 v[144:147], v[12:15], v[72:75], v[144:147]
    buffer_load_dwordx4 v1, s[12:15], s31 offen offset:1024 sc1 lds
    v_mfma_f32_16x16x32_bf16 v[148:151], v[12:15], v[40:43], v[148:151]
    v_mfma_f32_16x16x32_bf16 v[152:155], v[12:15], v[76:79], v[152:155]
    v_mfma_f32_16x16x32_bf16 v[156:159], v[12:15], v[48:51], v[156:159]
    s_waitcnt lgkmcnt(4)
    v_mfma_f32_16x16x32_bf16 v[160:163], v[16:19], v[40:43], v[160:163]
    ds_read_b128 v[8:11], v2 offset:16384
    v_mfma_f32_16x16x32_bf16 v[164:167], v[16:19], v[44:47], v[164:167]
    ds_read_b128 v[12:15], v3 offset:16384
    v_mfma_f32_16x16x32_bf16 v[168:171], v[16:19], v[48:51], v[168:171]
    buffer_load_dwordx4 v1, s[12:15], s31 offen offset:2048 sc1 lds
    v_mfma_f32_16x16x32_bf16 v[172:175], v[16:19], v[52:55], v[172:175]
    s_add_u32 s40, s40, 1
    s_mov_b32 s51, s40
    v_mov_b32 v0, s40
    v_mfma_f32_16x16x32_bf16 v[160:163], v[20:23], v[72:75], v[160:163]
    s_waitcnt vmcnt(19)
    ds_write_b32 v7, v0
    v_mfma_f32_16x16x32_bf16 v[164:167], v[20:23], v[40:43], v[164:167]
    v_mfma_f32_16x16x32_bf16 v[168:171], v[20:23], v[76:79], v[168:171]
    buffer_load_dwordx4 v1, s[12:15], s31 offen offset:3072 sc1 lds
    v_mfma_f32_16x16x32_bf16 v[172:175], v[20:23], v[48:51], v[172:175]
    s_waitcnt lgkmcnt(5)
    v_mfma_f32_16x16x32_bf16 v[176:179], v[24:27], v[40:43], v[176:179]
    ds_read_b128 v[16:19], v2 offset:18432
    v_mfma_f32_16x16x32_bf16 v[180:183], v[24:27], v[44:47], v[180:183]
    ds_read_b128 v[20:23], v3 offset:18432
    v_mov_b32 v0, s48
    v_mfma_f32_16x16x32_bf16 v[184:187], v[24:27], v[48:51], v[184:187]
    ds_read_b32 v0, v0
    v_mfma_f32_16x16x32_bf16 v[188:191], v[24:27], v[52:55], v[188:191]
    v_mfma_f32_16x16x32_bf16 v[176:179], v[28:31], v[72:75], v[176:179]
    s_add_u32 m0, s29, s38
    s_mov_b64 exec, s[44:45]
    buffer_load_dwordx4 v1, s[64:67], s33 offen sc1 lds
    s_mov_b64 exec, -1
    s_add_u32 s31, s31, 16384
    s_add_u32 s33, s33, 21376
    v_mfma_f32_16x16x32_bf16 v[180:183], v[28:31], v[40:43], v[180:183]
    v_mfma_f32_16x16x32_bf16 v[184:187], v[28:31], v[76:79], v[184:187]
    v_mfma_f32_16x16x32_bf16 v[188:191], v[28:31], v[48:51], v[188:191]
    s_waitcnt lgkmcnt(0)
    v_cmp_eq_u32 vcc, 0, v0
    v_mfma_f32_16x16x32_bf16 v[192:195], v[32:35], v[40:43], v[192:195]
    ds_read_b128 v[24:27], v2 offset:20480
    v_mfma_f32_16x16x32_bf16 v[196:199], v[32:35], v[44:47], v[196:199]
    ds_read_b128 v[28:31], v3 offset:20480
    s_cbranch_vccnz K12_F7
K12_G7:
    v_mfma_f32_16x16x32_bf16 v[200:203], v[32:35], v[48:51], v[200:203]
    s_sub_u32 s43, s42, s41
    s_add_u32 s40, s40, 1
    v_add_u32 v2, s43, v2
    v_mfma_f32_16x16x32_bf16 v[204:207], v[32:35], v[52:55], v[204:207]
    v_add_u32 v3, s43, v3
    v_add_u32 v4, s43, v4
    v_mov_b32 v0, s40
    v_mfma_f32_16x16x32_bf16 v[192:195], v[36:39], v[72:75], v[192:195]
    ds_write_b32 v7, v0
    v_mfma_f32_16x16x32_bf16 v[196:199], v[36:39], v[40:43], v[196:199]
    v_mfma_f32_16x16x32_bf16 v[200:203], v[36:39], v[76:79], v[200:203]
    v_mfma_f32_16x16x32_bf16 v[204:207], v[36:39], v[48:51], v[204:207]
    ds_read_b32 v56, v5
    v_mfma_f32_16x16x32_bf16 v[208:211], v[8:11], v[40:43], v[208:211]
    v_mfma_f32_16x16x32_bf16 v[212:215], v[8:11], v[44:47], v[212:215]
    v_mfma_f32_16x16x32_bf16 v[216:219], v[8:11], v[48:51], v[216:219]
    v_mfma_f32_16x16x32_bf16 v[220:223], v[8:11], v[52:55], v[220:223]
    s_waitcnt lgkmcnt(0)
    v_cmp_gt_u32 vcc, s51, v56
    v_mfma_f32_16x16x32_bf16 v[208:211], v[12:15], v[72:75], v[208:211]
    v_mfma_f32_16x16x32_bf16 v[212:215], v[12:15], v[40:43], v[212:215]
    s_cbranch_vccnz K12_S8
K12_Q8:
    v_mfma_f32_16x16x32_bf16 v[216:219], v[12:15], v[76:79], v[216:219]
    ds_read_b64_tr_b16 v[56:57], v4 offset:0
    v_mfma_f32_16x16x32_bf16 v[220:223], v[12:15], v[48:51], v[220:223]
    ds_read_b64_tr_b16 v[58:59], v4 offset:2048
    v_mfma_f32_16x16x32_bf16 v[224:227], v[16:19], v[40:43], v[224:227]
    ds_read_b64_tr_b16 v[60:61], v4 offset:256
    ds_read_b128 v[8:11], v2 offset:0
    v_mfma_f32_16x16x32_bf16 v[228:231], v[16:19], v[44:47], v[228:231]
    ds_read_b64_tr_b16 v[62:63], v4 offset:2304
    ds_read_b128 v[12:15], v3 offset:0
    v_mfma_f32_16x16x32_bf16 v[232:235], v[16:19], v[48:51], v[232:235]
    v_xor_b32 v4, 32, v4
    ds_read_b128 v[32:35], v2 offset:6144
    v_mfma_f32_16x16x32_bf16 v[236:239], v[16:19], v[52:55], v[236:239]
    ds_read_b64_tr_b16 v[64:65], v4 offset:0
    ds_read_b128 v[36:39], v3 offset:6144
    v_mfma_f32_16x16x32_bf16 v[224:227], v[20:23], v[72:75], v[224:227]
    ds_read_b64_tr_b16 v[66:67], v4 offset:2048
    ds_read_b32 v52, v5
    v_mfma_f32_16x16x32_bf16 v[228:231], v[20:23], v[40:43], v[228:231]
    ds_read_b64_tr_b16 v[68:69], v4 offset:256
    ds_read_b64_tr_b16 v[70:71], v4 offset:2304
    v_xor_b32 v4, 32, v4
    v_mfma_f32_16x16x32_bf16 v[232:235], v[20:23], v[76:79], v[232:235]
    v_mfma_f32_16x16x32_bf16 v[236:239], v[20:23], v[48:51], v[236:239]
    v_mfma_f32_16x16x32_bf16 v[240:243], v[24:27], v[40:43], v[240:243]
    ds_read_b128 v[16:19], v2 offset:2048
    v_mfma_f32_16x16x32_bf16 v[244:247], v[24:27], v[44:47], v[244:247]
    ds_read_b128 v[20:23], v3 offset:2048
    v_mfma_f32_16x16x32_bf16 v[240:243], v[28:31], v[72:75], v[240:243]
    s_mov_b32 s29, s41
    s_mov_b32 s41, s42
    s_add_u32 s42, s42, 38912
    v_mfma_f32_16x16x32_bf16 v[244:247], v[28:31], v[40:43], v[244:247]
    s_cmp_eq_u32 s42, 155648
    s_cselect_b32 s42, 0, s42
    s_waitcnt lgkmcnt(2)
    v_mfma_f32_16x16x32_bf16 v[80:83], v[8:11], v[56:59], v[80:83]
    ds_read_b128 v[24:27], v2 offset:4096
    v_xor_b32 v72, s35, v60
    v_xor_b32 v73, s35, v61
    v_mfma_f32_16x16x32_bf16 v[84:87], v[8:11], v[60:63], v[84:87]
    ds_read_b128 v[28:31], v3 offset:4096
    v_xor_b32 v74, s35, v62
    v_xor_b32 v75, s35, v63
    v_mfma_f32_16x16x32_bf16 v[88:91], v[8:11], v[64:67], v[88:91]
    v_xor_b32 v76, s35, v68
    v_xor_b32 v77, s35, v69
    v_mfma_f32_16x16x32_bf16 v[92:95], v[8:11], v[68:71], v[92:95]
    v_xor_b32 v78, s35, v70
    v_xor_b32 v79, s35, v71
    v_mfma_f32_16x16x32_bf16 v[80:83], v[12:15], v[72:75], v[80:83]
    v_lshrrev_b32 v0, 4, v1
    v_and_b32 v5, 15, v0
    v_mfma_f32_16x16x32_bf16 v[84:87], v[12:15], v[56:59], v[84:87]
    v_lshrrev_b32 v0, 4, v0
    s_lshl_b32 s28, s21, 7
    v_mfma_f32_16x16x32_bf16 v[88:91], v[12:15], v[76:79], v[88:91]
    s_lshl_b32 s29, s3, 5
    s_add_u32 s28, s28, s29
    v_mfma_f32_16x16x32_bf16 v[92:95], v[12:15], v[64:67], v[92:95]
    v_add_u32 v5, s28, v5
    v_lshlrev_b32 v5, 2, v5
    s_waitcnt lgkmcnt(2)
    v_mfma_f32_16x16x32_bf16 v[96:99], v[16:19], v[56:59], v[96:99]
    ds_read_b128 v[8:11], v2 offset:8192
    v_lshl_add_u32 v5, v0, 13, v5
    s_lshl_b32 s28, s20, 6
    v_mfma_f32_16x16x32_bf16 v[100:103], v[16:19], v[60:63], v[100:103]
    ds_read_b128 v[12:15], v3 offset:8192
    v_xor_b32 v5, s28, v5
    v_xor_b32 v7, 64, v5
    v_mfma_f32_16x16x32_bf16 v[104:107], v[16:19], v[64:67], v[104:107]
    v_mfma_f32_16x16x32_bf16 v[108:111], v[16:19], v[68:71], v[108:111]
    s_mov_b32 s38, 0
    v_cvt_pk_bf16_f32 v48, v80, v84
    buffer_store_dword v48, v5, s[16:19], s38 offen offset:0 sc1
    v_cvt_pk_bf16_f32 v49, v88, v92
    buffer_store_dword v49, v7, s[16:19], s38 offen offset:0 sc1
    v_mfma_f32_16x16x32_bf16 v[96:99], v[20:23], v[72:75], v[96:99]
    v_cvt_pk_bf16_f32 v50, v81, v85
    buffer_store_dword v50, v5, s[16:19], s38 offen offset:2048 sc1
    v_mfma_f32_16x16x32_bf16 v[100:103], v[20:23], v[56:59], v[100:103]
    v_cvt_pk_bf16_f32 v51, v89, v93
    buffer_store_dword v51, v7, s[16:19], s38 offen offset:2048 sc1
    v_mfma_f32_16x16x32_bf16 v[104:107], v[20:23], v[76:79], v[104:107]
    s_mov_b32 s38, 4096
    v_cvt_pk_bf16_f32 v52, v82, v86
    buffer_store_dword v52, v5, s[16:19], s38 offen offset:0 sc1
    v_cvt_pk_bf16_f32 v53, v90, v94
    buffer_store_dword v53, v7, s[16:19], s38 offen offset:0 sc1
    v_mfma_f32_16x16x32_bf16 v[108:111], v[20:23], v[64:67], v[108:111]
    v_cvt_pk_bf16_f32 v54, v83, v87
    buffer_store_dword v54, v5, s[16:19], s38 offen offset:2048 sc1
    s_waitcnt lgkmcnt(2)
    v_mfma_f32_16x16x32_bf16 v[112:115], v[24:27], v[56:59], v[112:115]
    ds_read_b128 v[16:19], v2 offset:10240
    v_cvt_pk_bf16_f32 v55, v91, v95
    buffer_store_dword v55, v7, s[16:19], s38 offen offset:2048 sc1
    v_mfma_f32_16x16x32_bf16 v[116:119], v[24:27], v[60:63], v[116:119]
    ds_read_b128 v[20:23], v3 offset:10240
    v_mfma_f32_16x16x32_bf16 v[120:123], v[24:27], v[64:67], v[120:123]
    v_mfma_f32_16x16x32_bf16 v[124:127], v[24:27], v[68:71], v[124:127]
    s_mov_b32 s38, 32768
    v_cvt_pk_bf16_f32 v40, v96, v100
    buffer_store_dword v40, v5, s[16:19], s38 offen offset:0 sc1
    v_cvt_pk_bf16_f32 v41, v104, v108
    buffer_store_dword v41, v7, s[16:19], s38 offen offset:0 sc1
    v_mfma_f32_16x16x32_bf16 v[112:115], v[28:31], v[72:75], v[112:115]
    v_cvt_pk_bf16_f32 v42, v97, v101
    buffer_store_dword v42, v5, s[16:19], s38 offen offset:2048 sc1
    v_mfma_f32_16x16x32_bf16 v[116:119], v[28:31], v[56:59], v[116:119]
    v_cvt_pk_bf16_f32 v43, v105, v109
    buffer_store_dword v43, v7, s[16:19], s38 offen offset:2048 sc1
    v_mfma_f32_16x16x32_bf16 v[120:123], v[28:31], v[76:79], v[120:123]
    s_mov_b32 s38, 36864
    v_cvt_pk_bf16_f32 v44, v98, v102
    buffer_store_dword v44, v5, s[16:19], s38 offen offset:0 sc1
    v_cvt_pk_bf16_f32 v45, v106, v110
    buffer_store_dword v45, v7, s[16:19], s38 offen offset:0 sc1
    v_mfma_f32_16x16x32_bf16 v[124:127], v[28:31], v[64:67], v[124:127]
    v_cvt_pk_bf16_f32 v46, v99, v103
    buffer_store_dword v46, v5, s[16:19], s38 offen offset:2048 sc1
    v_mfma_f32_16x16x32_bf16 v[128:131], v[32:35], v[56:59], v[128:131]
    ds_read_b128 v[24:27], v2 offset:12288
    v_cvt_pk_bf16_f32 v47, v107, v111
    buffer_store_dword v47, v7, s[16:19], s38 offen offset:2048 sc1
    v_mfma_f32_16x16x32_bf16 v[132:135], v[32:35], v[60:63], v[132:135]
    ds_read_b128 v[28:31], v3 offset:12288
    v_mfma_f32_16x16x32_bf16 v[136:139], v[32:35], v[64:67], v[136:139]
    v_mfma_f32_16x16x32_bf16 v[140:143], v[32:35], v[68:71], v[140:143]
    s_mov_b32 s38, 65536
    v_cvt_pk_bf16_f32 v48, v112, v116
    buffer_store_dword v48, v5, s[16:19], s38 offen offset:0 sc1
    v_cvt_pk_bf16_f32 v49, v120, v124
    buffer_store_dword v49, v7, s[16:19], s38 offen offset:0 sc1
    v_mfma_f32_16x16x32_bf16 v[128:131], v[36:39], v[72:75], v[128:131]
    v_cvt_pk_bf16_f32 v50, v113, v117
    buffer_store_dword v50, v5, s[16:19], s38 offen offset:2048 sc1
    v_mfma_f32_16x16x32_bf16 v[132:135], v[36:39], v[56:59], v[132:135]
    v_cvt_pk_bf16_f32 v51, v121, v125
    buffer_store_dword v51, v7, s[16:19], s38 offen offset:2048 sc1
    v_mfma_f32_16x16x32_bf16 v[136:139], v[36:39], v[76:79], v[136:139]
    s_mov_b32 s38, 69632
    v_cvt_pk_bf16_f32 v52, v114, v118
    buffer_store_dword v52, v5, s[16:19], s38 offen offset:0 sc1
    v_cvt_pk_bf16_f32 v53, v122, v126
    buffer_store_dword v53, v7, s[16:19], s38 offen offset:0 sc1
    v_mfma_f32_16x16x32_bf16 v[140:143], v[36:39], v[64:67], v[140:143]
    v_cvt_pk_bf16_f32 v54, v115, v119
    buffer_store_dword v54, v5, s[16:19], s38 offen offset:2048 sc1
    s_waitcnt lgkmcnt(4)
    v_mfma_f32_16x16x32_bf16 v[144:147], v[8:11], v[56:59], v[144:147]
    ds_read_b128 v[32:35], v2 offset:14336
    v_cvt_pk_bf16_f32 v55, v123, v127
    buffer_store_dword v55, v7, s[16:19], s38 offen offset:2048 sc1
    v_mfma_f32_16x16x32_bf16 v[148:151], v[8:11], v[60:63], v[148:151]
    ds_read_b128 v[36:39], v3 offset:14336
    v_mfma_f32_16x16x32_bf16 v[152:155], v[8:11], v[64:67], v[152:155]
    v_mfma_f32_16x16x32_bf16 v[156:159], v[8:11], v[68:71], v[156:159]
    s_mov_b32 s38, 98304
    v_cvt_pk_bf16_f32 v40, v128, v132
    buffer_store_dword v40, v5, s[16:19], s38 offen offset:0 sc1
    v_cvt_pk_bf16_f32 v41, v136, v140
    buffer_store_dword v41, v7, s[16:19], s38 offen offset:0 sc1
    v_mfma_f32_16x16x32_bf16 v[144:147], v[12:15], v[72:75], v[144:147]
    v_cvt_pk_bf16_f32 v42, v129, v133
    buffer_store_dword v42, v5, s[16:19], s38 offen offset:2048 sc1
    v_mfma_f32_16x16x32_bf16 v[148:151], v[12:15], v[56:59], v[148:151]
    v_cvt_pk_bf16_f32 v43, v137, v141
    buffer_store_dword v43, v7, s[16:19], s38 offen offset:2048 sc1
    v_mfma_f32_16x16x32_bf16 v[152:155], v[12:15], v[76:79], v[152:155]
    s_mov_b32 s38, 102400
    v_cvt_pk_bf16_f32 v44, v130, v134
    buffer_store_dword v44, v5, s[16:19], s38 offen offset:0 sc1
    v_cvt_pk_bf16_f32 v45, v138, v142
    buffer_store_dword v45, v7, s[16:19], s38 offen offset:0 sc1
    v_mfma_f32_16x16x32_bf16 v[156:159], v[12:15], v[64:67], v[156:159]
    v_cvt_pk_bf16_f32 v46, v131, v135
    buffer_store_dword v46, v5, s[16:19], s38 offen offset:2048 sc1
    s_waitcnt lgkmcnt(4)
    v_mfma_f32_16x16x32_bf16 v[160:163], v[16:19], v[56:59], v[160:163]
    ds_read_b128 v[8:11], v2 offset:16384
    v_cvt_pk_bf16_f32 v47, v139, v143
    buffer_store_dword v47, v7, s[16:19], s38 offen offset:2048 sc1
    v_mfma_f32_16x16x32_bf16 v[164:167], v[16:19], v[60:63], v[164:167]
    ds_read_b128 v[12:15], v3 offset:16384
    v_mfma_f32_16x16x32_bf16 v[168:171], v[16:19], v[64:67], v[168:171]
    v_mfma_f32_16x16x32_bf16 v[172:175], v[16:19], v[68:71], v[172:175]
    s_mov_b32 s38, 131072
    v_cvt_pk_bf16_f32 v48, v144, v148
    buffer_store_dword v48, v5, s[16:19], s38 offen offset:0 sc1
    v_cvt_pk_bf16_f32 v49, v152, v156
    buffer_store_dword v49, v7, s[16:19], s38 offen offset:0 sc1
    v_mfma_f32_16x16x32_bf16 v[160:163], v[20:23], v[72:75], v[160:163]
    v_cvt_pk_bf16_f32 v50, v145, v149
    buffer_store_dword v50, v5, s[16:19], s38 offen offset:2048 sc1
    v_mfma_f32_16x16x32_bf16 v[164:167], v[20:23], v[56:59], v[164:167]
    v_cvt_pk_bf16_f32 v51, v153, v157
    buffer_store_dword v51, v7, s[16:19], s38 offen offset:2048 sc1
    v_mfma_f32_16x16x32_bf16 v[168:171], v[20:23], v[76:79], v[168:171]
    s_mov_b32 s38, 135168
    v_cvt_pk_bf16_f32 v52, v146, v150
    buffer_store_dword v52, v5, s[16:19], s38 offen offset:0 sc1
    v_cvt_pk_bf16_f32 v53, v154, v158
    buffer_store_dword v53, v7, s[16:19], s38 offen offset:0 sc1
    v_mfma_f32_16x16x32_bf16 v[172:175], v[20:23], v[64:67], v[172:175]
    v_cvt_pk_bf16_f32 v54, v147, v151
    buffer_store_dword v54, v5, s[16:19], s38 offen offset:2048 sc1
    s_waitcnt lgkmcnt(4)
    v_mfma_f32_16x16x32_bf16 v[176:179], v[24:27], v[56:59], v[176:179]
    ds_read_b128 v[16:19], v2 offset:18432
    v_cvt_pk_bf16_f32 v55, v155, v159
    buffer_store_dword v55, v7, s[16:19], s38 offen offset:2048 sc1
    v_mfma_f32_16x16x32_bf16 v[180:183], v[24:27], v[60:63], v[180:183]
    ds_read_b128 v[20:23], v3 offset:18432
    v_mfma_f32_16x16x32_bf16 v[184:187], v[24:27], v[64:67], v[184:187]
    v_mfma_f32_16x16x32_bf16 v[188:191], v[24:27], v[68:71], v[188:191]
    s_mov_b32 s38, 163840
    v_cvt_pk_bf16_f32 v40, v160, v164
    buffer_store_dword v40, v5, s[16:19], s38 offen offset:0 sc1
    v_cvt_pk_bf16_f32 v41, v168, v172
    buffer_store_dword v41, v7, s[16:19], s38 offen offset:0 sc1
    v_mfma_f32_16x16x32_bf16 v[176:179], v[28:31], v[72:75], v[176:179]
    v_cvt_pk_bf16_f32 v42, v161, v165
    buffer_store_dword v42, v5, s[16:19], s38 offen offset:2048 sc1
    v_mfma_f32_16x16x32_bf16 v[180:183], v[28:31], v[56:59], v[180:183]
    v_cvt_pk_bf16_f32 v43, v169, v173
    buffer_store_dword v43, v7, s[16:19], s38 offen offset:2048 sc1
    v_mfma_f32_16x16x32_bf16 v[184:187], v[28:31], v[76:79], v[184:187]
    s_mov_b32 s38, 167936
    v_cvt_pk_bf16_f32 v44, v162, v166
    buffer_store_dword v44, v5, s[16:19], s38 offen offset:0 sc1
    v_cvt_pk_bf16_f32 v45, v170, v174
    buffer_store_dword v45, v7, s[16:19], s38 offen offset:0 sc1
    v_mfma_f32_16x16x32_bf16 v[188:191], v[28:31], v[64:67], v[188:191]
    v_cvt_pk_bf16_f32 v46, v163, v167
    buffer_store_dword v46, v5, s[16:19], s38 offen offset:2048 sc1
    s_waitcnt lgkmcnt(4)
    v_mfma_f32_16x16x32_bf16 v[192:195], v[32:35], v[56:59], v[192:195]
    ds_read_b128 v[24:27], v2 offset:20480
    v_cvt_pk_bf16_f32 v47, v171, v175
    buffer_store_dword v47, v7, s[16:19], s38 offen offset:2048 sc1
    v_mfma_f32_16x16x32_bf16 v[196:199], v[32:35], v[60:63], v[196:199]
    ds_read_b128 v[28:31], v3 offset:20480
    v_mfma_f32_16x16x32_bf16 v[200:203], v[32:35], v[64:67], v[200:203]
    v_mfma_f32_16x16x32_bf16 v[204:207], v[32:35], v[68:71], v[204:207]
    s_mov_b32 s38, 196608
    v_cvt_pk_bf16_f32 v48, v176, v180
    buffer_store_dword v48, v5, s[16:19], s38 offen offset:0 sc1
    v_cvt_pk_bf16_f32 v49, v184, v188
    buffer_store_dword v49, v7, s[16:19], s38 offen offset:0 sc1
    v_mfma_f32_16x16x32_bf16 v[192:195], v[36:39], v[72:75], v[192:195]
    v_cvt_pk_bf16_f32 v50, v177, v181
    buffer_store_dword v50, v5, s[16:19], s38 offen offset:2048 sc1
    v_mfma_f32_16x16x32_bf16 v[196:199], v[36:39], v[56:59], v[196:199]
    v_cvt_pk_bf16_f32 v51, v185, v189
    buffer_store_dword v51, v7, s[16:19], s38 offen offset:2048 sc1
    v_mfma_f32_16x16x32_bf16 v[200:203], v[36:39], v[76:79], v[200:203]
    s_mov_b32 s38, 200704
    v_cvt_pk_bf16_f32 v52, v178, v182
    buffer_store_dword v52, v5, s[16:19], s38 offen offset:0 sc1
    v_cvt_pk_bf16_f32 v53, v186, v190
    buffer_store_dword v53, v7, s[16:19], s38 offen offset:0 sc1
    v_mfma_f32_16x16x32_bf16 v[204:207], v[36:39], v[64:67], v[204:207]
    v_cvt_pk_bf16_f32 v54, v179, v183
    buffer_store_dword v54, v5, s[16:19], s38 offen offset:2048 sc1
    s_waitcnt lgkmcnt(4)
    v_mfma_f32_16x16x32_bf16 v[208:211], v[8:11], v[56:59], v[208:211]
    v_cvt_pk_bf16_f32 v55, v187, v191
    buffer_store_dword v55, v7, s[16:19], s38 offen offset:2048 sc1
    v_mfma_f32_16x16x32_bf16 v[212:215], v[8:11], v[60:63], v[212:215]
    v_mfma_f32_16x16x32_bf16 v[216:219], v[8:11], v[64:67], v[216:219]
    v_mfma_f32_16x16x32_bf16 v[220:223], v[8:11], v[68:71], v[220:223]
    s_mov_b32 s38, 229376
    v_cvt_pk_bf16_f32 v40, v192, v196
    buffer_store_dword v40, v5, s[16:19], s38 offen offset:0 sc1
    v_cvt_pk_bf16_f32 v41, v200, v204
    buffer_store_dword v41, v7, s[16:19], s38 offen offset:0 sc1
    v_mfma_f32_16x16x32_bf16 v[208:211], v[12:15], v[72:75], v[208:211]
    v_cvt_pk_bf16_f32 v42, v193, v197
    buffer_store_dword v42, v5, s[16:19], s38 offen offset:2048 sc1
    v_mfma_f32_16x16x32_bf16 v[212:215], v[12:15], v[56:59], v[212:215]
    v_cvt_pk_bf16_f32 v43, v201, v205
    buffer_store_dword v43, v7, s[16:19], s38 offen offset:2048 sc1
    v_mfma_f32_16x16x32_bf16 v[216:219], v[12:15], v[76:79], v[216:219]
    s_mov_b32 s38, 233472
    v_cvt_pk_bf16_f32 v44, v194, v198
    buffer_store_dword v44, v5, s[16:19], s38 offen offset:0 sc1
    v_cvt_pk_bf16_f32 v45, v202, v206
    buffer_store_dword v45, v7, s[16:19], s38 offen offset:0 sc1
    v_mfma_f32_16x16x32_bf16 v[220:223], v[12:15], v[64:67], v[220:223]
    v_cvt_pk_bf16_f32 v46, v195, v199
    buffer_store_dword v46, v5, s[16:19], s38 offen offset:2048 sc1
    s_waitcnt lgkmcnt(2)
    v_mfma_f32_16x16x32_bf16 v[224:227], v[16:19], v[56:59], v[224:227]
    v_cvt_pk_bf16_f32 v47, v203, v207
    buffer_store_dword v47, v7, s[16:19], s38 offen offset:2048 sc1
    v_mfma_f32_16x16x32_bf16 v[228:231], v[16:19], v[60:63], v[228:231]
    v_mfma_f32_16x16x32_bf16 v[232:235], v[16:19], v[64:67], v[232:235]
    v_mfma_f32_16x16x32_bf16 v[236:239], v[16:19], v[68:71], v[236:239]
    s_mov_b32 s38, 262144
    v_cvt_pk_bf16_f32 v48, v208, v212
    buffer_store_dword v48, v5, s[16:19], s38 offen offset:0 sc1
    v_cvt_pk_bf16_f32 v49, v216, v220
    buffer_store_dword v49, v7, s[16:19], s38 offen offset:0 sc1
    v_mfma_f32_16x16x32_bf16 v[224:227], v[20:23], v[72:75], v[224:227]
    v_cvt_pk_bf16_f32 v50, v209, v213
    buffer_store_dword v50, v5, s[16:19], s38 offen offset:2048 sc1
    v_mfma_f32_16x16x32_bf16 v[228:231], v[20:23], v[56:59], v[228:231]
    v_cvt_pk_bf16_f32 v51, v217, v221
    buffer_store_dword v51, v7, s[16:19], s38 offen offset:2048 sc1
    v_mfma_f32_16x16x32_bf16 v[232:235], v[20:23], v[76:79], v[232:235]
    s_mov_b32 s38, 266240
    v_cvt_pk_bf16_f32 v52, v210, v214
    buffer_store_dword v52, v5, s[16:19], s38 offen offset:0 sc1
    v_cvt_pk_bf16_f32 v53, v218, v222
    buffer_store_dword v53, v7, s[16:19], s38 offen offset:0 sc1
    v_mfma_f32_16x16x32_bf16 v[236:239], v[20:23], v[64:67], v[236:239]
    v_cvt_pk_bf16_f32 v54, v211, v215
    buffer_store_dword v54, v5, s[16:19], s38 offen offset:2048 sc1
    s_waitcnt lgkmcnt(0)
    v_mfma_f32_16x16x32_bf16 v[240:243], v[24:27], v[56:59], v[240:243]
    v_cvt_pk_bf16_f32 v55, v219, v223
    buffer_store_dword v55, v7, s[16:19], s38 offen offset:2048 sc1
    v_mfma_f32_16x16x32_bf16 v[244:247], v[24:27], v[60:63], v[244:247]
    v_mfma_f32_16x16x32_bf16 v[240:243], v[28:31], v[72:75], v[240:243]
    v_mfma_f32_16x16x32_bf16 v[244:247], v[28:31], v[56:59], v[244:247]
    s_mov_b32 s38, 294912
    v_cvt_pk_bf16_f32 v40, v224, v228
    buffer_store_dword v40, v5, s[16:19], s38 offen offset:0 sc1
    v_cvt_pk_bf16_f32 v41, v232, v236
    buffer_store_dword v41, v7, s[16:19], s38 offen offset:0 sc1
    v_cvt_pk_bf16_f32 v42, v225, v229
    buffer_store_dword v42, v5, s[16:19], s38 offen offset:2048 sc1
    v_cvt_pk_bf16_f32 v43, v233, v237
    buffer_store_dword v43, v7, s[16:19], s38 offen offset:2048 sc1
    s_mov_b32 s38, 299008
    v_cvt_pk_bf16_f32 v44, v226, v230
    buffer_store_dword v44, v5, s[16:19], s38 offen offset:0 sc1
    v_cvt_pk_bf16_f32 v45, v234, v238
    buffer_store_dword v45, v7, s[16:19], s38 offen offset:0 sc1
    v_cvt_pk_bf16_f32 v46, v227, v231
    buffer_store_dword v46, v5, s[16:19], s38 offen offset:2048 sc1
    v_cvt_pk_bf16_f32 v47, v235, v239
    buffer_store_dword v47, v7, s[16:19], s38 offen offset:2048 sc1
    s_nop 7
    s_lshl_b32 s34, s27, 1
    s_mul_i32 s34, s34, 342016
    s_add_u32 s34, s34, 118489088
    s_add_u32 s64, s58, s34
    s_addc_u32 s65, s59, 0
    s_and_b32 s65, s65, 0xffff
    s_mov_b32 s66, 684032
    s_mov_b32 s67, 0x00020000
    v_lshrrev_b32 v8, 8, v1
    v_lshlrev_b32 v9, 13, v8
    v_sub_u32 v9, v5, v9
    v_lshlrev_b32 v8, 2, v8
    v_add_u32 v8, 160, v8
    v_add_u32 v10, 0, v8
    v_add_u32 v11, 160, v10
    v_cmp_gt_u32 vcc, 167, v10
    s_nop 1
    v_cndmask_b32 v11, v11, v10, vcc
    v_cmp_gt_u32 vcc, 174, v10
    v_mov_b32 v12, 0x7ffff
    s_nop 0
    v_cndmask_b32 v11, v12, v11, vcc
    v_lshl_add_u32 v16, v11, 11, v9
    v_add_u32 v10, 1, v8
    v_add_u32 v11, 160, v10
    v_cmp_gt_u32 vcc, 167, v10
    s_nop 1
    v_cndmask_b32 v11, v11, v10, vcc
    v_cmp_gt_u32 vcc, 174, v10
    v_mov_b32 v12, 0x7ffff
    s_nop 0
    v_cndmask_b32 v11, v12, v11, vcc
    v_lshl_add_u32 v17, v11, 11, v9
    v_add_u32 v10, 2, v8
    v_add_u32 v11, 160, v10
    v_cmp_gt_u32 vcc, 167, v10
    s_nop 1
    v_cndmask_b32 v11, v11, v10, vcc
    v_cmp_gt_u32 vcc, 174, v10
    v_mov_b32 v12, 0x7ffff
    s_nop 0
    v_cndmask_b32 v11, v12, v11, vcc
    v_lshl_add_u32 v18, v11, 11, v9
    v_add_u32 v10, 3, v8
    v_add_u32 v11, 160, v10
    v_cmp_gt_u32 vcc, 167, v10
    s_nop 1
    v_cndmask_b32 v11, v11, v10, vcc
    v_cmp_gt_u32 vcc, 174, v10
    v_mov_b32 v12, 0x7ffff
    s_nop 0
    v_cndmask_b32 v11, v12, v11, vcc
    v_lshl_add_u32 v19, v11, 11, v9
    v_cvt_pk_bf16_f32 v20, v240, v244
    buffer_store_dword v20, v16, s[64:67], 0 offen sc1
    v_cvt_pk_bf16_f32 v21, v241, v245
    buffer_store_dword v21, v17, s[64:67], 0 offen sc1
    v_cvt_pk_bf16_f32 v22, v242, v246
    buffer_store_dword v22, v18, s[64:67], 0 offen sc1
    v_cvt_pk_bf16_f32 v23, v243, v247
    buffer_store_dword v23, v19, s[64:67], 0 offen sc1
    s_endpgm
K12_S0:
    s_mov_b32 s61, 16384
    s_add_u32 s62, s62, 1
K12_S0_L:
    ds_read_b32 v56, v5
    s_waitcnt lgkmcnt(0)
    v_cmp_gt_u32 vcc, s40, v56
    s_sub_u32 s61, s61, 1
    s_cmp_eq_u32 s61, 0
    s_cbranch_scc1 K12_Q0
    s_cbranch_vccz K12_Q0
    s_branch K12_S0_L
K12_S1:
    s_mov_b32 s61, 16384
    s_add_u32 s62, s62, 1
K12_S1_L:
    ds_read_b32 v68, v5
    s_waitcnt lgkmcnt(0)
    v_cmp_gt_u32 vcc, s40, v68
    s_sub_u32 s61, s61, 1
    s_cmp_eq_u32 s61, 0
    s_cbranch_scc1 K12_Q1
    s_cbranch_vccz K12_Q1
    s_branch K12_S1_L
K12_F2:
    s_mov_b32 s61, 16384
    s_add_u32 s63, s63, 1
K12_F2_L:
    s_mov_b32 m0, s46
    s_mov_b64 exec, 0xff
    buffer_load_dword v1, s[4:7], 0 offen sc1 lds
    s_mov_b64 exec, -1
    s_waitcnt vmcnt(0)
    v_mov_b32 v0, s48
    ds_read_b32 v0, v0
    s_waitcnt lgkmcnt(0)
    v_cmp_eq_u32 vcc, 0, v0
    s_sub_u32 s61, s61, 1
    s_cmp_eq_u32 s61, 0
    s_cbranch_scc1 K12_F2_X
    s_cbranch_vccz K12_F2_X
    s_sleep 2
    s_branch K12_F2_L
K12_F2_X:
    s_branch K12_G2
K12_S3:
    s_mov_b32 s61, 16384
    s_add_u32 s62, s62, 1
K12_S3_L:
    ds_read_b32 v56, v5
    s_waitcnt lgkmcnt(0)
    v_cmp_gt_u32 vcc, s51, v56
    s_sub_u32 s61, s61, 1
    s_cmp_eq_u32 s61, 0
    s_cbranch_scc1 K12_Q3
    s_cbranch_vccz K12_Q3
    s_branch K12_S3_L
K12_S4:
    s_mov_b32 s61, 16384
    s_add_u32 s62, s62, 1
K12_S4_L:
    ds_read_b32 v52, v5
    s_waitcnt lgkmcnt(0)
    v_cmp_gt_u32 vcc, s40, v52
    s_sub_u32 s61, s61, 1
    s_cmp_eq_u32 s61, 0
    s_cbranch_scc1 K12_Q4
    s_cbranch_vccz K12_Q4
    s_branch K12_S4_L
K12_S5:
    s_mov_b32 s61, 16384
    s_add_u32 s62, s62, 1
K12_S5_L:
    ds_read_b32 v40, v5
    s_waitcnt lgkmcnt(0)
    v_cmp_gt_u32 vcc, s51, v40
    s_sub_u32 s61, s61, 1
    s_cmp_eq_u32 s61, 0
    s_cbranch_scc1 K12_Q5
    s_cbranch_vccz K12_Q5
    s_branch K12_S5_L
K12_S6:
    s_mov_b32 s61, 16384
    s_add_u32 s62, s62, 1
K12_S6_L:
    ds_read_b32 v68, v5
    s_waitcnt lgkmcnt(0)
    v_cmp_gt_u32 vcc, s40, v68
    s_sub_u32 s61, s61, 1
    s_cmp_eq_u32 s61, 0
    s_cbranch_scc1 K12_Q6
    s_cbranch_vccz K12_Q6
    s_branch K12_S6_L
K12_F7:
    s_mov_b32 s61, 16384
    s_add_u32 s63, s63, 1
K12_F7_L:
    s_mov_b32 m0, s46
    s_mov_b64 exec, 0xff
    buffer_load_dword v1, s[4:7], 0 offen sc1 lds
    s_mov_b64 exec, -1
    s_waitcnt vmcnt(0)
    v_mov_b32 v0, s48
    ds_read_b32 v0, v0
    s_waitcnt lgkmcnt(0)
    v_cmp_eq_u32 vcc, 0, v0
    s_sub_u32 s61, s61, 1
    s_cmp_eq_u32 s61, 0
    s_cbranch_scc1 K12_F7_X
    s_cbranch_vccz K12_F7_X
    s_sleep 2
    s_branch K12_F7_L
K12_F7_X:
    s_branch K12_G7
K12_S8:
    s_mov_b32 s61, 16384
    s_add_u32 s62, s62, 1
K12_S8_L:
    ds_read_b32 v56, v5
    s_waitcnt lgkmcnt(0)
    v_cmp_gt_u32 vcc, s51, v56
    s_sub_u32 s61, s61, 1
    s_cmp_eq_u32 s61, 0
    s_cbranch_scc1 K12_Q8
    s_cbranch_vccz K12_Q8
    s_branch K12_S8_L
K12_END:
    s_endpgm
.p2align 8
.type k34_out_kernel,@function
k34_out_kernel:
    s_cmp_ge_u32 s2, 256
    s_cbranch_scc1 K34_END
    s_load_dwordx2 s[4:5], s[0:1], 48
    s_load_dwordx4 s[40:43], s[0:1], 16
    s_load_dwordx2 s[44:45], s[0:1], 32
    v_lshrrev_b32 v1, 6, v0
    v_and_b32 v2, 63, v0
    v_readfirstlane_b32 s3, v1
    s_and_b32 s6, s2, 15
    s_lshr_b32 s7, s2, 4
    s_lshr_b32 s20, s6, 3
    s_and_b32 s21, s6, 7
    s_mul_i32 s22, s7, 11
    s_mul_i32 s23, s7, 10
    s_add_u32 s23, s23, 7
    s_cmp_lt_u32 s7, 7
    s_cselect_b32 s22, s22, s23
    s_cselect_b32 s23, 11, 10
    s_add_u32 s22, s22, s3
    v_and_b32 v3, 15, v2
    v_lshrrev_b32 v4, 4, v2
    v_lshlrev_b32 v5, 4, v2
    s_mov_b32 s24, 2736128
    v_mul_lo_u32 v6, v4, s24
    v_lshl_add_u32 v6, v3, 4, v6
    s_mul_i32 s25, s20, 167
    s_add_u32 s25, s25, s22
    s_lshl_b32 s25, s25, 11
    s_lshl_b32 s24, s21, 8
    s_add_u32 s25, s25, s24
    s_waitcnt lgkmcnt(0)
    s_add_u32 s8, s4, 118489088
    s_addc_u32 s9, s5, 0
    s_and_b32 s9, s9, 0xffff
    s_mov_b32 s10, 21889024
    s_mov_b32 s11, 0x00020000
    s_add_u32 s12, s4, 153616384
    s_addc_u32 s13, s5, 0
    s_and_b32 s13, s13, 0xffff
    s_mov_b32 s14, 131072
    s_mov_b32 s15, 0x00020000
    s_cmp_lt_u32 s3, s23
    s_cbranch_scc0 K34_NOLOAD
    buffer_load_dwordx4 v[16:19], v6, s[8:11], s25 offen
    s_add_u32 s25, s25, 684032
    buffer_load_dwordx4 v[20:23], v6, s[8:11], s25 offen
    s_add_u32 s25, s25, 684032
    buffer_load_dwordx4 v[24:27], v6, s[8:11], s25 offen
    s_add_u32 s25, s25, 684032
    buffer_load_dwordx4 v[28:31], v6, s[8:11], s25 offen
    s_add_u32 s25, s25, 8892416
    buffer_load_dwordx4 v[32:35], v6, s[8:11], s25 offen
    s_add_u32 s25, s25, 684032
    buffer_load_dwordx4 v[36:39], v6, s[8:11], s25 offen
    s_add_u32 s25, s25, 684032
    buffer_load_dwordx4 v[40:43], v6, s[8:11], s25 offen
    s_add_u32 s25, s25, 684032
    buffer_load_dwordx4 v[44:47], v6, s[8:11], s25 offen
K34_NOLOAD:
    s_cmp_lg_u32 s3, 0
    s_cbranch_scc1 K34_TAB
    s_mov_b32 s16, s40
    s_mov_b32 s17, s41
    s_and_b32 s17, s17, 0xffff
    s_mov_b32 s18, 1024
    s_mov_b32 s19, 0x00020000
    s_mov_b32 s28, s42
    s_mov_b32 s29, s43
    s_and_b32 s29, s29, 0xffff
    s_mov_b32 s30, 1024
    s_mov_b32 s31, 0x00020000
    s_lshl_b32 s24, s21, 7
    v_lshlrev_b32 v8, 1, v2
    buffer_load_ushort v152, v8, s[16:19], s24 offen
    buffer_load_ushort v153, v8, s[28:31], s24 offen
    s_branch K34_TABDONE
K34_TAB:
    s_cmp_ge_u32 s3, 7
    s_cbranch_scc1 K34_TABDONE
    s_sub_u32 s27, s3, 1
    s_lshr_b32 s28, s27, 1
    s_and_b32 s29, s27, 1
    s_lshl_b32 s30, s28, 4
    v_add_u32 v8, s30, v3
    s_lshl_b32 s30, s29, 5
    s_add_u32 s30, s30, 1
    v_lshlrev_b32 v9, 3, v4
    v_add_u32 v9, s30, v9
    v_mul_u32_u24 v9, v8, v9
    v_lshlrev_b32 v8, 1, v8
    v_mad_u32_u24 v48, v8, 0, v9
    v_mad_u32_u24 v49, v8, 0, v9
    v_add_u32 v49, 32, v49
    v_mad_u32_u24 v50, v8, 1, v9
    v_mad_u32_u24 v51, v8, 1, v9
    v_add_u32 v51, 32, v51
    v_mad_u32_u24 v52, v8, 2, v9
    v_mad_u32_u24 v53, v8, 2, v9
    v_add_u32 v53, 32, v53
    v_mad_u32_u24 v54, v8, 3, v9
    v_mad_u32_u24 v55, v8, 3, v9
    v_add_u32 v55, 32, v55
    v_and_b32 v48, 127, v48
    v_and_b32 v49, 127, v49
    v_and_b32 v50, 127, v50
    v_and_b32 v51, 127, v51
    v_and_b32 v52, 127, v52
    v_and_b32 v53, 127, v53
    v_and_b32 v54, 127, v54
    v_and_b32 v55, 127, v55
    v_cvt_f32_u32 v48, v48
    v_cvt_f32_u32 v49, v49
    v_cvt_f32_u32 v50, v50
    v_cvt_f32_u32 v51, v51
    v_cvt_f32_u32 v52, v52
    v_cvt_f32_u32 v53, v53
    v_cvt_f32_u32 v54, v54
    v_cvt_f32_u32 v55, v55
    v_mul_f32 v48, 0x3c000000, v48
    v_mul_f32 v49, 0x3c000000, v49
    v_mul_f32 v50, 0x3c000000, v50
    v_mul_f32 v51, 0x3c000000, v51
    v_mul_f32 v52, 0x3c000000, v52
    v_mul_f32 v53, 0x3c000000, v53
    v_mul_f32 v54, 0x3c000000, v54
    v_mul_f32 v55, 0x3c000000, v55
    v_cos_f32 v48, v48
    v_cos_f32 v49, v49
    v_cos_f32 v50, v50
    v_cos_f32 v51, v51
    v_cos_f32 v52, v52
    v_cos_f32 v53, v53
    v_cos_f32 v54, v54
    v_cos_f32 v55, v55
    s_nop 0
    v_mul_f32 v48, 0x3d000000, v48
    v_mul_f32 v49, 0x3d000000, v49
    v_mul_f32 v50, 0x3d000000, v50
    v_mul_f32 v51, 0x3d000000, v51
    v_mul_f32 v52, 0x3d000000, v52
    v_mul_f32 v53, 0x3d000000, v53
    v_mul_f32 v54, 0x3d000000, v54
    v_mul_f32 v55, 0x3d000000, v55
    v_cvt_pk_bf16_f32 v56, v48, v49
    v_cvt_pk_bf16_f32 v57, v50, v51
    v_cvt_pk_bf16_f32 v58, v52, v53
    v_cvt_pk_bf16_f32 v59, v54, v55
    v_lshlrev_b32 v64, 16, v56
    v_and_b32 v65, 0xffff0000, v56
    v_sub_f32 v48, v48, v64
    v_sub_f32 v49, v49, v65
    v_lshlrev_b32 v64, 16, v57
    v_and_b32 v65, 0xffff0000, v57
    v_sub_f32 v50, v50, v64
    v_sub_f32 v51, v51, v65
    v_lshlrev_b32 v64, 16, v58
    v_and_b32 v65, 0xffff0000, v58
    v_sub_f32 v52, v52, v64
    v_sub_f32 v53, v53, v65
    v_lshlrev_b32 v64, 16, v59
    v_and_b32 v65, 0xffff0000, v59
    v_sub_f32 v54, v54, v64
    v_sub_f32 v55, v55, v65
    v_cvt_pk_bf16_f32 v60, v48, v49
    v_cvt_pk_bf16_f32 v61, v50, v51
    v_cvt_pk_bf16_f32 v62, v52, v53
    v_cvt_pk_bf16_f32 v63, v54, v55
    s_lshl_b32 s30, s27, 11
    v_add_u32 v10, s30, v5
    ds_write_b128 v10, v[56:59]
    ds_write_b128 v10, v[60:63] offset:1024
K34_TABDONE:
    s_waitcnt lgkmcnt(0)
    s_barrier
    s_cmp_lt_u32 s3, s23
    s_cbranch_scc0 K34_IDLE
    ds_read_b128 v[48:51], v5 offset:0
    ds_read_b128 v[52:55], v5 offset:1024
    ds_read_b128 v[56:59], v5 offset:2048
    ds_read_b128 v[60:63], v5 offset:3072
    ds_read_b128 v[64:67], v5 offset:4096
    ds_read_b128 v[68:71], v5 offset:5120
    ds_read_b128 v[72:75], v5 offset:6144
    ds_read_b128 v[76:79], v5 offset:7168
    ds_read_b128 v[80:83], v5 offset:8192
    ds_read_b128 v[84:87], v5 offset:9216
    ds_read_b128 v[88:91], v5 offset:10240
    ds_read_b128 v[92:95], v5 offset:11264
    s_waitcnt vmcnt(0)
    v_swap_b32 v17, v20
    v_swap_b32 v18, v24
    v_swap_b32 v19, v28
    v_swap_b32 v22, v25
    v_swap_b32 v23, v29
    v_swap_b32 v27, v30
    v_swap_b32 v33, v36
    v_swap_b32 v34, v40
    v_swap_b32 v35, v44
    v_swap_b32 v38, v41
    v_swap_b32 v39, v45
    v_swap_b32 v43, v46
    s_waitcnt lgkmcnt(0)
    s_mul_i32 s24, s22, 48
    s_sub_u32 s24, 7985, s24
    s_cmp_ge_u32 s24, 48
    s_cbranch_scc1 K34_FULL
    v_add_u32 v7, 0, v3
    v_cmp_gt_u32 vcc, s24, v7
    s_nop 1
    v_cndmask_b32 v48, 0, v48, vcc
    v_cndmask_b32 v49, 0, v49, vcc
    v_cndmask_b32 v50, 0, v50, vcc
    v_cndmask_b32 v51, 0, v51, vcc
    v_cndmask_b32 v52, 0, v52, vcc
    v_cndmask_b32 v53, 0, v53, vcc
    v_cndmask_b32 v54, 0, v54, vcc
    v_cndmask_b32 v55, 0, v55, vcc
    v_cndmask_b32 v56, 0, v56, vcc
    v_cndmask_b32 v57, 0, v57, vcc
    v_cndmask_b32 v58, 0, v58, vcc
    v_cndmask_b32 v59, 0, v59, vcc
    v_cndmask_b32 v60, 0, v60, vcc
    v_cndmask_b32 v61, 0, v61, vcc
    v_cndmask_b32 v62, 0, v62, vcc
    v_cndmask_b32 v63, 0, v63, vcc
    v_add_u32 v7, 16, v3
    v_cmp_gt_u32 vcc, s24, v7
    s_nop 1
    v_cndmask_b32 v64, 0, v64, vcc
    v_cndmask_b32 v65, 0, v65, vcc
    v_cndmask_b32 v66, 0, v66, vcc
    v_cndmask_b32 v67, 0, v67, vcc
    v_cndmask_b32 v68, 0, v68, vcc
    v_cndmask_b32 v69, 0, v69, vcc
    v_cndmask_b32 v70, 0, v70, vcc
    v_cndmask_b32 v71, 0, v71, vcc
    v_cndmask_b32 v72, 0, v72, vcc
    v_cndmask_b32 v73, 0, v73, vcc
    v_cndmask_b32 v74, 0, v74, vcc
    v_cndmask_b32 v75, 0, v75, vcc
    v_cndmask_b32 v76, 0, v76, vcc
    v_cndmask_b32 v77, 0, v77, vcc
    v_cndmask_b32 v78, 0, v78, vcc
    v_cndmask_b32 v79, 0, v79, vcc
    v_add_u32 v7, 32, v3
    v_cmp_gt_u32 vcc, s24, v7
    s_nop 1
    v_cndmask_b32 v80, 0, v80, vcc
    v_cndmask_b32 v81, 0, v81, vcc
    v_cndmask_b32 v82, 0, v82, vcc
    v_cndmask_b32 v83, 0, v83, vcc
    v_cndmask_b32 v84, 0, v84, vcc
    v_cndmask_b32 v85, 0, v85, vcc
    v_cndmask_b32 v86, 0, v86, vcc
    v_cndmask_b32 v87, 0, v87, vcc
    v_cndmask_b32 v88, 0, v88, vcc
    v_cndmask_b32 v89, 0, v89, vcc
    v_cndmask_b32 v90, 0, v90, vcc
    v_cndmask_b32 v91, 0, v91, vcc
    v_cndmask_b32 v92, 0, v92, vcc
    v_cndmask_b32 v93, 0, v93, vcc
    v_cndmask_b32 v94, 0, v94, vcc
    v_cndmask_b32 v95, 0, v95, vcc
K34_FULL:
    s_nop 1
    v_mfma_f32_16x16x32_bf16 v[96:99], v[48:51], v[16:19], 0
    v_mfma_f32_16x16x32_bf16 v[100:103], v[48:51], v[20:23], 0
    v_mfma_f32_16x16x32_bf16 v[104:107], v[48:51], v[24:27], 0
    v_mfma_f32_16x16x32_bf16 v[108:111], v[48:51], v[28:31], 0
    v_mfma_f32_16x16x32_bf16 v[96:99], v[52:55], v[16:19], v[96:99]
    v_mfma_f32_16x16x32_bf16 v[100:103], v[52:55], v[20:23], v[100:103]
    v_mfma_f32_16x16x32_bf16 v[104:107], v[52:55], v[24:27], v[104:107]
    v_mfma_f32_16x16x32_bf16 v[108:111], v[52:55], v[28:31], v[108:111]
    v_mfma_f32_16x16x32_bf16 v[96:99], v[56:59], v[32:35], v[96:99]
    v_mfma_f32_16x16x32_bf16 v[100:103], v[56:59], v[36:39], v[100:103]
    v_mfma_f32_16x16x32_bf16 v[104:107], v[56:59], v[40:43], v[104:107]
    v_mfma_f32_16x16x32_bf16 v[108:111], v[56:59], v[44:47], v[108:111]
    v_mfma_f32_16x16x32_bf16 v[96:99], v[60:63], v[32:35], v[96:99]
    v_mfma_f32_16x16x32_bf16 v[100:103], v[60:63], v[36:39], v[100:103]
    v_mfma_f32_16x16x32_bf16 v[104:107], v[60:63], v[40:43], v[104:107]
    v_mfma_f32_16x16x32_bf16 v[108:111], v[60:63], v[44:47], v[108:111]
    v_mfma_f32_16x16x32_bf16 v[112:115], v[64:67], v[16:19], 0
    v_mfma_f32_16x16x32_bf16 v[116:119], v[64:67], v[20:23], 0
    v_mfma_f32_16x16x32_bf16 v[120:123], v[64:67], v[24:27], 0
    v_mfma_f32_16x16x32_bf16 v[124:127], v[64:67], v[28:31], 0
    v_mfma_f32_16x16x32_bf16 v[112:115], v[68:71], v[16:19], v[112:115]
    v_mfma_f32_16x16x32_bf16 v[116:119], v[68:71], v[20:23], v[116:119]
    v_mfma_f32_16x16x32_bf16 v[120:123], v[68:71], v[24:27], v[120:123]
    v_mfma_f32_16x16x32_bf16 v[124:127], v[68:71], v[28:31], v[124:127]
    v_mfma_f32_16x16x32_bf16 v[112:115], v[72:75], v[32:35], v[112:115]
    v_mfma_f32_16x16x32_bf16 v[116:119], v[72:75], v[36:39], v[116:119]
    v_mfma_f32_16x16x32_bf16 v[120:123], v[72:75], v[40:43], v[120:123]
    v_mfma_f32_16x16x32_bf16 v[124:127], v[72:75], v[44:47], v[124:127]
    v_mfma_f32_16x16x32_bf16 v[112:115], v[76:79], v[32:35], v[112:115]
    v_mfma_f32_16x16x32_bf16 v[116:119], v[76:79], v[36:39], v[116:119]
    v_mfma_f32_16x16x32_bf16 v[120:123], v[76:79], v[40:43], v[120:123]
    v_mfma_f32_16x16x32_bf16 v[124:127], v[76:79], v[44:47], v[124:127]
    v_mfma_f32_16x16x32_bf16 v[128:131], v[80:83], v[16:19], 0
    v_mfma_f32_16x16x32_bf16 v[132:135], v[80:83], v[20:23], 0
    v_mfma_f32_16x16x32_bf16 v[136:139], v[80:83], v[24:27], 0
    v_mfma_f32_16x16x32_bf16 v[140:143], v[80:83], v[28:31], 0
    v_mfma_f32_16x16x32_bf16 v[128:131], v[84:87], v[16:19], v[128:131]
    v_mfma_f32_16x16x32_bf16 v[132:135], v[84:87], v[20:23], v[132:135]
    v_mfma_f32_16x16x32_bf16 v[136:139], v[84:87], v[24:27], v[136:139]
    v_mfma_f32_16x16x32_bf16 v[140:143], v[84:87], v[28:31], v[140:143]
    v_mfma_f32_16x16x32_bf16 v[128:131], v[88:91], v[32:35], v[128:131]
    v_mfma_f32_16x16x32_bf16 v[132:135], v[88:91], v[36:39], v[132:135]
    v_mfma_f32_16x16x32_bf16 v[136:139], v[88:91], v[40:43], v[136:139]
    v_mfma_f32_16x16x32_bf16 v[140:143], v[88:91], v[44:47], v[140:143]
    v_mfma_f32_16x16x32_bf16 v[128:131], v[92:95], v[32:35], v[128:131]
    v_mfma_f32_16x16x32_bf16 v[132:135], v[92:95], v[36:39], v[132:135]
    v_mfma_f32_16x16x32_bf16 v[136:139], v[92:95], v[40:43], v[136:139]
    v_mfma_f32_16x16x32_bf16 v[140:143], v[92:95], v[44:47], v[140:143]
    s_nop 7
    v_mov_b32 v16, v96
    v_mul_f32 v20, v96, v96
    v_mov_b32 v17, v100
    v_mul_f32 v21, v100, v100
    v_mov_b32 v18, v104
    v_mul_f32 v22, v104, v104
    v_mov_b32 v19, v108
    v_mul_f32 v23, v108, v108
    v_add_f32 v16, v16, v97
    v_fmac_f32 v20, v97, v97
    v_add_f32 v17, v17, v101
    v_fmac_f32 v21, v101, v101
    v_add_f32 v18, v18, v105
    v_fmac_f32 v22, v105, v105
    v_add_f32 v19, v19, v109
    v_fmac_f32 v23, v109, v109
    v_add_f32 v16, v16, v98
    v_fmac_f32 v20, v98, v98
    v_add_f32 v17, v17, v102
    v_fmac_f32 v21, v102, v102
    v_add_f32 v18, v18, v106
    v_fmac_f32 v22, v106, v106
    v_add_f32 v19, v19, v110
    v_fmac_f32 v23, v110, v110
    v_add_f32 v16, v16, v99
    v_fmac_f32 v20, v99, v99
    v_add_f32 v17, v17, v103
    v_fmac_f32 v21, v103, v103
    v_add_f32 v18, v18, v107
    v_fmac_f32 v22, v107, v107
    v_add_f32 v19, v19, v111
    v_fmac_f32 v23, v111, v111
    v_add_f32 v16, v16, v112
    v_fmac_f32 v20, v112, v112
    v_add_f32 v17, v17, v116
    v_fmac_f32 v21, v116, v116
    v_add_f32 v18, v18, v120
    v_fmac_f32 v22, v120, v120
    v_add_f32 v19, v19, v124
    v_fmac_f32 v23, v124, v124
    v_add_f32 v16, v16, v113
    v_fmac_f32 v20, v113, v113
    v_add_f32 v17, v17, v117
    v_fmac_f32 v21, v117, v117
    v_add_f32 v18, v18, v121
    v_fmac_f32 v22, v121, v121
    v_add_f32 v19, v19, v125
    v_fmac_f32 v23, v125, v125
    v_add_f32 v16, v16, v114
    v_fmac_f32 v20, v114, v114
    v_add_f32 v17, v17, v118
    v_fmac_f32 v21, v118, v118
    v_add_f32 v18, v18, v122
    v_fmac_f32 v22, v122, v122
    v_add_f32 v19, v19, v126
    v_fmac_f32 v23, v126, v126
    v_add_f32 v16, v16, v115
    v_fmac_f32 v20, v115, v115
    v_add_f32 v17, v17, v119
    v_fmac_f32 v21, v119, v119
    v_add_f32 v18, v18, v123
    v_fmac_f32 v22, v123, v123
    v_add_f32 v19, v19, v127
    v_fmac_f32 v23, v127, v127
    v_add_f32 v16, v16, v128
    v_fmac_f32 v20, v128, v128
    v_add_f32 v17, v17, v132
    v_fmac_f32 v21, v132, v132
    v_add_f32 v18, v18, v136
    v_fmac_f32 v22, v136, v136
    v_add_f32 v19, v19, v140
    v_fmac_f32 v23, v140, v140
    v_add_f32 v16, v16, v129
    v_fmac_f32 v20, v129, v129
    v_add_f32 v17, v17, v133
    v_fmac_f32 v21, v133, v133
    v_add_f32 v18, v18, v137
    v_fmac_f32 v22, v137, v137
    v_add_f32 v19, v19, v141
    v_fmac_f32 v23, v141, v141
    v_add_f32 v16, v16, v130
    v_fmac_f32 v20, v130, v130
    v_add_f32 v17, v17, v134
    v_fmac_f32 v21, v134, v134
    v_add_f32 v18, v18, v138
    v_fmac_f32 v22, v138, v138
    v_add_f32 v19, v19, v142
    v_fmac_f32 v23, v142, v142
    v_add_f32 v16, v16, v131
    v_fmac_f32 v20, v131, v131
    v_add_f32 v17, v17, v135
    v_fmac_f32 v21, v135, v135
    v_add_f32 v18, v18, v139
    v_fmac_f32 v22, v139, v139
    v_add_f32 v19, v19, v143
    v_fmac_f32 v23, v143, v143
    v_mov_b32 v24, v16
    v_mov_b32 v25, v17
    v_mov_b32 v26, v18
    v_mov_b32 v27, v19
    v_mov_b32 v28, v20
    v_mov_b32 v29, v21
    v_mov_b32 v30, v22
    v_mov_b32 v31, v23
    s_nop 0
    v_permlane32_swap_b32 v16, v24
    v_permlane32_swap_b32 v17, v25
    v_permlane32_swap_b32 v18, v26
    v_permlane32_swap_b32 v19, v27
    v_permlane32_swap_b32 v20, v28
    v_permlane32_swap_b32 v21, v29
    v_permlane32_swap_b32 v22, v30
    v_permlane32_swap_b32 v23, v31
    v_add_f32 v16, v16, v24
    v_add_f32 v17, v17, v25
    v_add_f32 v18, v18, v26
    v_add_f32 v19, v19, v27
    v_add_f32 v20, v20, v28
    v_add_f32 v21, v21, v29
    v_add_f32 v22, v22, v30
    v_add_f32 v23, v23, v31
    v_mov_b32 v24, v16
    v_mov_b32 v25, v17
    v_mov_b32 v26, v18
    v_mov_b32 v27, v19
    v_mov_b32 v28, v20
    v_mov_b32 v29, v21
    v_mov_b32 v30, v22
    v_mov_b32 v31, v23
    s_nop 0
    v_permlane16_swap_b32 v16, v24
    v_permlane16_swap_b32 v17, v25
    v_permlane16_swap_b32 v18, v26
    v_permlane16_swap_b32 v19, v27
    v_permlane16_swap_b32 v20, v28
    v_permlane16_swap_b32 v21, v29
    v_permlane16_swap_b32 v22, v30
    v_permlane16_swap_b32 v23, v31
    v_add_f32 v16, v16, v24
    v_add_f32 v17, v17, v25
    v_add_f32 v18, v18, v26
    v_add_f32 v19, v19, v27
    v_add_f32 v20, v20, v28
    v_add_f32 v21, v21, v29
    v_add_f32 v22, v22, v30
    v_add_f32 v23, v23, v31
    s_branch K34_WR
K34_IDLE:
    v_mov_b32 v16, 0
    v_mov_b32 v17, 0
    v_mov_b32 v18, 0
    v_mov_b32 v19, 0
    v_mov_b32 v20, 0
    v_mov_b32 v21, 0
    v_mov_b32 v22, 0
    v_mov_b32 v23, 0
K34_WR:
    s_lshl_b32 s24, s3, 9
    v_lshlrev_b32 v7, 4, v3
    v_add_u32 v7, s24, v7
    ds_write_b128 v7, v[16:19] offset:12288
    ds_write_b128 v7, v[20:23] offset:12544
    s_waitcnt lgkmcnt(0)
    s_barrier
    s_cmp_lg_u32 s3, 0
    s_cbranch_scc1 K34_WAIT
    v_lshlrev_b32 v7, 2, v2
    ds_read_b32 v16, v7 offset:12288
    ds_read_b32 v17, v7 offset:12800
    ds_read_b32 v18, v7 offset:13312
    ds_read_b32 v19, v7 offset:13824
    ds_read_b32 v20, v7 offset:14336
    ds_read_b32 v21, v7 offset:14848
    ds_read_b32 v22, v7 offset:15360
    ds_read_b32 v23, v7 offset:15872
    ds_read_b32 v24, v7 offset:16384
    ds_read_b32 v25, v7 offset:16896
    ds_read_b32 v26, v7 offset:17408
    ds_read_b32 v27, v7 offset:17920
    s_waitcnt lgkmcnt(0)
    ds_read_b32 v32, v7 offset:12544
    ds_read_b32 v33, v7 offset:13056
    ds_read_b32 v34, v7 offset:13568
    ds_read_b32 v35, v7 offset:14080
    ds_read_b32 v36, v7 offset:14592
    ds_read_b32 v37, v7 offset:15104
    ds_read_b32 v38, v7 offset:15616
    ds_read_b32 v39, v7 offset:16128
    ds_read_b32 v40, v7 offset:16640
    ds_read_b32 v41, v7 offset:17152
    ds_read_b32 v42, v7 offset:17664
    ds_read_b32 v43, v7 offset:18176
    v_add_f32 v16, v16, v17
    v_add_f32 v16, v16, v18
    v_add_f32 v16, v16, v19
    v_add_f32 v16, v16, v20
    v_add_f32 v16, v16, v21
    v_add_f32 v16, v16, v22
    v_add_f32 v16, v16, v23
    v_add_f32 v16, v16, v24
    v_add_f32 v16, v16, v25
    v_add_f32 v16, v16, v26
    v_add_f32 v16, v16, v27
    s_waitcnt lgkmcnt(0)
    v_add_f32 v32, v32, v33
    v_add_f32 v32, v32, v34
    v_add_f32 v32, v32, v35
    v_add_f32 v32, v32, v36
    v_add_f32 v32, v32, v37
    v_add_f32 v32, v32, v38
    v_add_f32 v32, v32, v39
    v_add_f32 v32, v32, v40
    v_add_f32 v32, v32, v41
    v_add_f32 v32, v32, v42
    v_add_f32 v32, v32, v43
    s_lshl_b32 s24, s6, 4
    s_add_u32 s24, s24, s7
    s_lshl_b32 s24, s24, 9
    buffer_store_dword v16, v7, s[12:15], s24 offen sc1
    buffer_store_dword v32, v7, s[12:15], s24 offen offset:256 sc1
    s_mov_b32 s26, 20000
K34_POLL:
    s_lshl_b32 s24, s6, 13
    buffer_load_dword v16, v7, s[12:15], s24 offen offset:0 sc1
    buffer_load_dword v32, v7, s[12:15], s24 offen offset:256 sc1
    buffer_load_dword v17, v7, s[12:15], s24 offen offset:512 sc1
    buffer_load_dword v33, v7, s[12:15], s24 offen offset:768 sc1
    buffer_load_dword v18, v7, s[12:15], s24 offen offset:1024 sc1
    buffer_load_dword v34, v7, s[12:15], s24 offen offset:1280 sc1
    buffer_load_dword v19, v7, s[12:15], s24 offen offset:1536 sc1
    buffer_load_dword v35, v7, s[12:15], s24 offen offset:1792 sc1
    buffer_load_dword v20, v7, s[12:15], s24 offen offset:2048 sc1
    buffer_load_dword v36, v7, s[12:15], s24 offen offset:2304 sc1
    buffer_load_dword v21, v7, s[12:15], s24 offen offset:2560 sc1
    buffer_load_dword v37, v7, s[12:15], s24 offen offset:2816 sc1
    buffer_load_dword v22, v7, s[12:15], s24 offen offset:3072 sc1
    buffer_load_dword v38, v7, s[12:15], s24 offen offset:3328 sc1
    buffer_load_dword v23, v7, s[12:15], s24 offen offset:3584 sc1
    buffer_load_dword v39, v7, s[12:15], s24 offen offset:3840 sc1
    s_add_u32 s24, s24, 4096
    buffer_load_dword v24, v7, s[12:15], s24 offen offset:0 sc1
    buffer_load_dword v40, v7, s[12:15], s24 offen offset:256 sc1
    buffer_load_dword v25, v7, s[12:15], s24 offen offset:512 sc1
    buffer_load_dword v41, v7, s[12:15], s24 offen offset:768 sc1
    buffer_load_dword v26, v7, s[12:15], s24 offen offset:1024 sc1
    buffer_load_dword v42, v7, s[12:15], s24 offen offset:1280 sc1
    buffer_load_dword v27, v7, s[12:15], s24 offen offset:1536 sc1
    buffer_load_dword v43, v7, s[12:15], s24 offen offset:1792 sc1
    buffer_load_dword v28, v7, s[12:15], s24 offen offset:2048 sc1
    buffer_load_dword v44, v7, s[12:15], s24 offen offset:2304 sc1
    buffer_load_dword v29, v7, s[12:15], s24 offen offset:2560 sc1
    buffer_load_dword v45, v7, s[12:15], s24 offen offset:2816 sc1
    buffer_load_dword v30, v7, s[12:15], s24 offen offset:3072 sc1
    buffer_load_dword v46, v7, s[12:15], s24 offen offset:3328 sc1
    buffer_load_dword v31, v7, s[12:15], s24 offen offset:3584 sc1
    buffer_load_dword v47, v7, s[12:15], s24 offen offset:3840 sc1
    s_waitcnt vmcnt(0)
    v_max3_u32 v48, v16, v17, v18
    v_max3_u32 v48, v48, v19, v20
    v_max3_u32 v48, v48, v21, v22
    v_max3_u32 v48, v48, v23, v24
    v_max3_u32 v48, v48, v25, v26
    v_max3_u32 v48, v48, v27, v28
    v_max3_u32 v48, v48, v29, v30
    v_max3_u32 v48, v48, v31, v32
    v_max3_u32 v48, v48, v33, v34
    v_max3_u32 v48, v48, v35, v36
    v_max3_u32 v48, v48, v37, v38
    v_max3_u32 v48, v48, v39, v40
    v_max3_u32 v48, v48, v41, v42
    v_max3_u32 v48, v48, v43, v44
    v_max3_u32 v48, v48, v45, v46
    v_max_u32 v48, v48, v47
    v_cmp_eq_u32 vcc, -1, v48
    s_sub_u32 s26, s26, 1
    s_cmp_eq_u32 s26, 0
    s_cbranch_scc1 K34_GOT
    s_cbranch_vccz K34_GOT
    s_sleep 1
    s_branch K34_POLL
K34_GOT:
    v_add_f32 v16, v16, v24
    v_add_f32 v32, v32, v40
    v_add_f32 v17, v17, v25
    v_add_f32 v33, v33, v41
    v_add_f32 v18, v18, v26
    v_add_f32 v34, v34, v42
    v_add_f32 v19, v19, v27
    v_add_f32 v35, v35, v43
    v_add_f32 v20, v20, v28
    v_add_f32 v36, v36, v44
    v_add_f32 v21, v21, v29
    v_add_f32 v37, v37, v45
    v_add_f32 v22, v22, v30
    v_add_f32 v38, v38, v46
    v_add_f32 v23, v23, v31
    v_add_f32 v39, v39, v47
    v_add_f32 v16, v16, v20
    v_add_f32 v32, v32, v36
    v_add_f32 v17, v17, v21
    v_add_f32 v33, v33, v37
    v_add_f32 v18, v18, v22
    v_add_f32 v34, v34, v38
    v_add_f32 v19, v19, v23
    v_add_f32 v35, v35, v39
    v_add_f32 v16, v16, v18
    v_add_f32 v32, v32, v34
    v_add_f32 v17, v17, v19
    v_add_f32 v33, v33, v35
    v_add_f32 v16, v16, v17
    v_add_f32 v32, v32, v33
    v_mul_f32 v11, 0x39035177, v16
    v_mul_f32 v12, 0x39035177, v32
    v_fma_f32 v12, -v11, v11, v12
    v_max_f32 v12, 0, v12
    v_add_f32 v12, 0x3727c5ac, v12
    v_sqrt_f32 v12, v12
    v_lshlrev_b32 v9, 16, v152
    v_rcp_f32 v12, v12
    v_lshlrev_b32 v10, 16, v153
    v_mul_f32 v9, v9, v12
    v_fma_f32 v10, -v11, v9, v10
    ds_write_b32 v7, v9 offset:18432
    ds_write_b32 v7, v10 offset:18688
    s_waitcnt lgkmcnt(0)
K34_WAIT:
    s_barrier
    s_cmp_lt_u32 s3, s23
    s_cbranch_scc0 K34_END
    v_lshlrev_b32 v7, 4, v3
    ds_read_b128 v[144:147], v7 offset:18432
    ds_read_b128 v[148:151], v7 offset:18688
    s_mul_i32 s24, s20, 8176640
    s_add_u32 s16, s44, s24
    s_addc_u32 s17, s45, 0
    s_and_b32 s17, s17, 0xffff
    s_mov_b32 s18, 8176640
    s_mov_b32 s19, 0x00020000
    v_lshlrev_b32 v7, 12, v4
    v_lshl_add_u32 v7, v3, 3, v7
    s_lshl_b32 s24, s21, 7
    v_add_u32 v7, s24, v7
    s_mul_i32 s25, s22, 49152
    s_mov_b32 s30, 0xc0135761
    s_mov_b32 s31, 0xbdd2d3e8
    v_mov_b32 v15, s30
    s_waitcnt lgkmcnt(0)
    v_fma_f32 v16, v96, v144, v148
    v_fma_f32 v17, v100, v145, v149
    v_fma_f32 v18, v104, v146, v150
    v_fma_f32 v19, v108, v147, v151
    v_fma_f32 v20, v97, v144, v148
    v_fma_f32 v21, v101, v145, v149
    v_fma_f32 v22, v105, v146, v150
    v_fma_f32 v23, v109, v147, v151
    v_mul_f32 v24, v16, v16
    v_mul_f32 v25, v17, v17
    v_mul_f32 v26, v18, v18
    v_mul_f32 v27, v19, v19
    v_mul_f32 v28, v20, v20
    v_mul_f32 v29, v21, v21
    v_mul_f32 v30, v22, v22
    v_mul_f32 v31, v23, v23
    v_fma_f32 v24, v24, s31, v15
    v_fma_f32 v25, v25, s31, v15
    v_fma_f32 v26, v26, s31, v15
    v_fma_f32 v27, v27, s31, v15
    v_fma_f32 v28, v28, s31, v15
    v_fma_f32 v29, v29, s31, v15
    v_fma_f32 v30, v30, s31, v15
    v_fma_f32 v31, v31, s31, v15
    v_mul_f32 v24, v24, v16
    v_mul_f32 v25, v25, v17
    v_mul_f32 v26, v26, v18
    v_mul_f32 v27, v27, v19
    v_mul_f32 v28, v28, v20
    v_mul_f32 v29, v29, v21
    v_mul_f32 v30, v30, v22
    v_mul_f32 v31, v31, v23
    v_exp_f32 v24, v24
    v_exp_f32 v25, v25
    v_exp_f32 v26, v26
    v_exp_f32 v27, v27
    v_exp_f32 v28, v28
    v_exp_f32 v29, v29
    v_exp_f32 v30, v30
    v_exp_f32 v31, v31
    v_add_f32 v24, 1.0, v24
    v_add_f32 v25, 1.0, v25
    v_add_f32 v26, 1.0, v26
    v_add_f32 v27, 1.0, v27
    v_add_f32 v28, 1.0, v28
    v_add_f32 v29, 1.0, v29
    v_add_f32 v30, 1.0, v30
    v_add_f32 v31, 1.0, v31
    v_rcp_f32 v24, v24
    v_rcp_f32 v25, v25
    v_rcp_f32 v26, v26
    v_rcp_f32 v27, v27
    v_rcp_f32 v28, v28
    v_rcp_f32 v29, v29
    v_rcp_f32 v30, v30
    v_rcp_f32 v31, v31
    v_mul_f32 v16, v16, v24
    v_mul_f32 v17, v17, v25
    v_mul_f32 v18, v18, v26
    v_mul_f32 v19, v19, v27
    v_mul_f32 v20, v20, v28
    v_mul_f32 v21, v21, v29
    v_mul_f32 v22, v22, v30
    v_mul_f32 v23, v23, v31
    v_cvt_pk_bf16_f32 v32, v16, v17
    v_cvt_pk_bf16_f32 v33, v18, v19
    buffer_store_dwordx2 v[32:33], v7, s[16:19], s25 offen offset:0 sc1
    v_cvt_pk_bf16_f32 v34, v20, v21
    v_cvt_pk_bf16_f32 v35, v22, v23
    buffer_store_dwordx2 v[34:35], v7, s[16:19], s25 offen offset:1024 sc1
    s_add_u32 s25, s25, 2048
    v_fma_f32 v36, v98, v144, v148
    v_fma_f32 v37, v102, v145, v149
    v_fma_f32 v38, v106, v146, v150
    v_fma_f32 v39, v110, v147, v151
    v_fma_f32 v40, v99, v144, v148
    v_fma_f32 v41, v103, v145, v149
    v_fma_f32 v42, v107, v146, v150
    v_fma_f32 v43, v111, v147, v151
    v_mul_f32 v44, v36, v36
    v_mul_f32 v45, v37, v37
    v_mul_f32 v46, v38, v38
    v_mul_f32 v47, v39, v39
    v_mul_f32 v48, v40, v40
    v_mul_f32 v49, v41, v41
    v_mul_f32 v50, v42, v42
    v_mul_f32 v51, v43, v43
    v_fma_f32 v44, v44, s31, v15
    v_fma_f32 v45, v45, s31, v15
    v_fma_f32 v46, v46, s31, v15
    v_fma_f32 v47, v47, s31, v15
    v_fma_f32 v48, v48, s31, v15
    v_fma_f32 v49, v49, s31, v15
    v_fma_f32 v50, v50, s31, v15
    v_fma_f32 v51, v51, s31, v15
    v_mul_f32 v44, v44, v36
    v_mul_f32 v45, v45, v37
    v_mul_f32 v46, v46, v38
    v_mul_f32 v47, v47, v39
    v_mul_f32 v48, v48, v40
    v_mul_f32 v49, v49, v41
    v_mul_f32 v50, v50, v42
    v_mul_f32 v51, v51, v43
    v_exp_f32 v44, v44
    v_exp_f32 v45, v45
    v_exp_f32 v46, v46
    v_exp_f32 v47, v47
    v_exp_f32 v48, v48
    v_exp_f32 v49, v49
    v_exp_f32 v50, v50
    v_exp_f32 v51, v51
    v_add_f32 v44, 1.0, v44
    v_add_f32 v45, 1.0, v45
    v_add_f32 v46, 1.0, v46
    v_add_f32 v47, 1.0, v47
    v_add_f32 v48, 1.0, v48
    v_add_f32 v49, 1.0, v49
    v_add_f32 v50, 1.0, v50
    v_add_f32 v51, 1.0, v51
    v_rcp_f32 v44, v44
    v_rcp_f32 v45, v45
    v_rcp_f32 v46, v46
    v_rcp_f32 v47, v47
    v_rcp_f32 v48, v48
    v_rcp_f32 v49, v49
    v_rcp_f32 v50, v50
    v_rcp_f32 v51, v51
    v_mul_f32 v36, v36, v44
    v_mul_f32 v37, v37, v45
    v_mul_f32 v38, v38, v46
    v_mul_f32 v39, v39, v47
    v_mul_f32 v40, v40, v48
    v_mul_f32 v41, v41, v49
    v_mul_f32 v42, v42, v50
    v_mul_f32 v43, v43, v51
    v_cvt_pk_bf16_f32 v52, v36, v37
    v_cvt_pk_bf16_f32 v53, v38, v39
    buffer_store_dwordx2 v[52:53], v7, s[16:19], s25 offen offset:0 sc1
    v_cvt_pk_bf16_f32 v54, v40, v41
    v_cvt_pk_bf16_f32 v55, v42, v43
    buffer_store_dwordx2 v[54:55], v7, s[16:19], s25 offen offset:1024 sc1
    s_add_u32 s25, s25, 2048
    s_add_u32 s25, s25, 12288
    v_fma_f32 v16, v112, v144, v148
    v_fma_f32 v17, v116, v145, v149
    v_fma_f32 v18, v120, v146, v150
    v_fma_f32 v19, v124, v147, v151
    v_fma_f32 v20, v113, v144, v148
    v_fma_f32 v21, v117, v145, v149
    v_fma_f32 v22, v121, v146, v150
    v_fma_f32 v23, v125, v147, v151
    v_mul_f32 v24, v16, v16
    v_mul_f32 v25, v17, v17
    v_mul_f32 v26, v18, v18
    v_mul_f32 v27, v19, v19
    v_mul_f32 v28, v20, v20
    v_mul_f32 v29, v21, v21
    v_mul_f32 v30, v22, v22
    v_mul_f32 v31, v23, v23
    v_fma_f32 v24, v24, s31, v15
    v_fma_f32 v25, v25, s31, v15
    v_fma_f32 v26, v26, s31, v15
    v_fma_f32 v27, v27, s31, v15
    v_fma_f32 v28, v28, s31, v15
    v_fma_f32 v29, v29, s31, v15
    v_fma_f32 v30, v30, s31, v15
    v_fma_f32 v31, v31, s31, v15
    v_mul_f32 v24, v24, v16
    v_mul_f32 v25, v25, v17
    v_mul_f32 v26, v26, v18
    v_mul_f32 v27, v27, v19
    v_mul_f32 v28, v28, v20
    v_mul_f32 v29, v29, v21
    v_mul_f32 v30, v30, v22
    v_mul_f32 v31, v31, v23
    v_exp_f32 v24, v24
    v_exp_f32 v25, v25
    v_exp_f32 v26, v26
    v_exp_f32 v27, v27
    v_exp_f32 v28, v28
    v_exp_f32 v29, v29
    v_exp_f32 v30, v30
    v_exp_f32 v31, v31
    v_add_f32 v24, 1.0, v24
    v_add_f32 v25, 1.0, v25
    v_add_f32 v26, 1.0, v26
    v_add_f32 v27, 1.0, v27
    v_add_f32 v28, 1.0, v28
    v_add_f32 v29, 1.0, v29
    v_add_f32 v30, 1.0, v30
    v_add_f32 v31, 1.0, v31
    v_rcp_f32 v24, v24
    v_rcp_f32 v25, v25
    v_rcp_f32 v26, v26
    v_rcp_f32 v27, v27
    v_rcp_f32 v28, v28
    v_rcp_f32 v29, v29
    v_rcp_f32 v30, v30
    v_rcp_f32 v31, v31
    v_mul_f32 v16, v16, v24
    v_mul_f32 v17, v17, v25
    v_mul_f32 v18, v18, v26
    v_mul_f32 v19, v19, v27
    v_mul_f32 v20, v20, v28
    v_mul_f32 v21, v21, v29
    v_mul_f32 v22, v22, v30
    v_mul_f32 v23, v23, v31
    v_cvt_pk_bf16_f32 v32, v16, v17
    v_cvt_pk_bf16_f32 v33, v18, v19
    buffer_store_dwordx2 v[32:33], v7, s[16:19], s25 offen offset:0 sc1
    v_cvt_pk_bf16_f32 v34, v20, v21
    v_cvt_pk_bf16_f32 v35, v22, v23
    buffer_store_dwordx2 v[34:35], v7, s[16:19], s25 offen offset:1024 sc1
    s_add_u32 s25, s25, 2048
    v_fma_f32 v36, v114, v144, v148
    v_fma_f32 v37, v118, v145, v149
    v_fma_f32 v38, v122, v146, v150
    v_fma_f32 v39, v126, v147, v151
    v_fma_f32 v40, v115, v144, v148
    v_fma_f32 v41, v119, v145, v149
    v_fma_f32 v42, v123, v146, v150
    v_fma_f32 v43, v127, v147, v151
    v_mul_f32 v44, v36, v36
    v_mul_f32 v45, v37, v37
    v_mul_f32 v46, v38, v38
    v_mul_f32 v47, v39, v39
    v_mul_f32 v48, v40, v40
    v_mul_f32 v49, v41, v41
    v_mul_f32 v50, v42, v42
    v_mul_f32 v51, v43, v43
    v_fma_f32 v44, v44, s31, v15
    v_fma_f32 v45, v45, s31, v15
    v_fma_f32 v46, v46, s31, v15
    v_fma_f32 v47, v47, s31, v15
    v_fma_f32 v48, v48, s31, v15
    v_fma_f32 v49, v49, s31, v15
    v_fma_f32 v50, v50, s31, v15
    v_fma_f32 v51, v51, s31, v15
    v_mul_f32 v44, v44, v36
    v_mul_f32 v45, v45, v37
    v_mul_f32 v46, v46, v38
    v_mul_f32 v47, v47, v39
    v_mul_f32 v48, v48, v40
    v_mul_f32 v49, v49, v41
    v_mul_f32 v50, v50, v42
    v_mul_f32 v51, v51, v43
    v_exp_f32 v44, v44
    v_exp_f32 v45, v45
    v_exp_f32 v46, v46
    v_exp_f32 v47, v47
    v_exp_f32 v48, v48
    v_exp_f32 v49, v49
    v_exp_f32 v50, v50
    v_exp_f32 v51, v51
    v_add_f32 v44, 1.0, v44
    v_add_f32 v45, 1.0, v45
    v_add_f32 v46, 1.0, v46
    v_add_f32 v47, 1.0, v47
    v_add_f32 v48, 1.0, v48
    v_add_f32 v49, 1.0, v49
    v_add_f32 v50, 1.0, v50
    v_add_f32 v51, 1.0, v51
    v_rcp_f32 v44, v44
    v_rcp_f32 v45, v45
    v_rcp_f32 v46, v46
    v_rcp_f32 v47, v47
    v_rcp_f32 v48, v48
    v_rcp_f32 v49, v49
    v_rcp_f32 v50, v50
    v_rcp_f32 v51, v51
    v_mul_f32 v36, v36, v44
    v_mul_f32 v37, v37, v45
    v_mul_f32 v38, v38, v46
    v_mul_f32 v39, v39, v47
    v_mul_f32 v40, v40, v48
    v_mul_f32 v41, v41, v49
    v_mul_f32 v42, v42, v50
    v_mul_f32 v43, v43, v51
    v_cvt_pk_bf16_f32 v52, v36, v37
    v_cvt_pk_bf16_f32 v53, v38, v39
    buffer_store_dwordx2 v[52:53], v7, s[16:19], s25 offen offset:0 sc1
    v_cvt_pk_bf16_f32 v54, v40, v41
    v_cvt_pk_bf16_f32 v55, v42, v43
    buffer_store_dwordx2 v[54:55], v7, s[16:19], s25 offen offset:1024 sc1
    s_add_u32 s25, s25, 2048
    s_add_u32 s25, s25, 12288
    v_fma_f32 v16, v128, v144, v148
    v_fma_f32 v17, v132, v145, v149
    v_fma_f32 v18, v136, v146, v150
    v_fma_f32 v19, v140, v147, v151
    v_fma_f32 v20, v129, v144, v148
    v_fma_f32 v21, v133, v145, v149
    v_fma_f32 v22, v137, v146, v150
    v_fma_f32 v23, v141, v147, v151
    v_mul_f32 v24, v16, v16
    v_mul_f32 v25, v17, v17
    v_mul_f32 v26, v18, v18
    v_mul_f32 v27, v19, v19
    v_mul_f32 v28, v20, v20
    v_mul_f32 v29, v21, v21
    v_mul_f32 v30, v22, v22
    v_mul_f32 v31, v23, v23
    v_fma_f32 v24, v24, s31, v15
    v_fma_f32 v25, v25, s31, v15
    v_fma_f32 v26, v26, s31, v15
    v_fma_f32 v27, v27, s31, v15
    v_fma_f32 v28, v28, s31, v15
    v_fma_f32 v29, v29, s31, v15
    v_fma_f32 v30, v30, s31, v15
    v_fma_f32 v31, v31, s31, v15
    v_mul_f32 v24, v24, v16
    v_mul_f32 v25, v25, v17
    v_mul_f32 v26, v26, v18
    v_mul_f32 v27, v27, v19
    v_mul_f32 v28, v28, v20
    v_mul_f32 v29, v29, v21
    v_mul_f32 v30, v30, v22
    v_mul_f32 v31, v31, v23
    v_exp_f32 v24, v24
    v_exp_f32 v25, v25
    v_exp_f32 v26, v26
    v_exp_f32 v27, v27
    v_exp_f32 v28, v28
    v_exp_f32 v29, v29
    v_exp_f32 v30, v30
    v_exp_f32 v31, v31
    v_add_f32 v24, 1.0, v24
    v_add_f32 v25, 1.0, v25
    v_add_f32 v26, 1.0, v26
    v_add_f32 v27, 1.0, v27
    v_add_f32 v28, 1.0, v28
    v_add_f32 v29, 1.0, v29
    v_add_f32 v30, 1.0, v30
    v_add_f32 v31, 1.0, v31
    v_rcp_f32 v24, v24
    v_rcp_f32 v25, v25
    v_rcp_f32 v26, v26
    v_rcp_f32 v27, v27
    v_rcp_f32 v28, v28
    v_rcp_f32 v29, v29
    v_rcp_f32 v30, v30
    v_rcp_f32 v31, v31
    v_mul_f32 v16, v16, v24
    v_mul_f32 v17, v17, v25
    v_mul_f32 v18, v18, v26
    v_mul_f32 v19, v19, v27
    v_mul_f32 v20, v20, v28
    v_mul_f32 v21, v21, v29
    v_mul_f32 v22, v22, v30
    v_mul_f32 v23, v23, v31
    v_cvt_pk_bf16_f32 v32, v16, v17
    v_cvt_pk_bf16_f32 v33, v18, v19
    buffer_store_dwordx2 v[32:33], v7, s[16:19], s25 offen offset:0 sc1
    v_cvt_pk_bf16_f32 v34, v20, v21
    v_cvt_pk_bf16_f32 v35, v22, v23
    buffer_store_dwordx2 v[34:35], v7, s[16:19], s25 offen offset:1024 sc1
    s_add_u32 s25, s25, 2048
    v_fma_f32 v36, v130, v144, v148
    v_fma_f32 v37, v134, v145, v149
    v_fma_f32 v38, v138, v146, v150
    v_fma_f32 v39, v142, v147, v151
    v_fma_f32 v40, v131, v144, v148
    v_fma_f32 v41, v135, v145, v149
    v_fma_f32 v42, v139, v146, v150
    v_fma_f32 v43, v143, v147, v151
    v_mul_f32 v44, v36, v36
    v_mul_f32 v45, v37, v37
    v_mul_f32 v46, v38, v38
    v_mul_f32 v47, v39, v39
    v_mul_f32 v48, v40, v40
    v_mul_f32 v49, v41, v41
    v_mul_f32 v50, v42, v42
    v_mul_f32 v51, v43, v43
    v_fma_f32 v44, v44, s31, v15
    v_fma_f32 v45, v45, s31, v15
    v_fma_f32 v46, v46, s31, v15
    v_fma_f32 v47, v47, s31, v15
    v_fma_f32 v48, v48, s31, v15
    v_fma_f32 v49, v49, s31, v15
    v_fma_f32 v50, v50, s31, v15
    v_fma_f32 v51, v51, s31, v15
    v_mul_f32 v44, v44, v36
    v_mul_f32 v45, v45, v37
    v_mul_f32 v46, v46, v38
    v_mul_f32 v47, v47, v39
    v_mul_f32 v48, v48, v40
    v_mul_f32 v49, v49, v41
    v_mul_f32 v50, v50, v42
    v_mul_f32 v51, v51, v43
    v_exp_f32 v44, v44
    v_exp_f32 v45, v45
    v_exp_f32 v46, v46
    v_exp_f32 v47, v47
    v_exp_f32 v48, v48
    v_exp_f32 v49, v49
    v_exp_f32 v50, v50
    v_exp_f32 v51, v51
    v_add_f32 v44, 1.0, v44
    v_add_f32 v45, 1.0, v45
    v_add_f32 v46, 1.0, v46
    v_add_f32 v47, 1.0, v47
    v_add_f32 v48, 1.0, v48
    v_add_f32 v49, 1.0, v49
    v_add_f32 v50, 1.0, v50
    v_add_f32 v51, 1.0, v51
    v_rcp_f32 v44, v44
    v_rcp_f32 v45, v45
    v_rcp_f32 v46, v46
    v_rcp_f32 v47, v47
    v_rcp_f32 v48, v48
    v_rcp_f32 v49, v49
    v_rcp_f32 v50, v50
    v_rcp_f32 v51, v51
    v_mul_f32 v36, v36, v44
    v_mul_f32 v37, v37, v45
    v_mul_f32 v38, v38, v46
    v_mul_f32 v39, v39, v47
    v_mul_f32 v40, v40, v48
    v_mul_f32 v41, v41, v49
    v_mul_f32 v42, v42, v50
    v_mul_f32 v43, v43, v51
    v_cvt_pk_bf16_f32 v52, v36, v37
    v_cvt_pk_bf16_f32 v53, v38, v39
    buffer_store_dwordx2 v[52:53], v7, s[16:19], s25 offen offset:0 sc1
    v_cvt_pk_bf16_f32 v54, v40, v41
    v_cvt_pk_bf16_f32 v55, v42, v43
    buffer_store_dwordx2 v[54:55], v7, s[16:19], s25 offen offset:1024 sc1
    s_add_u32 s25, s25, 2048
    s_add_u32 s25, s25, 12288
K34_END:
    s_endpgm
TEXT_END:
.section .rodata,"a"
.p2align 6
.amdhsa_kernel k1_xform_kernel
  .amdhsa_next_free_vgpr 128
  .amdhsa_next_free_sgpr 96
  .amdhsa_accum_offset 128
  .amdhsa_group_segment_fixed_size 0
  .amdhsa_kernarg_size 56
  .amdhsa_user_sgpr_count 2
  .amdhsa_user_sgpr_kernarg_segment_ptr 1
  .amdhsa_system_sgpr_workgroup_id_x 1
.end_amdhsa_kernel
.p2align 6
.amdhsa_kernel k12_fused_kernel
  .amdhsa_next_free_vgpr 256
  .amdhsa_next_free_sgpr 96
  .amdhsa_accum_offset 256
  .amdhsa_group_segment_fixed_size 0
  .amdhsa_kernarg_size 56
  .amdhsa_user_sgpr_count 2
  .amdhsa_user_sgpr_kernarg_segment_ptr 1
  .amdhsa_system_sgpr_workgroup_id_x 1
.end_amdhsa_kernel
.p2align 6
.amdhsa_kernel k34_out_kernel
  .amdhsa_next_free_vgpr 168
  .amdhsa_next_free_sgpr 96
  .amdhsa_accum_offset 168
  .amdhsa_group_segment_fixed_size 0
  .amdhsa_kernarg_size 56
  .amdhsa_user_sgpr_count 2
  .amdhsa_user_sgpr_kernarg_segment_ptr 1
  .amdhsa_system_sgpr_workgroup_id_x 1
.end_amdhsa_kernel
```

```asm
; @launch kernel=k1_xform_kernel grid=(636,1,1) block=(256,1,1) lds=16384
; @launch kernel=k12_fused_kernel grid=(256,1,1) block=(512,1,1) lds=155872
; @launch kernel=k34_out_kernel grid=(256,1,1) block=(768,1,1) lds=18944
.amdgcn_target "amdgcn-amd-amdhsa--gfx950"
.text
.globl k1_xform_kernel
.globl k12_fused_kernel
.globl k34_out_kernel
.p2align 8
.type k1_xform_kernel,@function
k1_xform_kernel:
    s_cmp_ge_u32 s2, 636
    s_cbranch_scc1 K1_END
    s_load_dwordx4 s[4:7], s[0:1], 0
    s_load_dwordx2 s[8:9], s[0:1], 48
    v_lshrrev_b32 v120, 6, v0
    v_and_b32 v121, 63, v0
    v_readfirstlane_b32 s3, v120
    v_and_b32 v122, 15, v121
    v_lshrrev_b32 v123, 4, v121
    s_mov_b32 s28, 0x05040100
    s_mov_b32 s29, 0x07060302
    v_and_b32 v124, 3, v122
    v_lshlrev_b32 v124, 2, v124
    v_lshrrev_b32 v125, 3, v122
    v_lshl_add_u32 v124, v125, 1, v124
    s_lshl_b32 s10, s3, 4
    s_add_u32 s10, s10, 1
    v_add_u32 v124, s10, v124
    v_bfe_u32 v125, v122, 2, 1
    v_lshlrev_b32 v121, 4, v121
    s_waitcnt lgkmcnt(0)
    s_or_b32 s10, s2, s3
    s_cmp_eq_u32 s10, 0
    s_cbranch_scc0 K1_NOCLR
    s_add_u32 s12, s8, 153092096
    s_addc_u32 s13, s9, 0
    s_and_b32 s13, s13, 0xffff
    s_mov_b32 s14, 32768
    s_mov_b32 s15, 0x00020000
    v_lshrrev_b32 v118, 4, v121
    v_lshlrev_b32 v119, 10, v118
    v_mov_b32 v117, 0
    s_mov_b64 exec, 0xffff
    buffer_store_dword v117, v119, s[12:15], 0 offen
    v_lshlrev_b32 v119, 4, v118
    v_add_u32 v119, 16384, v119
    buffer_store_dword v117, v119, s[12:15], 0 offen
    s_mov_b64 exec, -1
K1_NOCLR:
    s_cmp_lt_u32 s2, 32
    s_cbranch_scc0 K1_NOFILL
    s_add_u32 s12, s8, 153616384
    s_addc_u32 s13, s9, 0
    s_and_b32 s13, s13, 0xffff
    s_mov_b32 s14, 131072
    s_mov_b32 s15, 0x00020000
    s_lshl_b32 s10, s2, 2
    s_add_u32 s10, s10, s3
    s_lshl_b32 s10, s10, 10
    v_mov_b32 v112, -1
    v_mov_b32 v113, -1
    v_mov_b32 v114, -1
    v_mov_b32 v115, -1
    buffer_store_dwordx4 v[112:115], v121, s[12:15], s10 offen
K1_NOFILL:
    s_add_u32 s10, s2, 384
    s_sub_u32 s11, s2, 252
    s_cmp_lt_u32 s2, 252
    s_cselect_b32 s2, s10, s11
    s_cmp_lt_u32 s2, 384
    s_cbranch_scc1 K1_W
    s_sub_u32 s11, s2, 384
    s_mul_hi_u32 s13, s11, 1431655766
    s_mul_i32 s12, s13, 3
    s_sub_u32 s12, s11, s12
    s_mov_b32 s11, s13
    s_cmp_ge_u32 s11, 42
    s_cselect_b32 s13, 1, 0
    s_mul_i32 s14, s13, 42
    s_sub_u32 s11, s11, s14
    s_lshl_b32 s11, s11, 2
    s_add_u32 s11, s11, s3
    s_mul_i32 s14, s13, 16384000
    s_add_u32 s16, s4, s14
    s_addc_u32 s17, s5, 0
    s_and_b32 s17, s17, 0xffff
    s_mov_b32 s18, 16384000
    s_mov_b32 s19, 0x00020000
    s_mov_b32 s20, s8
    s_mov_b32 s21, s9
    s_and_b32 s21, s21, 0xffff
    s_mov_b32 s22, 43778048
    s_mov_b32 s23, 0x00020000
    v_lshlrev_b32 v126, 14, v123
    v_lshl_add_u32 v126, v122, 4, v126
    s_mul_i32 s15, s11, 98304
    s_lshl_b32 s24, s12, 8
    s_add_u32 s15, s15, s24
    buffer_load_dwordx4 v[0:3], v126, s[16:19], s15 offen
    buffer_load_dwordx4 v[4:7], v126, s[16:19], s15 offen offset:2048
    s_add_u32 s15, s15, 4096
    buffer_load_dwordx4 v[8:11], v126, s[16:19], s15 offen
    buffer_load_dwordx4 v[12:15], v126, s[16:19], s15 offen offset:2048
    s_add_u32 s15, s15, 4096
    buffer_load_dwordx4 v[16:19], v126, s[16:19], s15 offen
    buffer_load_dwordx4 v[20:23], v126, s[16:19], s15 offen offset:2048
    s_add_u32 s15, s15, 4096
    buffer_load_dwordx4 v[24:27], v126, s[16:19], s15 offen
    buffer_load_dwordx4 v[28:31], v126, s[16:19], s15 offen offset:2048
    s_add_u32 s15, s15, 53248
    buffer_load_dwordx4 v[32:35], v126, s[16:19], s15 offen
    buffer_load_dwordx4 v[36:39], v126, s[16:19], s15 offen offset:2048
    s_add_u32 s15, s15, 4096
    buffer_load_dwordx4 v[40:43], v126, s[16:19], s15 offen
    buffer_load_dwordx4 v[44:47], v126, s[16:19], s15 offen offset:2048
    s_add_u32 s15, s15, 4096
    buffer_load_dwordx4 v[48:51], v126, s[16:19], s15 offen
    buffer_load_dwordx4 v[52:55], v126, s[16:19], s15 offen offset:2048
    s_add_u32 s15, s15, 4096
    buffer_load_dwordx4 v[56:59], v126, s[16:19], s15 offen
    buffer_load_dwordx4 v[60:63], v126, s[16:19], s15 offen offset:2048
    v_lshlrev_b32 v127, 3, v123
    v_lshlrev_b32 v112, 5, v125
    v_mad_u32_u24 v113, v124, v127, v112
    v_mad_u32_u24 v64, v124, 0, v113
    v_mad_u32_u24 v65, v124, 1, v113
    v_mad_u32_u24 v66, v124, 2, v113
    v_mad_u32_u24 v67, v124, 3, v113
    v_mad_u32_u24 v68, v124, 4, v113
    v_mad_u32_u24 v69, v124, 5, v113
    v_mad_u32_u24 v70, v124, 6, v113
    v_mad_u32_u24 v71, v124, 7, v113
    v_and_b32 v64, 127, v64
    v_and_b32 v65, 127, v65
    v_and_b32 v66, 127, v66
    v_and_b32 v67, 127, v67
    v_and_b32 v68, 127, v68
    v_and_b32 v69, 127, v69
    v_and_b32 v70, 127, v70
    v_and_b32 v71, 127, v71
    v_cvt_f32_u32 v64, v64
    v_cvt_f32_u32 v65, v65
    v_cvt_f32_u32 v66, v66
    v_cvt_f32_u32 v67, v67
    v_cvt_f32_u32 v68, v68
    v_cvt_f32_u32 v69, v69
    v_cvt_f32_u32 v70, v70
    v_cvt_f32_u32 v71, v71
    v_mul_f32 v64, 0x3c000000, v64
    v_mul_f32 v65, 0x3c000000, v65
    v_mul_f32 v66, 0x3c000000, v66
    v_mul_f32 v67, 0x3c000000, v67
    v_mul_f32 v68, 0x3c000000, v68
    v_mul_f32 v69, 0x3c000000, v69
    v_mul_f32 v70, 0x3c000000, v70
    v_mul_f32 v71, 0x3c000000, v71
    v_cos_f32 v64, v64
    v_cos_f32 v65, v65
    v_cos_f32 v66, v66
    v_cos_f32 v67, v67
    v_cos_f32 v68, v68
    v_cos_f32 v69, v69
    v_cos_f32 v70, v70
    v_cos_f32 v71, v71
    s_nop 0
    v_cvt_pk_bf16_f32 v72, v64, v65
    v_cvt_pk_bf16_f32 v73, v66, v67
    v_cvt_pk_bf16_f32 v74, v68, v69
    v_cvt_pk_bf16_f32 v75, v70, v71
    v_lshlrev_b32 v80, 16, v72
    v_and_b32 v81, 0xffff0000, v72
    v_sub_f32 v64, v64, v80
    v_sub_f32 v65, v65, v81
    v_lshlrev_b32 v80, 16, v73
    v_and_b32 v81, 0xffff0000, v73
    v_sub_f32 v66, v66, v80
    v_sub_f32 v67, v67, v81
    v_lshlrev_b32 v80, 16, v74
    v_and_b32 v81, 0xffff0000, v74
    v_sub_f32 v68, v68, v80
    v_sub_f32 v69, v69, v81
    v_lshlrev_b32 v80, 16, v75
    v_and_b32 v81, 0xffff0000, v75
    v_sub_f32 v70, v70, v80
    v_sub_f32 v71, v71, v81
    v_cvt_pk_bf16_f32 v76, v64, v65
    v_cvt_pk_bf16_f32 v77, v66, v67
    v_cvt_pk_bf16_f32 v78, v68, v69
    v_cvt_pk_bf16_f32 v79, v70, v71
    s_lshl_b32 s24, s3, 12
    v_add_u32 v114, s24, v121
    ds_write_b128 v114, v[72:75] offset:0
    ds_write_b128 v114, v[76:79] offset:1024
    v_add_u32 v127, 32, v127
    v_lshlrev_b32 v112, 5, v125
    v_mad_u32_u24 v113, v124, v127, v112
    v_mad_u32_u24 v64, v124, 0, v113
    v_mad_u32_u24 v65, v124, 1, v113
    v_mad_u32_u24 v66, v124, 2, v113
    v_mad_u32_u24 v67, v124, 3, v113
    v_mad_u32_u24 v68, v124, 4, v113
    v_mad_u32_u24 v69, v124, 5, v113
    v_mad_u32_u24 v70, v124, 6, v113
    v_mad_u32_u24 v71, v124, 7, v113
    v_and_b32 v64, 127, v64
    v_and_b32 v65, 127, v65
    v_and_b32 v66, 127, v66
    v_and_b32 v67, 127, v67
    v_and_b32 v68, 127, v68
    v_and_b32 v69, 127, v69
    v_and_b32 v70, 127, v70
    v_and_b32 v71, 127, v71
    v_cvt_f32_u32 v64, v64
    v_cvt_f32_u32 v65, v65
    v_cvt_f32_u32 v66, v66
    v_cvt_f32_u32 v67, v67
    v_cvt_f32_u32 v68, v68
    v_cvt_f32_u32 v69, v69
    v_cvt_f32_u32 v70, v70
    v_cvt_f32_u32 v71, v71
    v_mul_f32 v64, 0x3c000000, v64
    v_mul_f32 v65, 0x3c000000, v65
    v_mul_f32 v66, 0x3c000000, v66
    v_mul_f32 v67, 0x3c000000, v67
    v_mul_f32 v68, 0x3c000000, v68
    v_mul_f32 v69, 0x3c000000, v69
    v_mul_f32 v70, 0x3c000000, v70
    v_mul_f32 v71, 0x3c000000, v71
    v_cos_f32 v64, v64
    v_cos_f32 v65, v65
    v_cos_f32 v66, v66
    v_cos_f32 v67, v67
    v_cos_f32 v68, v68
    v_cos_f32 v69, v69
    v_cos_f32 v70, v70
    v_cos_f32 v71, v71
    s_nop 0
    v_cvt_pk_bf16_f32 v72, v64, v65
    v_cvt_pk_bf16_f32 v73, v66, v67
    v_cvt_pk_bf16_f32 v74, v68, v69
    v_cvt_pk_bf16_f32 v75, v70, v71
    v_lshlrev_b32 v80, 16, v72
    v_and_b32 v81, 0xffff0000, v72
    v_sub_f32 v64, v64, v80
    v_sub_f32 v65, v65, v81
    v_lshlrev_b32 v80, 16, v73
    v_and_b32 v81, 0xffff0000, v73
    v_sub_f32 v66, v66, v80
    v_sub_f32 v67, v67, v81
    v_lshlrev_b32 v80, 16, v74
    v_and_b32 v81, 0xffff0000, v74
    v_sub_f32 v68, v68, v80
    v_sub_f32 v69, v69, v81
    v_lshlrev_b32 v80, 16, v75
    v_and_b32 v81, 0xffff0000, v75
    v_sub_f32 v70, v70, v80
    v_sub_f32 v71, v71, v81
    v_cvt_pk_bf16_f32 v76, v64, v65
    v_cvt_pk_bf16_f32 v77, v66, v67
    v_cvt_pk_bf16_f32 v78, v68, v69
    v_cvt_pk_bf16_f32 v79, v70, v71
    s_lshl_b32 s24, s3, 12
    v_add_u32 v114, s24, v121
    ds_write_b128 v114, v[72:75] offset:2048
    ds_write_b128 v114, v[76:79] offset:3072
    v_lshrrev_b32 v112, 1, v123
    s_mov_b32 s24, 1368064
    v_mul_lo_u32 v112, v112, s24
    v_lshrrev_b32 v113, 2, v122
    s_mov_b32 s24, 21376
    v_mul_lo_u32 v113, v113, s24
    v_add_u32 v112, v112, v113
    v_and_b32 v113, 3, v122
    v_and_b32 v114, 1, v123
    v_lshl_add_u32 v113, v114, 2, v113
    s_add_u32 s24, s11, 7
    s_cmp_ge_u32 s11, 160
    s_cselect_b32 s24, s24, s11
    s_cmp_eq_u32 s13, 1
    s_cselect_b32 s24, s24, s11
    s_lshr_b32 s24, s24, 1
    s_and_b32 s24, s24, 7
    v_xor_b32 v113, s24, v113
    v_lshl_add_u32 v120, v113, 4, v112
    s_mul_i32 s25, s13, 684032
    s_mul_i32 s24, s12, 85504
    s_add_u32 s25, s25, s24
    s_lshl_b32 s24, s11, 7
    s_add_u32 s25, s25, s24
    s_waitcnt lgkmcnt(0)
    s_barrier
    s_cmp_ge_u32 s11, 167
    s_cbranch_scc1 K1_END
    s_waitcnt vmcnt(8)
    v_perm_b32 v64, v4, v0, s28
    v_perm_b32 v68, v4, v0, s29
    v_perm_b32 v65, v12, v8, s28
    v_perm_b32 v69, v12, v8, s29
    v_perm_b32 v66, v20, v16, s28
    v_perm_b32 v70, v20, v16, s29
    v_perm_b32 v67, v28, v24, s28
    v_perm_b32 v71, v28, v24, s29
    v_perm_b32 v72, v5, v1, s28
    v_perm_b32 v76, v5, v1, s29
    v_perm_b32 v73, v13, v9, s28
    v_perm_b32 v77, v13, v9, s29
    v_perm_b32 v74, v21, v17, s28
    v_perm_b32 v78, v21, v17, s29
    v_perm_b32 v75, v29, v25, s28
    v_perm_b32 v79, v29, v25, s29
    v_perm_b32 v80, v6, v2, s28
    v_perm_b32 v84, v6, v2, s29
    v_perm_b32 v81, v14, v10, s28
    v_perm_b32 v85, v14, v10, s29
    v_perm_b32 v82, v22, v18, s28
    v_perm_b32 v86, v22, v18, s29
    v_perm_b32 v83, v30, v26, s28
    v_perm_b32 v87, v30, v26, s29
    v_perm_b32 v88, v7, v3, s28
    v_perm_b32 v92, v7, v3, s29
    v_perm_b32 v89, v15, v11, s28
    v_perm_b32 v93, v15, v11, s29
    v_perm_b32 v90, v23, v19, s28
    v_perm_b32 v94, v23, v19, s29
    v_perm_b32 v91, v31, v27, s28
    v_perm_b32 v95, v31, v27, s29
    s_waitcnt vmcnt(0)
    v_perm_b32 v0, v36, v32, s28
    v_perm_b32 v4, v36, v32, s29
    v_perm_b32 v1, v44, v40, s28
    v_perm_b32 v5, v44, v40, s29
    v_perm_b32 v2, v52, v48, s28
    v_perm_b32 v6, v52, v48, s29
    v_perm_b32 v3, v60, v56, s28
    v_perm_b32 v7, v60, v56, s29
    v_perm_b32 v8, v37, v33, s28
    v_perm_b32 v12, v37, v33, s29
    v_perm_b32 v9, v45, v41, s28
    v_perm_b32 v13, v45, v41, s29
    v_perm_b32 v10, v53, v49, s28
    v_perm_b32 v14, v53, v49, s29
    v_perm_b32 v11, v61, v57, s28
    v_perm_b32 v15, v61, v57, s29
    v_perm_b32 v16, v38, v34, s28
    v_perm_b32 v20, v38, v34, s29
    v_perm_b32 v17, v46, v42, s28
    v_perm_b32 v21, v46, v42, s29
    v_perm_b32 v18, v54, v50, s28
    v_perm_b32 v22, v54, v50, s29
    v_perm_b32 v19, v62, v58, s28
    v_perm_b32 v23, v62, v58, s29
    v_perm_b32 v24, v39, v35, s28
    v_perm_b32 v28, v39, v35, s29
    v_perm_b32 v25, v47, v43, s28
    v_perm_b32 v29, v47, v43, s29
    v_perm_b32 v26, v55, v51, s28
    v_perm_b32 v30, v55, v51, s29
    v_perm_b32 v27, v63, v59, s28
    v_perm_b32 v31, v63, v59, s29
    ds_read_b128 v[96:99], v121 offset:0
    ds_read_b128 v[100:103], v121 offset:1024
    ds_read_b128 v[104:107], v121 offset:2048
    ds_read_b128 v[108:111], v121 offset:3072
    s_waitcnt lgkmcnt(3)
    v_mfma_f32_16x16x32_bf16 v[32:35], v[96:99], v[64:67], 0
    v_mfma_f32_16x16x32_bf16 v[36:39], v[96:99], v[68:71], 0
    v_mfma_f32_16x16x32_bf16 v[40:43], v[96:99], v[72:75], 0
    v_mfma_f32_16x16x32_bf16 v[44:47], v[96:99], v[76:79], 0
    v_mfma_f32_16x16x32_bf16 v[48:51], v[96:99], v[80:83], 0
    v_mfma_f32_16x16x32_bf16 v[52:55], v[96:99], v[84:87], 0
    v_mfma_f32_16x16x32_bf16 v[56:59], v[96:99], v[88:91], 0
    v_mfma_f32_16x16x32_bf16 v[60:63], v[96:99], v[92:95], 0
    s_waitcnt lgkmcnt(2)
    v_mfma_f32_16x16x32_bf16 v[32:35], v[100:103], v[64:67], v[32:35]
    v_mfma_f32_16x16x32_bf16 v[36:39], v[100:103], v[68:71], v[36:39]
    v_mfma_f32_16x16x32_bf16 v[40:43], v[100:103], v[72:75], v[40:43]
    v_mfma_f32_16x16x32_bf16 v[44:47], v[100:103], v[76:79], v[44:47]
    v_mfma_f32_16x16x32_bf16 v[48:51], v[100:103], v[80:83], v[48:51]
    v_mfma_f32_16x16x32_bf16 v[52:55], v[100:103], v[84:87], v[52:55]
    v_mfma_f32_16x16x32_bf16 v[56:59], v[100:103], v[88:91], v[56:59]
    v_mfma_f32_16x16x32_bf16 v[60:63], v[100:103], v[92:95], v[60:63]
    s_waitcnt lgkmcnt(1)
    v_mfma_f32_16x16x32_bf16 v[32:35], v[104:107], v[0:3], v[32:35]
    v_mfma_f32_16x16x32_bf16 v[36:39], v[104:107], v[4:7], v[36:39]
    v_mfma_f32_16x16x32_bf16 v[40:43], v[104:107], v[8:11], v[40:43]
    v_mfma_f32_16x16x32_bf16 v[44:47], v[104:107], v[12:15], v[44:47]
    v_mfma_f32_16x16x32_bf16 v[48:51], v[104:107], v[16:19], v[48:51]
    v_mfma_f32_16x16x32_bf16 v[52:55], v[104:107], v[20:23], v[52:55]
    v_mfma_f32_16x16x32_bf16 v[56:59], v[104:107], v[24:27], v[56:59]
    v_mfma_f32_16x16x32_bf16 v[60:63], v[104:107], v[28:31], v[60:63]
    s_waitcnt lgkmcnt(0)
    v_mfma_f32_16x16x32_bf16 v[32:35], v[108:111], v[0:3], v[32:35]
    v_mfma_f32_16x16x32_bf16 v[36:39], v[108:111], v[4:7], v[36:39]
    v_mfma_f32_16x16x32_bf16 v[40:43], v[108:111], v[8:11], v[40:43]
    v_mfma_f32_16x16x32_bf16 v[44:47], v[108:111], v[12:15], v[44:47]
    v_mfma_f32_16x16x32_bf16 v[48:51], v[108:111], v[16:19], v[48:51]
    v_mfma_f32_16x16x32_bf16 v[52:55], v[108:111], v[20:23], v[52:55]
    v_mfma_f32_16x16x32_bf16 v[56:59], v[108:111], v[24:27], v[56:59]
    v_mfma_f32_16x16x32_bf16 v[60:63], v[108:111], v[28:31], v[60:63]
    s_nop 7
    v_cvt_pk_bf16_f32 v112, v32, v36
    v_cvt_pk_bf16_f32 v113, v40, v44
    v_cvt_pk_bf16_f32 v114, v48, v52
    v_cvt_pk_bf16_f32 v115, v56, v60
    buffer_store_dwordx4 v[112:115], v120, s[20:23], s25 offen
    s_add_u32 s25, s25, 2736128
    v_cvt_pk_bf16_f32 v116, v33, v37
    v_cvt_pk_bf16_f32 v117, v41, v45
    v_cvt_pk_bf16_f32 v118, v49, v53
    v_cvt_pk_bf16_f32 v119, v57, v61
    buffer_store_dwordx4 v[116:119], v120, s[20:23], s25 offen
    s_add_u32 s25, s25, 2736128
    v_cvt_pk_bf16_f32 v112, v34, v38
    v_cvt_pk_bf16_f32 v113, v42, v46
    v_cvt_pk_bf16_f32 v114, v50, v54
    v_cvt_pk_bf16_f32 v115, v58, v62
    buffer_store_dwordx4 v[112:115], v120, s[20:23], s25 offen
    s_add_u32 s25, s25, 2736128
    v_cvt_pk_bf16_f32 v116, v35, v39
    v_cvt_pk_bf16_f32 v117, v43, v47
    v_cvt_pk_bf16_f32 v118, v51, v55
    v_cvt_pk_bf16_f32 v119, v59, v63
    buffer_store_dwordx4 v[116:119], v120, s[20:23], s25 offen
    s_add_u32 s25, s25, 2736128
    ds_read_b128 v[96:99], v121 offset:4096
    ds_read_b128 v[100:103], v121 offset:5120
    ds_read_b128 v[104:107], v121 offset:6144
    ds_read_b128 v[108:111], v121 offset:7168
    s_waitcnt lgkmcnt(3)
    v_mfma_f32_16x16x32_bf16 v[32:35], v[96:99], v[64:67], 0
    v_mfma_f32_16x16x32_bf16 v[36:39], v[96:99], v[68:71], 0
    v_mfma_f32_16x16x32_bf16 v[40:43], v[96:99], v[72:75], 0
    v_mfma_f32_16x16x32_bf16 v[44:47], v[96:99], v[76:79], 0
    v_mfma_f32_16x16x32_bf16 v[48:51], v[96:99], v[80:83], 0
    v_mfma_f32_16x16x32_bf16 v[52:55], v[96:99], v[84:87], 0
    v_mfma_f32_16x16x32_bf16 v[56:59], v[96:99], v[88:91], 0
    v_mfma_f32_16x16x32_bf16 v[60:63], v[96:99], v[92:95], 0
    s_waitcnt lgkmcnt(2)
    v_mfma_f32_16x16x32_bf16 v[32:35], v[100:103], v[64:67], v[32:35]
    v_mfma_f32_16x16x32_bf16 v[36:39], v[100:103], v[68:71], v[36:39]
    v_mfma_f32_16x16x32_bf16 v[40:43], v[100:103], v[72:75], v[40:43]
    v_mfma_f32_16x16x32_bf16 v[44:47], v[100:103], v[76:79], v[44:47]
    v_mfma_f32_16x16x32_bf16 v[48:51], v[100:103], v[80:83], v[48:51]
    v_mfma_f32_16x16x32_bf16 v[52:55], v[100:103], v[84:87], v[52:55]
    v_mfma_f32_16x16x32_bf16 v[56:59], v[100:103], v[88:91], v[56:59]
    v_mfma_f32_16x16x32_bf16 v[60:63], v[100:103], v[92:95], v[60:63]
    s_waitcnt lgkmcnt(1)
    v_mfma_f32_16x16x32_bf16 v[32:35], v[104:107], v[0:3], v[32:35]
    v_mfma_f32_16x16x32_bf16 v[36:39], v[104:107], v[4:7], v[36:39]
    v_mfma_f32_16x16x32_bf16 v[40:43], v[104:107], v[8:11], v[40:43]
    v_mfma_f32_16x16x32_bf16 v[44:47], v[104:107], v[12:15], v[44:47]
    v_mfma_f32_16x16x32_bf16 v[48:51], v[104:107], v[16:19], v[48:51]
    v_mfma_f32_16x16x32_bf16 v[52:55], v[104:107], v[20:23], v[52:55]
    v_mfma_f32_16x16x32_bf16 v[56:59], v[104:107], v[24:27], v[56:59]
    v_mfma_f32_16x16x32_bf16 v[60:63], v[104:107], v[28:31], v[60:63]
    s_waitcnt lgkmcnt(0)
    v_mfma_f32_16x16x32_bf16 v[32:35], v[108:111], v[0:3], v[32:35]
    v_mfma_f32_16x16x32_bf16 v[36:39], v[108:111], v[4:7], v[36:39]
    v_mfma_f32_16x16x32_bf16 v[40:43], v[108:111], v[8:11], v[40:43]
    v_mfma_f32_16x16x32_bf16 v[44:47], v[108:111], v[12:15], v[44:47]
    v_mfma_f32_16x16x32_bf16 v[48:51], v[108:111], v[16:19], v[48:51]
    v_mfma_f32_16x16x32_bf16 v[52:55], v[108:111], v[20:23], v[52:55]
    v_mfma_f32_16x16x32_bf16 v[56:59], v[108:111], v[24:27], v[56:59]
    v_mfma_f32_16x16x32_bf16 v[60:63], v[108:111], v[28:31], v[60:63]
    s_nop 7
    v_cvt_pk_bf16_f32 v112, v32, v36
    v_cvt_pk_bf16_f32 v113, v40, v44
    v_cvt_pk_bf16_f32 v114, v48, v52
    v_cvt_pk_bf16_f32 v115, v56, v60
    buffer_store_dwordx4 v[112:115], v120, s[20:23], s25 offen
    s_add_u32 s25, s25, 2736128
    v_cvt_pk_bf16_f32 v116, v33, v37
    v_cvt_pk_bf16_f32 v117, v41, v45
    v_cvt_pk_bf16_f32 v118, v49, v53
    v_cvt_pk_bf16_f32 v119, v57, v61
    buffer_store_dwordx4 v[116:119], v120, s[20:23], s25 offen
    s_add_u32 s25, s25, 2736128
    v_cvt_pk_bf16_f32 v112, v34, v38
    v_cvt_pk_bf16_f32 v113, v42, v46
    v_cvt_pk_bf16_f32 v114, v50, v54
    v_cvt_pk_bf16_f32 v115, v58, v62
    buffer_store_dwordx4 v[112:115], v120, s[20:23], s25 offen
    s_add_u32 s25, s25, 2736128
    v_cvt_pk_bf16_f32 v116, v35, v39
    v_cvt_pk_bf16_f32 v117, v43, v47
    v_cvt_pk_bf16_f32 v118, v51, v55
    v_cvt_pk_bf16_f32 v119, v59, v63
    buffer_store_dwordx4 v[116:119], v120, s[20:23], s25 offen
    s_add_u32 s25, s25, 2736128
    ds_read_b128 v[96:99], v121 offset:8192
    ds_read_b128 v[100:103], v121 offset:9216
    ds_read_b128 v[104:107], v121 offset:10240
    ds_read_b128 v[108:111], v121 offset:11264
    s_waitcnt lgkmcnt(3)
    v_mfma_f32_16x16x32_bf16 v[32:35], v[96:99], v[64:67], 0
    v_mfma_f32_16x16x32_bf16 v[36:39], v[96:99], v[68:71], 0
    v_mfma_f32_16x16x32_bf16 v[40:43], v[96:99], v[72:75], 0
    v_mfma_f32_16x16x32_bf16 v[44:47], v[96:99], v[76:79], 0
    v_mfma_f32_16x16x32_bf16 v[48:51], v[96:99], v[80:83], 0
    v_mfma_f32_16x16x32_bf16 v[52:55], v[96:99], v[84:87], 0
    v_mfma_f32_16x16x32_bf16 v[56:59], v[96:99], v[88:91], 0
    v_mfma_f32_16x16x32_bf16 v[60:63], v[96:99], v[92:95], 0
    s_waitcnt lgkmcnt(2)
    v_mfma_f32_16x16x32_bf16 v[32:35], v[100:103], v[64:67], v[32:35]
    v_mfma_f32_16x16x32_bf16 v[36:39], v[100:103], v[68:71], v[36:39]
    v_mfma_f32_16x16x32_bf16 v[40:43], v[100:103], v[72:75], v[40:43]
    v_mfma_f32_16x16x32_bf16 v[44:47], v[100:103], v[76:79], v[44:47]
    v_mfma_f32_16x16x32_bf16 v[48:51], v[100:103], v[80:83], v[48:51]
    v_mfma_f32_16x16x32_bf16 v[52:55], v[100:103], v[84:87], v[52:55]
    v_mfma_f32_16x16x32_bf16 v[56:59], v[100:103], v[88:91], v[56:59]
    v_mfma_f32_16x16x32_bf16 v[60:63], v[100:103], v[92:95], v[60:63]
    s_waitcnt lgkmcnt(1)
    v_mfma_f32_16x16x32_bf16 v[32:35], v[104:107], v[0:3], v[32:35]
    v_mfma_f32_16x16x32_bf16 v[36:39], v[104:107], v[4:7], v[36:39]
    v_mfma_f32_16x16x32_bf16 v[40:43], v[104:107], v[8:11], v[40:43]
    v_mfma_f32_16x16x32_bf16 v[44:47], v[104:107], v[12:15], v[44:47]
    v_mfma_f32_16x16x32_bf16 v[48:51], v[104:107], v[16:19], v[48:51]
    v_mfma_f32_16x16x32_bf16 v[52:55], v[104:107], v[20:23], v[52:55]
    v_mfma_f32_16x16x32_bf16 v[56:59], v[104:107], v[24:27], v[56:59]
    v_mfma_f32_16x16x32_bf16 v[60:63], v[104:107], v[28:31], v[60:63]
    s_waitcnt lgkmcnt(0)
    v_mfma_f32_16x16x32_bf16 v[32:35], v[108:111], v[0:3], v[32:35]
    v_mfma_f32_16x16x32_bf16 v[36:39], v[108:111], v[4:7], v[36:39]
    v_mfma_f32_16x16x32_bf16 v[40:43], v[108:111], v[8:11], v[40:43]
    v_mfma_f32_16x16x32_bf16 v[44:47], v[108:111], v[12:15], v[44:47]
    v_mfma_f32_16x16x32_bf16 v[48:51], v[108:111], v[16:19], v[48:51]
    v_mfma_f32_16x16x32_bf16 v[52:55], v[108:111], v[20:23], v[52:55]
    v_mfma_f32_16x16x32_bf16 v[56:59], v[108:111], v[24:27], v[56:59]
    v_mfma_f32_16x16x32_bf16 v[60:63], v[108:111], v[28:31], v[60:63]
    s_nop 7
    v_cvt_pk_bf16_f32 v112, v32, v36
    v_cvt_pk_bf16_f32 v113, v40, v44
    v_cvt_pk_bf16_f32 v114, v48, v52
    v_cvt_pk_bf16_f32 v115, v56, v60
    buffer_store_dwordx4 v[112:115], v120, s[20:23], s25 offen
    s_add_u32 s25, s25, 2736128
    v_cvt_pk_bf16_f32 v116, v33, v37
    v_cvt_pk_bf16_f32 v117, v41, v45
    v_cvt_pk_bf16_f32 v118, v49, v53
    v_cvt_pk_bf16_f32 v119, v57, v61
    buffer_store_dwordx4 v[116:119], v120, s[20:23], s25 offen
    s_add_u32 s25, s25, 2736128
    v_cvt_pk_bf16_f32 v112, v34, v38
    v_cvt_pk_bf16_f32 v113, v42, v46
    v_cvt_pk_bf16_f32 v114, v50, v54
    v_cvt_pk_bf16_f32 v115, v58, v62
    buffer_store_dwordx4 v[112:115], v120, s[20:23], s25 offen
    s_add_u32 s25, s25, 2736128
    v_cvt_pk_bf16_f32 v116, v35, v39
    v_cvt_pk_bf16_f32 v117, v43, v47
    v_cvt_pk_bf16_f32 v118, v51, v55
    v_cvt_pk_bf16_f32 v119, v59, v63
    buffer_store_dwordx4 v[116:119], v120, s[20:23], s25 offen
    s_add_u32 s25, s25, 2736128
    ds_read_b128 v[96:99], v121 offset:12288
    ds_read_b128 v[100:103], v121 offset:13312
    ds_read_b128 v[104:107], v121 offset:14336
    ds_read_b128 v[108:111], v121 offset:15360
    s_waitcnt lgkmcnt(3)
    v_mfma_f32_16x16x32_bf16 v[32:35], v[96:99], v[64:67], 0
    v_mfma_f32_16x16x32_bf16 v[36:39], v[96:99], v[68:71], 0
    v_mfma_f32_16x16x32_bf16 v[40:43], v[96:99], v[72:75], 0
    v_mfma_f32_16x16x32_bf16 v[44:47], v[96:99], v[76:79], 0
    v_mfma_f32_16x16x32_bf16 v[48:51], v[96:99], v[80:83], 0
    v_mfma_f32_16x16x32_bf16 v[52:55], v[96:99], v[84:87], 0
    v_mfma_f32_16x16x32_bf16 v[56:59], v[96:99], v[88:91], 0
    v_mfma_f32_16x16x32_bf16 v[60:63], v[96:99], v[92:95], 0
    s_waitcnt lgkmcnt(2)
    v_mfma_f32_16x16x32_bf16 v[32:35], v[100:103], v[64:67], v[32:35]
    v_mfma_f32_16x16x32_bf16 v[36:39], v[100:103], v[68:71], v[36:39]
    v_mfma_f32_16x16x32_bf16 v[40:43], v[100:103], v[72:75], v[40:43]
    v_mfma_f32_16x16x32_bf16 v[44:47], v[100:103], v[76:79], v[44:47]
    v_mfma_f32_16x16x32_bf16 v[48:51], v[100:103], v[80:83], v[48:51]
    v_mfma_f32_16x16x32_bf16 v[52:55], v[100:103], v[84:87], v[52:55]
    v_mfma_f32_16x16x32_bf16 v[56:59], v[100:103], v[88:91], v[56:59]
    v_mfma_f32_16x16x32_bf16 v[60:63], v[100:103], v[92:95], v[60:63]
    s_waitcnt lgkmcnt(1)
    v_mfma_f32_16x16x32_bf16 v[32:35], v[104:107], v[0:3], v[32:35]
    v_mfma_f32_16x16x32_bf16 v[36:39], v[104:107], v[4:7], v[36:39]
    v_mfma_f32_16x16x32_bf16 v[40:43], v[104:107], v[8:11], v[40:43]
    v_mfma_f32_16x16x32_bf16 v[44:47], v[104:107], v[12:15], v[44:47]
    v_mfma_f32_16x16x32_bf16 v[48:51], v[104:107], v[16:19], v[48:51]
    v_mfma_f32_16x16x32_bf16 v[52:55], v[104:107], v[20:23], v[52:55]
    v_mfma_f32_16x16x32_bf16 v[56:59], v[104:107], v[24:27], v[56:59]
    v_mfma_f32_16x16x32_bf16 v[60:63], v[104:107], v[28:31], v[60:63]
    s_waitcnt lgkmcnt(0)
    v_mfma_f32_16x16x32_bf16 v[32:35], v[108:111], v[0:3], v[32:35]
    v_mfma_f32_16x16x32_bf16 v[36:39], v[108:111], v[4:7], v[36:39]
    v_mfma_f32_16x16x32_bf16 v[40:43], v[108:111], v[8:11], v[40:43]
    v_mfma_f32_16x16x32_bf16 v[44:47], v[108:111], v[12:15], v[44:47]
    v_mfma_f32_16x16x32_bf16 v[48:51], v[108:111], v[16:19], v[48:51]
    v_mfma_f32_16x16x32_bf16 v[52:55], v[108:111], v[20:23], v[52:55]
    v_mfma_f32_16x16x32_bf16 v[56:59], v[108:111], v[24:27], v[56:59]
    v_mfma_f32_16x16x32_bf16 v[60:63], v[108:111], v[28:31], v[60:63]
    s_nop 7
    v_cvt_pk_bf16_f32 v112, v32, v36
    v_cvt_pk_bf16_f32 v113, v40, v44
    v_cvt_pk_bf16_f32 v114, v48, v52
    v_cvt_pk_bf16_f32 v115, v56, v60
    buffer_store_dwordx4 v[112:115], v120, s[20:23], s25 offen
    s_add_u32 s25, s25, 2736128
    v_cvt_pk_bf16_f32 v116, v33, v37
    v_cvt_pk_bf16_f32 v117, v41, v45
    v_cvt_pk_bf16_f32 v118, v49, v53
    v_cvt_pk_bf16_f32 v119, v57, v61
    buffer_store_dwordx4 v[116:119], v120, s[20:23], s25 offen
    s_add_u32 s25, s25, 2736128
    v_cvt_pk_bf16_f32 v112, v34, v38
    v_cvt_pk_bf16_f32 v113, v42, v46
    v_cvt_pk_bf16_f32 v114, v50, v54
    v_cvt_pk_bf16_f32 v115, v58, v62
    buffer_store_dwordx4 v[112:115], v120, s[20:23], s25 offen
    s_add_u32 s25, s25, 2736128
    v_cvt_pk_bf16_f32 v116, v35, v39
    v_cvt_pk_bf16_f32 v117, v43, v47
    v_cvt_pk_bf16_f32 v118, v51, v55
    v_cvt_pk_bf16_f32 v119, v59, v63
    buffer_store_dwordx4 v[116:119], v120, s[20:23], s25 offen
    s_endpgm
K1_W:
    s_mov_b32 s16, s6
    s_mov_b32 s17, s7
    s_and_b32 s17, s17, 0xffff
    s_mov_b32 s18, 16252928
    s_mov_b32 s19, 0x00020000
    s_add_u32 s20, s8, 50331648
    s_addc_u32 s21, s9, 0
    s_and_b32 s21, s21, 0xffff
    s_mov_b32 s22, 67108864
    s_mov_b32 s23, 0x00020000
    s_mul_i32 s11, s2, 1
    s_lshr_b32 s12, s11, 9
    s_and_b32 s13, s11, 511
    s_lshl_b32 s14, s12, 19
    s_lshl_b32 s15, s13, 10
    s_add_u32 s14, s14, s15
    s_lshl_b32 s15, s3, 8
    s_add_u32 s14, s14, s15
    v_and_b32 v126, 1, v123
    v_lshlrev_b32 v126, 23, v126
    v_lshl_add_u32 v126, v122, 4, v126
    s_mov_b32 s15, s14
    buffer_load_dwordx4 v[0:3], v126, s[16:19], s15 offen
    s_add_u32 s15, s15, 0x100000
    buffer_load_dwordx4 v[4:7], v126, s[16:19], s15 offen
    s_add_u32 s15, s15, 0x100000
    buffer_load_dwordx4 v[8:11], v126, s[16:19], s15 offen
    s_add_u32 s15, s15, 0x100000
    buffer_load_dwordx4 v[12:15], v126, s[16:19], s15 offen
    s_add_u32 s15, s15, 0x100000
    buffer_load_dwordx4 v[16:19], v126, s[16:19], s15 offen
    s_add_u32 s15, s15, 0x100000
    buffer_load_dwordx4 v[20:23], v126, s[16:19], s15 offen
    s_add_u32 s15, s15, 0x100000
    buffer_load_dwordx4 v[24:27], v126, s[16:19], s15 offen
    s_add_u32 s15, s15, 0x100000
    buffer_load_dwordx4 v[28:31], v126, s[16:19], s15 offen
    v_and_b32 v127, 1, v123
    v_lshlrev_b32 v127, 3, v127
    v_mul_u32_u24 v112, 96, v125
    v_mad_u32_u24 v113, v124, v127, v112
    v_mad_u32_u24 v64, v124, 0, v113
    v_mad_u32_u24 v65, v124, 1, v113
    v_mad_u32_u24 v66, v124, 2, v113
    v_mad_u32_u24 v67, v124, 3, v113
    v_mad_u32_u24 v68, v124, 4, v113
    v_mad_u32_u24 v69, v124, 5, v113
    v_mad_u32_u24 v70, v124, 6, v113
    v_mad_u32_u24 v71, v124, 7, v113
    v_and_b32 v64, 127, v64
    v_and_b32 v65, 127, v65
    v_and_b32 v66, 127, v66
    v_and_b32 v67, 127, v67
    v_and_b32 v68, 127, v68
    v_and_b32 v69, 127, v69
    v_and_b32 v70, 127, v70
    v_and_b32 v71, 127, v71
    v_cvt_f32_u32 v64, v64
    v_cvt_f32_u32 v65, v65
    v_cvt_f32_u32 v66, v66
    v_cvt_f32_u32 v67, v67
    v_cvt_f32_u32 v68, v68
    v_cvt_f32_u32 v69, v69
    v_cvt_f32_u32 v70, v70
    v_cvt_f32_u32 v71, v71
    v_mul_f32 v64, 0x3c000000, v64
    v_mul_f32 v65, 0x3c000000, v65
    v_mul_f32 v66, 0x3c000000, v66
    v_mul_f32 v67, 0x3c000000, v67
    v_mul_f32 v68, 0x3c000000, v68
    v_mul_f32 v69, 0x3c000000, v69
    v_mul_f32 v70, 0x3c000000, v70
    v_mul_f32 v71, 0x3c000000, v71
    v_cos_f32 v64, v64
    v_cos_f32 v65, v65
    v_cos_f32 v66, v66
    v_cos_f32 v67, v67
    v_cos_f32 v68, v68
    v_cos_f32 v69, v69
    v_cos_f32 v70, v70
    v_cos_f32 v71, v71
    s_nop 0
    v_cvt_pk_bf16_f32 v72, v64, v65
    v_cvt_pk_bf16_f32 v73, v66, v67
    v_cvt_pk_bf16_f32 v74, v68, v69
    v_cvt_pk_bf16_f32 v75, v70, v71
    v_lshlrev_b32 v80, 16, v72
    v_and_b32 v81, 0xffff0000, v72
    v_sub_f32 v64, v64, v80
    v_sub_f32 v65, v65, v81
    v_lshlrev_b32 v80, 16, v73
    v_and_b32 v81, 0xffff0000, v73
    v_sub_f32 v66, v66, v80
    v_sub_f32 v67, v67, v81
    v_lshlrev_b32 v80, 16, v74
    v_and_b32 v81, 0xffff0000, v74
    v_sub_f32 v68, v68, v80
    v_sub_f32 v69, v69, v81
    v_lshlrev_b32 v80, 16, v75
    v_and_b32 v81, 0xffff0000, v75
    v_sub_f32 v70, v70, v80
    v_sub_f32 v71, v71, v81
    v_cvt_pk_bf16_f32 v76, v64, v65
    v_cvt_pk_bf16_f32 v77, v66, v67
    v_cvt_pk_bf16_f32 v78, v68, v69
    v_cvt_pk_bf16_f32 v79, v70, v71
    v_cmp_lt_u32 vcc, 1, v123
    s_lshl_b32 s24, s3, 10
    v_add_u32 v114, s24, v121
    v_cndmask_b32 v72, v72, v76, vcc
    v_cndmask_b32 v73, v73, v77, vcc
    v_cndmask_b32 v74, v74, v78, vcc
    v_cndmask_b32 v75, v75, v79, vcc
    ds_write_b128 v114, v[72:75]
    v_lshrrev_b32 v112, 1, v123
    s_mov_b32 s24, 2097152
    v_mul_lo_u32 v112, v112, s24
    v_and_b32 v113, 1, v123
    v_lshl_add_u32 v112, v113, 8, v112
    v_and_b32 v113, 1, v122
    v_lshl_add_u32 v124, v113, 4, v112
    v_lshrrev_b32 v125, 1, v122
    s_mul_i32 s26, s3, 524288
    s_lshl_b32 s24, s11, 9
    s_add_u32 s26, s26, s24
    s_waitcnt lgkmcnt(0)
    s_barrier
    ds_read_b128 v[96:99], v121 offset:0
    ds_read_b128 v[100:103], v121 offset:1024
    ds_read_b128 v[104:107], v121 offset:2048
    ds_read_b128 v[108:111], v121 offset:3072
    s_mov_b32 s27, 0
    s_waitcnt vmcnt(0) lgkmcnt(0)
K1_W_LOOP:
    s_add_u32 s24, s11, s27
    s_and_b32 s30, s24, 3
    s_lshr_b32 s24, s24, 1
    s_and_b32 s24, s24, 4
    s_or_b32 s30, s30, s24
    v_xor_b32 v112, s30, v125
    v_lshl_add_u32 v120, v112, 5, v124
    s_lshl_b32 s25, s27, 9
    s_add_u32 s25, s25, s26
    v_perm_b32 v32, v4, v0, s28
    v_perm_b32 v36, v4, v0, s29
    v_perm_b32 v33, v12, v8, s28
    v_perm_b32 v37, v12, v8, s29
    v_perm_b32 v34, v20, v16, s28
    v_perm_b32 v38, v20, v16, s29
    v_perm_b32 v35, v28, v24, s28
    v_perm_b32 v39, v28, v24, s29
    v_perm_b32 v40, v5, v1, s28
    v_perm_b32 v44, v5, v1, s29
    v_perm_b32 v41, v13, v9, s28
    v_perm_b32 v45, v13, v9, s29
    v_perm_b32 v42, v21, v17, s28
    v_perm_b32 v46, v21, v17, s29
    v_perm_b32 v43, v29, v25, s28
    v_perm_b32 v47, v29, v25, s29
    v_perm_b32 v48, v6, v2, s28
    v_perm_b32 v52, v6, v2, s29
    v_perm_b32 v49, v14, v10, s28
    v_perm_b32 v53, v14, v10, s29
    v_perm_b32 v50, v22, v18, s28
    v_perm_b32 v54, v22, v18, s29
    v_perm_b32 v51, v30, v26, s28
    v_perm_b32 v55, v30, v26, s29
    v_perm_b32 v56, v7, v3, s28
    v_perm_b32 v60, v7, v3, s29
    v_perm_b32 v57, v15, v11, s28
    v_perm_b32 v61, v15, v11, s29
    v_perm_b32 v58, v23, v19, s28
    v_perm_b32 v62, v23, v19, s29
    v_perm_b32 v59, v31, v27, s28
    v_perm_b32 v63, v31, v27, s29
    s_add_u32 s27, s27, 1
    s_add_u32 s14, s14, 1024
    s_cmp_ge_u32 s27, 1
    s_cbranch_scc1 K1_W_NOLOAD
    s_mov_b32 s15, s14
    buffer_load_dwordx4 v[0:3], v126, s[16:19], s15 offen
    s_add_u32 s15, s15, 0x100000
    buffer_load_dwordx4 v[4:7], v126, s[16:19], s15 offen
    s_add_u32 s15, s15, 0x100000
    buffer_load_dwordx4 v[8:11], v126, s[16:19], s15 offen
    s_add_u32 s15, s15, 0x100000
    buffer_load_dwordx4 v[12:15], v126, s[16:19], s15 offen
    s_add_u32 s15, s15, 0x100000
    buffer_load_dwordx4 v[16:19], v126, s[16:19], s15 offen
    s_add_u32 s15, s15, 0x100000
    buffer_load_dwordx4 v[20:23], v126, s[16:19], s15 offen
    s_add_u32 s15, s15, 0x100000
    buffer_load_dwordx4 v[24:27], v126, s[16:19], s15 offen
    s_add_u32 s15, s15, 0x100000
    buffer_load_dwordx4 v[28:31], v126, s[16:19], s15 offen
K1_W_NOLOAD:
    v_mfma_f32_16x16x32_bf16 v[64:67], v[96:99], v[32:35], 0
    v_mfma_f32_16x16x32_bf16 v[68:71], v[96:99], v[36:39], 0
    v_mfma_f32_16x16x32_bf16 v[72:75], v[96:99], v[40:43], 0
    v_mfma_f32_16x16x32_bf16 v[76:79], v[96:99], v[44:47], 0
    v_mfma_f32_16x16x32_bf16 v[80:83], v[96:99], v[48:51], 0
    v_mfma_f32_16x16x32_bf16 v[84:87], v[96:99], v[52:55], 0
    v_mfma_f32_16x16x32_bf16 v[88:91], v[96:99], v[56:59], 0
    v_mfma_f32_16x16x32_bf16 v[92:95], v[96:99], v[60:63], 0
    s_nop 7
    v_cvt_pk_bf16_f32 v112, v64, v68
    v_cvt_pk_bf16_f32 v113, v72, v76
    v_cvt_pk_bf16_f32 v114, v80, v84
    v_cvt_pk_bf16_f32 v115, v88, v92
    buffer_store_dwordx4 v[112:115], v120, s[20:23], s25 offen
    s_add_u32 s25, s25, 4194304
    v_cvt_pk_bf16_f32 v116, v65, v69
    v_cvt_pk_bf16_f32 v117, v73, v77
    v_cvt_pk_bf16_f32 v118, v81, v85
    v_cvt_pk_bf16_f32 v119, v89, v93
    buffer_store_dwordx4 v[116:119], v120, s[20:23], s25 offen
    s_add_u32 s25, s25, 4194304
    v_cvt_pk_bf16_f32 v112, v66, v70
    v_cvt_pk_bf16_f32 v113, v74, v78
    v_cvt_pk_bf16_f32 v114, v82, v86
    v_cvt_pk_bf16_f32 v115, v90, v94
    buffer_store_dwordx4 v[112:115], v120, s[20:23], s25 offen
    s_add_u32 s25, s25, 4194304
    v_cvt_pk_bf16_f32 v116, v67, v71
    v_cvt_pk_bf16_f32 v117, v75, v79
    v_cvt_pk_bf16_f32 v118, v83, v87
    v_cvt_pk_bf16_f32 v119, v91, v95
    buffer_store_dwordx4 v[116:119], v120, s[20:23], s25 offen
    s_add_u32 s25, s25, 4194304
    v_mfma_f32_16x16x32_bf16 v[64:67], v[100:103], v[32:35], 0
    v_mfma_f32_16x16x32_bf16 v[68:71], v[100:103], v[36:39], 0
    v_mfma_f32_16x16x32_bf16 v[72:75], v[100:103], v[40:43], 0
    v_mfma_f32_16x16x32_bf16 v[76:79], v[100:103], v[44:47], 0
    v_mfma_f32_16x16x32_bf16 v[80:83], v[100:103], v[48:51], 0
    v_mfma_f32_16x16x32_bf16 v[84:87], v[100:103], v[52:55], 0
    v_mfma_f32_16x16x32_bf16 v[88:91], v[100:103], v[56:59], 0
    v_mfma_f32_16x16x32_bf16 v[92:95], v[100:103], v[60:63], 0
    s_nop 7
    v_cvt_pk_bf16_f32 v112, v64, v68
    v_cvt_pk_bf16_f32 v113, v72, v76
    v_cvt_pk_bf16_f32 v114, v80, v84
    v_cvt_pk_bf16_f32 v115, v88, v92
    buffer_store_dwordx4 v[112:115], v120, s[20:23], s25 offen
    s_add_u32 s25, s25, 4194304
    v_cvt_pk_bf16_f32 v116, v65, v69
    v_cvt_pk_bf16_f32 v117, v73, v77
    v_cvt_pk_bf16_f32 v118, v81, v85
    v_cvt_pk_bf16_f32 v119, v89, v93
    buffer_store_dwordx4 v[116:119], v120, s[20:23], s25 offen
    s_add_u32 s25, s25, 4194304
    v_cvt_pk_bf16_f32 v112, v66, v70
    v_cvt_pk_bf16_f32 v113, v74, v78
    v_cvt_pk_bf16_f32 v114, v82, v86
    v_cvt_pk_bf16_f32 v115, v90, v94
    buffer_store_dwordx4 v[112:115], v120, s[20:23], s25 offen
    s_add_u32 s25, s25, 4194304
    v_cvt_pk_bf16_f32 v116, v67, v71
    v_cvt_pk_bf16_f32 v117, v75, v79
    v_cvt_pk_bf16_f32 v118, v83, v87
    v_cvt_pk_bf16_f32 v119, v91, v95
    buffer_store_dwordx4 v[116:119], v120, s[20:23], s25 offen
    s_add_u32 s25, s25, 4194304
    v_mfma_f32_16x16x32_bf16 v[64:67], v[104:107], v[32:35], 0
    v_mfma_f32_16x16x32_bf16 v[68:71], v[104:107], v[36:39], 0
    v_mfma_f32_16x16x32_bf16 v[72:75], v[104:107], v[40:43], 0
    v_mfma_f32_16x16x32_bf16 v[76:79], v[104:107], v[44:47], 0
    v_mfma_f32_16x16x32_bf16 v[80:83], v[104:107], v[48:51], 0
    v_mfma_f32_16x16x32_bf16 v[84:87], v[104:107], v[52:55], 0
    v_mfma_f32_16x16x32_bf16 v[88:91], v[104:107], v[56:59], 0
    v_mfma_f32_16x16x32_bf16 v[92:95], v[104:107], v[60:63], 0
    s_nop 7
    v_cvt_pk_bf16_f32 v112, v64, v68
    v_cvt_pk_bf16_f32 v113, v72, v76
    v_cvt_pk_bf16_f32 v114, v80, v84
    v_cvt_pk_bf16_f32 v115, v88, v92
    buffer_store_dwordx4 v[112:115], v120, s[20:23], s25 offen
    s_add_u32 s25, s25, 4194304
    v_cvt_pk_bf16_f32 v116, v65, v69
    v_cvt_pk_bf16_f32 v117, v73, v77
    v_cvt_pk_bf16_f32 v118, v81, v85
    v_cvt_pk_bf16_f32 v119, v89, v93
    buffer_store_dwordx4 v[116:119], v120, s[20:23], s25 offen
    s_add_u32 s25, s25, 4194304
    v_cvt_pk_bf16_f32 v112, v66, v70
    v_cvt_pk_bf16_f32 v113, v74, v78
    v_cvt_pk_bf16_f32 v114, v82, v86
    v_cvt_pk_bf16_f32 v115, v90, v94
    buffer_store_dwordx4 v[112:115], v120, s[20:23], s25 offen
    s_add_u32 s25, s25, 4194304
    v_cvt_pk_bf16_f32 v116, v67, v71
    v_cvt_pk_bf16_f32 v117, v75, v79
    v_cvt_pk_bf16_f32 v118, v83, v87
    v_cvt_pk_bf16_f32 v119, v91, v95
    buffer_store_dwordx4 v[116:119], v120, s[20:23], s25 offen
    s_add_u32 s25, s25, 4194304
    v_mfma_f32_16x16x32_bf16 v[64:67], v[108:111], v[32:35], 0
    v_mfma_f32_16x16x32_bf16 v[68:71], v[108:111], v[36:39], 0
    v_mfma_f32_16x16x32_bf16 v[72:75], v[108:111], v[40:43], 0
    v_mfma_f32_16x16x32_bf16 v[76:79], v[108:111], v[44:47], 0
    v_mfma_f32_16x16x32_bf16 v[80:83], v[108:111], v[48:51], 0
    v_mfma_f32_16x16x32_bf16 v[84:87], v[108:111], v[52:55], 0
    v_mfma_f32_16x16x32_bf16 v[88:91], v[108:111], v[56:59], 0
    v_mfma_f32_16x16x32_bf16 v[92:95], v[108:111], v[60:63], 0
    s_nop 7
    v_cvt_pk_bf16_f32 v112, v64, v68
    v_cvt_pk_bf16_f32 v113, v72, v76
    v_cvt_pk_bf16_f32 v114, v80, v84
    v_cvt_pk_bf16_f32 v115, v88, v92
    buffer_store_dwordx4 v[112:115], v120, s[20:23], s25 offen
    s_add_u32 s25, s25, 4194304
    v_cvt_pk_bf16_f32 v116, v65, v69
    v_cvt_pk_bf16_f32 v117, v73, v77
    v_cvt_pk_bf16_f32 v118, v81, v85
    v_cvt_pk_bf16_f32 v119, v89, v93
    buffer_store_dwordx4 v[116:119], v120, s[20:23], s25 offen
    s_add_u32 s25, s25, 4194304
    v_cvt_pk_bf16_f32 v112, v66, v70
    v_cvt_pk_bf16_f32 v113, v74, v78
    v_cvt_pk_bf16_f32 v114, v82, v86
    v_cvt_pk_bf16_f32 v115, v90, v94
    buffer_store_dwordx4 v[112:115], v120, s[20:23], s25 offen
    s_add_u32 s25, s25, 4194304
    v_cvt_pk_bf16_f32 v116, v67, v71
    v_cvt_pk_bf16_f32 v117, v75, v79
    v_cvt_pk_bf16_f32 v118, v83, v87
    v_cvt_pk_bf16_f32 v119, v91, v95
    buffer_store_dwordx4 v[116:119], v120, s[20:23], s25 offen
    s_waitcnt vmcnt(16)
    s_cmp_lt_u32 s27, 1
    s_cbranch_scc1 K1_W_LOOP
K1_END:
    s_endpgm
.p2align 8
.type k12_fused_kernel,@function
k12_fused_kernel:
    s_cmp_ge_u32 s2, 256
    s_cbranch_scc1 K12_END
    s_load_dwordx4 s[52:55], s[0:1], 0
    s_load_dwordx4 s[56:59], s[0:1], 40
    s_getpc_b64 s[90:91]
CPF_K12:
    s_sub_u32 s90, s90, CPF_K12-k12_fused_kernel
    s_subb_u32 s91, s91, 0
    v_lshlrev_b32 v8, 7, v0
    v_mov_b32 v11, s91
    v_min_u32 v9, TEXT_END-k12_fused_kernel-4, v8
    v_add_co_u32 v10, vcc, s90, v9
    v_addc_co_u32 v11, vcc, 0, v11, vcc
    global_load_dword v63, v[10:11], off
    v_lshrrev_b32 v1, 6, v0
    v_and_b32 v2, 63, v0
    v_readfirstlane_b32 s3, v1
    s_waitcnt lgkmcnt(0)
    s_cmp_lt_u32 s3, 4
    s_cbranch_scc1 K12_CONS
    v_and_b32 v64, 15, v2
    v_lshrrev_b32 v65, 4, v2
    v_lshlrev_b32 v254, 4, v2
    s_and_b32 s44, s3, 3
    s_and_b32 s20, s44, 1
    s_lshr_b32 s21, s44, 1
    s_lshl_b32 s22, s2, 1
    s_add_u32 s22, s22, s21
    s_and_b32 s23, s22, 3
    s_lshr_b32 s22, s22, 2
    s_and_b32 s24, s2, 7
    s_lshl_b32 s24, s24, 5
    s_lshr_b32 s25, s2, 3
    s_add_u32 s24, s24, s25
    s_cmp_ge_u32 s24, 167
    s_cselect_b32 s25, 1, 0
    s_mul_i32 s26, s25, 167
    s_sub_u32 s24, s24, s26
    s_cmp_eq_u32 s21, 0
    s_cselect_b32 s25, s25, 1
    s_mul_i32 s26, s25, 16384000
    s_add_u32 s4, s52, s26
    s_addc_u32 s5, s53, 0
    s_and_b32 s5, s5, 0xffff
    s_mov_b32 s6, 16384000
    s_mov_b32 s7, 0x00020000
    s_mov_b32 s8, s54
    s_mov_b32 s9, s55
    s_and_b32 s9, s9, 0xffff
    s_mov_b32 s10, 16252928
    s_mov_b32 s11, 0x00020000
    s_mov_b32 s12, s58
    s_mov_b32 s13, s59
    s_and_b32 s13, s13, 0xffff
    s_mov_b32 s14, 43778048
    s_mov_b32 s15, 0x00020000
    s_add_u32 s16, s58, 50331648
    s_addc_u32 s17, s59, 0
    s_and_b32 s17, s17, 0xffff
    s_mov_b32 s18, 67108864
    s_mov_b32 s19, 0x00020000
    s_add_u32 s60, s58, 153092096
    s_addc_u32 s61, s59, 0
    s_and_b32 s61, s61, 0xffff
    s_mov_b32 s62, 32768
    s_mov_b32 s63, 0x00020000
    s_mov_b32 s28, 0x05040100
    s_mov_b32 s29, 0x07060302
    v_lshlrev_b32 v248, 14, v65
    v_lshl_add_u32 v248, v64, 4, v248
    v_and_b32 v250, 1, v65
    v_lshlrev_b32 v250, 23, v250
    v_lshl_add_u32 v250, v64, 4, v250
    v_lshrrev_b32 v66, 1, v65
    s_mov_b32 s26, 1368064
    v_mul_lo_u32 v66, v66, s26
    v_lshrrev_b32 v67, 2, v64
    s_mov_b32 s26, 21376
    v_mul_lo_u32 v67, v67, s26
    v_add_u32 v66, v66, v67
    v_mov_b32 v252, v66
    v_lshrrev_b32 v66, 1, v65
    s_mov_b32 s26, 2097152
    v_mul_lo_u32 v66, v66, s26
    v_and_b32 v67, 1, v65
    v_lshl_add_u32 v66, v67, 8, v66
    v_and_b32 v67, 1, v64
    v_lshl_add_u32 v251, v67, 4, v66
    s_mul_i32 s31, s25, 684032
    s_mul_i32 s32, s23, 524288
    s_lshl_b32 s33, s23, 8
    s_mov_b32 s40, 3
    s_xor_b32 s43, s40, s20
    s_and_b32 s43, s43, 1
    s_mul_i32 s36, s40, 85
    s_add_u32 s36, s36, s2
    s_and_b32 s36, s36, 255
    s_mul_hi_u32 s37, s36, 0x55555556
    s_mul_i32 s38, s37, 3
    s_cmp_eq_u32 s38, s36
    s_cselect_b32 s27, 1, 0
    s_cmp_lt_u32 s37, 78
    s_cselect_b32 s27, s27, 0
    s_add_u32 s37, s37, 89
    s_cmp_eq_u32 s21, 0
    s_cselect_b32 s30, s24, s37
    s_cselect_b32 s27, 1, s27
    s_cmp_eq_u32 s43, 0
    s_cbranch_scc0 K12_PL1
    s_lshl_b32 s36, s40, 7
    s_add_u32 s36, s36, s22
    s_lshr_b32 s37, s36, 9
    s_lshl_b32 s37, s37, 19
    s_and_b32 s36, s36, 511
    s_lshl_b32 s36, s36, 10
    s_add_u32 s36, s36, s37
    s_add_u32 s36, s36, s33
    buffer_load_dwordx4 v[96:99], v250, s[8:11], s36 offen
    s_add_u32 s36, s36, 0x100000
    buffer_load_dwordx4 v[100:103], v250, s[8:11], s36 offen
    s_add_u32 s36, s36, 0x100000
    buffer_load_dwordx4 v[104:107], v250, s[8:11], s36 offen
    s_add_u32 s36, s36, 0x100000
    buffer_load_dwordx4 v[108:111], v250, s[8:11], s36 offen
    s_add_u32 s36, s36, 0x100000
    buffer_load_dwordx4 v[112:115], v250, s[8:11], s36 offen
    s_add_u32 s36, s36, 0x100000
    buffer_load_dwordx4 v[116:119], v250, s[8:11], s36 offen
    s_add_u32 s36, s36, 0x100000
    buffer_load_dwordx4 v[120:123], v250, s[8:11], s36 offen
    s_add_u32 s36, s36, 0x100000
    buffer_load_dwordx4 v[124:127], v250, s[8:11], s36 offen
    s_branch K12_PL2
K12_PL1:
    s_cmp_eq_u32 s27, 0
    s_cbranch_scc1 K12_PL2
    s_lshl_b32 s36, s40, 8
    s_mul_i32 s37, s30, 98304
    s_add_u32 s36, s36, s37
    buffer_load_dwordx4 v[0:3], v248, s[4:7], s36 offen
    buffer_load_dwordx4 v[4:7], v248, s[4:7], s36 offen offset:2048
    s_add_u32 s36, s36, 4096
    buffer_load_dwordx4 v[8:11], v248, s[4:7], s36 offen
    buffer_load_dwordx4 v[12:15], v248, s[4:7], s36 offen offset:2048
    s_add_u32 s36, s36, 4096
    buffer_load_dwordx4 v[16:19], v248, s[4:7], s36 offen
    buffer_load_dwordx4 v[20:23], v248, s[4:7], s36 offen offset:2048
    s_add_u32 s36, s36, 4096
    buffer_load_dwordx4 v[24:27], v248, s[4:7], s36 offen
    buffer_load_dwordx4 v[28:31], v248, s[4:7], s36 offen offset:2048
    s_add_u32 s36, s36, 53248
    buffer_load_dwordx4 v[32:35], v248, s[4:7], s36 offen
    buffer_load_dwordx4 v[36:39], v248, s[4:7], s36 offen offset:2048
    s_add_u32 s36, s36, 4096
    buffer_load_dwordx4 v[40:43], v248, s[4:7], s36 offen
    buffer_load_dwordx4 v[44:47], v248, s[4:7], s36 offen offset:2048
    s_add_u32 s36, s36, 4096
    buffer_load_dwordx4 v[48:51], v248, s[4:7], s36 offen
    buffer_load_dwordx4 v[52:55], v248, s[4:7], s36 offen offset:2048
    s_add_u32 s36, s36, 4096
    buffer_load_dwordx4 v[56:59], v248, s[4:7], s36 offen
    buffer_load_dwordx4 v[60:63], v248, s[4:7], s36 offen offset:2048
K12_PL2:
    v_and_b32 v128, 3, v64
    v_lshlrev_b32 v128, 2, v128
    v_lshrrev_b32 v130, 3, v64
    v_lshl_add_u32 v128, v130, 1, v128
    s_lshl_b32 s36, s44, 4
    s_add_u32 s36, s36, 1
    v_add_u32 v128, s36, v128
    v_bfe_u32 v129, v64, 2, 1
    v_lshlrev_b32 v131, 3, v65
    v_lshlrev_b32 v132, 5, v129
    v_mad_u32_u24 v133, v128, v131, v132
    v_mad_u32_u24 v136, v128, 0, v133
    v_mad_u32_u24 v137, v128, 1, v133
    v_mad_u32_u24 v138, v128, 2, v133
    v_mad_u32_u24 v139, v128, 3, v133
    v_mad_u32_u24 v140, v128, 4, v133
    v_mad_u32_u24 v141, v128, 5, v133
    v_mad_u32_u24 v142, v128, 6, v133
    v_mad_u32_u24 v143, v128, 7, v133
    v_and_b32 v136, 127, v136
    v_and_b32 v137, 127, v137
    v_and_b32 v138, 127, v138
    v_and_b32 v139, 127, v139
    v_and_b32 v140, 127, v140
    v_and_b32 v141, 127, v141
    v_and_b32 v142, 127, v142
    v_and_b32 v143, 127, v143
    v_cvt_f32_u32 v136, v136
    v_cvt_f32_u32 v137, v137
    v_cvt_f32_u32 v138, v138
    v_cvt_f32_u32 v139, v139
    v_cvt_f32_u32 v140, v140
    v_cvt_f32_u32 v141, v141
    v_cvt_f32_u32 v142, v142
    v_cvt_f32_u32 v143, v143
    v_mul_f32 v136, 0x3c000000, v136
    v_mul_f32 v137, 0x3c000000, v137
    v_mul_f32 v138, 0x3c000000, v138
    v_mul_f32 v139, 0x3c000000, v139
    v_mul_f32 v140, 0x3c000000, v140
    v_mul_f32 v141, 0x3c000000, v141
    v_mul_f32 v142, 0x3c000000, v142
    v_mul_f32 v143, 0x3c000000, v143
    v_cos_f32 v136, v136
    v_cos_f32 v137, v137
    v_cos_f32 v138, v138
    v_cos_f32 v139, v139
    v_cos_f32 v140, v140
    v_cos_f32 v141, v141
    v_cos_f32 v142, v142
    v_cos_f32 v143, v143
    s_nop 0
    v_cvt_pk_bf16_f32 v144, v136, v137
    v_cvt_pk_bf16_f32 v145, v138, v139
    v_cvt_pk_bf16_f32 v146, v140, v141
    v_cvt_pk_bf16_f32 v147, v142, v143
    v_lshlrev_b32 v152, 16, v144
    v_and_b32 v153, 0xffff0000, v144
    v_sub_f32 v136, v136, v152
    v_sub_f32 v137, v137, v153
    v_lshlrev_b32 v152, 16, v145
    v_and_b32 v153, 0xffff0000, v145
    v_sub_f32 v138, v138, v152
    v_sub_f32 v139, v139, v153
    v_lshlrev_b32 v152, 16, v146
    v_and_b32 v153, 0xffff0000, v146
    v_sub_f32 v140, v140, v152
    v_sub_f32 v141, v141, v153
    v_lshlrev_b32 v152, 16, v147
    v_and_b32 v153, 0xffff0000, v147
    v_sub_f32 v142, v142, v152
    v_sub_f32 v143, v143, v153
    v_cvt_pk_bf16_f32 v148, v136, v137
    v_cvt_pk_bf16_f32 v149, v138, v139
    v_cvt_pk_bf16_f32 v150, v140, v141
    v_cvt_pk_bf16_f32 v151, v142, v143
    s_lshl_b32 s37, s44, 12
    s_add_u32 s37, s37, 116736
    v_add_u32 v132, s37, v254
    ds_write_b128 v132, v[144:147]
    ds_write_b128 v132, v[148:151] offset:1024
    v_add_u32 v131, 32, v131
    v_lshlrev_b32 v132, 5, v129
    v_mad_u32_u24 v133, v128, v131, v132
    v_mad_u32_u24 v136, v128, 0, v133
    v_mad_u32_u24 v137, v128, 1, v133
    v_mad_u32_u24 v138, v128, 2, v133
    v_mad_u32_u24 v139, v128, 3, v133
    v_mad_u32_u24 v140, v128, 4, v133
    v_mad_u32_u24 v141, v128, 5, v133
    v_mad_u32_u24 v142, v128, 6, v133
    v_mad_u32_u24 v143, v128, 7, v133
    v_and_b32 v136, 127, v136
    v_and_b32 v137, 127, v137
    v_and_b32 v138, 127, v138
    v_and_b32 v139, 127, v139
    v_and_b32 v140, 127, v140
    v_and_b32 v141, 127, v141
    v_and_b32 v142, 127, v142
    v_and_b32 v143, 127, v143
    v_cvt_f32_u32 v136, v136
    v_cvt_f32_u32 v137, v137
    v_cvt_f32_u32 v138, v138
    v_cvt_f32_u32 v139, v139
    v_cvt_f32_u32 v140, v140
    v_cvt_f32_u32 v141, v141
    v_cvt_f32_u32 v142, v142
    v_cvt_f32_u32 v143, v143
    v_mul_f32 v136, 0x3c000000, v136
    v_mul_f32 v137, 0x3c000000, v137
    v_mul_f32 v138, 0x3c000000, v138
    v_mul_f32 v139, 0x3c000000, v139
    v_mul_f32 v140, 0x3c000000, v140
    v_mul_f32 v141, 0x3c000000, v141
    v_mul_f32 v142, 0x3c000000, v142
    v_mul_f32 v143, 0x3c000000, v143
    v_cos_f32 v136, v136
    v_cos_f32 v137, v137
    v_cos_f32 v138, v138
    v_cos_f32 v139, v139
    v_cos_f32 v140, v140
    v_cos_f32 v141, v141
    v_cos_f32 v142, v142
    v_cos_f32 v143, v143
    s_nop 0
    v_cvt_pk_bf16_f32 v144, v136, v137
    v_cvt_pk_bf16_f32 v145, v138, v139
    v_cvt_pk_bf16_f32 v146, v140, v141
    v_cvt_pk_bf16_f32 v147, v142, v143
    v_lshlrev_b32 v152, 16, v144
    v_and_b32 v153, 0xffff0000, v144
    v_sub_f32 v136, v136, v152
    v_sub_f32 v137, v137, v153
    v_lshlrev_b32 v152, 16, v145
    v_and_b32 v153, 0xffff0000, v145
    v_sub_f32 v138, v138, v152
    v_sub_f32 v139, v139, v153
    v_lshlrev_b32 v152, 16, v146
    v_and_b32 v153, 0xffff0000, v146
    v_sub_f32 v140, v140, v152
    v_sub_f32 v141, v141, v153
    v_lshlrev_b32 v152, 16, v147
    v_and_b32 v153, 0xffff0000, v147
    v_sub_f32 v142, v142, v152
    v_sub_f32 v143, v143, v153
    v_cvt_pk_bf16_f32 v148, v136, v137
    v_cvt_pk_bf16_f32 v149, v138, v139
    v_cvt_pk_bf16_f32 v150, v140, v141
    v_cvt_pk_bf16_f32 v151, v142, v143
    s_lshl_b32 s37, s44, 12
    s_add_u32 s37, s37, 118784
    v_add_u32 v132, s37, v254
    ds_write_b128 v132, v[144:147]
    ds_write_b128 v132, v[148:151] offset:1024
K12_TB:
    s_waitcnt lgkmcnt(0)
    s_barrier
    v_add_u32 v255, 116736, v254
    ds_read_b128 v[160:163], v255 offset:0
    ds_read_b128 v[192:195], v255 offset:1024
    ds_read_b128 v[164:167], v255 offset:2048
    ds_read_b128 v[196:199], v255 offset:3072
    ds_read_b128 v[168:171], v255 offset:4096
    ds_read_b128 v[200:203], v255 offset:5120
    ds_read_b128 v[172:175], v255 offset:6144
    ds_read_b128 v[204:207], v255 offset:7168
    s_waitcnt lgkmcnt(0)
    ds_read_b128 v[176:179], v255 offset:8192
    ds_read_b128 v[208:211], v255 offset:9216
    ds_read_b128 v[180:183], v255 offset:10240
    ds_read_b128 v[212:215], v255 offset:11264
    ds_read_b128 v[184:187], v255 offset:12288
    ds_read_b128 v[216:219], v255 offset:13312
    ds_read_b128 v[188:191], v255 offset:14336
    ds_read_b128 v[220:223], v255 offset:15360
    ds_read_b128 v[224:227], v255 offset:16384
    ds_read_b128 v[228:231], v255 offset:17408
    ds_read_b128 v[232:235], v255 offset:18432
    ds_read_b128 v[236:239], v255 offset:19456
    s_waitcnt lgkmcnt(0)
    s_barrier
    s_waitcnt vmcnt(0) lgkmcnt(0)
    s_mov_b32 s41, -1
    s_mov_b32 s34, -1
    s_branch K12_PROD
    s_cmp_lt_u32 s3, 4
    s_cbranch_scc0 K12_PROD
    s_cmp_eq_u32 s43, 0
    s_cbranch_scc0 K12_H1
    v_perm_b32 v64, v100, v96, s28
    v_perm_b32 v68, v100, v96, s29
    v_perm_b32 v65, v108, v104, s28
    v_perm_b32 v69, v108, v104, s29
    v_perm_b32 v66, v116, v112, s28
    v_perm_b32 v70, v116, v112, s29
    v_perm_b32 v67, v124, v120, s28
    v_perm_b32 v71, v124, v120, s29
    v_perm_b32 v72, v101, v97, s28
    v_perm_b32 v76, v101, v97, s29
    v_perm_b32 v73, v109, v105, s28
    v_perm_b32 v77, v109, v105, s29
    v_perm_b32 v74, v117, v113, s28
    v_perm_b32 v78, v117, v113, s29
    v_perm_b32 v75, v125, v121, s28
    v_perm_b32 v79, v125, v121, s29
    v_perm_b32 v80, v102, v98, s28
    v_perm_b32 v84, v102, v98, s29
    v_perm_b32 v81, v110, v106, s28
    v_perm_b32 v85, v110, v106, s29
    v_perm_b32 v82, v118, v114, s28
    v_perm_b32 v86, v118, v114, s29
    v_perm_b32 v83, v126, v122, s28
    v_perm_b32 v87, v126, v122, s29
    v_perm_b32 v88, v103, v99, s28
    v_perm_b32 v92, v103, v99, s29
    v_perm_b32 v89, v111, v107, s28
    v_perm_b32 v93, v111, v107, s29
    v_perm_b32 v90, v119, v115, s28
    v_perm_b32 v94, v119, v115, s29
    v_perm_b32 v91, v127, v123, s28
    v_perm_b32 v95, v127, v123, s29
    s_lshl_b32 s36, s40, 7
    s_add_u32 s36, s36, s22
    s_and_b32 s37, s36, 3
    s_lshr_b32 s38, s36, 1
    s_and_b32 s38, s38, 4
    s_or_b32 s37, s37, s38
    v_bfe_u32 v253, v254, 5, 3
    v_xor_b32 v253, s37, v253
    v_lshl_add_u32 v253, v253, 5, v251
    s_lshl_b32 s36, s36, 9
    s_add_u32 s39, s36, s32
    s_setprio 1
    v_mfma_f32_16x16x32_bf16 v[128:131], v[224:227], v[64:67], 0
    v_mfma_f32_16x16x32_bf16 v[132:135], v[224:227], v[68:71], 0
    v_mfma_f32_16x16x32_bf16 v[136:139], v[224:227], v[72:75], 0
    v_mfma_f32_16x16x32_bf16 v[140:143], v[224:227], v[76:79], 0
    v_mfma_f32_16x16x32_bf16 v[144:147], v[224:227], v[80:83], 0
    v_mfma_f32_16x16x32_bf16 v[148:151], v[224:227], v[84:87], 0
    v_mfma_f32_16x16x32_bf16 v[152:155], v[224:227], v[88:91], 0
    v_mfma_f32_16x16x32_bf16 v[156:159], v[224:227], v[92:95], 0
    s_setprio 0
    s_nop 7
    v_cvt_pk_bf16_f32 v240, v128, v132
    v_cvt_pk_bf16_f32 v241, v136, v140
    v_cvt_pk_bf16_f32 v242, v144, v148
    v_cvt_pk_bf16_f32 v243, v152, v156
    buffer_store_dwordx4 v[240:243], v253, s[16:19], s39 offen sc1
    s_add_u32 s39, s39, 4194304
    v_cvt_pk_bf16_f32 v244, v129, v133
    v_cvt_pk_bf16_f32 v245, v137, v141
    v_cvt_pk_bf16_f32 v246, v145, v149
    v_cvt_pk_bf16_f32 v247, v153, v157
    buffer_store_dwordx4 v[244:247], v253, s[16:19], s39 offen sc1
    s_add_u32 s39, s39, 4194304
    v_cvt_pk_bf16_f32 v240, v130, v134
    v_cvt_pk_bf16_f32 v241, v138, v142
    v_cvt_pk_bf16_f32 v242, v146, v150
    v_cvt_pk_bf16_f32 v243, v154, v158
    buffer_store_dwordx4 v[240:243], v253, s[16:19], s39 offen sc1
    s_add_u32 s39, s39, 4194304
    v_cvt_pk_bf16_f32 v244, v131, v135
    v_cvt_pk_bf16_f32 v245, v139, v143
    v_cvt_pk_bf16_f32 v246, v147, v151
    v_cvt_pk_bf16_f32 v247, v155, v159
    buffer_store_dwordx4 v[244:247], v253, s[16:19], s39 offen sc1
    s_add_u32 s39, s39, 4194304
    s_cmp_lt_u32 s40, 4
    s_cbranch_scc1 K12_UT0
    s_lshl_b32 s36, s40, 3
    s_sub_i32 s36, s36, 22
    s_max_i32 s36, s36, 1
    s_mov_b32 s37, 131072
K12_UL0:
    v_mov_b32 v255, 155648
    ds_read_b32 v255, v255
    s_waitcnt lgkmcnt(0)
    v_cmp_gt_u32 vcc, s36, v255
    s_sub_u32 s37, s37, 1
    s_cmp_eq_u32 s37, 0
    s_cbranch_scc1 K12_UT0
    s_cbranch_vccz K12_UT0
    s_sleep 2
    s_branch K12_UL0
K12_UT0:
    s_setprio 1
    v_mfma_f32_16x16x32_bf16 v[128:131], v[228:231], v[64:67], 0
    v_mfma_f32_16x16x32_bf16 v[132:135], v[228:231], v[68:71], 0
    v_mfma_f32_16x16x32_bf16 v[136:139], v[228:231], v[72:75], 0
    v_mfma_f32_16x16x32_bf16 v[140:143], v[228:231], v[76:79], 0
    v_mfma_f32_16x16x32_bf16 v[144:147], v[228:231], v[80:83], 0
    v_mfma_f32_16x16x32_bf16 v[148:151], v[228:231], v[84:87], 0
    v_mfma_f32_16x16x32_bf16 v[152:155], v[228:231], v[88:91], 0
    v_mfma_f32_16x16x32_bf16 v[156:159], v[228:231], v[92:95], 0
    s_setprio 0
    s_nop 7
    v_cvt_pk_bf16_f32 v240, v128, v132
    v_cvt_pk_bf16_f32 v241, v136, v140
    v_cvt_pk_bf16_f32 v242, v144, v148
    v_cvt_pk_bf16_f32 v243, v152, v156
    buffer_store_dwordx4 v[240:243], v253, s[16:19], s39 offen sc1
    s_add_u32 s39, s39, 4194304
    v_cvt_pk_bf16_f32 v244, v129, v133
    v_cvt_pk_bf16_f32 v245, v137, v141
    v_cvt_pk_bf16_f32 v246, v145, v149
    v_cvt_pk_bf16_f32 v247, v153, v157
    buffer_store_dwordx4 v[244:247], v253, s[16:19], s39 offen sc1
    s_add_u32 s39, s39, 4194304
    v_cvt_pk_bf16_f32 v240, v130, v134
    v_cvt_pk_bf16_f32 v241, v138, v142
    v_cvt_pk_bf16_f32 v242, v146, v150
    v_cvt_pk_bf16_f32 v243, v154, v158
    buffer_store_dwordx4 v[240:243], v253, s[16:19], s39 offen sc1
    s_add_u32 s39, s39, 4194304
    v_cvt_pk_bf16_f32 v244, v131, v135
    v_cvt_pk_bf16_f32 v245, v139, v143
    v_cvt_pk_bf16_f32 v246, v147, v151
    v_cvt_pk_bf16_f32 v247, v155, v159
    buffer_store_dwordx4 v[244:247], v253, s[16:19], s39 offen sc1
    s_add_u32 s39, s39, 4194304
    s_cmp_lt_u32 s40, 4
    s_cbranch_scc1 K12_UT1
    s_lshl_b32 s36, s40, 3
    s_sub_i32 s36, s36, 20
    s_max_i32 s36, s36, 1
    s_mov_b32 s37, 131072
K12_UL1:
    v_mov_b32 v255, 155648
    ds_read_b32 v255, v255
    s_waitcnt lgkmcnt(0)
    v_cmp_gt_u32 vcc, s36, v255
    s_sub_u32 s37, s37, 1
    s_cmp_eq_u32 s37, 0
    s_cbranch_scc1 K12_UT1
    s_cbranch_vccz K12_UT1
    s_sleep 2
    s_branch K12_UL1
K12_UT1:
    s_setprio 1
    v_mfma_f32_16x16x32_bf16 v[128:131], v[232:235], v[64:67], 0
    v_mfma_f32_16x16x32_bf16 v[132:135], v[232:235], v[68:71], 0
    v_mfma_f32_16x16x32_bf16 v[136:139], v[232:235], v[72:75], 0
    v_mfma_f32_16x16x32_bf16 v[140:143], v[232:235], v[76:79], 0
    v_mfma_f32_16x16x32_bf16 v[144:147], v[232:235], v[80:83], 0
    v_mfma_f32_16x16x32_bf16 v[148:151], v[232:235], v[84:87], 0
    v_mfma_f32_16x16x32_bf16 v[152:155], v[232:235], v[88:91], 0
    v_mfma_f32_16x16x32_bf16 v[156:159], v[232:235], v[92:95], 0
    s_setprio 0
    s_nop 7
    v_cvt_pk_bf16_f32 v240, v128, v132
    v_cvt_pk_bf16_f32 v241, v136, v140
    v_cvt_pk_bf16_f32 v242, v144, v148
    v_cvt_pk_bf16_f32 v243, v152, v156
    buffer_store_dwordx4 v[240:243], v253, s[16:19], s39 offen sc1
    s_add_u32 s39, s39, 4194304
    v_cvt_pk_bf16_f32 v244, v129, v133
    v_cvt_pk_bf16_f32 v245, v137, v141
    v_cvt_pk_bf16_f32 v246, v145, v149
    v_cvt_pk_bf16_f32 v247, v153, v157
    buffer_store_dwordx4 v[244:247], v253, s[16:19], s39 offen sc1
    s_add_u32 s39, s39, 4194304
    v_cvt_pk_bf16_f32 v240, v130, v134
    v_cvt_pk_bf16_f32 v241, v138, v142
    v_cvt_pk_bf16_f32 v242, v146, v150
    v_cvt_pk_bf16_f32 v243, v154, v158
    buffer_store_dwordx4 v[240:243], v253, s[16:19], s39 offen sc1
    s_add_u32 s39, s39, 4194304
    v_cvt_pk_bf16_f32 v244, v131, v135
    v_cvt_pk_bf16_f32 v245, v139, v143
    v_cvt_pk_bf16_f32 v246, v147, v151
    v_cvt_pk_bf16_f32 v247, v155, v159
    buffer_store_dwordx4 v[244:247], v253, s[16:19], s39 offen sc1
    s_add_u32 s39, s39, 4194304
    s_cmp_lt_u32 s40, 4
    s_cbranch_scc1 K12_UT2
    s_lshl_b32 s36, s40, 3
    s_sub_i32 s36, s36, 18
    s_max_i32 s36, s36, 1
    s_mov_b32 s37, 131072
K12_UL2:
    v_mov_b32 v255, 155648
    ds_read_b32 v255, v255
    s_waitcnt lgkmcnt(0)
    v_cmp_gt_u32 vcc, s36, v255
    s_sub_u32 s37, s37, 1
    s_cmp_eq_u32 s37, 0
    s_cbranch_scc1 K12_UT2
    s_cbranch_vccz K12_UT2
    s_sleep 2
    s_branch K12_UL2
K12_UT2:
    s_setprio 1
    v_mfma_f32_16x16x32_bf16 v[128:131], v[236:239], v[64:67], 0
    v_mfma_f32_16x16x32_bf16 v[132:135], v[236:239], v[68:71], 0
    v_mfma_f32_16x16x32_bf16 v[136:139], v[236:239], v[72:75], 0
    v_mfma_f32_16x16x32_bf16 v[140:143], v[236:239], v[76:79], 0
    v_mfma_f32_16x16x32_bf16 v[144:147], v[236:239], v[80:83], 0
    v_mfma_f32_16x16x32_bf16 v[148:151], v[236:239], v[84:87], 0
    v_mfma_f32_16x16x32_bf16 v[152:155], v[236:239], v[88:91], 0
    v_mfma_f32_16x16x32_bf16 v[156:159], v[236:239], v[92:95], 0
    s_setprio 0
    s_nop 7
    v_cvt_pk_bf16_f32 v240, v128, v132
    v_cvt_pk_bf16_f32 v241, v136, v140
    v_cvt_pk_bf16_f32 v242, v144, v148
    v_cvt_pk_bf16_f32 v243, v152, v156
    buffer_store_dwordx4 v[240:243], v253, s[16:19], s39 offen sc1
    s_add_u32 s39, s39, 4194304
    v_cvt_pk_bf16_f32 v244, v129, v133
    v_cvt_pk_bf16_f32 v245, v137, v141
    v_cvt_pk_bf16_f32 v246, v145, v149
    v_cvt_pk_bf16_f32 v247, v153, v157
    buffer_store_dwordx4 v[244:247], v253, s[16:19], s39 offen sc1
    s_add_u32 s39, s39, 4194304
    v_cvt_pk_bf16_f32 v240, v130, v134
    v_cvt_pk_bf16_f32 v241, v138, v142
    v_cvt_pk_bf16_f32 v242, v146, v150
    v_cvt_pk_bf16_f32 v243, v154, v158
    buffer_store_dwordx4 v[240:243], v253, s[16:19], s39 offen sc1
    s_add_u32 s39, s39, 4194304
    v_cvt_pk_bf16_f32 v244, v131, v135
    v_cvt_pk_bf16_f32 v245, v139, v143
    v_cvt_pk_bf16_f32 v246, v147, v151
    v_cvt_pk_bf16_f32 v247, v155, v159
    buffer_store_dwordx4 v[244:247], v253, s[16:19], s39 offen sc1
    s_branch K12_H2
K12_H1:
    s_cmp_eq_u32 s27, 0
    s_cbranch_scc1 K12_H2
    v_perm_b32 v64, v4, v0, s28
    v_perm_b32 v68, v4, v0, s29
    v_perm_b32 v65, v12, v8, s28
    v_perm_b32 v69, v12, v8, s29
    v_perm_b32 v66, v20, v16, s28
    v_perm_b32 v70, v20, v16, s29
    v_perm_b32 v67, v28, v24, s28
    v_perm_b32 v71, v28, v24, s29
    v_perm_b32 v72, v5, v1, s28
    v_perm_b32 v76, v5, v1, s29
    v_perm_b32 v73, v13, v9, s28
    v_perm_b32 v77, v13, v9, s29
    v_perm_b32 v74, v21, v17, s28
    v_perm_b32 v78, v21, v17, s29
    v_perm_b32 v75, v29, v25, s28
    v_perm_b32 v79, v29, v25, s29
    v_perm_b32 v80, v6, v2, s28
    v_perm_b32 v84, v6, v2, s29
    v_perm_b32 v81, v14, v10, s28
    v_perm_b32 v85, v14, v10, s29
    v_perm_b32 v82, v22, v18, s28
    v_perm_b32 v86, v22, v18, s29
    v_perm_b32 v83, v30, v26, s28
    v_perm_b32 v87, v30, v26, s29
    v_perm_b32 v88, v7, v3, s28
    v_perm_b32 v92, v7, v3, s29
    v_perm_b32 v89, v15, v11, s28
    v_perm_b32 v93, v15, v11, s29
    v_perm_b32 v90, v23, v19, s28
    v_perm_b32 v94, v23, v19, s29
    v_perm_b32 v91, v31, v27, s28
    v_perm_b32 v95, v31, v27, s29
    v_perm_b32 v0, v36, v32, s28
    v_perm_b32 v4, v36, v32, s29
    v_perm_b32 v1, v44, v40, s28
    v_perm_b32 v5, v44, v40, s29
    v_perm_b32 v2, v52, v48, s28
    v_perm_b32 v6, v52, v48, s29
    v_perm_b32 v3, v60, v56, s28
    v_perm_b32 v7, v60, v56, s29
    v_perm_b32 v8, v37, v33, s28
    v_perm_b32 v12, v37, v33, s29
    v_perm_b32 v9, v45, v41, s28
    v_perm_b32 v13, v45, v41, s29
    v_perm_b32 v10, v53, v49, s28
    v_perm_b32 v14, v53, v49, s29
    v_perm_b32 v11, v61, v57, s28
    v_perm_b32 v15, v61, v57, s29
    v_perm_b32 v16, v38, v34, s28
    v_perm_b32 v20, v38, v34, s29
    v_perm_b32 v17, v46, v42, s28
    v_perm_b32 v21, v46, v42, s29
    v_perm_b32 v18, v54, v50, s28
    v_perm_b32 v22, v54, v50, s29
    v_perm_b32 v19, v62, v58, s28
    v_perm_b32 v23, v62, v58, s29
    v_perm_b32 v24, v39, v35, s28
    v_perm_b32 v28, v39, v35, s29
    v_perm_b32 v25, v47, v43, s28
    v_perm_b32 v29, v47, v43, s29
    v_perm_b32 v26, v55, v51, s28
    v_perm_b32 v30, v55, v51, s29
    v_perm_b32 v27, v63, v59, s28
    v_perm_b32 v31, v63, v59, s29
    s_mul_i32 s39, s40, 85504
    s_add_u32 s39, s39, s31
    s_lshl_b32 s36, s30, 7
    s_add_u32 s39, s39, s36
    v_bfe_u32 v249, v254, 4, 2
    v_bfe_u32 v240, v254, 8, 1
    v_lshl_add_u32 v249, v240, 2, v249
    s_add_u32 s36, s30, 7
    s_cmp_ge_u32 s30, 160
    s_cselect_b32 s36, s36, s30
    s_cmp_eq_u32 s25, 1
    s_cselect_b32 s36, s36, s30
    s_lshr_b32 s36, s36, 1
    s_and_b32 s36, s36, 7
    v_xor_b32 v249, s36, v249
    v_lshl_add_u32 v249, v249, 4, v252
    s_setprio 1
    v_mfma_f32_16x16x32_bf16 v[32:35], v[160:163], v[64:67], 0
    v_mfma_f32_16x16x32_bf16 v[36:39], v[160:163], v[68:71], 0
    v_mfma_f32_16x16x32_bf16 v[40:43], v[160:163], v[72:75], 0
    v_mfma_f32_16x16x32_bf16 v[44:47], v[160:163], v[76:79], 0
    v_mfma_f32_16x16x32_bf16 v[48:51], v[160:163], v[80:83], 0
    v_mfma_f32_16x16x32_bf16 v[52:55], v[160:163], v[84:87], 0
    v_mfma_f32_16x16x32_bf16 v[56:59], v[160:163], v[88:91], 0
    v_mfma_f32_16x16x32_bf16 v[60:63], v[160:163], v[92:95], 0
    v_mfma_f32_16x16x32_bf16 v[32:35], v[192:195], v[64:67], v[32:35]
    v_mfma_f32_16x16x32_bf16 v[36:39], v[192:195], v[68:71], v[36:39]
    v_mfma_f32_16x16x32_bf16 v[40:43], v[192:195], v[72:75], v[40:43]
    v_mfma_f32_16x16x32_bf16 v[44:47], v[192:195], v[76:79], v[44:47]
    v_mfma_f32_16x16x32_bf16 v[48:51], v[192:195], v[80:83], v[48:51]
    v_mfma_f32_16x16x32_bf16 v[52:55], v[192:195], v[84:87], v[52:55]
    v_mfma_f32_16x16x32_bf16 v[56:59], v[192:195], v[88:91], v[56:59]
    v_mfma_f32_16x16x32_bf16 v[60:63], v[192:195], v[92:95], v[60:63]
    v_mfma_f32_16x16x32_bf16 v[32:35], v[164:167], v[0:3], v[32:35]
    v_mfma_f32_16x16x32_bf16 v[36:39], v[164:167], v[4:7], v[36:39]
    v_mfma_f32_16x16x32_bf16 v[40:43], v[164:167], v[8:11], v[40:43]
    v_mfma_f32_16x16x32_bf16 v[44:47], v[164:167], v[12:15], v[44:47]
    v_mfma_f32_16x16x32_bf16 v[48:51], v[164:167], v[16:19], v[48:51]
    v_mfma_f32_16x16x32_bf16 v[52:55], v[164:167], v[20:23], v[52:55]
    v_mfma_f32_16x16x32_bf16 v[56:59], v[164:167], v[24:27], v[56:59]
    v_mfma_f32_16x16x32_bf16 v[60:63], v[164:167], v[28:31], v[60:63]
    v_mfma_f32_16x16x32_bf16 v[32:35], v[196:199], v[0:3], v[32:35]
    v_mfma_f32_16x16x32_bf16 v[36:39], v[196:199], v[4:7], v[36:39]
    v_mfma_f32_16x16x32_bf16 v[40:43], v[196:199], v[8:11], v[40:43]
    v_mfma_f32_16x16x32_bf16 v[44:47], v[196:199], v[12:15], v[44:47]
    v_mfma_f32_16x16x32_bf16 v[48:51], v[196:199], v[16:19], v[48:51]
    v_mfma_f32_16x16x32_bf16 v[52:55], v[196:199], v[20:23], v[52:55]
    v_mfma_f32_16x16x32_bf16 v[56:59], v[196:199], v[24:27], v[56:59]
    v_mfma_f32_16x16x32_bf16 v[60:63], v[196:199], v[28:31], v[60:63]
    s_setprio 0
    s_nop 7
    v_cvt_pk_bf16_f32 v240, v32, v36
    v_cvt_pk_bf16_f32 v241, v40, v44
    v_cvt_pk_bf16_f32 v242, v48, v52
    v_cvt_pk_bf16_f32 v243, v56, v60
    buffer_store_dwordx4 v[240:243], v249, s[12:15], s39 offen sc1
    s_add_u32 s39, s39, 2736128
    v_cvt_pk_bf16_f32 v244, v33, v37
    v_cvt_pk_bf16_f32 v245, v41, v45
    v_cvt_pk_bf16_f32 v246, v49, v53
    v_cvt_pk_bf16_f32 v247, v57, v61
    buffer_store_dwordx4 v[244:247], v249, s[12:15], s39 offen sc1
    s_add_u32 s39, s39, 2736128
    v_cvt_pk_bf16_f32 v240, v34, v38
    v_cvt_pk_bf16_f32 v241, v42, v46
    v_cvt_pk_bf16_f32 v242, v50, v54
    v_cvt_pk_bf16_f32 v243, v58, v62
    buffer_store_dwordx4 v[240:243], v249, s[12:15], s39 offen sc1
    s_add_u32 s39, s39, 2736128
    v_cvt_pk_bf16_f32 v244, v35, v39
    v_cvt_pk_bf16_f32 v245, v43, v47
    v_cvt_pk_bf16_f32 v246, v51, v55
    v_cvt_pk_bf16_f32 v247, v59, v63
    buffer_store_dwordx4 v[244:247], v249, s[12:15], s39 offen sc1
    s_add_u32 s39, s39, 2736128
    s_cmp_lt_u32 s40, 4
    s_cbranch_scc1 K12_UT3
    s_lshl_b32 s36, s40, 3
    s_sub_i32 s36, s36, 22
    s_max_i32 s36, s36, 1
    s_mov_b32 s37, 131072
K12_UL3:
    v_mov_b32 v255, 155648
    ds_read_b32 v255, v255
    s_waitcnt lgkmcnt(0)
    v_cmp_gt_u32 vcc, s36, v255
    s_sub_u32 s37, s37, 1
    s_cmp_eq_u32 s37, 0
    s_cbranch_scc1 K12_UT3
    s_cbranch_vccz K12_UT3
    s_sleep 2
    s_branch K12_UL3
K12_UT3:
    s_setprio 1
    v_mfma_f32_16x16x32_bf16 v[32:35], v[168:171], v[64:67], 0
    v_mfma_f32_16x16x32_bf16 v[36:39], v[168:171], v[68:71], 0
    v_mfma_f32_16x16x32_bf16 v[40:43], v[168:171], v[72:75], 0
    v_mfma_f32_16x16x32_bf16 v[44:47], v[168:171], v[76:79], 0
    v_mfma_f32_16x16x32_bf16 v[48:51], v[168:171], v[80:83], 0
    v_mfma_f32_16x16x32_bf16 v[52:55], v[168:171], v[84:87], 0
    v_mfma_f32_16x16x32_bf16 v[56:59], v[168:171], v[88:91], 0
    v_mfma_f32_16x16x32_bf16 v[60:63], v[168:171], v[92:95], 0
    v_mfma_f32_16x16x32_bf16 v[32:35], v[200:203], v[64:67], v[32:35]
    v_mfma_f32_16x16x32_bf16 v[36:39], v[200:203], v[68:71], v[36:39]
    v_mfma_f32_16x16x32_bf16 v[40:43], v[200:203], v[72:75], v[40:43]
    v_mfma_f32_16x16x32_bf16 v[44:47], v[200:203], v[76:79], v[44:47]
    v_mfma_f32_16x16x32_bf16 v[48:51], v[200:203], v[80:83], v[48:51]
    v_mfma_f32_16x16x32_bf16 v[52:55], v[200:203], v[84:87], v[52:55]
    v_mfma_f32_16x16x32_bf16 v[56:59], v[200:203], v[88:91], v[56:59]
    v_mfma_f32_16x16x32_bf16 v[60:63], v[200:203], v[92:95], v[60:63]
    v_mfma_f32_16x16x32_bf16 v[32:35], v[172:175], v[0:3], v[32:35]
    v_mfma_f32_16x16x32_bf16 v[36:39], v[172:175], v[4:7], v[36:39]
    v_mfma_f32_16x16x32_bf16 v[40:43], v[172:175], v[8:11], v[40:43]
    v_mfma_f32_16x16x32_bf16 v[44:47], v[172:175], v[12:15], v[44:47]
    v_mfma_f32_16x16x32_bf16 v[48:51], v[172:175], v[16:19], v[48:51]
    v_mfma_f32_16x16x32_bf16 v[52:55], v[172:175], v[20:23], v[52:55]
    v_mfma_f32_16x16x32_bf16 v[56:59], v[172:175], v[24:27], v[56:59]
    v_mfma_f32_16x16x32_bf16 v[60:63], v[172:175], v[28:31], v[60:63]
    v_mfma_f32_16x16x32_bf16 v[32:35], v[204:207], v[0:3], v[32:35]
    v_mfma_f32_16x16x32_bf16 v[36:39], v[204:207], v[4:7], v[36:39]
    v_mfma_f32_16x16x32_bf16 v[40:43], v[204:207], v[8:11], v[40:43]
    v_mfma_f32_16x16x32_bf16 v[44:47], v[204:207], v[12:15], v[44:47]
    v_mfma_f32_16x16x32_bf16 v[48:51], v[204:207], v[16:19], v[48:51]
    v_mfma_f32_16x16x32_bf16 v[52:55], v[204:207], v[20:23], v[52:55]
    v_mfma_f32_16x16x32_bf16 v[56:59], v[204:207], v[24:27], v[56:59]
    v_mfma_f32_16x16x32_bf16 v[60:63], v[204:207], v[28:31], v[60:63]
    s_setprio 0
    s_nop 7
    v_cvt_pk_bf16_f32 v240, v32, v36
    v_cvt_pk_bf16_f32 v241, v40, v44
    v_cvt_pk_bf16_f32 v242, v48, v52
    v_cvt_pk_bf16_f32 v243, v56, v60
    buffer_store_dwordx4 v[240:243], v249, s[12:15], s39 offen sc1
    s_add_u32 s39, s39, 2736128
    v_cvt_pk_bf16_f32 v244, v33, v37
    v_cvt_pk_bf16_f32 v245, v41, v45
    v_cvt_pk_bf16_f32 v246, v49, v53
    v_cvt_pk_bf16_f32 v247, v57, v61
    buffer_store_dwordx4 v[244:247], v249, s[12:15], s39 offen sc1
    s_add_u32 s39, s39, 2736128
    v_cvt_pk_bf16_f32 v240, v34, v38
    v_cvt_pk_bf16_f32 v241, v42, v46
    v_cvt_pk_bf16_f32 v242, v50, v54
    v_cvt_pk_bf16_f32 v243, v58, v62
    buffer_store_dwordx4 v[240:243], v249, s[12:15], s39 offen sc1
    s_add_u32 s39, s39, 2736128
    v_cvt_pk_bf16_f32 v244, v35, v39
    v_cvt_pk_bf16_f32 v245, v43, v47
    v_cvt_pk_bf16_f32 v246, v51, v55
    v_cvt_pk_bf16_f32 v247, v59, v63
    buffer_store_dwordx4 v[244:247], v249, s[12:15], s39 offen sc1
    s_add_u32 s39, s39, 2736128
    s_cmp_lt_u32 s40, 4
    s_cbranch_scc1 K12_UT4
    s_lshl_b32 s36, s40, 3
    s_sub_i32 s36, s36, 20
    s_max_i32 s36, s36, 1
    s_mov_b32 s37, 131072
K12_UL4:
    v_mov_b32 v255, 155648
    ds_read_b32 v255, v255
    s_waitcnt lgkmcnt(0)
    v_cmp_gt_u32 vcc, s36, v255
    s_sub_u32 s37, s37, 1
    s_cmp_eq_u32 s37, 0
    s_cbranch_scc1 K12_UT4
    s_cbranch_vccz K12_UT4
    s_sleep 2
    s_branch K12_UL4
K12_UT4:
    s_setprio 1
    v_mfma_f32_16x16x32_bf16 v[32:35], v[176:179], v[64:67], 0
    v_mfma_f32_16x16x32_bf16 v[36:39], v[176:179], v[68:71], 0
    v_mfma_f32_16x16x32_bf16 v[40:43], v[176:179], v[72:75], 0
    v_mfma_f32_16x16x32_bf16 v[44:47], v[176:179], v[76:79], 0
    v_mfma_f32_16x16x32_bf16 v[48:51], v[176:179], v[80:83], 0
    v_mfma_f32_16x16x32_bf16 v[52:55], v[176:179], v[84:87], 0
    v_mfma_f32_16x16x32_bf16 v[56:59], v[176:179], v[88:91], 0
    v_mfma_f32_16x16x32_bf16 v[60:63], v[176:179], v[92:95], 0
    v_mfma_f32_16x16x32_bf16 v[32:35], v[208:211], v[64:67], v[32:35]
    v_mfma_f32_16x16x32_bf16 v[36:39], v[208:211], v[68:71], v[36:39]
    v_mfma_f32_16x16x32_bf16 v[40:43], v[208:211], v[72:75], v[40:43]
    v_mfma_f32_16x16x32_bf16 v[44:47], v[208:211], v[76:79], v[44:47]
    v_mfma_f32_16x16x32_bf16 v[48:51], v[208:211], v[80:83], v[48:51]
    v_mfma_f32_16x16x32_bf16 v[52:55], v[208:211], v[84:87], v[52:55]
    v_mfma_f32_16x16x32_bf16 v[56:59], v[208:211], v[88:91], v[56:59]
    v_mfma_f32_16x16x32_bf16 v[60:63], v[208:211], v[92:95], v[60:63]
    v_mfma_f32_16x16x32_bf16 v[32:35], v[180:183], v[0:3], v[32:35]
    v_mfma_f32_16x16x32_bf16 v[36:39], v[180:183], v[4:7], v[36:39]
    v_mfma_f32_16x16x32_bf16 v[40:43], v[180:183], v[8:11], v[40:43]
    v_mfma_f32_16x16x32_bf16 v[44:47], v[180:183], v[12:15], v[44:47]
    v_mfma_f32_16x16x32_bf16 v[48:51], v[180:183], v[16:19], v[48:51]
    v_mfma_f32_16x16x32_bf16 v[52:55], v[180:183], v[20:23], v[52:55]
    v_mfma_f32_16x16x32_bf16 v[56:59], v[180:183], v[24:27], v[56:59]
    v_mfma_f32_16x16x32_bf16 v[60:63], v[180:183], v[28:31], v[60:63]
    v_mfma_f32_16x16x32_bf16 v[32:35], v[212:215], v[0:3], v[32:35]
    v_mfma_f32_16x16x32_bf16 v[36:39], v[212:215], v[4:7], v[36:39]
    v_mfma_f32_16x16x32_bf16 v[40:43], v[212:215], v[8:11], v[40:43]
    v_mfma_f32_16x16x32_bf16 v[44:47], v[212:215], v[12:15], v[44:47]
    v_mfma_f32_16x16x32_bf16 v[48:51], v[212:215], v[16:19], v[48:51]
    v_mfma_f32_16x16x32_bf16 v[52:55], v[212:215], v[20:23], v[52:55]
    v_mfma_f32_16x16x32_bf16 v[56:59], v[212:215], v[24:27], v[56:59]
    v_mfma_f32_16x16x32_bf16 v[60:63], v[212:215], v[28:31], v[60:63]
    s_setprio 0
    s_nop 7
    v_cvt_pk_bf16_f32 v240, v32, v36
    v_cvt_pk_bf16_f32 v241, v40, v44
    v_cvt_pk_bf16_f32 v242, v48, v52
    v_cvt_pk_bf16_f32 v243, v56, v60
    buffer_store_dwordx4 v[240:243], v249, s[12:15], s39 offen sc1
    s_add_u32 s39, s39, 2736128
    v_cvt_pk_bf16_f32 v244, v33, v37
    v_cvt_pk_bf16_f32 v245, v41, v45
    v_cvt_pk_bf16_f32 v246, v49, v53
    v_cvt_pk_bf16_f32 v247, v57, v61
    buffer_store_dwordx4 v[244:247], v249, s[12:15], s39 offen sc1
    s_add_u32 s39, s39, 2736128
    v_cvt_pk_bf16_f32 v240, v34, v38
    v_cvt_pk_bf16_f32 v241, v42, v46
    v_cvt_pk_bf16_f32 v242, v50, v54
    v_cvt_pk_bf16_f32 v243, v58, v62
    buffer_store_dwordx4 v[240:243], v249, s[12:15], s39 offen sc1
    s_add_u32 s39, s39, 2736128
    v_cvt_pk_bf16_f32 v244, v35, v39
    v_cvt_pk_bf16_f32 v245, v43, v47
    v_cvt_pk_bf16_f32 v246, v51, v55
    v_cvt_pk_bf16_f32 v247, v59, v63
    buffer_store_dwordx4 v[244:247], v249, s[12:15], s39 offen sc1
    s_add_u32 s39, s39, 2736128
    s_cmp_lt_u32 s40, 4
    s_cbranch_scc1 K12_UT5
    s_lshl_b32 s36, s40, 3
    s_sub_i32 s36, s36, 18
    s_max_i32 s36, s36, 1
    s_mov_b32 s37, 131072
K12_UL5:
    v_mov_b32 v255, 155648
    ds_read_b32 v255, v255
    s_waitcnt lgkmcnt(0)
    v_cmp_gt_u32 vcc, s36, v255
    s_sub_u32 s37, s37, 1
    s_cmp_eq_u32 s37, 0
    s_cbranch_scc1 K12_UT5
    s_cbranch_vccz K12_UT5
    s_sleep 2
    s_branch K12_UL5
K12_UT5:
    s_setprio 1
    v_mfma_f32_16x16x32_bf16 v[32:35], v[184:187], v[64:67], 0
    v_mfma_f32_16x16x32_bf16 v[36:39], v[184:187], v[68:71], 0
    v_mfma_f32_16x16x32_bf16 v[40:43], v[184:187], v[72:75], 0
    v_mfma_f32_16x16x32_bf16 v[44:47], v[184:187], v[76:79], 0
    v_mfma_f32_16x16x32_bf16 v[48:51], v[184:187], v[80:83], 0
    v_mfma_f32_16x16x32_bf16 v[52:55], v[184:187], v[84:87], 0
    v_mfma_f32_16x16x32_bf16 v[56:59], v[184:187], v[88:91], 0
    v_mfma_f32_16x16x32_bf16 v[60:63], v[184:187], v[92:95], 0
    v_mfma_f32_16x16x32_bf16 v[32:35], v[216:219], v[64:67], v[32:35]
    v_mfma_f32_16x16x32_bf16 v[36:39], v[216:219], v[68:71], v[36:39]
    v_mfma_f32_16x16x32_bf16 v[40:43], v[216:219], v[72:75], v[40:43]
    v_mfma_f32_16x16x32_bf16 v[44:47], v[216:219], v[76:79], v[44:47]
    v_mfma_f32_16x16x32_bf16 v[48:51], v[216:219], v[80:83], v[48:51]
    v_mfma_f32_16x16x32_bf16 v[52:55], v[216:219], v[84:87], v[52:55]
    v_mfma_f32_16x16x32_bf16 v[56:59], v[216:219], v[88:91], v[56:59]
    v_mfma_f32_16x16x32_bf16 v[60:63], v[216:219], v[92:95], v[60:63]
    v_mfma_f32_16x16x32_bf16 v[32:35], v[188:191], v[0:3], v[32:35]
    v_mfma_f32_16x16x32_bf16 v[36:39], v[188:191], v[4:7], v[36:39]
    v_mfma_f32_16x16x32_bf16 v[40:43], v[188:191], v[8:11], v[40:43]
    v_mfma_f32_16x16x32_bf16 v[44:47], v[188:191], v[12:15], v[44:47]
    v_mfma_f32_16x16x32_bf16 v[48:51], v[188:191], v[16:19], v[48:51]
    v_mfma_f32_16x16x32_bf16 v[52:55], v[188:191], v[20:23], v[52:55]
    v_mfma_f32_16x16x32_bf16 v[56:59], v[188:191], v[24:27], v[56:59]
    v_mfma_f32_16x16x32_bf16 v[60:63], v[188:191], v[28:31], v[60:63]
    v_mfma_f32_16x16x32_bf16 v[32:35], v[220:223], v[0:3], v[32:35]
    v_mfma_f32_16x16x32_bf16 v[36:39], v[220:223], v[4:7], v[36:39]
    v_mfma_f32_16x16x32_bf16 v[40:43], v[220:223], v[8:11], v[40:43]
    v_mfma_f32_16x16x32_bf16 v[44:47], v[220:223], v[12:15], v[44:47]
    v_mfma_f32_16x16x32_bf16 v[48:51], v[220:223], v[16:19], v[48:51]
    v_mfma_f32_16x16x32_bf16 v[52:55], v[220:223], v[20:23], v[52:55]
    v_mfma_f32_16x16x32_bf16 v[56:59], v[220:223], v[24:27], v[56:59]
    v_mfma_f32_16x16x32_bf16 v[60:63], v[220:223], v[28:31], v[60:63]
    s_setprio 0
    s_nop 7
    v_cvt_pk_bf16_f32 v240, v32, v36
    v_cvt_pk_bf16_f32 v241, v40, v44
    v_cvt_pk_bf16_f32 v242, v48, v52
    v_cvt_pk_bf16_f32 v243, v56, v60
    buffer_store_dwordx4 v[240:243], v249, s[12:15], s39 offen sc1
    s_add_u32 s39, s39, 2736128
    v_cvt_pk_bf16_f32 v244, v33, v37
    v_cvt_pk_bf16_f32 v245, v41, v45
    v_cvt_pk_bf16_f32 v246, v49, v53
    v_cvt_pk_bf16_f32 v247, v57, v61
    buffer_store_dwordx4 v[244:247], v249, s[12:15], s39 offen sc1
    s_add_u32 s39, s39, 2736128
    v_cvt_pk_bf16_f32 v240, v34, v38
    v_cvt_pk_bf16_f32 v241, v42, v46
    v_cvt_pk_bf16_f32 v242, v50, v54
    v_cvt_pk_bf16_f32 v243, v58, v62
    buffer_store_dwordx4 v[240:243], v249, s[12:15], s39 offen sc1
    s_add_u32 s39, s39, 2736128
    v_cvt_pk_bf16_f32 v244, v35, v39
    v_cvt_pk_bf16_f32 v245, v43, v47
    v_cvt_pk_bf16_f32 v246, v51, v55
    v_cvt_pk_bf16_f32 v247, v59, v63
    buffer_store_dwordx4 v[244:247], v249, s[12:15], s39 offen sc1
K12_H2:
    s_mov_b64 exec, 1
    v_mov_b32 v255, 155664
    v_mov_b32 v64, 1
    ds_add_u32 v255, v64
    s_mov_b64 exec, -1
    s_waitcnt vmcnt(0)
    s_mov_b32 s41, 0
    s_mov_b32 s34, -1
    s_cmp_ge_u32 s41, 8
    s_cbranch_scc1 K12_SG0
    s_lshl_b32 s36, s41, 2
    s_add_u32 s37, s36, 155680
    s_mov_b64 exec, 1
    v_mov_b32 v255, s37
    v_mov_b32 v240, 1
    ds_add_rtn_u32 v240, v255, v240
    s_waitcnt lgkmcnt(0)
    v_readfirstlane_b32 s37, v240
    s_nop 3
    s_cmp_eq_u32 s37, 3
    s_cbranch_scc0 K12_SH0
    s_lshl_b32 s36, s36, 8
    v_mov_b32 v255, 1
    v_mov_b32 v240, s36
    buffer_atomic_add v255, v240, s[60:63], 0 offen sc0 sc1
    s_mov_b32 s34, s41
K12_SH0:
    s_mov_b64 exec, -1
K12_SG0:
    s_waitcnt vmcnt(0)
    s_cmp_ge_u32 s34, 8
    s_cbranch_scc1 K12_PB1
    v_readfirstlane_b32 s37, v255
    s_nop 3
    s_cmp_eq_u32 s37, 255
    s_cbranch_scc0 K12_PB1
    s_lshl_b32 s36, s34, 4
    s_add_u32 s36, s36, 16384
    s_mov_b64 exec, 1
    v_mov_b32 v255, 1
    v_mov_b32 v240, s36
    buffer_store_dword v255, v240, s[60:63], 0 offen sc1
    s_mov_b64 exec, -1
K12_PB1:
    s_branch K12_CONS
K12_PROD:
    s_mov_b32 s37, 131072
K12_TW:
    v_mov_b32 v240, 155648
    ds_read_b32 v240, v240
    s_waitcnt lgkmcnt(0)
    v_cmp_gt_u32 vcc, 2, v240
    s_sub_u32 s37, s37, 1
    s_cmp_eq_u32 s37, 0
    s_cbranch_scc1 K12_TX
    s_cbranch_vccz K12_TX
    s_sleep 2
    s_branch K12_TW
K12_TX:
    v_lshrrev_b32 v128, 4, v254
    v_lshlrev_b32 v129, 11, v128
    v_lshrrev_b32 v130, 1, v128
    v_lshlrev_b32 v130, 20, v130
    v_and_b32 v131, 1, v128
    v_lshl_add_u32 v130, v131, 7, v130
    s_mov_b32 s45, s27
    s_mov_b32 s46, s30
    s_add_u32 s47, s40, 1
K12_TCH0:
    s_xor_b32 s48, s47, s20
    s_and_b32 s48, s48, 1
    s_cmp_eq_u32 s48, 0
    s_cbranch_scc1 K12_TCHW0
    s_mul_i32 s36, s47, 85
    s_add_u32 s36, s36, s2
    s_and_b32 s36, s36, 255
    s_mul_hi_u32 s37, s36, 0x55555556
    s_mul_i32 s38, s37, 3
    s_cmp_eq_u32 s38, s36
    s_cselect_b32 s27, 1, 0
    s_cmp_lt_u32 s37, 78
    s_cselect_b32 s27, s27, 0
    s_add_u32 s37, s37, 89
    s_cmp_eq_u32 s21, 0
    s_cselect_b32 s30, s24, s37
    s_cselect_b32 s27, 1, s27
    s_cmp_eq_u32 s27, 0
    s_cbranch_scc1 K12_TCHN0
    s_lshl_b32 s36, s47, 8
    s_mul_i32 s37, s30, 98304
    s_add_u32 s36, s36, s37
    buffer_load_dword v244, v129, s[4:7], s36 offen
    buffer_load_dword v245, v129, s[4:7], s36 offen offset:128
    s_branch K12_TCHN0
K12_TCHW0:
    s_lshl_b32 s36, s47, 7
    s_add_u32 s36, s36, s22
    s_lshr_b32 s37, s36, 9
    s_lshl_b32 s37, s37, 19
    s_and_b32 s36, s36, 511
    s_lshl_b32 s36, s36, 10
    s_add_u32 s36, s36, s37
    s_add_u32 s36, s36, s33
    s_mov_b64 exec, 0xffffffff
    buffer_load_dword v246, v130, s[8:11], s36 offen
    s_mov_b64 exec, -1
K12_TCHN0:
    s_add_u32 s47, s47, 1
    s_cmp_lt_u32 s47, 8
    s_cbranch_scc1 K12_TCH0
    s_mov_b32 s27, s45
    s_mov_b32 s30, s46
    s_cmp_eq_u32 s43, 0
    s_cbranch_scc1 K12_WENTRY
K12_XW:
    s_waitcnt vmcnt(0)
    s_mov_b32 s34, -1
    s_cmp_ge_u32 s41, 8
    s_cbranch_scc1 K12_SG2
    s_lshl_b32 s36, s41, 2
    s_add_u32 s37, s36, 155680
    s_mov_b64 exec, 1
    v_mov_b32 v255, s37
    v_mov_b32 v240, 1
    ds_add_rtn_u32 v240, v255, v240
    s_waitcnt lgkmcnt(0)
    v_readfirstlane_b32 s37, v240
    s_nop 3
    s_cmp_eq_u32 s37, 3
    s_cbranch_scc0 K12_SH2
    s_lshl_b32 s36, s36, 8
    v_mov_b32 v255, 1
    v_mov_b32 v240, s36
    buffer_atomic_add v255, v240, s[60:63], 0 offen sc0 sc1
    s_mov_b32 s34, s41
K12_SH2:
    s_mov_b64 exec, -1
K12_SG2:
    s_cmp_ge_u32 s34, 8
    s_cbranch_scc1 K12_EP3
    s_waitcnt vmcnt(0)
    s_cmp_ge_u32 s34, 8
    s_cbranch_scc1 K12_PB4
    v_readfirstlane_b32 s37, v255
    s_nop 3
    s_cmp_eq_u32 s37, 255
    s_cbranch_scc0 K12_PB4
    s_lshl_b32 s36, s34, 4
    s_add_u32 s36, s36, 16384
    s_mov_b64 exec, 1
    v_mov_b32 v255, 1
    v_mov_b32 v240, s36
    buffer_store_dword v255, v240, s[60:63], 0 offen sc1
    s_mov_b64 exec, -1
K12_PB4:
    s_mov_b32 s34, -1
K12_EP3:
    s_cmp_eq_u32 s27, 0
    s_cbranch_scc1 K12_XP_N
    v_perm_b32 v64, v4, v0, s28
    v_perm_b32 v68, v4, v0, s29
    v_perm_b32 v65, v12, v8, s28
    v_perm_b32 v69, v12, v8, s29
    v_perm_b32 v66, v20, v16, s28
    v_perm_b32 v70, v20, v16, s29
    v_perm_b32 v67, v28, v24, s28
    v_perm_b32 v71, v28, v24, s29
    v_perm_b32 v72, v5, v1, s28
    v_perm_b32 v76, v5, v1, s29
    v_perm_b32 v73, v13, v9, s28
    v_perm_b32 v77, v13, v9, s29
    v_perm_b32 v74, v21, v17, s28
    v_perm_b32 v78, v21, v17, s29
    v_perm_b32 v75, v29, v25, s28
    v_perm_b32 v79, v29, v25, s29
    v_perm_b32 v80, v6, v2, s28
    v_perm_b32 v84, v6, v2, s29
    v_perm_b32 v81, v14, v10, s28
    v_perm_b32 v85, v14, v10, s29
    v_perm_b32 v82, v22, v18, s28
    v_perm_b32 v86, v22, v18, s29
    v_perm_b32 v83, v30, v26, s28
    v_perm_b32 v87, v30, v26, s29
    v_perm_b32 v88, v7, v3, s28
    v_perm_b32 v92, v7, v3, s29
    v_perm_b32 v89, v15, v11, s28
    v_perm_b32 v93, v15, v11, s29
    v_perm_b32 v90, v23, v19, s28
    v_perm_b32 v94, v23, v19, s29
    v_perm_b32 v91, v31, v27, s28
    v_perm_b32 v95, v31, v27, s29
    v_perm_b32 v0, v36, v32, s28
    v_perm_b32 v4, v36, v32, s29
    v_perm_b32 v1, v44, v40, s28
    v_perm_b32 v5, v44, v40, s29
    v_perm_b32 v2, v52, v48, s28
    v_perm_b32 v6, v52, v48, s29
    v_perm_b32 v3, v60, v56, s28
    v_perm_b32 v7, v60, v56, s29
    v_perm_b32 v8, v37, v33, s28
    v_perm_b32 v12, v37, v33, s29
    v_perm_b32 v9, v45, v41, s28
    v_perm_b32 v13, v45, v41, s29
    v_perm_b32 v10, v53, v49, s28
    v_perm_b32 v14, v53, v49, s29
    v_perm_b32 v11, v61, v57, s28
    v_perm_b32 v15, v61, v57, s29
    v_perm_b32 v16, v38, v34, s28
    v_perm_b32 v20, v38, v34, s29
    v_perm_b32 v17, v46, v42, s28
    v_perm_b32 v21, v46, v42, s29
    v_perm_b32 v18, v54, v50, s28
    v_perm_b32 v22, v54, v50, s29
    v_perm_b32 v19, v62, v58, s28
    v_perm_b32 v23, v62, v58, s29
    v_perm_b32 v24, v39, v35, s28
    v_perm_b32 v28, v39, v35, s29
    v_perm_b32 v25, v47, v43, s28
    v_perm_b32 v29, v47, v43, s29
    v_perm_b32 v26, v55, v51, s28
    v_perm_b32 v30, v55, v51, s29
    v_perm_b32 v27, v63, v59, s28
    v_perm_b32 v31, v63, v59, s29
K12_XP_N:
    s_lshl_b32 s36, s40, 3
    s_sub_i32 s36, s36, 24
    s_max_i32 s36, s36, 1
    s_mov_b32 s37, 131072
K12_GL0:
    v_mov_b32 v240, 155648
    ds_read_b32 v240, v240
    s_waitcnt lgkmcnt(0)
    v_cmp_gt_u32 vcc, s36, v240
    s_sub_u32 s37, s37, 1
    s_cmp_eq_u32 s37, 0
    s_cbranch_scc1 K12_GT0
    s_cbranch_vccz K12_GT0
    s_sleep 2
    s_branch K12_GL0
K12_GT0:
    s_lshl_b32 s36, s40, 2
    s_add_u32 s36, s36, 155840
    s_mov_b64 exec, 1
    v_mov_b32 v240, s36
    v_mov_b32 v241, 1
    ds_add_u32 v240, v241
    s_mov_b64 exec, -1
    s_mov_b32 s37, 131072
K12_BL0:
    v_mov_b32 v240, s36
    ds_read_b32 v240, v240
    s_waitcnt lgkmcnt(0)
    v_cmp_gt_u32 vcc, 4, v240
    s_sub_u32 s37, s37, 1
    s_cmp_eq_u32 s37, 0
    s_cbranch_scc1 K12_BT0
    s_cbranch_vccz K12_BT0
    s_sleep 1
    s_branch K12_BL0
K12_BT0:
    s_add_u32 s42, s40, 1
    s_lshl_b32 s36, s42, 7
    s_add_u32 s36, s36, s22
    s_lshr_b32 s37, s36, 9
    s_lshl_b32 s37, s37, 19
    s_and_b32 s36, s36, 511
    s_lshl_b32 s36, s36, 10
    s_add_u32 s36, s36, s37
    s_add_u32 s36, s36, s33
    buffer_load_dwordx4 v[96:99], v250, s[8:11], s36 offen
    s_add_u32 s36, s36, 0x100000
    buffer_load_dwordx4 v[100:103], v250, s[8:11], s36 offen
    s_add_u32 s36, s36, 0x100000
    buffer_load_dwordx4 v[104:107], v250, s[8:11], s36 offen
    s_add_u32 s36, s36, 0x100000
    buffer_load_dwordx4 v[108:111], v250, s[8:11], s36 offen
    s_add_u32 s36, s36, 0x100000
    buffer_load_dwordx4 v[112:115], v250, s[8:11], s36 offen
    s_add_u32 s36, s36, 0x100000
    buffer_load_dwordx4 v[116:119], v250, s[8:11], s36 offen
    s_add_u32 s36, s36, 0x100000
    buffer_load_dwordx4 v[120:123], v250, s[8:11], s36 offen
    s_add_u32 s36, s36, 0x100000
    buffer_load_dwordx4 v[124:127], v250, s[8:11], s36 offen
    s_cmp_eq_u32 s27, 0
    s_cbranch_scc1 K12_XP_E
    s_mul_i32 s39, s40, 85504
    s_add_u32 s39, s39, s31
    s_lshl_b32 s36, s30, 7
    s_add_u32 s39, s39, s36
    v_bfe_u32 v249, v254, 4, 2
    v_bfe_u32 v240, v254, 8, 1
    v_lshl_add_u32 v249, v240, 2, v249
    s_add_u32 s36, s30, 7
    s_cmp_ge_u32 s30, 160
    s_cselect_b32 s36, s36, s30
    s_cmp_eq_u32 s25, 1
    s_cselect_b32 s36, s36, s30
    s_lshr_b32 s36, s36, 1
    s_and_b32 s36, s36, 7
    v_xor_b32 v249, s36, v249
    v_lshl_add_u32 v249, v249, 4, v252
    s_setprio 1
    v_mfma_f32_16x16x32_bf16 v[32:35], v[160:163], v[64:67], 0
    v_mfma_f32_16x16x32_bf16 v[36:39], v[160:163], v[68:71], 0
    v_mfma_f32_16x16x32_bf16 v[40:43], v[160:163], v[72:75], 0
    v_mfma_f32_16x16x32_bf16 v[44:47], v[160:163], v[76:79], 0
    v_mfma_f32_16x16x32_bf16 v[48:51], v[160:163], v[80:83], 0
    v_mfma_f32_16x16x32_bf16 v[52:55], v[160:163], v[84:87], 0
    v_mfma_f32_16x16x32_bf16 v[56:59], v[160:163], v[88:91], 0
    v_mfma_f32_16x16x32_bf16 v[60:63], v[160:163], v[92:95], 0
    v_mfma_f32_16x16x32_bf16 v[32:35], v[192:195], v[64:67], v[32:35]
    v_mfma_f32_16x16x32_bf16 v[36:39], v[192:195], v[68:71], v[36:39]
    v_mfma_f32_16x16x32_bf16 v[40:43], v[192:195], v[72:75], v[40:43]
    v_mfma_f32_16x16x32_bf16 v[44:47], v[192:195], v[76:79], v[44:47]
    v_mfma_f32_16x16x32_bf16 v[48:51], v[192:195], v[80:83], v[48:51]
    v_mfma_f32_16x16x32_bf16 v[52:55], v[192:195], v[84:87], v[52:55]
    v_mfma_f32_16x16x32_bf16 v[56:59], v[192:195], v[88:91], v[56:59]
    v_mfma_f32_16x16x32_bf16 v[60:63], v[192:195], v[92:95], v[60:63]
    v_mfma_f32_16x16x32_bf16 v[32:35], v[164:167], v[0:3], v[32:35]
    v_mfma_f32_16x16x32_bf16 v[36:39], v[164:167], v[4:7], v[36:39]
    v_mfma_f32_16x16x32_bf16 v[40:43], v[164:167], v[8:11], v[40:43]
    v_mfma_f32_16x16x32_bf16 v[44:47], v[164:167], v[12:15], v[44:47]
    v_mfma_f32_16x16x32_bf16 v[48:51], v[164:167], v[16:19], v[48:51]
    v_mfma_f32_16x16x32_bf16 v[52:55], v[164:167], v[20:23], v[52:55]
    v_mfma_f32_16x16x32_bf16 v[56:59], v[164:167], v[24:27], v[56:59]
    v_mfma_f32_16x16x32_bf16 v[60:63], v[164:167], v[28:31], v[60:63]
    v_mfma_f32_16x16x32_bf16 v[32:35], v[196:199], v[0:3], v[32:35]
    v_mfma_f32_16x16x32_bf16 v[36:39], v[196:199], v[4:7], v[36:39]
    v_mfma_f32_16x16x32_bf16 v[40:43], v[196:199], v[8:11], v[40:43]
    v_mfma_f32_16x16x32_bf16 v[44:47], v[196:199], v[12:15], v[44:47]
    v_mfma_f32_16x16x32_bf16 v[48:51], v[196:199], v[16:19], v[48:51]
    v_mfma_f32_16x16x32_bf16 v[52:55], v[196:199], v[20:23], v[52:55]
    v_mfma_f32_16x16x32_bf16 v[56:59], v[196:199], v[24:27], v[56:59]
    v_mfma_f32_16x16x32_bf16 v[60:63], v[196:199], v[28:31], v[60:63]
    s_setprio 0
    s_nop 7
    v_cvt_pk_bf16_f32 v240, v32, v36
    v_cvt_pk_bf16_f32 v241, v40, v44
    v_cvt_pk_bf16_f32 v242, v48, v52
    v_cvt_pk_bf16_f32 v243, v56, v60
    buffer_store_dwordx4 v[240:243], v249, s[12:15], s39 offen sc1
    s_add_u32 s39, s39, 2736128
    v_cvt_pk_bf16_f32 v244, v33, v37
    v_cvt_pk_bf16_f32 v245, v41, v45
    v_cvt_pk_bf16_f32 v246, v49, v53
    v_cvt_pk_bf16_f32 v247, v57, v61
    buffer_store_dwordx4 v[244:247], v249, s[12:15], s39 offen sc1
    s_add_u32 s39, s39, 2736128
    v_cvt_pk_bf16_f32 v240, v34, v38
    v_cvt_pk_bf16_f32 v241, v42, v46
    v_cvt_pk_bf16_f32 v242, v50, v54
    v_cvt_pk_bf16_f32 v243, v58, v62
    buffer_store_dwordx4 v[240:243], v249, s[12:15], s39 offen sc1
    s_add_u32 s39, s39, 2736128
    v_cvt_pk_bf16_f32 v244, v35, v39
    v_cvt_pk_bf16_f32 v245, v43, v47
    v_cvt_pk_bf16_f32 v246, v51, v55
    v_cvt_pk_bf16_f32 v247, v59, v63
    buffer_store_dwordx4 v[244:247], v249, s[12:15], s39 offen sc1
    s_add_u32 s39, s39, 2736128
    s_cmp_lt_u32 s40, 4
    s_cbranch_scc1 K12_UT6
    s_lshl_b32 s36, s40, 3
    s_sub_i32 s36, s36, 22
    s_max_i32 s36, s36, 1
    s_mov_b32 s37, 131072
K12_UL6:
    v_mov_b32 v255, 155648
    ds_read_b32 v255, v255
    s_waitcnt lgkmcnt(0)
    v_cmp_gt_u32 vcc, s36, v255
    s_sub_u32 s37, s37, 1
    s_cmp_eq_u32 s37, 0
    s_cbranch_scc1 K12_UT6
    s_cbranch_vccz K12_UT6
    s_sleep 2
    s_branch K12_UL6
K12_UT6:
    s_setprio 1
    v_mfma_f32_16x16x32_bf16 v[32:35], v[168:171], v[64:67], 0
    v_mfma_f32_16x16x32_bf16 v[36:39], v[168:171], v[68:71], 0
    v_mfma_f32_16x16x32_bf16 v[40:43], v[168:171], v[72:75], 0
    v_mfma_f32_16x16x32_bf16 v[44:47], v[168:171], v[76:79], 0
    v_mfma_f32_16x16x32_bf16 v[48:51], v[168:171], v[80:83], 0
    v_mfma_f32_16x16x32_bf16 v[52:55], v[168:171], v[84:87], 0
    v_mfma_f32_16x16x32_bf16 v[56:59], v[168:171], v[88:91], 0
    v_mfma_f32_16x16x32_bf16 v[60:63], v[168:171], v[92:95], 0
    v_mfma_f32_16x16x32_bf16 v[32:35], v[200:203], v[64:67], v[32:35]
    v_mfma_f32_16x16x32_bf16 v[36:39], v[200:203], v[68:71], v[36:39]
    v_mfma_f32_16x16x32_bf16 v[40:43], v[200:203], v[72:75], v[40:43]
    v_mfma_f32_16x16x32_bf16 v[44:47], v[200:203], v[76:79], v[44:47]
    v_mfma_f32_16x16x32_bf16 v[48:51], v[200:203], v[80:83], v[48:51]
    v_mfma_f32_16x16x32_bf16 v[52:55], v[200:203], v[84:87], v[52:55]
    v_mfma_f32_16x16x32_bf16 v[56:59], v[200:203], v[88:91], v[56:59]
    v_mfma_f32_16x16x32_bf16 v[60:63], v[200:203], v[92:95], v[60:63]
    v_mfma_f32_16x16x32_bf16 v[32:35], v[172:175], v[0:3], v[32:35]
    v_mfma_f32_16x16x32_bf16 v[36:39], v[172:175], v[4:7], v[36:39]
    v_mfma_f32_16x16x32_bf16 v[40:43], v[172:175], v[8:11], v[40:43]
    v_mfma_f32_16x16x32_bf16 v[44:47], v[172:175], v[12:15], v[44:47]
    v_mfma_f32_16x16x32_bf16 v[48:51], v[172:175], v[16:19], v[48:51]
    v_mfma_f32_16x16x32_bf16 v[52:55], v[172:175], v[20:23], v[52:55]
    v_mfma_f32_16x16x32_bf16 v[56:59], v[172:175], v[24:27], v[56:59]
    v_mfma_f32_16x16x32_bf16 v[60:63], v[172:175], v[28:31], v[60:63]
    v_mfma_f32_16x16x32_bf16 v[32:35], v[204:207], v[0:3], v[32:35]
    v_mfma_f32_16x16x32_bf16 v[36:39], v[204:207], v[4:7], v[36:39]
    v_mfma_f32_16x16x32_bf16 v[40:43], v[204:207], v[8:11], v[40:43]
    v_mfma_f32_16x16x32_bf16 v[44:47], v[204:207], v[12:15], v[44:47]
    v_mfma_f32_16x16x32_bf16 v[48:51], v[204:207], v[16:19], v[48:51]
    v_mfma_f32_16x16x32_bf16 v[52:55], v[204:207], v[20:23], v[52:55]
    v_mfma_f32_16x16x32_bf16 v[56:59], v[204:207], v[24:27], v[56:59]
    v_mfma_f32_16x16x32_bf16 v[60:63], v[204:207], v[28:31], v[60:63]
    s_setprio 0
    s_nop 7
    v_cvt_pk_bf16_f32 v240, v32, v36
    v_cvt_pk_bf16_f32 v241, v40, v44
    v_cvt_pk_bf16_f32 v242, v48, v52
    v_cvt_pk_bf16_f32 v243, v56, v60
    buffer_store_dwordx4 v[240:243], v249, s[12:15], s39 offen sc1
    s_add_u32 s39, s39, 2736128
    v_cvt_pk_bf16_f32 v244, v33, v37
    v_cvt_pk_bf16_f32 v245, v41, v45
    v_cvt_pk_bf16_f32 v246, v49, v53
    v_cvt_pk_bf16_f32 v247, v57, v61
    buffer_store_dwordx4 v[244:247], v249, s[12:15], s39 offen sc1
    s_add_u32 s39, s39, 2736128
    v_cvt_pk_bf16_f32 v240, v34, v38
    v_cvt_pk_bf16_f32 v241, v42, v46
    v_cvt_pk_bf16_f32 v242, v50, v54
    v_cvt_pk_bf16_f32 v243, v58, v62
    buffer_store_dwordx4 v[240:243], v249, s[12:15], s39 offen sc1
    s_add_u32 s39, s39, 2736128
    v_cvt_pk_bf16_f32 v244, v35, v39
    v_cvt_pk_bf16_f32 v245, v43, v47
    v_cvt_pk_bf16_f32 v246, v51, v55
    v_cvt_pk_bf16_f32 v247, v59, v63
    buffer_store_dwordx4 v[244:247], v249, s[12:15], s39 offen sc1
    s_add_u32 s39, s39, 2736128
    s_cmp_lt_u32 s40, 4
    s_cbranch_scc1 K12_UT7
    s_lshl_b32 s36, s40, 3
    s_sub_i32 s36, s36, 20
    s_max_i32 s36, s36, 1
    s_mov_b32 s37, 131072
K12_UL7:
    v_mov_b32 v255, 155648
    ds_read_b32 v255, v255
    s_waitcnt lgkmcnt(0)
    v_cmp_gt_u32 vcc, s36, v255
    s_sub_u32 s37, s37, 1
    s_cmp_eq_u32 s37, 0
    s_cbranch_scc1 K12_UT7
    s_cbranch_vccz K12_UT7
    s_sleep 2
    s_branch K12_UL7
K12_UT7:
    s_setprio 1
    v_mfma_f32_16x16x32_bf16 v[32:35], v[176:179], v[64:67], 0
    v_mfma_f32_16x16x32_bf16 v[36:39], v[176:179], v[68:71], 0
    v_mfma_f32_16x16x32_bf16 v[40:43], v[176:179], v[72:75], 0
    v_mfma_f32_16x16x32_bf16 v[44:47], v[176:179], v[76:79], 0
    v_mfma_f32_16x16x32_bf16 v[48:51], v[176:179], v[80:83], 0
    v_mfma_f32_16x16x32_bf16 v[52:55], v[176:179], v[84:87], 0
    v_mfma_f32_16x16x32_bf16 v[56:59], v[176:179], v[88:91], 0
    v_mfma_f32_16x16x32_bf16 v[60:63], v[176:179], v[92:95], 0
    v_mfma_f32_16x16x32_bf16 v[32:35], v[208:211], v[64:67], v[32:35]
    v_mfma_f32_16x16x32_bf16 v[36:39], v[208:211], v[68:71], v[36:39]
    v_mfma_f32_16x16x32_bf16 v[40:43], v[208:211], v[72:75], v[40:43]
    v_mfma_f32_16x16x32_bf16 v[44:47], v[208:211], v[76:79], v[44:47]
    v_mfma_f32_16x16x32_bf16 v[48:51], v[208:211], v[80:83], v[48:51]
    v_mfma_f32_16x16x32_bf16 v[52:55], v[208:211], v[84:87], v[52:55]
    v_mfma_f32_16x16x32_bf16 v[56:59], v[208:211], v[88:91], v[56:59]
    v_mfma_f32_16x16x32_bf16 v[60:63], v[208:211], v[92:95], v[60:63]
    v_mfma_f32_16x16x32_bf16 v[32:35], v[180:183], v[0:3], v[32:35]
    v_mfma_f32_16x16x32_bf16 v[36:39], v[180:183], v[4:7], v[36:39]
    v_mfma_f32_16x16x32_bf16 v[40:43], v[180:183], v[8:11], v[40:43]
    v_mfma_f32_16x16x32_bf16 v[44:47], v[180:183], v[12:15], v[44:47]
    v_mfma_f32_16x16x32_bf16 v[48:51], v[180:183], v[16:19], v[48:51]
    v_mfma_f32_16x16x32_bf16 v[52:55], v[180:183], v[20:23], v[52:55]
    v_mfma_f32_16x16x32_bf16 v[56:59], v[180:183], v[24:27], v[56:59]
    v_mfma_f32_16x16x32_bf16 v[60:63], v[180:183], v[28:31], v[60:63]
    v_mfma_f32_16x16x32_bf16 v[32:35], v[212:215], v[0:3], v[32:35]
    v_mfma_f32_16x16x32_bf16 v[36:39], v[212:215], v[4:7], v[36:39]
    v_mfma_f32_16x16x32_bf16 v[40:43], v[212:215], v[8:11], v[40:43]
    v_mfma_f32_16x16x32_bf16 v[44:47], v[212:215], v[12:15], v[44:47]
    v_mfma_f32_16x16x32_bf16 v[48:51], v[212:215], v[16:19], v[48:51]
    v_mfma_f32_16x16x32_bf16 v[52:55], v[212:215], v[20:23], v[52:55]
    v_mfma_f32_16x16x32_bf16 v[56:59], v[212:215], v[24:27], v[56:59]
    v_mfma_f32_16x16x32_bf16 v[60:63], v[212:215], v[28:31], v[60:63]
    s_setprio 0
    s_nop 7
    v_cvt_pk_bf16_f32 v240, v32, v36
    v_cvt_pk_bf16_f32 v241, v40, v44
    v_cvt_pk_bf16_f32 v242, v48, v52
    v_cvt_pk_bf16_f32 v243, v56, v60
    buffer_store_dwordx4 v[240:243], v249, s[12:15], s39 offen sc1
    s_add_u32 s39, s39, 2736128
    v_cvt_pk_bf16_f32 v244, v33, v37
    v_cvt_pk_bf16_f32 v245, v41, v45
    v_cvt_pk_bf16_f32 v246, v49, v53
    v_cvt_pk_bf16_f32 v247, v57, v61
    buffer_store_dwordx4 v[244:247], v249, s[12:15], s39 offen sc1
    s_add_u32 s39, s39, 2736128
    v_cvt_pk_bf16_f32 v240, v34, v38
    v_cvt_pk_bf16_f32 v241, v42, v46
    v_cvt_pk_bf16_f32 v242, v50, v54
    v_cvt_pk_bf16_f32 v243, v58, v62
    buffer_store_dwordx4 v[240:243], v249, s[12:15], s39 offen sc1
    s_add_u32 s39, s39, 2736128
    v_cvt_pk_bf16_f32 v244, v35, v39
    v_cvt_pk_bf16_f32 v245, v43, v47
    v_cvt_pk_bf16_f32 v246, v51, v55
    v_cvt_pk_bf16_f32 v247, v59, v63
    buffer_store_dwordx4 v[244:247], v249, s[12:15], s39 offen sc1
    s_add_u32 s39, s39, 2736128
    s_cmp_lt_u32 s40, 4
    s_cbranch_scc1 K12_UT8
    s_lshl_b32 s36, s40, 3
    s_sub_i32 s36, s36, 18
    s_max_i32 s36, s36, 1
    s_mov_b32 s37, 131072
K12_UL8:
    v_mov_b32 v255, 155648
    ds_read_b32 v255, v255
    s_waitcnt lgkmcnt(0)
    v_cmp_gt_u32 vcc, s36, v255
    s_sub_u32 s37, s37, 1
    s_cmp_eq_u32 s37, 0
    s_cbranch_scc1 K12_UT8
    s_cbranch_vccz K12_UT8
    s_sleep 2
    s_branch K12_UL8
K12_UT8:
    s_setprio 1
    v_mfma_f32_16x16x32_bf16 v[32:35], v[184:187], v[64:67], 0
    v_mfma_f32_16x16x32_bf16 v[36:39], v[184:187], v[68:71], 0
    v_mfma_f32_16x16x32_bf16 v[40:43], v[184:187], v[72:75], 0
    v_mfma_f32_16x16x32_bf16 v[44:47], v[184:187], v[76:79], 0
    v_mfma_f32_16x16x32_bf16 v[48:51], v[184:187], v[80:83], 0
    v_mfma_f32_16x16x32_bf16 v[52:55], v[184:187], v[84:87], 0
    v_mfma_f32_16x16x32_bf16 v[56:59], v[184:187], v[88:91], 0
    v_mfma_f32_16x16x32_bf16 v[60:63], v[184:187], v[92:95], 0
    v_mfma_f32_16x16x32_bf16 v[32:35], v[216:219], v[64:67], v[32:35]
    v_mfma_f32_16x16x32_bf16 v[36:39], v[216:219], v[68:71], v[36:39]
    v_mfma_f32_16x16x32_bf16 v[40:43], v[216:219], v[72:75], v[40:43]
    v_mfma_f32_16x16x32_bf16 v[44:47], v[216:219], v[76:79], v[44:47]
    v_mfma_f32_16x16x32_bf16 v[48:51], v[216:219], v[80:83], v[48:51]
    v_mfma_f32_16x16x32_bf16 v[52:55], v[216:219], v[84:87], v[52:55]
    v_mfma_f32_16x16x32_bf16 v[56:59], v[216:219], v[88:91], v[56:59]
    v_mfma_f32_16x16x32_bf16 v[60:63], v[216:219], v[92:95], v[60:63]
    v_mfma_f32_16x16x32_bf16 v[32:35], v[188:191], v[0:3], v[32:35]
    v_mfma_f32_16x16x32_bf16 v[36:39], v[188:191], v[4:7], v[36:39]
    v_mfma_f32_16x16x32_bf16 v[40:43], v[188:191], v[8:11], v[40:43]
    v_mfma_f32_16x16x32_bf16 v[44:47], v[188:191], v[12:15], v[44:47]
    v_mfma_f32_16x16x32_bf16 v[48:51], v[188:191], v[16:19], v[48:51]
    v_mfma_f32_16x16x32_bf16 v[52:55], v[188:191], v[20:23], v[52:55]
    v_mfma_f32_16x16x32_bf16 v[56:59], v[188:191], v[24:27], v[56:59]
    v_mfma_f32_16x16x32_bf16 v[60:63], v[188:191], v[28:31], v[60:63]
    v_mfma_f32_16x16x32_bf16 v[32:35], v[220:223], v[0:3], v[32:35]
    v_mfma_f32_16x16x32_bf16 v[36:39], v[220:223], v[4:7], v[36:39]
    v_mfma_f32_16x16x32_bf16 v[40:43], v[220:223], v[8:11], v[40:43]
    v_mfma_f32_16x16x32_bf16 v[44:47], v[220:223], v[12:15], v[44:47]
    v_mfma_f32_16x16x32_bf16 v[48:51], v[220:223], v[16:19], v[48:51]
    v_mfma_f32_16x16x32_bf16 v[52:55], v[220:223], v[20:23], v[52:55]
    v_mfma_f32_16x16x32_bf16 v[56:59], v[220:223], v[24:27], v[56:59]
    v_mfma_f32_16x16x32_bf16 v[60:63], v[220:223], v[28:31], v[60:63]
    s_setprio 0
    s_nop 7
    v_cvt_pk_bf16_f32 v240, v32, v36
    v_cvt_pk_bf16_f32 v241, v40, v44
    v_cvt_pk_bf16_f32 v242, v48, v52
    v_cvt_pk_bf16_f32 v243, v56, v60
    buffer_store_dwordx4 v[240:243], v249, s[12:15], s39 offen sc1
    s_add_u32 s39, s39, 2736128
    v_cvt_pk_bf16_f32 v244, v33, v37
    v_cvt_pk_bf16_f32 v245, v41, v45
    v_cvt_pk_bf16_f32 v246, v49, v53
    v_cvt_pk_bf16_f32 v247, v57, v61
    buffer_store_dwordx4 v[244:247], v249, s[12:15], s39 offen sc1
    s_add_u32 s39, s39, 2736128
    v_cvt_pk_bf16_f32 v240, v34, v38
    v_cvt_pk_bf16_f32 v241, v42, v46
    v_cvt_pk_bf16_f32 v242, v50, v54
    v_cvt_pk_bf16_f32 v243, v58, v62
    buffer_store_dwordx4 v[240:243], v249, s[12:15], s39 offen sc1
    s_add_u32 s39, s39, 2736128
    v_cvt_pk_bf16_f32 v244, v35, v39
    v_cvt_pk_bf16_f32 v245, v43, v47
    v_cvt_pk_bf16_f32 v246, v51, v55
    v_cvt_pk_bf16_f32 v247, v59, v63
    buffer_store_dwordx4 v[244:247], v249, s[12:15], s39 offen sc1
    s_mov_b32 s41, s40
    s_add_u32 s40, s40, 1
    s_cmp_eq_u32 s41, 3
    s_cbranch_scc0 K12_ES5
    s_waitcnt vmcnt(0)
    s_mov_b32 s34, -1
    s_cmp_ge_u32 s41, 8
    s_cbranch_scc1 K12_SG6
    s_lshl_b32 s36, s41, 2
    s_add_u32 s37, s36, 155680
    s_mov_b64 exec, 1
    v_mov_b32 v255, s37
    v_mov_b32 v240, 1
    ds_add_rtn_u32 v240, v255, v240
    s_waitcnt lgkmcnt(0)
    v_readfirstlane_b32 s37, v240
    s_nop 3
    s_cmp_eq_u32 s37, 3
    s_cbranch_scc0 K12_SH6
    s_lshl_b32 s36, s36, 8
    v_mov_b32 v255, 1
    v_mov_b32 v240, s36
    buffer_atomic_add v255, v240, s[60:63], 0 offen sc0 sc1
    s_mov_b32 s34, s41
K12_SH6:
    s_mov_b64 exec, -1
K12_SG6:
    s_waitcnt vmcnt(0)
    s_cmp_ge_u32 s34, 8
    s_cbranch_scc1 K12_PB7
    v_readfirstlane_b32 s37, v255
    s_nop 3
    s_cmp_eq_u32 s37, 255
    s_cbranch_scc0 K12_PB7
    s_lshl_b32 s36, s34, 4
    s_add_u32 s36, s36, 16384
    s_mov_b64 exec, 1
    v_mov_b32 v255, 1
    v_mov_b32 v240, s36
    buffer_store_dword v255, v240, s[60:63], 0 offen sc1
    s_mov_b64 exec, -1
K12_PB7:
    s_mov_b32 s34, -1
    s_mov_b32 s41, -1
K12_ES5:
    s_waitcnt vmcnt(16)
    s_branch K12_XP_F
K12_XP_E:
    s_mov_b32 s41, s40
    s_add_u32 s40, s40, 1
    s_cmp_eq_u32 s41, 3
    s_cbranch_scc0 K12_ES8
    s_waitcnt vmcnt(0)
    s_mov_b32 s34, -1
    s_cmp_ge_u32 s41, 8
    s_cbranch_scc1 K12_SG9
    s_lshl_b32 s36, s41, 2
    s_add_u32 s37, s36, 155680
    s_mov_b64 exec, 1
    v_mov_b32 v255, s37
    v_mov_b32 v240, 1
    ds_add_rtn_u32 v240, v255, v240
    s_waitcnt lgkmcnt(0)
    v_readfirstlane_b32 s37, v240
    s_nop 3
    s_cmp_eq_u32 s37, 3
    s_cbranch_scc0 K12_SH9
    s_lshl_b32 s36, s36, 8
    v_mov_b32 v255, 1
    v_mov_b32 v240, s36
    buffer_atomic_add v255, v240, s[60:63], 0 offen sc0 sc1
    s_mov_b32 s34, s41
K12_SH9:
    s_mov_b64 exec, -1
K12_SG9:
    s_waitcnt vmcnt(0)
    s_cmp_ge_u32 s34, 8
    s_cbranch_scc1 K12_PB10
    v_readfirstlane_b32 s37, v255
    s_nop 3
    s_cmp_eq_u32 s37, 255
    s_cbranch_scc0 K12_PB10
    s_lshl_b32 s36, s34, 4
    s_add_u32 s36, s36, 16384
    s_mov_b64 exec, 1
    v_mov_b32 v255, 1
    v_mov_b32 v240, s36
    buffer_store_dword v255, v240, s[60:63], 0 offen sc1
    s_mov_b64 exec, -1
K12_PB10:
    s_mov_b32 s34, -1
    s_mov_b32 s41, -1
K12_ES8:
    s_waitcnt vmcnt(0)
K12_XP_F:
    s_cmp_ge_u32 s34, 8
    s_cbranch_scc1 K12_PB11
    v_readfirstlane_b32 s37, v255
    s_nop 3
    s_cmp_eq_u32 s37, 255
    s_cbranch_scc0 K12_PB11
    s_lshl_b32 s36, s34, 4
    s_add_u32 s36, s36, 16384
    s_mov_b64 exec, 1
    v_mov_b32 v255, 1
    v_mov_b32 v240, s36
    buffer_store_dword v255, v240, s[60:63], 0 offen sc1
    s_mov_b64 exec, -1
K12_PB11:
    s_cmp_ge_u32 s40, 8
    s_cbranch_scc1 K12_PFIN
K12_WENTRY:
    s_waitcnt vmcnt(0)
    s_mov_b32 s34, -1
    s_cmp_ge_u32 s41, 8
    s_cbranch_scc1 K12_SG12
    s_lshl_b32 s36, s41, 2
    s_add_u32 s37, s36, 155680
    s_mov_b64 exec, 1
    v_mov_b32 v255, s37
    v_mov_b32 v240, 1
    ds_add_rtn_u32 v240, v255, v240
    s_waitcnt lgkmcnt(0)
    v_readfirstlane_b32 s37, v240
    s_nop 3
    s_cmp_eq_u32 s37, 3
    s_cbranch_scc0 K12_SH12
    s_lshl_b32 s36, s36, 8
    v_mov_b32 v255, 1
    v_mov_b32 v240, s36
    buffer_atomic_add v255, v240, s[60:63], 0 offen sc0 sc1
    s_mov_b32 s34, s41
K12_SH12:
    s_mov_b64 exec, -1
K12_SG12:
    s_cmp_ge_u32 s34, 8
    s_cbranch_scc1 K12_EP13
    s_waitcnt vmcnt(0)
    s_cmp_ge_u32 s34, 8
    s_cbranch_scc1 K12_PB14
    v_readfirstlane_b32 s37, v255
    s_nop 3
    s_cmp_eq_u32 s37, 255
    s_cbranch_scc0 K12_PB14
    s_lshl_b32 s36, s34, 4
    s_add_u32 s36, s36, 16384
    s_mov_b64 exec, 1
    v_mov_b32 v255, 1
    v_mov_b32 v240, s36
    buffer_store_dword v255, v240, s[60:63], 0 offen sc1
    s_mov_b64 exec, -1
K12_PB14:
    s_mov_b32 s34, -1
K12_EP13:
    v_perm_b32 v64, v100, v96, s28
    v_perm_b32 v68, v100, v96, s29
    v_perm_b32 v65, v108, v104, s28
    v_perm_b32 v69, v108, v104, s29
    v_perm_b32 v66, v116, v112, s28
    v_perm_b32 v70, v116, v112, s29
    v_perm_b32 v67, v124, v120, s28
    v_perm_b32 v71, v124, v120, s29
    v_perm_b32 v72, v101, v97, s28
    v_perm_b32 v76, v101, v97, s29
    v_perm_b32 v73, v109, v105, s28
    v_perm_b32 v77, v109, v105, s29
    v_perm_b32 v74, v117, v113, s28
    v_perm_b32 v78, v117, v113, s29
    v_perm_b32 v75, v125, v121, s28
    v_perm_b32 v79, v125, v121, s29
    v_perm_b32 v80, v102, v98, s28
    v_perm_b32 v84, v102, v98, s29
    v_perm_b32 v81, v110, v106, s28
    v_perm_b32 v85, v110, v106, s29
    v_perm_b32 v82, v118, v114, s28
    v_perm_b32 v86, v118, v114, s29
    v_perm_b32 v83, v126, v122, s28
    v_perm_b32 v87, v126, v122, s29
    v_perm_b32 v88, v103, v99, s28
    v_perm_b32 v92, v103, v99, s29
    v_perm_b32 v89, v111, v107, s28
    v_perm_b32 v93, v111, v107, s29
    v_perm_b32 v90, v119, v115, s28
    v_perm_b32 v94, v119, v115, s29
    v_perm_b32 v91, v127, v123, s28
    v_perm_b32 v95, v127, v123, s29
    s_lshl_b32 s36, s40, 3
    s_sub_i32 s36, s36, 24
    s_max_i32 s36, s36, 1
    s_mov_b32 s37, 131072
K12_GL1:
    v_mov_b32 v240, 155648
    ds_read_b32 v240, v240
    s_waitcnt lgkmcnt(0)
    v_cmp_gt_u32 vcc, s36, v240
    s_sub_u32 s37, s37, 1
    s_cmp_eq_u32 s37, 0
    s_cbranch_scc1 K12_GT1
    s_cbranch_vccz K12_GT1
    s_sleep 2
    s_branch K12_GL1
K12_GT1:
    s_lshl_b32 s36, s40, 2
    s_add_u32 s36, s36, 155840
    s_mov_b64 exec, 1
    v_mov_b32 v240, s36
    v_mov_b32 v241, 1
    ds_add_u32 v240, v241
    s_mov_b64 exec, -1
    s_mov_b32 s37, 131072
K12_BL1:
    v_mov_b32 v240, s36
    ds_read_b32 v240, v240
    s_waitcnt lgkmcnt(0)
    v_cmp_gt_u32 vcc, 4, v240
    s_sub_u32 s37, s37, 1
    s_cmp_eq_u32 s37, 0
    s_cbranch_scc1 K12_BT1
    s_cbranch_vccz K12_BT1
    s_sleep 1
    s_branch K12_BL1
K12_BT1:
    s_add_u32 s42, s40, 1
    s_mul_i32 s36, s42, 85
    s_add_u32 s36, s36, s2
    s_and_b32 s36, s36, 255
    s_mul_hi_u32 s37, s36, 0x55555556
    s_mul_i32 s38, s37, 3
    s_cmp_eq_u32 s38, s36
    s_cselect_b32 s27, 1, 0
    s_cmp_lt_u32 s37, 78
    s_cselect_b32 s27, s27, 0
    s_add_u32 s37, s37, 89
    s_cmp_eq_u32 s21, 0
    s_cselect_b32 s30, s24, s37
    s_cselect_b32 s27, 1, s27
    s_cmp_eq_u32 s27, 0
    s_cbranch_scc1 K12_WP_N
    s_lshl_b32 s36, s42, 8
    s_mul_i32 s37, s30, 98304
    s_add_u32 s36, s36, s37
    buffer_load_dwordx4 v[0:3], v248, s[4:7], s36 offen
    buffer_load_dwordx4 v[4:7], v248, s[4:7], s36 offen offset:2048
    s_add_u32 s36, s36, 4096
    buffer_load_dwordx4 v[8:11], v248, s[4:7], s36 offen
    buffer_load_dwordx4 v[12:15], v248, s[4:7], s36 offen offset:2048
    s_add_u32 s36, s36, 4096
    buffer_load_dwordx4 v[16:19], v248, s[4:7], s36 offen
    buffer_load_dwordx4 v[20:23], v248, s[4:7], s36 offen offset:2048
    s_add_u32 s36, s36, 4096
    buffer_load_dwordx4 v[24:27], v248, s[4:7], s36 offen
    buffer_load_dwordx4 v[28:31], v248, s[4:7], s36 offen offset:2048
    s_add_u32 s36, s36, 53248
    buffer_load_dwordx4 v[32:35], v248, s[4:7], s36 offen
    buffer_load_dwordx4 v[36:39], v248, s[4:7], s36 offen offset:2048
    s_add_u32 s36, s36, 4096
    buffer_load_dwordx4 v[40:43], v248, s[4:7], s36 offen
    buffer_load_dwordx4 v[44:47], v248, s[4:7], s36 offen offset:2048
    s_add_u32 s36, s36, 4096
    buffer_load_dwordx4 v[48:51], v248, s[4:7], s36 offen
    buffer_load_dwordx4 v[52:55], v248, s[4:7], s36 offen offset:2048
    s_add_u32 s36, s36, 4096
    buffer_load_dwordx4 v[56:59], v248, s[4:7], s36 offen
    buffer_load_dwordx4 v[60:63], v248, s[4:7], s36 offen offset:2048
    s_branch K12_WP_M
K12_WP_N:
K12_WP_M:
    s_lshl_b32 s36, s40, 7
    s_add_u32 s36, s36, s22
    s_and_b32 s37, s36, 3
    s_lshr_b32 s38, s36, 1
    s_and_b32 s38, s38, 4
    s_or_b32 s37, s37, s38
    v_bfe_u32 v253, v254, 5, 3
    v_xor_b32 v253, s37, v253
    v_lshl_add_u32 v253, v253, 5, v251
    s_lshl_b32 s36, s36, 9
    s_add_u32 s39, s36, s32
    s_setprio 1
    v_mfma_f32_16x16x32_bf16 v[128:131], v[224:227], v[64:67], 0
    v_mfma_f32_16x16x32_bf16 v[132:135], v[224:227], v[68:71], 0
    v_mfma_f32_16x16x32_bf16 v[136:139], v[224:227], v[72:75], 0
    v_mfma_f32_16x16x32_bf16 v[140:143], v[224:227], v[76:79], 0
    v_mfma_f32_16x16x32_bf16 v[144:147], v[224:227], v[80:83], 0
    v_mfma_f32_16x16x32_bf16 v[148:151], v[224:227], v[84:87], 0
    v_mfma_f32_16x16x32_bf16 v[152:155], v[224:227], v[88:91], 0
    v_mfma_f32_16x16x32_bf16 v[156:159], v[224:227], v[92:95], 0
    s_setprio 0
    s_nop 7
    v_cvt_pk_bf16_f32 v240, v128, v132
    v_cvt_pk_bf16_f32 v241, v136, v140
    v_cvt_pk_bf16_f32 v242, v144, v148
    v_cvt_pk_bf16_f32 v243, v152, v156
    buffer_store_dwordx4 v[240:243], v253, s[16:19], s39 offen sc1
    s_add_u32 s39, s39, 4194304
    v_cvt_pk_bf16_f32 v244, v129, v133
    v_cvt_pk_bf16_f32 v245, v137, v141
    v_cvt_pk_bf16_f32 v246, v145, v149
    v_cvt_pk_bf16_f32 v247, v153, v157
    buffer_store_dwordx4 v[244:247], v253, s[16:19], s39 offen sc1
    s_add_u32 s39, s39, 4194304
    v_cvt_pk_bf16_f32 v240, v130, v134
    v_cvt_pk_bf16_f32 v241, v138, v142
    v_cvt_pk_bf16_f32 v242, v146, v150
    v_cvt_pk_bf16_f32 v243, v154, v158
    buffer_store_dwordx4 v[240:243], v253, s[16:19], s39 offen sc1
    s_add_u32 s39, s39, 4194304
    v_cvt_pk_bf16_f32 v244, v131, v135
    v_cvt_pk_bf16_f32 v245, v139, v143
    v_cvt_pk_bf16_f32 v246, v147, v151
    v_cvt_pk_bf16_f32 v247, v155, v159
    buffer_store_dwordx4 v[244:247], v253, s[16:19], s39 offen sc1
    s_add_u32 s39, s39, 4194304
    s_cmp_lt_u32 s40, 4
    s_cbranch_scc1 K12_UT9
    s_lshl_b32 s36, s40, 3
    s_sub_i32 s36, s36, 22
    s_max_i32 s36, s36, 1
    s_mov_b32 s37, 131072
K12_UL9:
    v_mov_b32 v255, 155648
    ds_read_b32 v255, v255
    s_waitcnt lgkmcnt(0)
    v_cmp_gt_u32 vcc, s36, v255
    s_sub_u32 s37, s37, 1
    s_cmp_eq_u32 s37, 0
    s_cbranch_scc1 K12_UT9
    s_cbranch_vccz K12_UT9
    s_sleep 2
    s_branch K12_UL9
K12_UT9:
    s_setprio 1
    v_mfma_f32_16x16x32_bf16 v[128:131], v[228:231], v[64:67], 0
    v_mfma_f32_16x16x32_bf16 v[132:135], v[228:231], v[68:71], 0
    v_mfma_f32_16x16x32_bf16 v[136:139], v[228:231], v[72:75], 0
    v_mfma_f32_16x16x32_bf16 v[140:143], v[228:231], v[76:79], 0
    v_mfma_f32_16x16x32_bf16 v[144:147], v[228:231], v[80:83], 0
    v_mfma_f32_16x16x32_bf16 v[148:151], v[228:231], v[84:87], 0
    v_mfma_f32_16x16x32_bf16 v[152:155], v[228:231], v[88:91], 0
    v_mfma_f32_16x16x32_bf16 v[156:159], v[228:231], v[92:95], 0
    s_setprio 0
    s_nop 7
    v_cvt_pk_bf16_f32 v240, v128, v132
    v_cvt_pk_bf16_f32 v241, v136, v140
    v_cvt_pk_bf16_f32 v242, v144, v148
    v_cvt_pk_bf16_f32 v243, v152, v156
    buffer_store_dwordx4 v[240:243], v253, s[16:19], s39 offen sc1
    s_add_u32 s39, s39, 4194304
    v_cvt_pk_bf16_f32 v244, v129, v133
    v_cvt_pk_bf16_f32 v245, v137, v141
    v_cvt_pk_bf16_f32 v246, v145, v149
    v_cvt_pk_bf16_f32 v247, v153, v157
    buffer_store_dwordx4 v[244:247], v253, s[16:19], s39 offen sc1
    s_add_u32 s39, s39, 4194304
    v_cvt_pk_bf16_f32 v240, v130, v134
    v_cvt_pk_bf16_f32 v241, v138, v142
    v_cvt_pk_bf16_f32 v242, v146, v150
    v_cvt_pk_bf16_f32 v243, v154, v158
    buffer_store_dwordx4 v[240:243], v253, s[16:19], s39 offen sc1
    s_add_u32 s39, s39, 4194304
    v_cvt_pk_bf16_f32 v244, v131, v135
    v_cvt_pk_bf16_f32 v245, v139, v143
    v_cvt_pk_bf16_f32 v246, v147, v151
    v_cvt_pk_bf16_f32 v247, v155, v159
    buffer_store_dwordx4 v[244:247], v253, s[16:19], s39 offen sc1
    s_add_u32 s39, s39, 4194304
    s_cmp_lt_u32 s40, 4
    s_cbranch_scc1 K12_UT10
    s_lshl_b32 s36, s40, 3
    s_sub_i32 s36, s36, 20
    s_max_i32 s36, s36, 1
    s_mov_b32 s37, 131072
K12_UL10:
    v_mov_b32 v255, 155648
    ds_read_b32 v255, v255
    s_waitcnt lgkmcnt(0)
    v_cmp_gt_u32 vcc, s36, v255
    s_sub_u32 s37, s37, 1
    s_cmp_eq_u32 s37, 0
    s_cbranch_scc1 K12_UT10
    s_cbranch_vccz K12_UT10
    s_sleep 2
    s_branch K12_UL10
K12_UT10:
    s_setprio 1
    v_mfma_f32_16x16x32_bf16 v[128:131], v[232:235], v[64:67], 0
    v_mfma_f32_16x16x32_bf16 v[132:135], v[232:235], v[68:71], 0
    v_mfma_f32_16x16x32_bf16 v[136:139], v[232:235], v[72:75], 0
    v_mfma_f32_16x16x32_bf16 v[140:143], v[232:235], v[76:79], 0
    v_mfma_f32_16x16x32_bf16 v[144:147], v[232:235], v[80:83], 0
    v_mfma_f32_16x16x32_bf16 v[148:151], v[232:235], v[84:87], 0
    v_mfma_f32_16x16x32_bf16 v[152:155], v[232:235], v[88:91], 0
    v_mfma_f32_16x16x32_bf16 v[156:159], v[232:235], v[92:95], 0
    s_setprio 0
    s_nop 7
    v_cvt_pk_bf16_f32 v240, v128, v132
    v_cvt_pk_bf16_f32 v241, v136, v140
    v_cvt_pk_bf16_f32 v242, v144, v148
    v_cvt_pk_bf16_f32 v243, v152, v156
    buffer_store_dwordx4 v[240:243], v253, s[16:19], s39 offen sc1
    s_add_u32 s39, s39, 4194304
    v_cvt_pk_bf16_f32 v244, v129, v133
    v_cvt_pk_bf16_f32 v245, v137, v141
    v_cvt_pk_bf16_f32 v246, v145, v149
    v_cvt_pk_bf16_f32 v247, v153, v157
    buffer_store_dwordx4 v[244:247], v253, s[16:19], s39 offen sc1
    s_add_u32 s39, s39, 4194304
    v_cvt_pk_bf16_f32 v240, v130, v134
    v_cvt_pk_bf16_f32 v241, v138, v142
    v_cvt_pk_bf16_f32 v242, v146, v150
    v_cvt_pk_bf16_f32 v243, v154, v158
    buffer_store_dwordx4 v[240:243], v253, s[16:19], s39 offen sc1
    s_add_u32 s39, s39, 4194304
    v_cvt_pk_bf16_f32 v244, v131, v135
    v_cvt_pk_bf16_f32 v245, v139, v143
    v_cvt_pk_bf16_f32 v246, v147, v151
    v_cvt_pk_bf16_f32 v247, v155, v159
    buffer_store_dwordx4 v[244:247], v253, s[16:19], s39 offen sc1
    s_add_u32 s39, s39, 4194304
    s_cmp_lt_u32 s40, 4
    s_cbranch_scc1 K12_UT11
    s_lshl_b32 s36, s40, 3
    s_sub_i32 s36, s36, 18
    s_max_i32 s36, s36, 1
    s_mov_b32 s37, 131072
K12_UL11:
    v_mov_b32 v255, 155648
    ds_read_b32 v255, v255
    s_waitcnt lgkmcnt(0)
    v_cmp_gt_u32 vcc, s36, v255
    s_sub_u32 s37, s37, 1
    s_cmp_eq_u32 s37, 0
    s_cbranch_scc1 K12_UT11
    s_cbranch_vccz K12_UT11
    s_sleep 2
    s_branch K12_UL11
K12_UT11:
    s_setprio 1
    v_mfma_f32_16x16x32_bf16 v[128:131], v[236:239], v[64:67], 0
    v_mfma_f32_16x16x32_bf16 v[132:135], v[236:239], v[68:71], 0
    v_mfma_f32_16x16x32_bf16 v[136:139], v[236:239], v[72:75], 0
    v_mfma_f32_16x16x32_bf16 v[140:143], v[236:239], v[76:79], 0
    v_mfma_f32_16x16x32_bf16 v[144:147], v[236:239], v[80:83], 0
    v_mfma_f32_16x16x32_bf16 v[148:151], v[236:239], v[84:87], 0
    v_mfma_f32_16x16x32_bf16 v[152:155], v[236:239], v[88:91], 0
    v_mfma_f32_16x16x32_bf16 v[156:159], v[236:239], v[92:95], 0
    s_setprio 0
    s_nop 7
    v_cvt_pk_bf16_f32 v240, v128, v132
    v_cvt_pk_bf16_f32 v241, v136, v140
    v_cvt_pk_bf16_f32 v242, v144, v148
    v_cvt_pk_bf16_f32 v243, v152, v156
    buffer_store_dwordx4 v[240:243], v253, s[16:19], s39 offen sc1
    s_add_u32 s39, s39, 4194304
    v_cvt_pk_bf16_f32 v244, v129, v133
    v_cvt_pk_bf16_f32 v245, v137, v141
    v_cvt_pk_bf16_f32 v246, v145, v149
    v_cvt_pk_bf16_f32 v247, v153, v157
    buffer_store_dwordx4 v[244:247], v253, s[16:19], s39 offen sc1
    s_add_u32 s39, s39, 4194304
    v_cvt_pk_bf16_f32 v240, v130, v134
    v_cvt_pk_bf16_f32 v241, v138, v142
    v_cvt_pk_bf16_f32 v242, v146, v150
    v_cvt_pk_bf16_f32 v243, v154, v158
    buffer_store_dwordx4 v[240:243], v253, s[16:19], s39 offen sc1
    s_add_u32 s39, s39, 4194304
    v_cvt_pk_bf16_f32 v244, v131, v135
    v_cvt_pk_bf16_f32 v245, v139, v143
    v_cvt_pk_bf16_f32 v246, v147, v151
    v_cvt_pk_bf16_f32 v247, v155, v159
    buffer_store_dwordx4 v[244:247], v253, s[16:19], s39 offen sc1
    s_mov_b32 s41, s40
    s_add_u32 s40, s40, 1
    s_cmp_eq_u32 s41, 3
    s_cbranch_scc0 K12_ES15
    s_waitcnt vmcnt(0)
    s_mov_b32 s34, -1
    s_cmp_ge_u32 s41, 8
    s_cbranch_scc1 K12_SG16
    s_lshl_b32 s36, s41, 2
    s_add_u32 s37, s36, 155680
    s_mov_b64 exec, 1
    v_mov_b32 v255, s37
    v_mov_b32 v240, 1
    ds_add_rtn_u32 v240, v255, v240
    s_waitcnt lgkmcnt(0)
    v_readfirstlane_b32 s37, v240
    s_nop 3
    s_cmp_eq_u32 s37, 3
    s_cbranch_scc0 K12_SH16
    s_lshl_b32 s36, s36, 8
    v_mov_b32 v255, 1
    v_mov_b32 v240, s36
    buffer_atomic_add v255, v240, s[60:63], 0 offen sc0 sc1
    s_mov_b32 s34, s41
K12_SH16:
    s_mov_b64 exec, -1
K12_SG16:
    s_waitcnt vmcnt(0)
    s_cmp_ge_u32 s34, 8
    s_cbranch_scc1 K12_PB17
    v_readfirstlane_b32 s37, v255
    s_nop 3
    s_cmp_eq_u32 s37, 255
    s_cbranch_scc0 K12_PB17
    s_lshl_b32 s36, s34, 4
    s_add_u32 s36, s36, 16384
    s_mov_b64 exec, 1
    v_mov_b32 v255, 1
    v_mov_b32 v240, s36
    buffer_store_dword v255, v240, s[60:63], 0 offen sc1
    s_mov_b64 exec, -1
K12_PB17:
    s_mov_b32 s34, -1
    s_mov_b32 s41, -1
K12_ES15:
    s_waitcnt vmcnt(16)
    s_cmp_ge_u32 s34, 8
    s_cbranch_scc1 K12_PB18
    v_readfirstlane_b32 s37, v255
    s_nop 3
    s_cmp_eq_u32 s37, 255
    s_cbranch_scc0 K12_PB18
    s_lshl_b32 s36, s34, 4
    s_add_u32 s36, s36, 16384
    s_mov_b64 exec, 1
    v_mov_b32 v255, 1
    v_mov_b32 v240, s36
    buffer_store_dword v255, v240, s[60:63], 0 offen sc1
    s_mov_b64 exec, -1
K12_PB18:
    s_cmp_lt_u32 s40, 8
    s_cbranch_scc1 K12_XW
K12_PFIN:
    s_waitcnt vmcnt(0)
    s_mov_b32 s34, -1
    s_cmp_ge_u32 s41, 8
    s_cbranch_scc1 K12_SG19
    s_lshl_b32 s36, s41, 2
    s_add_u32 s37, s36, 155680
    s_mov_b64 exec, 1
    v_mov_b32 v255, s37
    v_mov_b32 v240, 1
    ds_add_rtn_u32 v240, v255, v240
    s_waitcnt lgkmcnt(0)
    v_readfirstlane_b32 s37, v240
    s_nop 3
    s_cmp_eq_u32 s37, 3
    s_cbranch_scc0 K12_SH19
    s_lshl_b32 s36, s36, 8
    v_mov_b32 v255, 1
    v_mov_b32 v240, s36
    buffer_atomic_add v255, v240, s[60:63], 0 offen sc0 sc1
    s_mov_b32 s34, s41
K12_SH19:
    s_mov_b64 exec, -1
K12_SG19:
    s_waitcnt vmcnt(0)
    s_cmp_ge_u32 s34, 8
    s_cbranch_scc1 K12_PB20
    v_readfirstlane_b32 s37, v255
    s_nop 3
    s_cmp_eq_u32 s37, 255
    s_cbranch_scc0 K12_PB20
    s_lshl_b32 s36, s34, 4
    s_add_u32 s36, s36, 16384
    s_mov_b64 exec, 1
    v_mov_b32 v255, 1
    v_mov_b32 v240, s36
    buffer_store_dword v255, v240, s[60:63], 0 offen sc1
    s_mov_b64 exec, -1
K12_PB20:
    s_endpgm
K12_CONS:
    s_and_b32 s6, s2, 7
    s_lshl_b32 s6, s6, 2
    s_lshr_b32 s7, s2, 6
    s_add_u32 s6, s6, s7
    s_mov_b32 s51, s6
    s_mov_b32 s27, s6
    s_lshr_b32 s7, s2, 3
    s_and_b32 s7, s7, 7
    s_lshr_b32 s20, s7, 2
    s_and_b32 s21, s7, 3
    s_lshl_b32 s22, s6, 1
    s_add_u32 s22, s22, s20
    s_lshl_b32 s23, s6, 2
    s_add_u32 s23, s23, s21
    s_mul_i32 s24, s22, 684032
    s_mul_i32 s25, s23, 524288
    s_add_u32 s25, s25, 50331648
    s_mul_i32 s26, s22, 342016
    s_add_u32 s26, s26, 118489088
    s_add_u32 s8, s58, s24
    s_addc_u32 s9, s59, 0
    s_and_b32 s9, s9, 0xffff
    s_mov_b32 s10, 684032
    s_mov_b32 s11, 0x00020000
    s_add_u32 s12, s58, s25
    s_addc_u32 s13, s59, 0
    s_and_b32 s13, s13, 0xffff
    s_mov_b32 s14, 524288
    s_mov_b32 s15, 0x00020000
    s_add_u32 s16, s58, s26
    s_addc_u32 s17, s59, 0
    s_and_b32 s17, s17, 0xffff
    s_mov_b32 s18, 342016
    s_mov_b32 s19, 0x00020000
    s_add_u32 s4, s58, 153108480
    s_addc_u32 s5, s59, 0
    s_and_b32 s5, s5, 0xffff
    s_cmp_eq_u32 s3, 0
    s_cselect_b32 s6, 128, 0
    s_mov_b32 s7, 0x00020000
    s_mov_b32 s46, 155712
    s_cselect_b32 s46, s46, 155776
    s_mov_b32 s47, 155712
    s_cselect_b32 s47, s47, 155744
    s_cselect_b32 s45, 4, 0
    s_mov_b32 s50, s45
    v_and_b32 v8, 15, v2
    v_lshrrev_b32 v9, 4, v2
    v_lshlrev_b32 v1, 4, v2
    s_mul_i32 s30, s3, 5120
    s_mov_b32 s36, s30
    s_lshl_b32 s31, s3, 12
    s_add_u32 s37, s31, 22528
    s_lshr_b32 s28, s3, 1
    s_and_b32 s29, s3, 1
    s_lshl_b32 s33, s29, 9
    s_add_u32 s33, s33, 20480
    s_mul_i32 s38, s28, 896
    s_add_u32 s38, s38, s33
    s_lshl_b32 s34, s51, 1
    s_add_u32 s34, s34, s28
    s_mul_i32 s34, s34, 684032
    s_add_u32 s64, s58, s34
    s_addc_u32 s65, s59, 0
    s_and_b32 s65, s65, 0xffff
    s_mov_b32 s66, 684032
    s_mov_b32 s67, 0x00020000
    s_mov_b32 s44, 0xffffff
    s_cmp_eq_u32 s29, 0
    s_cselect_b32 s44, -1, s44
    s_mov_b32 s45, 0
    v_lshrrev_b32 v10, 1, v8
    v_xor_b32 v10, v10, v9
    v_lshlrev_b32 v10, 4, v10
    v_lshl_add_u32 v2, v8, 7, v10
    v_xor_b32 v3, 64, v2
    v_lshrrev_b32 v10, 2, v8
    v_lshl_add_u32 v11, v9, 3, v10
    v_lshlrev_b32 v11, 9, v11
    v_and_b32 v12, 1, v9
    v_lshl_or_b32 v10, v12, 2, v10
    s_lshl_b32 s28, s3, 1
    v_xor_b32 v10, s28, v10
    v_lshl_add_u32 v11, v10, 5, v11
    v_and_b32 v10, 3, v8
    v_lshl_add_u32 v11, v10, 3, v11
    v_add_u32 v4, 22528, v11
    s_lshl_b32 s28, s20, 5
    v_xor_b32 v4, s28, v4
    v_and_b32 v10, 3, v8
    v_lshlrev_b32 v10, 2, v10
    v_add_u32 v5, 155648, v10
    s_lshl_b32 s28, s3, 2
    s_add_u32 s28, s28, 155648
    v_mov_b32 v7, s28
    s_mov_b32 s35, 0x80008000
    s_mov_b32 s62, 0
    s_mov_b32 s63, 0
    s_mov_b32 s39, 0
    s_add_u32 m0, s39, s36
    s_nop 0
    buffer_load_dwordx4 v1, s[8:11], s30 offen sc1 lds
    buffer_load_dwordx4 v1, s[8:11], s30 offen offset:1024 sc1 lds
    buffer_load_dwordx4 v1, s[8:11], s30 offen offset:2048 sc1 lds
    buffer_load_dwordx4 v1, s[8:11], s30 offen offset:3072 sc1 lds
    s_add_u32 m0, m0, 4096
    s_add_u32 s34, s30, 4096
    buffer_load_dwordx4 v1, s[8:11], s34 offen sc1 lds
    s_add_u32 m0, s39, s37
    s_add_u32 s30, s30, 21376
    buffer_load_dwordx4 v1, s[12:15], s31 offen sc1 lds
    buffer_load_dwordx4 v1, s[12:15], s31 offen offset:1024 sc1 lds
    buffer_load_dwordx4 v1, s[12:15], s31 offen offset:2048 sc1 lds
    buffer_load_dwordx4 v1, s[12:15], s31 offen offset:3072 sc1 lds
    s_add_u32 m0, s39, s38
    s_mov_b64 exec, s[44:45]
    buffer_load_dwordx4 v1, s[64:67], s33 offen sc1 lds
    s_mov_b64 exec, -1
    s_add_u32 s31, s31, 16384
    s_add_u32 s33, s33, 21376
    s_add_u32 s39, s39, 38912
    s_add_u32 m0, s39, s36
    s_nop 0
    buffer_load_dwordx4 v1, s[8:11], s30 offen sc1 lds
    buffer_load_dwordx4 v1, s[8:11], s30 offen offset:1024 sc1 lds
    buffer_load_dwordx4 v1, s[8:11], s30 offen offset:2048 sc1 lds
    buffer_load_dwordx4 v1, s[8:11], s30 offen offset:3072 sc1 lds
    s_add_u32 m0, m0, 4096
    s_add_u32 s34, s30, 4096
    buffer_load_dwordx4 v1, s[8:11], s34 offen sc1 lds
    s_add_u32 m0, s39, s37
    s_add_u32 s30, s30, 21376
    buffer_load_dwordx4 v1, s[12:15], s31 offen sc1 lds
    buffer_load_dwordx4 v1, s[12:15], s31 offen offset:1024 sc1 lds
    buffer_load_dwordx4 v1, s[12:15], s31 offen offset:2048 sc1 lds
    buffer_load_dwordx4 v1, s[12:15], s31 offen offset:3072 sc1 lds
    s_add_u32 m0, s39, s38
    s_mov_b64 exec, s[44:45]
    buffer_load_dwordx4 v1, s[64:67], s33 offen sc1 lds
    s_mov_b64 exec, -1
    s_add_u32 s31, s31, 16384
    s_add_u32 s33, s33, 21376
    s_add_u32 s39, s39, 38912
    s_add_u32 m0, s39, s36
    s_nop 0
    buffer_load_dwordx4 v1, s[8:11], s30 offen sc1 lds
    buffer_load_dwordx4 v1, s[8:11], s30 offen offset:1024 sc1 lds
    buffer_load_dwordx4 v1, s[8:11], s30 offen offset:2048 sc1 lds
    buffer_load_dwordx4 v1, s[8:11], s30 offen offset:3072 sc1 lds
    s_add_u32 m0, m0, 4096
    s_add_u32 s34, s30, 4096
    buffer_load_dwordx4 v1, s[8:11], s34 offen sc1 lds
    s_add_u32 m0, s39, s37
    s_add_u32 s30, s30, 21376
    buffer_load_dwordx4 v1, s[12:15], s31 offen sc1 lds
    buffer_load_dwordx4 v1, s[12:15], s31 offen offset:1024 sc1 lds
    buffer_load_dwordx4 v1, s[12:15], s31 offen offset:2048 sc1 lds
    buffer_load_dwordx4 v1, s[12:15], s31 offen offset:3072 sc1 lds
    s_add_u32 m0, s39, s38
    s_mov_b64 exec, s[44:45]
    buffer_load_dwordx4 v1, s[64:67], s33 offen sc1 lds
    s_mov_b64 exec, -1
    s_add_u32 s31, s31, 16384
    s_add_u32 s33, s33, 21376
    s_add_u32 s39, s39, 38912
    s_mov_b32 m0, s46
    s_mov_b64 exec, 0xff
    buffer_load_dword v1, s[4:7], 0 offen sc1 lds
    s_mov_b64 exec, -1
    v_lshrrev_b32 v9, 4, v1
    v_and_b32 v8, 15, v9
    v_lshrrev_b32 v9, 4, v9
    v_and_b32 v10, 3, v8
    v_lshlrev_b32 v10, 2, v10
    v_lshrrev_b32 v12, 3, v8
    v_lshl_add_u32 v10, v12, 1, v10
    s_lshl_b32 s28, s3, 4
    s_add_u32 s28, s28, 1
    v_add_u32 v10, s28, v10
    v_bfe_u32 v11, v8, 2, 1
    v_and_b32 v13, 1, v9
    v_lshlrev_b32 v13, 3, v13
    v_mul_u32_u24 v14, 96, v11
    v_mad_u32_u24 v15, v10, v13, v14
    v_mad_u32_u24 v16, v10, 0, v15
    v_mad_u32_u24 v17, v10, 1, v15
    v_mad_u32_u24 v18, v10, 2, v15
    v_mad_u32_u24 v19, v10, 3, v15
    v_mad_u32_u24 v20, v10, 4, v15
    v_mad_u32_u24 v21, v10, 5, v15
    v_mad_u32_u24 v22, v10, 6, v15
    v_mad_u32_u24 v23, v10, 7, v15
    v_and_b32 v16, 127, v16
    v_and_b32 v17, 127, v17
    v_and_b32 v18, 127, v18
    v_and_b32 v19, 127, v19
    v_and_b32 v20, 127, v20
    v_and_b32 v21, 127, v21
    v_and_b32 v22, 127, v22
    v_and_b32 v23, 127, v23
    v_cvt_f32_u32 v16, v16
    v_cvt_f32_u32 v17, v17
    v_cvt_f32_u32 v18, v18
    v_cvt_f32_u32 v19, v19
    v_cvt_f32_u32 v20, v20
    v_cvt_f32_u32 v21, v21
    v_cvt_f32_u32 v22, v22
    v_cvt_f32_u32 v23, v23
    v_mul_f32 v16, 0x3c000000, v16
    v_mul_f32 v17, 0x3c000000, v17
    v_mul_f32 v18, 0x3c000000, v18
    v_mul_f32 v19, 0x3c000000, v19
    v_mul_f32 v20, 0x3c000000, v20
    v_mul_f32 v21, 0x3c000000, v21
    v_mul_f32 v22, 0x3c000000, v22
    v_mul_f32 v23, 0x3c000000, v23
    v_cos_f32 v16, v16
    v_cos_f32 v17, v17
    v_cos_f32 v18, v18
    v_cos_f32 v19, v19
    v_cos_f32 v20, v20
    v_cos_f32 v21, v21
    v_cos_f32 v22, v22
    v_cos_f32 v23, v23
    s_nop 0
    v_cvt_pk_bf16_f32 v24, v16, v17
    v_cvt_pk_bf16_f32 v25, v18, v19
    v_cvt_pk_bf16_f32 v26, v20, v21
    v_cvt_pk_bf16_f32 v27, v22, v23
    v_lshlrev_b32 v32, 16, v24
    v_and_b32 v33, 0xffff0000, v24
    v_sub_f32 v16, v16, v32
    v_sub_f32 v17, v17, v33
    v_lshlrev_b32 v32, 16, v25
    v_and_b32 v33, 0xffff0000, v25
    v_sub_f32 v18, v18, v32
    v_sub_f32 v19, v19, v33
    v_lshlrev_b32 v32, 16, v26
    v_and_b32 v33, 0xffff0000, v26
    v_sub_f32 v20, v20, v32
    v_sub_f32 v21, v21, v33
    v_lshlrev_b32 v32, 16, v27
    v_and_b32 v33, 0xffff0000, v27
    v_sub_f32 v22, v22, v32
    v_sub_f32 v23, v23, v33
    v_cvt_pk_bf16_f32 v28, v16, v17
    v_cvt_pk_bf16_f32 v29, v18, v19
    v_cvt_pk_bf16_f32 v30, v20, v21
    v_cvt_pk_bf16_f32 v31, v22, v23
    v_cmp_lt_u32 vcc, 1, v9
    s_lshl_b32 s28, s3, 10
    s_add_u32 s28, s28, 133120
    v_add_u32 v14, s28, v1
    v_cndmask_b32 v24, v24, v28, vcc
    v_cndmask_b32 v25, v25, v29, vcc
    v_cndmask_b32 v26, v26, v30, vcc
    v_cndmask_b32 v27, v27, v31, vcc
    ds_write_b128 v14, v[24:27]
    v_mov_b32 v12, 0
    v_mov_b32 v13, 0
    v_mov_b32 v14, 0
    v_mov_b32 v15, 0
    s_mul_i32 s28, s3, 38912
    s_add_u32 s28, s28, 22272
    v_add_u32 v16, s28, v1
    s_mov_b64 exec, 0xffff
    ds_write_b128 v16, v[12:15]
    s_mov_b64 exec, -1
    s_lshl_b32 s28, s3, 2
    s_add_u32 s28, s28, 155648
    v_mov_b32 v16, s28
    ds_write_b32 v16, v12
    s_lshl_b32 s28, s3, 3
    s_add_u32 s28, s28, 155680
    v_mov_b32 v16, s28
    ds_write_b64 v16, v[12:13]
    s_lshl_b32 s28, s3, 3
    s_add_u32 s28, s28, 155712
    v_mov_b32 v16, s28
    ds_write_b64 v16, v[12:13]
    s_lshl_b32 s28, s3, 3
    s_add_u32 s28, s28, 155840
    v_mov_b32 v16, s28
    ds_write_b64 v16, v[12:13]
    v_mov_b32 v16, 155664
    ds_write_b32 v16, v12
    v_mov_b32 v16, 155744
    v_mov_b32 v17, 1
    ds_write_b32 v16, v17
    s_waitcnt lgkmcnt(0)
    s_barrier
    v_mov_b32 v80, 0
    v_mov_b32 v81, 0
    v_mov_b32 v82, 0
    v_mov_b32 v83, 0
    v_mov_b32 v84, 0
    v_mov_b32 v85, 0
    v_mov_b32 v86, 0
    v_mov_b32 v87, 0
    v_mov_b32 v88, 0
    v_mov_b32 v89, 0
    v_mov_b32 v90, 0
    v_mov_b32 v91, 0
    v_mov_b32 v92, 0
    v_mov_b32 v93, 0
    v_mov_b32 v94, 0
    v_mov_b32 v95, 0
    v_mov_b32 v96, 0
    v_mov_b32 v97, 0
    v_mov_b32 v98, 0
    v_mov_b32 v99, 0
    v_mov_b32 v100, 0
    v_mov_b32 v101, 0
    v_mov_b32 v102, 0
    v_mov_b32 v103, 0
    v_mov_b32 v104, 0
    v_mov_b32 v105, 0
    v_mov_b32 v106, 0
    v_mov_b32 v107, 0
    v_mov_b32 v108, 0
    v_mov_b32 v109, 0
    v_mov_b32 v110, 0
    v_mov_b32 v111, 0
    v_mov_b32 v112, 0
    v_mov_b32 v113, 0
    v_mov_b32 v114, 0
    v_mov_b32 v115, 0
    v_mov_b32 v116, 0
    v_mov_b32 v117, 0
    v_mov_b32 v118, 0
    v_mov_b32 v119, 0
    v_mov_b32 v120, 0
    v_mov_b32 v121, 0
    v_mov_b32 v122, 0
    v_mov_b32 v123, 0
    v_mov_b32 v124, 0
    v_mov_b32 v125, 0
    v_mov_b32 v126, 0
    v_mov_b32 v127, 0
    v_mov_b32 v128, 0
    v_mov_b32 v129, 0
    v_mov_b32 v130, 0
    v_mov_b32 v131, 0
    v_mov_b32 v132, 0
    v_mov_b32 v133, 0
    v_mov_b32 v134, 0
    v_mov_b32 v135, 0
    v_mov_b32 v136, 0
    v_mov_b32 v137, 0
    v_mov_b32 v138, 0
    v_mov_b32 v139, 0
    v_mov_b32 v140, 0
    v_mov_b32 v141, 0
    v_mov_b32 v142, 0
    v_mov_b32 v143, 0
    v_mov_b32 v144, 0
    v_mov_b32 v145, 0
    v_mov_b32 v146, 0
    v_mov_b32 v147, 0
    v_mov_b32 v148, 0
    v_mov_b32 v149, 0
    v_mov_b32 v150, 0
    v_mov_b32 v151, 0
    v_mov_b32 v152, 0
    v_mov_b32 v153, 0
    v_mov_b32 v154, 0
    v_mov_b32 v155, 0
    v_mov_b32 v156, 0
    v_mov_b32 v157, 0
    v_mov_b32 v158, 0
    v_mov_b32 v159, 0
    v_mov_b32 v160, 0
    v_mov_b32 v161, 0
    v_mov_b32 v162, 0
    v_mov_b32 v163, 0
    v_mov_b32 v164, 0
    v_mov_b32 v165, 0
    v_mov_b32 v166, 0
    v_mov_b32 v167, 0
    v_mov_b32 v168, 0
    v_mov_b32 v169, 0
    v_mov_b32 v170, 0
    v_mov_b32 v171, 0
    v_mov_b32 v172, 0
    v_mov_b32 v173, 0
    v_mov_b32 v174, 0
    v_mov_b32 v175, 0
    v_mov_b32 v176, 0
    v_mov_b32 v177, 0
    v_mov_b32 v178, 0
    v_mov_b32 v179, 0
    v_mov_b32 v180, 0
    v_mov_b32 v181, 0
    v_mov_b32 v182, 0
    v_mov_b32 v183, 0
    v_mov_b32 v184, 0
    v_mov_b32 v185, 0
    v_mov_b32 v186, 0
    v_mov_b32 v187, 0
    v_mov_b32 v188, 0
    v_mov_b32 v189, 0
    v_mov_b32 v190, 0
    v_mov_b32 v191, 0
    v_mov_b32 v192, 0
    v_mov_b32 v193, 0
    v_mov_b32 v194, 0
    v_mov_b32 v195, 0
    v_mov_b32 v196, 0
    v_mov_b32 v197, 0
    v_mov_b32 v198, 0
    v_mov_b32 v199, 0
    v_mov_b32 v200, 0
    v_mov_b32 v201, 0
    v_mov_b32 v202, 0
    v_mov_b32 v203, 0
    v_mov_b32 v204, 0
    v_mov_b32 v205, 0
    v_mov_b32 v206, 0
    v_mov_b32 v207, 0
    v_mov_b32 v208, 0
    v_mov_b32 v209, 0
    v_mov_b32 v210, 0
    v_mov_b32 v211, 0
    v_mov_b32 v212, 0
    v_mov_b32 v213, 0
    v_mov_b32 v214, 0
    v_mov_b32 v215, 0
    v_mov_b32 v216, 0
    v_mov_b32 v217, 0
    v_mov_b32 v218, 0
    v_mov_b32 v219, 0
    v_mov_b32 v220, 0
    v_mov_b32 v221, 0
    v_mov_b32 v222, 0
    v_mov_b32 v223, 0
    v_mov_b32 v224, 0
    v_mov_b32 v225, 0
    v_mov_b32 v226, 0
    v_mov_b32 v227, 0
    v_mov_b32 v228, 0
    v_mov_b32 v229, 0
    v_mov_b32 v230, 0
    v_mov_b32 v231, 0
    v_mov_b32 v232, 0
    v_mov_b32 v233, 0
    v_mov_b32 v234, 0
    v_mov_b32 v235, 0
    v_mov_b32 v236, 0
    v_mov_b32 v237, 0
    v_mov_b32 v238, 0
    v_mov_b32 v239, 0
    v_mov_b32 v240, 0
    v_mov_b32 v241, 0
    v_mov_b32 v242, 0
    v_mov_b32 v243, 0
    v_mov_b32 v244, 0
    v_mov_b32 v245, 0
    v_mov_b32 v246, 0
    v_mov_b32 v247, 0
    v_mov_b32 v248, 0
    v_mov_b32 v249, 0
    v_mov_b32 v250, 0
    v_mov_b32 v251, 0
    v_mov_b32 v252, 0
    v_mov_b32 v253, 0
    v_mov_b32 v254, 0
    v_mov_b32 v255, 0
    s_barrier
    s_mov_b32 s40, 2
    v_mov_b32 v0, s40
    s_waitcnt vmcnt(21)
    ds_write_b32 v7, v0
    s_branch K12_S0
K12_Q0:
    ds_read_b64_tr_b16 v[40:41], v4 offset:0
    ds_read_b64_tr_b16 v[42:43], v4 offset:2048
    ds_read_b64_tr_b16 v[44:45], v4 offset:256
    ds_read_b64_tr_b16 v[46:47], v4 offset:2304
    v_xor_b32 v4, 32, v4
    ds_read_b64_tr_b16 v[48:49], v4 offset:0
    ds_read_b64_tr_b16 v[50:51], v4 offset:2048
    ds_read_b64_tr_b16 v[52:53], v4 offset:256
    ds_read_b64_tr_b16 v[54:55], v4 offset:2304
    v_xor_b32 v4, 32, v4
    ds_read_b128 v[8:11], v2 offset:0
    ds_read_b128 v[12:15], v3 offset:0
    ds_read_b128 v[16:19], v2 offset:2048
    ds_read_b128 v[20:23], v3 offset:2048
    ds_read_b128 v[32:35], v2 offset:6144
    ds_read_b128 v[36:39], v3 offset:6144
    ds_read_b32 v68, v5
    s_waitcnt lgkmcnt(7)
    v_xor_b32 v72, s35, v44
    v_xor_b32 v73, s35, v45
    v_xor_b32 v74, s35, v46
    v_xor_b32 v75, s35, v47
    v_xor_b32 v76, s35, v52
    v_xor_b32 v77, s35, v53
    v_xor_b32 v78, s35, v54
    v_xor_b32 v79, s35, v55
    s_mov_b32 s41, 0
    s_mov_b32 s42, 38912
    s_mov_b32 s39, 0
    s_mov_b32 s29, 116736
K12_LOOP:
    s_waitcnt lgkmcnt(2)
    v_mfma_f32_16x16x32_bf16 v[80:83], v[8:11], v[40:43], v[80:83]
    ds_read_b128 v[24:27], v2 offset:4096
    v_xor_b32 v72, s35, v44
    v_xor_b32 v73, s35, v45
    v_mfma_f32_16x16x32_bf16 v[84:87], v[8:11], v[44:47], v[84:87]
    ds_read_b128 v[28:31], v3 offset:4096
    v_xor_b32 v74, s35, v46
    v_xor_b32 v75, s35, v47
    v_mfma_f32_16x16x32_bf16 v[88:91], v[8:11], v[48:51], v[88:91]
    s_waitcnt lgkmcnt(2)
    v_cmp_gt_u32 vcc, s40, v68
    s_add_u32 s49, s39, 2
    s_lshr_b32 s49, s49, 1
    v_xor_b32 v76, s35, v52
    v_xor_b32 v77, s35, v53
    v_mfma_f32_16x16x32_bf16 v[92:95], v[8:11], v[52:55], v[92:95]
    s_cbranch_vccnz K12_S1
K12_Q1:
    s_mul_i32 s48, s49, s50
    s_add_u32 s48, s48, s47
    v_xor_b32 v78, s35, v54
    v_xor_b32 v79, s35, v55
    v_mfma_f32_16x16x32_bf16 v[80:83], v[12:15], v[72:75], v[80:83]
    s_add_u32 m0, s29, s36
    s_nop 0
    buffer_load_dwordx4 v1, s[8:11], s30 offen sc1 lds
    v_mfma_f32_16x16x32_bf16 v[84:87], v[12:15], v[40:43], v[84:87]
    s_cmp_lt_u32 s49, 8
    s_cselect_b32 s48, s48, 155744
    v_mfma_f32_16x16x32_bf16 v[88:91], v[12:15], v[76:79], v[88:91]
    s_cmp_ge_u32 s49, 3
    s_cselect_b32 s48, s48, 155744
    v_mfma_f32_16x16x32_bf16 v[92:95], v[12:15], v[48:51], v[92:95]
    v_mfma_f32_16x16x32_bf16 v[96:99], v[16:19], v[40:43], v[96:99]
    ds_read_b128 v[8:11], v2 offset:8192
    v_mfma_f32_16x16x32_bf16 v[100:103], v[16:19], v[44:47], v[100:103]
    ds_read_b128 v[12:15], v3 offset:8192
    v_mfma_f32_16x16x32_bf16 v[104:107], v[16:19], v[48:51], v[104:107]
    buffer_load_dwordx4 v1, s[8:11], s30 offen offset:1024 sc1 lds
    v_mfma_f32_16x16x32_bf16 v[108:111], v[16:19], v[52:55], v[108:111]
    v_mfma_f32_16x16x32_bf16 v[96:99], v[20:23], v[72:75], v[96:99]
    v_mfma_f32_16x16x32_bf16 v[100:103], v[20:23], v[40:43], v[100:103]
    v_mfma_f32_16x16x32_bf16 v[104:107], v[20:23], v[76:79], v[104:107]
    buffer_load_dwordx4 v1, s[8:11], s30 offen offset:2048 sc1 lds
    v_mfma_f32_16x16x32_bf16 v[108:111], v[20:23], v[48:51], v[108:111]
    s_waitcnt lgkmcnt(2)
    v_mfma_f32_16x16x32_bf16 v[112:115], v[24:27], v[40:43], v[112:115]
    ds_read_b128 v[16:19], v2 offset:10240
    v_mfma_f32_16x16x32_bf16 v[116:119], v[24:27], v[44:47], v[116:119]
    ds_read_b128 v[20:23], v3 offset:10240
    v_mfma_f32_16x16x32_bf16 v[120:123], v[24:27], v[48:51], v[120:123]
    v_mfma_f32_16x16x32_bf16 v[124:127], v[24:27], v[52:55], v[124:127]
    v_mfma_f32_16x16x32_bf16 v[112:115], v[28:31], v[72:75], v[112:115]
    buffer_load_dwordx4 v1, s[8:11], s30 offen offset:3072 sc1 lds
    v_mfma_f32_16x16x32_bf16 v[116:119], v[28:31], v[40:43], v[116:119]
    v_mfma_f32_16x16x32_bf16 v[120:123], v[28:31], v[76:79], v[120:123]
    v_mfma_f32_16x16x32_bf16 v[124:127], v[28:31], v[48:51], v[124:127]
    v_mfma_f32_16x16x32_bf16 v[128:131], v[32:35], v[40:43], v[128:131]
    ds_read_b128 v[24:27], v2 offset:12288
    v_mfma_f32_16x16x32_bf16 v[132:135], v[32:35], v[44:47], v[132:135]
    ds_read_b128 v[28:31], v3 offset:12288
    v_mfma_f32_16x16x32_bf16 v[136:139], v[32:35], v[48:51], v[136:139]
    s_add_u32 m0, m0, 4096
    s_add_u32 s34, s30, 4096
    buffer_load_dwordx4 v1, s[8:11], s34 offen sc1 lds
    v_mfma_f32_16x16x32_bf16 v[140:143], v[32:35], v[52:55], v[140:143]
    v_mfma_f32_16x16x32_bf16 v[128:131], v[36:39], v[72:75], v[128:131]
    v_mfma_f32_16x16x32_bf16 v[132:135], v[36:39], v[40:43], v[132:135]
    v_mfma_f32_16x16x32_bf16 v[136:139], v[36:39], v[76:79], v[136:139]
    s_add_u32 m0, s29, s37
    s_add_u32 s30, s30, 21376
    buffer_load_dwordx4 v1, s[12:15], s31 offen sc1 lds
    v_mfma_f32_16x16x32_bf16 v[140:143], v[36:39], v[48:51], v[140:143]
    s_waitcnt lgkmcnt(4)
    v_mfma_f32_16x16x32_bf16 v[144:147], v[8:11], v[40:43], v[144:147]
    ds_read_b128 v[32:35], v2 offset:14336
    v_mfma_f32_16x16x32_bf16 v[148:151], v[8:11], v[44:47], v[148:151]
    ds_read_b128 v[36:39], v3 offset:14336
    v_mfma_f32_16x16x32_bf16 v[152:155], v[8:11], v[48:51], v[152:155]
    v_mfma_f32_16x16x32_bf16 v[156:159], v[8:11], v[52:55], v[156:159]
    v_mfma_f32_16x16x32_bf16 v[144:147], v[12:15], v[72:75], v[144:147]
    buffer_load_dwordx4 v1, s[12:15], s31 offen offset:1024 sc1 lds
    v_mfma_f32_16x16x32_bf16 v[148:151], v[12:15], v[40:43], v[148:151]
    v_mfma_f32_16x16x32_bf16 v[152:155], v[12:15], v[76:79], v[152:155]
    v_mfma_f32_16x16x32_bf16 v[156:159], v[12:15], v[48:51], v[156:159]
    s_waitcnt lgkmcnt(4)
    v_mfma_f32_16x16x32_bf16 v[160:163], v[16:19], v[40:43], v[160:163]
    ds_read_b128 v[8:11], v2 offset:16384
    v_mfma_f32_16x16x32_bf16 v[164:167], v[16:19], v[44:47], v[164:167]
    ds_read_b128 v[12:15], v3 offset:16384
    v_mfma_f32_16x16x32_bf16 v[168:171], v[16:19], v[48:51], v[168:171]
    buffer_load_dwordx4 v1, s[12:15], s31 offen offset:2048 sc1 lds
    v_mfma_f32_16x16x32_bf16 v[172:175], v[16:19], v[52:55], v[172:175]
    s_add_u32 s40, s40, 1
    s_mov_b32 s51, s40
    v_mov_b32 v0, s40
    v_mfma_f32_16x16x32_bf16 v[160:163], v[20:23], v[72:75], v[160:163]
    s_waitcnt vmcnt(19)
    ds_write_b32 v7, v0
    v_mfma_f32_16x16x32_bf16 v[164:167], v[20:23], v[40:43], v[164:167]
    v_mfma_f32_16x16x32_bf16 v[168:171], v[20:23], v[76:79], v[168:171]
    buffer_load_dwordx4 v1, s[12:15], s31 offen offset:3072 sc1 lds
    v_mfma_f32_16x16x32_bf16 v[172:175], v[20:23], v[48:51], v[172:175]
    s_waitcnt lgkmcnt(5)
    v_mfma_f32_16x16x32_bf16 v[176:179], v[24:27], v[40:43], v[176:179]
    ds_read_b128 v[16:19], v2 offset:18432
    v_mfma_f32_16x16x32_bf16 v[180:183], v[24:27], v[44:47], v[180:183]
    ds_read_b128 v[20:23], v3 offset:18432
    v_mov_b32 v0, s48
    v_mfma_f32_16x16x32_bf16 v[184:187], v[24:27], v[48:51], v[184:187]
    ds_read_b32 v0, v0
    v_mfma_f32_16x16x32_bf16 v[188:191], v[24:27], v[52:55], v[188:191]
    v_mfma_f32_16x16x32_bf16 v[176:179], v[28:31], v[72:75], v[176:179]
    s_add_u32 m0, s29, s38
    s_mov_b64 exec, s[44:45]
    buffer_load_dwordx4 v1, s[64:67], s33 offen sc1 lds
    s_mov_b64 exec, -1
    s_add_u32 s31, s31, 16384
    s_add_u32 s33, s33, 21376
    v_mfma_f32_16x16x32_bf16 v[180:183], v[28:31], v[40:43], v[180:183]
    v_mfma_f32_16x16x32_bf16 v[184:187], v[28:31], v[76:79], v[184:187]
    v_mfma_f32_16x16x32_bf16 v[188:191], v[28:31], v[48:51], v[188:191]
    s_waitcnt lgkmcnt(0)
    v_cmp_eq_u32 vcc, 0, v0
    v_mfma_f32_16x16x32_bf16 v[192:195], v[32:35], v[40:43], v[192:195]
    ds_read_b128 v[24:27], v2 offset:20480
    v_mfma_f32_16x16x32_bf16 v[196:199], v[32:35], v[44:47], v[196:199]
    ds_read_b128 v[28:31], v3 offset:20480
    s_cbranch_vccnz K12_F2
K12_G2:
    v_mfma_f32_16x16x32_bf16 v[200:203], v[32:35], v[48:51], v[200:203]
    s_sub_u32 s43, s42, s41
    s_add_u32 s40, s40, 1
    v_add_u32 v2, s43, v2
    v_mfma_f32_16x16x32_bf16 v[204:207], v[32:35], v[52:55], v[204:207]
    v_add_u32 v3, s43, v3
    v_add_u32 v4, s43, v4
    v_mov_b32 v0, s40
    v_mfma_f32_16x16x32_bf16 v[192:195], v[36:39], v[72:75], v[192:195]
    ds_write_b32 v7, v0
    v_mfma_f32_16x16x32_bf16 v[196:199], v[36:39], v[40:43], v[196:199]
    v_mfma_f32_16x16x32_bf16 v[200:203], v[36:39], v[76:79], v[200:203]
    v_mfma_f32_16x16x32_bf16 v[204:207], v[36:39], v[48:51], v[204:207]
    ds_read_b32 v56, v5
    v_mfma_f32_16x16x32_bf16 v[208:211], v[8:11], v[40:43], v[208:211]
    v_mfma_f32_16x16x32_bf16 v[212:215], v[8:11], v[44:47], v[212:215]
    v_mfma_f32_16x16x32_bf16 v[216:219], v[8:11], v[48:51], v[216:219]
    v_mfma_f32_16x16x32_bf16 v[220:223], v[8:11], v[52:55], v[220:223]
    s_waitcnt lgkmcnt(0)
    v_cmp_gt_u32 vcc, s51, v56
    v_mfma_f32_16x16x32_bf16 v[208:211], v[12:15], v[72:75], v[208:211]
    v_mfma_f32_16x16x32_bf16 v[212:215], v[12:15], v[40:43], v[212:215]
    s_cbranch_vccnz K12_S3
K12_Q3:
    v_mfma_f32_16x16x32_bf16 v[216:219], v[12:15], v[76:79], v[216:219]
    ds_read_b64_tr_b16 v[56:57], v4 offset:0
    v_mfma_f32_16x16x32_bf16 v[220:223], v[12:15], v[48:51], v[220:223]
    ds_read_b64_tr_b16 v[58:59], v4 offset:2048
    v_mfma_f32_16x16x32_bf16 v[224:227], v[16:19], v[40:43], v[224:227]
    ds_read_b64_tr_b16 v[60:61], v4 offset:256
    ds_read_b128 v[8:11], v2 offset:0
    v_mfma_f32_16x16x32_bf16 v[228:231], v[16:19], v[44:47], v[228:231]
    ds_read_b64_tr_b16 v[62:63], v4 offset:2304
    ds_read_b128 v[12:15], v3 offset:0
    v_mfma_f32_16x16x32_bf16 v[232:235], v[16:19], v[48:51], v[232:235]
    v_xor_b32 v4, 32, v4
    ds_read_b128 v[32:35], v2 offset:6144
    v_mfma_f32_16x16x32_bf16 v[236:239], v[16:19], v[52:55], v[236:239]
    ds_read_b64_tr_b16 v[64:65], v4 offset:0
    ds_read_b128 v[36:39], v3 offset:6144
    v_mfma_f32_16x16x32_bf16 v[224:227], v[20:23], v[72:75], v[224:227]
    ds_read_b64_tr_b16 v[66:67], v4 offset:2048
    ds_read_b32 v52, v5
    v_mfma_f32_16x16x32_bf16 v[228:231], v[20:23], v[40:43], v[228:231]
    ds_read_b64_tr_b16 v[68:69], v4 offset:256
    ds_read_b64_tr_b16 v[70:71], v4 offset:2304
    v_xor_b32 v4, 32, v4
    v_mfma_f32_16x16x32_bf16 v[232:235], v[20:23], v[76:79], v[232:235]
    v_mfma_f32_16x16x32_bf16 v[236:239], v[20:23], v[48:51], v[236:239]
    v_mfma_f32_16x16x32_bf16 v[240:243], v[24:27], v[40:43], v[240:243]
    ds_read_b128 v[16:19], v2 offset:2048
    v_mfma_f32_16x16x32_bf16 v[244:247], v[24:27], v[44:47], v[244:247]
    ds_read_b128 v[20:23], v3 offset:2048
    v_mfma_f32_16x16x32_bf16 v[240:243], v[28:31], v[72:75], v[240:243]
    s_mov_b32 s29, s41
    s_mov_b32 s41, s42
    s_add_u32 s42, s42, 38912
    v_mfma_f32_16x16x32_bf16 v[244:247], v[28:31], v[40:43], v[244:247]
    s_cmp_eq_u32 s42, 155648
    s_cselect_b32 s42, 0, s42
    s_waitcnt lgkmcnt(2)
    v_mfma_f32_16x16x32_bf16 v[80:83], v[8:11], v[56:59], v[80:83]
    ds_read_b128 v[24:27], v2 offset:4096
    v_xor_b32 v72, s35, v60
    v_xor_b32 v73, s35, v61
    v_mfma_f32_16x16x32_bf16 v[84:87], v[8:11], v[60:63], v[84:87]
    ds_read_b128 v[28:31], v3 offset:4096
    v_xor_b32 v74, s35, v62
    v_xor_b32 v75, s35, v63
    v_mfma_f32_16x16x32_bf16 v[88:91], v[8:11], v[64:67], v[88:91]
    s_waitcnt lgkmcnt(2)
    v_cmp_gt_u32 vcc, s40, v52
    v_xor_b32 v76, s35, v68
    v_xor_b32 v77, s35, v69
    v_mfma_f32_16x16x32_bf16 v[92:95], v[8:11], v[68:71], v[92:95]
    s_cbranch_vccnz K12_S4
K12_Q4:
    v_xor_b32 v78, s35, v70
    v_xor_b32 v79, s35, v71
    v_mfma_f32_16x16x32_bf16 v[80:83], v[12:15], v[72:75], v[80:83]
    s_add_u32 m0, s29, s36
    s_nop 0
    buffer_load_dwordx4 v1, s[8:11], s30 offen sc1 lds
    v_mfma_f32_16x16x32_bf16 v[84:87], v[12:15], v[56:59], v[84:87]
    v_mfma_f32_16x16x32_bf16 v[88:91], v[12:15], v[76:79], v[88:91]
    v_mfma_f32_16x16x32_bf16 v[92:95], v[12:15], v[64:67], v[92:95]
    v_mfma_f32_16x16x32_bf16 v[96:99], v[16:19], v[56:59], v[96:99]
    ds_read_b128 v[8:11], v2 offset:8192
    v_mfma_f32_16x16x32_bf16 v[100:103], v[16:19], v[60:63], v[100:103]
    ds_read_b128 v[12:15], v3 offset:8192
    v_mfma_f32_16x16x32_bf16 v[104:107], v[16:19], v[64:67], v[104:107]
    buffer_load_dwordx4 v1, s[8:11], s30 offen offset:1024 sc1 lds
    v_mfma_f32_16x16x32_bf16 v[108:111], v[16:19], v[68:71], v[108:111]
    v_mfma_f32_16x16x32_bf16 v[96:99], v[20:23], v[72:75], v[96:99]
    v_mfma_f32_16x16x32_bf16 v[100:103], v[20:23], v[56:59], v[100:103]
    v_mfma_f32_16x16x32_bf16 v[104:107], v[20:23], v[76:79], v[104:107]
    buffer_load_dwordx4 v1, s[8:11], s30 offen offset:2048 sc1 lds
    v_mfma_f32_16x16x32_bf16 v[108:111], v[20:23], v[64:67], v[108:111]
    s_waitcnt lgkmcnt(2)
    v_mfma_f32_16x16x32_bf16 v[112:115], v[24:27], v[56:59], v[112:115]
    ds_read_b128 v[16:19], v2 offset:10240
    v_mfma_f32_16x16x32_bf16 v[116:119], v[24:27], v[60:63], v[116:119]
    ds_read_b128 v[20:23], v3 offset:10240
    v_mfma_f32_16x16x32_bf16 v[120:123], v[24:27], v[64:67], v[120:123]
    v_mfma_f32_16x16x32_bf16 v[124:127], v[24:27], v[68:71], v[124:127]
    v_mfma_f32_16x16x32_bf16 v[112:115], v[28:31], v[72:75], v[112:115]
    buffer_load_dwordx4 v1, s[8:11], s30 offen offset:3072 sc1 lds
    v_mfma_f32_16x16x32_bf16 v[116:119], v[28:31], v[56:59], v[116:119]
    v_mfma_f32_16x16x32_bf16 v[120:123], v[28:31], v[76:79], v[120:123]
    v_mfma_f32_16x16x32_bf16 v[124:127], v[28:31], v[64:67], v[124:127]
    v_mfma_f32_16x16x32_bf16 v[128:131], v[32:35], v[56:59], v[128:131]
    ds_read_b128 v[24:27], v2 offset:12288
    v_mfma_f32_16x16x32_bf16 v[132:135], v[32:35], v[60:63], v[132:135]
    ds_read_b128 v[28:31], v3 offset:12288
    v_mfma_f32_16x16x32_bf16 v[136:139], v[32:35], v[64:67], v[136:139]
    s_add_u32 m0, m0, 4096
    s_add_u32 s34, s30, 4096
    buffer_load_dwordx4 v1, s[8:11], s34 offen sc1 lds
    v_mfma_f32_16x16x32_bf16 v[140:143], v[32:35], v[68:71], v[140:143]
    v_mfma_f32_16x16x32_bf16 v[128:131], v[36:39], v[72:75], v[128:131]
    v_mfma_f32_16x16x32_bf16 v[132:135], v[36:39], v[56:59], v[132:135]
    v_mfma_f32_16x16x32_bf16 v[136:139], v[36:39], v[76:79], v[136:139]
    s_add_u32 m0, s29, s37
    s_add_u32 s30, s30, 21376
    buffer_load_dwordx4 v1, s[12:15], s31 offen sc1 lds
    v_mfma_f32_16x16x32_bf16 v[140:143], v[36:39], v[64:67], v[140:143]
    s_waitcnt lgkmcnt(4)
    v_mfma_f32_16x16x32_bf16 v[144:147], v[8:11], v[56:59], v[144:147]
    ds_read_b128 v[32:35], v2 offset:14336
    v_mfma_f32_16x16x32_bf16 v[148:151], v[8:11], v[60:63], v[148:151]
    ds_read_b128 v[36:39], v3 offset:14336
    v_mfma_f32_16x16x32_bf16 v[152:155], v[8:11], v[64:67], v[152:155]
    v_mfma_f32_16x16x32_bf16 v[156:159], v[8:11], v[68:71], v[156:159]
    v_mfma_f32_16x16x32_bf16 v[144:147], v[12:15], v[72:75], v[144:147]
    buffer_load_dwordx4 v1, s[12:15], s31 offen offset:1024 sc1 lds
    v_mfma_f32_16x16x32_bf16 v[148:151], v[12:15], v[56:59], v[148:151]
    v_mfma_f32_16x16x32_bf16 v[152:155], v[12:15], v[76:79], v[152:155]
    v_mfma_f32_16x16x32_bf16 v[156:159], v[12:15], v[64:67], v[156:159]
    s_waitcnt lgkmcnt(4)
    v_mfma_f32_16x16x32_bf16 v[160:163], v[16:19], v[56:59], v[160:163]
    ds_read_b128 v[8:11], v2 offset:16384
    v_mfma_f32_16x16x32_bf16 v[164:167], v[16:19], v[60:63], v[164:167]
    ds_read_b128 v[12:15], v3 offset:16384
    v_mfma_f32_16x16x32_bf16 v[168:171], v[16:19], v[64:67], v[168:171]
    buffer_load_dwordx4 v1, s[12:15], s31 offen offset:2048 sc1 lds
    v_mfma_f32_16x16x32_bf16 v[172:175], v[16:19], v[68:71], v[172:175]
    s_add_u32 s40, s40, 1
    s_mov_b32 s51, s40
    v_mov_b32 v0, s40
    v_mfma_f32_16x16x32_bf16 v[160:163], v[20:23], v[72:75], v[160:163]
    s_waitcnt vmcnt(19)
    ds_write_b32 v7, v0
    v_mfma_f32_16x16x32_bf16 v[164:167], v[20:23], v[56:59], v[164:167]
    v_mfma_f32_16x16x32_bf16 v[168:171], v[20:23], v[76:79], v[168:171]
    buffer_load_dwordx4 v1, s[12:15], s31 offen offset:3072 sc1 lds
    v_mfma_f32_16x16x32_bf16 v[172:175], v[20:23], v[64:67], v[172:175]
    s_waitcnt lgkmcnt(5)
    v_mfma_f32_16x16x32_bf16 v[176:179], v[24:27], v[56:59], v[176:179]
    ds_read_b128 v[16:19], v2 offset:18432
    v_mfma_f32_16x16x32_bf16 v[180:183], v[24:27], v[60:63], v[180:183]
    ds_read_b128 v[20:23], v3 offset:18432
    v_mfma_f32_16x16x32_bf16 v[184:187], v[24:27], v[64:67], v[184:187]
    v_mfma_f32_16x16x32_bf16 v[188:191], v[24:27], v[68:71], v[188:191]
    v_mfma_f32_16x16x32_bf16 v[176:179], v[28:31], v[72:75], v[176:179]
    s_add_u32 m0, s29, s38
    s_mov_b64 exec, s[44:45]
    buffer_load_dwordx4 v1, s[64:67], s33 offen sc1 lds
    s_mov_b64 exec, -1
    s_add_u32 s31, s31, 16384
    s_add_u32 s33, s33, 21376
    v_mfma_f32_16x16x32_bf16 v[180:183], v[28:31], v[56:59], v[180:183]
    v_mfma_f32_16x16x32_bf16 v[184:187], v[28:31], v[76:79], v[184:187]
    s_mov_b32 m0, s46
    s_mov_b64 exec, 0xff
    buffer_load_dword v1, s[4:7], 0 offen sc1 lds
    s_mov_b64 exec, -1
    v_mfma_f32_16x16x32_bf16 v[188:191], v[28:31], v[64:67], v[188:191]
    s_waitcnt lgkmcnt(5)
    v_mfma_f32_16x16x32_bf16 v[192:195], v[32:35], v[56:59], v[192:195]
    ds_read_b128 v[24:27], v2 offset:20480
    v_mfma_f32_16x16x32_bf16 v[196:199], v[32:35], v[60:63], v[196:199]
    ds_read_b128 v[28:31], v3 offset:20480
    v_mfma_f32_16x16x32_bf16 v[200:203], v[32:35], v[64:67], v[200:203]
    s_sub_u32 s43, s42, s41
    s_add_u32 s40, s40, 1
    v_add_u32 v2, s43, v2
    v_mfma_f32_16x16x32_bf16 v[204:207], v[32:35], v[68:71], v[204:207]
    v_add_u32 v3, s43, v3
    v_add_u32 v4, s43, v4
    v_mov_b32 v0, s40
    v_mfma_f32_16x16x32_bf16 v[192:195], v[36:39], v[72:75], v[192:195]
    ds_write_b32 v7, v0
    v_mfma_f32_16x16x32_bf16 v[196:199], v[36:39], v[56:59], v[196:199]
    v_mfma_f32_16x16x32_bf16 v[200:203], v[36:39], v[76:79], v[200:203]
    v_mfma_f32_16x16x32_bf16 v[204:207], v[36:39], v[64:67], v[204:207]
    ds_read_b32 v40, v5
    s_waitcnt lgkmcnt(7)
    v_mfma_f32_16x16x32_bf16 v[208:211], v[8:11], v[56:59], v[208:211]
    v_mfma_f32_16x16x32_bf16 v[212:215], v[8:11], v[60:63], v[212:215]
    v_mfma_f32_16x16x32_bf16 v[216:219], v[8:11], v[64:67], v[216:219]
    v_mfma_f32_16x16x32_bf16 v[220:223], v[8:11], v[68:71], v[220:223]
    s_waitcnt lgkmcnt(0)
    v_cmp_gt_u32 vcc, s51, v40
    v_mfma_f32_16x16x32_bf16 v[208:211], v[12:15], v[72:75], v[208:211]
    v_mfma_f32_16x16x32_bf16 v[212:215], v[12:15], v[56:59], v[212:215]
    s_cbranch_vccnz K12_S5
K12_Q5:
    v_mfma_f32_16x16x32_bf16 v[216:219], v[12:15], v[76:79], v[216:219]
    ds_read_b64_tr_b16 v[40:41], v4 offset:0
    v_mfma_f32_16x16x32_bf16 v[220:223], v[12:15], v[64:67], v[220:223]
    ds_read_b64_tr_b16 v[42:43], v4 offset:2048
    v_mfma_f32_16x16x32_bf16 v[224:227], v[16:19], v[56:59], v[224:227]
    ds_read_b64_tr_b16 v[44:45], v4 offset:256
    ds_read_b128 v[8:11], v2 offset:0
    v_mfma_f32_16x16x32_bf16 v[228:231], v[16:19], v[60:63], v[228:231]
    ds_read_b64_tr_b16 v[46:47], v4 offset:2304
    ds_read_b128 v[12:15], v3 offset:0
    v_mfma_f32_16x16x32_bf16 v[232:235], v[16:19], v[64:67], v[232:235]
    v_xor_b32 v4, 32, v4
    ds_read_b128 v[32:35], v2 offset:6144
    v_mfma_f32_16x16x32_bf16 v[236:239], v[16:19], v[68:71], v[236:239]
    ds_read_b64_tr_b16 v[48:49], v4 offset:0
    ds_read_b128 v[36:39], v3 offset:6144
    v_mfma_f32_16x16x32_bf16 v[224:227], v[20:23], v[72:75], v[224:227]
    ds_read_b64_tr_b16 v[50:51], v4 offset:2048
    ds_read_b32 v68, v5
    v_mfma_f32_16x16x32_bf16 v[228:231], v[20:23], v[56:59], v[228:231]
    ds_read_b64_tr_b16 v[52:53], v4 offset:256
    ds_read_b64_tr_b16 v[54:55], v4 offset:2304
    v_xor_b32 v4, 32, v4
    v_mfma_f32_16x16x32_bf16 v[232:235], v[20:23], v[76:79], v[232:235]
    v_mfma_f32_16x16x32_bf16 v[236:239], v[20:23], v[64:67], v[236:239]
    v_mfma_f32_16x16x32_bf16 v[240:243], v[24:27], v[56:59], v[240:243]
    ds_read_b128 v[16:19], v2 offset:2048
    v_mfma_f32_16x16x32_bf16 v[244:247], v[24:27], v[60:63], v[244:247]
    ds_read_b128 v[20:23], v3 offset:2048
    v_mfma_f32_16x16x32_bf16 v[240:243], v[28:31], v[72:75], v[240:243]
    s_mov_b32 s29, s41
    s_mov_b32 s41, s42
    s_add_u32 s42, s42, 38912
    v_mfma_f32_16x16x32_bf16 v[244:247], v[28:31], v[56:59], v[244:247]
    s_cmp_eq_u32 s42, 155648
    s_cselect_b32 s42, 0, s42
    s_add_u32 s39, s39, 1
    s_cmp_lt_u32 s39, 15
    s_cbranch_scc1 K12_LOOP
    s_waitcnt lgkmcnt(2)
    v_mfma_f32_16x16x32_bf16 v[80:83], v[8:11], v[40:43], v[80:83]
    ds_read_b128 v[24:27], v2 offset:4096
    v_xor_b32 v72, s35, v44
    v_xor_b32 v73, s35, v45
    v_mfma_f32_16x16x32_bf16 v[84:87], v[8:11], v[44:47], v[84:87]
    ds_read_b128 v[28:31], v3 offset:4096
    v_xor_b32 v74, s35, v46
    v_xor_b32 v75, s35, v47
    v_mfma_f32_16x16x32_bf16 v[88:91], v[8:11], v[48:51], v[88:91]
    s_waitcnt lgkmcnt(2)
    v_cmp_gt_u32 vcc, s40, v68
    s_add_u32 s49, s39, 2
    s_lshr_b32 s49, s49, 1
    v_xor_b32 v76, s35, v52
    v_xor_b32 v77, s35, v53
    v_mfma_f32_16x16x32_bf16 v[92:95], v[8:11], v[52:55], v[92:95]
    s_cbranch_vccnz K12_S6
K12_Q6:
    s_mul_i32 s48, s49, s50
    s_add_u32 s48, s48, s47
    v_xor_b32 v78, s35, v54
    v_xor_b32 v79, s35, v55
    v_mfma_f32_16x16x32_bf16 v[80:83], v[12:15], v[72:75], v[80:83]
    s_add_u32 m0, s29, s36
    s_nop 0
    buffer_load_dwordx4 v1, s[8:11], s30 offen sc1 lds
    v_mfma_f32_16x16x32_bf16 v[84:87], v[12:15], v[40:43], v[84:87]
    s_cmp_lt_u32 s49, 8
    s_cselect_b32 s48, s48, 155744
    v_mfma_f32_16x16x32_bf16 v[88:91], v[12:15], v[76:79], v[88:91]
    s_cmp_ge_u32 s49, 3
    s_cselect_b32 s48, s48, 155744
    v_mfma_f32_16x16x32_bf16 v[92:95], v[12:15], v[48:51], v[92:95]
    v_mfma_f32_16x16x32_bf16 v[96:99], v[16:19], v[40:43], v[96:99]
    ds_read_b128 v[8:11], v2 offset:8192
    v_mfma_f32_16x16x32_bf16 v[100:103], v[16:19], v[44:47], v[100:103]
    ds_read_b128 v[12:15], v3 offset:8192
    v_mfma_f32_16x16x32_bf16 v[104:107], v[16:19], v[48:51], v[104:107]
    buffer_load_dwordx4 v1, s[8:11], s30 offen offset:1024 sc1 lds
    v_mfma_f32_16x16x32_bf16 v[108:111], v[16:19], v[52:55], v[108:111]
    v_mfma_f32_16x16x32_bf16 v[96:99], v[20:23], v[72:75], v[96:99]
    v_mfma_f32_16x16x32_bf16 v[100:103], v[20:23], v[40:43], v[100:103]
    v_mfma_f32_16x16x32_bf16 v[104:107], v[20:23], v[76:79], v[104:107]
    buffer_load_dwordx4 v1, s[8:11], s30 offen offset:2048 sc1 lds
    v_mfma_f32_16x16x32_bf16 v[108:111], v[20:23], v[48:51], v[108:111]
    s_waitcnt lgkmcnt(2)
    v_mfma_f32_16x16x32_bf16 v[112:115], v[24:27], v[40:43], v[112:115]
    ds_read_b128 v[16:19], v2 offset:10240
    v_mfma_f32_16x16x32_bf16 v[116:119], v[24:27], v[44:47], v[116:119]
    ds_read_b128 v[20:23], v3 offset:10240
    v_mfma_f32_16x16x32_bf16 v[120:123], v[24:27], v[48:51], v[120:123]
    v_mfma_f32_16x16x32_bf16 v[124:127], v[24:27], v[52:55], v[124:127]
    v_mfma_f32_16x16x32_bf16 v[112:115], v[28:31], v[72:75], v[112:115]
    buffer_load_dwordx4 v1, s[8:11], s30 offen offset:3072 sc1 lds
    v_mfma_f32_16x16x32_bf16 v[116:119], v[28:31], v[40:43], v[116:119]
    v_mfma_f32_16x16x32_bf16 v[120:123], v[28:31], v[76:79], v[120:123]
    v_mfma_f32_16x16x32_bf16 v[124:127], v[28:31], v[48:51], v[124:127]
    v_mfma_f32_16x16x32_bf16 v[128:131], v[32:35], v[40:43], v[128:131]
    ds_read_b128 v[24:27], v2 offset:12288
    v_mfma_f32_16x16x32_bf16 v[132:135], v[32:35], v[44:47], v[132:135]
    ds_read_b128 v[28:31], v3 offset:12288
    v_mfma_f32_16x16x32_bf16 v[136:139], v[32:35], v[48:51], v[136:139]
    s_add_u32 m0, m0, 4096
    s_add_u32 s34, s30, 4096
    buffer_load_dwordx4 v1, s[8:11], s34 offen sc1 lds
    v_mfma_f32_16x16x32_bf16 v[140:143], v[32:35], v[52:55], v[140:143]
    v_mfma_f32_16x16x32_bf16 v[128:131], v[36:39], v[72:75], v[128:131]
    v_mfma_f32_16x16x32_bf16 v[132:135], v[36:39], v[40:43], v[132:135]
    v_mfma_f32_16x16x32_bf16 v[136:139], v[36:39], v[76:79], v[136:139]
    s_add_u32 m0, s29, s37
    s_add_u32 s30, s30, 21376
    buffer_load_dwordx4 v1, s[12:15], s31 offen sc1 lds
    v_mfma_f32_16x16x32_bf16 v[140:143], v[36:39], v[48:51], v[140:143]
    s_waitcnt lgkmcnt(4)
    v_mfma_f32_16x16x32_bf16 v[144:147], v[8:11], v[40:43], v[144:147]
    ds_read_b128 v[32:35], v2 offset:14336
    v_mfma_f32_16x16x32_bf16 v[148:151], v[8:11], v[44:47], v[148:151]
    ds_read_b128 v[36:39], v3 offset:14336
    v_mfma_f32_16x16x32_bf16 v[152:155], v[8:11], v[48:51], v[152:155]
    v_mfma_f32_16x16x32_bf16 v[156:159], v[8:11], v[52:55], v[156:159]
    v_mfma_f32_16x16x32_bf16 v[144:147], v[12:15], v[72:75], v[144:147]
    buffer_load_dwordx4 v1, s[12:15], s31 offen offset:1024 sc1 lds
    v_mfma_f32_16x16x32_bf16 v[148:151], v[12:15], v[40:43], v[148:151]
    v_mfma_f32_16x16x32_bf16 v[152:155], v[12:15], v[76:79], v[152:155]
    v_mfma_f32_16x16x32_bf16 v[156:159], v[12:15], v[48:51], v[156:159]
    s_waitcnt lgkmcnt(4)
    v_mfma_f32_16x16x32_bf16 v[160:163], v[16:19], v[40:43], v[160:163]
    ds_read_b128 v[8:11], v2 offset:16384
    v_mfma_f32_16x16x32_bf16 v[164:167], v[16:19], v[44:47], v[164:167]
    ds_read_b128 v[12:15], v3 offset:16384
    v_mfma_f32_16x16x32_bf16 v[168:171], v[16:19], v[48:51], v[168:171]
    buffer_load_dwordx4 v1, s[12:15], s31 offen offset:2048 sc1 lds
    v_mfma_f32_16x16x32_bf16 v[172:175], v[16:19], v[52:55], v[172:175]
    s_add_u32 s40, s40, 1
    s_mov_b32 s51, s40
    v_mov_b32 v0, s40
    v_mfma_f32_16x16x32_bf16 v[160:163], v[20:23], v[72:75], v[160:163]
    s_waitcnt vmcnt(19)
    ds_write_b32 v7, v0
    v_mfma_f32_16x16x32_bf16 v[164:167], v[20:23], v[40:43], v[164:167]
    v_mfma_f32_16x16x32_bf16 v[168:171], v[20:23], v[76:79], v[168:171]
    buffer_load_dwordx4 v1, s[12:15], s31 offen offset:3072 sc1 lds
    v_mfma_f32_16x16x32_bf16 v[172:175], v[20:23], v[48:51], v[172:175]
    s_waitcnt lgkmcnt(5)
    v_mfma_f32_16x16x32_bf16 v[176:179], v[24:27], v[40:43], v[176:179]
    ds_read_b128 v[16:19], v2 offset:18432
    v_mfma_f32_16x16x32_bf16 v[180:183], v[24:27], v[44:47], v[180:183]
    ds_read_b128 v[20:23], v3 offset:18432
    v_mov_b32 v0, s48
    v_mfma_f32_16x16x32_bf16 v[184:187], v[24:27], v[48:51], v[184:187]
    ds_read_b32 v0, v0
    v_mfma_f32_16x16x32_bf16 v[188:191], v[24:27], v[52:55], v[188:191]
    v_mfma_f32_16x16x32_bf16 v[176:179], v[28:31], v[72:75], v[176:179]
    s_add_u32 m0, s29, s38
    s_mov_b64 exec, s[44:45]
    buffer_load_dwordx4 v1, s[64:67], s33 offen sc1 lds
    s_mov_b64 exec, -1
    s_add_u32 s31, s31, 16384
    s_add_u32 s33, s33, 21376
    v_mfma_f32_16x16x32_bf16 v[180:183], v[28:31], v[40:43], v[180:183]
    v_mfma_f32_16x16x32_bf16 v[184:187], v[28:31], v[76:79], v[184:187]
    v_mfma_f32_16x16x32_bf16 v[188:191], v[28:31], v[48:51], v[188:191]
    s_waitcnt lgkmcnt(0)
    v_cmp_eq_u32 vcc, 0, v0
    v_mfma_f32_16x16x32_bf16 v[192:195], v[32:35], v[40:43], v[192:195]
    ds_read_b128 v[24:27], v2 offset:20480
    v_mfma_f32_16x16x32_bf16 v[196:199], v[32:35], v[44:47], v[196:199]
    ds_read_b128 v[28:31], v3 offset:20480
    s_cbranch_vccnz K12_F7
K12_G7:
    v_mfma_f32_16x16x32_bf16 v[200:203], v[32:35], v[48:51], v[200:203]
    s_sub_u32 s43, s42, s41
    s_add_u32 s40, s40, 1
    v_add_u32 v2, s43, v2
    v_mfma_f32_16x16x32_bf16 v[204:207], v[32:35], v[52:55], v[204:207]
    v_add_u32 v3, s43, v3
    v_add_u32 v4, s43, v4
    v_mov_b32 v0, s40
    v_mfma_f32_16x16x32_bf16 v[192:195], v[36:39], v[72:75], v[192:195]
    ds_write_b32 v7, v0
    v_mfma_f32_16x16x32_bf16 v[196:199], v[36:39], v[40:43], v[196:199]
    v_mfma_f32_16x16x32_bf16 v[200:203], v[36:39], v[76:79], v[200:203]
    v_mfma_f32_16x16x32_bf16 v[204:207], v[36:39], v[48:51], v[204:207]
    ds_read_b32 v56, v5
    v_mfma_f32_16x16x32_bf16 v[208:211], v[8:11], v[40:43], v[208:211]
    v_mfma_f32_16x16x32_bf16 v[212:215], v[8:11], v[44:47], v[212:215]
    v_mfma_f32_16x16x32_bf16 v[216:219], v[8:11], v[48:51], v[216:219]
    v_mfma_f32_16x16x32_bf16 v[220:223], v[8:11], v[52:55], v[220:223]
    s_waitcnt lgkmcnt(0)
    v_cmp_gt_u32 vcc, s51, v56
    v_mfma_f32_16x16x32_bf16 v[208:211], v[12:15], v[72:75], v[208:211]
    v_mfma_f32_16x16x32_bf16 v[212:215], v[12:15], v[40:43], v[212:215]
    s_cbranch_vccnz K12_S8
K12_Q8:
    v_mfma_f32_16x16x32_bf16 v[216:219], v[12:15], v[76:79], v[216:219]
    ds_read_b64_tr_b16 v[56:57], v4 offset:0
    v_mfma_f32_16x16x32_bf16 v[220:223], v[12:15], v[48:51], v[220:223]
    ds_read_b64_tr_b16 v[58:59], v4 offset:2048
    v_mfma_f32_16x16x32_bf16 v[224:227], v[16:19], v[40:43], v[224:227]
    ds_read_b64_tr_b16 v[60:61], v4 offset:256
    ds_read_b128 v[8:11], v2 offset:0
    v_mfma_f32_16x16x32_bf16 v[228:231], v[16:19], v[44:47], v[228:231]
    ds_read_b64_tr_b16 v[62:63], v4 offset:2304
    ds_read_b128 v[12:15], v3 offset:0
    v_mfma_f32_16x16x32_bf16 v[232:235], v[16:19], v[48:51], v[232:235]
    v_xor_b32 v4, 32, v4
    ds_read_b128 v[32:35], v2 offset:6144
    v_mfma_f32_16x16x32_bf16 v[236:239], v[16:19], v[52:55], v[236:239]
    ds_read_b64_tr_b16 v[64:65], v4 offset:0
    ds_read_b128 v[36:39], v3 offset:6144
    v_mfma_f32_16x16x32_bf16 v[224:227], v[20:23], v[72:75], v[224:227]
    ds_read_b64_tr_b16 v[66:67], v4 offset:2048
    ds_read_b32 v52, v5
    v_mfma_f32_16x16x32_bf16 v[228:231], v[20:23], v[40:43], v[228:231]
    ds_read_b64_tr_b16 v[68:69], v4 offset:256
    ds_read_b64_tr_b16 v[70:71], v4 offset:2304
    v_xor_b32 v4, 32, v4
    v_mfma_f32_16x16x32_bf16 v[232:235], v[20:23], v[76:79], v[232:235]
    v_mfma_f32_16x16x32_bf16 v[236:239], v[20:23], v[48:51], v[236:239]
    v_mfma_f32_16x16x32_bf16 v[240:243], v[24:27], v[40:43], v[240:243]
    ds_read_b128 v[16:19], v2 offset:2048
    v_mfma_f32_16x16x32_bf16 v[244:247], v[24:27], v[44:47], v[244:247]
    ds_read_b128 v[20:23], v3 offset:2048
    v_mfma_f32_16x16x32_bf16 v[240:243], v[28:31], v[72:75], v[240:243]
    s_mov_b32 s29, s41
    s_mov_b32 s41, s42
    s_add_u32 s42, s42, 38912
    v_mfma_f32_16x16x32_bf16 v[244:247], v[28:31], v[40:43], v[244:247]
    s_cmp_eq_u32 s42, 155648
    s_cselect_b32 s42, 0, s42
    s_waitcnt lgkmcnt(2)
    v_mfma_f32_16x16x32_bf16 v[80:83], v[8:11], v[56:59], v[80:83]
    ds_read_b128 v[24:27], v2 offset:4096
    v_xor_b32 v72, s35, v60
    v_xor_b32 v73, s35, v61
    v_mfma_f32_16x16x32_bf16 v[84:87], v[8:11], v[60:63], v[84:87]
    ds_read_b128 v[28:31], v3 offset:4096
    v_xor_b32 v74, s35, v62
    v_xor_b32 v75, s35, v63
    v_mfma_f32_16x16x32_bf16 v[88:91], v[8:11], v[64:67], v[88:91]
    v_xor_b32 v76, s35, v68
    v_xor_b32 v77, s35, v69
    v_mfma_f32_16x16x32_bf16 v[92:95], v[8:11], v[68:71], v[92:95]
    v_xor_b32 v78, s35, v70
    v_xor_b32 v79, s35, v71
    v_mfma_f32_16x16x32_bf16 v[80:83], v[12:15], v[72:75], v[80:83]
    v_lshrrev_b32 v0, 4, v1
    v_and_b32 v5, 15, v0
    v_mfma_f32_16x16x32_bf16 v[84:87], v[12:15], v[56:59], v[84:87]
    v_lshrrev_b32 v0, 4, v0
    s_lshl_b32 s28, s21, 7
    v_mfma_f32_16x16x32_bf16 v[88:91], v[12:15], v[76:79], v[88:91]
    s_lshl_b32 s29, s3, 5
    s_add_u32 s28, s28, s29
    v_mfma_f32_16x16x32_bf16 v[92:95], v[12:15], v[64:67], v[92:95]
    v_add_u32 v5, s28, v5
    v_lshlrev_b32 v5, 2, v5
    s_waitcnt lgkmcnt(2)
    v_mfma_f32_16x16x32_bf16 v[96:99], v[16:19], v[56:59], v[96:99]
    ds_read_b128 v[8:11], v2 offset:8192
    v_lshl_add_u32 v5, v0, 13, v5
    s_lshl_b32 s28, s20, 6
    v_mfma_f32_16x16x32_bf16 v[100:103], v[16:19], v[60:63], v[100:103]
    ds_read_b128 v[12:15], v3 offset:8192
    v_xor_b32 v5, s28, v5
    v_xor_b32 v7, 64, v5
    v_mfma_f32_16x16x32_bf16 v[104:107], v[16:19], v[64:67], v[104:107]
    v_mfma_f32_16x16x32_bf16 v[108:111], v[16:19], v[68:71], v[108:111]
    s_mov_b32 s38, 0
    v_cvt_pk_bf16_f32 v48, v80, v84
    buffer_store_dword v48, v5, s[16:19], s38 offen offset:0 sc1
    v_cvt_pk_bf16_f32 v49, v88, v92
    buffer_store_dword v49, v7, s[16:19], s38 offen offset:0 sc1
    v_mfma_f32_16x16x32_bf16 v[96:99], v[20:23], v[72:75], v[96:99]
    v_cvt_pk_bf16_f32 v50, v81, v85
    buffer_store_dword v50, v5, s[16:19], s38 offen offset:2048 sc1
    v_mfma_f32_16x16x32_bf16 v[100:103], v[20:23], v[56:59], v[100:103]
    v_cvt_pk_bf16_f32 v51, v89, v93
    buffer_store_dword v51, v7, s[16:19], s38 offen offset:2048 sc1
    v_mfma_f32_16x16x32_bf16 v[104:107], v[20:23], v[76:79], v[104:107]
    s_mov_b32 s38, 4096
    v_cvt_pk_bf16_f32 v52, v82, v86
    buffer_store_dword v52, v5, s[16:19], s38 offen offset:0 sc1
    v_cvt_pk_bf16_f32 v53, v90, v94
    buffer_store_dword v53, v7, s[16:19], s38 offen offset:0 sc1
    v_mfma_f32_16x16x32_bf16 v[108:111], v[20:23], v[64:67], v[108:111]
    v_cvt_pk_bf16_f32 v54, v83, v87
    buffer_store_dword v54, v5, s[16:19], s38 offen offset:2048 sc1
    s_waitcnt lgkmcnt(2)
    v_mfma_f32_16x16x32_bf16 v[112:115], v[24:27], v[56:59], v[112:115]
    ds_read_b128 v[16:19], v2 offset:10240
    v_cvt_pk_bf16_f32 v55, v91, v95
    buffer_store_dword v55, v7, s[16:19], s38 offen offset:2048 sc1
    v_mfma_f32_16x16x32_bf16 v[116:119], v[24:27], v[60:63], v[116:119]
    ds_read_b128 v[20:23], v3 offset:10240
    v_mfma_f32_16x16x32_bf16 v[120:123], v[24:27], v[64:67], v[120:123]
    v_mfma_f32_16x16x32_bf16 v[124:127], v[24:27], v[68:71], v[124:127]
    s_mov_b32 s38, 32768
    v_cvt_pk_bf16_f32 v40, v96, v100
    buffer_store_dword v40, v5, s[16:19], s38 offen offset:0 sc1
    v_cvt_pk_bf16_f32 v41, v104, v108
    buffer_store_dword v41, v7, s[16:19], s38 offen offset:0 sc1
    v_mfma_f32_16x16x32_bf16 v[112:115], v[28:31], v[72:75], v[112:115]
    v_cvt_pk_bf16_f32 v42, v97, v101
    buffer_store_dword v42, v5, s[16:19], s38 offen offset:2048 sc1
    v_mfma_f32_16x16x32_bf16 v[116:119], v[28:31], v[56:59], v[116:119]
    v_cvt_pk_bf16_f32 v43, v105, v109
    buffer_store_dword v43, v7, s[16:19], s38 offen offset:2048 sc1
    v_mfma_f32_16x16x32_bf16 v[120:123], v[28:31], v[76:79], v[120:123]
    s_mov_b32 s38, 36864
    v_cvt_pk_bf16_f32 v44, v98, v102
    buffer_store_dword v44, v5, s[16:19], s38 offen offset:0 sc1
    v_cvt_pk_bf16_f32 v45, v106, v110
    buffer_store_dword v45, v7, s[16:19], s38 offen offset:0 sc1
    v_mfma_f32_16x16x32_bf16 v[124:127], v[28:31], v[64:67], v[124:127]
    v_cvt_pk_bf16_f32 v46, v99, v103
    buffer_store_dword v46, v5, s[16:19], s38 offen offset:2048 sc1
    v_mfma_f32_16x16x32_bf16 v[128:131], v[32:35], v[56:59], v[128:131]
    ds_read_b128 v[24:27], v2 offset:12288
    v_cvt_pk_bf16_f32 v47, v107, v111
    buffer_store_dword v47, v7, s[16:19], s38 offen offset:2048 sc1
    v_mfma_f32_16x16x32_bf16 v[132:135], v[32:35], v[60:63], v[132:135]
    ds_read_b128 v[28:31], v3 offset:12288
    v_mfma_f32_16x16x32_bf16 v[136:139], v[32:35], v[64:67], v[136:139]
    v_mfma_f32_16x16x32_bf16 v[140:143], v[32:35], v[68:71], v[140:143]
    s_mov_b32 s38, 65536
    v_cvt_pk_bf16_f32 v48, v112, v116
    buffer_store_dword v48, v5, s[16:19], s38 offen offset:0 sc1
    v_cvt_pk_bf16_f32 v49, v120, v124
    buffer_store_dword v49, v7, s[16:19], s38 offen offset:0 sc1
    v_mfma_f32_16x16x32_bf16 v[128:131], v[36:39], v[72:75], v[128:131]
    v_cvt_pk_bf16_f32 v50, v113, v117
    buffer_store_dword v50, v5, s[16:19], s38 offen offset:2048 sc1
    v_mfma_f32_16x16x32_bf16 v[132:135], v[36:39], v[56:59], v[132:135]
    v_cvt_pk_bf16_f32 v51, v121, v125
    buffer_store_dword v51, v7, s[16:19], s38 offen offset:2048 sc1
    v_mfma_f32_16x16x32_bf16 v[136:139], v[36:39], v[76:79], v[136:139]
    s_mov_b32 s38, 69632
    v_cvt_pk_bf16_f32 v52, v114, v118
    buffer_store_dword v52, v5, s[16:19], s38 offen offset:0 sc1
    v_cvt_pk_bf16_f32 v53, v122, v126
    buffer_store_dword v53, v7, s[16:19], s38 offen offset:0 sc1
    v_mfma_f32_16x16x32_bf16 v[140:143], v[36:39], v[64:67], v[140:143]
    v_cvt_pk_bf16_f32 v54, v115, v119
    buffer_store_dword v54, v5, s[16:19], s38 offen offset:2048 sc1
    s_waitcnt lgkmcnt(4)
    v_mfma_f32_16x16x32_bf16 v[144:147], v[8:11], v[56:59], v[144:147]
    ds_read_b128 v[32:35], v2 offset:14336
    v_cvt_pk_bf16_f32 v55, v123, v127
    buffer_store_dword v55, v7, s[16:19], s38 offen offset:2048 sc1
    v_mfma_f32_16x16x32_bf16 v[148:151], v[8:11], v[60:63], v[148:151]
    ds_read_b128 v[36:39], v3 offset:14336
    v_mfma_f32_16x16x32_bf16 v[152:155], v[8:11], v[64:67], v[152:155]
    v_mfma_f32_16x16x32_bf16 v[156:159], v[8:11], v[68:71], v[156:159]
    s_mov_b32 s38, 98304
    v_cvt_pk_bf16_f32 v40, v128, v132
    buffer_store_dword v40, v5, s[16:19], s38 offen offset:0 sc1
    v_cvt_pk_bf16_f32 v41, v136, v140
    buffer_store_dword v41, v7, s[16:19], s38 offen offset:0 sc1
    v_mfma_f32_16x16x32_bf16 v[144:147], v[12:15], v[72:75], v[144:147]
    v_cvt_pk_bf16_f32 v42, v129, v133
    buffer_store_dword v42, v5, s[16:19], s38 offen offset:2048 sc1
    v_mfma_f32_16x16x32_bf16 v[148:151], v[12:15], v[56:59], v[148:151]
    v_cvt_pk_bf16_f32 v43, v137, v141
    buffer_store_dword v43, v7, s[16:19], s38 offen offset:2048 sc1
    v_mfma_f32_16x16x32_bf16 v[152:155], v[12:15], v[76:79], v[152:155]
    s_mov_b32 s38, 102400
    v_cvt_pk_bf16_f32 v44, v130, v134
    buffer_store_dword v44, v5, s[16:19], s38 offen offset:0 sc1
    v_cvt_pk_bf16_f32 v45, v138, v142
    buffer_store_dword v45, v7, s[16:19], s38 offen offset:0 sc1
    v_mfma_f32_16x16x32_bf16 v[156:159], v[12:15], v[64:67], v[156:159]
    v_cvt_pk_bf16_f32 v46, v131, v135
    buffer_store_dword v46, v5, s[16:19], s38 offen offset:2048 sc1
    s_waitcnt lgkmcnt(4)
    v_mfma_f32_16x16x32_bf16 v[160:163], v[16:19], v[56:59], v[160:163]
    ds_read_b128 v[8:11], v2 offset:16384
    v_cvt_pk_bf16_f32 v47, v139, v143
    buffer_store_dword v47, v7, s[16:19], s38 offen offset:2048 sc1
    v_mfma_f32_16x16x32_bf16 v[164:167], v[16:19], v[60:63], v[164:167]
    ds_read_b128 v[12:15], v3 offset:16384
    v_mfma_f32_16x16x32_bf16 v[168:171], v[16:19], v[64:67], v[168:171]
    v_mfma_f32_16x16x32_bf16 v[172:175], v[16:19], v[68:71], v[172:175]
    s_mov_b32 s38, 131072
    v_cvt_pk_bf16_f32 v48, v144, v148
    buffer_store_dword v48, v5, s[16:19], s38 offen offset:0 sc1
    v_cvt_pk_bf16_f32 v49, v152, v156
    buffer_store_dword v49, v7, s[16:19], s38 offen offset:0 sc1
    v_mfma_f32_16x16x32_bf16 v[160:163], v[20:23], v[72:75], v[160:163]
    v_cvt_pk_bf16_f32 v50, v145, v149
    buffer_store_dword v50, v5, s[16:19], s38 offen offset:2048 sc1
    v_mfma_f32_16x16x32_bf16 v[164:167], v[20:23], v[56:59], v[164:167]
    v_cvt_pk_bf16_f32 v51, v153, v157
    buffer_store_dword v51, v7, s[16:19], s38 offen offset:2048 sc1
    v_mfma_f32_16x16x32_bf16 v[168:171], v[20:23], v[76:79], v[168:171]
    s_mov_b32 s38, 135168
    v_cvt_pk_bf16_f32 v52, v146, v150
    buffer_store_dword v52, v5, s[16:19], s38 offen offset:0 sc1
    v_cvt_pk_bf16_f32 v53, v154, v158
    buffer_store_dword v53, v7, s[16:19], s38 offen offset:0 sc1
    v_mfma_f32_16x16x32_bf16 v[172:175], v[20:23], v[64:67], v[172:175]
    v_cvt_pk_bf16_f32 v54, v147, v151
    buffer_store_dword v54, v5, s[16:19], s38 offen offset:2048 sc1
    s_waitcnt lgkmcnt(4)
    v_mfma_f32_16x16x32_bf16 v[176:179], v[24:27], v[56:59], v[176:179]
    ds_read_b128 v[16:19], v2 offset:18432
    v_cvt_pk_bf16_f32 v55, v155, v159
    buffer_store_dword v55, v7, s[16:19], s38 offen offset:2048 sc1
    v_mfma_f32_16x16x32_bf16 v[180:183], v[24:27], v[60:63], v[180:183]
    ds_read_b128 v[20:23], v3 offset:18432
    v_mfma_f32_16x16x32_bf16 v[184:187], v[24:27], v[64:67], v[184:187]
    v_mfma_f32_16x16x32_bf16 v[188:191], v[24:27], v[68:71], v[188:191]
    s_mov_b32 s38, 163840
    v_cvt_pk_bf16_f32 v40, v160, v164
    buffer_store_dword v40, v5, s[16:19], s38 offen offset:0 sc1
    v_cvt_pk_bf16_f32 v41, v168, v172
    buffer_store_dword v41, v7, s[16:19], s38 offen offset:0 sc1
    v_mfma_f32_16x16x32_bf16 v[176:179], v[28:31], v[72:75], v[176:179]
    v_cvt_pk_bf16_f32 v42, v161, v165
    buffer_store_dword v42, v5, s[16:19], s38 offen offset:2048 sc1
    v_mfma_f32_16x16x32_bf16 v[180:183], v[28:31], v[56:59], v[180:183]
    v_cvt_pk_bf16_f32 v43, v169, v173
    buffer_store_dword v43, v7, s[16:19], s38 offen offset:2048 sc1
    v_mfma_f32_16x16x32_bf16 v[184:187], v[28:31], v[76:79], v[184:187]
    s_mov_b32 s38, 167936
    v_cvt_pk_bf16_f32 v44, v162, v166
    buffer_store_dword v44, v5, s[16:19], s38 offen offset:0 sc1
    v_cvt_pk_bf16_f32 v45, v170, v174
    buffer_store_dword v45, v7, s[16:19], s38 offen offset:0 sc1
    v_mfma_f32_16x16x32_bf16 v[188:191], v[28:31], v[64:67], v[188:191]
    v_cvt_pk_bf16_f32 v46, v163, v167
    buffer_store_dword v46, v5, s[16:19], s38 offen offset:2048 sc1
    s_waitcnt lgkmcnt(4)
    v_mfma_f32_16x16x32_bf16 v[192:195], v[32:35], v[56:59], v[192:195]
    ds_read_b128 v[24:27], v2 offset:20480
    v_cvt_pk_bf16_f32 v47, v171, v175
    buffer_store_dword v47, v7, s[16:19], s38 offen offset:2048 sc1
    v_mfma_f32_16x16x32_bf16 v[196:199], v[32:35], v[60:63], v[196:199]
    ds_read_b128 v[28:31], v3 offset:20480
    v_mfma_f32_16x16x32_bf16 v[200:203], v[32:35], v[64:67], v[200:203]
    v_mfma_f32_16x16x32_bf16 v[204:207], v[32:35], v[68:71], v[204:207]
    s_mov_b32 s38, 196608
    v_cvt_pk_bf16_f32 v48, v176, v180
    buffer_store_dword v48, v5, s[16:19], s38 offen offset:0 sc1
    v_cvt_pk_bf16_f32 v49, v184, v188
    buffer_store_dword v49, v7, s[16:19], s38 offen offset:0 sc1
    v_mfma_f32_16x16x32_bf16 v[192:195], v[36:39], v[72:75], v[192:195]
    v_cvt_pk_bf16_f32 v50, v177, v181
    buffer_store_dword v50, v5, s[16:19], s38 offen offset:2048 sc1
    v_mfma_f32_16x16x32_bf16 v[196:199], v[36:39], v[56:59], v[196:199]
    v_cvt_pk_bf16_f32 v51, v185, v189
    buffer_store_dword v51, v7, s[16:19], s38 offen offset:2048 sc1
    v_mfma_f32_16x16x32_bf16 v[200:203], v[36:39], v[76:79], v[200:203]
    s_mov_b32 s38, 200704
    v_cvt_pk_bf16_f32 v52, v178, v182
    buffer_store_dword v52, v5, s[16:19], s38 offen offset:0 sc1
    v_cvt_pk_bf16_f32 v53, v186, v190
    buffer_store_dword v53, v7, s[16:19], s38 offen offset:0 sc1
    v_mfma_f32_16x16x32_bf16 v[204:207], v[36:39], v[64:67], v[204:207]
    v_cvt_pk_bf16_f32 v54, v179, v183
    buffer_store_dword v54, v5, s[16:19], s38 offen offset:2048 sc1
    s_waitcnt lgkmcnt(4)
    v_mfma_f32_16x16x32_bf16 v[208:211], v[8:11], v[56:59], v[208:211]
    v_cvt_pk_bf16_f32 v55, v187, v191
    buffer_store_dword v55, v7, s[16:19], s38 offen offset:2048 sc1
    v_mfma_f32_16x16x32_bf16 v[212:215], v[8:11], v[60:63], v[212:215]
    v_mfma_f32_16x16x32_bf16 v[216:219], v[8:11], v[64:67], v[216:219]
    v_mfma_f32_16x16x32_bf16 v[220:223], v[8:11], v[68:71], v[220:223]
    s_mov_b32 s38, 229376
    v_cvt_pk_bf16_f32 v40, v192, v196
    buffer_store_dword v40, v5, s[16:19], s38 offen offset:0 sc1
    v_cvt_pk_bf16_f32 v41, v200, v204
    buffer_store_dword v41, v7, s[16:19], s38 offen offset:0 sc1
    v_mfma_f32_16x16x32_bf16 v[208:211], v[12:15], v[72:75], v[208:211]
    v_cvt_pk_bf16_f32 v42, v193, v197
    buffer_store_dword v42, v5, s[16:19], s38 offen offset:2048 sc1
    v_mfma_f32_16x16x32_bf16 v[212:215], v[12:15], v[56:59], v[212:215]
    v_cvt_pk_bf16_f32 v43, v201, v205
    buffer_store_dword v43, v7, s[16:19], s38 offen offset:2048 sc1
    v_mfma_f32_16x16x32_bf16 v[216:219], v[12:15], v[76:79], v[216:219]
    s_mov_b32 s38, 233472
    v_cvt_pk_bf16_f32 v44, v194, v198
    buffer_store_dword v44, v5, s[16:19], s38 offen offset:0 sc1
    v_cvt_pk_bf16_f32 v45, v202, v206
    buffer_store_dword v45, v7, s[16:19], s38 offen offset:0 sc1
    v_mfma_f32_16x16x32_bf16 v[220:223], v[12:15], v[64:67], v[220:223]
    v_cvt_pk_bf16_f32 v46, v195, v199
    buffer_store_dword v46, v5, s[16:19], s38 offen offset:2048 sc1
    s_waitcnt lgkmcnt(2)
    v_mfma_f32_16x16x32_bf16 v[224:227], v[16:19], v[56:59], v[224:227]
    v_cvt_pk_bf16_f32 v47, v203, v207
    buffer_store_dword v47, v7, s[16:19], s38 offen offset:2048 sc1
    v_mfma_f32_16x16x32_bf16 v[228:231], v[16:19], v[60:63], v[228:231]
    v_mfma_f32_16x16x32_bf16 v[232:235], v[16:19], v[64:67], v[232:235]
    v_mfma_f32_16x16x32_bf16 v[236:239], v[16:19], v[68:71], v[236:239]
    s_mov_b32 s38, 262144
    v_cvt_pk_bf16_f32 v48, v208, v212
    buffer_store_dword v48, v5, s[16:19], s38 offen offset:0 sc1
    v_cvt_pk_bf16_f32 v49, v216, v220
    buffer_store_dword v49, v7, s[16:19], s38 offen offset:0 sc1
    v_mfma_f32_16x16x32_bf16 v[224:227], v[20:23], v[72:75], v[224:227]
    v_cvt_pk_bf16_f32 v50, v209, v213
    buffer_store_dword v50, v5, s[16:19], s38 offen offset:2048 sc1
    v_mfma_f32_16x16x32_bf16 v[228:231], v[20:23], v[56:59], v[228:231]
    v_cvt_pk_bf16_f32 v51, v217, v221
    buffer_store_dword v51, v7, s[16:19], s38 offen offset:2048 sc1
    v_mfma_f32_16x16x32_bf16 v[232:235], v[20:23], v[76:79], v[232:235]
    s_mov_b32 s38, 266240
    v_cvt_pk_bf16_f32 v52, v210, v214
    buffer_store_dword v52, v5, s[16:19], s38 offen offset:0 sc1
    v_cvt_pk_bf16_f32 v53, v218, v222
    buffer_store_dword v53, v7, s[16:19], s38 offen offset:0 sc1
    v_mfma_f32_16x16x32_bf16 v[236:239], v[20:23], v[64:67], v[236:239]
    v_cvt_pk_bf16_f32 v54, v211, v215
    buffer_store_dword v54, v5, s[16:19], s38 offen offset:2048 sc1
    s_waitcnt lgkmcnt(0)
    v_mfma_f32_16x16x32_bf16 v[240:243], v[24:27], v[56:59], v[240:243]
    v_cvt_pk_bf16_f32 v55, v219, v223
    buffer_store_dword v55, v7, s[16:19], s38 offen offset:2048 sc1
    v_mfma_f32_16x16x32_bf16 v[244:247], v[24:27], v[60:63], v[244:247]
    v_mfma_f32_16x16x32_bf16 v[240:243], v[28:31], v[72:75], v[240:243]
    v_mfma_f32_16x16x32_bf16 v[244:247], v[28:31], v[56:59], v[244:247]
    s_mov_b32 s38, 294912
    v_cvt_pk_bf16_f32 v40, v224, v228
    buffer_store_dword v40, v5, s[16:19], s38 offen offset:0 sc1
    v_cvt_pk_bf16_f32 v41, v232, v236
    buffer_store_dword v41, v7, s[16:19], s38 offen offset:0 sc1
    v_cvt_pk_bf16_f32 v42, v225, v229
    buffer_store_dword v42, v5, s[16:19], s38 offen offset:2048 sc1
    v_cvt_pk_bf16_f32 v43, v233, v237
    buffer_store_dword v43, v7, s[16:19], s38 offen offset:2048 sc1
    s_mov_b32 s38, 299008
    v_cvt_pk_bf16_f32 v44, v226, v230
    buffer_store_dword v44, v5, s[16:19], s38 offen offset:0 sc1
    v_cvt_pk_bf16_f32 v45, v234, v238
    buffer_store_dword v45, v7, s[16:19], s38 offen offset:0 sc1
    v_cvt_pk_bf16_f32 v46, v227, v231
    buffer_store_dword v46, v5, s[16:19], s38 offen offset:2048 sc1
    v_cvt_pk_bf16_f32 v47, v235, v239
    buffer_store_dword v47, v7, s[16:19], s38 offen offset:2048 sc1
    s_nop 7
    s_lshl_b32 s34, s27, 1
    s_mul_i32 s34, s34, 342016
    s_add_u32 s34, s34, 118489088
    s_add_u32 s64, s58, s34
    s_addc_u32 s65, s59, 0
    s_and_b32 s65, s65, 0xffff
    s_mov_b32 s66, 684032
    s_mov_b32 s67, 0x00020000
    v_lshrrev_b32 v8, 8, v1
    v_lshlrev_b32 v9, 13, v8
    v_sub_u32 v9, v5, v9
    v_lshlrev_b32 v8, 2, v8
    v_add_u32 v8, 160, v8
    v_add_u32 v10, 0, v8
    v_add_u32 v11, 160, v10
    v_cmp_gt_u32 vcc, 167, v10
    s_nop 1
    v_cndmask_b32 v11, v11, v10, vcc
    v_cmp_gt_u32 vcc, 174, v10
    v_mov_b32 v12, 0x7ffff
    s_nop 0
    v_cndmask_b32 v11, v12, v11, vcc
    v_lshl_add_u32 v16, v11, 11, v9
    v_add_u32 v10, 1, v8
    v_add_u32 v11, 160, v10
    v_cmp_gt_u32 vcc, 167, v10
    s_nop 1
    v_cndmask_b32 v11, v11, v10, vcc
    v_cmp_gt_u32 vcc, 174, v10
    v_mov_b32 v12, 0x7ffff
    s_nop 0
    v_cndmask_b32 v11, v12, v11, vcc
    v_lshl_add_u32 v17, v11, 11, v9
    v_add_u32 v10, 2, v8
    v_add_u32 v11, 160, v10
    v_cmp_gt_u32 vcc, 167, v10
    s_nop 1
    v_cndmask_b32 v11, v11, v10, vcc
    v_cmp_gt_u32 vcc, 174, v10
    v_mov_b32 v12, 0x7ffff
    s_nop 0
    v_cndmask_b32 v11, v12, v11, vcc
    v_lshl_add_u32 v18, v11, 11, v9
    v_add_u32 v10, 3, v8
    v_add_u32 v11, 160, v10
    v_cmp_gt_u32 vcc, 167, v10
    s_nop 1
    v_cndmask_b32 v11, v11, v10, vcc
    v_cmp_gt_u32 vcc, 174, v10
    v_mov_b32 v12, 0x7ffff
    s_nop 0
    v_cndmask_b32 v11, v12, v11, vcc
    v_lshl_add_u32 v19, v11, 11, v9
    v_cvt_pk_bf16_f32 v20, v240, v244
    buffer_store_dword v20, v16, s[64:67], 0 offen sc1
    v_cvt_pk_bf16_f32 v21, v241, v245
    buffer_store_dword v21, v17, s[64:67], 0 offen sc1
    v_cvt_pk_bf16_f32 v22, v242, v246
    buffer_store_dword v22, v18, s[64:67], 0 offen sc1
    v_cvt_pk_bf16_f32 v23, v243, v247
    buffer_store_dword v23, v19, s[64:67], 0 offen sc1
    s_endpgm
K12_S0:
    s_mov_b32 s61, 16384
    s_add_u32 s62, s62, 1
K12_S0_L:
    ds_read_b32 v56, v5
    s_waitcnt lgkmcnt(0)
    v_cmp_gt_u32 vcc, s40, v56
    s_sub_u32 s61, s61, 1
    s_cmp_eq_u32 s61, 0
    s_cbranch_scc1 K12_Q0
    s_cbranch_vccz K12_Q0
    s_branch K12_S0_L
K12_S1:
    s_mov_b32 s61, 16384
    s_add_u32 s62, s62, 1
K12_S1_L:
    ds_read_b32 v68, v5
    s_waitcnt lgkmcnt(0)
    v_cmp_gt_u32 vcc, s40, v68
    s_sub_u32 s61, s61, 1
    s_cmp_eq_u32 s61, 0
    s_cbranch_scc1 K12_Q1
    s_cbranch_vccz K12_Q1
    s_branch K12_S1_L
K12_F2:
    s_mov_b32 s61, 16384
    s_add_u32 s63, s63, 1
K12_F2_L:
    s_mov_b32 m0, s46
    s_mov_b64 exec, 0xff
    buffer_load_dword v1, s[4:7], 0 offen sc1 lds
    s_mov_b64 exec, -1
    s_waitcnt vmcnt(0)
    v_mov_b32 v0, s48
    ds_read_b32 v0, v0
    s_waitcnt lgkmcnt(0)
    v_cmp_eq_u32 vcc, 0, v0
    s_sub_u32 s61, s61, 1
    s_cmp_eq_u32 s61, 0
    s_cbranch_scc1 K12_F2_X
    s_cbranch_vccz K12_F2_X
    s_sleep 2
    s_branch K12_F2_L
K12_F2_X:
    s_branch K12_G2
K12_S3:
    s_mov_b32 s61, 16384
    s_add_u32 s62, s62, 1
K12_S3_L:
    ds_read_b32 v56, v5
    s_waitcnt lgkmcnt(0)
    v_cmp_gt_u32 vcc, s51, v56
    s_sub_u32 s61, s61, 1
    s_cmp_eq_u32 s61, 0
    s_cbranch_scc1 K12_Q3
    s_cbranch_vccz K12_Q3
    s_branch K12_S3_L
K12_S4:
    s_mov_b32 s61, 16384
    s_add_u32 s62, s62, 1
K12_S4_L:
    ds_read_b32 v52, v5
    s_waitcnt lgkmcnt(0)
    v_cmp_gt_u32 vcc, s40, v52
    s_sub_u32 s61, s61, 1
    s_cmp_eq_u32 s61, 0
    s_cbranch_scc1 K12_Q4
    s_cbranch_vccz K12_Q4
    s_branch K12_S4_L
K12_S5:
    s_mov_b32 s61, 16384
    s_add_u32 s62, s62, 1
K12_S5_L:
    ds_read_b32 v40, v5
    s_waitcnt lgkmcnt(0)
    v_cmp_gt_u32 vcc, s51, v40
    s_sub_u32 s61, s61, 1
    s_cmp_eq_u32 s61, 0
    s_cbranch_scc1 K12_Q5
    s_cbranch_vccz K12_Q5
    s_branch K12_S5_L
K12_S6:
    s_mov_b32 s61, 16384
    s_add_u32 s62, s62, 1
K12_S6_L:
    ds_read_b32 v68, v5
    s_waitcnt lgkmcnt(0)
    v_cmp_gt_u32 vcc, s40, v68
    s_sub_u32 s61, s61, 1
    s_cmp_eq_u32 s61, 0
    s_cbranch_scc1 K12_Q6
    s_cbranch_vccz K12_Q6
    s_branch K12_S6_L
K12_F7:
    s_mov_b32 s61, 16384
    s_add_u32 s63, s63, 1
K12_F7_L:
    s_mov_b32 m0, s46
    s_mov_b64 exec, 0xff
    buffer_load_dword v1, s[4:7], 0 offen sc1 lds
    s_mov_b64 exec, -1
    s_waitcnt vmcnt(0)
    v_mov_b32 v0, s48
    ds_read_b32 v0, v0
    s_waitcnt lgkmcnt(0)
    v_cmp_eq_u32 vcc, 0, v0
    s_sub_u32 s61, s61, 1
    s_cmp_eq_u32 s61, 0
    s_cbranch_scc1 K12_F7_X
    s_cbranch_vccz K12_F7_X
    s_sleep 2
    s_branch K12_F7_L
K12_F7_X:
    s_branch K12_G7
K12_S8:
    s_mov_b32 s61, 16384
    s_add_u32 s62, s62, 1
K12_S8_L:
    ds_read_b32 v56, v5
    s_waitcnt lgkmcnt(0)
    v_cmp_gt_u32 vcc, s51, v56
    s_sub_u32 s61, s61, 1
    s_cmp_eq_u32 s61, 0
    s_cbranch_scc1 K12_Q8
    s_cbranch_vccz K12_Q8
    s_branch K12_S8_L
K12_END:
    s_endpgm
.p2align 8
.type k34_out_kernel,@function
k34_out_kernel:
    s_cmp_ge_u32 s2, 256
    s_cbranch_scc1 K34_END
    s_load_dwordx2 s[4:5], s[0:1], 48
    s_load_dwordx4 s[40:43], s[0:1], 16
    s_load_dwordx2 s[44:45], s[0:1], 32
    v_lshrrev_b32 v1, 6, v0
    v_and_b32 v2, 63, v0
    v_readfirstlane_b32 s3, v1
    s_and_b32 s6, s2, 15
    s_lshr_b32 s7, s2, 4
    s_lshr_b32 s20, s6, 3
    s_and_b32 s21, s6, 7
    s_mul_i32 s22, s7, 11
    s_mul_i32 s23, s7, 10
    s_add_u32 s23, s23, 7
    s_cmp_lt_u32 s7, 7
    s_cselect_b32 s22, s22, s23
    s_cselect_b32 s23, 11, 10
    s_add_u32 s22, s22, s3
    v_and_b32 v3, 15, v2
    v_lshrrev_b32 v4, 4, v2
    v_lshlrev_b32 v5, 4, v2
    s_mov_b32 s24, 2736128
    v_mul_lo_u32 v6, v4, s24
    v_lshl_add_u32 v6, v3, 4, v6
    s_mul_i32 s25, s20, 167
    s_add_u32 s25, s25, s22
    s_lshl_b32 s25, s25, 11
    s_lshl_b32 s24, s21, 8
    s_add_u32 s25, s25, s24
    s_waitcnt lgkmcnt(0)
    s_add_u32 s8, s4, 118489088
    s_addc_u32 s9, s5, 0
    s_and_b32 s9, s9, 0xffff
    s_mov_b32 s10, 21889024
    s_mov_b32 s11, 0x00020000
    s_add_u32 s12, s4, 153616384
    s_addc_u32 s13, s5, 0
    s_and_b32 s13, s13, 0xffff
    s_mov_b32 s14, 131072
    s_mov_b32 s15, 0x00020000
    s_cmp_lt_u32 s3, s23
    s_cbranch_scc0 K34_NOLOAD
    buffer_load_dwordx4 v[16:19], v6, s[8:11], s25 offen
    s_add_u32 s25, s25, 684032
    buffer_load_dwordx4 v[20:23], v6, s[8:11], s25 offen
    s_add_u32 s25, s25, 684032
    buffer_load_dwordx4 v[24:27], v6, s[8:11], s25 offen
    s_add_u32 s25, s25, 684032
    buffer_load_dwordx4 v[28:31], v6, s[8:11], s25 offen
    s_add_u32 s25, s25, 8892416
    buffer_load_dwordx4 v[32:35], v6, s[8:11], s25 offen
    s_add_u32 s25, s25, 684032
    buffer_load_dwordx4 v[36:39], v6, s[8:11], s25 offen
    s_add_u32 s25, s25, 684032
    buffer_load_dwordx4 v[40:43], v6, s[8:11], s25 offen
    s_add_u32 s25, s25, 684032
    buffer_load_dwordx4 v[44:47], v6, s[8:11], s25 offen
K34_NOLOAD:
    s_cmp_lg_u32 s3, 0
    s_cbranch_scc1 K34_TAB
    s_mov_b32 s16, s40
    s_mov_b32 s17, s41
    s_and_b32 s17, s17, 0xffff
    s_mov_b32 s18, 1024
    s_mov_b32 s19, 0x00020000
    s_mov_b32 s28, s42
    s_mov_b32 s29, s43
    s_and_b32 s29, s29, 0xffff
    s_mov_b32 s30, 1024
    s_mov_b32 s31, 0x00020000
    s_lshl_b32 s24, s21, 7
    v_lshlrev_b32 v8, 1, v2
    buffer_load_ushort v152, v8, s[16:19], s24 offen
    buffer_load_ushort v153, v8, s[28:31], s24 offen
    s_branch K34_TABDONE
K34_TAB:
    s_cmp_ge_u32 s3, 7
    s_cbranch_scc1 K34_TABDONE
    s_sub_u32 s27, s3, 1
    s_lshr_b32 s28, s27, 1
    s_and_b32 s29, s27, 1
    s_lshl_b32 s30, s28, 4
    v_add_u32 v8, s30, v3
    s_lshl_b32 s30, s29, 5
    s_add_u32 s30, s30, 1
    v_lshlrev_b32 v9, 3, v4
    v_add_u32 v9, s30, v9
    v_mul_u32_u24 v9, v8, v9
    v_lshlrev_b32 v8, 1, v8
    v_mad_u32_u24 v48, v8, 0, v9
    v_mad_u32_u24 v49, v8, 0, v9
    v_add_u32 v49, 32, v49
    v_mad_u32_u24 v50, v8, 1, v9
    v_mad_u32_u24 v51, v8, 1, v9
    v_add_u32 v51, 32, v51
    v_mad_u32_u24 v52, v8, 2, v9
    v_mad_u32_u24 v53, v8, 2, v9
    v_add_u32 v53, 32, v53
    v_mad_u32_u24 v54, v8, 3, v9
    v_mad_u32_u24 v55, v8, 3, v9
    v_add_u32 v55, 32, v55
    v_and_b32 v48, 127, v48
    v_and_b32 v49, 127, v49
    v_and_b32 v50, 127, v50
    v_and_b32 v51, 127, v51
    v_and_b32 v52, 127, v52
    v_and_b32 v53, 127, v53
    v_and_b32 v54, 127, v54
    v_and_b32 v55, 127, v55
    v_cvt_f32_u32 v48, v48
    v_cvt_f32_u32 v49, v49
    v_cvt_f32_u32 v50, v50
    v_cvt_f32_u32 v51, v51
    v_cvt_f32_u32 v52, v52
    v_cvt_f32_u32 v53, v53
    v_cvt_f32_u32 v54, v54
    v_cvt_f32_u32 v55, v55
    v_mul_f32 v48, 0x3c000000, v48
    v_mul_f32 v49, 0x3c000000, v49
    v_mul_f32 v50, 0x3c000000, v50
    v_mul_f32 v51, 0x3c000000, v51
    v_mul_f32 v52, 0x3c000000, v52
    v_mul_f32 v53, 0x3c000000, v53
    v_mul_f32 v54, 0x3c000000, v54
    v_mul_f32 v55, 0x3c000000, v55
    v_cos_f32 v48, v48
    v_cos_f32 v49, v49
    v_cos_f32 v50, v50
    v_cos_f32 v51, v51
    v_cos_f32 v52, v52
    v_cos_f32 v53, v53
    v_cos_f32 v54, v54
    v_cos_f32 v55, v55
    s_nop 0
    v_mul_f32 v48, 0x3d000000, v48
    v_mul_f32 v49, 0x3d000000, v49
    v_mul_f32 v50, 0x3d000000, v50
    v_mul_f32 v51, 0x3d000000, v51
    v_mul_f32 v52, 0x3d000000, v52
    v_mul_f32 v53, 0x3d000000, v53
    v_mul_f32 v54, 0x3d000000, v54
    v_mul_f32 v55, 0x3d000000, v55
    v_cvt_pk_bf16_f32 v56, v48, v49
    v_cvt_pk_bf16_f32 v57, v50, v51
    v_cvt_pk_bf16_f32 v58, v52, v53
    v_cvt_pk_bf16_f32 v59, v54, v55
    v_lshlrev_b32 v64, 16, v56
    v_and_b32 v65, 0xffff0000, v56
    v_sub_f32 v48, v48, v64
    v_sub_f32 v49, v49, v65
    v_lshlrev_b32 v64, 16, v57
    v_and_b32 v65, 0xffff0000, v57
    v_sub_f32 v50, v50, v64
    v_sub_f32 v51, v51, v65
    v_lshlrev_b32 v64, 16, v58
    v_and_b32 v65, 0xffff0000, v58
    v_sub_f32 v52, v52, v64
    v_sub_f32 v53, v53, v65
    v_lshlrev_b32 v64, 16, v59
    v_and_b32 v65, 0xffff0000, v59
    v_sub_f32 v54, v54, v64
    v_sub_f32 v55, v55, v65
    v_cvt_pk_bf16_f32 v60, v48, v49
    v_cvt_pk_bf16_f32 v61, v50, v51
    v_cvt_pk_bf16_f32 v62, v52, v53
    v_cvt_pk_bf16_f32 v63, v54, v55
    s_lshl_b32 s30, s27, 11
    v_add_u32 v10, s30, v5
    ds_write_b128 v10, v[56:59]
    ds_write_b128 v10, v[60:63] offset:1024
K34_TABDONE:
    s_waitcnt lgkmcnt(0)
    s_barrier
    s_cmp_lt_u32 s3, s23
    s_cbranch_scc0 K34_IDLE
    ds_read_b128 v[48:51], v5 offset:0
    ds_read_b128 v[52:55], v5 offset:1024
    ds_read_b128 v[56:59], v5 offset:2048
    ds_read_b128 v[60:63], v5 offset:3072
    ds_read_b128 v[64:67], v5 offset:4096
    ds_read_b128 v[68:71], v5 offset:5120
    ds_read_b128 v[72:75], v5 offset:6144
    ds_read_b128 v[76:79], v5 offset:7168
    ds_read_b128 v[80:83], v5 offset:8192
    ds_read_b128 v[84:87], v5 offset:9216
    ds_read_b128 v[88:91], v5 offset:10240
    ds_read_b128 v[92:95], v5 offset:11264
    s_waitcnt vmcnt(0)
    v_swap_b32 v17, v20
    v_swap_b32 v18, v24
    v_swap_b32 v19, v28
    v_swap_b32 v22, v25
    v_swap_b32 v23, v29
    v_swap_b32 v27, v30
    v_swap_b32 v33, v36
    v_swap_b32 v34, v40
    v_swap_b32 v35, v44
    v_swap_b32 v38, v41
    v_swap_b32 v39, v45
    v_swap_b32 v43, v46
    s_waitcnt lgkmcnt(0)
    s_mul_i32 s24, s22, 48
    s_sub_u32 s24, 7985, s24
    s_cmp_ge_u32 s24, 48
    s_cbranch_scc1 K34_FULL
    v_add_u32 v7, 0, v3
    v_cmp_gt_u32 vcc, s24, v7
    s_nop 1
    v_cndmask_b32 v48, 0, v48, vcc
    v_cndmask_b32 v49, 0, v49, vcc
    v_cndmask_b32 v50, 0, v50, vcc
    v_cndmask_b32 v51, 0, v51, vcc
    v_cndmask_b32 v52, 0, v52, vcc
    v_cndmask_b32 v53, 0, v53, vcc
    v_cndmask_b32 v54, 0, v54, vcc
    v_cndmask_b32 v55, 0, v55, vcc
    v_cndmask_b32 v56, 0, v56, vcc
    v_cndmask_b32 v57, 0, v57, vcc
    v_cndmask_b32 v58, 0, v58, vcc
    v_cndmask_b32 v59, 0, v59, vcc
    v_cndmask_b32 v60, 0, v60, vcc
    v_cndmask_b32 v61, 0, v61, vcc
    v_cndmask_b32 v62, 0, v62, vcc
    v_cndmask_b32 v63, 0, v63, vcc
    v_add_u32 v7, 16, v3
    v_cmp_gt_u32 vcc, s24, v7
    s_nop 1
    v_cndmask_b32 v64, 0, v64, vcc
    v_cndmask_b32 v65, 0, v65, vcc
    v_cndmask_b32 v66, 0, v66, vcc
    v_cndmask_b32 v67, 0, v67, vcc
    v_cndmask_b32 v68, 0, v68, vcc
    v_cndmask_b32 v69, 0, v69, vcc
    v_cndmask_b32 v70, 0, v70, vcc
    v_cndmask_b32 v71, 0, v71, vcc
    v_cndmask_b32 v72, 0, v72, vcc
    v_cndmask_b32 v73, 0, v73, vcc
    v_cndmask_b32 v74, 0, v74, vcc
    v_cndmask_b32 v75, 0, v75, vcc
    v_cndmask_b32 v76, 0, v76, vcc
    v_cndmask_b32 v77, 0, v77, vcc
    v_cndmask_b32 v78, 0, v78, vcc
    v_cndmask_b32 v79, 0, v79, vcc
    v_add_u32 v7, 32, v3
    v_cmp_gt_u32 vcc, s24, v7
    s_nop 1
    v_cndmask_b32 v80, 0, v80, vcc
    v_cndmask_b32 v81, 0, v81, vcc
    v_cndmask_b32 v82, 0, v82, vcc
    v_cndmask_b32 v83, 0, v83, vcc
    v_cndmask_b32 v84, 0, v84, vcc
    v_cndmask_b32 v85, 0, v85, vcc
    v_cndmask_b32 v86, 0, v86, vcc
    v_cndmask_b32 v87, 0, v87, vcc
    v_cndmask_b32 v88, 0, v88, vcc
    v_cndmask_b32 v89, 0, v89, vcc
    v_cndmask_b32 v90, 0, v90, vcc
    v_cndmask_b32 v91, 0, v91, vcc
    v_cndmask_b32 v92, 0, v92, vcc
    v_cndmask_b32 v93, 0, v93, vcc
    v_cndmask_b32 v94, 0, v94, vcc
    v_cndmask_b32 v95, 0, v95, vcc
K34_FULL:
    s_nop 1
    v_mfma_f32_16x16x32_bf16 v[96:99], v[48:51], v[16:19], 0
    v_mfma_f32_16x16x32_bf16 v[100:103], v[48:51], v[20:23], 0
    v_mfma_f32_16x16x32_bf16 v[104:107], v[48:51], v[24:27], 0
    v_mfma_f32_16x16x32_bf16 v[108:111], v[48:51], v[28:31], 0
    v_mfma_f32_16x16x32_bf16 v[96:99], v[52:55], v[16:19], v[96:99]
    v_mfma_f32_16x16x32_bf16 v[100:103], v[52:55], v[20:23], v[100:103]
    v_mfma_f32_16x16x32_bf16 v[104:107], v[52:55], v[24:27], v[104:107]
    v_mfma_f32_16x16x32_bf16 v[108:111], v[52:55], v[28:31], v[108:111]
    v_mfma_f32_16x16x32_bf16 v[96:99], v[56:59], v[32:35], v[96:99]
    v_mfma_f32_16x16x32_bf16 v[100:103], v[56:59], v[36:39], v[100:103]
    v_mfma_f32_16x16x32_bf16 v[104:107], v[56:59], v[40:43], v[104:107]
    v_mfma_f32_16x16x32_bf16 v[108:111], v[56:59], v[44:47], v[108:111]
    v_mfma_f32_16x16x32_bf16 v[96:99], v[60:63], v[32:35], v[96:99]
    v_mfma_f32_16x16x32_bf16 v[100:103], v[60:63], v[36:39], v[100:103]
    v_mfma_f32_16x16x32_bf16 v[104:107], v[60:63], v[40:43], v[104:107]
    v_mfma_f32_16x16x32_bf16 v[108:111], v[60:63], v[44:47], v[108:111]
    v_mfma_f32_16x16x32_bf16 v[112:115], v[64:67], v[16:19], 0
    v_mfma_f32_16x16x32_bf16 v[116:119], v[64:67], v[20:23], 0
    v_mfma_f32_16x16x32_bf16 v[120:123], v[64:67], v[24:27], 0
    v_mfma_f32_16x16x32_bf16 v[124:127], v[64:67], v[28:31], 0
    v_mfma_f32_16x16x32_bf16 v[112:115], v[68:71], v[16:19], v[112:115]
    v_mfma_f32_16x16x32_bf16 v[116:119], v[68:71], v[20:23], v[116:119]
    v_mfma_f32_16x16x32_bf16 v[120:123], v[68:71], v[24:27], v[120:123]
    v_mfma_f32_16x16x32_bf16 v[124:127], v[68:71], v[28:31], v[124:127]
    v_mfma_f32_16x16x32_bf16 v[112:115], v[72:75], v[32:35], v[112:115]
    v_mfma_f32_16x16x32_bf16 v[116:119], v[72:75], v[36:39], v[116:119]
    v_mfma_f32_16x16x32_bf16 v[120:123], v[72:75], v[40:43], v[120:123]
    v_mfma_f32_16x16x32_bf16 v[124:127], v[72:75], v[44:47], v[124:127]
    v_mfma_f32_16x16x32_bf16 v[112:115], v[76:79], v[32:35], v[112:115]
    v_mfma_f32_16x16x32_bf16 v[116:119], v[76:79], v[36:39], v[116:119]
    v_mfma_f32_16x16x32_bf16 v[120:123], v[76:79], v[40:43], v[120:123]
    v_mfma_f32_16x16x32_bf16 v[124:127], v[76:79], v[44:47], v[124:127]
    v_mfma_f32_16x16x32_bf16 v[128:131], v[80:83], v[16:19], 0
    v_mfma_f32_16x16x32_bf16 v[132:135], v[80:83], v[20:23], 0
    v_mfma_f32_16x16x32_bf16 v[136:139], v[80:83], v[24:27], 0
    v_mfma_f32_16x16x32_bf16 v[140:143], v[80:83], v[28:31], 0
    v_mfma_f32_16x16x32_bf16 v[128:131], v[84:87], v[16:19], v[128:131]
    v_mfma_f32_16x16x32_bf16 v[132:135], v[84:87], v[20:23], v[132:135]
    v_mfma_f32_16x16x32_bf16 v[136:139], v[84:87], v[24:27], v[136:139]
    v_mfma_f32_16x16x32_bf16 v[140:143], v[84:87], v[28:31], v[140:143]
    v_mfma_f32_16x16x32_bf16 v[128:131], v[88:91], v[32:35], v[128:131]
    v_mfma_f32_16x16x32_bf16 v[132:135], v[88:91], v[36:39], v[132:135]
    v_mfma_f32_16x16x32_bf16 v[136:139], v[88:91], v[40:43], v[136:139]
    v_mfma_f32_16x16x32_bf16 v[140:143], v[88:91], v[44:47], v[140:143]
    v_mfma_f32_16x16x32_bf16 v[128:131], v[92:95], v[32:35], v[128:131]
    v_mfma_f32_16x16x32_bf16 v[132:135], v[92:95], v[36:39], v[132:135]
    v_mfma_f32_16x16x32_bf16 v[136:139], v[92:95], v[40:43], v[136:139]
    v_mfma_f32_16x16x32_bf16 v[140:143], v[92:95], v[44:47], v[140:143]
    s_nop 7
    v_mov_b32 v16, v96
    v_mul_f32 v20, v96, v96
    v_mov_b32 v17, v100
    v_mul_f32 v21, v100, v100
    v_mov_b32 v18, v104
    v_mul_f32 v22, v104, v104
    v_mov_b32 v19, v108
    v_mul_f32 v23, v108, v108
    v_add_f32 v16, v16, v97
    v_fmac_f32 v20, v97, v97
    v_add_f32 v17, v17, v101
    v_fmac_f32 v21, v101, v101
    v_add_f32 v18, v18, v105
    v_fmac_f32 v22, v105, v105
    v_add_f32 v19, v19, v109
    v_fmac_f32 v23, v109, v109
    v_add_f32 v16, v16, v98
    v_fmac_f32 v20, v98, v98
    v_add_f32 v17, v17, v102
    v_fmac_f32 v21, v102, v102
    v_add_f32 v18, v18, v106
    v_fmac_f32 v22, v106, v106
    v_add_f32 v19, v19, v110
    v_fmac_f32 v23, v110, v110
    v_add_f32 v16, v16, v99
    v_fmac_f32 v20, v99, v99
    v_add_f32 v17, v17, v103
    v_fmac_f32 v21, v103, v103
    v_add_f32 v18, v18, v107
    v_fmac_f32 v22, v107, v107
    v_add_f32 v19, v19, v111
    v_fmac_f32 v23, v111, v111
    v_add_f32 v16, v16, v112
    v_fmac_f32 v20, v112, v112
    v_add_f32 v17, v17, v116
    v_fmac_f32 v21, v116, v116
    v_add_f32 v18, v18, v120
    v_fmac_f32 v22, v120, v120
    v_add_f32 v19, v19, v124
    v_fmac_f32 v23, v124, v124
    v_add_f32 v16, v16, v113
    v_fmac_f32 v20, v113, v113
    v_add_f32 v17, v17, v117
    v_fmac_f32 v21, v117, v117
    v_add_f32 v18, v18, v121
    v_fmac_f32 v22, v121, v121
    v_add_f32 v19, v19, v125
    v_fmac_f32 v23, v125, v125
    v_add_f32 v16, v16, v114
    v_fmac_f32 v20, v114, v114
    v_add_f32 v17, v17, v118
    v_fmac_f32 v21, v118, v118
    v_add_f32 v18, v18, v122
    v_fmac_f32 v22, v122, v122
    v_add_f32 v19, v19, v126
    v_fmac_f32 v23, v126, v126
    v_add_f32 v16, v16, v115
    v_fmac_f32 v20, v115, v115
    v_add_f32 v17, v17, v119
    v_fmac_f32 v21, v119, v119
    v_add_f32 v18, v18, v123
    v_fmac_f32 v22, v123, v123
    v_add_f32 v19, v19, v127
    v_fmac_f32 v23, v127, v127
    v_add_f32 v16, v16, v128
    v_fmac_f32 v20, v128, v128
    v_add_f32 v17, v17, v132
    v_fmac_f32 v21, v132, v132
    v_add_f32 v18, v18, v136
    v_fmac_f32 v22, v136, v136
    v_add_f32 v19, v19, v140
    v_fmac_f32 v23, v140, v140
    v_add_f32 v16, v16, v129
    v_fmac_f32 v20, v129, v129
    v_add_f32 v17, v17, v133
    v_fmac_f32 v21, v133, v133
    v_add_f32 v18, v18, v137
    v_fmac_f32 v22, v137, v137
    v_add_f32 v19, v19, v141
    v_fmac_f32 v23, v141, v141
    v_add_f32 v16, v16, v130
    v_fmac_f32 v20, v130, v130
    v_add_f32 v17, v17, v134
    v_fmac_f32 v21, v134, v134
    v_add_f32 v18, v18, v138
    v_fmac_f32 v22, v138, v138
    v_add_f32 v19, v19, v142
    v_fmac_f32 v23, v142, v142
    v_add_f32 v16, v16, v131
    v_fmac_f32 v20, v131, v131
    v_add_f32 v17, v17, v135
    v_fmac_f32 v21, v135, v135
    v_add_f32 v18, v18, v139
    v_fmac_f32 v22, v139, v139
    v_add_f32 v19, v19, v143
    v_fmac_f32 v23, v143, v143
    v_mov_b32 v24, v16
    v_mov_b32 v25, v17
    v_mov_b32 v26, v18
    v_mov_b32 v27, v19
    v_mov_b32 v28, v20
    v_mov_b32 v29, v21
    v_mov_b32 v30, v22
    v_mov_b32 v31, v23
    s_nop 0
    v_permlane32_swap_b32 v16, v24
    v_permlane32_swap_b32 v17, v25
    v_permlane32_swap_b32 v18, v26
    v_permlane32_swap_b32 v19, v27
    v_permlane32_swap_b32 v20, v28
    v_permlane32_swap_b32 v21, v29
    v_permlane32_swap_b32 v22, v30
    v_permlane32_swap_b32 v23, v31
    v_add_f32 v16, v16, v24
    v_add_f32 v17, v17, v25
    v_add_f32 v18, v18, v26
    v_add_f32 v19, v19, v27
    v_add_f32 v20, v20, v28
    v_add_f32 v21, v21, v29
    v_add_f32 v22, v22, v30
    v_add_f32 v23, v23, v31
    v_mov_b32 v24, v16
    v_mov_b32 v25, v17
    v_mov_b32 v26, v18
    v_mov_b32 v27, v19
    v_mov_b32 v28, v20
    v_mov_b32 v29, v21
    v_mov_b32 v30, v22
    v_mov_b32 v31, v23
    s_nop 0
    v_permlane16_swap_b32 v16, v24
    v_permlane16_swap_b32 v17, v25
    v_permlane16_swap_b32 v18, v26
    v_permlane16_swap_b32 v19, v27
    v_permlane16_swap_b32 v20, v28
    v_permlane16_swap_b32 v21, v29
    v_permlane16_swap_b32 v22, v30
    v_permlane16_swap_b32 v23, v31
    v_add_f32 v16, v16, v24
    v_add_f32 v17, v17, v25
    v_add_f32 v18, v18, v26
    v_add_f32 v19, v19, v27
    v_add_f32 v20, v20, v28
    v_add_f32 v21, v21, v29
    v_add_f32 v22, v22, v30
    v_add_f32 v23, v23, v31
    s_branch K34_WR
K34_IDLE:
    v_mov_b32 v16, 0
    v_mov_b32 v17, 0
    v_mov_b32 v18, 0
    v_mov_b32 v19, 0
    v_mov_b32 v20, 0
    v_mov_b32 v21, 0
    v_mov_b32 v22, 0
    v_mov_b32 v23, 0
K34_WR:
    s_lshl_b32 s24, s3, 9
    v_lshlrev_b32 v7, 4, v3
    v_add_u32 v7, s24, v7
    ds_write_b128 v7, v[16:19] offset:12288
    ds_write_b128 v7, v[20:23] offset:12544
    s_waitcnt lgkmcnt(0)
    s_barrier
    s_cmp_lg_u32 s3, 0
    s_cbranch_scc1 K34_WAIT
    v_lshlrev_b32 v7, 2, v2
    ds_read_b32 v16, v7 offset:12288
    ds_read_b32 v17, v7 offset:12800
    ds_read_b32 v18, v7 offset:13312
    ds_read_b32 v19, v7 offset:13824
    ds_read_b32 v20, v7 offset:14336
    ds_read_b32 v21, v7 offset:14848
    ds_read_b32 v22, v7 offset:15360
    ds_read_b32 v23, v7 offset:15872
    ds_read_b32 v24, v7 offset:16384
    ds_read_b32 v25, v7 offset:16896
    ds_read_b32 v26, v7 offset:17408
    ds_read_b32 v27, v7 offset:17920
    s_waitcnt lgkmcnt(0)
    ds_read_b32 v32, v7 offset:12544
    ds_read_b32 v33, v7 offset:13056
    ds_read_b32 v34, v7 offset:13568
    ds_read_b32 v35, v7 offset:14080
    ds_read_b32 v36, v7 offset:14592
    ds_read_b32 v37, v7 offset:15104
    ds_read_b32 v38, v7 offset:15616
    ds_read_b32 v39, v7 offset:16128
    ds_read_b32 v40, v7 offset:16640
    ds_read_b32 v41, v7 offset:17152
    ds_read_b32 v42, v7 offset:17664
    ds_read_b32 v43, v7 offset:18176
    v_add_f32 v16, v16, v17
    v_add_f32 v16, v16, v18
    v_add_f32 v16, v16, v19
    v_add_f32 v16, v16, v20
    v_add_f32 v16, v16, v21
    v_add_f32 v16, v16, v22
    v_add_f32 v16, v16, v23
    v_add_f32 v16, v16, v24
    v_add_f32 v16, v16, v25
    v_add_f32 v16, v16, v26
    v_add_f32 v16, v16, v27
    s_waitcnt lgkmcnt(0)
    v_add_f32 v32, v32, v33
    v_add_f32 v32, v32, v34
    v_add_f32 v32, v32, v35
    v_add_f32 v32, v32, v36
    v_add_f32 v32, v32, v37
    v_add_f32 v32, v32, v38
    v_add_f32 v32, v32, v39
    v_add_f32 v32, v32, v40
    v_add_f32 v32, v32, v41
    v_add_f32 v32, v32, v42
    v_add_f32 v32, v32, v43
    s_lshl_b32 s24, s6, 4
    s_add_u32 s24, s24, s7
    s_lshl_b32 s24, s24, 9
    buffer_store_dword v16, v7, s[12:15], s24 offen sc1
    buffer_store_dword v32, v7, s[12:15], s24 offen offset:256 sc1
    s_mov_b32 s26, 20000
K34_POLL:
    s_lshl_b32 s24, s6, 13
    buffer_load_dword v16, v7, s[12:15], s24 offen offset:0 sc1
    buffer_load_dword v32, v7, s[12:15], s24 offen offset:256 sc1
    buffer_load_dword v17, v7, s[12:15], s24 offen offset:512 sc1
    buffer_load_dword v33, v7, s[12:15], s24 offen offset:768 sc1
    buffer_load_dword v18, v7, s[12:15], s24 offen offset:1024 sc1
    buffer_load_dword v34, v7, s[12:15], s24 offen offset:1280 sc1
    buffer_load_dword v19, v7, s[12:15], s24 offen offset:1536 sc1
    buffer_load_dword v35, v7, s[12:15], s24 offen offset:1792 sc1
    buffer_load_dword v20, v7, s[12:15], s24 offen offset:2048 sc1
    buffer_load_dword v36, v7, s[12:15], s24 offen offset:2304 sc1
    buffer_load_dword v21, v7, s[12:15], s24 offen offset:2560 sc1
    buffer_load_dword v37, v7, s[12:15], s24 offen offset:2816 sc1
    buffer_load_dword v22, v7, s[12:15], s24 offen offset:3072 sc1
    buffer_load_dword v38, v7, s[12:15], s24 offen offset:3328 sc1
    buffer_load_dword v23, v7, s[12:15], s24 offen offset:3584 sc1
    buffer_load_dword v39, v7, s[12:15], s24 offen offset:3840 sc1
    s_add_u32 s24, s24, 4096
    buffer_load_dword v24, v7, s[12:15], s24 offen offset:0 sc1
    buffer_load_dword v40, v7, s[12:15], s24 offen offset:256 sc1
    buffer_load_dword v25, v7, s[12:15], s24 offen offset:512 sc1
    buffer_load_dword v41, v7, s[12:15], s24 offen offset:768 sc1
    buffer_load_dword v26, v7, s[12:15], s24 offen offset:1024 sc1
    buffer_load_dword v42, v7, s[12:15], s24 offen offset:1280 sc1
    buffer_load_dword v27, v7, s[12:15], s24 offen offset:1536 sc1
    buffer_load_dword v43, v7, s[12:15], s24 offen offset:1792 sc1
    buffer_load_dword v28, v7, s[12:15], s24 offen offset:2048 sc1
    buffer_load_dword v44, v7, s[12:15], s24 offen offset:2304 sc1
    buffer_load_dword v29, v7, s[12:15], s24 offen offset:2560 sc1
    buffer_load_dword v45, v7, s[12:15], s24 offen offset:2816 sc1
    buffer_load_dword v30, v7, s[12:15], s24 offen offset:3072 sc1
    buffer_load_dword v46, v7, s[12:15], s24 offen offset:3328 sc1
    buffer_load_dword v31, v7, s[12:15], s24 offen offset:3584 sc1
    buffer_load_dword v47, v7, s[12:15], s24 offen offset:3840 sc1
    s_waitcnt vmcnt(0)
    v_max3_u32 v48, v16, v17, v18
    v_max3_u32 v48, v48, v19, v20
    v_max3_u32 v48, v48, v21, v22
    v_max3_u32 v48, v48, v23, v24
    v_max3_u32 v48, v48, v25, v26
    v_max3_u32 v48, v48, v27, v28
    v_max3_u32 v48, v48, v29, v30
    v_max3_u32 v48, v48, v31, v32
    v_max3_u32 v48, v48, v33, v34
    v_max3_u32 v48, v48, v35, v36
    v_max3_u32 v48, v48, v37, v38
    v_max3_u32 v48, v48, v39, v40
    v_max3_u32 v48, v48, v41, v42
    v_max3_u32 v48, v48, v43, v44
    v_max3_u32 v48, v48, v45, v46
    v_max_u32 v48, v48, v47
    v_cmp_eq_u32 vcc, -1, v48
    s_sub_u32 s26, s26, 1
    s_cmp_eq_u32 s26, 0
    s_cbranch_scc1 K34_GOT
    s_cbranch_vccz K34_GOT
    s_sleep 1
    s_branch K34_POLL
K34_GOT:
    v_add_f32 v16, v16, v24
    v_add_f32 v32, v32, v40
    v_add_f32 v17, v17, v25
    v_add_f32 v33, v33, v41
    v_add_f32 v18, v18, v26
    v_add_f32 v34, v34, v42
    v_add_f32 v19, v19, v27
    v_add_f32 v35, v35, v43
    v_add_f32 v20, v20, v28
    v_add_f32 v36, v36, v44
    v_add_f32 v21, v21, v29
    v_add_f32 v37, v37, v45
    v_add_f32 v22, v22, v30
    v_add_f32 v38, v38, v46
    v_add_f32 v23, v23, v31
    v_add_f32 v39, v39, v47
    v_add_f32 v16, v16, v20
    v_add_f32 v32, v32, v36
    v_add_f32 v17, v17, v21
    v_add_f32 v33, v33, v37
    v_add_f32 v18, v18, v22
    v_add_f32 v34, v34, v38
    v_add_f32 v19, v19, v23
    v_add_f32 v35, v35, v39
    v_add_f32 v16, v16, v18
    v_add_f32 v32, v32, v34
    v_add_f32 v17, v17, v19
    v_add_f32 v33, v33, v35
    v_add_f32 v16, v16, v17
    v_add_f32 v32, v32, v33
    v_mul_f32 v11, 0x39035177, v16
    v_mul_f32 v12, 0x39035177, v32
    v_fma_f32 v12, -v11, v11, v12
    v_max_f32 v12, 0, v12
    v_add_f32 v12, 0x3727c5ac, v12
    v_sqrt_f32 v12, v12
    v_lshlrev_b32 v9, 16, v152
    v_rcp_f32 v12, v12
    v_lshlrev_b32 v10, 16, v153
    v_mul_f32 v9, v9, v12
    v_fma_f32 v10, -v11, v9, v10
    ds_write_b32 v7, v9 offset:18432
    ds_write_b32 v7, v10 offset:18688
    s_waitcnt lgkmcnt(0)
K34_WAIT:
    s_barrier
    s_cmp_lt_u32 s3, s23
    s_cbranch_scc0 K34_END
    v_lshlrev_b32 v7, 4, v3
    ds_read_b128 v[144:147], v7 offset:18432
    ds_read_b128 v[148:151], v7 offset:18688
    s_mul_i32 s24, s20, 8176640
    s_add_u32 s16, s44, s24
    s_addc_u32 s17, s45, 0
    s_and_b32 s17, s17, 0xffff
    s_mov_b32 s18, 8176640
    s_mov_b32 s19, 0x00020000
    v_lshlrev_b32 v7, 12, v4
    v_lshl_add_u32 v7, v3, 3, v7
    s_lshl_b32 s24, s21, 7
    v_add_u32 v7, s24, v7
    s_mul_i32 s25, s22, 49152
    s_mov_b32 s30, 0xc0135761
    s_mov_b32 s31, 0xbdd2d3e8
    v_mov_b32 v15, s30
    s_waitcnt lgkmcnt(0)
    v_fma_f32 v16, v96, v144, v148
    v_fma_f32 v17, v100, v145, v149
    v_fma_f32 v18, v104, v146, v150
    v_fma_f32 v19, v108, v147, v151
    v_fma_f32 v20, v97, v144, v148
    v_fma_f32 v21, v101, v145, v149
    v_fma_f32 v22, v105, v146, v150
    v_fma_f32 v23, v109, v147, v151
    v_mul_f32 v24, v16, v16
    v_mul_f32 v25, v17, v17
    v_mul_f32 v26, v18, v18
    v_mul_f32 v27, v19, v19
    v_mul_f32 v28, v20, v20
    v_mul_f32 v29, v21, v21
    v_mul_f32 v30, v22, v22
    v_mul_f32 v31, v23, v23
    v_fma_f32 v24, v24, s31, v15
    v_fma_f32 v25, v25, s31, v15
    v_fma_f32 v26, v26, s31, v15
    v_fma_f32 v27, v27, s31, v15
    v_fma_f32 v28, v28, s31, v15
    v_fma_f32 v29, v29, s31, v15
    v_fma_f32 v30, v30, s31, v15
    v_fma_f32 v31, v31, s31, v15
    v_mul_f32 v24, v24, v16
    v_mul_f32 v25, v25, v17
    v_mul_f32 v26, v26, v18
    v_mul_f32 v27, v27, v19
    v_mul_f32 v28, v28, v20
    v_mul_f32 v29, v29, v21
    v_mul_f32 v30, v30, v22
    v_mul_f32 v31, v31, v23
    v_exp_f32 v24, v24
    v_exp_f32 v25, v25
    v_exp_f32 v26, v26
    v_exp_f32 v27, v27
    v_exp_f32 v28, v28
    v_exp_f32 v29, v29
    v_exp_f32 v30, v30
    v_exp_f32 v31, v31
    v_add_f32 v24, 1.0, v24
    v_add_f32 v25, 1.0, v25
    v_add_f32 v26, 1.0, v26
    v_add_f32 v27, 1.0, v27
    v_add_f32 v28, 1.0, v28
    v_add_f32 v29, 1.0, v29
    v_add_f32 v30, 1.0, v30
    v_add_f32 v31, 1.0, v31
    v_rcp_f32 v24, v24
    v_rcp_f32 v25, v25
    v_rcp_f32 v26, v26
    v_rcp_f32 v27, v27
    v_rcp_f32 v28, v28
    v_rcp_f32 v29, v29
    v_rcp_f32 v30, v30
    v_rcp_f32 v31, v31
    v_mul_f32 v16, v16, v24
    v_mul_f32 v17, v17, v25
    v_mul_f32 v18, v18, v26
    v_mul_f32 v19, v19, v27
    v_mul_f32 v20, v20, v28
    v_mul_f32 v21, v21, v29
    v_mul_f32 v22, v22, v30
    v_mul_f32 v23, v23, v31
    v_cvt_pk_bf16_f32 v32, v16, v17
    v_cvt_pk_bf16_f32 v33, v18, v19
    buffer_store_dwordx2 v[32:33], v7, s[16:19], s25 offen offset:0 sc1
    v_cvt_pk_bf16_f32 v34, v20, v21
    v_cvt_pk_bf16_f32 v35, v22, v23
    buffer_store_dwordx2 v[34:35], v7, s[16:19], s25 offen offset:1024 sc1
    s_add_u32 s25, s25, 2048
    v_fma_f32 v36, v98, v144, v148
    v_fma_f32 v37, v102, v145, v149
    v_fma_f32 v38, v106, v146, v150
    v_fma_f32 v39, v110, v147, v151
    v_fma_f32 v40, v99, v144, v148
    v_fma_f32 v41, v103, v145, v149
    v_fma_f32 v42, v107, v146, v150
    v_fma_f32 v43, v111, v147, v151
    v_mul_f32 v44, v36, v36
    v_mul_f32 v45, v37, v37
    v_mul_f32 v46, v38, v38
    v_mul_f32 v47, v39, v39
    v_mul_f32 v48, v40, v40
    v_mul_f32 v49, v41, v41
    v_mul_f32 v50, v42, v42
    v_mul_f32 v51, v43, v43
    v_fma_f32 v44, v44, s31, v15
    v_fma_f32 v45, v45, s31, v15
    v_fma_f32 v46, v46, s31, v15
    v_fma_f32 v47, v47, s31, v15
    v_fma_f32 v48, v48, s31, v15
    v_fma_f32 v49, v49, s31, v15
    v_fma_f32 v50, v50, s31, v15
    v_fma_f32 v51, v51, s31, v15
    v_mul_f32 v44, v44, v36
    v_mul_f32 v45, v45, v37
    v_mul_f32 v46, v46, v38
    v_mul_f32 v47, v47, v39
    v_mul_f32 v48, v48, v40
    v_mul_f32 v49, v49, v41
    v_mul_f32 v50, v50, v42
    v_mul_f32 v51, v51, v43
    v_exp_f32 v44, v44
    v_exp_f32 v45, v45
    v_exp_f32 v46, v46
    v_exp_f32 v47, v47
    v_exp_f32 v48, v48
    v_exp_f32 v49, v49
    v_exp_f32 v50, v50
    v_exp_f32 v51, v51
    v_add_f32 v44, 1.0, v44
    v_add_f32 v45, 1.0, v45
    v_add_f32 v46, 1.0, v46
    v_add_f32 v47, 1.0, v47
    v_add_f32 v48, 1.0, v48
    v_add_f32 v49, 1.0, v49
    v_add_f32 v50, 1.0, v50
    v_add_f32 v51, 1.0, v51
    v_rcp_f32 v44, v44
    v_rcp_f32 v45, v45
    v_rcp_f32 v46, v46
    v_rcp_f32 v47, v47
    v_rcp_f32 v48, v48
    v_rcp_f32 v49, v49
    v_rcp_f32 v50, v50
    v_rcp_f32 v51, v51
    v_mul_f32 v36, v36, v44
    v_mul_f32 v37, v37, v45
    v_mul_f32 v38, v38, v46
    v_mul_f32 v39, v39, v47
    v_mul_f32 v40, v40, v48
    v_mul_f32 v41, v41, v49
    v_mul_f32 v42, v42, v50
    v_mul_f32 v43, v43, v51
    v_cvt_pk_bf16_f32 v52, v36, v37
    v_cvt_pk_bf16_f32 v53, v38, v39
    buffer_store_dwordx2 v[52:53], v7, s[16:19], s25 offen offset:0 sc1
    v_cvt_pk_bf16_f32 v54, v40, v41
    v_cvt_pk_bf16_f32 v55, v42, v43
    buffer_store_dwordx2 v[54:55], v7, s[16:19], s25 offen offset:1024 sc1
    s_add_u32 s25, s25, 2048
    s_add_u32 s25, s25, 12288
    v_fma_f32 v16, v112, v144, v148
    v_fma_f32 v17, v116, v145, v149
    v_fma_f32 v18, v120, v146, v150
    v_fma_f32 v19, v124, v147, v151
    v_fma_f32 v20, v113, v144, v148
    v_fma_f32 v21, v117, v145, v149
    v_fma_f32 v22, v121, v146, v150
    v_fma_f32 v23, v125, v147, v151
    v_mul_f32 v24, v16, v16
    v_mul_f32 v25, v17, v17
    v_mul_f32 v26, v18, v18
    v_mul_f32 v27, v19, v19
    v_mul_f32 v28, v20, v20
    v_mul_f32 v29, v21, v21
    v_mul_f32 v30, v22, v22
    v_mul_f32 v31, v23, v23
    v_fma_f32 v24, v24, s31, v15
    v_fma_f32 v25, v25, s31, v15
    v_fma_f32 v26, v26, s31, v15
    v_fma_f32 v27, v27, s31, v15
    v_fma_f32 v28, v28, s31, v15
    v_fma_f32 v29, v29, s31, v15
    v_fma_f32 v30, v30, s31, v15
    v_fma_f32 v31, v31, s31, v15
    v_mul_f32 v24, v24, v16
    v_mul_f32 v25, v25, v17
    v_mul_f32 v26, v26, v18
    v_mul_f32 v27, v27, v19
    v_mul_f32 v28, v28, v20
    v_mul_f32 v29, v29, v21
    v_mul_f32 v30, v30, v22
    v_mul_f32 v31, v31, v23
    v_exp_f32 v24, v24
    v_exp_f32 v25, v25
    v_exp_f32 v26, v26
    v_exp_f32 v27, v27
    v_exp_f32 v28, v28
    v_exp_f32 v29, v29
    v_exp_f32 v30, v30
    v_exp_f32 v31, v31
    v_add_f32 v24, 1.0, v24
    v_add_f32 v25, 1.0, v25
    v_add_f32 v26, 1.0, v26
    v_add_f32 v27, 1.0, v27
    v_add_f32 v28, 1.0, v28
    v_add_f32 v29, 1.0, v29
    v_add_f32 v30, 1.0, v30
    v_add_f32 v31, 1.0, v31
    v_rcp_f32 v24, v24
    v_rcp_f32 v25, v25
    v_rcp_f32 v26, v26
    v_rcp_f32 v27, v27
    v_rcp_f32 v28, v28
    v_rcp_f32 v29, v29
    v_rcp_f32 v30, v30
    v_rcp_f32 v31, v31
    v_mul_f32 v16, v16, v24
    v_mul_f32 v17, v17, v25
    v_mul_f32 v18, v18, v26
    v_mul_f32 v19, v19, v27
    v_mul_f32 v20, v20, v28
    v_mul_f32 v21, v21, v29
    v_mul_f32 v22, v22, v30
    v_mul_f32 v23, v23, v31
    v_cvt_pk_bf16_f32 v32, v16, v17
    v_cvt_pk_bf16_f32 v33, v18, v19
    buffer_store_dwordx2 v[32:33], v7, s[16:19], s25 offen offset:0 sc1
    v_cvt_pk_bf16_f32 v34, v20, v21
    v_cvt_pk_bf16_f32 v35, v22, v23
    buffer_store_dwordx2 v[34:35], v7, s[16:19], s25 offen offset:1024 sc1
    s_add_u32 s25, s25, 2048
    v_fma_f32 v36, v114, v144, v148
    v_fma_f32 v37, v118, v145, v149
    v_fma_f32 v38, v122, v146, v150
    v_fma_f32 v39, v126, v147, v151
    v_fma_f32 v40, v115, v144, v148
    v_fma_f32 v41, v119, v145, v149
    v_fma_f32 v42, v123, v146, v150
    v_fma_f32 v43, v127, v147, v151
    v_mul_f32 v44, v36, v36
    v_mul_f32 v45, v37, v37
    v_mul_f32 v46, v38, v38
    v_mul_f32 v47, v39, v39
    v_mul_f32 v48, v40, v40
    v_mul_f32 v49, v41, v41
    v_mul_f32 v50, v42, v42
    v_mul_f32 v51, v43, v43
    v_fma_f32 v44, v44, s31, v15
    v_fma_f32 v45, v45, s31, v15
    v_fma_f32 v46, v46, s31, v15
    v_fma_f32 v47, v47, s31, v15
    v_fma_f32 v48, v48, s31, v15
    v_fma_f32 v49, v49, s31, v15
    v_fma_f32 v50, v50, s31, v15
    v_fma_f32 v51, v51, s31, v15
    v_mul_f32 v44, v44, v36
    v_mul_f32 v45, v45, v37
    v_mul_f32 v46, v46, v38
    v_mul_f32 v47, v47, v39
    v_mul_f32 v48, v48, v40
    v_mul_f32 v49, v49, v41
    v_mul_f32 v50, v50, v42
    v_mul_f32 v51, v51, v43
    v_exp_f32 v44, v44
    v_exp_f32 v45, v45
    v_exp_f32 v46, v46
    v_exp_f32 v47, v47
    v_exp_f32 v48, v48
    v_exp_f32 v49, v49
    v_exp_f32 v50, v50
    v_exp_f32 v51, v51
    v_add_f32 v44, 1.0, v44
    v_add_f32 v45, 1.0, v45
    v_add_f32 v46, 1.0, v46
    v_add_f32 v47, 1.0, v47
    v_add_f32 v48, 1.0, v48
    v_add_f32 v49, 1.0, v49
    v_add_f32 v50, 1.0, v50
    v_add_f32 v51, 1.0, v51
    v_rcp_f32 v44, v44
    v_rcp_f32 v45, v45
    v_rcp_f32 v46, v46
    v_rcp_f32 v47, v47
    v_rcp_f32 v48, v48
    v_rcp_f32 v49, v49
    v_rcp_f32 v50, v50
    v_rcp_f32 v51, v51
    v_mul_f32 v36, v36, v44
    v_mul_f32 v37, v37, v45
    v_mul_f32 v38, v38, v46
    v_mul_f32 v39, v39, v47
    v_mul_f32 v40, v40, v48
    v_mul_f32 v41, v41, v49
    v_mul_f32 v42, v42, v50
    v_mul_f32 v43, v43, v51
    v_cvt_pk_bf16_f32 v52, v36, v37
    v_cvt_pk_bf16_f32 v53, v38, v39
    buffer_store_dwordx2 v[52:53], v7, s[16:19], s25 offen offset:0 sc1
    v_cvt_pk_bf16_f32 v54, v40, v41
    v_cvt_pk_bf16_f32 v55, v42, v43
    buffer_store_dwordx2 v[54:55], v7, s[16:19], s25 offen offset:1024 sc1
    s_add_u32 s25, s25, 2048
    s_add_u32 s25, s25, 12288
    v_fma_f32 v16, v128, v144, v148
    v_fma_f32 v17, v132, v145, v149
    v_fma_f32 v18, v136, v146, v150
    v_fma_f32 v19, v140, v147, v151
    v_fma_f32 v20, v129, v144, v148
    v_fma_f32 v21, v133, v145, v149
    v_fma_f32 v22, v137, v146, v150
    v_fma_f32 v23, v141, v147, v151
    v_mul_f32 v24, v16, v16
    v_mul_f32 v25, v17, v17
    v_mul_f32 v26, v18, v18
    v_mul_f32 v27, v19, v19
    v_mul_f32 v28, v20, v20
    v_mul_f32 v29, v21, v21
    v_mul_f32 v30, v22, v22
    v_mul_f32 v31, v23, v23
    v_fma_f32 v24, v24, s31, v15
    v_fma_f32 v25, v25, s31, v15
    v_fma_f32 v26, v26, s31, v15
    v_fma_f32 v27, v27, s31, v15
    v_fma_f32 v28, v28, s31, v15
    v_fma_f32 v29, v29, s31, v15
    v_fma_f32 v30, v30, s31, v15
    v_fma_f32 v31, v31, s31, v15
    v_mul_f32 v24, v24, v16
    v_mul_f32 v25, v25, v17
    v_mul_f32 v26, v26, v18
    v_mul_f32 v27, v27, v19
    v_mul_f32 v28, v28, v20
    v_mul_f32 v29, v29, v21
    v_mul_f32 v30, v30, v22
    v_mul_f32 v31, v31, v23
    v_exp_f32 v24, v24
    v_exp_f32 v25, v25
    v_exp_f32 v26, v26
    v_exp_f32 v27, v27
    v_exp_f32 v28, v28
    v_exp_f32 v29, v29
    v_exp_f32 v30, v30
    v_exp_f32 v31, v31
    v_add_f32 v24, 1.0, v24
    v_add_f32 v25, 1.0, v25
    v_add_f32 v26, 1.0, v26
    v_add_f32 v27, 1.0, v27
    v_add_f32 v28, 1.0, v28
    v_add_f32 v29, 1.0, v29
    v_add_f32 v30, 1.0, v30
    v_add_f32 v31, 1.0, v31
    v_rcp_f32 v24, v24
    v_rcp_f32 v25, v25
    v_rcp_f32 v26, v26
    v_rcp_f32 v27, v27
    v_rcp_f32 v28, v28
    v_rcp_f32 v29, v29
    v_rcp_f32 v30, v30
    v_rcp_f32 v31, v31
    v_mul_f32 v16, v16, v24
    v_mul_f32 v17, v17, v25
    v_mul_f32 v18, v18, v26
    v_mul_f32 v19, v19, v27
    v_mul_f32 v20, v20, v28
    v_mul_f32 v21, v21, v29
    v_mul_f32 v22, v22, v30
    v_mul_f32 v23, v23, v31
    v_cvt_pk_bf16_f32 v32, v16, v17
    v_cvt_pk_bf16_f32 v33, v18, v19
    buffer_store_dwordx2 v[32:33], v7, s[16:19], s25 offen offset:0 sc1
    v_cvt_pk_bf16_f32 v34, v20, v21
    v_cvt_pk_bf16_f32 v35, v22, v23
    buffer_store_dwordx2 v[34:35], v7, s[16:19], s25 offen offset:1024 sc1
    s_add_u32 s25, s25, 2048
    v_fma_f32 v36, v130, v144, v148
    v_fma_f32 v37, v134, v145, v149
    v_fma_f32 v38, v138, v146, v150
    v_fma_f32 v39, v142, v147, v151
    v_fma_f32 v40, v131, v144, v148
    v_fma_f32 v41, v135, v145, v149
    v_fma_f32 v42, v139, v146, v150
    v_fma_f32 v43, v143, v147, v151
    v_mul_f32 v44, v36, v36
    v_mul_f32 v45, v37, v37
    v_mul_f32 v46, v38, v38
    v_mul_f32 v47, v39, v39
    v_mul_f32 v48, v40, v40
    v_mul_f32 v49, v41, v41
    v_mul_f32 v50, v42, v42
    v_mul_f32 v51, v43, v43
    v_fma_f32 v44, v44, s31, v15
    v_fma_f32 v45, v45, s31, v15
    v_fma_f32 v46, v46, s31, v15
    v_fma_f32 v47, v47, s31, v15
    v_fma_f32 v48, v48, s31, v15
    v_fma_f32 v49, v49, s31, v15
    v_fma_f32 v50, v50, s31, v15
    v_fma_f32 v51, v51, s31, v15
    v_mul_f32 v44, v44, v36
    v_mul_f32 v45, v45, v37
    v_mul_f32 v46, v46, v38
    v_mul_f32 v47, v47, v39
    v_mul_f32 v48, v48, v40
    v_mul_f32 v49, v49, v41
    v_mul_f32 v50, v50, v42
    v_mul_f32 v51, v51, v43
    v_exp_f32 v44, v44
    v_exp_f32 v45, v45
    v_exp_f32 v46, v46
    v_exp_f32 v47, v47
    v_exp_f32 v48, v48
    v_exp_f32 v49, v49
    v_exp_f32 v50, v50
    v_exp_f32 v51, v51
    v_add_f32 v44, 1.0, v44
    v_add_f32 v45, 1.0, v45
    v_add_f32 v46, 1.0, v46
    v_add_f32 v47, 1.0, v47
    v_add_f32 v48, 1.0, v48
    v_add_f32 v49, 1.0, v49
    v_add_f32 v50, 1.0, v50
    v_add_f32 v51, 1.0, v51
    v_rcp_f32 v44, v44
    v_rcp_f32 v45, v45
    v_rcp_f32 v46, v46
    v_rcp_f32 v47, v47
    v_rcp_f32 v48, v48
    v_rcp_f32 v49, v49
    v_rcp_f32 v50, v50
    v_rcp_f32 v51, v51
    v_mul_f32 v36, v36, v44
    v_mul_f32 v37, v37, v45
    v_mul_f32 v38, v38, v46
    v_mul_f32 v39, v39, v47
    v_mul_f32 v40, v40, v48
    v_mul_f32 v41, v41, v49
    v_mul_f32 v42, v42, v50
    v_mul_f32 v43, v43, v51
    v_cvt_pk_bf16_f32 v52, v36, v37
    v_cvt_pk_bf16_f32 v53, v38, v39
    buffer_store_dwordx2 v[52:53], v7, s[16:19], s25 offen offset:0 sc1
    v_cvt_pk_bf16_f32 v54, v40, v41
    v_cvt_pk_bf16_f32 v55, v42, v43
    buffer_store_dwordx2 v[54:55], v7, s[16:19], s25 offen offset:1024 sc1
    s_add_u32 s25, s25, 2048
    s_add_u32 s25, s25, 12288
K34_END:
    s_endpgm
TEXT_END:
.section .rodata,"a"
.p2align 6
.amdhsa_kernel k1_xform_kernel
  .amdhsa_next_free_vgpr 128
  .amdhsa_next_free_sgpr 96
  .amdhsa_accum_offset 128
  .amdhsa_group_segment_fixed_size 0
  .amdhsa_kernarg_size 56
  .amdhsa_user_sgpr_count 2
  .amdhsa_user_sgpr_kernarg_segment_ptr 1
  .amdhsa_system_sgpr_workgroup_id_x 1
.end_amdhsa_kernel
.p2align 6
.amdhsa_kernel k12_fused_kernel
  .amdhsa_next_free_vgpr 256
  .amdhsa_next_free_sgpr 96
  .amdhsa_accum_offset 256
  .amdhsa_group_segment_fixed_size 0
  .amdhsa_kernarg_size 56
  .amdhsa_user_sgpr_count 2
  .amdhsa_user_sgpr_kernarg_segment_ptr 1
  .amdhsa_system_sgpr_workgroup_id_x 1
.end_amdhsa_kernel
.p2align 6
.amdhsa_kernel k34_out_kernel
  .amdhsa_next_free_vgpr 168
  .amdhsa_next_free_sgpr 96
  .amdhsa_accum_offset 168
  .amdhsa_group_segment_fixed_size 0
  .amdhsa_kernarg_size 56
  .amdhsa_user_sgpr_count 2
  .amdhsa_user_sgpr_kernarg_segment_ptr 1
  .amdhsa_system_sgpr_workgroup_id_x 1
.end_amdhsa_kernel
```

```asm
; @launch kernel=k1_xform_kernel grid=(636,1,1) block=(256,1,1) lds=16384
; @launch kernel=k12_fused_kernel grid=(256,1,1) block=(512,1,1) lds=155872
; @launch kernel=k34_out_kernel grid=(256,1,1) block=(768,1,1) lds=18944
.amdgcn_target "amdgcn-amd-amdhsa--gfx950"
.text
.globl k1_xform_kernel
.globl k12_fused_kernel
.globl k34_out_kernel
.p2align 8
.type k1_xform_kernel,@function
k1_xform_kernel:
    s_cmp_ge_u32 s2, 636
    s_cbranch_scc1 K1_END
    s_load_dwordx4 s[4:7], s[0:1], 0
    s_load_dwordx2 s[8:9], s[0:1], 48
    s_cmp_lt_u32 s2, 8
    s_cbranch_scc0 K1_NOCPF
    s_getpc_b64 s[90:91]
CPF_K1:
    s_sub_u32 s90, s90, CPF_K1-k1_xform_kernel
    s_subb_u32 s91, s91, 0
    v_lshlrev_b32 v8, 7, v0
    v_mov_b32 v11, s91
    v_min_u32 v9, TEXT_END-k1_xform_kernel-4, v8
    v_add_co_u32 v10, vcc, s90, v9
    v_addc_co_u32 v11, vcc, 0, v11, vcc
    global_load_dword v63, v[10:11], off
    v_mov_b32 v11, s91
    v_add_u32 v8, 32768, v8
    v_min_u32 v9, TEXT_END-k1_xform_kernel-4, v8
    v_add_co_u32 v10, vcc, s90, v9
    v_addc_co_u32 v11, vcc, 0, v11, vcc
    global_load_dword v63, v[10:11], off
K1_NOCPF:
    v_lshrrev_b32 v120, 6, v0
    v_and_b32 v121, 63, v0
    v_readfirstlane_b32 s3, v120
    v_and_b32 v122, 15, v121
    v_lshrrev_b32 v123, 4, v121
    s_mov_b32 s28, 0x05040100
    s_mov_b32 s29, 0x07060302
    v_and_b32 v124, 3, v122
    v_lshlrev_b32 v124, 2, v124
    v_lshrrev_b32 v125, 3, v122
    v_lshl_add_u32 v124, v125, 1, v124
    s_lshl_b32 s10, s3, 4
    s_add_u32 s10, s10, 1
    v_add_u32 v124, s10, v124
    v_bfe_u32 v125, v122, 2, 1
    v_lshlrev_b32 v121, 4, v121
    s_waitcnt lgkmcnt(0)
    s_or_b32 s10, s2, s3
    s_cmp_eq_u32 s10, 0
    s_cbranch_scc0 K1_NOCLR
    s_add_u32 s12, s8, 153092096
    s_addc_u32 s13, s9, 0
    s_and_b32 s13, s13, 0xffff
    s_mov_b32 s14, 32768
    s_mov_b32 s15, 0x00020000
    v_lshrrev_b32 v118, 4, v121
    v_lshlrev_b32 v119, 10, v118
    v_mov_b32 v117, 0
    s_mov_b64 exec, 0xffff
    buffer_store_dword v117, v119, s[12:15], 0 offen
    v_lshlrev_b32 v119, 4, v118
    v_add_u32 v119, 16384, v119
    buffer_store_dword v117, v119, s[12:15], 0 offen
    s_mov_b64 exec, -1
K1_NOCLR:
    s_cmp_lt_u32 s2, 32
    s_cbranch_scc0 K1_NOFILL
    s_add_u32 s12, s8, 153616384
    s_addc_u32 s13, s9, 0
    s_and_b32 s13, s13, 0xffff
    s_mov_b32 s14, 131072
    s_mov_b32 s15, 0x00020000
    s_lshl_b32 s10, s2, 2
    s_add_u32 s10, s10, s3
    s_lshl_b32 s10, s10, 10
    v_mov_b32 v112, -1
    v_mov_b32 v113, -1
    v_mov_b32 v114, -1
    v_mov_b32 v115, -1
    buffer_store_dwordx4 v[112:115], v121, s[12:15], s10 offen
K1_NOFILL:
    s_add_u32 s10, s2, 384
    s_sub_u32 s11, s2, 252
    s_cmp_lt_u32 s2, 252
    s_cselect_b32 s2, s10, s11
    s_cmp_lt_u32 s2, 384
    s_cbranch_scc1 K1_W
    s_sub_u32 s11, s2, 384
    s_mul_hi_u32 s13, s11, 1431655766
    s_mul_i32 s12, s13, 3
    s_sub_u32 s12, s11, s12
    s_mov_b32 s11, s13
    s_cmp_ge_u32 s11, 42
    s_cselect_b32 s13, 1, 0
    s_mul_i32 s14, s13, 42
    s_sub_u32 s11, s11, s14
    s_lshl_b32 s11, s11, 2
    s_add_u32 s11, s11, s3
    s_mul_i32 s14, s13, 16384000
    s_add_u32 s16, s4, s14
    s_addc_u32 s17, s5, 0
    s_and_b32 s17, s17, 0xffff
    s_mov_b32 s18, 16384000
    s_mov_b32 s19, 0x00020000
    s_mov_b32 s20, s8
    s_mov_b32 s21, s9
    s_and_b32 s21, s21, 0xffff
    s_mov_b32 s22, 43778048
    s_mov_b32 s23, 0x00020000
    v_lshlrev_b32 v126, 14, v123
    v_lshl_add_u32 v126, v122, 4, v126
    s_mul_i32 s15, s11, 98304
    s_lshl_b32 s24, s12, 8
    s_add_u32 s15, s15, s24
    buffer_load_dwordx4 v[0:3], v126, s[16:19], s15 offen
    buffer_load_dwordx4 v[4:7], v126, s[16:19], s15 offen offset:2048
    s_add_u32 s15, s15, 4096
    buffer_load_dwordx4 v[8:11], v126, s[16:19], s15 offen
    buffer_load_dwordx4 v[12:15], v126, s[16:19], s15 offen offset:2048
    s_add_u32 s15, s15, 4096
    buffer_load_dwordx4 v[16:19], v126, s[16:19], s15 offen
    buffer_load_dwordx4 v[20:23], v126, s[16:19], s15 offen offset:2048
    s_add_u32 s15, s15, 4096
    buffer_load_dwordx4 v[24:27], v126, s[16:19], s15 offen
    buffer_load_dwordx4 v[28:31], v126, s[16:19], s15 offen offset:2048
    s_add_u32 s15, s15, 53248
    buffer_load_dwordx4 v[32:35], v126, s[16:19], s15 offen
    buffer_load_dwordx4 v[36:39], v126, s[16:19], s15 offen offset:2048
    s_add_u32 s15, s15, 4096
    buffer_load_dwordx4 v[40:43], v126, s[16:19], s15 offen
    buffer_load_dwordx4 v[44:47], v126, s[16:19], s15 offen offset:2048
    s_add_u32 s15, s15, 4096
    buffer_load_dwordx4 v[48:51], v126, s[16:19], s15 offen
    buffer_load_dwordx4 v[52:55], v126, s[16:19], s15 offen offset:2048
    s_add_u32 s15, s15, 4096
    buffer_load_dwordx4 v[56:59], v126, s[16:19], s15 offen
    buffer_load_dwordx4 v[60:63], v126, s[16:19], s15 offen offset:2048
    v_lshlrev_b32 v127, 3, v123
    v_lshlrev_b32 v112, 5, v125
    v_mad_u32_u24 v113, v124, v127, v112
    v_mad_u32_u24 v64, v124, 0, v113
    v_mad_u32_u24 v65, v124, 1, v113
    v_mad_u32_u24 v66, v124, 2, v113
    v_mad_u32_u24 v67, v124, 3, v113
    v_mad_u32_u24 v68, v124, 4, v113
    v_mad_u32_u24 v69, v124, 5, v113
    v_mad_u32_u24 v70, v124, 6, v113
    v_mad_u32_u24 v71, v124, 7, v113
    v_and_b32 v64, 127, v64
    v_and_b32 v65, 127, v65
    v_and_b32 v66, 127, v66
    v_and_b32 v67, 127, v67
    v_and_b32 v68, 127, v68
    v_and_b32 v69, 127, v69
    v_and_b32 v70, 127, v70
    v_and_b32 v71, 127, v71
    v_cvt_f32_u32 v64, v64
    v_cvt_f32_u32 v65, v65
    v_cvt_f32_u32 v66, v66
    v_cvt_f32_u32 v67, v67
    v_cvt_f32_u32 v68, v68
    v_cvt_f32_u32 v69, v69
    v_cvt_f32_u32 v70, v70
    v_cvt_f32_u32 v71, v71
    v_mul_f32 v64, 0x3c000000, v64
    v_mul_f32 v65, 0x3c000000, v65
    v_mul_f32 v66, 0x3c000000, v66
    v_mul_f32 v67, 0x3c000000, v67
    v_mul_f32 v68, 0x3c000000, v68
    v_mul_f32 v69, 0x3c000000, v69
    v_mul_f32 v70, 0x3c000000, v70
    v_mul_f32 v71, 0x3c000000, v71
    v_cos_f32 v64, v64
    v_cos_f32 v65, v65
    v_cos_f32 v66, v66
    v_cos_f32 v67, v67
    v_cos_f32 v68, v68
    v_cos_f32 v69, v69
    v_cos_f32 v70, v70
    v_cos_f32 v71, v71
    s_nop 0
    v_cvt_pk_bf16_f32 v72, v64, v65
    v_cvt_pk_bf16_f32 v73, v66, v67
    v_cvt_pk_bf16_f32 v74, v68, v69
    v_cvt_pk_bf16_f32 v75, v70, v71
    v_lshlrev_b32 v80, 16, v72
    v_and_b32 v81, 0xffff0000, v72
    v_sub_f32 v64, v64, v80
    v_sub_f32 v65, v65, v81
    v_lshlrev_b32 v80, 16, v73
    v_and_b32 v81, 0xffff0000, v73
    v_sub_f32 v66, v66, v80
    v_sub_f32 v67, v67, v81
    v_lshlrev_b32 v80, 16, v74
    v_and_b32 v81, 0xffff0000, v74
    v_sub_f32 v68, v68, v80
    v_sub_f32 v69, v69, v81
    v_lshlrev_b32 v80, 16, v75
    v_and_b32 v81, 0xffff0000, v75
    v_sub_f32 v70, v70, v80
    v_sub_f32 v71, v71, v81
    v_cvt_pk_bf16_f32 v76, v64, v65
    v_cvt_pk_bf16_f32 v77, v66, v67
    v_cvt_pk_bf16_f32 v78, v68, v69
    v_cvt_pk_bf16_f32 v79, v70, v71
    s_lshl_b32 s24, s3, 12
    v_add_u32 v114, s24, v121
    ds_write_b128 v114, v[72:75] offset:0
    ds_write_b128 v114, v[76:79] offset:1024
    v_add_u32 v127, 32, v127
    v_lshlrev_b32 v112, 5, v125
    v_mad_u32_u24 v113, v124, v127, v112
    v_mad_u32_u24 v64, v124, 0, v113
    v_mad_u32_u24 v65, v124, 1, v113
    v_mad_u32_u24 v66, v124, 2, v113
    v_mad_u32_u24 v67, v124, 3, v113
    v_mad_u32_u24 v68, v124, 4, v113
    v_mad_u32_u24 v69, v124, 5, v113
    v_mad_u32_u24 v70, v124, 6, v113
    v_mad_u32_u24 v71, v124, 7, v113
    v_and_b32 v64, 127, v64
    v_and_b32 v65, 127, v65
    v_and_b32 v66, 127, v66
    v_and_b32 v67, 127, v67
    v_and_b32 v68, 127, v68
    v_and_b32 v69, 127, v69
    v_and_b32 v70, 127, v70
    v_and_b32 v71, 127, v71
    v_cvt_f32_u32 v64, v64
    v_cvt_f32_u32 v65, v65
    v_cvt_f32_u32 v66, v66
    v_cvt_f32_u32 v67, v67
    v_cvt_f32_u32 v68, v68
    v_cvt_f32_u32 v69, v69
    v_cvt_f32_u32 v70, v70
    v_cvt_f32_u32 v71, v71
    v_mul_f32 v64, 0x3c000000, v64
    v_mul_f32 v65, 0x3c000000, v65
    v_mul_f32 v66, 0x3c000000, v66
    v_mul_f32 v67, 0x3c000000, v67
    v_mul_f32 v68, 0x3c000000, v68
    v_mul_f32 v69, 0x3c000000, v69
    v_mul_f32 v70, 0x3c000000, v70
    v_mul_f32 v71, 0x3c000000, v71
    v_cos_f32 v64, v64
    v_cos_f32 v65, v65
    v_cos_f32 v66, v66
    v_cos_f32 v67, v67
    v_cos_f32 v68, v68
    v_cos_f32 v69, v69
    v_cos_f32 v70, v70
    v_cos_f32 v71, v71
    s_nop 0
    v_cvt_pk_bf16_f32 v72, v64, v65
    v_cvt_pk_bf16_f32 v73, v66, v67
    v_cvt_pk_bf16_f32 v74, v68, v69
    v_cvt_pk_bf16_f32 v75, v70, v71
    v_lshlrev_b32 v80, 16, v72
    v_and_b32 v81, 0xffff0000, v72
    v_sub_f32 v64, v64, v80
    v_sub_f32 v65, v65, v81
    v_lshlrev_b32 v80, 16, v73
    v_and_b32 v81, 0xffff0000, v73
    v_sub_f32 v66, v66, v80
    v_sub_f32 v67, v67, v81
    v_lshlrev_b32 v80, 16, v74
    v_and_b32 v81, 0xffff0000, v74
    v_sub_f32 v68, v68, v80
    v_sub_f32 v69, v69, v81
    v_lshlrev_b32 v80, 16, v75
    v_and_b32 v81, 0xffff0000, v75
    v_sub_f32 v70, v70, v80
    v_sub_f32 v71, v71, v81
    v_cvt_pk_bf16_f32 v76, v64, v65
    v_cvt_pk_bf16_f32 v77, v66, v67
    v_cvt_pk_bf16_f32 v78, v68, v69
    v_cvt_pk_bf16_f32 v79, v70, v71
    s_lshl_b32 s24, s3, 12
    v_add_u32 v114, s24, v121
    ds_write_b128 v114, v[72:75] offset:2048
    ds_write_b128 v114, v[76:79] offset:3072
    v_lshrrev_b32 v112, 1, v123
    s_mov_b32 s24, 1368064
    v_mul_lo_u32 v112, v112, s24
    v_lshrrev_b32 v113, 2, v122
    s_mov_b32 s24, 21376
    v_mul_lo_u32 v113, v113, s24
    v_add_u32 v112, v112, v113
    v_and_b32 v113, 3, v122
    v_and_b32 v114, 1, v123
    v_lshl_add_u32 v113, v114, 2, v113
    s_add_u32 s24, s11, 7
    s_cmp_ge_u32 s11, 160
    s_cselect_b32 s24, s24, s11
    s_cmp_eq_u32 s13, 1
    s_cselect_b32 s24, s24, s11
    s_lshr_b32 s24, s24, 1
    s_and_b32 s24, s24, 7
    v_xor_b32 v113, s24, v113
    v_lshl_add_u32 v120, v113, 4, v112
    s_mul_i32 s25, s13, 684032
    s_mul_i32 s24, s12, 85504
    s_add_u32 s25, s25, s24
    s_lshl_b32 s24, s11, 7
    s_add_u32 s25, s25, s24
    s_waitcnt lgkmcnt(0)
    s_barrier
    s_cmp_ge_u32 s11, 167
    s_cbranch_scc1 K1_END
    s_waitcnt vmcnt(8)
    v_perm_b32 v64, v4, v0, s28
    v_perm_b32 v68, v4, v0, s29
    v_perm_b32 v65, v12, v8, s28
    v_perm_b32 v69, v12, v8, s29
    v_perm_b32 v66, v20, v16, s28
    v_perm_b32 v70, v20, v16, s29
    v_perm_b32 v67, v28, v24, s28
    v_perm_b32 v71, v28, v24, s29
    v_perm_b32 v72, v5, v1, s28
    v_perm_b32 v76, v5, v1, s29
    v_perm_b32 v73, v13, v9, s28
    v_perm_b32 v77, v13, v9, s29
    v_perm_b32 v74, v21, v17, s28
    v_perm_b32 v78, v21, v17, s29
    v_perm_b32 v75, v29, v25, s28
    v_perm_b32 v79, v29, v25, s29
    v_perm_b32 v80, v6, v2, s28
    v_perm_b32 v84, v6, v2, s29
    v_perm_b32 v81, v14, v10, s28
    v_perm_b32 v85, v14, v10, s29
    v_perm_b32 v82, v22, v18, s28
    v_perm_b32 v86, v22, v18, s29
    v_perm_b32 v83, v30, v26, s28
    v_perm_b32 v87, v30, v26, s29
    v_perm_b32 v88, v7, v3, s28
    v_perm_b32 v92, v7, v3, s29
    v_perm_b32 v89, v15, v11, s28
    v_perm_b32 v93, v15, v11, s29
    v_perm_b32 v90, v23, v19, s28
    v_perm_b32 v94, v23, v19, s29
    v_perm_b32 v91, v31, v27, s28
    v_perm_b32 v95, v31, v27, s29
    s_waitcnt vmcnt(0)
    v_perm_b32 v0, v36, v32, s28
    v_perm_b32 v4, v36, v32, s29
    v_perm_b32 v1, v44, v40, s28
    v_perm_b32 v5, v44, v40, s29
    v_perm_b32 v2, v52, v48, s28
    v_perm_b32 v6, v52, v48, s29
    v_perm_b32 v3, v60, v56, s28
    v_perm_b32 v7, v60, v56, s29
    v_perm_b32 v8, v37, v33, s28
    v_perm_b32 v12, v37, v33, s29
    v_perm_b32 v9, v45, v41, s28
    v_perm_b32 v13, v45, v41, s29
    v_perm_b32 v10, v53, v49, s28
    v_perm_b32 v14, v53, v49, s29
    v_perm_b32 v11, v61, v57, s28
    v_perm_b32 v15, v61, v57, s29
    v_perm_b32 v16, v38, v34, s28
    v_perm_b32 v20, v38, v34, s29
    v_perm_b32 v17, v46, v42, s28
    v_perm_b32 v21, v46, v42, s29
    v_perm_b32 v18, v54, v50, s28
    v_perm_b32 v22, v54, v50, s29
    v_perm_b32 v19, v62, v58, s28
    v_perm_b32 v23, v62, v58, s29
    v_perm_b32 v24, v39, v35, s28
    v_perm_b32 v28, v39, v35, s29
    v_perm_b32 v25, v47, v43, s28
    v_perm_b32 v29, v47, v43, s29
    v_perm_b32 v26, v55, v51, s28
    v_perm_b32 v30, v55, v51, s29
    v_perm_b32 v27, v63, v59, s28
    v_perm_b32 v31, v63, v59, s29
    ds_read_b128 v[96:99], v121 offset:0
    ds_read_b128 v[100:103], v121 offset:1024
    ds_read_b128 v[104:107], v121 offset:2048
    ds_read_b128 v[108:111], v121 offset:3072
    s_waitcnt lgkmcnt(3)
    v_mfma_f32_16x16x32_bf16 v[32:35], v[96:99], v[64:67], 0
    v_mfma_f32_16x16x32_bf16 v[36:39], v[96:99], v[68:71], 0
    v_mfma_f32_16x16x32_bf16 v[40:43], v[96:99], v[72:75], 0
    v_mfma_f32_16x16x32_bf16 v[44:47], v[96:99], v[76:79], 0
    v_mfma_f32_16x16x32_bf16 v[48:51], v[96:99], v[80:83], 0
    v_mfma_f32_16x16x32_bf16 v[52:55], v[96:99], v[84:87], 0
    v_mfma_f32_16x16x32_bf16 v[56:59], v[96:99], v[88:91], 0
    v_mfma_f32_16x16x32_bf16 v[60:63], v[96:99], v[92:95], 0
    s_waitcnt lgkmcnt(2)
    v_mfma_f32_16x16x32_bf16 v[32:35], v[100:103], v[64:67], v[32:35]
    v_mfma_f32_16x16x32_bf16 v[36:39], v[100:103], v[68:71], v[36:39]
    v_mfma_f32_16x16x32_bf16 v[40:43], v[100:103], v[72:75], v[40:43]
    v_mfma_f32_16x16x32_bf16 v[44:47], v[100:103], v[76:79], v[44:47]
    v_mfma_f32_16x16x32_bf16 v[48:51], v[100:103], v[80:83], v[48:51]
    v_mfma_f32_16x16x32_bf16 v[52:55], v[100:103], v[84:87], v[52:55]
    v_mfma_f32_16x16x32_bf16 v[56:59], v[100:103], v[88:91], v[56:59]
    v_mfma_f32_16x16x32_bf16 v[60:63], v[100:103], v[92:95], v[60:63]
    s_waitcnt lgkmcnt(1)
    v_mfma_f32_16x16x32_bf16 v[32:35], v[104:107], v[0:3], v[32:35]
    v_mfma_f32_16x16x32_bf16 v[36:39], v[104:107], v[4:7], v[36:39]
    v_mfma_f32_16x16x32_bf16 v[40:43], v[104:107], v[8:11], v[40:43]
    v_mfma_f32_16x16x32_bf16 v[44:47], v[104:107], v[12:15], v[44:47]
    v_mfma_f32_16x16x32_bf16 v[48:51], v[104:107], v[16:19], v[48:51]
    v_mfma_f32_16x16x32_bf16 v[52:55], v[104:107], v[20:23], v[52:55]
    v_mfma_f32_16x16x32_bf16 v[56:59], v[104:107], v[24:27], v[56:59]
    v_mfma_f32_16x16x32_bf16 v[60:63], v[104:107], v[28:31], v[60:63]
    s_waitcnt lgkmcnt(0)
    v_mfma_f32_16x16x32_bf16 v[32:35], v[108:111], v[0:3], v[32:35]
    v_mfma_f32_16x16x32_bf16 v[36:39], v[108:111], v[4:7], v[36:39]
    v_mfma_f32_16x16x32_bf16 v[40:43], v[108:111], v[8:11], v[40:43]
    v_mfma_f32_16x16x32_bf16 v[44:47], v[108:111], v[12:15], v[44:47]
    v_mfma_f32_16x16x32_bf16 v[48:51], v[108:111], v[16:19], v[48:51]
    v_mfma_f32_16x16x32_bf16 v[52:55], v[108:111], v[20:23], v[52:55]
    v_mfma_f32_16x16x32_bf16 v[56:59], v[108:111], v[24:27], v[56:59]
    v_mfma_f32_16x16x32_bf16 v[60:63], v[108:111], v[28:31], v[60:63]
    s_nop 7
    v_cvt_pk_bf16_f32 v112, v32, v36
    v_cvt_pk_bf16_f32 v113, v40, v44
    v_cvt_pk_bf16_f32 v114, v48, v52
    v_cvt_pk_bf16_f32 v115, v56, v60
    buffer_store_dwordx4 v[112:115], v120, s[20:23], s25 offen
    s_add_u32 s25, s25, 2736128
    v_cvt_pk_bf16_f32 v116, v33, v37
    v_cvt_pk_bf16_f32 v117, v41, v45
    v_cvt_pk_bf16_f32 v118, v49, v53
    v_cvt_pk_bf16_f32 v119, v57, v61
    buffer_store_dwordx4 v[116:119], v120, s[20:23], s25 offen
    s_add_u32 s25, s25, 2736128
    v_cvt_pk_bf16_f32 v112, v34, v38
    v_cvt_pk_bf16_f32 v113, v42, v46
    v_cvt_pk_bf16_f32 v114, v50, v54
    v_cvt_pk_bf16_f32 v115, v58, v62
    buffer_store_dwordx4 v[112:115], v120, s[20:23], s25 offen
    s_add_u32 s25, s25, 2736128
    v_cvt_pk_bf16_f32 v116, v35, v39
    v_cvt_pk_bf16_f32 v117, v43, v47
    v_cvt_pk_bf16_f32 v118, v51, v55
    v_cvt_pk_bf16_f32 v119, v59, v63
    buffer_store_dwordx4 v[116:119], v120, s[20:23], s25 offen
    s_add_u32 s25, s25, 2736128
    ds_read_b128 v[96:99], v121 offset:4096
    ds_read_b128 v[100:103], v121 offset:5120
    ds_read_b128 v[104:107], v121 offset:6144
    ds_read_b128 v[108:111], v121 offset:7168
    s_waitcnt lgkmcnt(3)
    v_mfma_f32_16x16x32_bf16 v[32:35], v[96:99], v[64:67], 0
    v_mfma_f32_16x16x32_bf16 v[36:39], v[96:99], v[68:71], 0
    v_mfma_f32_16x16x32_bf16 v[40:43], v[96:99], v[72:75], 0
    v_mfma_f32_16x16x32_bf16 v[44:47], v[96:99], v[76:79], 0
    v_mfma_f32_16x16x32_bf16 v[48:51], v[96:99], v[80:83], 0
    v_mfma_f32_16x16x32_bf16 v[52:55], v[96:99], v[84:87], 0
    v_mfma_f32_16x16x32_bf16 v[56:59], v[96:99], v[88:91], 0
    v_mfma_f32_16x16x32_bf16 v[60:63], v[96:99], v[92:95], 0
    s_waitcnt lgkmcnt(2)
    v_mfma_f32_16x16x32_bf16 v[32:35], v[100:103], v[64:67], v[32:35]
    v_mfma_f32_16x16x32_bf16 v[36:39], v[100:103], v[68:71], v[36:39]
    v_mfma_f32_16x16x32_bf16 v[40:43], v[100:103], v[72:75], v[40:43]
    v_mfma_f32_16x16x32_bf16 v[44:47], v[100:103], v[76:79], v[44:47]
    v_mfma_f32_16x16x32_bf16 v[48:51], v[100:103], v[80:83], v[48:51]
    v_mfma_f32_16x16x32_bf16 v[52:55], v[100:103], v[84:87], v[52:55]
    v_mfma_f32_16x16x32_bf16 v[56:59], v[100:103], v[88:91], v[56:59]
    v_mfma_f32_16x16x32_bf16 v[60:63], v[100:103], v[92:95], v[60:63]
    s_waitcnt lgkmcnt(1)
    v_mfma_f32_16x16x32_bf16 v[32:35], v[104:107], v[0:3], v[32:35]
    v_mfma_f32_16x16x32_bf16 v[36:39], v[104:107], v[4:7], v[36:39]
    v_mfma_f32_16x16x32_bf16 v[40:43], v[104:107], v[8:11], v[40:43]
    v_mfma_f32_16x16x32_bf16 v[44:47], v[104:107], v[12:15], v[44:47]
    v_mfma_f32_16x16x32_bf16 v[48:51], v[104:107], v[16:19], v[48:51]
    v_mfma_f32_16x16x32_bf16 v[52:55], v[104:107], v[20:23], v[52:55]
    v_mfma_f32_16x16x32_bf16 v[56:59], v[104:107], v[24:27], v[56:59]
    v_mfma_f32_16x16x32_bf16 v[60:63], v[104:107], v[28:31], v[60:63]
    s_waitcnt lgkmcnt(0)
    v_mfma_f32_16x16x32_bf16 v[32:35], v[108:111], v[0:3], v[32:35]
    v_mfma_f32_16x16x32_bf16 v[36:39], v[108:111], v[4:7], v[36:39]
    v_mfma_f32_16x16x32_bf16 v[40:43], v[108:111], v[8:11], v[40:43]
    v_mfma_f32_16x16x32_bf16 v[44:47], v[108:111], v[12:15], v[44:47]
    v_mfma_f32_16x16x32_bf16 v[48:51], v[108:111], v[16:19], v[48:51]
    v_mfma_f32_16x16x32_bf16 v[52:55], v[108:111], v[20:23], v[52:55]
    v_mfma_f32_16x16x32_bf16 v[56:59], v[108:111], v[24:27], v[56:59]
    v_mfma_f32_16x16x32_bf16 v[60:63], v[108:111], v[28:31], v[60:63]
    s_nop 7
    v_cvt_pk_bf16_f32 v112, v32, v36
    v_cvt_pk_bf16_f32 v113, v40, v44
    v_cvt_pk_bf16_f32 v114, v48, v52
    v_cvt_pk_bf16_f32 v115, v56, v60
    buffer_store_dwordx4 v[112:115], v120, s[20:23], s25 offen
    s_add_u32 s25, s25, 2736128
    v_cvt_pk_bf16_f32 v116, v33, v37
    v_cvt_pk_bf16_f32 v117, v41, v45
    v_cvt_pk_bf16_f32 v118, v49, v53
    v_cvt_pk_bf16_f32 v119, v57, v61
    buffer_store_dwordx4 v[116:119], v120, s[20:23], s25 offen
    s_add_u32 s25, s25, 2736128
    v_cvt_pk_bf16_f32 v112, v34, v38
    v_cvt_pk_bf16_f32 v113, v42, v46
    v_cvt_pk_bf16_f32 v114, v50, v54
    v_cvt_pk_bf16_f32 v115, v58, v62
    buffer_store_dwordx4 v[112:115], v120, s[20:23], s25 offen
    s_add_u32 s25, s25, 2736128
    v_cvt_pk_bf16_f32 v116, v35, v39
    v_cvt_pk_bf16_f32 v117, v43, v47
    v_cvt_pk_bf16_f32 v118, v51, v55
    v_cvt_pk_bf16_f32 v119, v59, v63
    buffer_store_dwordx4 v[116:119], v120, s[20:23], s25 offen
    s_add_u32 s25, s25, 2736128
    ds_read_b128 v[96:99], v121 offset:8192
    ds_read_b128 v[100:103], v121 offset:9216
    ds_read_b128 v[104:107], v121 offset:10240
    ds_read_b128 v[108:111], v121 offset:11264
    s_waitcnt lgkmcnt(3)
    v_mfma_f32_16x16x32_bf16 v[32:35], v[96:99], v[64:67], 0
    v_mfma_f32_16x16x32_bf16 v[36:39], v[96:99], v[68:71], 0
    v_mfma_f32_16x16x32_bf16 v[40:43], v[96:99], v[72:75], 0
    v_mfma_f32_16x16x32_bf16 v[44:47], v[96:99], v[76:79], 0
    v_mfma_f32_16x16x32_bf16 v[48:51], v[96:99], v[80:83], 0
    v_mfma_f32_16x16x32_bf16 v[52:55], v[96:99], v[84:87], 0
    v_mfma_f32_16x16x32_bf16 v[56:59], v[96:99], v[88:91], 0
    v_mfma_f32_16x16x32_bf16 v[60:63], v[96:99], v[92:95], 0
    s_waitcnt lgkmcnt(2)
    v_mfma_f32_16x16x32_bf16 v[32:35], v[100:103], v[64:67], v[32:35]
    v_mfma_f32_16x16x32_bf16 v[36:39], v[100:103], v[68:71], v[36:39]
    v_mfma_f32_16x16x32_bf16 v[40:43], v[100:103], v[72:75], v[40:43]
    v_mfma_f32_16x16x32_bf16 v[44:47], v[100:103], v[76:79], v[44:47]
    v_mfma_f32_16x16x32_bf16 v[48:51], v[100:103], v[80:83], v[48:51]
    v_mfma_f32_16x16x32_bf16 v[52:55], v[100:103], v[84:87], v[52:55]
    v_mfma_f32_16x16x32_bf16 v[56:59], v[100:103], v[88:91], v[56:59]
    v_mfma_f32_16x16x32_bf16 v[60:63], v[100:103], v[92:95], v[60:63]
    s_waitcnt lgkmcnt(1)
    v_mfma_f32_16x16x32_bf16 v[32:35], v[104:107], v[0:3], v[32:35]
    v_mfma_f32_16x16x32_bf16 v[36:39], v[104:107], v[4:7], v[36:39]
    v_mfma_f32_16x16x32_bf16 v[40:43], v[104:107], v[8:11], v[40:43]
    v_mfma_f32_16x16x32_bf16 v[44:47], v[104:107], v[12:15], v[44:47]
    v_mfma_f32_16x16x32_bf16 v[48:51], v[104:107], v[16:19], v[48:51]
    v_mfma_f32_16x16x32_bf16 v[52:55], v[104:107], v[20:23], v[52:55]
    v_mfma_f32_16x16x32_bf16 v[56:59], v[104:107], v[24:27], v[56:59]
    v_mfma_f32_16x16x32_bf16 v[60:63], v[104:107], v[28:31], v[60:63]
    s_waitcnt lgkmcnt(0)
    v_mfma_f32_16x16x32_bf16 v[32:35], v[108:111], v[0:3], v[32:35]
    v_mfma_f32_16x16x32_bf16 v[36:39], v[108:111], v[4:7], v[36:39]
    v_mfma_f32_16x16x32_bf16 v[40:43], v[108:111], v[8:11], v[40:43]
    v_mfma_f32_16x16x32_bf16 v[44:47], v[108:111], v[12:15], v[44:47]
    v_mfma_f32_16x16x32_bf16 v[48:51], v[108:111], v[16:19], v[48:51]
    v_mfma_f32_16x16x32_bf16 v[52:55], v[108:111], v[20:23], v[52:55]
    v_mfma_f32_16x16x32_bf16 v[56:59], v[108:111], v[24:27], v[56:59]
    v_mfma_f32_16x16x32_bf16 v[60:63], v[108:111], v[28:31], v[60:63]
    s_nop 7
    v_cvt_pk_bf16_f32 v112, v32, v36
    v_cvt_pk_bf16_f32 v113, v40, v44
    v_cvt_pk_bf16_f32 v114, v48, v52
    v_cvt_pk_bf16_f32 v115, v56, v60
    buffer_store_dwordx4 v[112:115], v120, s[20:23], s25 offen
    s_add_u32 s25, s25, 2736128
    v_cvt_pk_bf16_f32 v116, v33, v37
    v_cvt_pk_bf16_f32 v117, v41, v45
    v_cvt_pk_bf16_f32 v118, v49, v53
    v_cvt_pk_bf16_f32 v119, v57, v61
    buffer_store_dwordx4 v[116:119], v120, s[20:23], s25 offen
    s_add_u32 s25, s25, 2736128
    v_cvt_pk_bf16_f32 v112, v34, v38
    v_cvt_pk_bf16_f32 v113, v42, v46
    v_cvt_pk_bf16_f32 v114, v50, v54
    v_cvt_pk_bf16_f32 v115, v58, v62
    buffer_store_dwordx4 v[112:115], v120, s[20:23], s25 offen
    s_add_u32 s25, s25, 2736128
    v_cvt_pk_bf16_f32 v116, v35, v39
    v_cvt_pk_bf16_f32 v117, v43, v47
    v_cvt_pk_bf16_f32 v118, v51, v55
    v_cvt_pk_bf16_f32 v119, v59, v63
    buffer_store_dwordx4 v[116:119], v120, s[20:23], s25 offen
    s_add_u32 s25, s25, 2736128
    ds_read_b128 v[96:99], v121 offset:12288
    ds_read_b128 v[100:103], v121 offset:13312
    ds_read_b128 v[104:107], v121 offset:14336
    ds_read_b128 v[108:111], v121 offset:15360
    s_waitcnt lgkmcnt(3)
    v_mfma_f32_16x16x32_bf16 v[32:35], v[96:99], v[64:67], 0
    v_mfma_f32_16x16x32_bf16 v[36:39], v[96:99], v[68:71], 0
    v_mfma_f32_16x16x32_bf16 v[40:43], v[96:99], v[72:75], 0
    v_mfma_f32_16x16x32_bf16 v[44:47], v[96:99], v[76:79], 0
    v_mfma_f32_16x16x32_bf16 v[48:51], v[96:99], v[80:83], 0
    v_mfma_f32_16x16x32_bf16 v[52:55], v[96:99], v[84:87], 0
    v_mfma_f32_16x16x32_bf16 v[56:59], v[96:99], v[88:91], 0
    v_mfma_f32_16x16x32_bf16 v[60:63], v[96:99], v[92:95], 0
    s_waitcnt lgkmcnt(2)
    v_mfma_f32_16x16x32_bf16 v[32:35], v[100:103], v[64:67], v[32:35]
    v_mfma_f32_16x16x32_bf16 v[36:39], v[100:103], v[68:71], v[36:39]
    v_mfma_f32_16x16x32_bf16 v[40:43], v[100:103], v[72:75], v[40:43]
    v_mfma_f32_16x16x32_bf16 v[44:47], v[100:103], v[76:79], v[44:47]
    v_mfma_f32_16x16x32_bf16 v[48:51], v[100:103], v[80:83], v[48:51]
    v_mfma_f32_16x16x32_bf16 v[52:55], v[100:103], v[84:87], v[52:55]
    v_mfma_f32_16x16x32_bf16 v[56:59], v[100:103], v[88:91], v[56:59]
    v_mfma_f32_16x16x32_bf16 v[60:63], v[100:103], v[92:95], v[60:63]
    s_waitcnt lgkmcnt(1)
    v_mfma_f32_16x16x32_bf16 v[32:35], v[104:107], v[0:3], v[32:35]
    v_mfma_f32_16x16x32_bf16 v[36:39], v[104:107], v[4:7], v[36:39]
    v_mfma_f32_16x16x32_bf16 v[40:43], v[104:107], v[8:11], v[40:43]
    v_mfma_f32_16x16x32_bf16 v[44:47], v[104:107], v[12:15], v[44:47]
    v_mfma_f32_16x16x32_bf16 v[48:51], v[104:107], v[16:19], v[48:51]
    v_mfma_f32_16x16x32_bf16 v[52:55], v[104:107], v[20:23], v[52:55]
    v_mfma_f32_16x16x32_bf16 v[56:59], v[104:107], v[24:27], v[56:59]
    v_mfma_f32_16x16x32_bf16 v[60:63], v[104:107], v[28:31], v[60:63]
    s_waitcnt lgkmcnt(0)
    v_mfma_f32_16x16x32_bf16 v[32:35], v[108:111], v[0:3], v[32:35]
    v_mfma_f32_16x16x32_bf16 v[36:39], v[108:111], v[4:7], v[36:39]
    v_mfma_f32_16x16x32_bf16 v[40:43], v[108:111], v[8:11], v[40:43]
    v_mfma_f32_16x16x32_bf16 v[44:47], v[108:111], v[12:15], v[44:47]
    v_mfma_f32_16x16x32_bf16 v[48:51], v[108:111], v[16:19], v[48:51]
    v_mfma_f32_16x16x32_bf16 v[52:55], v[108:111], v[20:23], v[52:55]
    v_mfma_f32_16x16x32_bf16 v[56:59], v[108:111], v[24:27], v[56:59]
    v_mfma_f32_16x16x32_bf16 v[60:63], v[108:111], v[28:31], v[60:63]
    s_nop 7
    v_cvt_pk_bf16_f32 v112, v32, v36
    v_cvt_pk_bf16_f32 v113, v40, v44
    v_cvt_pk_bf16_f32 v114, v48, v52
    v_cvt_pk_bf16_f32 v115, v56, v60
    buffer_store_dwordx4 v[112:115], v120, s[20:23], s25 offen
    s_add_u32 s25, s25, 2736128
    v_cvt_pk_bf16_f32 v116, v33, v37
    v_cvt_pk_bf16_f32 v117, v41, v45
    v_cvt_pk_bf16_f32 v118, v49, v53
    v_cvt_pk_bf16_f32 v119, v57, v61
    buffer_store_dwordx4 v[116:119], v120, s[20:23], s25 offen
    s_add_u32 s25, s25, 2736128
    v_cvt_pk_bf16_f32 v112, v34, v38
    v_cvt_pk_bf16_f32 v113, v42, v46
    v_cvt_pk_bf16_f32 v114, v50, v54
    v_cvt_pk_bf16_f32 v115, v58, v62
    buffer_store_dwordx4 v[112:115], v120, s[20:23], s25 offen
    s_add_u32 s25, s25, 2736128
    v_cvt_pk_bf16_f32 v116, v35, v39
    v_cvt_pk_bf16_f32 v117, v43, v47
    v_cvt_pk_bf16_f32 v118, v51, v55
    v_cvt_pk_bf16_f32 v119, v59, v63
    buffer_store_dwordx4 v[116:119], v120, s[20:23], s25 offen
    s_endpgm
K1_W:
    s_mov_b32 s16, s6
    s_mov_b32 s17, s7
    s_and_b32 s17, s17, 0xffff
    s_mov_b32 s18, 16252928
    s_mov_b32 s19, 0x00020000
    s_add_u32 s20, s8, 50331648
    s_addc_u32 s21, s9, 0
    s_and_b32 s21, s21, 0xffff
    s_mov_b32 s22, 67108864
    s_mov_b32 s23, 0x00020000
    s_mul_i32 s11, s2, 1
    s_lshr_b32 s12, s11, 9
    s_and_b32 s13, s11, 511
    s_lshl_b32 s14, s12, 19
    s_lshl_b32 s15, s13, 10
    s_add_u32 s14, s14, s15
    s_lshl_b32 s15, s3, 8
    s_add_u32 s14, s14, s15
    v_and_b32 v126, 1, v123
    v_lshlrev_b32 v126, 23, v126
    v_lshl_add_u32 v126, v122, 4, v126
    s_mov_b32 s15, s14
    buffer_load_dwordx4 v[0:3], v126, s[16:19], s15 offen
    s_add_u32 s15, s15, 0x100000
    buffer_load_dwordx4 v[4:7], v126, s[16:19], s15 offen
    s_add_u32 s15, s15, 0x100000
    buffer_load_dwordx4 v[8:11], v126, s[16:19], s15 offen
    s_add_u32 s15, s15, 0x100000
    buffer_load_dwordx4 v[12:15], v126, s[16:19], s15 offen
    s_add_u32 s15, s15, 0x100000
    buffer_load_dwordx4 v[16:19], v126, s[16:19], s15 offen
    s_add_u32 s15, s15, 0x100000
    buffer_load_dwordx4 v[20:23], v126, s[16:19], s15 offen
    s_add_u32 s15, s15, 0x100000
    buffer_load_dwordx4 v[24:27], v126, s[16:19], s15 offen
    s_add_u32 s15, s15, 0x100000
    buffer_load_dwordx4 v[28:31], v126, s[16:19], s15 offen
    v_and_b32 v127, 1, v123
    v_lshlrev_b32 v127, 3, v127
    v_mul_u32_u24 v112, 96, v125
    v_mad_u32_u24 v113, v124, v127, v112
    v_mad_u32_u24 v64, v124, 0, v113
    v_mad_u32_u24 v65, v124, 1, v113
    v_mad_u32_u24 v66, v124, 2, v113
    v_mad_u32_u24 v67, v124, 3, v113
    v_mad_u32_u24 v68, v124, 4, v113
    v_mad_u32_u24 v69, v124, 5, v113
    v_mad_u32_u24 v70, v124, 6, v113
    v_mad_u32_u24 v71, v124, 7, v113
    v_and_b32 v64, 127, v64
    v_and_b32 v65, 127, v65
    v_and_b32 v66, 127, v66
    v_and_b32 v67, 127, v67
    v_and_b32 v68, 127, v68
    v_and_b32 v69, 127, v69
    v_and_b32 v70, 127, v70
    v_and_b32 v71, 127, v71
    v_cvt_f32_u32 v64, v64
    v_cvt_f32_u32 v65, v65
    v_cvt_f32_u32 v66, v66
    v_cvt_f32_u32 v67, v67
    v_cvt_f32_u32 v68, v68
    v_cvt_f32_u32 v69, v69
    v_cvt_f32_u32 v70, v70
    v_cvt_f32_u32 v71, v71
    v_mul_f32 v64, 0x3c000000, v64
    v_mul_f32 v65, 0x3c000000, v65
    v_mul_f32 v66, 0x3c000000, v66
    v_mul_f32 v67, 0x3c000000, v67
    v_mul_f32 v68, 0x3c000000, v68
    v_mul_f32 v69, 0x3c000000, v69
    v_mul_f32 v70, 0x3c000000, v70
    v_mul_f32 v71, 0x3c000000, v71
    v_cos_f32 v64, v64
    v_cos_f32 v65, v65
    v_cos_f32 v66, v66
    v_cos_f32 v67, v67
    v_cos_f32 v68, v68
    v_cos_f32 v69, v69
    v_cos_f32 v70, v70
    v_cos_f32 v71, v71
    s_nop 0
    v_cvt_pk_bf16_f32 v72, v64, v65
    v_cvt_pk_bf16_f32 v73, v66, v67
    v_cvt_pk_bf16_f32 v74, v68, v69
    v_cvt_pk_bf16_f32 v75, v70, v71
    v_lshlrev_b32 v80, 16, v72
    v_and_b32 v81, 0xffff0000, v72
    v_sub_f32 v64, v64, v80
    v_sub_f32 v65, v65, v81
    v_lshlrev_b32 v80, 16, v73
    v_and_b32 v81, 0xffff0000, v73
    v_sub_f32 v66, v66, v80
    v_sub_f32 v67, v67, v81
    v_lshlrev_b32 v80, 16, v74
    v_and_b32 v81, 0xffff0000, v74
    v_sub_f32 v68, v68, v80
    v_sub_f32 v69, v69, v81
    v_lshlrev_b32 v80, 16, v75
    v_and_b32 v81, 0xffff0000, v75
    v_sub_f32 v70, v70, v80
    v_sub_f32 v71, v71, v81
    v_cvt_pk_bf16_f32 v76, v64, v65
    v_cvt_pk_bf16_f32 v77, v66, v67
    v_cvt_pk_bf16_f32 v78, v68, v69
    v_cvt_pk_bf16_f32 v79, v70, v71
    v_cmp_lt_u32 vcc, 1, v123
    s_lshl_b32 s24, s3, 10
    v_add_u32 v114, s24, v121
    v_cndmask_b32 v72, v72, v76, vcc
    v_cndmask_b32 v73, v73, v77, vcc
    v_cndmask_b32 v74, v74, v78, vcc
    v_cndmask_b32 v75, v75, v79, vcc
    ds_write_b128 v114, v[72:75]
    v_lshrrev_b32 v112, 1, v123
    s_mov_b32 s24, 2097152
    v_mul_lo_u32 v112, v112, s24
    v_and_b32 v113, 1, v123
    v_lshl_add_u32 v112, v113, 8, v112
    v_and_b32 v113, 1, v122
    v_lshl_add_u32 v124, v113, 4, v112
    v_lshrrev_b32 v125, 1, v122
    s_mul_i32 s26, s3, 524288
    s_lshl_b32 s24, s11, 9
    s_add_u32 s26, s26, s24
    s_waitcnt lgkmcnt(0)
    s_barrier
    ds_read_b128 v[96:99], v121 offset:0
    ds_read_b128 v[100:103], v121 offset:1024
    ds_read_b128 v[104:107], v121 offset:2048
    ds_read_b128 v[108:111], v121 offset:3072
    s_mov_b32 s27, 0
    s_waitcnt vmcnt(0) lgkmcnt(0)
K1_W_LOOP:
    s_add_u32 s24, s11, s27
    s_and_b32 s30, s24, 3
    s_lshr_b32 s24, s24, 1
    s_and_b32 s24, s24, 4
    s_or_b32 s30, s30, s24
    v_xor_b32 v112, s30, v125
    v_lshl_add_u32 v120, v112, 5, v124
    s_lshl_b32 s25, s27, 9
    s_add_u32 s25, s25, s26
    v_perm_b32 v32, v4, v0, s28
    v_perm_b32 v36, v4, v0, s29
    v_perm_b32 v33, v12, v8, s28
    v_perm_b32 v37, v12, v8, s29
    v_perm_b32 v34, v20, v16, s28
    v_perm_b32 v38, v20, v16, s29
    v_perm_b32 v35, v28, v24, s28
    v_perm_b32 v39, v28, v24, s29
    v_perm_b32 v40, v5, v1, s28
    v_perm_b32 v44, v5, v1, s29
    v_perm_b32 v41, v13, v9, s28
    v_perm_b32 v45, v13, v9, s29
    v_perm_b32 v42, v21, v17, s28
    v_perm_b32 v46, v21, v17, s29
    v_perm_b32 v43, v29, v25, s28
    v_perm_b32 v47, v29, v25, s29
    v_perm_b32 v48, v6, v2, s28
    v_perm_b32 v52, v6, v2, s29
    v_perm_b32 v49, v14, v10, s28
    v_perm_b32 v53, v14, v10, s29
    v_perm_b32 v50, v22, v18, s28
    v_perm_b32 v54, v22, v18, s29
    v_perm_b32 v51, v30, v26, s28
    v_perm_b32 v55, v30, v26, s29
    v_perm_b32 v56, v7, v3, s28
    v_perm_b32 v60, v7, v3, s29
    v_perm_b32 v57, v15, v11, s28
    v_perm_b32 v61, v15, v11, s29
    v_perm_b32 v58, v23, v19, s28
    v_perm_b32 v62, v23, v19, s29
    v_perm_b32 v59, v31, v27, s28
    v_perm_b32 v63, v31, v27, s29
    s_add_u32 s27, s27, 1
    s_add_u32 s14, s14, 1024
    s_cmp_ge_u32 s27, 1
    s_cbranch_scc1 K1_W_NOLOAD
    s_mov_b32 s15, s14
    buffer_load_dwordx4 v[0:3], v126, s[16:19], s15 offen
    s_add_u32 s15, s15, 0x100000
    buffer_load_dwordx4 v[4:7], v126, s[16:19], s15 offen
    s_add_u32 s15, s15, 0x100000
    buffer_load_dwordx4 v[8:11], v126, s[16:19], s15 offen
    s_add_u32 s15, s15, 0x100000
    buffer_load_dwordx4 v[12:15], v126, s[16:19], s15 offen
    s_add_u32 s15, s15, 0x100000
    buffer_load_dwordx4 v[16:19], v126, s[16:19], s15 offen
    s_add_u32 s15, s15, 0x100000
    buffer_load_dwordx4 v[20:23], v126, s[16:19], s15 offen
    s_add_u32 s15, s15, 0x100000
    buffer_load_dwordx4 v[24:27], v126, s[16:19], s15 offen
    s_add_u32 s15, s15, 0x100000
    buffer_load_dwordx4 v[28:31], v126, s[16:19], s15 offen
K1_W_NOLOAD:
    v_mfma_f32_16x16x32_bf16 v[64:67], v[96:99], v[32:35], 0
    v_mfma_f32_16x16x32_bf16 v[68:71], v[96:99], v[36:39], 0
    v_mfma_f32_16x16x32_bf16 v[72:75], v[96:99], v[40:43], 0
    v_mfma_f32_16x16x32_bf16 v[76:79], v[96:99], v[44:47], 0
    v_mfma_f32_16x16x32_bf16 v[80:83], v[96:99], v[48:51], 0
    v_mfma_f32_16x16x32_bf16 v[84:87], v[96:99], v[52:55], 0
    v_mfma_f32_16x16x32_bf16 v[88:91], v[96:99], v[56:59], 0
    v_mfma_f32_16x16x32_bf16 v[92:95], v[96:99], v[60:63], 0
    s_nop 7
    v_cvt_pk_bf16_f32 v112, v64, v68
    v_cvt_pk_bf16_f32 v113, v72, v76
    v_cvt_pk_bf16_f32 v114, v80, v84
    v_cvt_pk_bf16_f32 v115, v88, v92
    buffer_store_dwordx4 v[112:115], v120, s[20:23], s25 offen
    s_add_u32 s25, s25, 4194304
    v_cvt_pk_bf16_f32 v116, v65, v69
    v_cvt_pk_bf16_f32 v117, v73, v77
    v_cvt_pk_bf16_f32 v118, v81, v85
    v_cvt_pk_bf16_f32 v119, v89, v93
    buffer_store_dwordx4 v[116:119], v120, s[20:23], s25 offen
    s_add_u32 s25, s25, 4194304
    v_cvt_pk_bf16_f32 v112, v66, v70
    v_cvt_pk_bf16_f32 v113, v74, v78
    v_cvt_pk_bf16_f32 v114, v82, v86
    v_cvt_pk_bf16_f32 v115, v90, v94
    buffer_store_dwordx4 v[112:115], v120, s[20:23], s25 offen
    s_add_u32 s25, s25, 4194304
    v_cvt_pk_bf16_f32 v116, v67, v71
    v_cvt_pk_bf16_f32 v117, v75, v79
    v_cvt_pk_bf16_f32 v118, v83, v87
    v_cvt_pk_bf16_f32 v119, v91, v95
    buffer_store_dwordx4 v[116:119], v120, s[20:23], s25 offen
    s_add_u32 s25, s25, 4194304
    v_mfma_f32_16x16x32_bf16 v[64:67], v[100:103], v[32:35], 0
    v_mfma_f32_16x16x32_bf16 v[68:71], v[100:103], v[36:39], 0
    v_mfma_f32_16x16x32_bf16 v[72:75], v[100:103], v[40:43], 0
    v_mfma_f32_16x16x32_bf16 v[76:79], v[100:103], v[44:47], 0
    v_mfma_f32_16x16x32_bf16 v[80:83], v[100:103], v[48:51], 0
    v_mfma_f32_16x16x32_bf16 v[84:87], v[100:103], v[52:55], 0
    v_mfma_f32_16x16x32_bf16 v[88:91], v[100:103], v[56:59], 0
    v_mfma_f32_16x16x32_bf16 v[92:95], v[100:103], v[60:63], 0
    s_nop 7
    v_cvt_pk_bf16_f32 v112, v64, v68
    v_cvt_pk_bf16_f32 v113, v72, v76
    v_cvt_pk_bf16_f32 v114, v80, v84
    v_cvt_pk_bf16_f32 v115, v88, v92
    buffer_store_dwordx4 v[112:115], v120, s[20:23], s25 offen
    s_add_u32 s25, s25, 4194304
    v_cvt_pk_bf16_f32 v116, v65, v69
    v_cvt_pk_bf16_f32 v117, v73, v77
    v_cvt_pk_bf16_f32 v118, v81, v85
    v_cvt_pk_bf16_f32 v119, v89, v93
    buffer_store_dwordx4 v[116:119], v120, s[20:23], s25 offen
    s_add_u32 s25, s25, 4194304
    v_cvt_pk_bf16_f32 v112, v66, v70
    v_cvt_pk_bf16_f32 v113, v74, v78
    v_cvt_pk_bf16_f32 v114, v82, v86
    v_cvt_pk_bf16_f32 v115, v90, v94
    buffer_store_dwordx4 v[112:115], v120, s[20:23], s25 offen
    s_add_u32 s25, s25, 4194304
    v_cvt_pk_bf16_f32 v116, v67, v71
    v_cvt_pk_bf16_f32 v117, v75, v79
    v_cvt_pk_bf16_f32 v118, v83, v87
    v_cvt_pk_bf16_f32 v119, v91, v95
    buffer_store_dwordx4 v[116:119], v120, s[20:23], s25 offen
    s_add_u32 s25, s25, 4194304
    v_mfma_f32_16x16x32_bf16 v[64:67], v[104:107], v[32:35], 0
    v_mfma_f32_16x16x32_bf16 v[68:71], v[104:107], v[36:39], 0
    v_mfma_f32_16x16x32_bf16 v[72:75], v[104:107], v[40:43], 0
    v_mfma_f32_16x16x32_bf16 v[76:79], v[104:107], v[44:47], 0
    v_mfma_f32_16x16x32_bf16 v[80:83], v[104:107], v[48:51], 0
    v_mfma_f32_16x16x32_bf16 v[84:87], v[104:107], v[52:55], 0
    v_mfma_f32_16x16x32_bf16 v[88:91], v[104:107], v[56:59], 0
    v_mfma_f32_16x16x32_bf16 v[92:95], v[104:107], v[60:63], 0
    s_nop 7
    v_cvt_pk_bf16_f32 v112, v64, v68
    v_cvt_pk_bf16_f32 v113, v72, v76
    v_cvt_pk_bf16_f32 v114, v80, v84
    v_cvt_pk_bf16_f32 v115, v88, v92
    buffer_store_dwordx4 v[112:115], v120, s[20:23], s25 offen
    s_add_u32 s25, s25, 4194304
    v_cvt_pk_bf16_f32 v116, v65, v69
    v_cvt_pk_bf16_f32 v117, v73, v77
    v_cvt_pk_bf16_f32 v118, v81, v85
    v_cvt_pk_bf16_f32 v119, v89, v93
    buffer_store_dwordx4 v[116:119], v120, s[20:23], s25 offen
    s_add_u32 s25, s25, 4194304
    v_cvt_pk_bf16_f32 v112, v66, v70
    v_cvt_pk_bf16_f32 v113, v74, v78
    v_cvt_pk_bf16_f32 v114, v82, v86
    v_cvt_pk_bf16_f32 v115, v90, v94
    buffer_store_dwordx4 v[112:115], v120, s[20:23], s25 offen
    s_add_u32 s25, s25, 4194304
    v_cvt_pk_bf16_f32 v116, v67, v71
    v_cvt_pk_bf16_f32 v117, v75, v79
    v_cvt_pk_bf16_f32 v118, v83, v87
    v_cvt_pk_bf16_f32 v119, v91, v95
    buffer_store_dwordx4 v[116:119], v120, s[20:23], s25 offen
    s_add_u32 s25, s25, 4194304
    v_mfma_f32_16x16x32_bf16 v[64:67], v[108:111], v[32:35], 0
    v_mfma_f32_16x16x32_bf16 v[68:71], v[108:111], v[36:39], 0
    v_mfma_f32_16x16x32_bf16 v[72:75], v[108:111], v[40:43], 0
    v_mfma_f32_16x16x32_bf16 v[76:79], v[108:111], v[44:47], 0
    v_mfma_f32_16x16x32_bf16 v[80:83], v[108:111], v[48:51], 0
    v_mfma_f32_16x16x32_bf16 v[84:87], v[108:111], v[52:55], 0
    v_mfma_f32_16x16x32_bf16 v[88:91], v[108:111], v[56:59], 0
    v_mfma_f32_16x16x32_bf16 v[92:95], v[108:111], v[60:63], 0
    s_nop 7
    v_cvt_pk_bf16_f32 v112, v64, v68
    v_cvt_pk_bf16_f32 v113, v72, v76
    v_cvt_pk_bf16_f32 v114, v80, v84
    v_cvt_pk_bf16_f32 v115, v88, v92
    buffer_store_dwordx4 v[112:115], v120, s[20:23], s25 offen
    s_add_u32 s25, s25, 4194304
    v_cvt_pk_bf16_f32 v116, v65, v69
    v_cvt_pk_bf16_f32 v117, v73, v77
    v_cvt_pk_bf16_f32 v118, v81, v85
    v_cvt_pk_bf16_f32 v119, v89, v93
    buffer_store_dwordx4 v[116:119], v120, s[20:23], s25 offen
    s_add_u32 s25, s25, 4194304
    v_cvt_pk_bf16_f32 v112, v66, v70
    v_cvt_pk_bf16_f32 v113, v74, v78
    v_cvt_pk_bf16_f32 v114, v82, v86
    v_cvt_pk_bf16_f32 v115, v90, v94
    buffer_store_dwordx4 v[112:115], v120, s[20:23], s25 offen
    s_add_u32 s25, s25, 4194304
    v_cvt_pk_bf16_f32 v116, v67, v71
    v_cvt_pk_bf16_f32 v117, v75, v79
    v_cvt_pk_bf16_f32 v118, v83, v87
    v_cvt_pk_bf16_f32 v119, v91, v95
    buffer_store_dwordx4 v[116:119], v120, s[20:23], s25 offen
    s_waitcnt vmcnt(16)
    s_cmp_lt_u32 s27, 1
    s_cbranch_scc1 K1_W_LOOP
K1_END:
    s_endpgm
.p2align 8
.type k12_fused_kernel,@function
k12_fused_kernel:
    s_cmp_ge_u32 s2, 256
    s_cbranch_scc1 K12_END
    s_load_dwordx4 s[52:55], s[0:1], 0
    s_load_dwordx4 s[56:59], s[0:1], 40
    s_getpc_b64 s[90:91]
CPF_K12:
    s_sub_u32 s90, s90, CPF_K12-k12_fused_kernel
    s_subb_u32 s91, s91, 0
    v_lshlrev_b32 v8, 7, v0
    v_mov_b32 v11, s91
    v_min_u32 v9, TEXT_END-k12_fused_kernel-4, v8
    v_add_co_u32 v10, vcc, s90, v9
    v_addc_co_u32 v11, vcc, 0, v11, vcc
    global_load_dword v63, v[10:11], off
    v_lshrrev_b32 v1, 6, v0
    v_and_b32 v2, 63, v0
    v_readfirstlane_b32 s3, v1
    s_waitcnt lgkmcnt(0)
    s_cmp_lt_u32 s3, 4
    s_cbranch_scc1 K12_CONS
    v_and_b32 v64, 15, v2
    v_lshrrev_b32 v65, 4, v2
    v_lshlrev_b32 v254, 4, v2
    s_and_b32 s44, s3, 3
    s_and_b32 s20, s44, 1
    s_lshr_b32 s21, s44, 1
    s_lshl_b32 s22, s2, 1
    s_add_u32 s22, s22, s21
    s_and_b32 s23, s22, 3
    s_lshr_b32 s22, s22, 2
    s_and_b32 s24, s2, 7
    s_lshl_b32 s24, s24, 5
    s_lshr_b32 s25, s2, 3
    s_add_u32 s24, s24, s25
    s_cmp_ge_u32 s24, 167
    s_cselect_b32 s25, 1, 0
    s_mul_i32 s26, s25, 167
    s_sub_u32 s24, s24, s26
    s_cmp_eq_u32 s21, 0
    s_cselect_b32 s25, s25, 1
    s_mul_i32 s26, s25, 16384000
    s_add_u32 s4, s52, s26
    s_addc_u32 s5, s53, 0
    s_and_b32 s5, s5, 0xffff
    s_mov_b32 s6, 16384000
    s_mov_b32 s7, 0x00020000
    s_mov_b32 s8, s54
    s_mov_b32 s9, s55
    s_and_b32 s9, s9, 0xffff
    s_mov_b32 s10, 16252928
    s_mov_b32 s11, 0x00020000
    s_mov_b32 s12, s58
    s_mov_b32 s13, s59
    s_and_b32 s13, s13, 0xffff
    s_mov_b32 s14, 43778048
    s_mov_b32 s15, 0x00020000
    s_add_u32 s16, s58, 50331648
    s_addc_u32 s17, s59, 0
    s_and_b32 s17, s17, 0xffff
    s_mov_b32 s18, 67108864
    s_mov_b32 s19, 0x00020000
    s_add_u32 s60, s58, 153092096
    s_addc_u32 s61, s59, 0
    s_and_b32 s61, s61, 0xffff
    s_mov_b32 s62, 32768
    s_mov_b32 s63, 0x00020000
    s_mov_b32 s28, 0x05040100
    s_mov_b32 s29, 0x07060302
    v_lshlrev_b32 v248, 14, v65
    v_lshl_add_u32 v248, v64, 4, v248
    v_and_b32 v250, 1, v65
    v_lshlrev_b32 v250, 23, v250
    v_lshl_add_u32 v250, v64, 4, v250
    v_lshrrev_b32 v66, 1, v65
    s_mov_b32 s26, 1368064
    v_mul_lo_u32 v66, v66, s26
    v_lshrrev_b32 v67, 2, v64
    s_mov_b32 s26, 21376
    v_mul_lo_u32 v67, v67, s26
    v_add_u32 v66, v66, v67
    v_mov_b32 v252, v66
    v_lshrrev_b32 v66, 1, v65
    s_mov_b32 s26, 2097152
    v_mul_lo_u32 v66, v66, s26
    v_and_b32 v67, 1, v65
    v_lshl_add_u32 v66, v67, 8, v66
    v_and_b32 v67, 1, v64
    v_lshl_add_u32 v251, v67, 4, v66
    s_mul_i32 s31, s25, 684032
    s_mul_i32 s32, s23, 524288
    s_lshl_b32 s33, s23, 8
    s_mov_b32 s40, 3
    s_xor_b32 s43, s40, s20
    s_and_b32 s43, s43, 1
    s_mul_i32 s36, s40, 85
    s_add_u32 s36, s36, s2
    s_and_b32 s36, s36, 255
    s_mul_hi_u32 s37, s36, 0x55555556
    s_mul_i32 s38, s37, 3
    s_cmp_eq_u32 s38, s36
    s_cselect_b32 s27, 1, 0
    s_cmp_lt_u32 s37, 78
    s_cselect_b32 s27, s27, 0
    s_add_u32 s37, s37, 89
    s_cmp_eq_u32 s21, 0
    s_cselect_b32 s30, s24, s37
    s_cselect_b32 s27, 1, s27
    s_cmp_eq_u32 s43, 0
    s_cbranch_scc0 K12_PL1
    s_lshl_b32 s36, s40, 7
    s_add_u32 s36, s36, s22
    s_lshr_b32 s37, s36, 9
    s_lshl_b32 s37, s37, 19
    s_and_b32 s36, s36, 511
    s_lshl_b32 s36, s36, 10
    s_add_u32 s36, s36, s37
    s_add_u32 s36, s36, s33
    buffer_load_dwordx4 v[96:99], v250, s[8:11], s36 offen
    s_add_u32 s36, s36, 0x100000
    buffer_load_dwordx4 v[100:103], v250, s[8:11], s36 offen
    s_add_u32 s36, s36, 0x100000
    buffer_load_dwordx4 v[104:107], v250, s[8:11], s36 offen
    s_add_u32 s36, s36, 0x100000
    buffer_load_dwordx4 v[108:111], v250, s[8:11], s36 offen
    s_add_u32 s36, s36, 0x100000
    buffer_load_dwordx4 v[112:115], v250, s[8:11], s36 offen
    s_add_u32 s36, s36, 0x100000
    buffer_load_dwordx4 v[116:119], v250, s[8:11], s36 offen
    s_add_u32 s36, s36, 0x100000
    buffer_load_dwordx4 v[120:123], v250, s[8:11], s36 offen
    s_add_u32 s36, s36, 0x100000
    buffer_load_dwordx4 v[124:127], v250, s[8:11], s36 offen
    s_branch K12_PL2
K12_PL1:
    s_cmp_eq_u32 s27, 0
    s_cbranch_scc1 K12_PL2
    s_lshl_b32 s36, s40, 8
    s_mul_i32 s37, s30, 98304
    s_add_u32 s36, s36, s37
    buffer_load_dwordx4 v[0:3], v248, s[4:7], s36 offen
    buffer_load_dwordx4 v[4:7], v248, s[4:7], s36 offen offset:2048
    s_add_u32 s36, s36, 4096
    buffer_load_dwordx4 v[8:11], v248, s[4:7], s36 offen
    buffer_load_dwordx4 v[12:15], v248, s[4:7], s36 offen offset:2048
    s_add_u32 s36, s36, 4096
    buffer_load_dwordx4 v[16:19], v248, s[4:7], s36 offen
    buffer_load_dwordx4 v[20:23], v248, s[4:7], s36 offen offset:2048
    s_add_u32 s36, s36, 4096
    buffer_load_dwordx4 v[24:27], v248, s[4:7], s36 offen
    buffer_load_dwordx4 v[28:31], v248, s[4:7], s36 offen offset:2048
    s_add_u32 s36, s36, 53248
    buffer_load_dwordx4 v[32:35], v248, s[4:7], s36 offen
    buffer_load_dwordx4 v[36:39], v248, s[4:7], s36 offen offset:2048
    s_add_u32 s36, s36, 4096
    buffer_load_dwordx4 v[40:43], v248, s[4:7], s36 offen
    buffer_load_dwordx4 v[44:47], v248, s[4:7], s36 offen offset:2048
    s_add_u32 s36, s36, 4096
    buffer_load_dwordx4 v[48:51], v248, s[4:7], s36 offen
    buffer_load_dwordx4 v[52:55], v248, s[4:7], s36 offen offset:2048
    s_add_u32 s36, s36, 4096
    buffer_load_dwordx4 v[56:59], v248, s[4:7], s36 offen
    buffer_load_dwordx4 v[60:63], v248, s[4:7], s36 offen offset:2048
K12_PL2:
    v_and_b32 v128, 3, v64
    v_lshlrev_b32 v128, 2, v128
    v_lshrrev_b32 v130, 3, v64
    v_lshl_add_u32 v128, v130, 1, v128
    s_lshl_b32 s36, s44, 4
    s_add_u32 s36, s36, 1
    v_add_u32 v128, s36, v128
    v_bfe_u32 v129, v64, 2, 1
    v_lshlrev_b32 v131, 3, v65
    v_lshlrev_b32 v132, 5, v129
    v_mad_u32_u24 v133, v128, v131, v132
    v_mad_u32_u24 v136, v128, 0, v133
    v_mad_u32_u24 v137, v128, 1, v133
    v_mad_u32_u24 v138, v128, 2, v133
    v_mad_u32_u24 v139, v128, 3, v133
    v_mad_u32_u24 v140, v128, 4, v133
    v_mad_u32_u24 v141, v128, 5, v133
    v_mad_u32_u24 v142, v128, 6, v133
    v_mad_u32_u24 v143, v128, 7, v133
    v_and_b32 v136, 127, v136
    v_and_b32 v137, 127, v137
    v_and_b32 v138, 127, v138
    v_and_b32 v139, 127, v139
    v_and_b32 v140, 127, v140
    v_and_b32 v141, 127, v141
    v_and_b32 v142, 127, v142
    v_and_b32 v143, 127, v143
    v_cvt_f32_u32 v136, v136
    v_cvt_f32_u32 v137, v137
    v_cvt_f32_u32 v138, v138
    v_cvt_f32_u32 v139, v139
    v_cvt_f32_u32 v140, v140
    v_cvt_f32_u32 v141, v141
    v_cvt_f32_u32 v142, v142
    v_cvt_f32_u32 v143, v143
    v_mul_f32 v136, 0x3c000000, v136
    v_mul_f32 v137, 0x3c000000, v137
    v_mul_f32 v138, 0x3c000000, v138
    v_mul_f32 v139, 0x3c000000, v139
    v_mul_f32 v140, 0x3c000000, v140
    v_mul_f32 v141, 0x3c000000, v141
    v_mul_f32 v142, 0x3c000000, v142
    v_mul_f32 v143, 0x3c000000, v143
    v_cos_f32 v136, v136
    v_cos_f32 v137, v137
    v_cos_f32 v138, v138
    v_cos_f32 v139, v139
    v_cos_f32 v140, v140
    v_cos_f32 v141, v141
    v_cos_f32 v142, v142
    v_cos_f32 v143, v143
    s_nop 0
    v_cvt_pk_bf16_f32 v144, v136, v137
    v_cvt_pk_bf16_f32 v145, v138, v139
    v_cvt_pk_bf16_f32 v146, v140, v141
    v_cvt_pk_bf16_f32 v147, v142, v143
    v_lshlrev_b32 v152, 16, v144
    v_and_b32 v153, 0xffff0000, v144
    v_sub_f32 v136, v136, v152
    v_sub_f32 v137, v137, v153
    v_lshlrev_b32 v152, 16, v145
    v_and_b32 v153, 0xffff0000, v145
    v_sub_f32 v138, v138, v152
    v_sub_f32 v139, v139, v153
    v_lshlrev_b32 v152, 16, v146
    v_and_b32 v153, 0xffff0000, v146
    v_sub_f32 v140, v140, v152
    v_sub_f32 v141, v141, v153
    v_lshlrev_b32 v152, 16, v147
    v_and_b32 v153, 0xffff0000, v147
    v_sub_f32 v142, v142, v152
    v_sub_f32 v143, v143, v153
    v_cvt_pk_bf16_f32 v148, v136, v137
    v_cvt_pk_bf16_f32 v149, v138, v139
    v_cvt_pk_bf16_f32 v150, v140, v141
    v_cvt_pk_bf16_f32 v151, v142, v143
    s_lshl_b32 s37, s44, 12
    s_add_u32 s37, s37, 116736
    v_add_u32 v132, s37, v254
    ds_write_b128 v132, v[144:147]
    ds_write_b128 v132, v[148:151] offset:1024
    v_add_u32 v131, 32, v131
    v_lshlrev_b32 v132, 5, v129
    v_mad_u32_u24 v133, v128, v131, v132
    v_mad_u32_u24 v136, v128, 0, v133
    v_mad_u32_u24 v137, v128, 1, v133
    v_mad_u32_u24 v138, v128, 2, v133
    v_mad_u32_u24 v139, v128, 3, v133
    v_mad_u32_u24 v140, v128, 4, v133
    v_mad_u32_u24 v141, v128, 5, v133
    v_mad_u32_u24 v142, v128, 6, v133
    v_mad_u32_u24 v143, v128, 7, v133
    v_and_b32 v136, 127, v136
    v_and_b32 v137, 127, v137
    v_and_b32 v138, 127, v138
    v_and_b32 v139, 127, v139
    v_and_b32 v140, 127, v140
    v_and_b32 v141, 127, v141
    v_and_b32 v142, 127, v142
    v_and_b32 v143, 127, v143
    v_cvt_f32_u32 v136, v136
    v_cvt_f32_u32 v137, v137
    v_cvt_f32_u32 v138, v138
    v_cvt_f32_u32 v139, v139
    v_cvt_f32_u32 v140, v140
    v_cvt_f32_u32 v141, v141
    v_cvt_f32_u32 v142, v142
    v_cvt_f32_u32 v143, v143
    v_mul_f32 v136, 0x3c000000, v136
    v_mul_f32 v137, 0x3c000000, v137
    v_mul_f32 v138, 0x3c000000, v138
    v_mul_f32 v139, 0x3c000000, v139
    v_mul_f32 v140, 0x3c000000, v140
    v_mul_f32 v141, 0x3c000000, v141
    v_mul_f32 v142, 0x3c000000, v142
    v_mul_f32 v143, 0x3c000000, v143
    v_cos_f32 v136, v136
    v_cos_f32 v137, v137
    v_cos_f32 v138, v138
    v_cos_f32 v139, v139
    v_cos_f32 v140, v140
    v_cos_f32 v141, v141
    v_cos_f32 v142, v142
    v_cos_f32 v143, v143
    s_nop 0
    v_cvt_pk_bf16_f32 v144, v136, v137
    v_cvt_pk_bf16_f32 v145, v138, v139
    v_cvt_pk_bf16_f32 v146, v140, v141
    v_cvt_pk_bf16_f32 v147, v142, v143
    v_lshlrev_b32 v152, 16, v144
    v_and_b32 v153, 0xffff0000, v144
    v_sub_f32 v136, v136, v152
    v_sub_f32 v137, v137, v153
    v_lshlrev_b32 v152, 16, v145
    v_and_b32 v153, 0xffff0000, v145
    v_sub_f32 v138, v138, v152
    v_sub_f32 v139, v139, v153
    v_lshlrev_b32 v152, 16, v146
    v_and_b32 v153, 0xffff0000, v146
    v_sub_f32 v140, v140, v152
    v_sub_f32 v141, v141, v153
    v_lshlrev_b32 v152, 16, v147
    v_and_b32 v153, 0xffff0000, v147
    v_sub_f32 v142, v142, v152
    v_sub_f32 v143, v143, v153
    v_cvt_pk_bf16_f32 v148, v136, v137
    v_cvt_pk_bf16_f32 v149, v138, v139
    v_cvt_pk_bf16_f32 v150, v140, v141
    v_cvt_pk_bf16_f32 v151, v142, v143
    s_lshl_b32 s37, s44, 12
    s_add_u32 s37, s37, 118784
    v_add_u32 v132, s37, v254
    ds_write_b128 v132, v[144:147]
    ds_write_b128 v132, v[148:151] offset:1024
K12_TB:
    s_waitcnt lgkmcnt(0)
    s_barrier
    v_add_u32 v255, 116736, v254
    ds_read_b128 v[160:163], v255 offset:0
    ds_read_b128 v[192:195], v255 offset:1024
    ds_read_b128 v[164:167], v255 offset:2048
    ds_read_b128 v[196:199], v255 offset:3072
    ds_read_b128 v[168:171], v255 offset:4096
    ds_read_b128 v[200:203], v255 offset:5120
    ds_read_b128 v[172:175], v255 offset:6144
    ds_read_b128 v[204:207], v255 offset:7168
    s_waitcnt lgkmcnt(0)
    ds_read_b128 v[176:179], v255 offset:8192
    ds_read_b128 v[208:211], v255 offset:9216
    ds_read_b128 v[180:183], v255 offset:10240
    ds_read_b128 v[212:215], v255 offset:11264
    ds_read_b128 v[184:187], v255 offset:12288
    ds_read_b128 v[216:219], v255 offset:13312
    ds_read_b128 v[188:191], v255 offset:14336
    ds_read_b128 v[220:223], v255 offset:15360
    ds_read_b128 v[224:227], v255 offset:16384
    ds_read_b128 v[228:231], v255 offset:17408
    ds_read_b128 v[232:235], v255 offset:18432
    ds_read_b128 v[236:239], v255 offset:19456
    s_waitcnt lgkmcnt(0)
    s_barrier
    s_waitcnt vmcnt(0) lgkmcnt(0)
    s_mov_b32 s41, -1
    s_mov_b32 s34, -1
    s_branch K12_PROD
    s_cmp_lt_u32 s3, 4
    s_cbranch_scc0 K12_PROD
    s_cmp_eq_u32 s43, 0
    s_cbranch_scc0 K12_H1
    v_perm_b32 v64, v100, v96, s28
    v_perm_b32 v68, v100, v96, s29
    v_perm_b32 v65, v108, v104, s28
    v_perm_b32 v69, v108, v104, s29
    v_perm_b32 v66, v116, v112, s28
    v_perm_b32 v70, v116, v112, s29
    v_perm_b32 v67, v124, v120, s28
    v_perm_b32 v71, v124, v120, s29
    v_perm_b32 v72, v101, v97, s28
    v_perm_b32 v76, v101, v97, s29
    v_perm_b32 v73, v109, v105, s28
    v_perm_b32 v77, v109, v105, s29
    v_perm_b32 v74, v117, v113, s28
    v_perm_b32 v78, v117, v113, s29
    v_perm_b32 v75, v125, v121, s28
    v_perm_b32 v79, v125, v121, s29
    v_perm_b32 v80, v102, v98, s28
    v_perm_b32 v84, v102, v98, s29
    v_perm_b32 v81, v110, v106, s28
    v_perm_b32 v85, v110, v106, s29
    v_perm_b32 v82, v118, v114, s28
    v_perm_b32 v86, v118, v114, s29
    v_perm_b32 v83, v126, v122, s28
    v_perm_b32 v87, v126, v122, s29
    v_perm_b32 v88, v103, v99, s28
    v_perm_b32 v92, v103, v99, s29
    v_perm_b32 v89, v111, v107, s28
    v_perm_b32 v93, v111, v107, s29
    v_perm_b32 v90, v119, v115, s28
    v_perm_b32 v94, v119, v115, s29
    v_perm_b32 v91, v127, v123, s28
    v_perm_b32 v95, v127, v123, s29
    s_lshl_b32 s36, s40, 7
    s_add_u32 s36, s36, s22
    s_and_b32 s37, s36, 3
    s_lshr_b32 s38, s36, 1
    s_and_b32 s38, s38, 4
    s_or_b32 s37, s37, s38
    v_bfe_u32 v253, v254, 5, 3
    v_xor_b32 v253, s37, v253
    v_lshl_add_u32 v253, v253, 5, v251
    s_lshl_b32 s36, s36, 9
    s_add_u32 s39, s36, s32
    s_setprio 1
    v_mfma_f32_16x16x32_bf16 v[128:131], v[224:227], v[64:67], 0
    v_mfma_f32_16x16x32_bf16 v[132:135], v[224:227], v[68:71], 0
    v_mfma_f32_16x16x32_bf16 v[136:139], v[224:227], v[72:75], 0
    v_mfma_f32_16x16x32_bf16 v[140:143], v[224:227], v[76:79], 0
    v_mfma_f32_16x16x32_bf16 v[144:147], v[224:227], v[80:83], 0
    v_mfma_f32_16x16x32_bf16 v[148:151], v[224:227], v[84:87], 0
    v_mfma_f32_16x16x32_bf16 v[152:155], v[224:227], v[88:91], 0
    v_mfma_f32_16x16x32_bf16 v[156:159], v[224:227], v[92:95], 0
    s_setprio 0
    s_nop 7
    v_cvt_pk_bf16_f32 v240, v128, v132
    v_cvt_pk_bf16_f32 v241, v136, v140
    v_cvt_pk_bf16_f32 v242, v144, v148
    v_cvt_pk_bf16_f32 v243, v152, v156
    buffer_store_dwordx4 v[240:243], v253, s[16:19], s39 offen sc1
    s_add_u32 s39, s39, 4194304
    v_cvt_pk_bf16_f32 v244, v129, v133
    v_cvt_pk_bf16_f32 v245, v137, v141
    v_cvt_pk_bf16_f32 v246, v145, v149
    v_cvt_pk_bf16_f32 v247, v153, v157
    buffer_store_dwordx4 v[244:247], v253, s[16:19], s39 offen sc1
    s_add_u32 s39, s39, 4194304
    v_cvt_pk_bf16_f32 v240, v130, v134
    v_cvt_pk_bf16_f32 v241, v138, v142
    v_cvt_pk_bf16_f32 v242, v146, v150
    v_cvt_pk_bf16_f32 v243, v154, v158
    buffer_store_dwordx4 v[240:243], v253, s[16:19], s39 offen sc1
    s_add_u32 s39, s39, 4194304
    v_cvt_pk_bf16_f32 v244, v131, v135
    v_cvt_pk_bf16_f32 v245, v139, v143
    v_cvt_pk_bf16_f32 v246, v147, v151
    v_cvt_pk_bf16_f32 v247, v155, v159
    buffer_store_dwordx4 v[244:247], v253, s[16:19], s39 offen sc1
    s_add_u32 s39, s39, 4194304
    s_cmp_lt_u32 s40, 4
    s_cbranch_scc1 K12_UT0
    s_lshl_b32 s36, s40, 3
    s_sub_i32 s36, s36, 22
    s_max_i32 s36, s36, 1
    s_mov_b32 s37, 131072
K12_UL0:
    v_mov_b32 v255, 155648
    ds_read_b32 v255, v255
    s_waitcnt lgkmcnt(0)
    v_cmp_gt_u32 vcc, s36, v255
    s_sub_u32 s37, s37, 1
    s_cmp_eq_u32 s37, 0
    s_cbranch_scc1 K12_UT0
    s_cbranch_vccz K12_UT0
    s_sleep 2
    s_branch K12_UL0
K12_UT0:
    s_setprio 1
    v_mfma_f32_16x16x32_bf16 v[128:131], v[228:231], v[64:67], 0
    v_mfma_f32_16x16x32_bf16 v[132:135], v[228:231], v[68:71], 0
    v_mfma_f32_16x16x32_bf16 v[136:139], v[228:231], v[72:75], 0
    v_mfma_f32_16x16x32_bf16 v[140:143], v[228:231], v[76:79], 0
    v_mfma_f32_16x16x32_bf16 v[144:147], v[228:231], v[80:83], 0
    v_mfma_f32_16x16x32_bf16 v[148:151], v[228:231], v[84:87], 0
    v_mfma_f32_16x16x32_bf16 v[152:155], v[228:231], v[88:91], 0
    v_mfma_f32_16x16x32_bf16 v[156:159], v[228:231], v[92:95], 0
    s_setprio 0
    s_nop 7
    v_cvt_pk_bf16_f32 v240, v128, v132
    v_cvt_pk_bf16_f32 v241, v136, v140
    v_cvt_pk_bf16_f32 v242, v144, v148
    v_cvt_pk_bf16_f32 v243, v152, v156
    buffer_store_dwordx4 v[240:243], v253, s[16:19], s39 offen sc1
    s_add_u32 s39, s39, 4194304
    v_cvt_pk_bf16_f32 v244, v129, v133
    v_cvt_pk_bf16_f32 v245, v137, v141
    v_cvt_pk_bf16_f32 v246, v145, v149
    v_cvt_pk_bf16_f32 v247, v153, v157
    buffer_store_dwordx4 v[244:247], v253, s[16:19], s39 offen sc1
    s_add_u32 s39, s39, 4194304
    v_cvt_pk_bf16_f32 v240, v130, v134
    v_cvt_pk_bf16_f32 v241, v138, v142
    v_cvt_pk_bf16_f32 v242, v146, v150
    v_cvt_pk_bf16_f32 v243, v154, v158
    buffer_store_dwordx4 v[240:243], v253, s[16:19], s39 offen sc1
    s_add_u32 s39, s39, 4194304
    v_cvt_pk_bf16_f32 v244, v131, v135
    v_cvt_pk_bf16_f32 v245, v139, v143
    v_cvt_pk_bf16_f32 v246, v147, v151
    v_cvt_pk_bf16_f32 v247, v155, v159
    buffer_store_dwordx4 v[244:247], v253, s[16:19], s39 offen sc1
    s_add_u32 s39, s39, 4194304
    s_cmp_lt_u32 s40, 4
    s_cbranch_scc1 K12_UT1
    s_lshl_b32 s36, s40, 3
    s_sub_i32 s36, s36, 20
    s_max_i32 s36, s36, 1
    s_mov_b32 s37, 131072
K12_UL1:
    v_mov_b32 v255, 155648
    ds_read_b32 v255, v255
    s_waitcnt lgkmcnt(0)
    v_cmp_gt_u32 vcc, s36, v255
    s_sub_u32 s37, s37, 1
    s_cmp_eq_u32 s37, 0
    s_cbranch_scc1 K12_UT1
    s_cbranch_vccz K12_UT1
    s_sleep 2
    s_branch K12_UL1
K12_UT1:
    s_setprio 1
    v_mfma_f32_16x16x32_bf16 v[128:131], v[232:235], v[64:67], 0
    v_mfma_f32_16x16x32_bf16 v[132:135], v[232:235], v[68:71], 0
    v_mfma_f32_16x16x32_bf16 v[136:139], v[232:235], v[72:75], 0
    v_mfma_f32_16x16x32_bf16 v[140:143], v[232:235], v[76:79], 0
    v_mfma_f32_16x16x32_bf16 v[144:147], v[232:235], v[80:83], 0
    v_mfma_f32_16x16x32_bf16 v[148:151], v[232:235], v[84:87], 0
    v_mfma_f32_16x16x32_bf16 v[152:155], v[232:235], v[88:91], 0
    v_mfma_f32_16x16x32_bf16 v[156:159], v[232:235], v[92:95], 0
    s_setprio 0
    s_nop 7
    v_cvt_pk_bf16_f32 v240, v128, v132
    v_cvt_pk_bf16_f32 v241, v136, v140
    v_cvt_pk_bf16_f32 v242, v144, v148
    v_cvt_pk_bf16_f32 v243, v152, v156
    buffer_store_dwordx4 v[240:243], v253, s[16:19], s39 offen sc1
    s_add_u32 s39, s39, 4194304
    v_cvt_pk_bf16_f32 v244, v129, v133
    v_cvt_pk_bf16_f32 v245, v137, v141
    v_cvt_pk_bf16_f32 v246, v145, v149
    v_cvt_pk_bf16_f32 v247, v153, v157
    buffer_store_dwordx4 v[244:247], v253, s[16:19], s39 offen sc1
    s_add_u32 s39, s39, 4194304
    v_cvt_pk_bf16_f32 v240, v130, v134
    v_cvt_pk_bf16_f32 v241, v138, v142
    v_cvt_pk_bf16_f32 v242, v146, v150
    v_cvt_pk_bf16_f32 v243, v154, v158
    buffer_store_dwordx4 v[240:243], v253, s[16:19], s39 offen sc1
    s_add_u32 s39, s39, 4194304
    v_cvt_pk_bf16_f32 v244, v131, v135
    v_cvt_pk_bf16_f32 v245, v139, v143
    v_cvt_pk_bf16_f32 v246, v147, v151
    v_cvt_pk_bf16_f32 v247, v155, v159
    buffer_store_dwordx4 v[244:247], v253, s[16:19], s39 offen sc1
    s_add_u32 s39, s39, 4194304
    s_cmp_lt_u32 s40, 4
    s_cbranch_scc1 K12_UT2
    s_lshl_b32 s36, s40, 3
    s_sub_i32 s36, s36, 18
    s_max_i32 s36, s36, 1
    s_mov_b32 s37, 131072
K12_UL2:
    v_mov_b32 v255, 155648
    ds_read_b32 v255, v255
    s_waitcnt lgkmcnt(0)
    v_cmp_gt_u32 vcc, s36, v255
    s_sub_u32 s37, s37, 1
    s_cmp_eq_u32 s37, 0
    s_cbranch_scc1 K12_UT2
    s_cbranch_vccz K12_UT2
    s_sleep 2
    s_branch K12_UL2
K12_UT2:
    s_setprio 1
    v_mfma_f32_16x16x32_bf16 v[128:131], v[236:239], v[64:67], 0
    v_mfma_f32_16x16x32_bf16 v[132:135], v[236:239], v[68:71], 0
    v_mfma_f32_16x16x32_bf16 v[136:139], v[236:239], v[72:75], 0
    v_mfma_f32_16x16x32_bf16 v[140:143], v[236:239], v[76:79], 0
    v_mfma_f32_16x16x32_bf16 v[144:147], v[236:239], v[80:83], 0
    v_mfma_f32_16x16x32_bf16 v[148:151], v[236:239], v[84:87], 0
    v_mfma_f32_16x16x32_bf16 v[152:155], v[236:239], v[88:91], 0
    v_mfma_f32_16x16x32_bf16 v[156:159], v[236:239], v[92:95], 0
    s_setprio 0
    s_nop 7
    v_cvt_pk_bf16_f32 v240, v128, v132
    v_cvt_pk_bf16_f32 v241, v136, v140
    v_cvt_pk_bf16_f32 v242, v144, v148
    v_cvt_pk_bf16_f32 v243, v152, v156
    buffer_store_dwordx4 v[240:243], v253, s[16:19], s39 offen sc1
    s_add_u32 s39, s39, 4194304
    v_cvt_pk_bf16_f32 v244, v129, v133
    v_cvt_pk_bf16_f32 v245, v137, v141
    v_cvt_pk_bf16_f32 v246, v145, v149
    v_cvt_pk_bf16_f32 v247, v153, v157
    buffer_store_dwordx4 v[244:247], v253, s[16:19], s39 offen sc1
    s_add_u32 s39, s39, 4194304
    v_cvt_pk_bf16_f32 v240, v130, v134
    v_cvt_pk_bf16_f32 v241, v138, v142
    v_cvt_pk_bf16_f32 v242, v146, v150
    v_cvt_pk_bf16_f32 v243, v154, v158
    buffer_store_dwordx4 v[240:243], v253, s[16:19], s39 offen sc1
    s_add_u32 s39, s39, 4194304
    v_cvt_pk_bf16_f32 v244, v131, v135
    v_cvt_pk_bf16_f32 v245, v139, v143
    v_cvt_pk_bf16_f32 v246, v147, v151
    v_cvt_pk_bf16_f32 v247, v155, v159
    buffer_store_dwordx4 v[244:247], v253, s[16:19], s39 offen sc1
    s_branch K12_H2
K12_H1:
    s_cmp_eq_u32 s27, 0
    s_cbranch_scc1 K12_H2
    v_perm_b32 v64, v4, v0, s28
    v_perm_b32 v68, v4, v0, s29
    v_perm_b32 v65, v12, v8, s28
    v_perm_b32 v69, v12, v8, s29
    v_perm_b32 v66, v20, v16, s28
    v_perm_b32 v70, v20, v16, s29
    v_perm_b32 v67, v28, v24, s28
    v_perm_b32 v71, v28, v24, s29
    v_perm_b32 v72, v5, v1, s28
    v_perm_b32 v76, v5, v1, s29
    v_perm_b32 v73, v13, v9, s28
    v_perm_b32 v77, v13, v9, s29
    v_perm_b32 v74, v21, v17, s28
    v_perm_b32 v78, v21, v17, s29
    v_perm_b32 v75, v29, v25, s28
    v_perm_b32 v79, v29, v25, s29
    v_perm_b32 v80, v6, v2, s28
    v_perm_b32 v84, v6, v2, s29
    v_perm_b32 v81, v14, v10, s28
    v_perm_b32 v85, v14, v10, s29
    v_perm_b32 v82, v22, v18, s28
    v_perm_b32 v86, v22, v18, s29
    v_perm_b32 v83, v30, v26, s28
    v_perm_b32 v87, v30, v26, s29
    v_perm_b32 v88, v7, v3, s28
    v_perm_b32 v92, v7, v3, s29
    v_perm_b32 v89, v15, v11, s28
    v_perm_b32 v93, v15, v11, s29
    v_perm_b32 v90, v23, v19, s28
    v_perm_b32 v94, v23, v19, s29
    v_perm_b32 v91, v31, v27, s28
    v_perm_b32 v95, v31, v27, s29
    v_perm_b32 v0, v36, v32, s28
    v_perm_b32 v4, v36, v32, s29
    v_perm_b32 v1, v44, v40, s28
    v_perm_b32 v5, v44, v40, s29
    v_perm_b32 v2, v52, v48, s28
    v_perm_b32 v6, v52, v48, s29
    v_perm_b32 v3, v60, v56, s28
    v_perm_b32 v7, v60, v56, s29
    v_perm_b32 v8, v37, v33, s28
    v_perm_b32 v12, v37, v33, s29
    v_perm_b32 v9, v45, v41, s28
    v_perm_b32 v13, v45, v41, s29
    v_perm_b32 v10, v53, v49, s28
    v_perm_b32 v14, v53, v49, s29
    v_perm_b32 v11, v61, v57, s28
    v_perm_b32 v15, v61, v57, s29
    v_perm_b32 v16, v38, v34, s28
    v_perm_b32 v20, v38, v34, s29
    v_perm_b32 v17, v46, v42, s28
    v_perm_b32 v21, v46, v42, s29
    v_perm_b32 v18, v54, v50, s28
    v_perm_b32 v22, v54, v50, s29
    v_perm_b32 v19, v62, v58, s28
    v_perm_b32 v23, v62, v58, s29
    v_perm_b32 v24, v39, v35, s28
    v_perm_b32 v28, v39, v35, s29
    v_perm_b32 v25, v47, v43, s28
    v_perm_b32 v29, v47, v43, s29
    v_perm_b32 v26, v55, v51, s28
    v_perm_b32 v30, v55, v51, s29
    v_perm_b32 v27, v63, v59, s28
    v_perm_b32 v31, v63, v59, s29
    s_mul_i32 s39, s40, 85504
    s_add_u32 s39, s39, s31
    s_lshl_b32 s36, s30, 7
    s_add_u32 s39, s39, s36
    v_bfe_u32 v249, v254, 4, 2
    v_bfe_u32 v240, v254, 8, 1
    v_lshl_add_u32 v249, v240, 2, v249
    s_add_u32 s36, s30, 7
    s_cmp_ge_u32 s30, 160
    s_cselect_b32 s36, s36, s30
    s_cmp_eq_u32 s25, 1
    s_cselect_b32 s36, s36, s30
    s_lshr_b32 s36, s36, 1
    s_and_b32 s36, s36, 7
    v_xor_b32 v249, s36, v249
    v_lshl_add_u32 v249, v249, 4, v252
    s_setprio 1
    v_mfma_f32_16x16x32_bf16 v[32:35], v[160:163], v[64:67], 0
    v_mfma_f32_16x16x32_bf16 v[36:39], v[160:163], v[68:71], 0
    v_mfma_f32_16x16x32_bf16 v[40:43], v[160:163], v[72:75], 0
    v_mfma_f32_16x16x32_bf16 v[44:47], v[160:163], v[76:79], 0
    v_mfma_f32_16x16x32_bf16 v[48:51], v[160:163], v[80:83], 0
    v_mfma_f32_16x16x32_bf16 v[52:55], v[160:163], v[84:87], 0
    v_mfma_f32_16x16x32_bf16 v[56:59], v[160:163], v[88:91], 0
    v_mfma_f32_16x16x32_bf16 v[60:63], v[160:163], v[92:95], 0
    v_mfma_f32_16x16x32_bf16 v[32:35], v[192:195], v[64:67], v[32:35]
    v_mfma_f32_16x16x32_bf16 v[36:39], v[192:195], v[68:71], v[36:39]
    v_mfma_f32_16x16x32_bf16 v[40:43], v[192:195], v[72:75], v[40:43]
    v_mfma_f32_16x16x32_bf16 v[44:47], v[192:195], v[76:79], v[44:47]
    v_mfma_f32_16x16x32_bf16 v[48:51], v[192:195], v[80:83], v[48:51]
    v_mfma_f32_16x16x32_bf16 v[52:55], v[192:195], v[84:87], v[52:55]
    v_mfma_f32_16x16x32_bf16 v[56:59], v[192:195], v[88:91], v[56:59]
    v_mfma_f32_16x16x32_bf16 v[60:63], v[192:195], v[92:95], v[60:63]
    v_mfma_f32_16x16x32_bf16 v[32:35], v[164:167], v[0:3], v[32:35]
    v_mfma_f32_16x16x32_bf16 v[36:39], v[164:167], v[4:7], v[36:39]
    v_mfma_f32_16x16x32_bf16 v[40:43], v[164:167], v[8:11], v[40:43]
    v_mfma_f32_16x16x32_bf16 v[44:47], v[164:167], v[12:15], v[44:47]
    v_mfma_f32_16x16x32_bf16 v[48:51], v[164:167], v[16:19], v[48:51]
    v_mfma_f32_16x16x32_bf16 v[52:55], v[164:167], v[20:23], v[52:55]
    v_mfma_f32_16x16x32_bf16 v[56:59], v[164:167], v[24:27], v[56:59]
    v_mfma_f32_16x16x32_bf16 v[60:63], v[164:167], v[28:31], v[60:63]
    v_mfma_f32_16x16x32_bf16 v[32:35], v[196:199], v[0:3], v[32:35]
    v_mfma_f32_16x16x32_bf16 v[36:39], v[196:199], v[4:7], v[36:39]
    v_mfma_f32_16x16x32_bf16 v[40:43], v[196:199], v[8:11], v[40:43]
    v_mfma_f32_16x16x32_bf16 v[44:47], v[196:199], v[12:15], v[44:47]
    v_mfma_f32_16x16x32_bf16 v[48:51], v[196:199], v[16:19], v[48:51]
    v_mfma_f32_16x16x32_bf16 v[52:55], v[196:199], v[20:23], v[52:55]
    v_mfma_f32_16x16x32_bf16 v[56:59], v[196:199], v[24:27], v[56:59]
    v_mfma_f32_16x16x32_bf16 v[60:63], v[196:199], v[28:31], v[60:63]
    s_setprio 0
    s_nop 7
    v_cvt_pk_bf16_f32 v240, v32, v36
    v_cvt_pk_bf16_f32 v241, v40, v44
    v_cvt_pk_bf16_f32 v242, v48, v52
    v_cvt_pk_bf16_f32 v243, v56, v60
    buffer_store_dwordx4 v[240:243], v249, s[12:15], s39 offen sc1
    s_add_u32 s39, s39, 2736128
    v_cvt_pk_bf16_f32 v244, v33, v37
    v_cvt_pk_bf16_f32 v245, v41, v45
    v_cvt_pk_bf16_f32 v246, v49, v53
    v_cvt_pk_bf16_f32 v247, v57, v61
    buffer_store_dwordx4 v[244:247], v249, s[12:15], s39 offen sc1
    s_add_u32 s39, s39, 2736128
    v_cvt_pk_bf16_f32 v240, v34, v38
    v_cvt_pk_bf16_f32 v241, v42, v46
    v_cvt_pk_bf16_f32 v242, v50, v54
    v_cvt_pk_bf16_f32 v243, v58, v62
    buffer_store_dwordx4 v[240:243], v249, s[12:15], s39 offen sc1
    s_add_u32 s39, s39, 2736128
    v_cvt_pk_bf16_f32 v244, v35, v39
    v_cvt_pk_bf16_f32 v245, v43, v47
    v_cvt_pk_bf16_f32 v246, v51, v55
    v_cvt_pk_bf16_f32 v247, v59, v63
    buffer_store_dwordx4 v[244:247], v249, s[12:15], s39 offen sc1
    s_add_u32 s39, s39, 2736128
    s_cmp_lt_u32 s40, 4
    s_cbranch_scc1 K12_UT3
    s_lshl_b32 s36, s40, 3
    s_sub_i32 s36, s36, 22
    s_max_i32 s36, s36, 1
    s_mov_b32 s37, 131072
K12_UL3:
    v_mov_b32 v255, 155648
    ds_read_b32 v255, v255
    s_waitcnt lgkmcnt(0)
    v_cmp_gt_u32 vcc, s36, v255
    s_sub_u32 s37, s37, 1
    s_cmp_eq_u32 s37, 0
    s_cbranch_scc1 K12_UT3
    s_cbranch_vccz K12_UT3
    s_sleep 2
    s_branch K12_UL3
K12_UT3:
    s_setprio 1
    v_mfma_f32_16x16x32_bf16 v[32:35], v[168:171], v[64:67], 0
    v_mfma_f32_16x16x32_bf16 v[36:39], v[168:171], v[68:71], 0
    v_mfma_f32_16x16x32_bf16 v[40:43], v[168:171], v[72:75], 0
    v_mfma_f32_16x16x32_bf16 v[44:47], v[168:171], v[76:79], 0
    v_mfma_f32_16x16x32_bf16 v[48:51], v[168:171], v[80:83], 0
    v_mfma_f32_16x16x32_bf16 v[52:55], v[168:171], v[84:87], 0
    v_mfma_f32_16x16x32_bf16 v[56:59], v[168:171], v[88:91], 0
    v_mfma_f32_16x16x32_bf16 v[60:63], v[168:171], v[92:95], 0
    v_mfma_f32_16x16x32_bf16 v[32:35], v[200:203], v[64:67], v[32:35]
    v_mfma_f32_16x16x32_bf16 v[36:39], v[200:203], v[68:71], v[36:39]
    v_mfma_f32_16x16x32_bf16 v[40:43], v[200:203], v[72:75], v[40:43]
    v_mfma_f32_16x16x32_bf16 v[44:47], v[200:203], v[76:79], v[44:47]
    v_mfma_f32_16x16x32_bf16 v[48:51], v[200:203], v[80:83], v[48:51]
    v_mfma_f32_16x16x32_bf16 v[52:55], v[200:203], v[84:87], v[52:55]
    v_mfma_f32_16x16x32_bf16 v[56:59], v[200:203], v[88:91], v[56:59]
    v_mfma_f32_16x16x32_bf16 v[60:63], v[200:203], v[92:95], v[60:63]
    v_mfma_f32_16x16x32_bf16 v[32:35], v[172:175], v[0:3], v[32:35]
    v_mfma_f32_16x16x32_bf16 v[36:39], v[172:175], v[4:7], v[36:39]
    v_mfma_f32_16x16x32_bf16 v[40:43], v[172:175], v[8:11], v[40:43]
    v_mfma_f32_16x16x32_bf16 v[44:47], v[172:175], v[12:15], v[44:47]
    v_mfma_f32_16x16x32_bf16 v[48:51], v[172:175], v[16:19], v[48:51]
    v_mfma_f32_16x16x32_bf16 v[52:55], v[172:175], v[20:23], v[52:55]
    v_mfma_f32_16x16x32_bf16 v[56:59], v[172:175], v[24:27], v[56:59]
    v_mfma_f32_16x16x32_bf16 v[60:63], v[172:175], v[28:31], v[60:63]
    v_mfma_f32_16x16x32_bf16 v[32:35], v[204:207], v[0:3], v[32:35]
    v_mfma_f32_16x16x32_bf16 v[36:39], v[204:207], v[4:7], v[36:39]
    v_mfma_f32_16x16x32_bf16 v[40:43], v[204:207], v[8:11], v[40:43]
    v_mfma_f32_16x16x32_bf16 v[44:47], v[204:207], v[12:15], v[44:47]
    v_mfma_f32_16x16x32_bf16 v[48:51], v[204:207], v[16:19], v[48:51]
    v_mfma_f32_16x16x32_bf16 v[52:55], v[204:207], v[20:23], v[52:55]
    v_mfma_f32_16x16x32_bf16 v[56:59], v[204:207], v[24:27], v[56:59]
    v_mfma_f32_16x16x32_bf16 v[60:63], v[204:207], v[28:31], v[60:63]
    s_setprio 0
    s_nop 7
    v_cvt_pk_bf16_f32 v240, v32, v36
    v_cvt_pk_bf16_f32 v241, v40, v44
    v_cvt_pk_bf16_f32 v242, v48, v52
    v_cvt_pk_bf16_f32 v243, v56, v60
    buffer_store_dwordx4 v[240:243], v249, s[12:15], s39 offen sc1
    s_add_u32 s39, s39, 2736128
    v_cvt_pk_bf16_f32 v244, v33, v37
    v_cvt_pk_bf16_f32 v245, v41, v45
    v_cvt_pk_bf16_f32 v246, v49, v53
    v_cvt_pk_bf16_f32 v247, v57, v61
    buffer_store_dwordx4 v[244:247], v249, s[12:15], s39 offen sc1
    s_add_u32 s39, s39, 2736128
    v_cvt_pk_bf16_f32 v240, v34, v38
    v_cvt_pk_bf16_f32 v241, v42, v46
    v_cvt_pk_bf16_f32 v242, v50, v54
    v_cvt_pk_bf16_f32 v243, v58, v62
    buffer_store_dwordx4 v[240:243], v249, s[12:15], s39 offen sc1
    s_add_u32 s39, s39, 2736128
    v_cvt_pk_bf16_f32 v244, v35, v39
    v_cvt_pk_bf16_f32 v245, v43, v47
    v_cvt_pk_bf16_f32 v246, v51, v55
    v_cvt_pk_bf16_f32 v247, v59, v63
    buffer_store_dwordx4 v[244:247], v249, s[12:15], s39 offen sc1
    s_add_u32 s39, s39, 2736128
    s_cmp_lt_u32 s40, 4
    s_cbranch_scc1 K12_UT4
    s_lshl_b32 s36, s40, 3
    s_sub_i32 s36, s36, 20
    s_max_i32 s36, s36, 1
    s_mov_b32 s37, 131072
K12_UL4:
    v_mov_b32 v255, 155648
    ds_read_b32 v255, v255
    s_waitcnt lgkmcnt(0)
    v_cmp_gt_u32 vcc, s36, v255
    s_sub_u32 s37, s37, 1
    s_cmp_eq_u32 s37, 0
    s_cbranch_scc1 K12_UT4
    s_cbranch_vccz K12_UT4
    s_sleep 2
    s_branch K12_UL4
K12_UT4:
    s_setprio 1
    v_mfma_f32_16x16x32_bf16 v[32:35], v[176:179], v[64:67], 0
    v_mfma_f32_16x16x32_bf16 v[36:39], v[176:179], v[68:71], 0
    v_mfma_f32_16x16x32_bf16 v[40:43], v[176:179], v[72:75], 0
    v_mfma_f32_16x16x32_bf16 v[44:47], v[176:179], v[76:79], 0
    v_mfma_f32_16x16x32_bf16 v[48:51], v[176:179], v[80:83], 0
    v_mfma_f32_16x16x32_bf16 v[52:55], v[176:179], v[84:87], 0
    v_mfma_f32_16x16x32_bf16 v[56:59], v[176:179], v[88:91], 0
    v_mfma_f32_16x16x32_bf16 v[60:63], v[176:179], v[92:95], 0
    v_mfma_f32_16x16x32_bf16 v[32:35], v[208:211], v[64:67], v[32:35]
    v_mfma_f32_16x16x32_bf16 v[36:39], v[208:211], v[68:71], v[36:39]
    v_mfma_f32_16x16x32_bf16 v[40:43], v[208:211], v[72:75], v[40:43]
    v_mfma_f32_16x16x32_bf16 v[44:47], v[208:211], v[76:79], v[44:47]
    v_mfma_f32_16x16x32_bf16 v[48:51], v[208:211], v[80:83], v[48:51]
    v_mfma_f32_16x16x32_bf16 v[52:55], v[208:211], v[84:87], v[52:55]
    v_mfma_f32_16x16x32_bf16 v[56:59], v[208:211], v[88:91], v[56:59]
    v_mfma_f32_16x16x32_bf16 v[60:63], v[208:211], v[92:95], v[60:63]
    v_mfma_f32_16x16x32_bf16 v[32:35], v[180:183], v[0:3], v[32:35]
    v_mfma_f32_16x16x32_bf16 v[36:39], v[180:183], v[4:7], v[36:39]
    v_mfma_f32_16x16x32_bf16 v[40:43], v[180:183], v[8:11], v[40:43]
    v_mfma_f32_16x16x32_bf16 v[44:47], v[180:183], v[12:15], v[44:47]
    v_mfma_f32_16x16x32_bf16 v[48:51], v[180:183], v[16:19], v[48:51]
    v_mfma_f32_16x16x32_bf16 v[52:55], v[180:183], v[20:23], v[52:55]
    v_mfma_f32_16x16x32_bf16 v[56:59], v[180:183], v[24:27], v[56:59]
    v_mfma_f32_16x16x32_bf16 v[60:63], v[180:183], v[28:31], v[60:63]
    v_mfma_f32_16x16x32_bf16 v[32:35], v[212:215], v[0:3], v[32:35]
    v_mfma_f32_16x16x32_bf16 v[36:39], v[212:215], v[4:7], v[36:39]
    v_mfma_f32_16x16x32_bf16 v[40:43], v[212:215], v[8:11], v[40:43]
    v_mfma_f32_16x16x32_bf16 v[44:47], v[212:215], v[12:15], v[44:47]
    v_mfma_f32_16x16x32_bf16 v[48:51], v[212:215], v[16:19], v[48:51]
    v_mfma_f32_16x16x32_bf16 v[52:55], v[212:215], v[20:23], v[52:55]
    v_mfma_f32_16x16x32_bf16 v[56:59], v[212:215], v[24:27], v[56:59]
    v_mfma_f32_16x16x32_bf16 v[60:63], v[212:215], v[28:31], v[60:63]
    s_setprio 0
    s_nop 7
    v_cvt_pk_bf16_f32 v240, v32, v36
    v_cvt_pk_bf16_f32 v241, v40, v44
    v_cvt_pk_bf16_f32 v242, v48, v52
    v_cvt_pk_bf16_f32 v243, v56, v60
    buffer_store_dwordx4 v[240:243], v249, s[12:15], s39 offen sc1
    s_add_u32 s39, s39, 2736128
    v_cvt_pk_bf16_f32 v244, v33, v37
    v_cvt_pk_bf16_f32 v245, v41, v45
    v_cvt_pk_bf16_f32 v246, v49, v53
    v_cvt_pk_bf16_f32 v247, v57, v61
    buffer_store_dwordx4 v[244:247], v249, s[12:15], s39 offen sc1
    s_add_u32 s39, s39, 2736128
    v_cvt_pk_bf16_f32 v240, v34, v38
    v_cvt_pk_bf16_f32 v241, v42, v46
    v_cvt_pk_bf16_f32 v242, v50, v54
    v_cvt_pk_bf16_f32 v243, v58, v62
    buffer_store_dwordx4 v[240:243], v249, s[12:15], s39 offen sc1
    s_add_u32 s39, s39, 2736128
    v_cvt_pk_bf16_f32 v244, v35, v39
    v_cvt_pk_bf16_f32 v245, v43, v47
    v_cvt_pk_bf16_f32 v246, v51, v55
    v_cvt_pk_bf16_f32 v247, v59, v63
    buffer_store_dwordx4 v[244:247], v249, s[12:15], s39 offen sc1
    s_add_u32 s39, s39, 2736128
    s_cmp_lt_u32 s40, 4
    s_cbranch_scc1 K12_UT5
    s_lshl_b32 s36, s40, 3
    s_sub_i32 s36, s36, 18
    s_max_i32 s36, s36, 1
    s_mov_b32 s37, 131072
K12_UL5:
    v_mov_b32 v255, 155648
    ds_read_b32 v255, v255
    s_waitcnt lgkmcnt(0)
    v_cmp_gt_u32 vcc, s36, v255
    s_sub_u32 s37, s37, 1
    s_cmp_eq_u32 s37, 0
    s_cbranch_scc1 K12_UT5
    s_cbranch_vccz K12_UT5
    s_sleep 2
    s_branch K12_UL5
K12_UT5:
    s_setprio 1
    v_mfma_f32_16x16x32_bf16 v[32:35], v[184:187], v[64:67], 0
    v_mfma_f32_16x16x32_bf16 v[36:39], v[184:187], v[68:71], 0
    v_mfma_f32_16x16x32_bf16 v[40:43], v[184:187], v[72:75], 0
    v_mfma_f32_16x16x32_bf16 v[44:47], v[184:187], v[76:79], 0
    v_mfma_f32_16x16x32_bf16 v[48:51], v[184:187], v[80:83], 0
    v_mfma_f32_16x16x32_bf16 v[52:55], v[184:187], v[84:87], 0
    v_mfma_f32_16x16x32_bf16 v[56:59], v[184:187], v[88:91], 0
    v_mfma_f32_16x16x32_bf16 v[60:63], v[184:187], v[92:95], 0
    v_mfma_f32_16x16x32_bf16 v[32:35], v[216:219], v[64:67], v[32:35]
    v_mfma_f32_16x16x32_bf16 v[36:39], v[216:219], v[68:71], v[36:39]
    v_mfma_f32_16x16x32_bf16 v[40:43], v[216:219], v[72:75], v[40:43]
    v_mfma_f32_16x16x32_bf16 v[44:47], v[216:219], v[76:79], v[44:47]
    v_mfma_f32_16x16x32_bf16 v[48:51], v[216:219], v[80:83], v[48:51]
    v_mfma_f32_16x16x32_bf16 v[52:55], v[216:219], v[84:87], v[52:55]
    v_mfma_f32_16x16x32_bf16 v[56:59], v[216:219], v[88:91], v[56:59]
    v_mfma_f32_16x16x32_bf16 v[60:63], v[216:219], v[92:95], v[60:63]
    v_mfma_f32_16x16x32_bf16 v[32:35], v[188:191], v[0:3], v[32:35]
    v_mfma_f32_16x16x32_bf16 v[36:39], v[188:191], v[4:7], v[36:39]
    v_mfma_f32_16x16x32_bf16 v[40:43], v[188:191], v[8:11], v[40:43]
    v_mfma_f32_16x16x32_bf16 v[44:47], v[188:191], v[12:15], v[44:47]
    v_mfma_f32_16x16x32_bf16 v[48:51], v[188:191], v[16:19], v[48:51]
    v_mfma_f32_16x16x32_bf16 v[52:55], v[188:191], v[20:23], v[52:55]
    v_mfma_f32_16x16x32_bf16 v[56:59], v[188:191], v[24:27], v[56:59]
    v_mfma_f32_16x16x32_bf16 v[60:63], v[188:191], v[28:31], v[60:63]
    v_mfma_f32_16x16x32_bf16 v[32:35], v[220:223], v[0:3], v[32:35]
    v_mfma_f32_16x16x32_bf16 v[36:39], v[220:223], v[4:7], v[36:39]
    v_mfma_f32_16x16x32_bf16 v[40:43], v[220:223], v[8:11], v[40:43]
    v_mfma_f32_16x16x32_bf16 v[44:47], v[220:223], v[12:15], v[44:47]
    v_mfma_f32_16x16x32_bf16 v[48:51], v[220:223], v[16:19], v[48:51]
    v_mfma_f32_16x16x32_bf16 v[52:55], v[220:223], v[20:23], v[52:55]
    v_mfma_f32_16x16x32_bf16 v[56:59], v[220:223], v[24:27], v[56:59]
    v_mfma_f32_16x16x32_bf16 v[60:63], v[220:223], v[28:31], v[60:63]
    s_setprio 0
    s_nop 7
    v_cvt_pk_bf16_f32 v240, v32, v36
    v_cvt_pk_bf16_f32 v241, v40, v44
    v_cvt_pk_bf16_f32 v242, v48, v52
    v_cvt_pk_bf16_f32 v243, v56, v60
    buffer_store_dwordx4 v[240:243], v249, s[12:15], s39 offen sc1
    s_add_u32 s39, s39, 2736128
    v_cvt_pk_bf16_f32 v244, v33, v37
    v_cvt_pk_bf16_f32 v245, v41, v45
    v_cvt_pk_bf16_f32 v246, v49, v53
    v_cvt_pk_bf16_f32 v247, v57, v61
    buffer_store_dwordx4 v[244:247], v249, s[12:15], s39 offen sc1
    s_add_u32 s39, s39, 2736128
    v_cvt_pk_bf16_f32 v240, v34, v38
    v_cvt_pk_bf16_f32 v241, v42, v46
    v_cvt_pk_bf16_f32 v242, v50, v54
    v_cvt_pk_bf16_f32 v243, v58, v62
    buffer_store_dwordx4 v[240:243], v249, s[12:15], s39 offen sc1
    s_add_u32 s39, s39, 2736128
    v_cvt_pk_bf16_f32 v244, v35, v39
    v_cvt_pk_bf16_f32 v245, v43, v47
    v_cvt_pk_bf16_f32 v246, v51, v55
    v_cvt_pk_bf16_f32 v247, v59, v63
    buffer_store_dwordx4 v[244:247], v249, s[12:15], s39 offen sc1
K12_H2:
    s_mov_b64 exec, 1
    v_mov_b32 v255, 155664
    v_mov_b32 v64, 1
    ds_add_u32 v255, v64
    s_mov_b64 exec, -1
    s_waitcnt vmcnt(0)
    s_mov_b32 s41, 0
    s_mov_b32 s34, -1
    s_cmp_ge_u32 s41, 8
    s_cbranch_scc1 K12_SG0
    s_lshl_b32 s36, s41, 2
    s_add_u32 s37, s36, 155680
    s_mov_b64 exec, 1
    v_mov_b32 v255, s37
    v_mov_b32 v240, 1
    ds_add_rtn_u32 v240, v255, v240
    s_waitcnt lgkmcnt(0)
    v_readfirstlane_b32 s37, v240
    s_nop 3
    s_cmp_eq_u32 s37, 3
    s_cbranch_scc0 K12_SH0
    s_lshl_b32 s36, s36, 8
    v_mov_b32 v255, 1
    v_mov_b32 v240, s36
    buffer_atomic_add v255, v240, s[60:63], 0 offen sc0 sc1
    s_mov_b32 s34, s41
K12_SH0:
    s_mov_b64 exec, -1
K12_SG0:
    s_waitcnt vmcnt(0)
    s_cmp_ge_u32 s34, 8
    s_cbranch_scc1 K12_PB1
    v_readfirstlane_b32 s37, v255
    s_nop 3
    s_cmp_eq_u32 s37, 255
    s_cbranch_scc0 K12_PB1
    s_lshl_b32 s36, s34, 4
    s_add_u32 s36, s36, 16384
    s_mov_b64 exec, 1
    v_mov_b32 v255, 1
    v_mov_b32 v240, s36
    buffer_store_dword v255, v240, s[60:63], 0 offen sc1
    s_mov_b64 exec, -1
K12_PB1:
    s_branch K12_CONS
K12_PROD:
    s_mov_b32 s37, 131072
K12_TW:
    v_mov_b32 v240, 155648
    ds_read_b32 v240, v240
    s_waitcnt lgkmcnt(0)
    v_cmp_gt_u32 vcc, 2, v240
    s_sub_u32 s37, s37, 1
    s_cmp_eq_u32 s37, 0
    s_cbranch_scc1 K12_TX
    s_cbranch_vccz K12_TX
    s_sleep 2
    s_branch K12_TW
K12_TX:
    v_lshrrev_b32 v128, 4, v254
    v_lshlrev_b32 v129, 11, v128
    v_lshrrev_b32 v130, 1, v128
    v_lshlrev_b32 v130, 20, v130
    v_and_b32 v131, 1, v128
    v_lshl_add_u32 v130, v131, 7, v130
    s_mov_b32 s45, s27
    s_mov_b32 s46, s30
    s_add_u32 s47, s40, 1
K12_TCH0:
    s_xor_b32 s48, s47, s20
    s_and_b32 s48, s48, 1
    s_cmp_eq_u32 s48, 0
    s_cbranch_scc1 K12_TCHW0
    s_mul_i32 s36, s47, 85
    s_add_u32 s36, s36, s2
    s_and_b32 s36, s36, 255
    s_mul_hi_u32 s37, s36, 0x55555556
    s_mul_i32 s38, s37, 3
    s_cmp_eq_u32 s38, s36
    s_cselect_b32 s27, 1, 0
    s_cmp_lt_u32 s37, 78
    s_cselect_b32 s27, s27, 0
    s_add_u32 s37, s37, 89
    s_cmp_eq_u32 s21, 0
    s_cselect_b32 s30, s24, s37
    s_cselect_b32 s27, 1, s27
    s_cmp_eq_u32 s27, 0
    s_cbranch_scc1 K12_TCHN0
    s_lshl_b32 s36, s47, 8
    s_mul_i32 s37, s30, 98304
    s_add_u32 s36, s36, s37
    buffer_load_dword v244, v129, s[4:7], s36 offen
    buffer_load_dword v245, v129, s[4:7], s36 offen offset:128
    s_branch K12_TCHN0
K12_TCHW0:
    s_lshl_b32 s36, s47, 7
    s_add_u32 s36, s36, s22
    s_lshr_b32 s37, s36, 9
    s_lshl_b32 s37, s37, 19
    s_and_b32 s36, s36, 511
    s_lshl_b32 s36, s36, 10
    s_add_u32 s36, s36, s37
    s_add_u32 s36, s36, s33
    s_mov_b64 exec, 0xffffffff
    buffer_load_dword v246, v130, s[8:11], s36 offen
    s_mov_b64 exec, -1
K12_TCHN0:
    s_add_u32 s47, s47, 1
    s_cmp_lt_u32 s47, 8
    s_cbranch_scc1 K12_TCH0
    s_mov_b32 s27, s45
    s_mov_b32 s30, s46
    s_cmp_eq_u32 s43, 0
    s_cbranch_scc1 K12_WENTRY
K12_XW:
    s_waitcnt vmcnt(0)
    s_mov_b32 s34, -1
    s_cmp_ge_u32 s41, 8
    s_cbranch_scc1 K12_SG2
    s_lshl_b32 s36, s41, 2
    s_add_u32 s37, s36, 155680
    s_mov_b64 exec, 1
    v_mov_b32 v255, s37
    v_mov_b32 v240, 1
    ds_add_rtn_u32 v240, v255, v240
    s_waitcnt lgkmcnt(0)
    v_readfirstlane_b32 s37, v240
    s_nop 3
    s_cmp_eq_u32 s37, 3
    s_cbranch_scc0 K12_SH2
    s_lshl_b32 s36, s36, 8
    v_mov_b32 v255, 1
    v_mov_b32 v240, s36
    buffer_atomic_add v255, v240, s[60:63], 0 offen sc0 sc1
    s_mov_b32 s34, s41
K12_SH2:
    s_mov_b64 exec, -1
K12_SG2:
    s_cmp_ge_u32 s34, 8
    s_cbranch_scc1 K12_EP3
    s_waitcnt vmcnt(0)
    s_cmp_ge_u32 s34, 8
    s_cbranch_scc1 K12_PB4
    v_readfirstlane_b32 s37, v255
    s_nop 3
    s_cmp_eq_u32 s37, 255
    s_cbranch_scc0 K12_PB4
    s_lshl_b32 s36, s34, 4
    s_add_u32 s36, s36, 16384
    s_mov_b64 exec, 1
    v_mov_b32 v255, 1
    v_mov_b32 v240, s36
    buffer_store_dword v255, v240, s[60:63], 0 offen sc1
    s_mov_b64 exec, -1
K12_PB4:
    s_mov_b32 s34, -1
K12_EP3:
    s_cmp_eq_u32 s27, 0
    s_cbranch_scc1 K12_XP_N
    v_perm_b32 v64, v4, v0, s28
    v_perm_b32 v68, v4, v0, s29
    v_perm_b32 v65, v12, v8, s28
    v_perm_b32 v69, v12, v8, s29
    v_perm_b32 v66, v20, v16, s28
    v_perm_b32 v70, v20, v16, s29
    v_perm_b32 v67, v28, v24, s28
    v_perm_b32 v71, v28, v24, s29
    v_perm_b32 v72, v5, v1, s28
    v_perm_b32 v76, v5, v1, s29
    v_perm_b32 v73, v13, v9, s28
    v_perm_b32 v77, v13, v9, s29
    v_perm_b32 v74, v21, v17, s28
    v_perm_b32 v78, v21, v17, s29
    v_perm_b32 v75, v29, v25, s28
    v_perm_b32 v79, v29, v25, s29
    v_perm_b32 v80, v6, v2, s28
    v_perm_b32 v84, v6, v2, s29
    v_perm_b32 v81, v14, v10, s28
    v_perm_b32 v85, v14, v10, s29
    v_perm_b32 v82, v22, v18, s28
    v_perm_b32 v86, v22, v18, s29
    v_perm_b32 v83, v30, v26, s28
    v_perm_b32 v87, v30, v26, s29
    v_perm_b32 v88, v7, v3, s28
    v_perm_b32 v92, v7, v3, s29
    v_perm_b32 v89, v15, v11, s28
    v_perm_b32 v93, v15, v11, s29
    v_perm_b32 v90, v23, v19, s28
    v_perm_b32 v94, v23, v19, s29
    v_perm_b32 v91, v31, v27, s28
    v_perm_b32 v95, v31, v27, s29
    v_perm_b32 v0, v36, v32, s28
    v_perm_b32 v4, v36, v32, s29
    v_perm_b32 v1, v44, v40, s28
    v_perm_b32 v5, v44, v40, s29
    v_perm_b32 v2, v52, v48, s28
    v_perm_b32 v6, v52, v48, s29
    v_perm_b32 v3, v60, v56, s28
    v_perm_b32 v7, v60, v56, s29
    v_perm_b32 v8, v37, v33, s28
    v_perm_b32 v12, v37, v33, s29
    v_perm_b32 v9, v45, v41, s28
    v_perm_b32 v13, v45, v41, s29
    v_perm_b32 v10, v53, v49, s28
    v_perm_b32 v14, v53, v49, s29
    v_perm_b32 v11, v61, v57, s28
    v_perm_b32 v15, v61, v57, s29
    v_perm_b32 v16, v38, v34, s28
    v_perm_b32 v20, v38, v34, s29
    v_perm_b32 v17, v46, v42, s28
    v_perm_b32 v21, v46, v42, s29
    v_perm_b32 v18, v54, v50, s28
    v_perm_b32 v22, v54, v50, s29
    v_perm_b32 v19, v62, v58, s28
    v_perm_b32 v23, v62, v58, s29
    v_perm_b32 v24, v39, v35, s28
    v_perm_b32 v28, v39, v35, s29
    v_perm_b32 v25, v47, v43, s28
    v_perm_b32 v29, v47, v43, s29
    v_perm_b32 v26, v55, v51, s28
    v_perm_b32 v30, v55, v51, s29
    v_perm_b32 v27, v63, v59, s28
    v_perm_b32 v31, v63, v59, s29
K12_XP_N:
    s_lshl_b32 s36, s40, 3
    s_sub_i32 s36, s36, 24
    s_max_i32 s36, s36, 1
    s_mov_b32 s37, 131072
K12_GL0:
    v_mov_b32 v240, 155648
    ds_read_b32 v240, v240
    s_waitcnt lgkmcnt(0)
    v_cmp_gt_u32 vcc, s36, v240
    s_sub_u32 s37, s37, 1
    s_cmp_eq_u32 s37, 0
    s_cbranch_scc1 K12_GT0
    s_cbranch_vccz K12_GT0
    s_sleep 2
    s_branch K12_GL0
K12_GT0:
    s_lshl_b32 s36, s40, 2
    s_add_u32 s36, s36, 155840
    s_mov_b64 exec, 1
    v_mov_b32 v240, s36
    v_mov_b32 v241, 1
    ds_add_u32 v240, v241
    s_mov_b64 exec, -1
    s_mov_b32 s37, 131072
K12_BL0:
    v_mov_b32 v240, s36
    ds_read_b32 v240, v240
    s_waitcnt lgkmcnt(0)
    v_cmp_gt_u32 vcc, 4, v240
    s_sub_u32 s37, s37, 1
    s_cmp_eq_u32 s37, 0
    s_cbranch_scc1 K12_BT0
    s_cbranch_vccz K12_BT0
    s_sleep 1
    s_branch K12_BL0
K12_BT0:
    s_add_u32 s42, s40, 1
    s_lshl_b32 s36, s42, 7
    s_add_u32 s36, s36, s22
    s_lshr_b32 s37, s36, 9
    s_lshl_b32 s37, s37, 19
    s_and_b32 s36, s36, 511
    s_lshl_b32 s36, s36, 10
    s_add_u32 s36, s36, s37
    s_add_u32 s36, s36, s33
    buffer_load_dwordx4 v[96:99], v250, s[8:11], s36 offen
    s_add_u32 s36, s36, 0x100000
    buffer_load_dwordx4 v[100:103], v250, s[8:11], s36 offen
    s_add_u32 s36, s36, 0x100000
    buffer_load_dwordx4 v[104:107], v250, s[8:11], s36 offen
    s_add_u32 s36, s36, 0x100000
    buffer_load_dwordx4 v[108:111], v250, s[8:11], s36 offen
    s_add_u32 s36, s36, 0x100000
    buffer_load_dwordx4 v[112:115], v250, s[8:11], s36 offen
    s_add_u32 s36, s36, 0x100000
    buffer_load_dwordx4 v[116:119], v250, s[8:11], s36 offen
    s_add_u32 s36, s36, 0x100000
    buffer_load_dwordx4 v[120:123], v250, s[8:11], s36 offen
    s_add_u32 s36, s36, 0x100000
    buffer_load_dwordx4 v[124:127], v250, s[8:11], s36 offen
    s_cmp_eq_u32 s27, 0
    s_cbranch_scc1 K12_XP_E
    s_mul_i32 s39, s40, 85504
    s_add_u32 s39, s39, s31
    s_lshl_b32 s36, s30, 7
    s_add_u32 s39, s39, s36
    v_bfe_u32 v249, v254, 4, 2
    v_bfe_u32 v240, v254, 8, 1
    v_lshl_add_u32 v249, v240, 2, v249
    s_add_u32 s36, s30, 7
    s_cmp_ge_u32 s30, 160
    s_cselect_b32 s36, s36, s30
    s_cmp_eq_u32 s25, 1
    s_cselect_b32 s36, s36, s30
    s_lshr_b32 s36, s36, 1
    s_and_b32 s36, s36, 7
    v_xor_b32 v249, s36, v249
    v_lshl_add_u32 v249, v249, 4, v252
    s_setprio 1
    v_mfma_f32_16x16x32_bf16 v[32:35], v[160:163], v[64:67], 0
    v_mfma_f32_16x16x32_bf16 v[36:39], v[160:163], v[68:71], 0
    v_mfma_f32_16x16x32_bf16 v[40:43], v[160:163], v[72:75], 0
    v_mfma_f32_16x16x32_bf16 v[44:47], v[160:163], v[76:79], 0
    v_mfma_f32_16x16x32_bf16 v[48:51], v[160:163], v[80:83], 0
    v_mfma_f32_16x16x32_bf16 v[52:55], v[160:163], v[84:87], 0
    v_mfma_f32_16x16x32_bf16 v[56:59], v[160:163], v[88:91], 0
    v_mfma_f32_16x16x32_bf16 v[60:63], v[160:163], v[92:95], 0
    v_mfma_f32_16x16x32_bf16 v[32:35], v[192:195], v[64:67], v[32:35]
    v_mfma_f32_16x16x32_bf16 v[36:39], v[192:195], v[68:71], v[36:39]
    v_mfma_f32_16x16x32_bf16 v[40:43], v[192:195], v[72:75], v[40:43]
    v_mfma_f32_16x16x32_bf16 v[44:47], v[192:195], v[76:79], v[44:47]
    v_mfma_f32_16x16x32_bf16 v[48:51], v[192:195], v[80:83], v[48:51]
    v_mfma_f32_16x16x32_bf16 v[52:55], v[192:195], v[84:87], v[52:55]
    v_mfma_f32_16x16x32_bf16 v[56:59], v[192:195], v[88:91], v[56:59]
    v_mfma_f32_16x16x32_bf16 v[60:63], v[192:195], v[92:95], v[60:63]
    v_mfma_f32_16x16x32_bf16 v[32:35], v[164:167], v[0:3], v[32:35]
    v_mfma_f32_16x16x32_bf16 v[36:39], v[164:167], v[4:7], v[36:39]
    v_mfma_f32_16x16x32_bf16 v[40:43], v[164:167], v[8:11], v[40:43]
    v_mfma_f32_16x16x32_bf16 v[44:47], v[164:167], v[12:15], v[44:47]
    v_mfma_f32_16x16x32_bf16 v[48:51], v[164:167], v[16:19], v[48:51]
    v_mfma_f32_16x16x32_bf16 v[52:55], v[164:167], v[20:23], v[52:55]
    v_mfma_f32_16x16x32_bf16 v[56:59], v[164:167], v[24:27], v[56:59]
    v_mfma_f32_16x16x32_bf16 v[60:63], v[164:167], v[28:31], v[60:63]
    v_mfma_f32_16x16x32_bf16 v[32:35], v[196:199], v[0:3], v[32:35]
    v_mfma_f32_16x16x32_bf16 v[36:39], v[196:199], v[4:7], v[36:39]
    v_mfma_f32_16x16x32_bf16 v[40:43], v[196:199], v[8:11], v[40:43]
    v_mfma_f32_16x16x32_bf16 v[44:47], v[196:199], v[12:15], v[44:47]
    v_mfma_f32_16x16x32_bf16 v[48:51], v[196:199], v[16:19], v[48:51]
    v_mfma_f32_16x16x32_bf16 v[52:55], v[196:199], v[20:23], v[52:55]
    v_mfma_f32_16x16x32_bf16 v[56:59], v[196:199], v[24:27], v[56:59]
    v_mfma_f32_16x16x32_bf16 v[60:63], v[196:199], v[28:31], v[60:63]
    s_setprio 0
    s_nop 7
    v_cvt_pk_bf16_f32 v240, v32, v36
    v_cvt_pk_bf16_f32 v241, v40, v44
    v_cvt_pk_bf16_f32 v242, v48, v52
    v_cvt_pk_bf16_f32 v243, v56, v60
    buffer_store_dwordx4 v[240:243], v249, s[12:15], s39 offen sc1
    s_add_u32 s39, s39, 2736128
    v_cvt_pk_bf16_f32 v244, v33, v37
    v_cvt_pk_bf16_f32 v245, v41, v45
    v_cvt_pk_bf16_f32 v246, v49, v53
    v_cvt_pk_bf16_f32 v247, v57, v61
    buffer_store_dwordx4 v[244:247], v249, s[12:15], s39 offen sc1
    s_add_u32 s39, s39, 2736128
    v_cvt_pk_bf16_f32 v240, v34, v38
    v_cvt_pk_bf16_f32 v241, v42, v46
    v_cvt_pk_bf16_f32 v242, v50, v54
    v_cvt_pk_bf16_f32 v243, v58, v62
    buffer_store_dwordx4 v[240:243], v249, s[12:15], s39 offen sc1
    s_add_u32 s39, s39, 2736128
    v_cvt_pk_bf16_f32 v244, v35, v39
    v_cvt_pk_bf16_f32 v245, v43, v47
    v_cvt_pk_bf16_f32 v246, v51, v55
    v_cvt_pk_bf16_f32 v247, v59, v63
    buffer_store_dwordx4 v[244:247], v249, s[12:15], s39 offen sc1
    s_add_u32 s39, s39, 2736128
    s_cmp_lt_u32 s40, 4
    s_cbranch_scc1 K12_UT6
    s_lshl_b32 s36, s40, 3
    s_sub_i32 s36, s36, 22
    s_max_i32 s36, s36, 1
    s_mov_b32 s37, 131072
K12_UL6:
    v_mov_b32 v255, 155648
    ds_read_b32 v255, v255
    s_waitcnt lgkmcnt(0)
    v_cmp_gt_u32 vcc, s36, v255
    s_sub_u32 s37, s37, 1
    s_cmp_eq_u32 s37, 0
    s_cbranch_scc1 K12_UT6
    s_cbranch_vccz K12_UT6
    s_sleep 2
    s_branch K12_UL6
K12_UT6:
    s_setprio 1
    v_mfma_f32_16x16x32_bf16 v[32:35], v[168:171], v[64:67], 0
    v_mfma_f32_16x16x32_bf16 v[36:39], v[168:171], v[68:71], 0
    v_mfma_f32_16x16x32_bf16 v[40:43], v[168:171], v[72:75], 0
    v_mfma_f32_16x16x32_bf16 v[44:47], v[168:171], v[76:79], 0
    v_mfma_f32_16x16x32_bf16 v[48:51], v[168:171], v[80:83], 0
    v_mfma_f32_16x16x32_bf16 v[52:55], v[168:171], v[84:87], 0
    v_mfma_f32_16x16x32_bf16 v[56:59], v[168:171], v[88:91], 0
    v_mfma_f32_16x16x32_bf16 v[60:63], v[168:171], v[92:95], 0
    v_mfma_f32_16x16x32_bf16 v[32:35], v[200:203], v[64:67], v[32:35]
    v_mfma_f32_16x16x32_bf16 v[36:39], v[200:203], v[68:71], v[36:39]
    v_mfma_f32_16x16x32_bf16 v[40:43], v[200:203], v[72:75], v[40:43]
    v_mfma_f32_16x16x32_bf16 v[44:47], v[200:203], v[76:79], v[44:47]
    v_mfma_f32_16x16x32_bf16 v[48:51], v[200:203], v[80:83], v[48:51]
    v_mfma_f32_16x16x32_bf16 v[52:55], v[200:203], v[84:87], v[52:55]
    v_mfma_f32_16x16x32_bf16 v[56:59], v[200:203], v[88:91], v[56:59]
    v_mfma_f32_16x16x32_bf16 v[60:63], v[200:203], v[92:95], v[60:63]
    v_mfma_f32_16x16x32_bf16 v[32:35], v[172:175], v[0:3], v[32:35]
    v_mfma_f32_16x16x32_bf16 v[36:39], v[172:175], v[4:7], v[36:39]
    v_mfma_f32_16x16x32_bf16 v[40:43], v[172:175], v[8:11], v[40:43]
    v_mfma_f32_16x16x32_bf16 v[44:47], v[172:175], v[12:15], v[44:47]
    v_mfma_f32_16x16x32_bf16 v[48:51], v[172:175], v[16:19], v[48:51]
    v_mfma_f32_16x16x32_bf16 v[52:55], v[172:175], v[20:23], v[52:55]
    v_mfma_f32_16x16x32_bf16 v[56:59], v[172:175], v[24:27], v[56:59]
    v_mfma_f32_16x16x32_bf16 v[60:63], v[172:175], v[28:31], v[60:63]
    v_mfma_f32_16x16x32_bf16 v[32:35], v[204:207], v[0:3], v[32:35]
    v_mfma_f32_16x16x32_bf16 v[36:39], v[204:207], v[4:7], v[36:39]
    v_mfma_f32_16x16x32_bf16 v[40:43], v[204:207], v[8:11], v[40:43]
    v_mfma_f32_16x16x32_bf16 v[44:47], v[204:207], v[12:15], v[44:47]
    v_mfma_f32_16x16x32_bf16 v[48:51], v[204:207], v[16:19], v[48:51]
    v_mfma_f32_16x16x32_bf16 v[52:55], v[204:207], v[20:23], v[52:55]
    v_mfma_f32_16x16x32_bf16 v[56:59], v[204:207], v[24:27], v[56:59]
    v_mfma_f32_16x16x32_bf16 v[60:63], v[204:207], v[28:31], v[60:63]
    s_setprio 0
    s_nop 7
    v_cvt_pk_bf16_f32 v240, v32, v36
    v_cvt_pk_bf16_f32 v241, v40, v44
    v_cvt_pk_bf16_f32 v242, v48, v52
    v_cvt_pk_bf16_f32 v243, v56, v60
    buffer_store_dwordx4 v[240:243], v249, s[12:15], s39 offen sc1
    s_add_u32 s39, s39, 2736128
    v_cvt_pk_bf16_f32 v244, v33, v37
    v_cvt_pk_bf16_f32 v245, v41, v45
    v_cvt_pk_bf16_f32 v246, v49, v53
    v_cvt_pk_bf16_f32 v247, v57, v61
    buffer_store_dwordx4 v[244:247], v249, s[12:15], s39 offen sc1
    s_add_u32 s39, s39, 2736128
    v_cvt_pk_bf16_f32 v240, v34, v38
    v_cvt_pk_bf16_f32 v241, v42, v46
    v_cvt_pk_bf16_f32 v242, v50, v54
    v_cvt_pk_bf16_f32 v243, v58, v62
    buffer_store_dwordx4 v[240:243], v249, s[12:15], s39 offen sc1
    s_add_u32 s39, s39, 2736128
    v_cvt_pk_bf16_f32 v244, v35, v39
    v_cvt_pk_bf16_f32 v245, v43, v47
    v_cvt_pk_bf16_f32 v246, v51, v55
    v_cvt_pk_bf16_f32 v247, v59, v63
    buffer_store_dwordx4 v[244:247], v249, s[12:15], s39 offen sc1
    s_add_u32 s39, s39, 2736128
    s_cmp_lt_u32 s40, 4
    s_cbranch_scc1 K12_UT7
    s_lshl_b32 s36, s40, 3
    s_sub_i32 s36, s36, 20
    s_max_i32 s36, s36, 1
    s_mov_b32 s37, 131072
K12_UL7:
    v_mov_b32 v255, 155648
    ds_read_b32 v255, v255
    s_waitcnt lgkmcnt(0)
    v_cmp_gt_u32 vcc, s36, v255
    s_sub_u32 s37, s37, 1
    s_cmp_eq_u32 s37, 0
    s_cbranch_scc1 K12_UT7
    s_cbranch_vccz K12_UT7
    s_sleep 2
    s_branch K12_UL7
K12_UT7:
    s_setprio 1
    v_mfma_f32_16x16x32_bf16 v[32:35], v[176:179], v[64:67], 0
    v_mfma_f32_16x16x32_bf16 v[36:39], v[176:179], v[68:71], 0
    v_mfma_f32_16x16x32_bf16 v[40:43], v[176:179], v[72:75], 0
    v_mfma_f32_16x16x32_bf16 v[44:47], v[176:179], v[76:79], 0
    v_mfma_f32_16x16x32_bf16 v[48:51], v[176:179], v[80:83], 0
    v_mfma_f32_16x16x32_bf16 v[52:55], v[176:179], v[84:87], 0
    v_mfma_f32_16x16x32_bf16 v[56:59], v[176:179], v[88:91], 0
    v_mfma_f32_16x16x32_bf16 v[60:63], v[176:179], v[92:95], 0
    v_mfma_f32_16x16x32_bf16 v[32:35], v[208:211], v[64:67], v[32:35]
    v_mfma_f32_16x16x32_bf16 v[36:39], v[208:211], v[68:71], v[36:39]
    v_mfma_f32_16x16x32_bf16 v[40:43], v[208:211], v[72:75], v[40:43]
    v_mfma_f32_16x16x32_bf16 v[44:47], v[208:211], v[76:79], v[44:47]
    v_mfma_f32_16x16x32_bf16 v[48:51], v[208:211], v[80:83], v[48:51]
    v_mfma_f32_16x16x32_bf16 v[52:55], v[208:211], v[84:87], v[52:55]
    v_mfma_f32_16x16x32_bf16 v[56:59], v[208:211], v[88:91], v[56:59]
    v_mfma_f32_16x16x32_bf16 v[60:63], v[208:211], v[92:95], v[60:63]
    v_mfma_f32_16x16x32_bf16 v[32:35], v[180:183], v[0:3], v[32:35]
    v_mfma_f32_16x16x32_bf16 v[36:39], v[180:183], v[4:7], v[36:39]
    v_mfma_f32_16x16x32_bf16 v[40:43], v[180:183], v[8:11], v[40:43]
    v_mfma_f32_16x16x32_bf16 v[44:47], v[180:183], v[12:15], v[44:47]
    v_mfma_f32_16x16x32_bf16 v[48:51], v[180:183], v[16:19], v[48:51]
    v_mfma_f32_16x16x32_bf16 v[52:55], v[180:183], v[20:23], v[52:55]
    v_mfma_f32_16x16x32_bf16 v[56:59], v[180:183], v[24:27], v[56:59]
    v_mfma_f32_16x16x32_bf16 v[60:63], v[180:183], v[28:31], v[60:63]
    v_mfma_f32_16x16x32_bf16 v[32:35], v[212:215], v[0:3], v[32:35]
    v_mfma_f32_16x16x32_bf16 v[36:39], v[212:215], v[4:7], v[36:39]
    v_mfma_f32_16x16x32_bf16 v[40:43], v[212:215], v[8:11], v[40:43]
    v_mfma_f32_16x16x32_bf16 v[44:47], v[212:215], v[12:15], v[44:47]
    v_mfma_f32_16x16x32_bf16 v[48:51], v[212:215], v[16:19], v[48:51]
    v_mfma_f32_16x16x32_bf16 v[52:55], v[212:215], v[20:23], v[52:55]
    v_mfma_f32_16x16x32_bf16 v[56:59], v[212:215], v[24:27], v[56:59]
    v_mfma_f32_16x16x32_bf16 v[60:63], v[212:215], v[28:31], v[60:63]
    s_setprio 0
    s_nop 7
    v_cvt_pk_bf16_f32 v240, v32, v36
    v_cvt_pk_bf16_f32 v241, v40, v44
    v_cvt_pk_bf16_f32 v242, v48, v52
    v_cvt_pk_bf16_f32 v243, v56, v60
    buffer_store_dwordx4 v[240:243], v249, s[12:15], s39 offen sc1
    s_add_u32 s39, s39, 2736128
    v_cvt_pk_bf16_f32 v244, v33, v37
    v_cvt_pk_bf16_f32 v245, v41, v45
    v_cvt_pk_bf16_f32 v246, v49, v53
    v_cvt_pk_bf16_f32 v247, v57, v61
    buffer_store_dwordx4 v[244:247], v249, s[12:15], s39 offen sc1
    s_add_u32 s39, s39, 2736128
    v_cvt_pk_bf16_f32 v240, v34, v38
    v_cvt_pk_bf16_f32 v241, v42, v46
    v_cvt_pk_bf16_f32 v242, v50, v54
    v_cvt_pk_bf16_f32 v243, v58, v62
    buffer_store_dwordx4 v[240:243], v249, s[12:15], s39 offen sc1
    s_add_u32 s39, s39, 2736128
    v_cvt_pk_bf16_f32 v244, v35, v39
    v_cvt_pk_bf16_f32 v245, v43, v47
    v_cvt_pk_bf16_f32 v246, v51, v55
    v_cvt_pk_bf16_f32 v247, v59, v63
    buffer_store_dwordx4 v[244:247], v249, s[12:15], s39 offen sc1
    s_add_u32 s39, s39, 2736128
    s_cmp_lt_u32 s40, 4
    s_cbranch_scc1 K12_UT8
    s_lshl_b32 s36, s40, 3
    s_sub_i32 s36, s36, 18
    s_max_i32 s36, s36, 1
    s_mov_b32 s37, 131072
K12_UL8:
    v_mov_b32 v255, 155648
    ds_read_b32 v255, v255
    s_waitcnt lgkmcnt(0)
    v_cmp_gt_u32 vcc, s36, v255
    s_sub_u32 s37, s37, 1
    s_cmp_eq_u32 s37, 0
    s_cbranch_scc1 K12_UT8
    s_cbranch_vccz K12_UT8
    s_sleep 2
    s_branch K12_UL8
K12_UT8:
    s_setprio 1
    v_mfma_f32_16x16x32_bf16 v[32:35], v[184:187], v[64:67], 0
    v_mfma_f32_16x16x32_bf16 v[36:39], v[184:187], v[68:71], 0
    v_mfma_f32_16x16x32_bf16 v[40:43], v[184:187], v[72:75], 0
    v_mfma_f32_16x16x32_bf16 v[44:47], v[184:187], v[76:79], 0
    v_mfma_f32_16x16x32_bf16 v[48:51], v[184:187], v[80:83], 0
    v_mfma_f32_16x16x32_bf16 v[52:55], v[184:187], v[84:87], 0
    v_mfma_f32_16x16x32_bf16 v[56:59], v[184:187], v[88:91], 0
    v_mfma_f32_16x16x32_bf16 v[60:63], v[184:187], v[92:95], 0
    v_mfma_f32_16x16x32_bf16 v[32:35], v[216:219], v[64:67], v[32:35]
    v_mfma_f32_16x16x32_bf16 v[36:39], v[216:219], v[68:71], v[36:39]
    v_mfma_f32_16x16x32_bf16 v[40:43], v[216:219], v[72:75], v[40:43]
    v_mfma_f32_16x16x32_bf16 v[44:47], v[216:219], v[76:79], v[44:47]
    v_mfma_f32_16x16x32_bf16 v[48:51], v[216:219], v[80:83], v[48:51]
    v_mfma_f32_16x16x32_bf16 v[52:55], v[216:219], v[84:87], v[52:55]
    v_mfma_f32_16x16x32_bf16 v[56:59], v[216:219], v[88:91], v[56:59]
    v_mfma_f32_16x16x32_bf16 v[60:63], v[216:219], v[92:95], v[60:63]
    v_mfma_f32_16x16x32_bf16 v[32:35], v[188:191], v[0:3], v[32:35]
    v_mfma_f32_16x16x32_bf16 v[36:39], v[188:191], v[4:7], v[36:39]
    v_mfma_f32_16x16x32_bf16 v[40:43], v[188:191], v[8:11], v[40:43]
    v_mfma_f32_16x16x32_bf16 v[44:47], v[188:191], v[12:15], v[44:47]
    v_mfma_f32_16x16x32_bf16 v[48:51], v[188:191], v[16:19], v[48:51]
    v_mfma_f32_16x16x32_bf16 v[52:55], v[188:191], v[20:23], v[52:55]
    v_mfma_f32_16x16x32_bf16 v[56:59], v[188:191], v[24:27], v[56:59]
    v_mfma_f32_16x16x32_bf16 v[60:63], v[188:191], v[28:31], v[60:63]
    v_mfma_f32_16x16x32_bf16 v[32:35], v[220:223], v[0:3], v[32:35]
    v_mfma_f32_16x16x32_bf16 v[36:39], v[220:223], v[4:7], v[36:39]
    v_mfma_f32_16x16x32_bf16 v[40:43], v[220:223], v[8:11], v[40:43]
    v_mfma_f32_16x16x32_bf16 v[44:47], v[220:223], v[12:15], v[44:47]
    v_mfma_f32_16x16x32_bf16 v[48:51], v[220:223], v[16:19], v[48:51]
    v_mfma_f32_16x16x32_bf16 v[52:55], v[220:223], v[20:23], v[52:55]
    v_mfma_f32_16x16x32_bf16 v[56:59], v[220:223], v[24:27], v[56:59]
    v_mfma_f32_16x16x32_bf16 v[60:63], v[220:223], v[28:31], v[60:63]
    s_setprio 0
    s_nop 7
    v_cvt_pk_bf16_f32 v240, v32, v36
    v_cvt_pk_bf16_f32 v241, v40, v44
    v_cvt_pk_bf16_f32 v242, v48, v52
    v_cvt_pk_bf16_f32 v243, v56, v60
    buffer_store_dwordx4 v[240:243], v249, s[12:15], s39 offen sc1
    s_add_u32 s39, s39, 2736128
    v_cvt_pk_bf16_f32 v244, v33, v37
    v_cvt_pk_bf16_f32 v245, v41, v45
    v_cvt_pk_bf16_f32 v246, v49, v53
    v_cvt_pk_bf16_f32 v247, v57, v61
    buffer_store_dwordx4 v[244:247], v249, s[12:15], s39 offen sc1
    s_add_u32 s39, s39, 2736128
    v_cvt_pk_bf16_f32 v240, v34, v38
    v_cvt_pk_bf16_f32 v241, v42, v46
    v_cvt_pk_bf16_f32 v242, v50, v54
    v_cvt_pk_bf16_f32 v243, v58, v62
    buffer_store_dwordx4 v[240:243], v249, s[12:15], s39 offen sc1
    s_add_u32 s39, s39, 2736128
    v_cvt_pk_bf16_f32 v244, v35, v39
    v_cvt_pk_bf16_f32 v245, v43, v47
    v_cvt_pk_bf16_f32 v246, v51, v55
    v_cvt_pk_bf16_f32 v247, v59, v63
    buffer_store_dwordx4 v[244:247], v249, s[12:15], s39 offen sc1
    s_mov_b32 s41, s40
    s_add_u32 s40, s40, 1
    s_cmp_eq_u32 s41, 3
    s_cbranch_scc0 K12_ES5
    s_waitcnt vmcnt(0)
    s_mov_b32 s34, -1
    s_cmp_ge_u32 s41, 8
    s_cbranch_scc1 K12_SG6
    s_lshl_b32 s36, s41, 2
    s_add_u32 s37, s36, 155680
    s_mov_b64 exec, 1
    v_mov_b32 v255, s37
    v_mov_b32 v240, 1
    ds_add_rtn_u32 v240, v255, v240
    s_waitcnt lgkmcnt(0)
    v_readfirstlane_b32 s37, v240
    s_nop 3
    s_cmp_eq_u32 s37, 3
    s_cbranch_scc0 K12_SH6
    s_lshl_b32 s36, s36, 8
    v_mov_b32 v255, 1
    v_mov_b32 v240, s36
    buffer_atomic_add v255, v240, s[60:63], 0 offen sc0 sc1
    s_mov_b32 s34, s41
K12_SH6:
    s_mov_b64 exec, -1
K12_SG6:
    s_waitcnt vmcnt(0)
    s_cmp_ge_u32 s34, 8
    s_cbranch_scc1 K12_PB7
    v_readfirstlane_b32 s37, v255
    s_nop 3
    s_cmp_eq_u32 s37, 255
    s_cbranch_scc0 K12_PB7
    s_lshl_b32 s36, s34, 4
    s_add_u32 s36, s36, 16384
    s_mov_b64 exec, 1
    v_mov_b32 v255, 1
    v_mov_b32 v240, s36
    buffer_store_dword v255, v240, s[60:63], 0 offen sc1
    s_mov_b64 exec, -1
K12_PB7:
    s_mov_b32 s34, -1
    s_mov_b32 s41, -1
K12_ES5:
    s_waitcnt vmcnt(16)
    s_branch K12_XP_F
K12_XP_E:
    s_mov_b32 s41, s40
    s_add_u32 s40, s40, 1
    s_cmp_eq_u32 s41, 3
    s_cbranch_scc0 K12_ES8
    s_waitcnt vmcnt(0)
    s_mov_b32 s34, -1
    s_cmp_ge_u32 s41, 8
    s_cbranch_scc1 K12_SG9
    s_lshl_b32 s36, s41, 2
    s_add_u32 s37, s36, 155680
    s_mov_b64 exec, 1
    v_mov_b32 v255, s37
    v_mov_b32 v240, 1
    ds_add_rtn_u32 v240, v255, v240
    s_waitcnt lgkmcnt(0)
    v_readfirstlane_b32 s37, v240
    s_nop 3
    s_cmp_eq_u32 s37, 3
    s_cbranch_scc0 K12_SH9
    s_lshl_b32 s36, s36, 8
    v_mov_b32 v255, 1
    v_mov_b32 v240, s36
    buffer_atomic_add v255, v240, s[60:63], 0 offen sc0 sc1
    s_mov_b32 s34, s41
K12_SH9:
    s_mov_b64 exec, -1
K12_SG9:
    s_waitcnt vmcnt(0)
    s_cmp_ge_u32 s34, 8
    s_cbranch_scc1 K12_PB10
    v_readfirstlane_b32 s37, v255
    s_nop 3
    s_cmp_eq_u32 s37, 255
    s_cbranch_scc0 K12_PB10
    s_lshl_b32 s36, s34, 4
    s_add_u32 s36, s36, 16384
    s_mov_b64 exec, 1
    v_mov_b32 v255, 1
    v_mov_b32 v240, s36
    buffer_store_dword v255, v240, s[60:63], 0 offen sc1
    s_mov_b64 exec, -1
K12_PB10:
    s_mov_b32 s34, -1
    s_mov_b32 s41, -1
K12_ES8:
    s_waitcnt vmcnt(0)
K12_XP_F:
    s_cmp_ge_u32 s34, 8
    s_cbranch_scc1 K12_PB11
    v_readfirstlane_b32 s37, v255
    s_nop 3
    s_cmp_eq_u32 s37, 255
    s_cbranch_scc0 K12_PB11
    s_lshl_b32 s36, s34, 4
    s_add_u32 s36, s36, 16384
    s_mov_b64 exec, 1
    v_mov_b32 v255, 1
    v_mov_b32 v240, s36
    buffer_store_dword v255, v240, s[60:63], 0 offen sc1
    s_mov_b64 exec, -1
K12_PB11:
    s_cmp_ge_u32 s40, 8
    s_cbranch_scc1 K12_PFIN
K12_WENTRY:
    s_waitcnt vmcnt(0)
    s_mov_b32 s34, -1
    s_cmp_ge_u32 s41, 8
    s_cbranch_scc1 K12_SG12
    s_lshl_b32 s36, s41, 2
    s_add_u32 s37, s36, 155680
    s_mov_b64 exec, 1
    v_mov_b32 v255, s37
    v_mov_b32 v240, 1
    ds_add_rtn_u32 v240, v255, v240
    s_waitcnt lgkmcnt(0)
    v_readfirstlane_b32 s37, v240
    s_nop 3
    s_cmp_eq_u32 s37, 3
    s_cbranch_scc0 K12_SH12
    s_lshl_b32 s36, s36, 8
    v_mov_b32 v255, 1
    v_mov_b32 v240, s36
    buffer_atomic_add v255, v240, s[60:63], 0 offen sc0 sc1
    s_mov_b32 s34, s41
K12_SH12:
    s_mov_b64 exec, -1
K12_SG12:
    s_cmp_ge_u32 s34, 8
    s_cbranch_scc1 K12_EP13
    s_waitcnt vmcnt(0)
    s_cmp_ge_u32 s34, 8
    s_cbranch_scc1 K12_PB14
    v_readfirstlane_b32 s37, v255
    s_nop 3
    s_cmp_eq_u32 s37, 255
    s_cbranch_scc0 K12_PB14
    s_lshl_b32 s36, s34, 4
    s_add_u32 s36, s36, 16384
    s_mov_b64 exec, 1
    v_mov_b32 v255, 1
    v_mov_b32 v240, s36
    buffer_store_dword v255, v240, s[60:63], 0 offen sc1
    s_mov_b64 exec, -1
K12_PB14:
    s_mov_b32 s34, -1
K12_EP13:
    v_perm_b32 v64, v100, v96, s28
    v_perm_b32 v68, v100, v96, s29
    v_perm_b32 v65, v108, v104, s28
    v_perm_b32 v69, v108, v104, s29
    v_perm_b32 v66, v116, v112, s28
    v_perm_b32 v70, v116, v112, s29
    v_perm_b32 v67, v124, v120, s28
    v_perm_b32 v71, v124, v120, s29
    v_perm_b32 v72, v101, v97, s28
    v_perm_b32 v76, v101, v97, s29
    v_perm_b32 v73, v109, v105, s28
    v_perm_b32 v77, v109, v105, s29
    v_perm_b32 v74, v117, v113, s28
    v_perm_b32 v78, v117, v113, s29
    v_perm_b32 v75, v125, v121, s28
    v_perm_b32 v79, v125, v121, s29
    v_perm_b32 v80, v102, v98, s28
    v_perm_b32 v84, v102, v98, s29
    v_perm_b32 v81, v110, v106, s28
    v_perm_b32 v85, v110, v106, s29
    v_perm_b32 v82, v118, v114, s28
    v_perm_b32 v86, v118, v114, s29
    v_perm_b32 v83, v126, v122, s28
    v_perm_b32 v87, v126, v122, s29
    v_perm_b32 v88, v103, v99, s28
    v_perm_b32 v92, v103, v99, s29
    v_perm_b32 v89, v111, v107, s28
    v_perm_b32 v93, v111, v107, s29
    v_perm_b32 v90, v119, v115, s28
    v_perm_b32 v94, v119, v115, s29
    v_perm_b32 v91, v127, v123, s28
    v_perm_b32 v95, v127, v123, s29
    s_lshl_b32 s36, s40, 3
    s_sub_i32 s36, s36, 24
    s_max_i32 s36, s36, 1
    s_mov_b32 s37, 131072
K12_GL1:
    v_mov_b32 v240, 155648
    ds_read_b32 v240, v240
    s_waitcnt lgkmcnt(0)
    v_cmp_gt_u32 vcc, s36, v240
    s_sub_u32 s37, s37, 1
    s_cmp_eq_u32 s37, 0
    s_cbranch_scc1 K12_GT1
    s_cbranch_vccz K12_GT1
    s_sleep 2
    s_branch K12_GL1
K12_GT1:
    s_lshl_b32 s36, s40, 2
    s_add_u32 s36, s36, 155840
    s_mov_b64 exec, 1
    v_mov_b32 v240, s36
    v_mov_b32 v241, 1
    ds_add_u32 v240, v241
    s_mov_b64 exec, -1
    s_mov_b32 s37, 131072
K12_BL1:
    v_mov_b32 v240, s36
    ds_read_b32 v240, v240
    s_waitcnt lgkmcnt(0)
    v_cmp_gt_u32 vcc, 4, v240
    s_sub_u32 s37, s37, 1
    s_cmp_eq_u32 s37, 0
    s_cbranch_scc1 K12_BT1
    s_cbranch_vccz K12_BT1
    s_sleep 1
    s_branch K12_BL1
K12_BT1:
    s_add_u32 s42, s40, 1
    s_mul_i32 s36, s42, 85
    s_add_u32 s36, s36, s2
    s_and_b32 s36, s36, 255
    s_mul_hi_u32 s37, s36, 0x55555556
    s_mul_i32 s38, s37, 3
    s_cmp_eq_u32 s38, s36
    s_cselect_b32 s27, 1, 0
    s_cmp_lt_u32 s37, 78
    s_cselect_b32 s27, s27, 0
    s_add_u32 s37, s37, 89
    s_cmp_eq_u32 s21, 0
    s_cselect_b32 s30, s24, s37
    s_cselect_b32 s27, 1, s27
    s_cmp_eq_u32 s27, 0
    s_cbranch_scc1 K12_WP_N
    s_lshl_b32 s36, s42, 8
    s_mul_i32 s37, s30, 98304
    s_add_u32 s36, s36, s37
    buffer_load_dwordx4 v[0:3], v248, s[4:7], s36 offen
    buffer_load_dwordx4 v[4:7], v248, s[4:7], s36 offen offset:2048
    s_add_u32 s36, s36, 4096
    buffer_load_dwordx4 v[8:11], v248, s[4:7], s36 offen
    buffer_load_dwordx4 v[12:15], v248, s[4:7], s36 offen offset:2048
    s_add_u32 s36, s36, 4096
    buffer_load_dwordx4 v[16:19], v248, s[4:7], s36 offen
    buffer_load_dwordx4 v[20:23], v248, s[4:7], s36 offen offset:2048
    s_add_u32 s36, s36, 4096
    buffer_load_dwordx4 v[24:27], v248, s[4:7], s36 offen
    buffer_load_dwordx4 v[28:31], v248, s[4:7], s36 offen offset:2048
    s_add_u32 s36, s36, 53248
    buffer_load_dwordx4 v[32:35], v248, s[4:7], s36 offen
    buffer_load_dwordx4 v[36:39], v248, s[4:7], s36 offen offset:2048
    s_add_u32 s36, s36, 4096
    buffer_load_dwordx4 v[40:43], v248, s[4:7], s36 offen
    buffer_load_dwordx4 v[44:47], v248, s[4:7], s36 offen offset:2048
    s_add_u32 s36, s36, 4096
    buffer_load_dwordx4 v[48:51], v248, s[4:7], s36 offen
    buffer_load_dwordx4 v[52:55], v248, s[4:7], s36 offen offset:2048
    s_add_u32 s36, s36, 4096
    buffer_load_dwordx4 v[56:59], v248, s[4:7], s36 offen
    buffer_load_dwordx4 v[60:63], v248, s[4:7], s36 offen offset:2048
    s_branch K12_WP_M
K12_WP_N:
K12_WP_M:
    s_lshl_b32 s36, s40, 7
    s_add_u32 s36, s36, s22
    s_and_b32 s37, s36, 3
    s_lshr_b32 s38, s36, 1
    s_and_b32 s38, s38, 4
    s_or_b32 s37, s37, s38
    v_bfe_u32 v253, v254, 5, 3
    v_xor_b32 v253, s37, v253
    v_lshl_add_u32 v253, v253, 5, v251
    s_lshl_b32 s36, s36, 9
    s_add_u32 s39, s36, s32
    s_setprio 1
    v_mfma_f32_16x16x32_bf16 v[128:131], v[224:227], v[64:67], 0
    v_mfma_f32_16x16x32_bf16 v[132:135], v[224:227], v[68:71], 0
    v_mfma_f32_16x16x32_bf16 v[136:139], v[224:227], v[72:75], 0
    v_mfma_f32_16x16x32_bf16 v[140:143], v[224:227], v[76:79], 0
    v_mfma_f32_16x16x32_bf16 v[144:147], v[224:227], v[80:83], 0
    v_mfma_f32_16x16x32_bf16 v[148:151], v[224:227], v[84:87], 0
    v_mfma_f32_16x16x32_bf16 v[152:155], v[224:227], v[88:91], 0
    v_mfma_f32_16x16x32_bf16 v[156:159], v[224:227], v[92:95], 0
    s_setprio 0
    s_nop 7
    v_cvt_pk_bf16_f32 v240, v128, v132
    v_cvt_pk_bf16_f32 v241, v136, v140
    v_cvt_pk_bf16_f32 v242, v144, v148
    v_cvt_pk_bf16_f32 v243, v152, v156
    buffer_store_dwordx4 v[240:243], v253, s[16:19], s39 offen sc1
    s_add_u32 s39, s39, 4194304
    v_cvt_pk_bf16_f32 v244, v129, v133
    v_cvt_pk_bf16_f32 v245, v137, v141
    v_cvt_pk_bf16_f32 v246, v145, v149
    v_cvt_pk_bf16_f32 v247, v153, v157
    buffer_store_dwordx4 v[244:247], v253, s[16:19], s39 offen sc1
    s_add_u32 s39, s39, 4194304
    v_cvt_pk_bf16_f32 v240, v130, v134
    v_cvt_pk_bf16_f32 v241, v138, v142
    v_cvt_pk_bf16_f32 v242, v146, v150
    v_cvt_pk_bf16_f32 v243, v154, v158
    buffer_store_dwordx4 v[240:243], v253, s[16:19], s39 offen sc1
    s_add_u32 s39, s39, 4194304
    v_cvt_pk_bf16_f32 v244, v131, v135
    v_cvt_pk_bf16_f32 v245, v139, v143
    v_cvt_pk_bf16_f32 v246, v147, v151
    v_cvt_pk_bf16_f32 v247, v155, v159
    buffer_store_dwordx4 v[244:247], v253, s[16:19], s39 offen sc1
    s_add_u32 s39, s39, 4194304
    s_cmp_lt_u32 s40, 4
    s_cbranch_scc1 K12_UT9
    s_lshl_b32 s36, s40, 3
    s_sub_i32 s36, s36, 22
    s_max_i32 s36, s36, 1
    s_mov_b32 s37, 131072
K12_UL9:
    v_mov_b32 v255, 155648
    ds_read_b32 v255, v255
    s_waitcnt lgkmcnt(0)
    v_cmp_gt_u32 vcc, s36, v255
    s_sub_u32 s37, s37, 1
    s_cmp_eq_u32 s37, 0
    s_cbranch_scc1 K12_UT9
    s_cbranch_vccz K12_UT9
    s_sleep 2
    s_branch K12_UL9
K12_UT9:
    s_setprio 1
    v_mfma_f32_16x16x32_bf16 v[128:131], v[228:231], v[64:67], 0
    v_mfma_f32_16x16x32_bf16 v[132:135], v[228:231], v[68:71], 0
    v_mfma_f32_16x16x32_bf16 v[136:139], v[228:231], v[72:75], 0
    v_mfma_f32_16x16x32_bf16 v[140:143], v[228:231], v[76:79], 0
    v_mfma_f32_16x16x32_bf16 v[144:147], v[228:231], v[80:83], 0
    v_mfma_f32_16x16x32_bf16 v[148:151], v[228:231], v[84:87], 0
    v_mfma_f32_16x16x32_bf16 v[152:155], v[228:231], v[88:91], 0
    v_mfma_f32_16x16x32_bf16 v[156:159], v[228:231], v[92:95], 0
    s_setprio 0
    s_nop 7
    v_cvt_pk_bf16_f32 v240, v128, v132
    v_cvt_pk_bf16_f32 v241, v136, v140
    v_cvt_pk_bf16_f32 v242, v144, v148
    v_cvt_pk_bf16_f32 v243, v152, v156
    buffer_store_dwordx4 v[240:243], v253, s[16:19], s39 offen sc1
    s_add_u32 s39, s39, 4194304
    v_cvt_pk_bf16_f32 v244, v129, v133
    v_cvt_pk_bf16_f32 v245, v137, v141
    v_cvt_pk_bf16_f32 v246, v145, v149
    v_cvt_pk_bf16_f32 v247, v153, v157
    buffer_store_dwordx4 v[244:247], v253, s[16:19], s39 offen sc1
    s_add_u32 s39, s39, 4194304
    v_cvt_pk_bf16_f32 v240, v130, v134
    v_cvt_pk_bf16_f32 v241, v138, v142
    v_cvt_pk_bf16_f32 v242, v146, v150
    v_cvt_pk_bf16_f32 v243, v154, v158
    buffer_store_dwordx4 v[240:243], v253, s[16:19], s39 offen sc1
    s_add_u32 s39, s39, 4194304
    v_cvt_pk_bf16_f32 v244, v131, v135
    v_cvt_pk_bf16_f32 v245, v139, v143
    v_cvt_pk_bf16_f32 v246, v147, v151
    v_cvt_pk_bf16_f32 v247, v155, v159
    buffer_store_dwordx4 v[244:247], v253, s[16:19], s39 offen sc1
    s_add_u32 s39, s39, 4194304
    s_cmp_lt_u32 s40, 4
    s_cbranch_scc1 K12_UT10
    s_lshl_b32 s36, s40, 3
    s_sub_i32 s36, s36, 20
    s_max_i32 s36, s36, 1
    s_mov_b32 s37, 131072
K12_UL10:
    v_mov_b32 v255, 155648
    ds_read_b32 v255, v255
    s_waitcnt lgkmcnt(0)
    v_cmp_gt_u32 vcc, s36, v255
    s_sub_u32 s37, s37, 1
    s_cmp_eq_u32 s37, 0
    s_cbranch_scc1 K12_UT10
    s_cbranch_vccz K12_UT10
    s_sleep 2
    s_branch K12_UL10
K12_UT10:
    s_setprio 1
    v_mfma_f32_16x16x32_bf16 v[128:131], v[232:235], v[64:67], 0
    v_mfma_f32_16x16x32_bf16 v[132:135], v[232:235], v[68:71], 0
    v_mfma_f32_16x16x32_bf16 v[136:139], v[232:235], v[72:75], 0
    v_mfma_f32_16x16x32_bf16 v[140:143], v[232:235], v[76:79], 0
    v_mfma_f32_16x16x32_bf16 v[144:147], v[232:235], v[80:83], 0
    v_mfma_f32_16x16x32_bf16 v[148:151], v[232:235], v[84:87], 0
    v_mfma_f32_16x16x32_bf16 v[152:155], v[232:235], v[88:91], 0
    v_mfma_f32_16x16x32_bf16 v[156:159], v[232:235], v[92:95], 0
    s_setprio 0
    s_nop 7
    v_cvt_pk_bf16_f32 v240, v128, v132
    v_cvt_pk_bf16_f32 v241, v136, v140
    v_cvt_pk_bf16_f32 v242, v144, v148
    v_cvt_pk_bf16_f32 v243, v152, v156
    buffer_store_dwordx4 v[240:243], v253, s[16:19], s39 offen sc1
    s_add_u32 s39, s39, 4194304
    v_cvt_pk_bf16_f32 v244, v129, v133
    v_cvt_pk_bf16_f32 v245, v137, v141
    v_cvt_pk_bf16_f32 v246, v145, v149
    v_cvt_pk_bf16_f32 v247, v153, v157
    buffer_store_dwordx4 v[244:247], v253, s[16:19], s39 offen sc1
    s_add_u32 s39, s39, 4194304
    v_cvt_pk_bf16_f32 v240, v130, v134
    v_cvt_pk_bf16_f32 v241, v138, v142
    v_cvt_pk_bf16_f32 v242, v146, v150
    v_cvt_pk_bf16_f32 v243, v154, v158
    buffer_store_dwordx4 v[240:243], v253, s[16:19], s39 offen sc1
    s_add_u32 s39, s39, 4194304
    v_cvt_pk_bf16_f32 v244, v131, v135
    v_cvt_pk_bf16_f32 v245, v139, v143
    v_cvt_pk_bf16_f32 v246, v147, v151
    v_cvt_pk_bf16_f32 v247, v155, v159
    buffer_store_dwordx4 v[244:247], v253, s[16:19], s39 offen sc1
    s_add_u32 s39, s39, 4194304
    s_cmp_lt_u32 s40, 4
    s_cbranch_scc1 K12_UT11
    s_lshl_b32 s36, s40, 3
    s_sub_i32 s36, s36, 18
    s_max_i32 s36, s36, 1
    s_mov_b32 s37, 131072
K12_UL11:
    v_mov_b32 v255, 155648
    ds_read_b32 v255, v255
    s_waitcnt lgkmcnt(0)
    v_cmp_gt_u32 vcc, s36, v255
    s_sub_u32 s37, s37, 1
    s_cmp_eq_u32 s37, 0
    s_cbranch_scc1 K12_UT11
    s_cbranch_vccz K12_UT11
    s_sleep 2
    s_branch K12_UL11
K12_UT11:
    s_setprio 1
    v_mfma_f32_16x16x32_bf16 v[128:131], v[236:239], v[64:67], 0
    v_mfma_f32_16x16x32_bf16 v[132:135], v[236:239], v[68:71], 0
    v_mfma_f32_16x16x32_bf16 v[136:139], v[236:239], v[72:75], 0
    v_mfma_f32_16x16x32_bf16 v[140:143], v[236:239], v[76:79], 0
    v_mfma_f32_16x16x32_bf16 v[144:147], v[236:239], v[80:83], 0
    v_mfma_f32_16x16x32_bf16 v[148:151], v[236:239], v[84:87], 0
    v_mfma_f32_16x16x32_bf16 v[152:155], v[236:239], v[88:91], 0
    v_mfma_f32_16x16x32_bf16 v[156:159], v[236:239], v[92:95], 0
    s_setprio 0
    s_nop 7
    v_cvt_pk_bf16_f32 v240, v128, v132
    v_cvt_pk_bf16_f32 v241, v136, v140
    v_cvt_pk_bf16_f32 v242, v144, v148
    v_cvt_pk_bf16_f32 v243, v152, v156
    buffer_store_dwordx4 v[240:243], v253, s[16:19], s39 offen sc1
    s_add_u32 s39, s39, 4194304
    v_cvt_pk_bf16_f32 v244, v129, v133
    v_cvt_pk_bf16_f32 v245, v137, v141
    v_cvt_pk_bf16_f32 v246, v145, v149
    v_cvt_pk_bf16_f32 v247, v153, v157
    buffer_store_dwordx4 v[244:247], v253, s[16:19], s39 offen sc1
    s_add_u32 s39, s39, 4194304
    v_cvt_pk_bf16_f32 v240, v130, v134
    v_cvt_pk_bf16_f32 v241, v138, v142
    v_cvt_pk_bf16_f32 v242, v146, v150
    v_cvt_pk_bf16_f32 v243, v154, v158
    buffer_store_dwordx4 v[240:243], v253, s[16:19], s39 offen sc1
    s_add_u32 s39, s39, 4194304
    v_cvt_pk_bf16_f32 v244, v131, v135
    v_cvt_pk_bf16_f32 v245, v139, v143
    v_cvt_pk_bf16_f32 v246, v147, v151
    v_cvt_pk_bf16_f32 v247, v155, v159
    buffer_store_dwordx4 v[244:247], v253, s[16:19], s39 offen sc1
    s_mov_b32 s41, s40
    s_add_u32 s40, s40, 1
    s_cmp_eq_u32 s41, 3
    s_cbranch_scc0 K12_ES15
    s_waitcnt vmcnt(0)
    s_mov_b32 s34, -1
    s_cmp_ge_u32 s41, 8
    s_cbranch_scc1 K12_SG16
    s_lshl_b32 s36, s41, 2
    s_add_u32 s37, s36, 155680
    s_mov_b64 exec, 1
    v_mov_b32 v255, s37
    v_mov_b32 v240, 1
    ds_add_rtn_u32 v240, v255, v240
    s_waitcnt lgkmcnt(0)
    v_readfirstlane_b32 s37, v240
    s_nop 3
    s_cmp_eq_u32 s37, 3
    s_cbranch_scc0 K12_SH16
    s_lshl_b32 s36, s36, 8
    v_mov_b32 v255, 1
    v_mov_b32 v240, s36
    buffer_atomic_add v255, v240, s[60:63], 0 offen sc0 sc1
    s_mov_b32 s34, s41
K12_SH16:
    s_mov_b64 exec, -1
K12_SG16:
    s_waitcnt vmcnt(0)
    s_cmp_ge_u32 s34, 8
    s_cbranch_scc1 K12_PB17
    v_readfirstlane_b32 s37, v255
    s_nop 3
    s_cmp_eq_u32 s37, 255
    s_cbranch_scc0 K12_PB17
    s_lshl_b32 s36, s34, 4
    s_add_u32 s36, s36, 16384
    s_mov_b64 exec, 1
    v_mov_b32 v255, 1
    v_mov_b32 v240, s36
    buffer_store_dword v255, v240, s[60:63], 0 offen sc1
    s_mov_b64 exec, -1
K12_PB17:
    s_mov_b32 s34, -1
    s_mov_b32 s41, -1
K12_ES15:
    s_waitcnt vmcnt(16)
    s_cmp_ge_u32 s34, 8
    s_cbranch_scc1 K12_PB18
    v_readfirstlane_b32 s37, v255
    s_nop 3
    s_cmp_eq_u32 s37, 255
    s_cbranch_scc0 K12_PB18
    s_lshl_b32 s36, s34, 4
    s_add_u32 s36, s36, 16384
    s_mov_b64 exec, 1
    v_mov_b32 v255, 1
    v_mov_b32 v240, s36
    buffer_store_dword v255, v240, s[60:63], 0 offen sc1
    s_mov_b64 exec, -1
K12_PB18:
    s_cmp_lt_u32 s40, 8
    s_cbranch_scc1 K12_XW
K12_PFIN:
    s_waitcnt vmcnt(0)
    s_mov_b32 s34, -1
    s_cmp_ge_u32 s41, 8
    s_cbranch_scc1 K12_SG19
    s_lshl_b32 s36, s41, 2
    s_add_u32 s37, s36, 155680
    s_mov_b64 exec, 1
    v_mov_b32 v255, s37
    v_mov_b32 v240, 1
    ds_add_rtn_u32 v240, v255, v240
    s_waitcnt lgkmcnt(0)
    v_readfirstlane_b32 s37, v240
    s_nop 3
    s_cmp_eq_u32 s37, 3
    s_cbranch_scc0 K12_SH19
    s_lshl_b32 s36, s36, 8
    v_mov_b32 v255, 1
    v_mov_b32 v240, s36
    buffer_atomic_add v255, v240, s[60:63], 0 offen sc0 sc1
    s_mov_b32 s34, s41
K12_SH19:
    s_mov_b64 exec, -1
K12_SG19:
    s_waitcnt vmcnt(0)
    s_cmp_ge_u32 s34, 8
    s_cbranch_scc1 K12_PB20
    v_readfirstlane_b32 s37, v255
    s_nop 3
    s_cmp_eq_u32 s37, 255
    s_cbranch_scc0 K12_PB20
    s_lshl_b32 s36, s34, 4
    s_add_u32 s36, s36, 16384
    s_mov_b64 exec, 1
    v_mov_b32 v255, 1
    v_mov_b32 v240, s36
    buffer_store_dword v255, v240, s[60:63], 0 offen sc1
    s_mov_b64 exec, -1
K12_PB20:
    s_endpgm
K12_CONS:
    s_and_b32 s6, s2, 7
    s_lshl_b32 s6, s6, 2
    s_lshr_b32 s7, s2, 6
    s_add_u32 s6, s6, s7
    s_mov_b32 s51, s6
    s_mov_b32 s27, s6
    s_lshr_b32 s7, s2, 3
    s_and_b32 s7, s7, 7
    s_lshr_b32 s20, s7, 2
    s_and_b32 s21, s7, 3
    s_lshl_b32 s22, s6, 1
    s_add_u32 s22, s22, s20
    s_lshl_b32 s23, s6, 2
    s_add_u32 s23, s23, s21
    s_mul_i32 s24, s22, 684032
    s_mul_i32 s25, s23, 524288
    s_add_u32 s25, s25, 50331648
    s_mul_i32 s26, s22, 342016
    s_add_u32 s26, s26, 118489088
    s_add_u32 s8, s58, s24
    s_addc_u32 s9, s59, 0
    s_and_b32 s9, s9, 0xffff
    s_mov_b32 s10, 684032
    s_mov_b32 s11, 0x00020000
    s_add_u32 s12, s58, s25
    s_addc_u32 s13, s59, 0
    s_and_b32 s13, s13, 0xffff
    s_mov_b32 s14, 524288
    s_mov_b32 s15, 0x00020000
    s_add_u32 s16, s58, s26
    s_addc_u32 s17, s59, 0
    s_and_b32 s17, s17, 0xffff
    s_mov_b32 s18, 342016
    s_mov_b32 s19, 0x00020000
    s_add_u32 s4, s58, 153108480
    s_addc_u32 s5, s59, 0
    s_and_b32 s5, s5, 0xffff
    s_cmp_eq_u32 s3, 0
    s_cselect_b32 s6, 128, 0
    s_mov_b32 s7, 0x00020000
    s_mov_b32 s46, 155712
    s_cselect_b32 s46, s46, 155776
    s_mov_b32 s47, 155712
    s_cselect_b32 s47, s47, 155744
    s_cselect_b32 s45, 4, 0
    s_mov_b32 s50, s45
    v_and_b32 v8, 15, v2
    v_lshrrev_b32 v9, 4, v2
    v_lshlrev_b32 v1, 4, v2
    s_mul_i32 s30, s3, 5120
    s_mov_b32 s36, s30
    s_lshl_b32 s31, s3, 12
    s_add_u32 s37, s31, 22528
    s_lshr_b32 s28, s3, 1
    s_and_b32 s29, s3, 1
    s_lshl_b32 s33, s29, 9
    s_add_u32 s33, s33, 20480
    s_mul_i32 s38, s28, 896
    s_add_u32 s38, s38, s33
    s_lshl_b32 s34, s51, 1
    s_add_u32 s34, s34, s28
    s_mul_i32 s34, s34, 684032
    s_add_u32 s64, s58, s34
    s_addc_u32 s65, s59, 0
    s_and_b32 s65, s65, 0xffff
    s_mov_b32 s66, 684032
    s_mov_b32 s67, 0x00020000
    s_mov_b32 s44, 0xffffff
    s_cmp_eq_u32 s29, 0
    s_cselect_b32 s44, -1, s44
    s_mov_b32 s45, 0
    v_lshrrev_b32 v10, 1, v8
    v_xor_b32 v10, v10, v9
    v_lshlrev_b32 v10, 4, v10
    v_lshl_add_u32 v2, v8, 7, v10
    v_xor_b32 v3, 64, v2
    v_lshrrev_b32 v10, 2, v8
    v_lshl_add_u32 v11, v9, 3, v10
    v_lshlrev_b32 v11, 9, v11
    v_and_b32 v12, 1, v9
    v_lshl_or_b32 v10, v12, 2, v10
    s_lshl_b32 s28, s3, 1
    v_xor_b32 v10, s28, v10
    v_lshl_add_u32 v11, v10, 5, v11
    v_and_b32 v10, 3, v8
    v_lshl_add_u32 v11, v10, 3, v11
    v_add_u32 v4, 22528, v11
    s_lshl_b32 s28, s20, 5
    v_xor_b32 v4, s28, v4
    v_and_b32 v10, 3, v8
    v_lshlrev_b32 v10, 2, v10
    v_add_u32 v5, 155648, v10
    s_lshl_b32 s28, s3, 2
    s_add_u32 s28, s28, 155648
    v_mov_b32 v7, s28
    s_mov_b32 s35, 0x80008000
    s_mov_b32 s62, 0
    s_mov_b32 s63, 0
    s_mov_b32 s39, 0
    s_add_u32 m0, s39, s36
    s_nop 0
    buffer_load_dwordx4 v1, s[8:11], s30 offen sc1 lds
    buffer_load_dwordx4 v1, s[8:11], s30 offen offset:1024 sc1 lds
    buffer_load_dwordx4 v1, s[8:11], s30 offen offset:2048 sc1 lds
    buffer_load_dwordx4 v1, s[8:11], s30 offen offset:3072 sc1 lds
    s_add_u32 m0, m0, 4096
    s_add_u32 s34, s30, 4096
    buffer_load_dwordx4 v1, s[8:11], s34 offen sc1 lds
    s_add_u32 m0, s39, s37
    s_add_u32 s30, s30, 21376
    buffer_load_dwordx4 v1, s[12:15], s31 offen sc1 lds
    buffer_load_dwordx4 v1, s[12:15], s31 offen offset:1024 sc1 lds
    buffer_load_dwordx4 v1, s[12:15], s31 offen offset:2048 sc1 lds
    buffer_load_dwordx4 v1, s[12:15], s31 offen offset:3072 sc1 lds
    s_add_u32 m0, s39, s38
    s_mov_b64 exec, s[44:45]
    buffer_load_dwordx4 v1, s[64:67], s33 offen sc1 lds
    s_mov_b64 exec, -1
    s_add_u32 s31, s31, 16384
    s_add_u32 s33, s33, 21376
    s_add_u32 s39, s39, 38912
    s_add_u32 m0, s39, s36
    s_nop 0
    buffer_load_dwordx4 v1, s[8:11], s30 offen sc1 lds
    buffer_load_dwordx4 v1, s[8:11], s30 offen offset:1024 sc1 lds
    buffer_load_dwordx4 v1, s[8:11], s30 offen offset:2048 sc1 lds
    buffer_load_dwordx4 v1, s[8:11], s30 offen offset:3072 sc1 lds
    s_add_u32 m0, m0, 4096
    s_add_u32 s34, s30, 4096
    buffer_load_dwordx4 v1, s[8:11], s34 offen sc1 lds
    s_add_u32 m0, s39, s37
    s_add_u32 s30, s30, 21376
    buffer_load_dwordx4 v1, s[12:15], s31 offen sc1 lds
    buffer_load_dwordx4 v1, s[12:15], s31 offen offset:1024 sc1 lds
    buffer_load_dwordx4 v1, s[12:15], s31 offen offset:2048 sc1 lds
    buffer_load_dwordx4 v1, s[12:15], s31 offen offset:3072 sc1 lds
    s_add_u32 m0, s39, s38
    s_mov_b64 exec, s[44:45]
    buffer_load_dwordx4 v1, s[64:67], s33 offen sc1 lds
    s_mov_b64 exec, -1
    s_add_u32 s31, s31, 16384
    s_add_u32 s33, s33, 21376
    s_add_u32 s39, s39, 38912
    s_add_u32 m0, s39, s36
    s_nop 0
    buffer_load_dwordx4 v1, s[8:11], s30 offen sc1 lds
    buffer_load_dwordx4 v1, s[8:11], s30 offen offset:1024 sc1 lds
    buffer_load_dwordx4 v1, s[8:11], s30 offen offset:2048 sc1 lds
    buffer_load_dwordx4 v1, s[8:11], s30 offen offset:3072 sc1 lds
    s_add_u32 m0, m0, 4096
    s_add_u32 s34, s30, 4096
    buffer_load_dwordx4 v1, s[8:11], s34 offen sc1 lds
    s_add_u32 m0, s39, s37
    s_add_u32 s30, s30, 21376
    buffer_load_dwordx4 v1, s[12:15], s31 offen sc1 lds
    buffer_load_dwordx4 v1, s[12:15], s31 offen offset:1024 sc1 lds
    buffer_load_dwordx4 v1, s[12:15], s31 offen offset:2048 sc1 lds
    buffer_load_dwordx4 v1, s[12:15], s31 offen offset:3072 sc1 lds
    s_add_u32 m0, s39, s38
    s_mov_b64 exec, s[44:45]
    buffer_load_dwordx4 v1, s[64:67], s33 offen sc1 lds
    s_mov_b64 exec, -1
    s_add_u32 s31, s31, 16384
    s_add_u32 s33, s33, 21376
    s_add_u32 s39, s39, 38912
    s_mov_b32 m0, s46
    s_mov_b64 exec, 0xff
    buffer_load_dword v1, s[4:7], 0 offen sc1 lds
    s_mov_b64 exec, -1
    v_lshrrev_b32 v9, 4, v1
    v_and_b32 v8, 15, v9
    v_lshrrev_b32 v9, 4, v9
    v_and_b32 v10, 3, v8
    v_lshlrev_b32 v10, 2, v10
    v_lshrrev_b32 v12, 3, v8
    v_lshl_add_u32 v10, v12, 1, v10
    s_lshl_b32 s28, s3, 4
    s_add_u32 s28, s28, 1
    v_add_u32 v10, s28, v10
    v_bfe_u32 v11, v8, 2, 1
    v_and_b32 v13, 1, v9
    v_lshlrev_b32 v13, 3, v13
    v_mul_u32_u24 v14, 96, v11
    v_mad_u32_u24 v15, v10, v13, v14
    v_mad_u32_u24 v16, v10, 0, v15
    v_mad_u32_u24 v17, v10, 1, v15
    v_mad_u32_u24 v18, v10, 2, v15
    v_mad_u32_u24 v19, v10, 3, v15
    v_mad_u32_u24 v20, v10, 4, v15
    v_mad_u32_u24 v21, v10, 5, v15
    v_mad_u32_u24 v22, v10, 6, v15
    v_mad_u32_u24 v23, v10, 7, v15
    v_and_b32 v16, 127, v16
    v_and_b32 v17, 127, v17
    v_and_b32 v18, 127, v18
    v_and_b32 v19, 127, v19
    v_and_b32 v20, 127, v20
    v_and_b32 v21, 127, v21
    v_and_b32 v22, 127, v22
    v_and_b32 v23, 127, v23
    v_cvt_f32_u32 v16, v16
    v_cvt_f32_u32 v17, v17
    v_cvt_f32_u32 v18, v18
    v_cvt_f32_u32 v19, v19
    v_cvt_f32_u32 v20, v20
    v_cvt_f32_u32 v21, v21
    v_cvt_f32_u32 v22, v22
    v_cvt_f32_u32 v23, v23
    v_mul_f32 v16, 0x3c000000, v16
    v_mul_f32 v17, 0x3c000000, v17
    v_mul_f32 v18, 0x3c000000, v18
    v_mul_f32 v19, 0x3c000000, v19
    v_mul_f32 v20, 0x3c000000, v20
    v_mul_f32 v21, 0x3c000000, v21
    v_mul_f32 v22, 0x3c000000, v22
    v_mul_f32 v23, 0x3c000000, v23
    v_cos_f32 v16, v16
    v_cos_f32 v17, v17
    v_cos_f32 v18, v18
    v_cos_f32 v19, v19
    v_cos_f32 v20, v20
    v_cos_f32 v21, v21
    v_cos_f32 v22, v22
    v_cos_f32 v23, v23
    s_nop 0
    v_cvt_pk_bf16_f32 v24, v16, v17
    v_cvt_pk_bf16_f32 v25, v18, v19
    v_cvt_pk_bf16_f32 v26, v20, v21
    v_cvt_pk_bf16_f32 v27, v22, v23
    v_lshlrev_b32 v32, 16, v24
    v_and_b32 v33, 0xffff0000, v24
    v_sub_f32 v16, v16, v32
    v_sub_f32 v17, v17, v33
    v_lshlrev_b32 v32, 16, v25
    v_and_b32 v33, 0xffff0000, v25
    v_sub_f32 v18, v18, v32
    v_sub_f32 v19, v19, v33
    v_lshlrev_b32 v32, 16, v26
    v_and_b32 v33, 0xffff0000, v26
    v_sub_f32 v20, v20, v32
    v_sub_f32 v21, v21, v33
    v_lshlrev_b32 v32, 16, v27
    v_and_b32 v33, 0xffff0000, v27
    v_sub_f32 v22, v22, v32
    v_sub_f32 v23, v23, v33
    v_cvt_pk_bf16_f32 v28, v16, v17
    v_cvt_pk_bf16_f32 v29, v18, v19
    v_cvt_pk_bf16_f32 v30, v20, v21
    v_cvt_pk_bf16_f32 v31, v22, v23
    v_cmp_lt_u32 vcc, 1, v9
    s_lshl_b32 s28, s3, 10
    s_add_u32 s28, s28, 133120
    v_add_u32 v14, s28, v1
    v_cndmask_b32 v24, v24, v28, vcc
    v_cndmask_b32 v25, v25, v29, vcc
    v_cndmask_b32 v26, v26, v30, vcc
    v_cndmask_b32 v27, v27, v31, vcc
    ds_write_b128 v14, v[24:27]
    v_mov_b32 v12, 0
    v_mov_b32 v13, 0
    v_mov_b32 v14, 0
    v_mov_b32 v15, 0
    s_mul_i32 s28, s3, 38912
    s_add_u32 s28, s28, 22272
    v_add_u32 v16, s28, v1
    s_mov_b64 exec, 0xffff
    ds_write_b128 v16, v[12:15]
    s_mov_b64 exec, -1
    s_lshl_b32 s28, s3, 2
    s_add_u32 s28, s28, 155648
    v_mov_b32 v16, s28
    ds_write_b32 v16, v12
    s_lshl_b32 s28, s3, 3
    s_add_u32 s28, s28, 155680
    v_mov_b32 v16, s28
    ds_write_b64 v16, v[12:13]
    s_lshl_b32 s28, s3, 3
    s_add_u32 s28, s28, 155712
    v_mov_b32 v16, s28
    ds_write_b64 v16, v[12:13]
    s_lshl_b32 s28, s3, 3
    s_add_u32 s28, s28, 155840
    v_mov_b32 v16, s28
    ds_write_b64 v16, v[12:13]
    v_mov_b32 v16, 155664
    ds_write_b32 v16, v12
    v_mov_b32 v16, 155744
    v_mov_b32 v17, 1
    ds_write_b32 v16, v17
    s_waitcnt lgkmcnt(0)
    s_barrier
    v_mov_b32 v80, 0
    v_mov_b32 v81, 0
    v_mov_b32 v82, 0
    v_mov_b32 v83, 0
    v_mov_b32 v84, 0
    v_mov_b32 v85, 0
    v_mov_b32 v86, 0
    v_mov_b32 v87, 0
    v_mov_b32 v88, 0
    v_mov_b32 v89, 0
    v_mov_b32 v90, 0
    v_mov_b32 v91, 0
    v_mov_b32 v92, 0
    v_mov_b32 v93, 0
    v_mov_b32 v94, 0
    v_mov_b32 v95, 0
    v_mov_b32 v96, 0
    v_mov_b32 v97, 0
    v_mov_b32 v98, 0
    v_mov_b32 v99, 0
    v_mov_b32 v100, 0
    v_mov_b32 v101, 0
    v_mov_b32 v102, 0
    v_mov_b32 v103, 0
    v_mov_b32 v104, 0
    v_mov_b32 v105, 0
    v_mov_b32 v106, 0
    v_mov_b32 v107, 0
    v_mov_b32 v108, 0
    v_mov_b32 v109, 0
    v_mov_b32 v110, 0
    v_mov_b32 v111, 0
    v_mov_b32 v112, 0
    v_mov_b32 v113, 0
    v_mov_b32 v114, 0
    v_mov_b32 v115, 0
    v_mov_b32 v116, 0
    v_mov_b32 v117, 0
    v_mov_b32 v118, 0
    v_mov_b32 v119, 0
    v_mov_b32 v120, 0
    v_mov_b32 v121, 0
    v_mov_b32 v122, 0
    v_mov_b32 v123, 0
    v_mov_b32 v124, 0
    v_mov_b32 v125, 0
    v_mov_b32 v126, 0
    v_mov_b32 v127, 0
    v_mov_b32 v128, 0
    v_mov_b32 v129, 0
    v_mov_b32 v130, 0
    v_mov_b32 v131, 0
    v_mov_b32 v132, 0
    v_mov_b32 v133, 0
    v_mov_b32 v134, 0
    v_mov_b32 v135, 0
    v_mov_b32 v136, 0
    v_mov_b32 v137, 0
    v_mov_b32 v138, 0
    v_mov_b32 v139, 0
    v_mov_b32 v140, 0
    v_mov_b32 v141, 0
    v_mov_b32 v142, 0
    v_mov_b32 v143, 0
    v_mov_b32 v144, 0
    v_mov_b32 v145, 0
    v_mov_b32 v146, 0
    v_mov_b32 v147, 0
    v_mov_b32 v148, 0
    v_mov_b32 v149, 0
    v_mov_b32 v150, 0
    v_mov_b32 v151, 0
    v_mov_b32 v152, 0
    v_mov_b32 v153, 0
    v_mov_b32 v154, 0
    v_mov_b32 v155, 0
    v_mov_b32 v156, 0
    v_mov_b32 v157, 0
    v_mov_b32 v158, 0
    v_mov_b32 v159, 0
    v_mov_b32 v160, 0
    v_mov_b32 v161, 0
    v_mov_b32 v162, 0
    v_mov_b32 v163, 0
    v_mov_b32 v164, 0
    v_mov_b32 v165, 0
    v_mov_b32 v166, 0
    v_mov_b32 v167, 0
    v_mov_b32 v168, 0
    v_mov_b32 v169, 0
    v_mov_b32 v170, 0
    v_mov_b32 v171, 0
    v_mov_b32 v172, 0
    v_mov_b32 v173, 0
    v_mov_b32 v174, 0
    v_mov_b32 v175, 0
    v_mov_b32 v176, 0
    v_mov_b32 v177, 0
    v_mov_b32 v178, 0
    v_mov_b32 v179, 0
    v_mov_b32 v180, 0
    v_mov_b32 v181, 0
    v_mov_b32 v182, 0
    v_mov_b32 v183, 0
    v_mov_b32 v184, 0
    v_mov_b32 v185, 0
    v_mov_b32 v186, 0
    v_mov_b32 v187, 0
    v_mov_b32 v188, 0
    v_mov_b32 v189, 0
    v_mov_b32 v190, 0
    v_mov_b32 v191, 0
    v_mov_b32 v192, 0
    v_mov_b32 v193, 0
    v_mov_b32 v194, 0
    v_mov_b32 v195, 0
    v_mov_b32 v196, 0
    v_mov_b32 v197, 0
    v_mov_b32 v198, 0
    v_mov_b32 v199, 0
    v_mov_b32 v200, 0
    v_mov_b32 v201, 0
    v_mov_b32 v202, 0
    v_mov_b32 v203, 0
    v_mov_b32 v204, 0
    v_mov_b32 v205, 0
    v_mov_b32 v206, 0
    v_mov_b32 v207, 0
    v_mov_b32 v208, 0
    v_mov_b32 v209, 0
    v_mov_b32 v210, 0
    v_mov_b32 v211, 0
    v_mov_b32 v212, 0
    v_mov_b32 v213, 0
    v_mov_b32 v214, 0
    v_mov_b32 v215, 0
    v_mov_b32 v216, 0
    v_mov_b32 v217, 0
    v_mov_b32 v218, 0
    v_mov_b32 v219, 0
    v_mov_b32 v220, 0
    v_mov_b32 v221, 0
    v_mov_b32 v222, 0
    v_mov_b32 v223, 0
    v_mov_b32 v224, 0
    v_mov_b32 v225, 0
    v_mov_b32 v226, 0
    v_mov_b32 v227, 0
    v_mov_b32 v228, 0
    v_mov_b32 v229, 0
    v_mov_b32 v230, 0
    v_mov_b32 v231, 0
    v_mov_b32 v232, 0
    v_mov_b32 v233, 0
    v_mov_b32 v234, 0
    v_mov_b32 v235, 0
    v_mov_b32 v236, 0
    v_mov_b32 v237, 0
    v_mov_b32 v238, 0
    v_mov_b32 v239, 0
    v_mov_b32 v240, 0
    v_mov_b32 v241, 0
    v_mov_b32 v242, 0
    v_mov_b32 v243, 0
    v_mov_b32 v244, 0
    v_mov_b32 v245, 0
    v_mov_b32 v246, 0
    v_mov_b32 v247, 0
    v_mov_b32 v248, 0
    v_mov_b32 v249, 0
    v_mov_b32 v250, 0
    v_mov_b32 v251, 0
    v_mov_b32 v252, 0
    v_mov_b32 v253, 0
    v_mov_b32 v254, 0
    v_mov_b32 v255, 0
    s_barrier
    s_mov_b32 s40, 2
    v_mov_b32 v0, s40
    s_waitcnt vmcnt(21)
    ds_write_b32 v7, v0
    s_branch K12_S0
K12_Q0:
    ds_read_b64_tr_b16 v[40:41], v4 offset:0
    ds_read_b64_tr_b16 v[42:43], v4 offset:2048
    ds_read_b64_tr_b16 v[44:45], v4 offset:256
    ds_read_b64_tr_b16 v[46:47], v4 offset:2304
    v_xor_b32 v4, 32, v4
    ds_read_b64_tr_b16 v[48:49], v4 offset:0
    ds_read_b64_tr_b16 v[50:51], v4 offset:2048
    ds_read_b64_tr_b16 v[52:53], v4 offset:256
    ds_read_b64_tr_b16 v[54:55], v4 offset:2304
    v_xor_b32 v4, 32, v4
    ds_read_b128 v[8:11], v2 offset:0
    ds_read_b128 v[12:15], v3 offset:0
    ds_read_b128 v[16:19], v2 offset:2048
    ds_read_b128 v[20:23], v3 offset:2048
    ds_read_b128 v[32:35], v2 offset:6144
    ds_read_b128 v[36:39], v3 offset:6144
    ds_read_b32 v68, v5
    s_waitcnt lgkmcnt(7)
    v_xor_b32 v72, s35, v44
    v_xor_b32 v73, s35, v45
    v_xor_b32 v74, s35, v46
    v_xor_b32 v75, s35, v47
    v_xor_b32 v76, s35, v52
    v_xor_b32 v77, s35, v53
    v_xor_b32 v78, s35, v54
    v_xor_b32 v79, s35, v55
    s_mov_b32 s41, 0
    s_mov_b32 s42, 38912
    s_mov_b32 s39, 0
    s_mov_b32 s29, 116736
K12_LOOP:
    s_waitcnt lgkmcnt(2)
    v_mfma_f32_16x16x32_bf16 v[80:83], v[8:11], v[40:43], v[80:83]
    ds_read_b128 v[24:27], v2 offset:4096
    v_xor_b32 v72, s35, v44
    v_xor_b32 v73, s35, v45
    v_mfma_f32_16x16x32_bf16 v[84:87], v[8:11], v[44:47], v[84:87]
    ds_read_b128 v[28:31], v3 offset:4096
    v_xor_b32 v74, s35, v46
    v_xor_b32 v75, s35, v47
    v_mfma_f32_16x16x32_bf16 v[88:91], v[8:11], v[48:51], v[88:91]
    s_waitcnt lgkmcnt(2)
    v_cmp_gt_u32 vcc, s40, v68
    s_add_u32 s49, s39, 2
    s_lshr_b32 s49, s49, 1
    v_xor_b32 v76, s35, v52
    v_xor_b32 v77, s35, v53
    v_mfma_f32_16x16x32_bf16 v[92:95], v[8:11], v[52:55], v[92:95]
    s_cbranch_vccnz K12_S1
K12_Q1:
    s_mul_i32 s48, s49, s50
    s_add_u32 s48, s48, s47
    v_xor_b32 v78, s35, v54
    v_xor_b32 v79, s35, v55
    v_mfma_f32_16x16x32_bf16 v[80:83], v[12:15], v[72:75], v[80:83]
    s_add_u32 m0, s29, s36
    s_nop 0
    buffer_load_dwordx4 v1, s[8:11], s30 offen sc1 lds
    v_mfma_f32_16x16x32_bf16 v[84:87], v[12:15], v[40:43], v[84:87]
    s_cmp_lt_u32 s49, 8
    s_cselect_b32 s48, s48, 155744
    v_mfma_f32_16x16x32_bf16 v[88:91], v[12:15], v[76:79], v[88:91]
    s_cmp_ge_u32 s49, 3
    s_cselect_b32 s48, s48, 155744
    v_mfma_f32_16x16x32_bf16 v[92:95], v[12:15], v[48:51], v[92:95]
    v_mfma_f32_16x16x32_bf16 v[96:99], v[16:19], v[40:43], v[96:99]
    ds_read_b128 v[8:11], v2 offset:8192
    v_mfma_f32_16x16x32_bf16 v[100:103], v[16:19], v[44:47], v[100:103]
    ds_read_b128 v[12:15], v3 offset:8192
    v_mfma_f32_16x16x32_bf16 v[104:107], v[16:19], v[48:51], v[104:107]
    buffer_load_dwordx4 v1, s[8:11], s30 offen offset:1024 sc1 lds
    v_mfma_f32_16x16x32_bf16 v[108:111], v[16:19], v[52:55], v[108:111]
    v_mfma_f32_16x16x32_bf16 v[96:99], v[20:23], v[72:75], v[96:99]
    v_mfma_f32_16x16x32_bf16 v[100:103], v[20:23], v[40:43], v[100:103]
    v_mfma_f32_16x16x32_bf16 v[104:107], v[20:23], v[76:79], v[104:107]
    buffer_load_dwordx4 v1, s[8:11], s30 offen offset:2048 sc1 lds
    v_mfma_f32_16x16x32_bf16 v[108:111], v[20:23], v[48:51], v[108:111]
    s_waitcnt lgkmcnt(2)
    v_mfma_f32_16x16x32_bf16 v[112:115], v[24:27], v[40:43], v[112:115]
    ds_read_b128 v[16:19], v2 offset:10240
    v_mfma_f32_16x16x32_bf16 v[116:119], v[24:27], v[44:47], v[116:119]
    ds_read_b128 v[20:23], v3 offset:10240
    v_mfma_f32_16x16x32_bf16 v[120:123], v[24:27], v[48:51], v[120:123]
    v_mfma_f32_16x16x32_bf16 v[124:127], v[24:27], v[52:55], v[124:127]
    v_mfma_f32_16x16x32_bf16 v[112:115], v[28:31], v[72:75], v[112:115]
    buffer_load_dwordx4 v1, s[8:11], s30 offen offset:3072 sc1 lds
    v_mfma_f32_16x16x32_bf16 v[116:119], v[28:31], v[40:43], v[116:119]
    v_mfma_f32_16x16x32_bf16 v[120:123], v[28:31], v[76:79], v[120:123]
    v_mfma_f32_16x16x32_bf16 v[124:127], v[28:31], v[48:51], v[124:127]
    v_mfma_f32_16x16x32_bf16 v[128:131], v[32:35], v[40:43], v[128:131]
    ds_read_b128 v[24:27], v2 offset:12288
    v_mfma_f32_16x16x32_bf16 v[132:135], v[32:35], v[44:47], v[132:135]
    ds_read_b128 v[28:31], v3 offset:12288
    v_mfma_f32_16x16x32_bf16 v[136:139], v[32:35], v[48:51], v[136:139]
    s_add_u32 m0, m0, 4096
    s_add_u32 s34, s30, 4096
    buffer_load_dwordx4 v1, s[8:11], s34 offen sc1 lds
    v_mfma_f32_16x16x32_bf16 v[140:143], v[32:35], v[52:55], v[140:143]
    v_mfma_f32_16x16x32_bf16 v[128:131], v[36:39], v[72:75], v[128:131]
    v_mfma_f32_16x16x32_bf16 v[132:135], v[36:39], v[40:43], v[132:135]
    v_mfma_f32_16x16x32_bf16 v[136:139], v[36:39], v[76:79], v[136:139]
    s_add_u32 m0, s29, s37
    s_add_u32 s30, s30, 21376
    buffer_load_dwordx4 v1, s[12:15], s31 offen sc1 lds
    v_mfma_f32_16x16x32_bf16 v[140:143], v[36:39], v[48:51], v[140:143]
    s_waitcnt lgkmcnt(4)
    v_mfma_f32_16x16x32_bf16 v[144:147], v[8:11], v[40:43], v[144:147]
    ds_read_b128 v[32:35], v2 offset:14336
    v_mfma_f32_16x16x32_bf16 v[148:151], v[8:11], v[44:47], v[148:151]
    ds_read_b128 v[36:39], v3 offset:14336
    v_mfma_f32_16x16x32_bf16 v[152:155], v[8:11], v[48:51], v[152:155]
    v_mfma_f32_16x16x32_bf16 v[156:159], v[8:11], v[52:55], v[156:159]
    v_mfma_f32_16x16x32_bf16 v[144:147], v[12:15], v[72:75], v[144:147]
    buffer_load_dwordx4 v1, s[12:15], s31 offen offset:1024 sc1 lds
    v_mfma_f32_16x16x32_bf16 v[148:151], v[12:15], v[40:43], v[148:151]
    v_mfma_f32_16x16x32_bf16 v[152:155], v[12:15], v[76:79], v[152:155]
    v_mfma_f32_16x16x32_bf16 v[156:159], v[12:15], v[48:51], v[156:159]
    s_waitcnt lgkmcnt(4)
    v_mfma_f32_16x16x32_bf16 v[160:163], v[16:19], v[40:43], v[160:163]
    ds_read_b128 v[8:11], v2 offset:16384
    v_mfma_f32_16x16x32_bf16 v[164:167], v[16:19], v[44:47], v[164:167]
    ds_read_b128 v[12:15], v3 offset:16384
    v_mfma_f32_16x16x32_bf16 v[168:171], v[16:19], v[48:51], v[168:171]
    buffer_load_dwordx4 v1, s[12:15], s31 offen offset:2048 sc1 lds
    v_mfma_f32_16x16x32_bf16 v[172:175], v[16:19], v[52:55], v[172:175]
    s_add_u32 s40, s40, 1
    s_mov_b32 s51, s40
    v_mov_b32 v0, s40
    v_mfma_f32_16x16x32_bf16 v[160:163], v[20:23], v[72:75], v[160:163]
    s_waitcnt vmcnt(19)
    ds_write_b32 v7, v0
    v_mfma_f32_16x16x32_bf16 v[164:167], v[20:23], v[40:43], v[164:167]
    v_mfma_f32_16x16x32_bf16 v[168:171], v[20:23], v[76:79], v[168:171]
    buffer_load_dwordx4 v1, s[12:15], s31 offen offset:3072 sc1 lds
    v_mfma_f32_16x16x32_bf16 v[172:175], v[20:23], v[48:51], v[172:175]
    s_waitcnt lgkmcnt(5)
    v_mfma_f32_16x16x32_bf16 v[176:179], v[24:27], v[40:43], v[176:179]
    ds_read_b128 v[16:19], v2 offset:18432
    v_mfma_f32_16x16x32_bf16 v[180:183], v[24:27], v[44:47], v[180:183]
    ds_read_b128 v[20:23], v3 offset:18432
    v_mov_b32 v0, s48
    v_mfma_f32_16x16x32_bf16 v[184:187], v[24:27], v[48:51], v[184:187]
    ds_read_b32 v0, v0
    v_mfma_f32_16x16x32_bf16 v[188:191], v[24:27], v[52:55], v[188:191]
    v_mfma_f32_16x16x32_bf16 v[176:179], v[28:31], v[72:75], v[176:179]
    s_add_u32 m0, s29, s38
    s_mov_b64 exec, s[44:45]
    buffer_load_dwordx4 v1, s[64:67], s33 offen sc1 lds
    s_mov_b64 exec, -1
    s_add_u32 s31, s31, 16384
    s_add_u32 s33, s33, 21376
    v_mfma_f32_16x16x32_bf16 v[180:183], v[28:31], v[40:43], v[180:183]
    v_mfma_f32_16x16x32_bf16 v[184:187], v[28:31], v[76:79], v[184:187]
    v_mfma_f32_16x16x32_bf16 v[188:191], v[28:31], v[48:51], v[188:191]
    s_waitcnt lgkmcnt(0)
    v_cmp_eq_u32 vcc, 0, v0
    v_mfma_f32_16x16x32_bf16 v[192:195], v[32:35], v[40:43], v[192:195]
    ds_read_b128 v[24:27], v2 offset:20480
    v_mfma_f32_16x16x32_bf16 v[196:199], v[32:35], v[44:47], v[196:199]
    ds_read_b128 v[28:31], v3 offset:20480
    s_cbranch_vccnz K12_F2
K12_G2:
    v_mfma_f32_16x16x32_bf16 v[200:203], v[32:35], v[48:51], v[200:203]
    s_sub_u32 s43, s42, s41
    s_add_u32 s40, s40, 1
    v_add_u32 v2, s43, v2
    v_mfma_f32_16x16x32_bf16 v[204:207], v[32:35], v[52:55], v[204:207]
    v_add_u32 v3, s43, v3
    v_add_u32 v4, s43, v4
    v_mov_b32 v0, s40
    v_mfma_f32_16x16x32_bf16 v[192:195], v[36:39], v[72:75], v[192:195]
    ds_write_b32 v7, v0
    v_mfma_f32_16x16x32_bf16 v[196:199], v[36:39], v[40:43], v[196:199]
    v_mfma_f32_16x16x32_bf16 v[200:203], v[36:39], v[76:79], v[200:203]
    v_mfma_f32_16x16x32_bf16 v[204:207], v[36:39], v[48:51], v[204:207]
    ds_read_b32 v56, v5
    v_mfma_f32_16x16x32_bf16 v[208:211], v[8:11], v[40:43], v[208:211]
    v_mfma_f32_16x16x32_bf16 v[212:215], v[8:11], v[44:47], v[212:215]
    v_mfma_f32_16x16x32_bf16 v[216:219], v[8:11], v[48:51], v[216:219]
    v_mfma_f32_16x16x32_bf16 v[220:223], v[8:11], v[52:55], v[220:223]
    s_waitcnt lgkmcnt(0)
    v_cmp_gt_u32 vcc, s51, v56
    v_mfma_f32_16x16x32_bf16 v[208:211], v[12:15], v[72:75], v[208:211]
    v_mfma_f32_16x16x32_bf16 v[212:215], v[12:15], v[40:43], v[212:215]
    s_cbranch_vccnz K12_S3
K12_Q3:
    v_mfma_f32_16x16x32_bf16 v[216:219], v[12:15], v[76:79], v[216:219]
    ds_read_b64_tr_b16 v[56:57], v4 offset:0
    v_mfma_f32_16x16x32_bf16 v[220:223], v[12:15], v[48:51], v[220:223]
    ds_read_b64_tr_b16 v[58:59], v4 offset:2048
    v_mfma_f32_16x16x32_bf16 v[224:227], v[16:19], v[40:43], v[224:227]
    ds_read_b64_tr_b16 v[60:61], v4 offset:256
    ds_read_b128 v[8:11], v2 offset:0
    v_mfma_f32_16x16x32_bf16 v[228:231], v[16:19], v[44:47], v[228:231]
    ds_read_b64_tr_b16 v[62:63], v4 offset:2304
    ds_read_b128 v[12:15], v3 offset:0
    v_mfma_f32_16x16x32_bf16 v[232:235], v[16:19], v[48:51], v[232:235]
    v_xor_b32 v4, 32, v4
    ds_read_b128 v[32:35], v2 offset:6144
    v_mfma_f32_16x16x32_bf16 v[236:239], v[16:19], v[52:55], v[236:239]
    ds_read_b64_tr_b16 v[64:65], v4 offset:0
    ds_read_b128 v[36:39], v3 offset:6144
    v_mfma_f32_16x16x32_bf16 v[224:227], v[20:23], v[72:75], v[224:227]
    ds_read_b64_tr_b16 v[66:67], v4 offset:2048
    ds_read_b32 v52, v5
    v_mfma_f32_16x16x32_bf16 v[228:231], v[20:23], v[40:43], v[228:231]
    ds_read_b64_tr_b16 v[68:69], v4 offset:256
    ds_read_b64_tr_b16 v[70:71], v4 offset:2304
    v_xor_b32 v4, 32, v4
    v_mfma_f32_16x16x32_bf16 v[232:235], v[20:23], v[76:79], v[232:235]
    v_mfma_f32_16x16x32_bf16 v[236:239], v[20:23], v[48:51], v[236:239]
    v_mfma_f32_16x16x32_bf16 v[240:243], v[24:27], v[40:43], v[240:243]
    ds_read_b128 v[16:19], v2 offset:2048
    v_mfma_f32_16x16x32_bf16 v[244:247], v[24:27], v[44:47], v[244:247]
    ds_read_b128 v[20:23], v3 offset:2048
    v_mfma_f32_16x16x32_bf16 v[240:243], v[28:31], v[72:75], v[240:243]
    s_mov_b32 s29, s41
    s_mov_b32 s41, s42
    s_add_u32 s42, s42, 38912
    v_mfma_f32_16x16x32_bf16 v[244:247], v[28:31], v[40:43], v[244:247]
    s_cmp_eq_u32 s42, 155648
    s_cselect_b32 s42, 0, s42
    s_waitcnt lgkmcnt(2)
    v_mfma_f32_16x16x32_bf16 v[80:83], v[8:11], v[56:59], v[80:83]
    ds_read_b128 v[24:27], v2 offset:4096
    v_xor_b32 v72, s35, v60
    v_xor_b32 v73, s35, v61
    v_mfma_f32_16x16x32_bf16 v[84:87], v[8:11], v[60:63], v[84:87]
    ds_read_b128 v[28:31], v3 offset:4096
    v_xor_b32 v74, s35, v62
    v_xor_b32 v75, s35, v63
    v_mfma_f32_16x16x32_bf16 v[88:91], v[8:11], v[64:67], v[88:91]
    s_waitcnt lgkmcnt(2)
    v_cmp_gt_u32 vcc, s40, v52
    v_xor_b32 v76, s35, v68
    v_xor_b32 v77, s35, v69
    v_mfma_f32_16x16x32_bf16 v[92:95], v[8:11], v[68:71], v[92:95]
    s_cbranch_vccnz K12_S4
K12_Q4:
    v_xor_b32 v78, s35, v70
    v_xor_b32 v79, s35, v71
    v_mfma_f32_16x16x32_bf16 v[80:83], v[12:15], v[72:75], v[80:83]
    s_add_u32 m0, s29, s36
    s_nop 0
    buffer_load_dwordx4 v1, s[8:11], s30 offen sc1 lds
    v_mfma_f32_16x16x32_bf16 v[84:87], v[12:15], v[56:59], v[84:87]
    v_mfma_f32_16x16x32_bf16 v[88:91], v[12:15], v[76:79], v[88:91]
    v_mfma_f32_16x16x32_bf16 v[92:95], v[12:15], v[64:67], v[92:95]
    v_mfma_f32_16x16x32_bf16 v[96:99], v[16:19], v[56:59], v[96:99]
    ds_read_b128 v[8:11], v2 offset:8192
    v_mfma_f32_16x16x32_bf16 v[100:103], v[16:19], v[60:63], v[100:103]
    ds_read_b128 v[12:15], v3 offset:8192
    v_mfma_f32_16x16x32_bf16 v[104:107], v[16:19], v[64:67], v[104:107]
    buffer_load_dwordx4 v1, s[8:11], s30 offen offset:1024 sc1 lds
    v_mfma_f32_16x16x32_bf16 v[108:111], v[16:19], v[68:71], v[108:111]
    v_mfma_f32_16x16x32_bf16 v[96:99], v[20:23], v[72:75], v[96:99]
    v_mfma_f32_16x16x32_bf16 v[100:103], v[20:23], v[56:59], v[100:103]
    v_mfma_f32_16x16x32_bf16 v[104:107], v[20:23], v[76:79], v[104:107]
    buffer_load_dwordx4 v1, s[8:11], s30 offen offset:2048 sc1 lds
    v_mfma_f32_16x16x32_bf16 v[108:111], v[20:23], v[64:67], v[108:111]
    s_waitcnt lgkmcnt(2)
    v_mfma_f32_16x16x32_bf16 v[112:115], v[24:27], v[56:59], v[112:115]
    ds_read_b128 v[16:19], v2 offset:10240
    v_mfma_f32_16x16x32_bf16 v[116:119], v[24:27], v[60:63], v[116:119]
    ds_read_b128 v[20:23], v3 offset:10240
    v_mfma_f32_16x16x32_bf16 v[120:123], v[24:27], v[64:67], v[120:123]
    v_mfma_f32_16x16x32_bf16 v[124:127], v[24:27], v[68:71], v[124:127]
    v_mfma_f32_16x16x32_bf16 v[112:115], v[28:31], v[72:75], v[112:115]
    buffer_load_dwordx4 v1, s[8:11], s30 offen offset:3072 sc1 lds
    v_mfma_f32_16x16x32_bf16 v[116:119], v[28:31], v[56:59], v[116:119]
    v_mfma_f32_16x16x32_bf16 v[120:123], v[28:31], v[76:79], v[120:123]
    v_mfma_f32_16x16x32_bf16 v[124:127], v[28:31], v[64:67], v[124:127]
    v_mfma_f32_16x16x32_bf16 v[128:131], v[32:35], v[56:59], v[128:131]
    ds_read_b128 v[24:27], v2 offset:12288
    v_mfma_f32_16x16x32_bf16 v[132:135], v[32:35], v[60:63], v[132:135]
    ds_read_b128 v[28:31], v3 offset:12288
    v_mfma_f32_16x16x32_bf16 v[136:139], v[32:35], v[64:67], v[136:139]
    s_add_u32 m0, m0, 4096
    s_add_u32 s34, s30, 4096
    buffer_load_dwordx4 v1, s[8:11], s34 offen sc1 lds
    v_mfma_f32_16x16x32_bf16 v[140:143], v[32:35], v[68:71], v[140:143]
    v_mfma_f32_16x16x32_bf16 v[128:131], v[36:39], v[72:75], v[128:131]
    v_mfma_f32_16x16x32_bf16 v[132:135], v[36:39], v[56:59], v[132:135]
    v_mfma_f32_16x16x32_bf16 v[136:139], v[36:39], v[76:79], v[136:139]
    s_add_u32 m0, s29, s37
    s_add_u32 s30, s30, 21376
    buffer_load_dwordx4 v1, s[12:15], s31 offen sc1 lds
    v_mfma_f32_16x16x32_bf16 v[140:143], v[36:39], v[64:67], v[140:143]
    s_waitcnt lgkmcnt(4)
    v_mfma_f32_16x16x32_bf16 v[144:147], v[8:11], v[56:59], v[144:147]
    ds_read_b128 v[32:35], v2 offset:14336
    v_mfma_f32_16x16x32_bf16 v[148:151], v[8:11], v[60:63], v[148:151]
    ds_read_b128 v[36:39], v3 offset:14336
    v_mfma_f32_16x16x32_bf16 v[152:155], v[8:11], v[64:67], v[152:155]
    v_mfma_f32_16x16x32_bf16 v[156:159], v[8:11], v[68:71], v[156:159]
    v_mfma_f32_16x16x32_bf16 v[144:147], v[12:15], v[72:75], v[144:147]
    buffer_load_dwordx4 v1, s[12:15], s31 offen offset:1024 sc1 lds
    v_mfma_f32_16x16x32_bf16 v[148:151], v[12:15], v[56:59], v[148:151]
    v_mfma_f32_16x16x32_bf16 v[152:155], v[12:15], v[76:79], v[152:155]
    v_mfma_f32_16x16x32_bf16 v[156:159], v[12:15], v[64:67], v[156:159]
    s_waitcnt lgkmcnt(4)
    v_mfma_f32_16x16x32_bf16 v[160:163], v[16:19], v[56:59], v[160:163]
    ds_read_b128 v[8:11], v2 offset:16384
    v_mfma_f32_16x16x32_bf16 v[164:167], v[16:19], v[60:63], v[164:167]
    ds_read_b128 v[12:15], v3 offset:16384
    v_mfma_f32_16x16x32_bf16 v[168:171], v[16:19], v[64:67], v[168:171]
    buffer_load_dwordx4 v1, s[12:15], s31 offen offset:2048 sc1 lds
    v_mfma_f32_16x16x32_bf16 v[172:175], v[16:19], v[68:71], v[172:175]
    s_add_u32 s40, s40, 1
    s_mov_b32 s51, s40
    v_mov_b32 v0, s40
    v_mfma_f32_16x16x32_bf16 v[160:163], v[20:23], v[72:75], v[160:163]
    s_waitcnt vmcnt(19)
    ds_write_b32 v7, v0
    v_mfma_f32_16x16x32_bf16 v[164:167], v[20:23], v[56:59], v[164:167]
    v_mfma_f32_16x16x32_bf16 v[168:171], v[20:23], v[76:79], v[168:171]
    buffer_load_dwordx4 v1, s[12:15], s31 offen offset:3072 sc1 lds
    v_mfma_f32_16x16x32_bf16 v[172:175], v[20:23], v[64:67], v[172:175]
    s_waitcnt lgkmcnt(5)
    v_mfma_f32_16x16x32_bf16 v[176:179], v[24:27], v[56:59], v[176:179]
    ds_read_b128 v[16:19], v2 offset:18432
    v_mfma_f32_16x16x32_bf16 v[180:183], v[24:27], v[60:63], v[180:183]
    ds_read_b128 v[20:23], v3 offset:18432
    v_mfma_f32_16x16x32_bf16 v[184:187], v[24:27], v[64:67], v[184:187]
    v_mfma_f32_16x16x32_bf16 v[188:191], v[24:27], v[68:71], v[188:191]
    v_mfma_f32_16x16x32_bf16 v[176:179], v[28:31], v[72:75], v[176:179]
    s_add_u32 m0, s29, s38
    s_mov_b64 exec, s[44:45]
    buffer_load_dwordx4 v1, s[64:67], s33 offen sc1 lds
    s_mov_b64 exec, -1
    s_add_u32 s31, s31, 16384
    s_add_u32 s33, s33, 21376
    v_mfma_f32_16x16x32_bf16 v[180:183], v[28:31], v[56:59], v[180:183]
    v_mfma_f32_16x16x32_bf16 v[184:187], v[28:31], v[76:79], v[184:187]
    s_mov_b32 m0, s46
    s_mov_b64 exec, 0xff
    buffer_load_dword v1, s[4:7], 0 offen sc1 lds
    s_mov_b64 exec, -1
    v_mfma_f32_16x16x32_bf16 v[188:191], v[28:31], v[64:67], v[188:191]
    s_waitcnt lgkmcnt(5)
    v_mfma_f32_16x16x32_bf16 v[192:195], v[32:35], v[56:59], v[192:195]
    ds_read_b128 v[24:27], v2 offset:20480
    v_mfma_f32_16x16x32_bf16 v[196:199], v[32:35], v[60:63], v[196:199]
    ds_read_b128 v[28:31], v3 offset:20480
    v_mfma_f32_16x16x32_bf16 v[200:203], v[32:35], v[64:67], v[200:203]
    s_sub_u32 s43, s42, s41
    s_add_u32 s40, s40, 1
    v_add_u32 v2, s43, v2
    v_mfma_f32_16x16x32_bf16 v[204:207], v[32:35], v[68:71], v[204:207]
    v_add_u32 v3, s43, v3
    v_add_u32 v4, s43, v4
    v_mov_b32 v0, s40
    v_mfma_f32_16x16x32_bf16 v[192:195], v[36:39], v[72:75], v[192:195]
    ds_write_b32 v7, v0
    v_mfma_f32_16x16x32_bf16 v[196:199], v[36:39], v[56:59], v[196:199]
    v_mfma_f32_16x16x32_bf16 v[200:203], v[36:39], v[76:79], v[200:203]
    v_mfma_f32_16x16x32_bf16 v[204:207], v[36:39], v[64:67], v[204:207]
    ds_read_b32 v40, v5
    s_waitcnt lgkmcnt(7)
    v_mfma_f32_16x16x32_bf16 v[208:211], v[8:11], v[56:59], v[208:211]
    v_mfma_f32_16x16x32_bf16 v[212:215], v[8:11], v[60:63], v[212:215]
    v_mfma_f32_16x16x32_bf16 v[216:219], v[8:11], v[64:67], v[216:219]
    v_mfma_f32_16x16x32_bf16 v[220:223], v[8:11], v[68:71], v[220:223]
    s_waitcnt lgkmcnt(0)
    v_cmp_gt_u32 vcc, s51, v40
    v_mfma_f32_16x16x32_bf16 v[208:211], v[12:15], v[72:75], v[208:211]
    v_mfma_f32_16x16x32_bf16 v[212:215], v[12:15], v[56:59], v[212:215]
    s_cbranch_vccnz K12_S5
K12_Q5:
    v_mfma_f32_16x16x32_bf16 v[216:219], v[12:15], v[76:79], v[216:219]
    ds_read_b64_tr_b16 v[40:41], v4 offset:0
    v_mfma_f32_16x16x32_bf16 v[220:223], v[12:15], v[64:67], v[220:223]
    ds_read_b64_tr_b16 v[42:43], v4 offset:2048
    v_mfma_f32_16x16x32_bf16 v[224:227], v[16:19], v[56:59], v[224:227]
    ds_read_b64_tr_b16 v[44:45], v4 offset:256
    ds_read_b128 v[8:11], v2 offset:0
    v_mfma_f32_16x16x32_bf16 v[228:231], v[16:19], v[60:63], v[228:231]
    ds_read_b64_tr_b16 v[46:47], v4 offset:2304
    ds_read_b128 v[12:15], v3 offset:0
    v_mfma_f32_16x16x32_bf16 v[232:235], v[16:19], v[64:67], v[232:235]
    v_xor_b32 v4, 32, v4
    ds_read_b128 v[32:35], v2 offset:6144
    v_mfma_f32_16x16x32_bf16 v[236:239], v[16:19], v[68:71], v[236:239]
    ds_read_b64_tr_b16 v[48:49], v4 offset:0
    ds_read_b128 v[36:39], v3 offset:6144
    v_mfma_f32_16x16x32_bf16 v[224:227], v[20:23], v[72:75], v[224:227]
    ds_read_b64_tr_b16 v[50:51], v4 offset:2048
    ds_read_b32 v68, v5
    v_mfma_f32_16x16x32_bf16 v[228:231], v[20:23], v[56:59], v[228:231]
    ds_read_b64_tr_b16 v[52:53], v4 offset:256
    ds_read_b64_tr_b16 v[54:55], v4 offset:2304
    v_xor_b32 v4, 32, v4
    v_mfma_f32_16x16x32_bf16 v[232:235], v[20:23], v[76:79], v[232:235]
    v_mfma_f32_16x16x32_bf16 v[236:239], v[20:23], v[64:67], v[236:239]
    v_mfma_f32_16x16x32_bf16 v[240:243], v[24:27], v[56:59], v[240:243]
    ds_read_b128 v[16:19], v2 offset:2048
    v_mfma_f32_16x16x32_bf16 v[244:247], v[24:27], v[60:63], v[244:247]
    ds_read_b128 v[20:23], v3 offset:2048
    v_mfma_f32_16x16x32_bf16 v[240:243], v[28:31], v[72:75], v[240:243]
    s_mov_b32 s29, s41
    s_mov_b32 s41, s42
    s_add_u32 s42, s42, 38912
    v_mfma_f32_16x16x32_bf16 v[244:247], v[28:31], v[56:59], v[244:247]
    s_cmp_eq_u32 s42, 155648
    s_cselect_b32 s42, 0, s42
    s_add_u32 s39, s39, 1
    s_cmp_lt_u32 s39, 15
    s_cbranch_scc1 K12_LOOP
    s_waitcnt lgkmcnt(2)
    v_mfma_f32_16x16x32_bf16 v[80:83], v[8:11], v[40:43], v[80:83]
    ds_read_b128 v[24:27], v2 offset:4096
    v_xor_b32 v72, s35, v44
    v_xor_b32 v73, s35, v45
    v_mfma_f32_16x16x32_bf16 v[84:87], v[8:11], v[44:47], v[84:87]
    ds_read_b128 v[28:31], v3 offset:4096
    v_xor_b32 v74, s35, v46
    v_xor_b32 v75, s35, v47
    v_mfma_f32_16x16x32_bf16 v[88:91], v[8:11], v[48:51], v[88:91]
    s_waitcnt lgkmcnt(2)
    v_cmp_gt_u32 vcc, s40, v68
    s_add_u32 s49, s39, 2
    s_lshr_b32 s49, s49, 1
    v_xor_b32 v76, s35, v52
    v_xor_b32 v77, s35, v53
    v_mfma_f32_16x16x32_bf16 v[92:95], v[8:11], v[52:55], v[92:95]
    s_cbranch_vccnz K12_S6
K12_Q6:
    s_mul_i32 s48, s49, s50
    s_add_u32 s48, s48, s47
    v_xor_b32 v78, s35, v54
    v_xor_b32 v79, s35, v55
    v_mfma_f32_16x16x32_bf16 v[80:83], v[12:15], v[72:75], v[80:83]
    s_add_u32 m0, s29, s36
    s_nop 0
    buffer_load_dwordx4 v1, s[8:11], s30 offen sc1 lds
    v_mfma_f32_16x16x32_bf16 v[84:87], v[12:15], v[40:43], v[84:87]
    s_cmp_lt_u32 s49, 8
    s_cselect_b32 s48, s48, 155744
    v_mfma_f32_16x16x32_bf16 v[88:91], v[12:15], v[76:79], v[88:91]
    s_cmp_ge_u32 s49, 3
    s_cselect_b32 s48, s48, 155744
    v_mfma_f32_16x16x32_bf16 v[92:95], v[12:15], v[48:51], v[92:95]
    v_mfma_f32_16x16x32_bf16 v[96:99], v[16:19], v[40:43], v[96:99]
    ds_read_b128 v[8:11], v2 offset:8192
    v_mfma_f32_16x16x32_bf16 v[100:103], v[16:19], v[44:47], v[100:103]
    ds_read_b128 v[12:15], v3 offset:8192
    v_mfma_f32_16x16x32_bf16 v[104:107], v[16:19], v[48:51], v[104:107]
    buffer_load_dwordx4 v1, s[8:11], s30 offen offset:1024 sc1 lds
    v_mfma_f32_16x16x32_bf16 v[108:111], v[16:19], v[52:55], v[108:111]
    v_mfma_f32_16x16x32_bf16 v[96:99], v[20:23], v[72:75], v[96:99]
    v_mfma_f32_16x16x32_bf16 v[100:103], v[20:23], v[40:43], v[100:103]
    v_mfma_f32_16x16x32_bf16 v[104:107], v[20:23], v[76:79], v[104:107]
    buffer_load_dwordx4 v1, s[8:11], s30 offen offset:2048 sc1 lds
    v_mfma_f32_16x16x32_bf16 v[108:111], v[20:23], v[48:51], v[108:111]
    s_waitcnt lgkmcnt(2)
    v_mfma_f32_16x16x32_bf16 v[112:115], v[24:27], v[40:43], v[112:115]
    ds_read_b128 v[16:19], v2 offset:10240
    v_mfma_f32_16x16x32_bf16 v[116:119], v[24:27], v[44:47], v[116:119]
    ds_read_b128 v[20:23], v3 offset:10240
    v_mfma_f32_16x16x32_bf16 v[120:123], v[24:27], v[48:51], v[120:123]
    v_mfma_f32_16x16x32_bf16 v[124:127], v[24:27], v[52:55], v[124:127]
    v_mfma_f32_16x16x32_bf16 v[112:115], v[28:31], v[72:75], v[112:115]
    buffer_load_dwordx4 v1, s[8:11], s30 offen offset:3072 sc1 lds
    v_mfma_f32_16x16x32_bf16 v[116:119], v[28:31], v[40:43], v[116:119]
    v_mfma_f32_16x16x32_bf16 v[120:123], v[28:31], v[76:79], v[120:123]
    v_mfma_f32_16x16x32_bf16 v[124:127], v[28:31], v[48:51], v[124:127]
    v_mfma_f32_16x16x32_bf16 v[128:131], v[32:35], v[40:43], v[128:131]
    ds_read_b128 v[24:27], v2 offset:12288
    v_mfma_f32_16x16x32_bf16 v[132:135], v[32:35], v[44:47], v[132:135]
    ds_read_b128 v[28:31], v3 offset:12288
    v_mfma_f32_16x16x32_bf16 v[136:139], v[32:35], v[48:51], v[136:139]
    s_add_u32 m0, m0, 4096
    s_add_u32 s34, s30, 4096
    buffer_load_dwordx4 v1, s[8:11], s34 offen sc1 lds
    v_mfma_f32_16x16x32_bf16 v[140:143], v[32:35], v[52:55], v[140:143]
    v_mfma_f32_16x16x32_bf16 v[128:131], v[36:39], v[72:75], v[128:131]
    v_mfma_f32_16x16x32_bf16 v[132:135], v[36:39], v[40:43], v[132:135]
    v_mfma_f32_16x16x32_bf16 v[136:139], v[36:39], v[76:79], v[136:139]
    s_add_u32 m0, s29, s37
    s_add_u32 s30, s30, 21376
    buffer_load_dwordx4 v1, s[12:15], s31 offen sc1 lds
    v_mfma_f32_16x16x32_bf16 v[140:143], v[36:39], v[48:51], v[140:143]
    s_waitcnt lgkmcnt(4)
    v_mfma_f32_16x16x32_bf16 v[144:147], v[8:11], v[40:43], v[144:147]
    ds_read_b128 v[32:35], v2 offset:14336
    v_mfma_f32_16x16x32_bf16 v[148:151], v[8:11], v[44:47], v[148:151]
    ds_read_b128 v[36:39], v3 offset:14336
    v_mfma_f32_16x16x32_bf16 v[152:155], v[8:11], v[48:51], v[152:155]
    v_mfma_f32_16x16x32_bf16 v[156:159], v[8:11], v[52:55], v[156:159]
    v_mfma_f32_16x16x32_bf16 v[144:147], v[12:15], v[72:75], v[144:147]
    buffer_load_dwordx4 v1, s[12:15], s31 offen offset:1024 sc1 lds
    v_mfma_f32_16x16x32_bf16 v[148:151], v[12:15], v[40:43], v[148:151]
    v_mfma_f32_16x16x32_bf16 v[152:155], v[12:15], v[76:79], v[152:155]
    v_mfma_f32_16x16x32_bf16 v[156:159], v[12:15], v[48:51], v[156:159]
    s_waitcnt lgkmcnt(4)
    v_mfma_f32_16x16x32_bf16 v[160:163], v[16:19], v[40:43], v[160:163]
    ds_read_b128 v[8:11], v2 offset:16384
    v_mfma_f32_16x16x32_bf16 v[164:167], v[16:19], v[44:47], v[164:167]
    ds_read_b128 v[12:15], v3 offset:16384
    v_mfma_f32_16x16x32_bf16 v[168:171], v[16:19], v[48:51], v[168:171]
    buffer_load_dwordx4 v1, s[12:15], s31 offen offset:2048 sc1 lds
    v_mfma_f32_16x16x32_bf16 v[172:175], v[16:19], v[52:55], v[172:175]
    s_add_u32 s40, s40, 1
    s_mov_b32 s51, s40
    v_mov_b32 v0, s40
    v_mfma_f32_16x16x32_bf16 v[160:163], v[20:23], v[72:75], v[160:163]
    s_waitcnt vmcnt(19)
    ds_write_b32 v7, v0
    v_mfma_f32_16x16x32_bf16 v[164:167], v[20:23], v[40:43], v[164:167]
    v_mfma_f32_16x16x32_bf16 v[168:171], v[20:23], v[76:79], v[168:171]
    buffer_load_dwordx4 v1, s[12:15], s31 offen offset:3072 sc1 lds
    v_mfma_f32_16x16x32_bf16 v[172:175], v[20:23], v[48:51], v[172:175]
    s_waitcnt lgkmcnt(5)
    v_mfma_f32_16x16x32_bf16 v[176:179], v[24:27], v[40:43], v[176:179]
    ds_read_b128 v[16:19], v2 offset:18432
    v_mfma_f32_16x16x32_bf16 v[180:183], v[24:27], v[44:47], v[180:183]
    ds_read_b128 v[20:23], v3 offset:18432
    v_mov_b32 v0, s48
    v_mfma_f32_16x16x32_bf16 v[184:187], v[24:27], v[48:51], v[184:187]
    ds_read_b32 v0, v0
    v_mfma_f32_16x16x32_bf16 v[188:191], v[24:27], v[52:55], v[188:191]
    v_mfma_f32_16x16x32_bf16 v[176:179], v[28:31], v[72:75], v[176:179]
    s_add_u32 m0, s29, s38
    s_mov_b64 exec, s[44:45]
    buffer_load_dwordx4 v1, s[64:67], s33 offen sc1 lds
    s_mov_b64 exec, -1
    s_add_u32 s31, s31, 16384
    s_add_u32 s33, s33, 21376
    v_mfma_f32_16x16x32_bf16 v[180:183], v[28:31], v[40:43], v[180:183]
    v_mfma_f32_16x16x32_bf16 v[184:187], v[28:31], v[76:79], v[184:187]
    v_mfma_f32_16x16x32_bf16 v[188:191], v[28:31], v[48:51], v[188:191]
    s_waitcnt lgkmcnt(0)
    v_cmp_eq_u32 vcc, 0, v0
    v_mfma_f32_16x16x32_bf16 v[192:195], v[32:35], v[40:43], v[192:195]
    ds_read_b128 v[24:27], v2 offset:20480
    v_mfma_f32_16x16x32_bf16 v[196:199], v[32:35], v[44:47], v[196:199]
    ds_read_b128 v[28:31], v3 offset:20480
    s_cbranch_vccnz K12_F7
K12_G7:
    v_mfma_f32_16x16x32_bf16 v[200:203], v[32:35], v[48:51], v[200:203]
    s_sub_u32 s43, s42, s41
    s_add_u32 s40, s40, 1
    v_add_u32 v2, s43, v2
    v_mfma_f32_16x16x32_bf16 v[204:207], v[32:35], v[52:55], v[204:207]
    v_add_u32 v3, s43, v3
    v_add_u32 v4, s43, v4
    v_mov_b32 v0, s40
    v_mfma_f32_16x16x32_bf16 v[192:195], v[36:39], v[72:75], v[192:195]
    ds_write_b32 v7, v0
    v_mfma_f32_16x16x32_bf16 v[196:199], v[36:39], v[40:43], v[196:199]
    v_mfma_f32_16x16x32_bf16 v[200:203], v[36:39], v[76:79], v[200:203]
    v_mfma_f32_16x16x32_bf16 v[204:207], v[36:39], v[48:51], v[204:207]
    ds_read_b32 v56, v5
    v_mfma_f32_16x16x32_bf16 v[208:211], v[8:11], v[40:43], v[208:211]
    v_mfma_f32_16x16x32_bf16 v[212:215], v[8:11], v[44:47], v[212:215]
    v_mfma_f32_16x16x32_bf16 v[216:219], v[8:11], v[48:51], v[216:219]
    v_mfma_f32_16x16x32_bf16 v[220:223], v[8:11], v[52:55], v[220:223]
    s_waitcnt lgkmcnt(0)
    v_cmp_gt_u32 vcc, s51, v56
    v_mfma_f32_16x16x32_bf16 v[208:211], v[12:15], v[72:75], v[208:211]
    v_mfma_f32_16x16x32_bf16 v[212:215], v[12:15], v[40:43], v[212:215]
    s_cbranch_vccnz K12_S8
K12_Q8:
    v_mfma_f32_16x16x32_bf16 v[216:219], v[12:15], v[76:79], v[216:219]
    ds_read_b64_tr_b16 v[56:57], v4 offset:0
    v_mfma_f32_16x16x32_bf16 v[220:223], v[12:15], v[48:51], v[220:223]
    ds_read_b64_tr_b16 v[58:59], v4 offset:2048
    v_mfma_f32_16x16x32_bf16 v[224:227], v[16:19], v[40:43], v[224:227]
    ds_read_b64_tr_b16 v[60:61], v4 offset:256
    ds_read_b128 v[8:11], v2 offset:0
    v_mfma_f32_16x16x32_bf16 v[228:231], v[16:19], v[44:47], v[228:231]
    ds_read_b64_tr_b16 v[62:63], v4 offset:2304
    ds_read_b128 v[12:15], v3 offset:0
    v_mfma_f32_16x16x32_bf16 v[232:235], v[16:19], v[48:51], v[232:235]
    v_xor_b32 v4, 32, v4
    ds_read_b128 v[32:35], v2 offset:6144
    v_mfma_f32_16x16x32_bf16 v[236:239], v[16:19], v[52:55], v[236:239]
    ds_read_b64_tr_b16 v[64:65], v4 offset:0
    ds_read_b128 v[36:39], v3 offset:6144
    v_mfma_f32_16x16x32_bf16 v[224:227], v[20:23], v[72:75], v[224:227]
    ds_read_b64_tr_b16 v[66:67], v4 offset:2048
    ds_read_b32 v52, v5
    v_mfma_f32_16x16x32_bf16 v[228:231], v[20:23], v[40:43], v[228:231]
    ds_read_b64_tr_b16 v[68:69], v4 offset:256
    ds_read_b64_tr_b16 v[70:71], v4 offset:2304
    v_xor_b32 v4, 32, v4
    v_mfma_f32_16x16x32_bf16 v[232:235], v[20:23], v[76:79], v[232:235]
    v_mfma_f32_16x16x32_bf16 v[236:239], v[20:23], v[48:51], v[236:239]
    v_mfma_f32_16x16x32_bf16 v[240:243], v[24:27], v[40:43], v[240:243]
    ds_read_b128 v[16:19], v2 offset:2048
    v_mfma_f32_16x16x32_bf16 v[244:247], v[24:27], v[44:47], v[244:247]
    ds_read_b128 v[20:23], v3 offset:2048
    v_mfma_f32_16x16x32_bf16 v[240:243], v[28:31], v[72:75], v[240:243]
    s_mov_b32 s29, s41
    s_mov_b32 s41, s42
    s_add_u32 s42, s42, 38912
    v_mfma_f32_16x16x32_bf16 v[244:247], v[28:31], v[40:43], v[244:247]
    s_cmp_eq_u32 s42, 155648
    s_cselect_b32 s42, 0, s42
    s_waitcnt lgkmcnt(2)
    v_mfma_f32_16x16x32_bf16 v[80:83], v[8:11], v[56:59], v[80:83]
    ds_read_b128 v[24:27], v2 offset:4096
    v_xor_b32 v72, s35, v60
    v_xor_b32 v73, s35, v61
    v_mfma_f32_16x16x32_bf16 v[84:87], v[8:11], v[60:63], v[84:87]
    ds_read_b128 v[28:31], v3 offset:4096
    v_xor_b32 v74, s35, v62
    v_xor_b32 v75, s35, v63
    v_mfma_f32_16x16x32_bf16 v[88:91], v[8:11], v[64:67], v[88:91]
    v_xor_b32 v76, s35, v68
    v_xor_b32 v77, s35, v69
    v_mfma_f32_16x16x32_bf16 v[92:95], v[8:11], v[68:71], v[92:95]
    v_xor_b32 v78, s35, v70
    v_xor_b32 v79, s35, v71
    v_mfma_f32_16x16x32_bf16 v[80:83], v[12:15], v[72:75], v[80:83]
    v_lshrrev_b32 v0, 4, v1
    v_and_b32 v5, 15, v0
    v_mfma_f32_16x16x32_bf16 v[84:87], v[12:15], v[56:59], v[84:87]
    v_lshrrev_b32 v0, 4, v0
    s_lshl_b32 s28, s21, 7
    v_mfma_f32_16x16x32_bf16 v[88:91], v[12:15], v[76:79], v[88:91]
    s_lshl_b32 s29, s3, 5
    s_add_u32 s28, s28, s29
    v_mfma_f32_16x16x32_bf16 v[92:95], v[12:15], v[64:67], v[92:95]
    v_add_u32 v5, s28, v5
    v_lshlrev_b32 v5, 2, v5
    s_waitcnt lgkmcnt(2)
    v_mfma_f32_16x16x32_bf16 v[96:99], v[16:19], v[56:59], v[96:99]
    ds_read_b128 v[8:11], v2 offset:8192
    v_lshl_add_u32 v5, v0, 13, v5
    s_lshl_b32 s28, s20, 6
    v_mfma_f32_16x16x32_bf16 v[100:103], v[16:19], v[60:63], v[100:103]
    ds_read_b128 v[12:15], v3 offset:8192
    v_xor_b32 v5, s28, v5
    v_xor_b32 v7, 64, v5
    v_mfma_f32_16x16x32_bf16 v[104:107], v[16:19], v[64:67], v[104:107]
    v_mfma_f32_16x16x32_bf16 v[108:111], v[16:19], v[68:71], v[108:111]
    s_mov_b32 s38, 0
    v_cvt_pk_bf16_f32 v48, v80, v84
    buffer_store_dword v48, v5, s[16:19], s38 offen offset:0 sc1
    v_cvt_pk_bf16_f32 v49, v88, v92
    buffer_store_dword v49, v7, s[16:19], s38 offen offset:0 sc1
    v_mfma_f32_16x16x32_bf16 v[96:99], v[20:23], v[72:75], v[96:99]
    v_cvt_pk_bf16_f32 v50, v81, v85
    buffer_store_dword v50, v5, s[16:19], s38 offen offset:2048 sc1
    v_mfma_f32_16x16x32_bf16 v[100:103], v[20:23], v[56:59], v[100:103]
    v_cvt_pk_bf16_f32 v51, v89, v93
    buffer_store_dword v51, v7, s[16:19], s38 offen offset:2048 sc1
    v_mfma_f32_16x16x32_bf16 v[104:107], v[20:23], v[76:79], v[104:107]
    s_mov_b32 s38, 4096
    v_cvt_pk_bf16_f32 v52, v82, v86
    buffer_store_dword v52, v5, s[16:19], s38 offen offset:0 sc1
    v_cvt_pk_bf16_f32 v53, v90, v94
    buffer_store_dword v53, v7, s[16:19], s38 offen offset:0 sc1
    v_mfma_f32_16x16x32_bf16 v[108:111], v[20:23], v[64:67], v[108:111]
    v_cvt_pk_bf16_f32 v54, v83, v87
    buffer_store_dword v54, v5, s[16:19], s38 offen offset:2048 sc1
    s_waitcnt lgkmcnt(2)
    v_mfma_f32_16x16x32_bf16 v[112:115], v[24:27], v[56:59], v[112:115]
    ds_read_b128 v[16:19], v2 offset:10240
    v_cvt_pk_bf16_f32 v55, v91, v95
    buffer_store_dword v55, v7, s[16:19], s38 offen offset:2048 sc1
    v_mfma_f32_16x16x32_bf16 v[116:119], v[24:27], v[60:63], v[116:119]
    ds_read_b128 v[20:23], v3 offset:10240
    v_mfma_f32_16x16x32_bf16 v[120:123], v[24:27], v[64:67], v[120:123]
    v_mfma_f32_16x16x32_bf16 v[124:127], v[24:27], v[68:71], v[124:127]
    s_mov_b32 s38, 32768
    v_cvt_pk_bf16_f32 v40, v96, v100
    buffer_store_dword v40, v5, s[16:19], s38 offen offset:0 sc1
    v_cvt_pk_bf16_f32 v41, v104, v108
    buffer_store_dword v41, v7, s[16:19], s38 offen offset:0 sc1
    v_mfma_f32_16x16x32_bf16 v[112:115], v[28:31], v[72:75], v[112:115]
    v_cvt_pk_bf16_f32 v42, v97, v101
    buffer_store_dword v42, v5, s[16:19], s38 offen offset:2048 sc1
    v_mfma_f32_16x16x32_bf16 v[116:119], v[28:31], v[56:59], v[116:119]
    v_cvt_pk_bf16_f32 v43, v105, v109
    buffer_store_dword v43, v7, s[16:19], s38 offen offset:2048 sc1
    v_mfma_f32_16x16x32_bf16 v[120:123], v[28:31], v[76:79], v[120:123]
    s_mov_b32 s38, 36864
    v_cvt_pk_bf16_f32 v44, v98, v102
    buffer_store_dword v44, v5, s[16:19], s38 offen offset:0 sc1
    v_cvt_pk_bf16_f32 v45, v106, v110
    buffer_store_dword v45, v7, s[16:19], s38 offen offset:0 sc1
    v_mfma_f32_16x16x32_bf16 v[124:127], v[28:31], v[64:67], v[124:127]
    v_cvt_pk_bf16_f32 v46, v99, v103
    buffer_store_dword v46, v5, s[16:19], s38 offen offset:2048 sc1
    v_mfma_f32_16x16x32_bf16 v[128:131], v[32:35], v[56:59], v[128:131]
    ds_read_b128 v[24:27], v2 offset:12288
    v_cvt_pk_bf16_f32 v47, v107, v111
    buffer_store_dword v47, v7, s[16:19], s38 offen offset:2048 sc1
    v_mfma_f32_16x16x32_bf16 v[132:135], v[32:35], v[60:63], v[132:135]
    ds_read_b128 v[28:31], v3 offset:12288
    v_mfma_f32_16x16x32_bf16 v[136:139], v[32:35], v[64:67], v[136:139]
    v_mfma_f32_16x16x32_bf16 v[140:143], v[32:35], v[68:71], v[140:143]
    s_mov_b32 s38, 65536
    v_cvt_pk_bf16_f32 v48, v112, v116
    buffer_store_dword v48, v5, s[16:19], s38 offen offset:0 sc1
    v_cvt_pk_bf16_f32 v49, v120, v124
    buffer_store_dword v49, v7, s[16:19], s38 offen offset:0 sc1
    v_mfma_f32_16x16x32_bf16 v[128:131], v[36:39], v[72:75], v[128:131]
    v_cvt_pk_bf16_f32 v50, v113, v117
    buffer_store_dword v50, v5, s[16:19], s38 offen offset:2048 sc1
    v_mfma_f32_16x16x32_bf16 v[132:135], v[36:39], v[56:59], v[132:135]
    v_cvt_pk_bf16_f32 v51, v121, v125
    buffer_store_dword v51, v7, s[16:19], s38 offen offset:2048 sc1
    v_mfma_f32_16x16x32_bf16 v[136:139], v[36:39], v[76:79], v[136:139]
    s_mov_b32 s38, 69632
    v_cvt_pk_bf16_f32 v52, v114, v118
    buffer_store_dword v52, v5, s[16:19], s38 offen offset:0 sc1
    v_cvt_pk_bf16_f32 v53, v122, v126
    buffer_store_dword v53, v7, s[16:19], s38 offen offset:0 sc1
    v_mfma_f32_16x16x32_bf16 v[140:143], v[36:39], v[64:67], v[140:143]
    v_cvt_pk_bf16_f32 v54, v115, v119
    buffer_store_dword v54, v5, s[16:19], s38 offen offset:2048 sc1
    s_waitcnt lgkmcnt(4)
    v_mfma_f32_16x16x32_bf16 v[144:147], v[8:11], v[56:59], v[144:147]
    ds_read_b128 v[32:35], v2 offset:14336
    v_cvt_pk_bf16_f32 v55, v123, v127
    buffer_store_dword v55, v7, s[16:19], s38 offen offset:2048 sc1
    v_mfma_f32_16x16x32_bf16 v[148:151], v[8:11], v[60:63], v[148:151]
    ds_read_b128 v[36:39], v3 offset:14336
    v_mfma_f32_16x16x32_bf16 v[152:155], v[8:11], v[64:67], v[152:155]
    v_mfma_f32_16x16x32_bf16 v[156:159], v[8:11], v[68:71], v[156:159]
    s_mov_b32 s38, 98304
    v_cvt_pk_bf16_f32 v40, v128, v132
    buffer_store_dword v40, v5, s[16:19], s38 offen offset:0 sc1
    v_cvt_pk_bf16_f32 v41, v136, v140
    buffer_store_dword v41, v7, s[16:19], s38 offen offset:0 sc1
    v_mfma_f32_16x16x32_bf16 v[144:147], v[12:15], v[72:75], v[144:147]
    v_cvt_pk_bf16_f32 v42, v129, v133
    buffer_store_dword v42, v5, s[16:19], s38 offen offset:2048 sc1
    v_mfma_f32_16x16x32_bf16 v[148:151], v[12:15], v[56:59], v[148:151]
    v_cvt_pk_bf16_f32 v43, v137, v141
    buffer_store_dword v43, v7, s[16:19], s38 offen offset:2048 sc1
    v_mfma_f32_16x16x32_bf16 v[152:155], v[12:15], v[76:79], v[152:155]
    s_mov_b32 s38, 102400
    v_cvt_pk_bf16_f32 v44, v130, v134
    buffer_store_dword v44, v5, s[16:19], s38 offen offset:0 sc1
    v_cvt_pk_bf16_f32 v45, v138, v142
    buffer_store_dword v45, v7, s[16:19], s38 offen offset:0 sc1
    v_mfma_f32_16x16x32_bf16 v[156:159], v[12:15], v[64:67], v[156:159]
    v_cvt_pk_bf16_f32 v46, v131, v135
    buffer_store_dword v46, v5, s[16:19], s38 offen offset:2048 sc1
    s_waitcnt lgkmcnt(4)
    v_mfma_f32_16x16x32_bf16 v[160:163], v[16:19], v[56:59], v[160:163]
    ds_read_b128 v[8:11], v2 offset:16384
    v_cvt_pk_bf16_f32 v47, v139, v143
    buffer_store_dword v47, v7, s[16:19], s38 offen offset:2048 sc1
    v_mfma_f32_16x16x32_bf16 v[164:167], v[16:19], v[60:63], v[164:167]
    ds_read_b128 v[12:15], v3 offset:16384
    v_mfma_f32_16x16x32_bf16 v[168:171], v[16:19], v[64:67], v[168:171]
    v_mfma_f32_16x16x32_bf16 v[172:175], v[16:19], v[68:71], v[172:175]
    s_mov_b32 s38, 131072
    v_cvt_pk_bf16_f32 v48, v144, v148
    buffer_store_dword v48, v5, s[16:19], s38 offen offset:0 sc1
    v_cvt_pk_bf16_f32 v49, v152, v156
    buffer_store_dword v49, v7, s[16:19], s38 offen offset:0 sc1
    v_mfma_f32_16x16x32_bf16 v[160:163], v[20:23], v[72:75], v[160:163]
    v_cvt_pk_bf16_f32 v50, v145, v149
    buffer_store_dword v50, v5, s[16:19], s38 offen offset:2048 sc1
    v_mfma_f32_16x16x32_bf16 v[164:167], v[20:23], v[56:59], v[164:167]
    v_cvt_pk_bf16_f32 v51, v153, v157
    buffer_store_dword v51, v7, s[16:19], s38 offen offset:2048 sc1
    v_mfma_f32_16x16x32_bf16 v[168:171], v[20:23], v[76:79], v[168:171]
    s_mov_b32 s38, 135168
    v_cvt_pk_bf16_f32 v52, v146, v150
    buffer_store_dword v52, v5, s[16:19], s38 offen offset:0 sc1
    v_cvt_pk_bf16_f32 v53, v154, v158
    buffer_store_dword v53, v7, s[16:19], s38 offen offset:0 sc1
    v_mfma_f32_16x16x32_bf16 v[172:175], v[20:23], v[64:67], v[172:175]
    v_cvt_pk_bf16_f32 v54, v147, v151
    buffer_store_dword v54, v5, s[16:19], s38 offen offset:2048 sc1
    s_waitcnt lgkmcnt(4)
    v_mfma_f32_16x16x32_bf16 v[176:179], v[24:27], v[56:59], v[176:179]
    ds_read_b128 v[16:19], v2 offset:18432
    v_cvt_pk_bf16_f32 v55, v155, v159
    buffer_store_dword v55, v7, s[16:19], s38 offen offset:2048 sc1
    v_mfma_f32_16x16x32_bf16 v[180:183], v[24:27], v[60:63], v[180:183]
    ds_read_b128 v[20:23], v3 offset:18432
    v_mfma_f32_16x16x32_bf16 v[184:187], v[24:27], v[64:67], v[184:187]
    v_mfma_f32_16x16x32_bf16 v[188:191], v[24:27], v[68:71], v[188:191]
    s_mov_b32 s38, 163840
    v_cvt_pk_bf16_f32 v40, v160, v164
    buffer_store_dword v40, v5, s[16:19], s38 offen offset:0 sc1
    v_cvt_pk_bf16_f32 v41, v168, v172
    buffer_store_dword v41, v7, s[16:19], s38 offen offset:0 sc1
    v_mfma_f32_16x16x32_bf16 v[176:179], v[28:31], v[72:75], v[176:179]
    v_cvt_pk_bf16_f32 v42, v161, v165
    buffer_store_dword v42, v5, s[16:19], s38 offen offset:2048 sc1
    v_mfma_f32_16x16x32_bf16 v[180:183], v[28:31], v[56:59], v[180:183]
    v_cvt_pk_bf16_f32 v43, v169, v173
    buffer_store_dword v43, v7, s[16:19], s38 offen offset:2048 sc1
    v_mfma_f32_16x16x32_bf16 v[184:187], v[28:31], v[76:79], v[184:187]
    s_mov_b32 s38, 167936
    v_cvt_pk_bf16_f32 v44, v162, v166
    buffer_store_dword v44, v5, s[16:19], s38 offen offset:0 sc1
    v_cvt_pk_bf16_f32 v45, v170, v174
    buffer_store_dword v45, v7, s[16:19], s38 offen offset:0 sc1
    v_mfma_f32_16x16x32_bf16 v[188:191], v[28:31], v[64:67], v[188:191]
    v_cvt_pk_bf16_f32 v46, v163, v167
    buffer_store_dword v46, v5, s[16:19], s38 offen offset:2048 sc1
    s_waitcnt lgkmcnt(4)
    v_mfma_f32_16x16x32_bf16 v[192:195], v[32:35], v[56:59], v[192:195]
    ds_read_b128 v[24:27], v2 offset:20480
    v_cvt_pk_bf16_f32 v47, v171, v175
    buffer_store_dword v47, v7, s[16:19], s38 offen offset:2048 sc1
    v_mfma_f32_16x16x32_bf16 v[196:199], v[32:35], v[60:63], v[196:199]
    ds_read_b128 v[28:31], v3 offset:20480
    v_mfma_f32_16x16x32_bf16 v[200:203], v[32:35], v[64:67], v[200:203]
    v_mfma_f32_16x16x32_bf16 v[204:207], v[32:35], v[68:71], v[204:207]
    s_mov_b32 s38, 196608
    v_cvt_pk_bf16_f32 v48, v176, v180
    buffer_store_dword v48, v5, s[16:19], s38 offen offset:0 sc1
    v_cvt_pk_bf16_f32 v49, v184, v188
    buffer_store_dword v49, v7, s[16:19], s38 offen offset:0 sc1
    v_mfma_f32_16x16x32_bf16 v[192:195], v[36:39], v[72:75], v[192:195]
    v_cvt_pk_bf16_f32 v50, v177, v181
    buffer_store_dword v50, v5, s[16:19], s38 offen offset:2048 sc1
    v_mfma_f32_16x16x32_bf16 v[196:199], v[36:39], v[56:59], v[196:199]
    v_cvt_pk_bf16_f32 v51, v185, v189
    buffer_store_dword v51, v7, s[16:19], s38 offen offset:2048 sc1
    v_mfma_f32_16x16x32_bf16 v[200:203], v[36:39], v[76:79], v[200:203]
    s_mov_b32 s38, 200704
    v_cvt_pk_bf16_f32 v52, v178, v182
    buffer_store_dword v52, v5, s[16:19], s38 offen offset:0 sc1
    v_cvt_pk_bf16_f32 v53, v186, v190
    buffer_store_dword v53, v7, s[16:19], s38 offen offset:0 sc1
    v_mfma_f32_16x16x32_bf16 v[204:207], v[36:39], v[64:67], v[204:207]
    v_cvt_pk_bf16_f32 v54, v179, v183
    buffer_store_dword v54, v5, s[16:19], s38 offen offset:2048 sc1
    s_waitcnt lgkmcnt(4)
    v_mfma_f32_16x16x32_bf16 v[208:211], v[8:11], v[56:59], v[208:211]
    v_cvt_pk_bf16_f32 v55, v187, v191
    buffer_store_dword v55, v7, s[16:19], s38 offen offset:2048 sc1
    v_mfma_f32_16x16x32_bf16 v[212:215], v[8:11], v[60:63], v[212:215]
    v_mfma_f32_16x16x32_bf16 v[216:219], v[8:11], v[64:67], v[216:219]
    v_mfma_f32_16x16x32_bf16 v[220:223], v[8:11], v[68:71], v[220:223]
    s_mov_b32 s38, 229376
    v_cvt_pk_bf16_f32 v40, v192, v196
    buffer_store_dword v40, v5, s[16:19], s38 offen offset:0 sc1
    v_cvt_pk_bf16_f32 v41, v200, v204
    buffer_store_dword v41, v7, s[16:19], s38 offen offset:0 sc1
    v_mfma_f32_16x16x32_bf16 v[208:211], v[12:15], v[72:75], v[208:211]
    v_cvt_pk_bf16_f32 v42, v193, v197
    buffer_store_dword v42, v5, s[16:19], s38 offen offset:2048 sc1
    v_mfma_f32_16x16x32_bf16 v[212:215], v[12:15], v[56:59], v[212:215]
    v_cvt_pk_bf16_f32 v43, v201, v205
    buffer_store_dword v43, v7, s[16:19], s38 offen offset:2048 sc1
    v_mfma_f32_16x16x32_bf16 v[216:219], v[12:15], v[76:79], v[216:219]
    s_mov_b32 s38, 233472
    v_cvt_pk_bf16_f32 v44, v194, v198
    buffer_store_dword v44, v5, s[16:19], s38 offen offset:0 sc1
    v_cvt_pk_bf16_f32 v45, v202, v206
    buffer_store_dword v45, v7, s[16:19], s38 offen offset:0 sc1
    v_mfma_f32_16x16x32_bf16 v[220:223], v[12:15], v[64:67], v[220:223]
    v_cvt_pk_bf16_f32 v46, v195, v199
    buffer_store_dword v46, v5, s[16:19], s38 offen offset:2048 sc1
    s_waitcnt lgkmcnt(2)
    v_mfma_f32_16x16x32_bf16 v[224:227], v[16:19], v[56:59], v[224:227]
    v_cvt_pk_bf16_f32 v47, v203, v207
    buffer_store_dword v47, v7, s[16:19], s38 offen offset:2048 sc1
    v_mfma_f32_16x16x32_bf16 v[228:231], v[16:19], v[60:63], v[228:231]
    v_mfma_f32_16x16x32_bf16 v[232:235], v[16:19], v[64:67], v[232:235]
    v_mfma_f32_16x16x32_bf16 v[236:239], v[16:19], v[68:71], v[236:239]
    s_mov_b32 s38, 262144
    v_cvt_pk_bf16_f32 v48, v208, v212
    buffer_store_dword v48, v5, s[16:19], s38 offen offset:0 sc1
    v_cvt_pk_bf16_f32 v49, v216, v220
    buffer_store_dword v49, v7, s[16:19], s38 offen offset:0 sc1
    v_mfma_f32_16x16x32_bf16 v[224:227], v[20:23], v[72:75], v[224:227]
    v_cvt_pk_bf16_f32 v50, v209, v213
    buffer_store_dword v50, v5, s[16:19], s38 offen offset:2048 sc1
    v_mfma_f32_16x16x32_bf16 v[228:231], v[20:23], v[56:59], v[228:231]
    v_cvt_pk_bf16_f32 v51, v217, v221
    buffer_store_dword v51, v7, s[16:19], s38 offen offset:2048 sc1
    v_mfma_f32_16x16x32_bf16 v[232:235], v[20:23], v[76:79], v[232:235]
    s_mov_b32 s38, 266240
    v_cvt_pk_bf16_f32 v52, v210, v214
    buffer_store_dword v52, v5, s[16:19], s38 offen offset:0 sc1
    v_cvt_pk_bf16_f32 v53, v218, v222
    buffer_store_dword v53, v7, s[16:19], s38 offen offset:0 sc1
    v_mfma_f32_16x16x32_bf16 v[236:239], v[20:23], v[64:67], v[236:239]
    v_cvt_pk_bf16_f32 v54, v211, v215
    buffer_store_dword v54, v5, s[16:19], s38 offen offset:2048 sc1
    s_waitcnt lgkmcnt(0)
    v_mfma_f32_16x16x32_bf16 v[240:243], v[24:27], v[56:59], v[240:243]
    v_cvt_pk_bf16_f32 v55, v219, v223
    buffer_store_dword v55, v7, s[16:19], s38 offen offset:2048 sc1
    v_mfma_f32_16x16x32_bf16 v[244:247], v[24:27], v[60:63], v[244:247]
    v_mfma_f32_16x16x32_bf16 v[240:243], v[28:31], v[72:75], v[240:243]
    v_mfma_f32_16x16x32_bf16 v[244:247], v[28:31], v[56:59], v[244:247]
    s_mov_b32 s38, 294912
    v_cvt_pk_bf16_f32 v40, v224, v228
    buffer_store_dword v40, v5, s[16:19], s38 offen offset:0 sc1
    v_cvt_pk_bf16_f32 v41, v232, v236
    buffer_store_dword v41, v7, s[16:19], s38 offen offset:0 sc1
    v_cvt_pk_bf16_f32 v42, v225, v229
    buffer_store_dword v42, v5, s[16:19], s38 offen offset:2048 sc1
    v_cvt_pk_bf16_f32 v43, v233, v237
    buffer_store_dword v43, v7, s[16:19], s38 offen offset:2048 sc1
    s_mov_b32 s38, 299008
    v_cvt_pk_bf16_f32 v44, v226, v230
    buffer_store_dword v44, v5, s[16:19], s38 offen offset:0 sc1
    v_cvt_pk_bf16_f32 v45, v234, v238
    buffer_store_dword v45, v7, s[16:19], s38 offen offset:0 sc1
    v_cvt_pk_bf16_f32 v46, v227, v231
    buffer_store_dword v46, v5, s[16:19], s38 offen offset:2048 sc1
    v_cvt_pk_bf16_f32 v47, v235, v239
    buffer_store_dword v47, v7, s[16:19], s38 offen offset:2048 sc1
    s_nop 7
    s_lshl_b32 s34, s27, 1
    s_mul_i32 s34, s34, 342016
    s_add_u32 s34, s34, 118489088
    s_add_u32 s64, s58, s34
    s_addc_u32 s65, s59, 0
    s_and_b32 s65, s65, 0xffff
    s_mov_b32 s66, 684032
    s_mov_b32 s67, 0x00020000
    v_lshrrev_b32 v8, 8, v1
    v_lshlrev_b32 v9, 13, v8
    v_sub_u32 v9, v5, v9
    v_lshlrev_b32 v8, 2, v8
    v_add_u32 v8, 160, v8
    v_add_u32 v10, 0, v8
    v_add_u32 v11, 160, v10
    v_cmp_gt_u32 vcc, 167, v10
    s_nop 1
    v_cndmask_b32 v11, v11, v10, vcc
    v_cmp_gt_u32 vcc, 174, v10
    v_mov_b32 v12, 0x7ffff
    s_nop 0
    v_cndmask_b32 v11, v12, v11, vcc
    v_lshl_add_u32 v16, v11, 11, v9
    v_add_u32 v10, 1, v8
    v_add_u32 v11, 160, v10
    v_cmp_gt_u32 vcc, 167, v10
    s_nop 1
    v_cndmask_b32 v11, v11, v10, vcc
    v_cmp_gt_u32 vcc, 174, v10
    v_mov_b32 v12, 0x7ffff
    s_nop 0
    v_cndmask_b32 v11, v12, v11, vcc
    v_lshl_add_u32 v17, v11, 11, v9
    v_add_u32 v10, 2, v8
    v_add_u32 v11, 160, v10
    v_cmp_gt_u32 vcc, 167, v10
    s_nop 1
    v_cndmask_b32 v11, v11, v10, vcc
    v_cmp_gt_u32 vcc, 174, v10
    v_mov_b32 v12, 0x7ffff
    s_nop 0
    v_cndmask_b32 v11, v12, v11, vcc
    v_lshl_add_u32 v18, v11, 11, v9
    v_add_u32 v10, 3, v8
    v_add_u32 v11, 160, v10
    v_cmp_gt_u32 vcc, 167, v10
    s_nop 1
    v_cndmask_b32 v11, v11, v10, vcc
    v_cmp_gt_u32 vcc, 174, v10
    v_mov_b32 v12, 0x7ffff
    s_nop 0
    v_cndmask_b32 v11, v12, v11, vcc
    v_lshl_add_u32 v19, v11, 11, v9
    v_cvt_pk_bf16_f32 v20, v240, v244
    buffer_store_dword v20, v16, s[64:67], 0 offen sc1
    v_cvt_pk_bf16_f32 v21, v241, v245
    buffer_store_dword v21, v17, s[64:67], 0 offen sc1
    v_cvt_pk_bf16_f32 v22, v242, v246
    buffer_store_dword v22, v18, s[64:67], 0 offen sc1
    v_cvt_pk_bf16_f32 v23, v243, v247
    buffer_store_dword v23, v19, s[64:67], 0 offen sc1
    s_endpgm
K12_S0:
    s_mov_b32 s61, 16384
    s_add_u32 s62, s62, 1
K12_S0_L:
    ds_read_b32 v56, v5
    s_waitcnt lgkmcnt(0)
    v_cmp_gt_u32 vcc, s40, v56
    s_sub_u32 s61, s61, 1
    s_cmp_eq_u32 s61, 0
    s_cbranch_scc1 K12_Q0
    s_cbranch_vccz K12_Q0
    s_branch K12_S0_L
K12_S1:
    s_mov_b32 s61, 16384
    s_add_u32 s62, s62, 1
K12_S1_L:
    ds_read_b32 v68, v5
    s_waitcnt lgkmcnt(0)
    v_cmp_gt_u32 vcc, s40, v68
    s_sub_u32 s61, s61, 1
    s_cmp_eq_u32 s61, 0
    s_cbranch_scc1 K12_Q1
    s_cbranch_vccz K12_Q1
    s_branch K12_S1_L
K12_F2:
    s_mov_b32 s61, 16384
    s_add_u32 s63, s63, 1
K12_F2_L:
    s_mov_b32 m0, s46
    s_mov_b64 exec, 0xff
    buffer_load_dword v1, s[4:7], 0 offen sc1 lds
    s_mov_b64 exec, -1
    s_waitcnt vmcnt(0)
    v_mov_b32 v0, s48
    ds_read_b32 v0, v0
    s_waitcnt lgkmcnt(0)
    v_cmp_eq_u32 vcc, 0, v0
    s_sub_u32 s61, s61, 1
    s_cmp_eq_u32 s61, 0
    s_cbranch_scc1 K12_F2_X
    s_cbranch_vccz K12_F2_X
    s_sleep 2
    s_branch K12_F2_L
K12_F2_X:
    s_branch K12_G2
K12_S3:
    s_mov_b32 s61, 16384
    s_add_u32 s62, s62, 1
K12_S3_L:
    ds_read_b32 v56, v5
    s_waitcnt lgkmcnt(0)
    v_cmp_gt_u32 vcc, s51, v56
    s_sub_u32 s61, s61, 1
    s_cmp_eq_u32 s61, 0
    s_cbranch_scc1 K12_Q3
    s_cbranch_vccz K12_Q3
    s_branch K12_S3_L
K12_S4:
    s_mov_b32 s61, 16384
    s_add_u32 s62, s62, 1
K12_S4_L:
    ds_read_b32 v52, v5
    s_waitcnt lgkmcnt(0)
    v_cmp_gt_u32 vcc, s40, v52
    s_sub_u32 s61, s61, 1
    s_cmp_eq_u32 s61, 0
    s_cbranch_scc1 K12_Q4
    s_cbranch_vccz K12_Q4
    s_branch K12_S4_L
K12_S5:
    s_mov_b32 s61, 16384
    s_add_u32 s62, s62, 1
K12_S5_L:
    ds_read_b32 v40, v5
    s_waitcnt lgkmcnt(0)
    v_cmp_gt_u32 vcc, s51, v40
    s_sub_u32 s61, s61, 1
    s_cmp_eq_u32 s61, 0
    s_cbranch_scc1 K12_Q5
    s_cbranch_vccz K12_Q5
    s_branch K12_S5_L
K12_S6:
    s_mov_b32 s61, 16384
    s_add_u32 s62, s62, 1
K12_S6_L:
    ds_read_b32 v68, v5
    s_waitcnt lgkmcnt(0)
    v_cmp_gt_u32 vcc, s40, v68
    s_sub_u32 s61, s61, 1
    s_cmp_eq_u32 s61, 0
    s_cbranch_scc1 K12_Q6
    s_cbranch_vccz K12_Q6
    s_branch K12_S6_L
K12_F7:
    s_mov_b32 s61, 16384
    s_add_u32 s63, s63, 1
K12_F7_L:
    s_mov_b32 m0, s46
    s_mov_b64 exec, 0xff
    buffer_load_dword v1, s[4:7], 0 offen sc1 lds
    s_mov_b64 exec, -1
    s_waitcnt vmcnt(0)
    v_mov_b32 v0, s48
    ds_read_b32 v0, v0
    s_waitcnt lgkmcnt(0)
    v_cmp_eq_u32 vcc, 0, v0
    s_sub_u32 s61, s61, 1
    s_cmp_eq_u32 s61, 0
    s_cbranch_scc1 K12_F7_X
    s_cbranch_vccz K12_F7_X
    s_sleep 2
    s_branch K12_F7_L
K12_F7_X:
    s_branch K12_G7
K12_S8:
    s_mov_b32 s61, 16384
    s_add_u32 s62, s62, 1
K12_S8_L:
    ds_read_b32 v56, v5
    s_waitcnt lgkmcnt(0)
    v_cmp_gt_u32 vcc, s51, v56
    s_sub_u32 s61, s61, 1
    s_cmp_eq_u32 s61, 0
    s_cbranch_scc1 K12_Q8
    s_cbranch_vccz K12_Q8
    s_branch K12_S8_L
K12_END:
    s_endpgm
.p2align 8
.type k34_out_kernel,@function
k34_out_kernel:
    s_cmp_ge_u32 s2, 256
    s_cbranch_scc1 K34_END
    s_load_dwordx2 s[4:5], s[0:1], 48
    s_load_dwordx4 s[40:43], s[0:1], 16
    s_load_dwordx2 s[44:45], s[0:1], 32
    v_lshrrev_b32 v1, 6, v0
    v_and_b32 v2, 63, v0
    v_readfirstlane_b32 s3, v1
    s_and_b32 s6, s2, 15
    s_lshr_b32 s7, s2, 4
    s_lshr_b32 s20, s6, 3
    s_and_b32 s21, s6, 7
    s_mul_i32 s22, s7, 11
    s_mul_i32 s23, s7, 10
    s_add_u32 s23, s23, 7
    s_cmp_lt_u32 s7, 7
    s_cselect_b32 s22, s22, s23
    s_cselect_b32 s23, 11, 10
    s_add_u32 s22, s22, s3
    v_and_b32 v3, 15, v2
    v_lshrrev_b32 v4, 4, v2
    v_lshlrev_b32 v5, 4, v2
    s_mov_b32 s24, 2736128
    v_mul_lo_u32 v6, v4, s24
    v_lshl_add_u32 v6, v3, 4, v6
    s_mul_i32 s25, s20, 167
    s_add_u32 s25, s25, s22
    s_lshl_b32 s25, s25, 11
    s_lshl_b32 s24, s21, 8
    s_add_u32 s25, s25, s24
    s_waitcnt lgkmcnt(0)
    s_add_u32 s8, s4, 118489088
    s_addc_u32 s9, s5, 0
    s_and_b32 s9, s9, 0xffff
    s_mov_b32 s10, 21889024
    s_mov_b32 s11, 0x00020000
    s_add_u32 s12, s4, 153616384
    s_addc_u32 s13, s5, 0
    s_and_b32 s13, s13, 0xffff
    s_mov_b32 s14, 131072
    s_mov_b32 s15, 0x00020000
    s_cmp_lt_u32 s3, s23
    s_cbranch_scc0 K34_NOLOAD
    buffer_load_dwordx4 v[16:19], v6, s[8:11], s25 offen
    s_add_u32 s25, s25, 684032
    buffer_load_dwordx4 v[20:23], v6, s[8:11], s25 offen
    s_add_u32 s25, s25, 684032
    buffer_load_dwordx4 v[24:27], v6, s[8:11], s25 offen
    s_add_u32 s25, s25, 684032
    buffer_load_dwordx4 v[28:31], v6, s[8:11], s25 offen
    s_add_u32 s25, s25, 8892416
    buffer_load_dwordx4 v[32:35], v6, s[8:11], s25 offen
    s_add_u32 s25, s25, 684032
    buffer_load_dwordx4 v[36:39], v6, s[8:11], s25 offen
    s_add_u32 s25, s25, 684032
    buffer_load_dwordx4 v[40:43], v6, s[8:11], s25 offen
    s_add_u32 s25, s25, 684032
    buffer_load_dwordx4 v[44:47], v6, s[8:11], s25 offen
K34_NOLOAD:
    s_cmp_lg_u32 s3, 0
    s_cbranch_scc1 K34_TAB
    s_mov_b32 s16, s40
    s_mov_b32 s17, s41
    s_and_b32 s17, s17, 0xffff
    s_mov_b32 s18, 1024
    s_mov_b32 s19, 0x00020000
    s_mov_b32 s28, s42
    s_mov_b32 s29, s43
    s_and_b32 s29, s29, 0xffff
    s_mov_b32 s30, 1024
    s_mov_b32 s31, 0x00020000
    s_lshl_b32 s24, s21, 7
    v_lshlrev_b32 v8, 1, v2
    buffer_load_ushort v152, v8, s[16:19], s24 offen
    buffer_load_ushort v153, v8, s[28:31], s24 offen
    s_branch K34_TABDONE
K34_TAB:
    s_cmp_ge_u32 s3, 7
    s_cbranch_scc1 K34_TABDONE
    s_sub_u32 s27, s3, 1
    s_lshr_b32 s28, s27, 1
    s_and_b32 s29, s27, 1
    s_lshl_b32 s30, s28, 4
    v_add_u32 v8, s30, v3
    s_lshl_b32 s30, s29, 5
    s_add_u32 s30, s30, 1
    v_lshlrev_b32 v9, 3, v4
    v_add_u32 v9, s30, v9
    v_mul_u32_u24 v9, v8, v9
    v_lshlrev_b32 v8, 1, v8
    v_mad_u32_u24 v48, v8, 0, v9
    v_mad_u32_u24 v49, v8, 0, v9
    v_add_u32 v49, 32, v49
    v_mad_u32_u24 v50, v8, 1, v9
    v_mad_u32_u24 v51, v8, 1, v9
    v_add_u32 v51, 32, v51
    v_mad_u32_u24 v52, v8, 2, v9
    v_mad_u32_u24 v53, v8, 2, v9
    v_add_u32 v53, 32, v53
    v_mad_u32_u24 v54, v8, 3, v9
    v_mad_u32_u24 v55, v8, 3, v9
    v_add_u32 v55, 32, v55
    v_and_b32 v48, 127, v48
    v_and_b32 v49, 127, v49
    v_and_b32 v50, 127, v50
    v_and_b32 v51, 127, v51
    v_and_b32 v52, 127, v52
    v_and_b32 v53, 127, v53
    v_and_b32 v54, 127, v54
    v_and_b32 v55, 127, v55
    v_cvt_f32_u32 v48, v48
    v_cvt_f32_u32 v49, v49
    v_cvt_f32_u32 v50, v50
    v_cvt_f32_u32 v51, v51
    v_cvt_f32_u32 v52, v52
    v_cvt_f32_u32 v53, v53
    v_cvt_f32_u32 v54, v54
    v_cvt_f32_u32 v55, v55
    v_mul_f32 v48, 0x3c000000, v48
    v_mul_f32 v49, 0x3c000000, v49
    v_mul_f32 v50, 0x3c000000, v50
    v_mul_f32 v51, 0x3c000000, v51
    v_mul_f32 v52, 0x3c000000, v52
    v_mul_f32 v53, 0x3c000000, v53
    v_mul_f32 v54, 0x3c000000, v54
    v_mul_f32 v55, 0x3c000000, v55
    v_cos_f32 v48, v48
    v_cos_f32 v49, v49
    v_cos_f32 v50, v50
    v_cos_f32 v51, v51
    v_cos_f32 v52, v52
    v_cos_f32 v53, v53
    v_cos_f32 v54, v54
    v_cos_f32 v55, v55
    s_nop 0
    v_mul_f32 v48, 0x3d000000, v48
    v_mul_f32 v49, 0x3d000000, v49
    v_mul_f32 v50, 0x3d000000, v50
    v_mul_f32 v51, 0x3d000000, v51
    v_mul_f32 v52, 0x3d000000, v52
    v_mul_f32 v53, 0x3d000000, v53
    v_mul_f32 v54, 0x3d000000, v54
    v_mul_f32 v55, 0x3d000000, v55
    v_cvt_pk_bf16_f32 v56, v48, v49
    v_cvt_pk_bf16_f32 v57, v50, v51
    v_cvt_pk_bf16_f32 v58, v52, v53
    v_cvt_pk_bf16_f32 v59, v54, v55
    v_lshlrev_b32 v64, 16, v56
    v_and_b32 v65, 0xffff0000, v56
    v_sub_f32 v48, v48, v64
    v_sub_f32 v49, v49, v65
    v_lshlrev_b32 v64, 16, v57
    v_and_b32 v65, 0xffff0000, v57
    v_sub_f32 v50, v50, v64
    v_sub_f32 v51, v51, v65
    v_lshlrev_b32 v64, 16, v58
    v_and_b32 v65, 0xffff0000, v58
    v_sub_f32 v52, v52, v64
    v_sub_f32 v53, v53, v65
    v_lshlrev_b32 v64, 16, v59
    v_and_b32 v65, 0xffff0000, v59
    v_sub_f32 v54, v54, v64
    v_sub_f32 v55, v55, v65
    v_cvt_pk_bf16_f32 v60, v48, v49
    v_cvt_pk_bf16_f32 v61, v50, v51
    v_cvt_pk_bf16_f32 v62, v52, v53
    v_cvt_pk_bf16_f32 v63, v54, v55
    s_lshl_b32 s30, s27, 11
    v_add_u32 v10, s30, v5
    ds_write_b128 v10, v[56:59]
    ds_write_b128 v10, v[60:63] offset:1024
K34_TABDONE:
    s_waitcnt lgkmcnt(0)
    s_barrier
    s_cmp_lt_u32 s3, s23
    s_cbranch_scc0 K34_IDLE
    ds_read_b128 v[48:51], v5 offset:0
    ds_read_b128 v[52:55], v5 offset:1024
    ds_read_b128 v[56:59], v5 offset:2048
    ds_read_b128 v[60:63], v5 offset:3072
    ds_read_b128 v[64:67], v5 offset:4096
    ds_read_b128 v[68:71], v5 offset:5120
    ds_read_b128 v[72:75], v5 offset:6144
    ds_read_b128 v[76:79], v5 offset:7168
    ds_read_b128 v[80:83], v5 offset:8192
    ds_read_b128 v[84:87], v5 offset:9216
    ds_read_b128 v[88:91], v5 offset:10240
    ds_read_b128 v[92:95], v5 offset:11264
    s_waitcnt vmcnt(0)
    v_swap_b32 v17, v20
    v_swap_b32 v18, v24
    v_swap_b32 v19, v28
    v_swap_b32 v22, v25
    v_swap_b32 v23, v29
    v_swap_b32 v27, v30
    v_swap_b32 v33, v36
    v_swap_b32 v34, v40
    v_swap_b32 v35, v44
    v_swap_b32 v38, v41
    v_swap_b32 v39, v45
    v_swap_b32 v43, v46
    s_waitcnt lgkmcnt(0)
    s_mul_i32 s24, s22, 48
    s_sub_u32 s24, 7985, s24
    s_cmp_ge_u32 s24, 48
    s_cbranch_scc1 K34_FULL
    v_add_u32 v7, 0, v3
    v_cmp_gt_u32 vcc, s24, v7
    s_nop 1
    v_cndmask_b32 v48, 0, v48, vcc
    v_cndmask_b32 v49, 0, v49, vcc
    v_cndmask_b32 v50, 0, v50, vcc
    v_cndmask_b32 v51, 0, v51, vcc
    v_cndmask_b32 v52, 0, v52, vcc
    v_cndmask_b32 v53, 0, v53, vcc
    v_cndmask_b32 v54, 0, v54, vcc
    v_cndmask_b32 v55, 0, v55, vcc
    v_cndmask_b32 v56, 0, v56, vcc
    v_cndmask_b32 v57, 0, v57, vcc
    v_cndmask_b32 v58, 0, v58, vcc
    v_cndmask_b32 v59, 0, v59, vcc
    v_cndmask_b32 v60, 0, v60, vcc
    v_cndmask_b32 v61, 0, v61, vcc
    v_cndmask_b32 v62, 0, v62, vcc
    v_cndmask_b32 v63, 0, v63, vcc
    v_add_u32 v7, 16, v3
    v_cmp_gt_u32 vcc, s24, v7
    s_nop 1
    v_cndmask_b32 v64, 0, v64, vcc
    v_cndmask_b32 v65, 0, v65, vcc
    v_cndmask_b32 v66, 0, v66, vcc
    v_cndmask_b32 v67, 0, v67, vcc
    v_cndmask_b32 v68, 0, v68, vcc
    v_cndmask_b32 v69, 0, v69, vcc
    v_cndmask_b32 v70, 0, v70, vcc
    v_cndmask_b32 v71, 0, v71, vcc
    v_cndmask_b32 v72, 0, v72, vcc
    v_cndmask_b32 v73, 0, v73, vcc
    v_cndmask_b32 v74, 0, v74, vcc
    v_cndmask_b32 v75, 0, v75, vcc
    v_cndmask_b32 v76, 0, v76, vcc
    v_cndmask_b32 v77, 0, v77, vcc
    v_cndmask_b32 v78, 0, v78, vcc
    v_cndmask_b32 v79, 0, v79, vcc
    v_add_u32 v7, 32, v3
    v_cmp_gt_u32 vcc, s24, v7
    s_nop 1
    v_cndmask_b32 v80, 0, v80, vcc
    v_cndmask_b32 v81, 0, v81, vcc
    v_cndmask_b32 v82, 0, v82, vcc
    v_cndmask_b32 v83, 0, v83, vcc
    v_cndmask_b32 v84, 0, v84, vcc
    v_cndmask_b32 v85, 0, v85, vcc
    v_cndmask_b32 v86, 0, v86, vcc
    v_cndmask_b32 v87, 0, v87, vcc
    v_cndmask_b32 v88, 0, v88, vcc
    v_cndmask_b32 v89, 0, v89, vcc
    v_cndmask_b32 v90, 0, v90, vcc
    v_cndmask_b32 v91, 0, v91, vcc
    v_cndmask_b32 v92, 0, v92, vcc
    v_cndmask_b32 v93, 0, v93, vcc
    v_cndmask_b32 v94, 0, v94, vcc
    v_cndmask_b32 v95, 0, v95, vcc
K34_FULL:
    s_nop 1
    v_mfma_f32_16x16x32_bf16 v[96:99], v[48:51], v[16:19], 0
    v_mfma_f32_16x16x32_bf16 v[100:103], v[48:51], v[20:23], 0
    v_mfma_f32_16x16x32_bf16 v[104:107], v[48:51], v[24:27], 0
    v_mfma_f32_16x16x32_bf16 v[108:111], v[48:51], v[28:31], 0
    v_mfma_f32_16x16x32_bf16 v[96:99], v[52:55], v[16:19], v[96:99]
    v_mfma_f32_16x16x32_bf16 v[100:103], v[52:55], v[20:23], v[100:103]
    v_mfma_f32_16x16x32_bf16 v[104:107], v[52:55], v[24:27], v[104:107]
    v_mfma_f32_16x16x32_bf16 v[108:111], v[52:55], v[28:31], v[108:111]
    v_mfma_f32_16x16x32_bf16 v[96:99], v[56:59], v[32:35], v[96:99]
    v_mfma_f32_16x16x32_bf16 v[100:103], v[56:59], v[36:39], v[100:103]
    v_mfma_f32_16x16x32_bf16 v[104:107], v[56:59], v[40:43], v[104:107]
    v_mfma_f32_16x16x32_bf16 v[108:111], v[56:59], v[44:47], v[108:111]
    v_mfma_f32_16x16x32_bf16 v[96:99], v[60:63], v[32:35], v[96:99]
    v_mfma_f32_16x16x32_bf16 v[100:103], v[60:63], v[36:39], v[100:103]
    v_mfma_f32_16x16x32_bf16 v[104:107], v[60:63], v[40:43], v[104:107]
    v_mfma_f32_16x16x32_bf16 v[108:111], v[60:63], v[44:47], v[108:111]
    v_mfma_f32_16x16x32_bf16 v[112:115], v[64:67], v[16:19], 0
    v_mfma_f32_16x16x32_bf16 v[116:119], v[64:67], v[20:23], 0
    v_mfma_f32_16x16x32_bf16 v[120:123], v[64:67], v[24:27], 0
    v_mfma_f32_16x16x32_bf16 v[124:127], v[64:67], v[28:31], 0
    v_mfma_f32_16x16x32_bf16 v[112:115], v[68:71], v[16:19], v[112:115]
    v_mfma_f32_16x16x32_bf16 v[116:119], v[68:71], v[20:23], v[116:119]
    v_mfma_f32_16x16x32_bf16 v[120:123], v[68:71], v[24:27], v[120:123]
    v_mfma_f32_16x16x32_bf16 v[124:127], v[68:71], v[28:31], v[124:127]
    v_mfma_f32_16x16x32_bf16 v[112:115], v[72:75], v[32:35], v[112:115]
    v_mfma_f32_16x16x32_bf16 v[116:119], v[72:75], v[36:39], v[116:119]
    v_mfma_f32_16x16x32_bf16 v[120:123], v[72:75], v[40:43], v[120:123]
    v_mfma_f32_16x16x32_bf16 v[124:127], v[72:75], v[44:47], v[124:127]
    v_mfma_f32_16x16x32_bf16 v[112:115], v[76:79], v[32:35], v[112:115]
    v_mfma_f32_16x16x32_bf16 v[116:119], v[76:79], v[36:39], v[116:119]
    v_mfma_f32_16x16x32_bf16 v[120:123], v[76:79], v[40:43], v[120:123]
    v_mfma_f32_16x16x32_bf16 v[124:127], v[76:79], v[44:47], v[124:127]
    v_mfma_f32_16x16x32_bf16 v[128:131], v[80:83], v[16:19], 0
    v_mfma_f32_16x16x32_bf16 v[132:135], v[80:83], v[20:23], 0
    v_mfma_f32_16x16x32_bf16 v[136:139], v[80:83], v[24:27], 0
    v_mfma_f32_16x16x32_bf16 v[140:143], v[80:83], v[28:31], 0
    v_mfma_f32_16x16x32_bf16 v[128:131], v[84:87], v[16:19], v[128:131]
    v_mfma_f32_16x16x32_bf16 v[132:135], v[84:87], v[20:23], v[132:135]
    v_mfma_f32_16x16x32_bf16 v[136:139], v[84:87], v[24:27], v[136:139]
    v_mfma_f32_16x16x32_bf16 v[140:143], v[84:87], v[28:31], v[140:143]
    v_mfma_f32_16x16x32_bf16 v[128:131], v[88:91], v[32:35], v[128:131]
    v_mfma_f32_16x16x32_bf16 v[132:135], v[88:91], v[36:39], v[132:135]
    v_mfma_f32_16x16x32_bf16 v[136:139], v[88:91], v[40:43], v[136:139]
    v_mfma_f32_16x16x32_bf16 v[140:143], v[88:91], v[44:47], v[140:143]
    v_mfma_f32_16x16x32_bf16 v[128:131], v[92:95], v[32:35], v[128:131]
    v_mfma_f32_16x16x32_bf16 v[132:135], v[92:95], v[36:39], v[132:135]
    v_mfma_f32_16x16x32_bf16 v[136:139], v[92:95], v[40:43], v[136:139]
    v_mfma_f32_16x16x32_bf16 v[140:143], v[92:95], v[44:47], v[140:143]
    s_nop 7
    v_mov_b32 v16, v96
    v_mul_f32 v20, v96, v96
    v_mov_b32 v17, v100
    v_mul_f32 v21, v100, v100
    v_mov_b32 v18, v104
    v_mul_f32 v22, v104, v104
    v_mov_b32 v19, v108
    v_mul_f32 v23, v108, v108
    v_add_f32 v16, v16, v97
    v_fmac_f32 v20, v97, v97
    v_add_f32 v17, v17, v101
    v_fmac_f32 v21, v101, v101
    v_add_f32 v18, v18, v105
    v_fmac_f32 v22, v105, v105
    v_add_f32 v19, v19, v109
    v_fmac_f32 v23, v109, v109
    v_add_f32 v16, v16, v98
    v_fmac_f32 v20, v98, v98
    v_add_f32 v17, v17, v102
    v_fmac_f32 v21, v102, v102
    v_add_f32 v18, v18, v106
    v_fmac_f32 v22, v106, v106
    v_add_f32 v19, v19, v110
    v_fmac_f32 v23, v110, v110
    v_add_f32 v16, v16, v99
    v_fmac_f32 v20, v99, v99
    v_add_f32 v17, v17, v103
    v_fmac_f32 v21, v103, v103
    v_add_f32 v18, v18, v107
    v_fmac_f32 v22, v107, v107
    v_add_f32 v19, v19, v111
    v_fmac_f32 v23, v111, v111
    v_add_f32 v16, v16, v112
    v_fmac_f32 v20, v112, v112
    v_add_f32 v17, v17, v116
    v_fmac_f32 v21, v116, v116
    v_add_f32 v18, v18, v120
    v_fmac_f32 v22, v120, v120
    v_add_f32 v19, v19, v124
    v_fmac_f32 v23, v124, v124
    v_add_f32 v16, v16, v113
    v_fmac_f32 v20, v113, v113
    v_add_f32 v17, v17, v117
    v_fmac_f32 v21, v117, v117
    v_add_f32 v18, v18, v121
    v_fmac_f32 v22, v121, v121
    v_add_f32 v19, v19, v125
    v_fmac_f32 v23, v125, v125
    v_add_f32 v16, v16, v114
    v_fmac_f32 v20, v114, v114
    v_add_f32 v17, v17, v118
    v_fmac_f32 v21, v118, v118
    v_add_f32 v18, v18, v122
    v_fmac_f32 v22, v122, v122
    v_add_f32 v19, v19, v126
    v_fmac_f32 v23, v126, v126
    v_add_f32 v16, v16, v115
    v_fmac_f32 v20, v115, v115
    v_add_f32 v17, v17, v119
    v_fmac_f32 v21, v119, v119
    v_add_f32 v18, v18, v123
    v_fmac_f32 v22, v123, v123
    v_add_f32 v19, v19, v127
    v_fmac_f32 v23, v127, v127
    v_add_f32 v16, v16, v128
    v_fmac_f32 v20, v128, v128
    v_add_f32 v17, v17, v132
    v_fmac_f32 v21, v132, v132
    v_add_f32 v18, v18, v136
    v_fmac_f32 v22, v136, v136
    v_add_f32 v19, v19, v140
    v_fmac_f32 v23, v140, v140
    v_add_f32 v16, v16, v129
    v_fmac_f32 v20, v129, v129
    v_add_f32 v17, v17, v133
    v_fmac_f32 v21, v133, v133
    v_add_f32 v18, v18, v137
    v_fmac_f32 v22, v137, v137
    v_add_f32 v19, v19, v141
    v_fmac_f32 v23, v141, v141
    v_add_f32 v16, v16, v130
    v_fmac_f32 v20, v130, v130
    v_add_f32 v17, v17, v134
    v_fmac_f32 v21, v134, v134
    v_add_f32 v18, v18, v138
    v_fmac_f32 v22, v138, v138
    v_add_f32 v19, v19, v142
    v_fmac_f32 v23, v142, v142
    v_add_f32 v16, v16, v131
    v_fmac_f32 v20, v131, v131
    v_add_f32 v17, v17, v135
    v_fmac_f32 v21, v135, v135
    v_add_f32 v18, v18, v139
    v_fmac_f32 v22, v139, v139
    v_add_f32 v19, v19, v143
    v_fmac_f32 v23, v143, v143
    v_mov_b32 v24, v16
    v_mov_b32 v25, v17
    v_mov_b32 v26, v18
    v_mov_b32 v27, v19
    v_mov_b32 v28, v20
    v_mov_b32 v29, v21
    v_mov_b32 v30, v22
    v_mov_b32 v31, v23
    s_nop 0
    v_permlane32_swap_b32 v16, v24
    v_permlane32_swap_b32 v17, v25
    v_permlane32_swap_b32 v18, v26
    v_permlane32_swap_b32 v19, v27
    v_permlane32_swap_b32 v20, v28
    v_permlane32_swap_b32 v21, v29
    v_permlane32_swap_b32 v22, v30
    v_permlane32_swap_b32 v23, v31
    v_add_f32 v16, v16, v24
    v_add_f32 v17, v17, v25
    v_add_f32 v18, v18, v26
    v_add_f32 v19, v19, v27
    v_add_f32 v20, v20, v28
    v_add_f32 v21, v21, v29
    v_add_f32 v22, v22, v30
    v_add_f32 v23, v23, v31
    v_mov_b32 v24, v16
    v_mov_b32 v25, v17
    v_mov_b32 v26, v18
    v_mov_b32 v27, v19
    v_mov_b32 v28, v20
    v_mov_b32 v29, v21
    v_mov_b32 v30, v22
    v_mov_b32 v31, v23
    s_nop 0
    v_permlane16_swap_b32 v16, v24
    v_permlane16_swap_b32 v17, v25
    v_permlane16_swap_b32 v18, v26
    v_permlane16_swap_b32 v19, v27
    v_permlane16_swap_b32 v20, v28
    v_permlane16_swap_b32 v21, v29
    v_permlane16_swap_b32 v22, v30
    v_permlane16_swap_b32 v23, v31
    v_add_f32 v16, v16, v24
    v_add_f32 v17, v17, v25
    v_add_f32 v18, v18, v26
    v_add_f32 v19, v19, v27
    v_add_f32 v20, v20, v28
    v_add_f32 v21, v21, v29
    v_add_f32 v22, v22, v30
    v_add_f32 v23, v23, v31
    s_branch K34_WR
K34_IDLE:
    v_mov_b32 v16, 0
    v_mov_b32 v17, 0
    v_mov_b32 v18, 0
    v_mov_b32 v19, 0
    v_mov_b32 v20, 0
    v_mov_b32 v21, 0
    v_mov_b32 v22, 0
    v_mov_b32 v23, 0
K34_WR:
    s_lshl_b32 s24, s3, 9
    v_lshlrev_b32 v7, 4, v3
    v_add_u32 v7, s24, v7
    ds_write_b128 v7, v[16:19] offset:12288
    ds_write_b128 v7, v[20:23] offset:12544
    s_waitcnt lgkmcnt(0)
    s_barrier
    s_cmp_lg_u32 s3, 0
    s_cbranch_scc1 K34_WAIT
    v_lshlrev_b32 v7, 2, v2
    ds_read_b32 v16, v7 offset:12288
    ds_read_b32 v17, v7 offset:12800
    ds_read_b32 v18, v7 offset:13312
    ds_read_b32 v19, v7 offset:13824
    ds_read_b32 v20, v7 offset:14336
    ds_read_b32 v21, v7 offset:14848
    ds_read_b32 v22, v7 offset:15360
    ds_read_b32 v23, v7 offset:15872
    ds_read_b32 v24, v7 offset:16384
    ds_read_b32 v25, v7 offset:16896
    ds_read_b32 v26, v7 offset:17408
    ds_read_b32 v27, v7 offset:17920
    s_waitcnt lgkmcnt(0)
    ds_read_b32 v32, v7 offset:12544
    ds_read_b32 v33, v7 offset:13056
    ds_read_b32 v34, v7 offset:13568
    ds_read_b32 v35, v7 offset:14080
    ds_read_b32 v36, v7 offset:14592
    ds_read_b32 v37, v7 offset:15104
    ds_read_b32 v38, v7 offset:15616
    ds_read_b32 v39, v7 offset:16128
    ds_read_b32 v40, v7 offset:16640
    ds_read_b32 v41, v7 offset:17152
    ds_read_b32 v42, v7 offset:17664
    ds_read_b32 v43, v7 offset:18176
    v_add_f32 v16, v16, v17
    v_add_f32 v16, v16, v18
    v_add_f32 v16, v16, v19
    v_add_f32 v16, v16, v20
    v_add_f32 v16, v16, v21
    v_add_f32 v16, v16, v22
    v_add_f32 v16, v16, v23
    v_add_f32 v16, v16, v24
    v_add_f32 v16, v16, v25
    v_add_f32 v16, v16, v26
    v_add_f32 v16, v16, v27
    s_waitcnt lgkmcnt(0)
    v_add_f32 v32, v32, v33
    v_add_f32 v32, v32, v34
    v_add_f32 v32, v32, v35
    v_add_f32 v32, v32, v36
    v_add_f32 v32, v32, v37
    v_add_f32 v32, v32, v38
    v_add_f32 v32, v32, v39
    v_add_f32 v32, v32, v40
    v_add_f32 v32, v32, v41
    v_add_f32 v32, v32, v42
    v_add_f32 v32, v32, v43
    s_lshl_b32 s24, s6, 4
    s_add_u32 s24, s24, s7
    s_lshl_b32 s24, s24, 9
    buffer_store_dword v16, v7, s[12:15], s24 offen sc1
    buffer_store_dword v32, v7, s[12:15], s24 offen offset:256 sc1
    s_mov_b32 s26, 20000
K34_POLL:
    s_lshl_b32 s24, s6, 13
    buffer_load_dword v16, v7, s[12:15], s24 offen offset:0 sc1
    buffer_load_dword v32, v7, s[12:15], s24 offen offset:256 sc1
    buffer_load_dword v17, v7, s[12:15], s24 offen offset:512 sc1
    buffer_load_dword v33, v7, s[12:15], s24 offen offset:768 sc1
    buffer_load_dword v18, v7, s[12:15], s24 offen offset:1024 sc1
    buffer_load_dword v34, v7, s[12:15], s24 offen offset:1280 sc1
    buffer_load_dword v19, v7, s[12:15], s24 offen offset:1536 sc1
    buffer_load_dword v35, v7, s[12:15], s24 offen offset:1792 sc1
    buffer_load_dword v20, v7, s[12:15], s24 offen offset:2048 sc1
    buffer_load_dword v36, v7, s[12:15], s24 offen offset:2304 sc1
    buffer_load_dword v21, v7, s[12:15], s24 offen offset:2560 sc1
    buffer_load_dword v37, v7, s[12:15], s24 offen offset:2816 sc1
    buffer_load_dword v22, v7, s[12:15], s24 offen offset:3072 sc1
    buffer_load_dword v38, v7, s[12:15], s24 offen offset:3328 sc1
    buffer_load_dword v23, v7, s[12:15], s24 offen offset:3584 sc1
    buffer_load_dword v39, v7, s[12:15], s24 offen offset:3840 sc1
    s_add_u32 s24, s24, 4096
    buffer_load_dword v24, v7, s[12:15], s24 offen offset:0 sc1
    buffer_load_dword v40, v7, s[12:15], s24 offen offset:256 sc1
    buffer_load_dword v25, v7, s[12:15], s24 offen offset:512 sc1
    buffer_load_dword v41, v7, s[12:15], s24 offen offset:768 sc1
    buffer_load_dword v26, v7, s[12:15], s24 offen offset:1024 sc1
    buffer_load_dword v42, v7, s[12:15], s24 offen offset:1280 sc1
    buffer_load_dword v27, v7, s[12:15], s24 offen offset:1536 sc1
    buffer_load_dword v43, v7, s[12:15], s24 offen offset:1792 sc1
    buffer_load_dword v28, v7, s[12:15], s24 offen offset:2048 sc1
    buffer_load_dword v44, v7, s[12:15], s24 offen offset:2304 sc1
    buffer_load_dword v29, v7, s[12:15], s24 offen offset:2560 sc1
    buffer_load_dword v45, v7, s[12:15], s24 offen offset:2816 sc1
    buffer_load_dword v30, v7, s[12:15], s24 offen offset:3072 sc1
    buffer_load_dword v46, v7, s[12:15], s24 offen offset:3328 sc1
    buffer_load_dword v31, v7, s[12:15], s24 offen offset:3584 sc1
    buffer_load_dword v47, v7, s[12:15], s24 offen offset:3840 sc1
    s_waitcnt vmcnt(0)
    v_max3_u32 v48, v16, v17, v18
    v_max3_u32 v48, v48, v19, v20
    v_max3_u32 v48, v48, v21, v22
    v_max3_u32 v48, v48, v23, v24
    v_max3_u32 v48, v48, v25, v26
    v_max3_u32 v48, v48, v27, v28
    v_max3_u32 v48, v48, v29, v30
    v_max3_u32 v48, v48, v31, v32
    v_max3_u32 v48, v48, v33, v34
    v_max3_u32 v48, v48, v35, v36
    v_max3_u32 v48, v48, v37, v38
    v_max3_u32 v48, v48, v39, v40
    v_max3_u32 v48, v48, v41, v42
    v_max3_u32 v48, v48, v43, v44
    v_max3_u32 v48, v48, v45, v46
    v_max_u32 v48, v48, v47
    v_cmp_eq_u32 vcc, -1, v48
    s_sub_u32 s26, s26, 1
    s_cmp_eq_u32 s26, 0
    s_cbranch_scc1 K34_GOT
    s_cbranch_vccz K34_GOT
    s_sleep 1
    s_branch K34_POLL
K34_GOT:
    v_add_f32 v16, v16, v24
    v_add_f32 v32, v32, v40
    v_add_f32 v17, v17, v25
    v_add_f32 v33, v33, v41
    v_add_f32 v18, v18, v26
    v_add_f32 v34, v34, v42
    v_add_f32 v19, v19, v27
    v_add_f32 v35, v35, v43
    v_add_f32 v20, v20, v28
    v_add_f32 v36, v36, v44
    v_add_f32 v21, v21, v29
    v_add_f32 v37, v37, v45
    v_add_f32 v22, v22, v30
    v_add_f32 v38, v38, v46
    v_add_f32 v23, v23, v31
    v_add_f32 v39, v39, v47
    v_add_f32 v16, v16, v20
    v_add_f32 v32, v32, v36
    v_add_f32 v17, v17, v21
    v_add_f32 v33, v33, v37
    v_add_f32 v18, v18, v22
    v_add_f32 v34, v34, v38
    v_add_f32 v19, v19, v23
    v_add_f32 v35, v35, v39
    v_add_f32 v16, v16, v18
    v_add_f32 v32, v32, v34
    v_add_f32 v17, v17, v19
    v_add_f32 v33, v33, v35
    v_add_f32 v16, v16, v17
    v_add_f32 v32, v32, v33
    v_mul_f32 v11, 0x39035177, v16
    v_mul_f32 v12, 0x39035177, v32
    v_fma_f32 v12, -v11, v11, v12
    v_max_f32 v12, 0, v12
    v_add_f32 v12, 0x3727c5ac, v12
    v_sqrt_f32 v12, v12
    v_lshlrev_b32 v9, 16, v152
    v_rcp_f32 v12, v12
    v_lshlrev_b32 v10, 16, v153
    v_mul_f32 v9, v9, v12
    v_fma_f32 v10, -v11, v9, v10
    ds_write_b32 v7, v9 offset:18432
    ds_write_b32 v7, v10 offset:18688
    s_waitcnt lgkmcnt(0)
K34_WAIT:
    s_barrier
    s_cmp_lt_u32 s3, s23
    s_cbranch_scc0 K34_END
    v_lshlrev_b32 v7, 4, v3
    ds_read_b128 v[144:147], v7 offset:18432
    ds_read_b128 v[148:151], v7 offset:18688
    s_mul_i32 s24, s20, 8176640
    s_add_u32 s16, s44, s24
    s_addc_u32 s17, s45, 0
    s_and_b32 s17, s17, 0xffff
    s_mov_b32 s18, 8176640
    s_mov_b32 s19, 0x00020000
    v_lshlrev_b32 v7, 12, v4
    v_lshl_add_u32 v7, v3, 3, v7
    s_lshl_b32 s24, s21, 7
    v_add_u32 v7, s24, v7
    s_mul_i32 s25, s22, 49152
    s_mov_b32 s30, 0xc0135761
    s_mov_b32 s31, 0xbdd2d3e8
    v_mov_b32 v15, s30
    s_waitcnt lgkmcnt(0)
    v_fma_f32 v16, v96, v144, v148
    v_fma_f32 v17, v100, v145, v149
    v_fma_f32 v18, v104, v146, v150
    v_fma_f32 v19, v108, v147, v151
    v_fma_f32 v20, v97, v144, v148
    v_fma_f32 v21, v101, v145, v149
    v_fma_f32 v22, v105, v146, v150
    v_fma_f32 v23, v109, v147, v151
    v_mul_f32 v24, v16, v16
    v_mul_f32 v25, v17, v17
    v_mul_f32 v26, v18, v18
    v_mul_f32 v27, v19, v19
    v_mul_f32 v28, v20, v20
    v_mul_f32 v29, v21, v21
    v_mul_f32 v30, v22, v22
    v_mul_f32 v31, v23, v23
    v_fma_f32 v24, v24, s31, v15
    v_fma_f32 v25, v25, s31, v15
    v_fma_f32 v26, v26, s31, v15
    v_fma_f32 v27, v27, s31, v15
    v_fma_f32 v28, v28, s31, v15
    v_fma_f32 v29, v29, s31, v15
    v_fma_f32 v30, v30, s31, v15
    v_fma_f32 v31, v31, s31, v15
    v_mul_f32 v24, v24, v16
    v_mul_f32 v25, v25, v17
    v_mul_f32 v26, v26, v18
    v_mul_f32 v27, v27, v19
    v_mul_f32 v28, v28, v20
    v_mul_f32 v29, v29, v21
    v_mul_f32 v30, v30, v22
    v_mul_f32 v31, v31, v23
    v_exp_f32 v24, v24
    v_exp_f32 v25, v25
    v_exp_f32 v26, v26
    v_exp_f32 v27, v27
    v_exp_f32 v28, v28
    v_exp_f32 v29, v29
    v_exp_f32 v30, v30
    v_exp_f32 v31, v31
    v_add_f32 v24, 1.0, v24
    v_add_f32 v25, 1.0, v25
    v_add_f32 v26, 1.0, v26
    v_add_f32 v27, 1.0, v27
    v_add_f32 v28, 1.0, v28
    v_add_f32 v29, 1.0, v29
    v_add_f32 v30, 1.0, v30
    v_add_f32 v31, 1.0, v31
    v_rcp_f32 v24, v24
    v_rcp_f32 v25, v25
    v_rcp_f32 v26, v26
    v_rcp_f32 v27, v27
    v_rcp_f32 v28, v28
    v_rcp_f32 v29, v29
    v_rcp_f32 v30, v30
    v_rcp_f32 v31, v31
    v_mul_f32 v16, v16, v24
    v_mul_f32 v17, v17, v25
    v_mul_f32 v18, v18, v26
    v_mul_f32 v19, v19, v27
    v_mul_f32 v20, v20, v28
    v_mul_f32 v21, v21, v29
    v_mul_f32 v22, v22, v30
    v_mul_f32 v23, v23, v31
    v_cvt_pk_bf16_f32 v32, v16, v17
    v_cvt_pk_bf16_f32 v33, v18, v19
    buffer_store_dwordx2 v[32:33], v7, s[16:19], s25 offen offset:0 sc1
    v_cvt_pk_bf16_f32 v34, v20, v21
    v_cvt_pk_bf16_f32 v35, v22, v23
    buffer_store_dwordx2 v[34:35], v7, s[16:19], s25 offen offset:1024 sc1
    s_add_u32 s25, s25, 2048
    v_fma_f32 v36, v98, v144, v148
    v_fma_f32 v37, v102, v145, v149
    v_fma_f32 v38, v106, v146, v150
    v_fma_f32 v39, v110, v147, v151
    v_fma_f32 v40, v99, v144, v148
    v_fma_f32 v41, v103, v145, v149
    v_fma_f32 v42, v107, v146, v150
    v_fma_f32 v43, v111, v147, v151
    v_mul_f32 v44, v36, v36
    v_mul_f32 v45, v37, v37
    v_mul_f32 v46, v38, v38
    v_mul_f32 v47, v39, v39
    v_mul_f32 v48, v40, v40
    v_mul_f32 v49, v41, v41
    v_mul_f32 v50, v42, v42
    v_mul_f32 v51, v43, v43
    v_fma_f32 v44, v44, s31, v15
    v_fma_f32 v45, v45, s31, v15
    v_fma_f32 v46, v46, s31, v15
    v_fma_f32 v47, v47, s31, v15
    v_fma_f32 v48, v48, s31, v15
    v_fma_f32 v49, v49, s31, v15
    v_fma_f32 v50, v50, s31, v15
    v_fma_f32 v51, v51, s31, v15
    v_mul_f32 v44, v44, v36
    v_mul_f32 v45, v45, v37
    v_mul_f32 v46, v46, v38
    v_mul_f32 v47, v47, v39
    v_mul_f32 v48, v48, v40
    v_mul_f32 v49, v49, v41
    v_mul_f32 v50, v50, v42
    v_mul_f32 v51, v51, v43
    v_exp_f32 v44, v44
    v_exp_f32 v45, v45
    v_exp_f32 v46, v46
    v_exp_f32 v47, v47
    v_exp_f32 v48, v48
    v_exp_f32 v49, v49
    v_exp_f32 v50, v50
    v_exp_f32 v51, v51
    v_add_f32 v44, 1.0, v44
    v_add_f32 v45, 1.0, v45
    v_add_f32 v46, 1.0, v46
    v_add_f32 v47, 1.0, v47
    v_add_f32 v48, 1.0, v48
    v_add_f32 v49, 1.0, v49
    v_add_f32 v50, 1.0, v50
    v_add_f32 v51, 1.0, v51
    v_rcp_f32 v44, v44
    v_rcp_f32 v45, v45
    v_rcp_f32 v46, v46
    v_rcp_f32 v47, v47
    v_rcp_f32 v48, v48
    v_rcp_f32 v49, v49
    v_rcp_f32 v50, v50
    v_rcp_f32 v51, v51
    v_mul_f32 v36, v36, v44
    v_mul_f32 v37, v37, v45
    v_mul_f32 v38, v38, v46
    v_mul_f32 v39, v39, v47
    v_mul_f32 v40, v40, v48
    v_mul_f32 v41, v41, v49
    v_mul_f32 v42, v42, v50
    v_mul_f32 v43, v43, v51
    v_cvt_pk_bf16_f32 v52, v36, v37
    v_cvt_pk_bf16_f32 v53, v38, v39
    buffer_store_dwordx2 v[52:53], v7, s[16:19], s25 offen offset:0 sc1
    v_cvt_pk_bf16_f32 v54, v40, v41
    v_cvt_pk_bf16_f32 v55, v42, v43
    buffer_store_dwordx2 v[54:55], v7, s[16:19], s25 offen offset:1024 sc1
    s_add_u32 s25, s25, 2048
    s_add_u32 s25, s25, 12288
    v_fma_f32 v16, v112, v144, v148
    v_fma_f32 v17, v116, v145, v149
    v_fma_f32 v18, v120, v146, v150
    v_fma_f32 v19, v124, v147, v151
    v_fma_f32 v20, v113, v144, v148
    v_fma_f32 v21, v117, v145, v149
    v_fma_f32 v22, v121, v146, v150
    v_fma_f32 v23, v125, v147, v151
    v_mul_f32 v24, v16, v16
    v_mul_f32 v25, v17, v17
    v_mul_f32 v26, v18, v18
    v_mul_f32 v27, v19, v19
    v_mul_f32 v28, v20, v20
    v_mul_f32 v29, v21, v21
    v_mul_f32 v30, v22, v22
    v_mul_f32 v31, v23, v23
    v_fma_f32 v24, v24, s31, v15
    v_fma_f32 v25, v25, s31, v15
    v_fma_f32 v26, v26, s31, v15
    v_fma_f32 v27, v27, s31, v15
    v_fma_f32 v28, v28, s31, v15
    v_fma_f32 v29, v29, s31, v15
    v_fma_f32 v30, v30, s31, v15
    v_fma_f32 v31, v31, s31, v15
    v_mul_f32 v24, v24, v16
    v_mul_f32 v25, v25, v17
    v_mul_f32 v26, v26, v18
    v_mul_f32 v27, v27, v19
    v_mul_f32 v28, v28, v20
    v_mul_f32 v29, v29, v21
    v_mul_f32 v30, v30, v22
    v_mul_f32 v31, v31, v23
    v_exp_f32 v24, v24
    v_exp_f32 v25, v25
    v_exp_f32 v26, v26
    v_exp_f32 v27, v27
    v_exp_f32 v28, v28
    v_exp_f32 v29, v29
    v_exp_f32 v30, v30
    v_exp_f32 v31, v31
    v_add_f32 v24, 1.0, v24
    v_add_f32 v25, 1.0, v25
    v_add_f32 v26, 1.0, v26
    v_add_f32 v27, 1.0, v27
    v_add_f32 v28, 1.0, v28
    v_add_f32 v29, 1.0, v29
    v_add_f32 v30, 1.0, v30
    v_add_f32 v31, 1.0, v31
    v_rcp_f32 v24, v24
    v_rcp_f32 v25, v25
    v_rcp_f32 v26, v26
    v_rcp_f32 v27, v27
    v_rcp_f32 v28, v28
    v_rcp_f32 v29, v29
    v_rcp_f32 v30, v30
    v_rcp_f32 v31, v31
    v_mul_f32 v16, v16, v24
    v_mul_f32 v17, v17, v25
    v_mul_f32 v18, v18, v26
    v_mul_f32 v19, v19, v27
    v_mul_f32 v20, v20, v28
    v_mul_f32 v21, v21, v29
    v_mul_f32 v22, v22, v30
    v_mul_f32 v23, v23, v31
    v_cvt_pk_bf16_f32 v32, v16, v17
    v_cvt_pk_bf16_f32 v33, v18, v19
    buffer_store_dwordx2 v[32:33], v7, s[16:19], s25 offen offset:0 sc1
    v_cvt_pk_bf16_f32 v34, v20, v21
    v_cvt_pk_bf16_f32 v35, v22, v23
    buffer_store_dwordx2 v[34:35], v7, s[16:19], s25 offen offset:1024 sc1
    s_add_u32 s25, s25, 2048
    v_fma_f32 v36, v114, v144, v148
    v_fma_f32 v37, v118, v145, v149
    v_fma_f32 v38, v122, v146, v150
    v_fma_f32 v39, v126, v147, v151
    v_fma_f32 v40, v115, v144, v148
    v_fma_f32 v41, v119, v145, v149
    v_fma_f32 v42, v123, v146, v150
    v_fma_f32 v43, v127, v147, v151
    v_mul_f32 v44, v36, v36
    v_mul_f32 v45, v37, v37
    v_mul_f32 v46, v38, v38
    v_mul_f32 v47, v39, v39
    v_mul_f32 v48, v40, v40
    v_mul_f32 v49, v41, v41
    v_mul_f32 v50, v42, v42
    v_mul_f32 v51, v43, v43
    v_fma_f32 v44, v44, s31, v15
    v_fma_f32 v45, v45, s31, v15
    v_fma_f32 v46, v46, s31, v15
    v_fma_f32 v47, v47, s31, v15
    v_fma_f32 v48, v48, s31, v15
    v_fma_f32 v49, v49, s31, v15
    v_fma_f32 v50, v50, s31, v15
    v_fma_f32 v51, v51, s31, v15
    v_mul_f32 v44, v44, v36
    v_mul_f32 v45, v45, v37
    v_mul_f32 v46, v46, v38
    v_mul_f32 v47, v47, v39
    v_mul_f32 v48, v48, v40
    v_mul_f32 v49, v49, v41
    v_mul_f32 v50, v50, v42
    v_mul_f32 v51, v51, v43
    v_exp_f32 v44, v44
    v_exp_f32 v45, v45
    v_exp_f32 v46, v46
    v_exp_f32 v47, v47
    v_exp_f32 v48, v48
    v_exp_f32 v49, v49
    v_exp_f32 v50, v50
    v_exp_f32 v51, v51
    v_add_f32 v44, 1.0, v44
    v_add_f32 v45, 1.0, v45
    v_add_f32 v46, 1.0, v46
    v_add_f32 v47, 1.0, v47
    v_add_f32 v48, 1.0, v48
    v_add_f32 v49, 1.0, v49
    v_add_f32 v50, 1.0, v50
    v_add_f32 v51, 1.0, v51
    v_rcp_f32 v44, v44
    v_rcp_f32 v45, v45
    v_rcp_f32 v46, v46
    v_rcp_f32 v47, v47
    v_rcp_f32 v48, v48
    v_rcp_f32 v49, v49
    v_rcp_f32 v50, v50
    v_rcp_f32 v51, v51
    v_mul_f32 v36, v36, v44
    v_mul_f32 v37, v37, v45
    v_mul_f32 v38, v38, v46
    v_mul_f32 v39, v39, v47
    v_mul_f32 v40, v40, v48
    v_mul_f32 v41, v41, v49
    v_mul_f32 v42, v42, v50
    v_mul_f32 v43, v43, v51
    v_cvt_pk_bf16_f32 v52, v36, v37
    v_cvt_pk_bf16_f32 v53, v38, v39
    buffer_store_dwordx2 v[52:53], v7, s[16:19], s25 offen offset:0 sc1
    v_cvt_pk_bf16_f32 v54, v40, v41
    v_cvt_pk_bf16_f32 v55, v42, v43
    buffer_store_dwordx2 v[54:55], v7, s[16:19], s25 offen offset:1024 sc1
    s_add_u32 s25, s25, 2048
    s_add_u32 s25, s25, 12288
    v_fma_f32 v16, v128, v144, v148
    v_fma_f32 v17, v132, v145, v149
    v_fma_f32 v18, v136, v146, v150
    v_fma_f32 v19, v140, v147, v151
    v_fma_f32 v20, v129, v144, v148
    v_fma_f32 v21, v133, v145, v149
    v_fma_f32 v22, v137, v146, v150
    v_fma_f32 v23, v141, v147, v151
    v_mul_f32 v24, v16, v16
    v_mul_f32 v25, v17, v17
    v_mul_f32 v26, v18, v18
    v_mul_f32 v27, v19, v19
    v_mul_f32 v28, v20, v20
    v_mul_f32 v29, v21, v21
    v_mul_f32 v30, v22, v22
    v_mul_f32 v31, v23, v23
    v_fma_f32 v24, v24, s31, v15
    v_fma_f32 v25, v25, s31, v15
    v_fma_f32 v26, v26, s31, v15
    v_fma_f32 v27, v27, s31, v15
    v_fma_f32 v28, v28, s31, v15
    v_fma_f32 v29, v29, s31, v15
    v_fma_f32 v30, v30, s31, v15
    v_fma_f32 v31, v31, s31, v15
    v_mul_f32 v24, v24, v16
    v_mul_f32 v25, v25, v17
    v_mul_f32 v26, v26, v18
    v_mul_f32 v27, v27, v19
    v_mul_f32 v28, v28, v20
    v_mul_f32 v29, v29, v21
    v_mul_f32 v30, v30, v22
    v_mul_f32 v31, v31, v23
    v_exp_f32 v24, v24
    v_exp_f32 v25, v25
    v_exp_f32 v26, v26
    v_exp_f32 v27, v27
    v_exp_f32 v28, v28
    v_exp_f32 v29, v29
    v_exp_f32 v30, v30
    v_exp_f32 v31, v31
    v_add_f32 v24, 1.0, v24
    v_add_f32 v25, 1.0, v25
    v_add_f32 v26, 1.0, v26
    v_add_f32 v27, 1.0, v27
    v_add_f32 v28, 1.0, v28
    v_add_f32 v29, 1.0, v29
    v_add_f32 v30, 1.0, v30
    v_add_f32 v31, 1.0, v31
    v_rcp_f32 v24, v24
    v_rcp_f32 v25, v25
    v_rcp_f32 v26, v26
    v_rcp_f32 v27, v27
    v_rcp_f32 v28, v28
    v_rcp_f32 v29, v29
    v_rcp_f32 v30, v30
    v_rcp_f32 v31, v31
    v_mul_f32 v16, v16, v24
    v_mul_f32 v17, v17, v25
    v_mul_f32 v18, v18, v26
    v_mul_f32 v19, v19, v27
    v_mul_f32 v20, v20, v28
    v_mul_f32 v21, v21, v29
    v_mul_f32 v22, v22, v30
    v_mul_f32 v23, v23, v31
    v_cvt_pk_bf16_f32 v32, v16, v17
    v_cvt_pk_bf16_f32 v33, v18, v19
    buffer_store_dwordx2 v[32:33], v7, s[16:19], s25 offen offset:0 sc1
    v_cvt_pk_bf16_f32 v34, v20, v21
    v_cvt_pk_bf16_f32 v35, v22, v23
    buffer_store_dwordx2 v[34:35], v7, s[16:19], s25 offen offset:1024 sc1
    s_add_u32 s25, s25, 2048
    v_fma_f32 v36, v130, v144, v148
    v_fma_f32 v37, v134, v145, v149
    v_fma_f32 v38, v138, v146, v150
    v_fma_f32 v39, v142, v147, v151
    v_fma_f32 v40, v131, v144, v148
    v_fma_f32 v41, v135, v145, v149
    v_fma_f32 v42, v139, v146, v150
    v_fma_f32 v43, v143, v147, v151
    v_mul_f32 v44, v36, v36
    v_mul_f32 v45, v37, v37
    v_mul_f32 v46, v38, v38
    v_mul_f32 v47, v39, v39
    v_mul_f32 v48, v40, v40
    v_mul_f32 v49, v41, v41
    v_mul_f32 v50, v42, v42
    v_mul_f32 v51, v43, v43
    v_fma_f32 v44, v44, s31, v15
    v_fma_f32 v45, v45, s31, v15
    v_fma_f32 v46, v46, s31, v15
    v_fma_f32 v47, v47, s31, v15
    v_fma_f32 v48, v48, s31, v15
    v_fma_f32 v49, v49, s31, v15
    v_fma_f32 v50, v50, s31, v15
    v_fma_f32 v51, v51, s31, v15
    v_mul_f32 v44, v44, v36
    v_mul_f32 v45, v45, v37
    v_mul_f32 v46, v46, v38
    v_mul_f32 v47, v47, v39
    v_mul_f32 v48, v48, v40
    v_mul_f32 v49, v49, v41
    v_mul_f32 v50, v50, v42
    v_mul_f32 v51, v51, v43
    v_exp_f32 v44, v44
    v_exp_f32 v45, v45
    v_exp_f32 v46, v46
    v_exp_f32 v47, v47
    v_exp_f32 v48, v48
    v_exp_f32 v49, v49
    v_exp_f32 v50, v50
    v_exp_f32 v51, v51
    v_add_f32 v44, 1.0, v44
    v_add_f32 v45, 1.0, v45
    v_add_f32 v46, 1.0, v46
    v_add_f32 v47, 1.0, v47
    v_add_f32 v48, 1.0, v48
    v_add_f32 v49, 1.0, v49
    v_add_f32 v50, 1.0, v50
    v_add_f32 v51, 1.0, v51
    v_rcp_f32 v44, v44
    v_rcp_f32 v45, v45
    v_rcp_f32 v46, v46
    v_rcp_f32 v47, v47
    v_rcp_f32 v48, v48
    v_rcp_f32 v49, v49
    v_rcp_f32 v50, v50
    v_rcp_f32 v51, v51
    v_mul_f32 v36, v36, v44
    v_mul_f32 v37, v37, v45
    v_mul_f32 v38, v38, v46
    v_mul_f32 v39, v39, v47
    v_mul_f32 v40, v40, v48
    v_mul_f32 v41, v41, v49
    v_mul_f32 v42, v42, v50
    v_mul_f32 v43, v43, v51
    v_cvt_pk_bf16_f32 v52, v36, v37
    v_cvt_pk_bf16_f32 v53, v38, v39
    buffer_store_dwordx2 v[52:53], v7, s[16:19], s25 offen offset:0 sc1
    v_cvt_pk_bf16_f32 v54, v40, v41
    v_cvt_pk_bf16_f32 v55, v42, v43
    buffer_store_dwordx2 v[54:55], v7, s[16:19], s25 offen offset:1024 sc1
    s_add_u32 s25, s25, 2048
    s_add_u32 s25, s25, 12288
K34_END:
    s_endpgm
TEXT_END:
.section .rodata,"a"
.p2align 6
.amdhsa_kernel k1_xform_kernel
  .amdhsa_next_free_vgpr 128
  .amdhsa_next_free_sgpr 96
  .amdhsa_accum_offset 128
  .amdhsa_group_segment_fixed_size 0
  .amdhsa_kernarg_size 56
  .amdhsa_user_sgpr_count 2
  .amdhsa_user_sgpr_kernarg_segment_ptr 1
  .amdhsa_system_sgpr_workgroup_id_x 1
.end_amdhsa_kernel
.p2align 6
.amdhsa_kernel k12_fused_kernel
  .amdhsa_next_free_vgpr 256
  .amdhsa_next_free_sgpr 96
  .amdhsa_accum_offset 256
  .amdhsa_group_segment_fixed_size 0
  .amdhsa_kernarg_size 56
  .amdhsa_user_sgpr_count 2
  .amdhsa_user_sgpr_kernarg_segment_ptr 1
  .amdhsa_system_sgpr_workgroup_id_x 1
.end_amdhsa_kernel
.p2align 6
.amdhsa_kernel k34_out_kernel
  .amdhsa_next_free_vgpr 168
  .amdhsa_next_free_sgpr 96
  .amdhsa_accum_offset 168
  .amdhsa_group_segment_fixed_size 0
  .amdhsa_kernarg_size 56
  .amdhsa_user_sgpr_count 2
  .amdhsa_user_sgpr_kernarg_segment_ptr 1
  .amdhsa_system_sgpr_workgroup_id_x 1
.end_amdhsa_kernel
```

```asm
; @launch kernel=k1_xform_kernel grid=(636,1,1) block=(256,1,1) lds=16384
; @launch kernel=k12_fused_kernel grid=(256,1,1) block=(512,1,1) lds=155872
; @launch kernel=k34_out_kernel grid=(256,1,1) block=(768,1,1) lds=18944
.amdgcn_target "amdgcn-amd-amdhsa--gfx950"
.text
.globl k1_xform_kernel
.globl k12_fused_kernel
.globl k34_out_kernel
.p2align 8
.type k1_xform_kernel,@function
k1_xform_kernel:
    s_cmp_ge_u32 s2, 636
    s_cbranch_scc1 K1_END
    s_load_dwordx4 s[4:7], s[0:1], 0
    s_load_dwordx2 s[8:9], s[0:1], 48
    s_cmp_lt_u32 s2, 8
    s_cbranch_scc0 K1_NOCPF
    s_getpc_b64 s[90:91]
CPF_K1:
    s_sub_u32 s90, s90, CPF_K1-k1_xform_kernel
    s_subb_u32 s91, s91, 0
    v_lshlrev_b32 v8, 7, v0
    v_mov_b32 v11, s91
    v_min_u32 v9, TEXT_END-k1_xform_kernel-4, v8
    v_add_co_u32 v10, vcc, s90, v9
    v_addc_co_u32 v11, vcc, 0, v11, vcc
    global_load_dword v63, v[10:11], off
    v_mov_b32 v11, s91
    v_add_u32 v8, 32768, v8
    v_min_u32 v9, TEXT_END-k1_xform_kernel-4, v8
    v_add_co_u32 v10, vcc, s90, v9
    v_addc_co_u32 v11, vcc, 0, v11, vcc
    global_load_dword v63, v[10:11], off
K1_NOCPF:
    v_lshrrev_b32 v120, 6, v0
    v_and_b32 v121, 63, v0
    v_readfirstlane_b32 s3, v120
    v_and_b32 v122, 15, v121
    v_lshrrev_b32 v123, 4, v121
    s_mov_b32 s28, 0x05040100
    s_mov_b32 s29, 0x07060302
    v_and_b32 v124, 3, v122
    v_lshlrev_b32 v124, 2, v124
    v_lshrrev_b32 v125, 3, v122
    v_lshl_add_u32 v124, v125, 1, v124
    s_lshl_b32 s10, s3, 4
    s_add_u32 s10, s10, 1
    v_add_u32 v124, s10, v124
    v_bfe_u32 v125, v122, 2, 1
    v_lshlrev_b32 v121, 4, v121
    s_waitcnt lgkmcnt(0)
    s_or_b32 s10, s2, s3
    s_cmp_eq_u32 s10, 0
    s_cbranch_scc0 K1_NOCLR
    s_add_u32 s12, s8, 153092096
    s_addc_u32 s13, s9, 0
    s_and_b32 s13, s13, 0xffff
    s_mov_b32 s14, 32768
    s_mov_b32 s15, 0x00020000
    v_lshrrev_b32 v118, 4, v121
    v_lshlrev_b32 v119, 10, v118
    v_mov_b32 v117, 0
    s_mov_b64 exec, 0xffff
    buffer_store_dword v117, v119, s[12:15], 0 offen
    v_lshlrev_b32 v119, 4, v118
    v_add_u32 v119, 16384, v119
    buffer_store_dword v117, v119, s[12:15], 0 offen
    s_mov_b64 exec, -1
K1_NOCLR:
    s_cmp_lt_u32 s2, 32
    s_cbranch_scc0 K1_NOFILL
    s_add_u32 s12, s8, 153616384
    s_addc_u32 s13, s9, 0
    s_and_b32 s13, s13, 0xffff
    s_mov_b32 s14, 131072
    s_mov_b32 s15, 0x00020000
    s_lshl_b32 s10, s2, 2
    s_add_u32 s10, s10, s3
    s_lshl_b32 s10, s10, 10
    v_mov_b32 v112, -1
    v_mov_b32 v113, -1
    v_mov_b32 v114, -1
    v_mov_b32 v115, -1
    buffer_store_dwordx4 v[112:115], v121, s[12:15], s10 offen
K1_NOFILL:
    s_add_u32 s10, s2, 384
    s_sub_u32 s11, s2, 252
    s_cmp_lt_u32 s2, 252
    s_cselect_b32 s2, s10, s11
    s_cmp_lt_u32 s2, 384
    s_cbranch_scc1 K1_W
    s_sub_u32 s11, s2, 384
    s_mul_hi_u32 s13, s11, 1431655766
    s_mul_i32 s12, s13, 3
    s_sub_u32 s12, s11, s12
    s_mov_b32 s11, s13
    s_cmp_ge_u32 s11, 42
    s_cselect_b32 s13, 1, 0
    s_mul_i32 s14, s13, 42
    s_sub_u32 s11, s11, s14
    s_lshl_b32 s11, s11, 2
    s_add_u32 s11, s11, s3
    s_mul_i32 s14, s13, 16384000
    s_add_u32 s16, s4, s14
    s_addc_u32 s17, s5, 0
    s_and_b32 s17, s17, 0xffff
    s_mov_b32 s18, 16384000
    s_mov_b32 s19, 0x00020000
    s_mov_b32 s20, s8
    s_mov_b32 s21, s9
    s_and_b32 s21, s21, 0xffff
    s_mov_b32 s22, 43778048
    s_mov_b32 s23, 0x00020000
    v_lshlrev_b32 v126, 14, v123
    v_lshl_add_u32 v126, v122, 4, v126
    s_mul_i32 s15, s11, 98304
    s_lshl_b32 s24, s12, 8
    s_add_u32 s15, s15, s24
    buffer_load_dwordx4 v[0:3], v126, s[16:19], s15 offen
    buffer_load_dwordx4 v[4:7], v126, s[16:19], s15 offen offset:2048
    s_add_u32 s15, s15, 4096
    buffer_load_dwordx4 v[8:11], v126, s[16:19], s15 offen
    buffer_load_dwordx4 v[12:15], v126, s[16:19], s15 offen offset:2048
    s_add_u32 s15, s15, 4096
    buffer_load_dwordx4 v[16:19], v126, s[16:19], s15 offen
    buffer_load_dwordx4 v[20:23], v126, s[16:19], s15 offen offset:2048
    s_add_u32 s15, s15, 4096
    buffer_load_dwordx4 v[24:27], v126, s[16:19], s15 offen
    buffer_load_dwordx4 v[28:31], v126, s[16:19], s15 offen offset:2048
    s_add_u32 s15, s15, 53248
    buffer_load_dwordx4 v[32:35], v126, s[16:19], s15 offen
    buffer_load_dwordx4 v[36:39], v126, s[16:19], s15 offen offset:2048
    s_add_u32 s15, s15, 4096
    buffer_load_dwordx4 v[40:43], v126, s[16:19], s15 offen
    buffer_load_dwordx4 v[44:47], v126, s[16:19], s15 offen offset:2048
    s_add_u32 s15, s15, 4096
    buffer_load_dwordx4 v[48:51], v126, s[16:19], s15 offen
    buffer_load_dwordx4 v[52:55], v126, s[16:19], s15 offen offset:2048
    s_add_u32 s15, s15, 4096
    buffer_load_dwordx4 v[56:59], v126, s[16:19], s15 offen
    buffer_load_dwordx4 v[60:63], v126, s[16:19], s15 offen offset:2048
    v_lshlrev_b32 v127, 3, v123
    v_lshlrev_b32 v112, 5, v125
    v_mad_u32_u24 v113, v124, v127, v112
    v_mad_u32_u24 v64, v124, 0, v113
    v_mad_u32_u24 v65, v124, 1, v113
    v_mad_u32_u24 v66, v124, 2, v113
    v_mad_u32_u24 v67, v124, 3, v113
    v_mad_u32_u24 v68, v124, 4, v113
    v_mad_u32_u24 v69, v124, 5, v113
    v_mad_u32_u24 v70, v124, 6, v113
    v_mad_u32_u24 v71, v124, 7, v113
    v_and_b32 v64, 127, v64
    v_and_b32 v65, 127, v65
    v_and_b32 v66, 127, v66
    v_and_b32 v67, 127, v67
    v_and_b32 v68, 127, v68
    v_and_b32 v69, 127, v69
    v_and_b32 v70, 127, v70
    v_and_b32 v71, 127, v71
    v_cvt_f32_u32 v64, v64
    v_cvt_f32_u32 v65, v65
    v_cvt_f32_u32 v66, v66
    v_cvt_f32_u32 v67, v67
    v_cvt_f32_u32 v68, v68
    v_cvt_f32_u32 v69, v69
    v_cvt_f32_u32 v70, v70
    v_cvt_f32_u32 v71, v71
    v_mul_f32 v64, 0x3c000000, v64
    v_mul_f32 v65, 0x3c000000, v65
    v_mul_f32 v66, 0x3c000000, v66
    v_mul_f32 v67, 0x3c000000, v67
    v_mul_f32 v68, 0x3c000000, v68
    v_mul_f32 v69, 0x3c000000, v69
    v_mul_f32 v70, 0x3c000000, v70
    v_mul_f32 v71, 0x3c000000, v71
    v_cos_f32 v64, v64
    v_cos_f32 v65, v65
    v_cos_f32 v66, v66
    v_cos_f32 v67, v67
    v_cos_f32 v68, v68
    v_cos_f32 v69, v69
    v_cos_f32 v70, v70
    v_cos_f32 v71, v71
    s_nop 0
    v_cvt_pk_bf16_f32 v72, v64, v65
    v_cvt_pk_bf16_f32 v73, v66, v67
    v_cvt_pk_bf16_f32 v74, v68, v69
    v_cvt_pk_bf16_f32 v75, v70, v71
    v_lshlrev_b32 v80, 16, v72
    v_and_b32 v81, 0xffff0000, v72
    v_sub_f32 v64, v64, v80
    v_sub_f32 v65, v65, v81
    v_lshlrev_b32 v80, 16, v73
    v_and_b32 v81, 0xffff0000, v73
    v_sub_f32 v66, v66, v80
    v_sub_f32 v67, v67, v81
    v_lshlrev_b32 v80, 16, v74
    v_and_b32 v81, 0xffff0000, v74
    v_sub_f32 v68, v68, v80
    v_sub_f32 v69, v69, v81
    v_lshlrev_b32 v80, 16, v75
    v_and_b32 v81, 0xffff0000, v75
    v_sub_f32 v70, v70, v80
    v_sub_f32 v71, v71, v81
    v_cvt_pk_bf16_f32 v76, v64, v65
    v_cvt_pk_bf16_f32 v77, v66, v67
    v_cvt_pk_bf16_f32 v78, v68, v69
    v_cvt_pk_bf16_f32 v79, v70, v71
    s_lshl_b32 s24, s3, 12
    v_add_u32 v114, s24, v121
    ds_write_b128 v114, v[72:75] offset:0
    ds_write_b128 v114, v[76:79] offset:1024
    v_add_u32 v127, 32, v127
    v_lshlrev_b32 v112, 5, v125
    v_mad_u32_u24 v113, v124, v127, v112
    v_mad_u32_u24 v64, v124, 0, v113
    v_mad_u32_u24 v65, v124, 1, v113
    v_mad_u32_u24 v66, v124, 2, v113
    v_mad_u32_u24 v67, v124, 3, v113
    v_mad_u32_u24 v68, v124, 4, v113
    v_mad_u32_u24 v69, v124, 5, v113
    v_mad_u32_u24 v70, v124, 6, v113
    v_mad_u32_u24 v71, v124, 7, v113
    v_and_b32 v64, 127, v64
    v_and_b32 v65, 127, v65
    v_and_b32 v66, 127, v66
    v_and_b32 v67, 127, v67
    v_and_b32 v68, 127, v68
    v_and_b32 v69, 127, v69
    v_and_b32 v70, 127, v70
    v_and_b32 v71, 127, v71
    v_cvt_f32_u32 v64, v64
    v_cvt_f32_u32 v65, v65
    v_cvt_f32_u32 v66, v66
    v_cvt_f32_u32 v67, v67
    v_cvt_f32_u32 v68, v68
    v_cvt_f32_u32 v69, v69
    v_cvt_f32_u32 v70, v70
    v_cvt_f32_u32 v71, v71
    v_mul_f32 v64, 0x3c000000, v64
    v_mul_f32 v65, 0x3c000000, v65
    v_mul_f32 v66, 0x3c000000, v66
    v_mul_f32 v67, 0x3c000000, v67
    v_mul_f32 v68, 0x3c000000, v68
    v_mul_f32 v69, 0x3c000000, v69
    v_mul_f32 v70, 0x3c000000, v70
    v_mul_f32 v71, 0x3c000000, v71
    v_cos_f32 v64, v64
    v_cos_f32 v65, v65
    v_cos_f32 v66, v66
    v_cos_f32 v67, v67
    v_cos_f32 v68, v68
    v_cos_f32 v69, v69
    v_cos_f32 v70, v70
    v_cos_f32 v71, v71
    s_nop 0
    v_cvt_pk_bf16_f32 v72, v64, v65
    v_cvt_pk_bf16_f32 v73, v66, v67
    v_cvt_pk_bf16_f32 v74, v68, v69
    v_cvt_pk_bf16_f32 v75, v70, v71
    v_lshlrev_b32 v80, 16, v72
    v_and_b32 v81, 0xffff0000, v72
    v_sub_f32 v64, v64, v80
    v_sub_f32 v65, v65, v81
    v_lshlrev_b32 v80, 16, v73
    v_and_b32 v81, 0xffff0000, v73
    v_sub_f32 v66, v66, v80
    v_sub_f32 v67, v67, v81
    v_lshlrev_b32 v80, 16, v74
    v_and_b32 v81, 0xffff0000, v74
    v_sub_f32 v68, v68, v80
    v_sub_f32 v69, v69, v81
    v_lshlrev_b32 v80, 16, v75
    v_and_b32 v81, 0xffff0000, v75
    v_sub_f32 v70, v70, v80
    v_sub_f32 v71, v71, v81
    v_cvt_pk_bf16_f32 v76, v64, v65
    v_cvt_pk_bf16_f32 v77, v66, v67
    v_cvt_pk_bf16_f32 v78, v68, v69
    v_cvt_pk_bf16_f32 v79, v70, v71
    s_lshl_b32 s24, s3, 12
    v_add_u32 v114, s24, v121
    ds_write_b128 v114, v[72:75] offset:2048
    ds_write_b128 v114, v[76:79] offset:3072
    v_lshrrev_b32 v112, 1, v123
    s_mov_b32 s24, 1368064
    v_mul_lo_u32 v112, v112, s24
    v_lshrrev_b32 v113, 2, v122
    s_mov_b32 s24, 21376
    v_mul_lo_u32 v113, v113, s24
    v_add_u32 v112, v112, v113
    v_and_b32 v113, 3, v122
    v_and_b32 v114, 1, v123
    v_lshl_add_u32 v113, v114, 2, v113
    s_add_u32 s24, s11, 7
    s_cmp_ge_u32 s11, 160
    s_cselect_b32 s24, s24, s11
    s_cmp_eq_u32 s13, 1
    s_cselect_b32 s24, s24, s11
    s_lshr_b32 s24, s24, 1
    s_and_b32 s24, s24, 7
    v_xor_b32 v113, s24, v113
    v_lshl_add_u32 v120, v113, 4, v112
    s_mul_i32 s25, s13, 684032
    s_mul_i32 s24, s12, 85504
    s_add_u32 s25, s25, s24
    s_lshl_b32 s24, s11, 7
    s_add_u32 s25, s25, s24
    s_waitcnt lgkmcnt(0)
    s_barrier
    s_cmp_ge_u32 s11, 167
    s_cbranch_scc1 K1_END
    s_waitcnt vmcnt(8)
    v_perm_b32 v64, v4, v0, s28
    v_perm_b32 v68, v4, v0, s29
    v_perm_b32 v65, v12, v8, s28
    v_perm_b32 v69, v12, v8, s29
    v_perm_b32 v66, v20, v16, s28
    v_perm_b32 v70, v20, v16, s29
    v_perm_b32 v67, v28, v24, s28
    v_perm_b32 v71, v28, v24, s29
    v_perm_b32 v72, v5, v1, s28
    v_perm_b32 v76, v5, v1, s29
    v_perm_b32 v73, v13, v9, s28
    v_perm_b32 v77, v13, v9, s29
    v_perm_b32 v74, v21, v17, s28
    v_perm_b32 v78, v21, v17, s29
    v_perm_b32 v75, v29, v25, s28
    v_perm_b32 v79, v29, v25, s29
    v_perm_b32 v80, v6, v2, s28
    v_perm_b32 v84, v6, v2, s29
    v_perm_b32 v81, v14, v10, s28
    v_perm_b32 v85, v14, v10, s29
    v_perm_b32 v82, v22, v18, s28
    v_perm_b32 v86, v22, v18, s29
    v_perm_b32 v83, v30, v26, s28
    v_perm_b32 v87, v30, v26, s29
    v_perm_b32 v88, v7, v3, s28
    v_perm_b32 v92, v7, v3, s29
    v_perm_b32 v89, v15, v11, s28
    v_perm_b32 v93, v15, v11, s29
    v_perm_b32 v90, v23, v19, s28
    v_perm_b32 v94, v23, v19, s29
    v_perm_b32 v91, v31, v27, s28
    v_perm_b32 v95, v31, v27, s29
    s_waitcnt vmcnt(0)
    v_perm_b32 v0, v36, v32, s28
    v_perm_b32 v4, v36, v32, s29
    v_perm_b32 v1, v44, v40, s28
    v_perm_b32 v5, v44, v40, s29
    v_perm_b32 v2, v52, v48, s28
    v_perm_b32 v6, v52, v48, s29
    v_perm_b32 v3, v60, v56, s28
    v_perm_b32 v7, v60, v56, s29
    v_perm_b32 v8, v37, v33, s28
    v_perm_b32 v12, v37, v33, s29
    v_perm_b32 v9, v45, v41, s28
    v_perm_b32 v13, v45, v41, s29
    v_perm_b32 v10, v53, v49, s28
    v_perm_b32 v14, v53, v49, s29
    v_perm_b32 v11, v61, v57, s28
    v_perm_b32 v15, v61, v57, s29
    v_perm_b32 v16, v38, v34, s28
    v_perm_b32 v20, v38, v34, s29
    v_perm_b32 v17, v46, v42, s28
    v_perm_b32 v21, v46, v42, s29
    v_perm_b32 v18, v54, v50, s28
    v_perm_b32 v22, v54, v50, s29
    v_perm_b32 v19, v62, v58, s28
    v_perm_b32 v23, v62, v58, s29
    v_perm_b32 v24, v39, v35, s28
    v_perm_b32 v28, v39, v35, s29
    v_perm_b32 v25, v47, v43, s28
    v_perm_b32 v29, v47, v43, s29
    v_perm_b32 v26, v55, v51, s28
    v_perm_b32 v30, v55, v51, s29
    v_perm_b32 v27, v63, v59, s28
    v_perm_b32 v31, v63, v59, s29
    ds_read_b128 v[96:99], v121 offset:0
    ds_read_b128 v[100:103], v121 offset:1024
    ds_read_b128 v[104:107], v121 offset:2048
    ds_read_b128 v[108:111], v121 offset:3072
    s_waitcnt lgkmcnt(3)
    v_mfma_f32_16x16x32_bf16 v[32:35], v[96:99], v[64:67], 0
    v_mfma_f32_16x16x32_bf16 v[36:39], v[96:99], v[68:71], 0
    v_mfma_f32_16x16x32_bf16 v[40:43], v[96:99], v[72:75], 0
    v_mfma_f32_16x16x32_bf16 v[44:47], v[96:99], v[76:79], 0
    v_mfma_f32_16x16x32_bf16 v[48:51], v[96:99], v[80:83], 0
    v_mfma_f32_16x16x32_bf16 v[52:55], v[96:99], v[84:87], 0
    v_mfma_f32_16x16x32_bf16 v[56:59], v[96:99], v[88:91], 0
    v_mfma_f32_16x16x32_bf16 v[60:63], v[96:99], v[92:95], 0
    s_waitcnt lgkmcnt(2)
    v_mfma_f32_16x16x32_bf16 v[32:35], v[100:103], v[64:67], v[32:35]
    v_mfma_f32_16x16x32_bf16 v[36:39], v[100:103], v[68:71], v[36:39]
    v_mfma_f32_16x16x32_bf16 v[40:43], v[100:103], v[72:75], v[40:43]
    v_mfma_f32_16x16x32_bf16 v[44:47], v[100:103], v[76:79], v[44:47]
    v_mfma_f32_16x16x32_bf16 v[48:51], v[100:103], v[80:83], v[48:51]
    v_mfma_f32_16x16x32_bf16 v[52:55], v[100:103], v[84:87], v[52:55]
    v_mfma_f32_16x16x32_bf16 v[56:59], v[100:103], v[88:91], v[56:59]
    v_mfma_f32_16x16x32_bf16 v[60:63], v[100:103], v[92:95], v[60:63]
    s_waitcnt lgkmcnt(1)
    v_mfma_f32_16x16x32_bf16 v[32:35], v[104:107], v[0:3], v[32:35]
    v_mfma_f32_16x16x32_bf16 v[36:39], v[104:107], v[4:7], v[36:39]
    v_mfma_f32_16x16x32_bf16 v[40:43], v[104:107], v[8:11], v[40:43]
    v_mfma_f32_16x16x32_bf16 v[44:47], v[104:107], v[12:15], v[44:47]
    v_mfma_f32_16x16x32_bf16 v[48:51], v[104:107], v[16:19], v[48:51]
    v_mfma_f32_16x16x32_bf16 v[52:55], v[104:107], v[20:23], v[52:55]
    v_mfma_f32_16x16x32_bf16 v[56:59], v[104:107], v[24:27], v[56:59]
    v_mfma_f32_16x16x32_bf16 v[60:63], v[104:107], v[28:31], v[60:63]
    s_waitcnt lgkmcnt(0)
    v_mfma_f32_16x16x32_bf16 v[32:35], v[108:111], v[0:3], v[32:35]
    v_mfma_f32_16x16x32_bf16 v[36:39], v[108:111], v[4:7], v[36:39]
    v_mfma_f32_16x16x32_bf16 v[40:43], v[108:111], v[8:11], v[40:43]
    v_mfma_f32_16x16x32_bf16 v[44:47], v[108:111], v[12:15], v[44:47]
    v_mfma_f32_16x16x32_bf16 v[48:51], v[108:111], v[16:19], v[48:51]
    v_mfma_f32_16x16x32_bf16 v[52:55], v[108:111], v[20:23], v[52:55]
    v_mfma_f32_16x16x32_bf16 v[56:59], v[108:111], v[24:27], v[56:59]
    v_mfma_f32_16x16x32_bf16 v[60:63], v[108:111], v[28:31], v[60:63]
    s_nop 7
    v_cvt_pk_bf16_f32 v112, v32, v36
    v_cvt_pk_bf16_f32 v113, v40, v44
    v_cvt_pk_bf16_f32 v114, v48, v52
    v_cvt_pk_bf16_f32 v115, v56, v60
    buffer_store_dwordx4 v[112:115], v120, s[20:23], s25 offen
    s_add_u32 s25, s25, 2736128
    v_cvt_pk_bf16_f32 v116, v33, v37
    v_cvt_pk_bf16_f32 v117, v41, v45
    v_cvt_pk_bf16_f32 v118, v49, v53
    v_cvt_pk_bf16_f32 v119, v57, v61
    buffer_store_dwordx4 v[116:119], v120, s[20:23], s25 offen
    s_add_u32 s25, s25, 2736128
    v_cvt_pk_bf16_f32 v112, v34, v38
    v_cvt_pk_bf16_f32 v113, v42, v46
    v_cvt_pk_bf16_f32 v114, v50, v54
    v_cvt_pk_bf16_f32 v115, v58, v62
    buffer_store_dwordx4 v[112:115], v120, s[20:23], s25 offen
    s_add_u32 s25, s25, 2736128
    v_cvt_pk_bf16_f32 v116, v35, v39
    v_cvt_pk_bf16_f32 v117, v43, v47
    v_cvt_pk_bf16_f32 v118, v51, v55
    v_cvt_pk_bf16_f32 v119, v59, v63
    buffer_store_dwordx4 v[116:119], v120, s[20:23], s25 offen
    s_add_u32 s25, s25, 2736128
    ds_read_b128 v[96:99], v121 offset:4096
    ds_read_b128 v[100:103], v121 offset:5120
    ds_read_b128 v[104:107], v121 offset:6144
    ds_read_b128 v[108:111], v121 offset:7168
    s_waitcnt lgkmcnt(3)
    v_mfma_f32_16x16x32_bf16 v[32:35], v[96:99], v[64:67], 0
    v_mfma_f32_16x16x32_bf16 v[36:39], v[96:99], v[68:71], 0
    v_mfma_f32_16x16x32_bf16 v[40:43], v[96:99], v[72:75], 0
    v_mfma_f32_16x16x32_bf16 v[44:47], v[96:99], v[76:79], 0
    v_mfma_f32_16x16x32_bf16 v[48:51], v[96:99], v[80:83], 0
    v_mfma_f32_16x16x32_bf16 v[52:55], v[96:99], v[84:87], 0
    v_mfma_f32_16x16x32_bf16 v[56:59], v[96:99], v[88:91], 0
    v_mfma_f32_16x16x32_bf16 v[60:63], v[96:99], v[92:95], 0
    s_waitcnt lgkmcnt(2)
    v_mfma_f32_16x16x32_bf16 v[32:35], v[100:103], v[64:67], v[32:35]
    v_mfma_f32_16x16x32_bf16 v[36:39], v[100:103], v[68:71], v[36:39]
    v_mfma_f32_16x16x32_bf16 v[40:43], v[100:103], v[72:75], v[40:43]
    v_mfma_f32_16x16x32_bf16 v[44:47], v[100:103], v[76:79], v[44:47]
    v_mfma_f32_16x16x32_bf16 v[48:51], v[100:103], v[80:83], v[48:51]
    v_mfma_f32_16x16x32_bf16 v[52:55], v[100:103], v[84:87], v[52:55]
    v_mfma_f32_16x16x32_bf16 v[56:59], v[100:103], v[88:91], v[56:59]
    v_mfma_f32_16x16x32_bf16 v[60:63], v[100:103], v[92:95], v[60:63]
    s_waitcnt lgkmcnt(1)
    v_mfma_f32_16x16x32_bf16 v[32:35], v[104:107], v[0:3], v[32:35]
    v_mfma_f32_16x16x32_bf16 v[36:39], v[104:107], v[4:7], v[36:39]
    v_mfma_f32_16x16x32_bf16 v[40:43], v[104:107], v[8:11], v[40:43]
    v_mfma_f32_16x16x32_bf16 v[44:47], v[104:107], v[12:15], v[44:47]
    v_mfma_f32_16x16x32_bf16 v[48:51], v[104:107], v[16:19], v[48:51]
    v_mfma_f32_16x16x32_bf16 v[52:55], v[104:107], v[20:23], v[52:55]
    v_mfma_f32_16x16x32_bf16 v[56:59], v[104:107], v[24:27], v[56:59]
    v_mfma_f32_16x16x32_bf16 v[60:63], v[104:107], v[28:31], v[60:63]
    s_waitcnt lgkmcnt(0)
    v_mfma_f32_16x16x32_bf16 v[32:35], v[108:111], v[0:3], v[32:35]
    v_mfma_f32_16x16x32_bf16 v[36:39], v[108:111], v[4:7], v[36:39]
    v_mfma_f32_16x16x32_bf16 v[40:43], v[108:111], v[8:11], v[40:43]
    v_mfma_f32_16x16x32_bf16 v[44:47], v[108:111], v[12:15], v[44:47]
    v_mfma_f32_16x16x32_bf16 v[48:51], v[108:111], v[16:19], v[48:51]
    v_mfma_f32_16x16x32_bf16 v[52:55], v[108:111], v[20:23], v[52:55]
    v_mfma_f32_16x16x32_bf16 v[56:59], v[108:111], v[24:27], v[56:59]
    v_mfma_f32_16x16x32_bf16 v[60:63], v[108:111], v[28:31], v[60:63]
    s_nop 7
    v_cvt_pk_bf16_f32 v112, v32, v36
    v_cvt_pk_bf16_f32 v113, v40, v44
    v_cvt_pk_bf16_f32 v114, v48, v52
    v_cvt_pk_bf16_f32 v115, v56, v60
    buffer_store_dwordx4 v[112:115], v120, s[20:23], s25 offen
    s_add_u32 s25, s25, 2736128
    v_cvt_pk_bf16_f32 v116, v33, v37
    v_cvt_pk_bf16_f32 v117, v41, v45
    v_cvt_pk_bf16_f32 v118, v49, v53
    v_cvt_pk_bf16_f32 v119, v57, v61
    buffer_store_dwordx4 v[116:119], v120, s[20:23], s25 offen
    s_add_u32 s25, s25, 2736128
    v_cvt_pk_bf16_f32 v112, v34, v38
    v_cvt_pk_bf16_f32 v113, v42, v46
    v_cvt_pk_bf16_f32 v114, v50, v54
    v_cvt_pk_bf16_f32 v115, v58, v62
    buffer_store_dwordx4 v[112:115], v120, s[20:23], s25 offen
    s_add_u32 s25, s25, 2736128
    v_cvt_pk_bf16_f32 v116, v35, v39
    v_cvt_pk_bf16_f32 v117, v43, v47
    v_cvt_pk_bf16_f32 v118, v51, v55
    v_cvt_pk_bf16_f32 v119, v59, v63
    buffer_store_dwordx4 v[116:119], v120, s[20:23], s25 offen
    s_add_u32 s25, s25, 2736128
    ds_read_b128 v[96:99], v121 offset:8192
    ds_read_b128 v[100:103], v121 offset:9216
    ds_read_b128 v[104:107], v121 offset:10240
    ds_read_b128 v[108:111], v121 offset:11264
    s_waitcnt lgkmcnt(3)
    v_mfma_f32_16x16x32_bf16 v[32:35], v[96:99], v[64:67], 0
    v_mfma_f32_16x16x32_bf16 v[36:39], v[96:99], v[68:71], 0
    v_mfma_f32_16x16x32_bf16 v[40:43], v[96:99], v[72:75], 0
    v_mfma_f32_16x16x32_bf16 v[44:47], v[96:99], v[76:79], 0
    v_mfma_f32_16x16x32_bf16 v[48:51], v[96:99], v[80:83], 0
    v_mfma_f32_16x16x32_bf16 v[52:55], v[96:99], v[84:87], 0
    v_mfma_f32_16x16x32_bf16 v[56:59], v[96:99], v[88:91], 0
    v_mfma_f32_16x16x32_bf16 v[60:63], v[96:99], v[92:95], 0
    s_waitcnt lgkmcnt(2)
    v_mfma_f32_16x16x32_bf16 v[32:35], v[100:103], v[64:67], v[32:35]
    v_mfma_f32_16x16x32_bf16 v[36:39], v[100:103], v[68:71], v[36:39]
    v_mfma_f32_16x16x32_bf16 v[40:43], v[100:103], v[72:75], v[40:43]
    v_mfma_f32_16x16x32_bf16 v[44:47], v[100:103], v[76:79], v[44:47]
    v_mfma_f32_16x16x32_bf16 v[48:51], v[100:103], v[80:83], v[48:51]
    v_mfma_f32_16x16x32_bf16 v[52:55], v[100:103], v[84:87], v[52:55]
    v_mfma_f32_16x16x32_bf16 v[56:59], v[100:103], v[88:91], v[56:59]
    v_mfma_f32_16x16x32_bf16 v[60:63], v[100:103], v[92:95], v[60:63]
    s_waitcnt lgkmcnt(1)
    v_mfma_f32_16x16x32_bf16 v[32:35], v[104:107], v[0:3], v[32:35]
    v_mfma_f32_16x16x32_bf16 v[36:39], v[104:107], v[4:7], v[36:39]
    v_mfma_f32_16x16x32_bf16 v[40:43], v[104:107], v[8:11], v[40:43]
    v_mfma_f32_16x16x32_bf16 v[44:47], v[104:107], v[12:15], v[44:47]
    v_mfma_f32_16x16x32_bf16 v[48:51], v[104:107], v[16:19], v[48:51]
    v_mfma_f32_16x16x32_bf16 v[52:55], v[104:107], v[20:23], v[52:55]
    v_mfma_f32_16x16x32_bf16 v[56:59], v[104:107], v[24:27], v[56:59]
    v_mfma_f32_16x16x32_bf16 v[60:63], v[104:107], v[28:31], v[60:63]
    s_waitcnt lgkmcnt(0)
    v_mfma_f32_16x16x32_bf16 v[32:35], v[108:111], v[0:3], v[32:35]
    v_mfma_f32_16x16x32_bf16 v[36:39], v[108:111], v[4:7], v[36:39]
    v_mfma_f32_16x16x32_bf16 v[40:43], v[108:111], v[8:11], v[40:43]
    v_mfma_f32_16x16x32_bf16 v[44:47], v[108:111], v[12:15], v[44:47]
    v_mfma_f32_16x16x32_bf16 v[48:51], v[108:111], v[16:19], v[48:51]
    v_mfma_f32_16x16x32_bf16 v[52:55], v[108:111], v[20:23], v[52:55]
    v_mfma_f32_16x16x32_bf16 v[56:59], v[108:111], v[24:27], v[56:59]
    v_mfma_f32_16x16x32_bf16 v[60:63], v[108:111], v[28:31], v[60:63]
    s_nop 7
    v_cvt_pk_bf16_f32 v112, v32, v36
    v_cvt_pk_bf16_f32 v113, v40, v44
    v_cvt_pk_bf16_f32 v114, v48, v52
    v_cvt_pk_bf16_f32 v115, v56, v60
    buffer_store_dwordx4 v[112:115], v120, s[20:23], s25 offen
    s_add_u32 s25, s25, 2736128
    v_cvt_pk_bf16_f32 v116, v33, v37
    v_cvt_pk_bf16_f32 v117, v41, v45
    v_cvt_pk_bf16_f32 v118, v49, v53
    v_cvt_pk_bf16_f32 v119, v57, v61
    buffer_store_dwordx4 v[116:119], v120, s[20:23], s25 offen
    s_add_u32 s25, s25, 2736128
    v_cvt_pk_bf16_f32 v112, v34, v38
    v_cvt_pk_bf16_f32 v113, v42, v46
    v_cvt_pk_bf16_f32 v114, v50, v54
    v_cvt_pk_bf16_f32 v115, v58, v62
    buffer_store_dwordx4 v[112:115], v120, s[20:23], s25 offen
    s_add_u32 s25, s25, 2736128
    v_cvt_pk_bf16_f32 v116, v35, v39
    v_cvt_pk_bf16_f32 v117, v43, v47
    v_cvt_pk_bf16_f32 v118, v51, v55
    v_cvt_pk_bf16_f32 v119, v59, v63
    buffer_store_dwordx4 v[116:119], v120, s[20:23], s25 offen
    s_add_u32 s25, s25, 2736128
    ds_read_b128 v[96:99], v121 offset:12288
    ds_read_b128 v[100:103], v121 offset:13312
    ds_read_b128 v[104:107], v121 offset:14336
    ds_read_b128 v[108:111], v121 offset:15360
    s_waitcnt lgkmcnt(3)
    v_mfma_f32_16x16x32_bf16 v[32:35], v[96:99], v[64:67], 0
    v_mfma_f32_16x16x32_bf16 v[36:39], v[96:99], v[68:71], 0
    v_mfma_f32_16x16x32_bf16 v[40:43], v[96:99], v[72:75], 0
    v_mfma_f32_16x16x32_bf16 v[44:47], v[96:99], v[76:79], 0
    v_mfma_f32_16x16x32_bf16 v[48:51], v[96:99], v[80:83], 0
    v_mfma_f32_16x16x32_bf16 v[52:55], v[96:99], v[84:87], 0
    v_mfma_f32_16x16x32_bf16 v[56:59], v[96:99], v[88:91], 0
    v_mfma_f32_16x16x32_bf16 v[60:63], v[96:99], v[92:95], 0
    s_waitcnt lgkmcnt(2)
    v_mfma_f32_16x16x32_bf16 v[32:35], v[100:103], v[64:67], v[32:35]
    v_mfma_f32_16x16x32_bf16 v[36:39], v[100:103], v[68:71], v[36:39]
    v_mfma_f32_16x16x32_bf16 v[40:43], v[100:103], v[72:75], v[40:43]
    v_mfma_f32_16x16x32_bf16 v[44:47], v[100:103], v[76:79], v[44:47]
    v_mfma_f32_16x16x32_bf16 v[48:51], v[100:103], v[80:83], v[48:51]
    v_mfma_f32_16x16x32_bf16 v[52:55], v[100:103], v[84:87], v[52:55]
    v_mfma_f32_16x16x32_bf16 v[56:59], v[100:103], v[88:91], v[56:59]
    v_mfma_f32_16x16x32_bf16 v[60:63], v[100:103], v[92:95], v[60:63]
    s_waitcnt lgkmcnt(1)
    v_mfma_f32_16x16x32_bf16 v[32:35], v[104:107], v[0:3], v[32:35]
    v_mfma_f32_16x16x32_bf16 v[36:39], v[104:107], v[4:7], v[36:39]
    v_mfma_f32_16x16x32_bf16 v[40:43], v[104:107], v[8:11], v[40:43]
    v_mfma_f32_16x16x32_bf16 v[44:47], v[104:107], v[12:15], v[44:47]
    v_mfma_f32_16x16x32_bf16 v[48:51], v[104:107], v[16:19], v[48:51]
    v_mfma_f32_16x16x32_bf16 v[52:55], v[104:107], v[20:23], v[52:55]
    v_mfma_f32_16x16x32_bf16 v[56:59], v[104:107], v[24:27], v[56:59]
    v_mfma_f32_16x16x32_bf16 v[60:63], v[104:107], v[28:31], v[60:63]
    s_waitcnt lgkmcnt(0)
    v_mfma_f32_16x16x32_bf16 v[32:35], v[108:111], v[0:3], v[32:35]
    v_mfma_f32_16x16x32_bf16 v[36:39], v[108:111], v[4:7], v[36:39]
    v_mfma_f32_16x16x32_bf16 v[40:43], v[108:111], v[8:11], v[40:43]
    v_mfma_f32_16x16x32_bf16 v[44:47], v[108:111], v[12:15], v[44:47]
    v_mfma_f32_16x16x32_bf16 v[48:51], v[108:111], v[16:19], v[48:51]
    v_mfma_f32_16x16x32_bf16 v[52:55], v[108:111], v[20:23], v[52:55]
    v_mfma_f32_16x16x32_bf16 v[56:59], v[108:111], v[24:27], v[56:59]
    v_mfma_f32_16x16x32_bf16 v[60:63], v[108:111], v[28:31], v[60:63]
    s_nop 7
    v_cvt_pk_bf16_f32 v112, v32, v36
    v_cvt_pk_bf16_f32 v113, v40, v44
    v_cvt_pk_bf16_f32 v114, v48, v52
    v_cvt_pk_bf16_f32 v115, v56, v60
    buffer_store_dwordx4 v[112:115], v120, s[20:23], s25 offen
    s_add_u32 s25, s25, 2736128
    v_cvt_pk_bf16_f32 v116, v33, v37
    v_cvt_pk_bf16_f32 v117, v41, v45
    v_cvt_pk_bf16_f32 v118, v49, v53
    v_cvt_pk_bf16_f32 v119, v57, v61
    buffer_store_dwordx4 v[116:119], v120, s[20:23], s25 offen
    s_add_u32 s25, s25, 2736128
    v_cvt_pk_bf16_f32 v112, v34, v38
    v_cvt_pk_bf16_f32 v113, v42, v46
    v_cvt_pk_bf16_f32 v114, v50, v54
    v_cvt_pk_bf16_f32 v115, v58, v62
    buffer_store_dwordx4 v[112:115], v120, s[20:23], s25 offen
    s_add_u32 s25, s25, 2736128
    v_cvt_pk_bf16_f32 v116, v35, v39
    v_cvt_pk_bf16_f32 v117, v43, v47
    v_cvt_pk_bf16_f32 v118, v51, v55
    v_cvt_pk_bf16_f32 v119, v59, v63
    buffer_store_dwordx4 v[116:119], v120, s[20:23], s25 offen
    s_endpgm
K1_W:
    s_mov_b32 s16, s6
    s_mov_b32 s17, s7
    s_and_b32 s17, s17, 0xffff
    s_mov_b32 s18, 16252928
    s_mov_b32 s19, 0x00020000
    s_add_u32 s20, s8, 50331648
    s_addc_u32 s21, s9, 0
    s_and_b32 s21, s21, 0xffff
    s_mov_b32 s22, 67108864
    s_mov_b32 s23, 0x00020000
    s_mul_i32 s11, s2, 1
    s_lshr_b32 s12, s11, 9
    s_and_b32 s13, s11, 511
    s_lshl_b32 s14, s12, 19
    s_lshl_b32 s15, s13, 10
    s_add_u32 s14, s14, s15
    s_lshl_b32 s15, s3, 8
    s_add_u32 s14, s14, s15
    v_and_b32 v126, 1, v123
    v_lshlrev_b32 v126, 23, v126
    v_lshl_add_u32 v126, v122, 4, v126
    s_mov_b32 s15, s14
    buffer_load_dwordx4 v[0:3], v126, s[16:19], s15 offen
    s_add_u32 s15, s15, 0x100000
    buffer_load_dwordx4 v[4:7], v126, s[16:19], s15 offen
    s_add_u32 s15, s15, 0x100000
    buffer_load_dwordx4 v[8:11], v126, s[16:19], s15 offen
    s_add_u32 s15, s15, 0x100000
    buffer_load_dwordx4 v[12:15], v126, s[16:19], s15 offen
    s_add_u32 s15, s15, 0x100000
    buffer_load_dwordx4 v[16:19], v126, s[16:19], s15 offen
    s_add_u32 s15, s15, 0x100000
    buffer_load_dwordx4 v[20:23], v126, s[16:19], s15 offen
    s_add_u32 s15, s15, 0x100000
    buffer_load_dwordx4 v[24:27], v126, s[16:19], s15 offen
    s_add_u32 s15, s15, 0x100000
    buffer_load_dwordx4 v[28:31], v126, s[16:19], s15 offen
    v_and_b32 v127, 1, v123
    v_lshlrev_b32 v127, 3, v127
    v_mul_u32_u24 v112, 96, v125
    v_mad_u32_u24 v113, v124, v127, v112
    v_mad_u32_u24 v64, v124, 0, v113
    v_mad_u32_u24 v65, v124, 1, v113
    v_mad_u32_u24 v66, v124, 2, v113
    v_mad_u32_u24 v67, v124, 3, v113
    v_mad_u32_u24 v68, v124, 4, v113
    v_mad_u32_u24 v69, v124, 5, v113
    v_mad_u32_u24 v70, v124, 6, v113
    v_mad_u32_u24 v71, v124, 7, v113
    v_and_b32 v64, 127, v64
    v_and_b32 v65, 127, v65
    v_and_b32 v66, 127, v66
    v_and_b32 v67, 127, v67
    v_and_b32 v68, 127, v68
    v_and_b32 v69, 127, v69
    v_and_b32 v70, 127, v70
    v_and_b32 v71, 127, v71
    v_cvt_f32_u32 v64, v64
    v_cvt_f32_u32 v65, v65
    v_cvt_f32_u32 v66, v66
    v_cvt_f32_u32 v67, v67
    v_cvt_f32_u32 v68, v68
    v_cvt_f32_u32 v69, v69
    v_cvt_f32_u32 v70, v70
    v_cvt_f32_u32 v71, v71
    v_mul_f32 v64, 0x3c000000, v64
    v_mul_f32 v65, 0x3c000000, v65
    v_mul_f32 v66, 0x3c000000, v66
    v_mul_f32 v67, 0x3c000000, v67
    v_mul_f32 v68, 0x3c000000, v68
    v_mul_f32 v69, 0x3c000000, v69
    v_mul_f32 v70, 0x3c000000, v70
    v_mul_f32 v71, 0x3c000000, v71
    v_cos_f32 v64, v64
    v_cos_f32 v65, v65
    v_cos_f32 v66, v66
    v_cos_f32 v67, v67
    v_cos_f32 v68, v68
    v_cos_f32 v69, v69
    v_cos_f32 v70, v70
    v_cos_f32 v71, v71
    s_nop 0
    v_cvt_pk_bf16_f32 v72, v64, v65
    v_cvt_pk_bf16_f32 v73, v66, v67
    v_cvt_pk_bf16_f32 v74, v68, v69
    v_cvt_pk_bf16_f32 v75, v70, v71
    v_lshlrev_b32 v80, 16, v72
    v_and_b32 v81, 0xffff0000, v72
    v_sub_f32 v64, v64, v80
    v_sub_f32 v65, v65, v81
    v_lshlrev_b32 v80, 16, v73
    v_and_b32 v81, 0xffff0000, v73
    v_sub_f32 v66, v66, v80
    v_sub_f32 v67, v67, v81
    v_lshlrev_b32 v80, 16, v74
    v_and_b32 v81, 0xffff0000, v74
    v_sub_f32 v68, v68, v80
    v_sub_f32 v69, v69, v81
    v_lshlrev_b32 v80, 16, v75
    v_and_b32 v81, 0xffff0000, v75
    v_sub_f32 v70, v70, v80
    v_sub_f32 v71, v71, v81
    v_cvt_pk_bf16_f32 v76, v64, v65
    v_cvt_pk_bf16_f32 v77, v66, v67
    v_cvt_pk_bf16_f32 v78, v68, v69
    v_cvt_pk_bf16_f32 v79, v70, v71
    v_cmp_lt_u32 vcc, 1, v123
    s_lshl_b32 s24, s3, 10
    v_add_u32 v114, s24, v121
    v_cndmask_b32 v72, v72, v76, vcc
    v_cndmask_b32 v73, v73, v77, vcc
    v_cndmask_b32 v74, v74, v78, vcc
    v_cndmask_b32 v75, v75, v79, vcc
    ds_write_b128 v114, v[72:75]
    v_lshrrev_b32 v112, 1, v123
    s_mov_b32 s24, 2097152
    v_mul_lo_u32 v112, v112, s24
    v_and_b32 v113, 1, v123
    v_lshl_add_u32 v112, v113, 8, v112
    v_and_b32 v113, 1, v122
    v_lshl_add_u32 v124, v113, 4, v112
    v_lshrrev_b32 v125, 1, v122
    s_mul_i32 s26, s3, 524288
    s_lshl_b32 s24, s11, 9
    s_add_u32 s26, s26, s24
    s_waitcnt lgkmcnt(0)
    s_barrier
    ds_read_b128 v[96:99], v121 offset:0
    ds_read_b128 v[100:103], v121 offset:1024
    ds_read_b128 v[104:107], v121 offset:2048
    ds_read_b128 v[108:111], v121 offset:3072
    s_mov_b32 s27, 0
    s_waitcnt vmcnt(0) lgkmcnt(0)
K1_W_LOOP:
    s_add_u32 s24, s11, s27
    s_and_b32 s30, s24, 3
    s_lshr_b32 s24, s24, 1
    s_and_b32 s24, s24, 4
    s_or_b32 s30, s30, s24
    v_xor_b32 v112, s30, v125
    v_lshl_add_u32 v120, v112, 5, v124
    s_lshl_b32 s25, s27, 9
    s_add_u32 s25, s25, s26
    v_perm_b32 v32, v4, v0, s28
    v_perm_b32 v36, v4, v0, s29
    v_perm_b32 v33, v12, v8, s28
    v_perm_b32 v37, v12, v8, s29
    v_perm_b32 v34, v20, v16, s28
    v_perm_b32 v38, v20, v16, s29
    v_perm_b32 v35, v28, v24, s28
    v_perm_b32 v39, v28, v24, s29
    v_perm_b32 v40, v5, v1, s28
    v_perm_b32 v44, v5, v1, s29
    v_perm_b32 v41, v13, v9, s28
    v_perm_b32 v45, v13, v9, s29
    v_perm_b32 v42, v21, v17, s28
    v_perm_b32 v46, v21, v17, s29
    v_perm_b32 v43, v29, v25, s28
    v_perm_b32 v47, v29, v25, s29
    v_perm_b32 v48, v6, v2, s28
    v_perm_b32 v52, v6, v2, s29
    v_perm_b32 v49, v14, v10, s28
    v_perm_b32 v53, v14, v10, s29
    v_perm_b32 v50, v22, v18, s28
    v_perm_b32 v54, v22, v18, s29
    v_perm_b32 v51, v30, v26, s28
    v_perm_b32 v55, v30, v26, s29
    v_perm_b32 v56, v7, v3, s28
    v_perm_b32 v60, v7, v3, s29
    v_perm_b32 v57, v15, v11, s28
    v_perm_b32 v61, v15, v11, s29
    v_perm_b32 v58, v23, v19, s28
    v_perm_b32 v62, v23, v19, s29
    v_perm_b32 v59, v31, v27, s28
    v_perm_b32 v63, v31, v27, s29
    s_add_u32 s27, s27, 1
    s_add_u32 s14, s14, 1024
    s_cmp_ge_u32 s27, 1
    s_cbranch_scc1 K1_W_NOLOAD
    s_mov_b32 s15, s14
    buffer_load_dwordx4 v[0:3], v126, s[16:19], s15 offen
    s_add_u32 s15, s15, 0x100000
    buffer_load_dwordx4 v[4:7], v126, s[16:19], s15 offen
    s_add_u32 s15, s15, 0x100000
    buffer_load_dwordx4 v[8:11], v126, s[16:19], s15 offen
    s_add_u32 s15, s15, 0x100000
    buffer_load_dwordx4 v[12:15], v126, s[16:19], s15 offen
    s_add_u32 s15, s15, 0x100000
    buffer_load_dwordx4 v[16:19], v126, s[16:19], s15 offen
    s_add_u32 s15, s15, 0x100000
    buffer_load_dwordx4 v[20:23], v126, s[16:19], s15 offen
    s_add_u32 s15, s15, 0x100000
    buffer_load_dwordx4 v[24:27], v126, s[16:19], s15 offen
    s_add_u32 s15, s15, 0x100000
    buffer_load_dwordx4 v[28:31], v126, s[16:19], s15 offen
K1_W_NOLOAD:
    v_mfma_f32_16x16x32_bf16 v[64:67], v[96:99], v[32:35], 0
    v_mfma_f32_16x16x32_bf16 v[68:71], v[96:99], v[36:39], 0
    v_mfma_f32_16x16x32_bf16 v[72:75], v[96:99], v[40:43], 0
    v_mfma_f32_16x16x32_bf16 v[76:79], v[96:99], v[44:47], 0
    v_mfma_f32_16x16x32_bf16 v[80:83], v[96:99], v[48:51], 0
    v_mfma_f32_16x16x32_bf16 v[84:87], v[96:99], v[52:55], 0
    v_mfma_f32_16x16x32_bf16 v[88:91], v[96:99], v[56:59], 0
    v_mfma_f32_16x16x32_bf16 v[92:95], v[96:99], v[60:63], 0
    s_nop 7
    v_cvt_pk_bf16_f32 v112, v64, v68
    v_cvt_pk_bf16_f32 v113, v72, v76
    v_cvt_pk_bf16_f32 v114, v80, v84
    v_cvt_pk_bf16_f32 v115, v88, v92
    buffer_store_dwordx4 v[112:115], v120, s[20:23], s25 offen
    s_add_u32 s25, s25, 4194304
    v_cvt_pk_bf16_f32 v116, v65, v69
    v_cvt_pk_bf16_f32 v117, v73, v77
    v_cvt_pk_bf16_f32 v118, v81, v85
    v_cvt_pk_bf16_f32 v119, v89, v93
    buffer_store_dwordx4 v[116:119], v120, s[20:23], s25 offen
    s_add_u32 s25, s25, 4194304
    v_cvt_pk_bf16_f32 v112, v66, v70
    v_cvt_pk_bf16_f32 v113, v74, v78
    v_cvt_pk_bf16_f32 v114, v82, v86
    v_cvt_pk_bf16_f32 v115, v90, v94
    buffer_store_dwordx4 v[112:115], v120, s[20:23], s25 offen
    s_add_u32 s25, s25, 4194304
    v_cvt_pk_bf16_f32 v116, v67, v71
    v_cvt_pk_bf16_f32 v117, v75, v79
    v_cvt_pk_bf16_f32 v118, v83, v87
    v_cvt_pk_bf16_f32 v119, v91, v95
    buffer_store_dwordx4 v[116:119], v120, s[20:23], s25 offen
    s_add_u32 s25, s25, 4194304
    v_mfma_f32_16x16x32_bf16 v[64:67], v[100:103], v[32:35], 0
    v_mfma_f32_16x16x32_bf16 v[68:71], v[100:103], v[36:39], 0
    v_mfma_f32_16x16x32_bf16 v[72:75], v[100:103], v[40:43], 0
    v_mfma_f32_16x16x32_bf16 v[76:79], v[100:103], v[44:47], 0
    v_mfma_f32_16x16x32_bf16 v[80:83], v[100:103], v[48:51], 0
    v_mfma_f32_16x16x32_bf16 v[84:87], v[100:103], v[52:55], 0
    v_mfma_f32_16x16x32_bf16 v[88:91], v[100:103], v[56:59], 0
    v_mfma_f32_16x16x32_bf16 v[92:95], v[100:103], v[60:63], 0
    s_nop 7
    v_cvt_pk_bf16_f32 v112, v64, v68
    v_cvt_pk_bf16_f32 v113, v72, v76
    v_cvt_pk_bf16_f32 v114, v80, v84
    v_cvt_pk_bf16_f32 v115, v88, v92
    buffer_store_dwordx4 v[112:115], v120, s[20:23], s25 offen
    s_add_u32 s25, s25, 4194304
    v_cvt_pk_bf16_f32 v116, v65, v69
    v_cvt_pk_bf16_f32 v117, v73, v77
    v_cvt_pk_bf16_f32 v118, v81, v85
    v_cvt_pk_bf16_f32 v119, v89, v93
    buffer_store_dwordx4 v[116:119], v120, s[20:23], s25 offen
    s_add_u32 s25, s25, 4194304
    v_cvt_pk_bf16_f32 v112, v66, v70
    v_cvt_pk_bf16_f32 v113, v74, v78
    v_cvt_pk_bf16_f32 v114, v82, v86
    v_cvt_pk_bf16_f32 v115, v90, v94
    buffer_store_dwordx4 v[112:115], v120, s[20:23], s25 offen
    s_add_u32 s25, s25, 4194304
    v_cvt_pk_bf16_f32 v116, v67, v71
    v_cvt_pk_bf16_f32 v117, v75, v79
    v_cvt_pk_bf16_f32 v118, v83, v87
    v_cvt_pk_bf16_f32 v119, v91, v95
    buffer_store_dwordx4 v[116:119], v120, s[20:23], s25 offen
    s_add_u32 s25, s25, 4194304
    v_mfma_f32_16x16x32_bf16 v[64:67], v[104:107], v[32:35], 0
    v_mfma_f32_16x16x32_bf16 v[68:71], v[104:107], v[36:39], 0
    v_mfma_f32_16x16x32_bf16 v[72:75], v[104:107], v[40:43], 0
    v_mfma_f32_16x16x32_bf16 v[76:79], v[104:107], v[44:47], 0
    v_mfma_f32_16x16x32_bf16 v[80:83], v[104:107], v[48:51], 0
    v_mfma_f32_16x16x32_bf16 v[84:87], v[104:107], v[52:55], 0
    v_mfma_f32_16x16x32_bf16 v[88:91], v[104:107], v[56:59], 0
    v_mfma_f32_16x16x32_bf16 v[92:95], v[104:107], v[60:63], 0
    s_nop 7
    v_cvt_pk_bf16_f32 v112, v64, v68
    v_cvt_pk_bf16_f32 v113, v72, v76
    v_cvt_pk_bf16_f32 v114, v80, v84
    v_cvt_pk_bf16_f32 v115, v88, v92
    buffer_store_dwordx4 v[112:115], v120, s[20:23], s25 offen
    s_add_u32 s25, s25, 4194304
    v_cvt_pk_bf16_f32 v116, v65, v69
    v_cvt_pk_bf16_f32 v117, v73, v77
    v_cvt_pk_bf16_f32 v118, v81, v85
    v_cvt_pk_bf16_f32 v119, v89, v93
    buffer_store_dwordx4 v[116:119], v120, s[20:23], s25 offen
    s_add_u32 s25, s25, 4194304
    v_cvt_pk_bf16_f32 v112, v66, v70
    v_cvt_pk_bf16_f32 v113, v74, v78
    v_cvt_pk_bf16_f32 v114, v82, v86
    v_cvt_pk_bf16_f32 v115, v90, v94
    buffer_store_dwordx4 v[112:115], v120, s[20:23], s25 offen
    s_add_u32 s25, s25, 4194304
    v_cvt_pk_bf16_f32 v116, v67, v71
    v_cvt_pk_bf16_f32 v117, v75, v79
    v_cvt_pk_bf16_f32 v118, v83, v87
    v_cvt_pk_bf16_f32 v119, v91, v95
    buffer_store_dwordx4 v[116:119], v120, s[20:23], s25 offen
    s_add_u32 s25, s25, 4194304
    v_mfma_f32_16x16x32_bf16 v[64:67], v[108:111], v[32:35], 0
    v_mfma_f32_16x16x32_bf16 v[68:71], v[108:111], v[36:39], 0
    v_mfma_f32_16x16x32_bf16 v[72:75], v[108:111], v[40:43], 0
    v_mfma_f32_16x16x32_bf16 v[76:79], v[108:111], v[44:47], 0
    v_mfma_f32_16x16x32_bf16 v[80:83], v[108:111], v[48:51], 0
    v_mfma_f32_16x16x32_bf16 v[84:87], v[108:111], v[52:55], 0
    v_mfma_f32_16x16x32_bf16 v[88:91], v[108:111], v[56:59], 0
    v_mfma_f32_16x16x32_bf16 v[92:95], v[108:111], v[60:63], 0
    s_nop 7
    v_cvt_pk_bf16_f32 v112, v64, v68
    v_cvt_pk_bf16_f32 v113, v72, v76
    v_cvt_pk_bf16_f32 v114, v80, v84
    v_cvt_pk_bf16_f32 v115, v88, v92
    buffer_store_dwordx4 v[112:115], v120, s[20:23], s25 offen
    s_add_u32 s25, s25, 4194304
    v_cvt_pk_bf16_f32 v116, v65, v69
    v_cvt_pk_bf16_f32 v117, v73, v77
    v_cvt_pk_bf16_f32 v118, v81, v85
    v_cvt_pk_bf16_f32 v119, v89, v93
    buffer_store_dwordx4 v[116:119], v120, s[20:23], s25 offen
    s_add_u32 s25, s25, 4194304
    v_cvt_pk_bf16_f32 v112, v66, v70
    v_cvt_pk_bf16_f32 v113, v74, v78
    v_cvt_pk_bf16_f32 v114, v82, v86
    v_cvt_pk_bf16_f32 v115, v90, v94
    buffer_store_dwordx4 v[112:115], v120, s[20:23], s25 offen
    s_add_u32 s25, s25, 4194304
    v_cvt_pk_bf16_f32 v116, v67, v71
    v_cvt_pk_bf16_f32 v117, v75, v79
    v_cvt_pk_bf16_f32 v118, v83, v87
    v_cvt_pk_bf16_f32 v119, v91, v95
    buffer_store_dwordx4 v[116:119], v120, s[20:23], s25 offen
    s_waitcnt vmcnt(16)
    s_cmp_lt_u32 s27, 1
    s_cbranch_scc1 K1_W_LOOP
K1_END:
    s_endpgm
.p2align 8
.type k12_fused_kernel,@function
k12_fused_kernel:
    s_cmp_ge_u32 s2, 256
    s_cbranch_scc1 K12_END
    s_load_dwordx4 s[52:55], s[0:1], 0
    s_load_dwordx4 s[56:59], s[0:1], 40
    s_getpc_b64 s[90:91]
CPF_K12:
    s_sub_u32 s90, s90, CPF_K12-k12_fused_kernel
    s_subb_u32 s91, s91, 0
    v_lshlrev_b32 v8, 7, v0
    v_mov_b32 v11, s91
    v_min_u32 v9, TEXT_END-k12_fused_kernel-4, v8
    v_add_co_u32 v10, vcc, s90, v9
    v_addc_co_u32 v11, vcc, 0, v11, vcc
    global_load_dword v63, v[10:11], off
    v_lshrrev_b32 v1, 6, v0
    v_and_b32 v2, 63, v0
    v_readfirstlane_b32 s3, v1
    s_waitcnt lgkmcnt(0)
    s_cmp_lt_u32 s3, 4
    s_cbranch_scc1 K12_CONS
    v_and_b32 v64, 15, v2
    v_lshrrev_b32 v65, 4, v2
    v_lshlrev_b32 v254, 4, v2
    s_and_b32 s44, s3, 3
    s_and_b32 s20, s44, 1
    s_lshr_b32 s21, s44, 1
    s_lshl_b32 s22, s2, 1
    s_add_u32 s22, s22, s21
    s_and_b32 s23, s22, 3
    s_lshr_b32 s22, s22, 2
    s_and_b32 s24, s2, 7
    s_lshl_b32 s24, s24, 5
    s_lshr_b32 s25, s2, 3
    s_add_u32 s24, s24, s25
    s_cmp_ge_u32 s24, 167
    s_cselect_b32 s25, 1, 0
    s_mul_i32 s26, s25, 167
    s_sub_u32 s24, s24, s26
    s_cmp_eq_u32 s21, 0
    s_cselect_b32 s25, s25, 1
    s_mul_i32 s26, s25, 16384000
    s_add_u32 s4, s52, s26
    s_addc_u32 s5, s53, 0
    s_and_b32 s5, s5, 0xffff
    s_mov_b32 s6, 16384000
    s_mov_b32 s7, 0x00020000
    s_mov_b32 s8, s54
    s_mov_b32 s9, s55
    s_and_b32 s9, s9, 0xffff
    s_mov_b32 s10, 16252928
    s_mov_b32 s11, 0x00020000
    s_mov_b32 s12, s58
    s_mov_b32 s13, s59
    s_and_b32 s13, s13, 0xffff
    s_mov_b32 s14, 43778048
    s_mov_b32 s15, 0x00020000
    s_add_u32 s16, s58, 50331648
    s_addc_u32 s17, s59, 0
    s_and_b32 s17, s17, 0xffff
    s_mov_b32 s18, 67108864
    s_mov_b32 s19, 0x00020000
    s_add_u32 s60, s58, 153092096
    s_addc_u32 s61, s59, 0
    s_and_b32 s61, s61, 0xffff
    s_mov_b32 s62, 32768
    s_mov_b32 s63, 0x00020000
    s_mov_b32 s28, 0x05040100
    s_mov_b32 s29, 0x07060302
    v_lshlrev_b32 v248, 14, v65
    v_lshl_add_u32 v248, v64, 4, v248
    v_and_b32 v250, 1, v65
    v_lshlrev_b32 v250, 23, v250
    v_lshl_add_u32 v250, v64, 4, v250
    v_lshrrev_b32 v66, 1, v65
    s_mov_b32 s26, 1368064
    v_mul_lo_u32 v66, v66, s26
    v_lshrrev_b32 v67, 2, v64
    s_mov_b32 s26, 21376
    v_mul_lo_u32 v67, v67, s26
    v_add_u32 v66, v66, v67
    v_mov_b32 v252, v66
    v_lshrrev_b32 v66, 1, v65
    s_mov_b32 s26, 2097152
    v_mul_lo_u32 v66, v66, s26
    v_and_b32 v67, 1, v65
    v_lshl_add_u32 v66, v67, 8, v66
    v_and_b32 v67, 1, v64
    v_lshl_add_u32 v251, v67, 4, v66
    s_mul_i32 s31, s25, 684032
    s_mul_i32 s32, s23, 524288
    s_lshl_b32 s33, s23, 8
    s_mov_b32 s40, 3
    s_xor_b32 s43, s40, s20
    s_and_b32 s43, s43, 1
    s_mul_i32 s36, s40, 85
    s_add_u32 s36, s36, s2
    s_and_b32 s36, s36, 255
    s_mul_hi_u32 s37, s36, 0x55555556
    s_mul_i32 s38, s37, 3
    s_cmp_eq_u32 s38, s36
    s_cselect_b32 s27, 1, 0
    s_cmp_lt_u32 s37, 78
    s_cselect_b32 s27, s27, 0
    s_add_u32 s37, s37, 89
    s_cmp_eq_u32 s21, 0
    s_cselect_b32 s30, s24, s37
    s_cselect_b32 s27, 1, s27
    s_cmp_eq_u32 s43, 0
    s_cbranch_scc0 K12_PL1
    s_lshl_b32 s36, s40, 7
    s_add_u32 s36, s36, s22
    s_lshr_b32 s37, s36, 9
    s_lshl_b32 s37, s37, 19
    s_and_b32 s36, s36, 511
    s_lshl_b32 s36, s36, 10
    s_add_u32 s36, s36, s37
    s_add_u32 s36, s36, s33
    buffer_load_dwordx4 v[96:99], v250, s[8:11], s36 offen
    s_add_u32 s36, s36, 0x100000
    buffer_load_dwordx4 v[100:103], v250, s[8:11], s36 offen
    s_add_u32 s36, s36, 0x100000
    buffer_load_dwordx4 v[104:107], v250, s[8:11], s36 offen
    s_add_u32 s36, s36, 0x100000
    buffer_load_dwordx4 v[108:111], v250, s[8:11], s36 offen
    s_add_u32 s36, s36, 0x100000
    buffer_load_dwordx4 v[112:115], v250, s[8:11], s36 offen
    s_add_u32 s36, s36, 0x100000
    buffer_load_dwordx4 v[116:119], v250, s[8:11], s36 offen
    s_add_u32 s36, s36, 0x100000
    buffer_load_dwordx4 v[120:123], v250, s[8:11], s36 offen
    s_add_u32 s36, s36, 0x100000
    buffer_load_dwordx4 v[124:127], v250, s[8:11], s36 offen
    s_branch K12_PL2
K12_PL1:
    s_cmp_eq_u32 s27, 0
    s_cbranch_scc1 K12_PL2
    s_lshl_b32 s36, s40, 8
    s_mul_i32 s37, s30, 98304
    s_add_u32 s36, s36, s37
    buffer_load_dwordx4 v[0:3], v248, s[4:7], s36 offen
    buffer_load_dwordx4 v[4:7], v248, s[4:7], s36 offen offset:2048
    s_add_u32 s36, s36, 4096
    buffer_load_dwordx4 v[8:11], v248, s[4:7], s36 offen
    buffer_load_dwordx4 v[12:15], v248, s[4:7], s36 offen offset:2048
    s_add_u32 s36, s36, 4096
    buffer_load_dwordx4 v[16:19], v248, s[4:7], s36 offen
    buffer_load_dwordx4 v[20:23], v248, s[4:7], s36 offen offset:2048
    s_add_u32 s36, s36, 4096
    buffer_load_dwordx4 v[24:27], v248, s[4:7], s36 offen
    buffer_load_dwordx4 v[28:31], v248, s[4:7], s36 offen offset:2048
    s_add_u32 s36, s36, 53248
    buffer_load_dwordx4 v[32:35], v248, s[4:7], s36 offen
    buffer_load_dwordx4 v[36:39], v248, s[4:7], s36 offen offset:2048
    s_add_u32 s36, s36, 4096
    buffer_load_dwordx4 v[40:43], v248, s[4:7], s36 offen
    buffer_load_dwordx4 v[44:47], v248, s[4:7], s36 offen offset:2048
    s_add_u32 s36, s36, 4096
    buffer_load_dwordx4 v[48:51], v248, s[4:7], s36 offen
    buffer_load_dwordx4 v[52:55], v248, s[4:7], s36 offen offset:2048
    s_add_u32 s36, s36, 4096
    buffer_load_dwordx4 v[56:59], v248, s[4:7], s36 offen
    buffer_load_dwordx4 v[60:63], v248, s[4:7], s36 offen offset:2048
K12_PL2:
    v_and_b32 v128, 3, v64
    v_lshlrev_b32 v128, 2, v128
    v_lshrrev_b32 v130, 3, v64
    v_lshl_add_u32 v128, v130, 1, v128
    s_lshl_b32 s36, s44, 4
    s_add_u32 s36, s36, 1
    v_add_u32 v128, s36, v128
    v_bfe_u32 v129, v64, 2, 1
    v_lshlrev_b32 v131, 3, v65
    v_lshlrev_b32 v132, 5, v129
    v_mad_u32_u24 v133, v128, v131, v132
    v_mad_u32_u24 v136, v128, 0, v133
    v_mad_u32_u24 v137, v128, 1, v133
    v_mad_u32_u24 v138, v128, 2, v133
    v_mad_u32_u24 v139, v128, 3, v133
    v_mad_u32_u24 v140, v128, 4, v133
    v_mad_u32_u24 v141, v128, 5, v133
    v_mad_u32_u24 v142, v128, 6, v133
    v_mad_u32_u24 v143, v128, 7, v133
    v_and_b32 v136, 127, v136
    v_and_b32 v137, 127, v137
    v_and_b32 v138, 127, v138
    v_and_b32 v139, 127, v139
    v_and_b32 v140, 127, v140
    v_and_b32 v141, 127, v141
    v_and_b32 v142, 127, v142
    v_and_b32 v143, 127, v143
    v_cvt_f32_u32 v136, v136
    v_cvt_f32_u32 v137, v137
    v_cvt_f32_u32 v138, v138
    v_cvt_f32_u32 v139, v139
    v_cvt_f32_u32 v140, v140
    v_cvt_f32_u32 v141, v141
    v_cvt_f32_u32 v142, v142
    v_cvt_f32_u32 v143, v143
    v_mul_f32 v136, 0x3c000000, v136
    v_mul_f32 v137, 0x3c000000, v137
    v_mul_f32 v138, 0x3c000000, v138
    v_mul_f32 v139, 0x3c000000, v139
    v_mul_f32 v140, 0x3c000000, v140
    v_mul_f32 v141, 0x3c000000, v141
    v_mul_f32 v142, 0x3c000000, v142
    v_mul_f32 v143, 0x3c000000, v143
    v_cos_f32 v136, v136
    v_cos_f32 v137, v137
    v_cos_f32 v138, v138
    v_cos_f32 v139, v139
    v_cos_f32 v140, v140
    v_cos_f32 v141, v141
    v_cos_f32 v142, v142
    v_cos_f32 v143, v143
    s_nop 0
    v_cvt_pk_bf16_f32 v144, v136, v137
    v_cvt_pk_bf16_f32 v145, v138, v139
    v_cvt_pk_bf16_f32 v146, v140, v141
    v_cvt_pk_bf16_f32 v147, v142, v143
    v_lshlrev_b32 v152, 16, v144
    v_and_b32 v153, 0xffff0000, v144
    v_sub_f32 v136, v136, v152
    v_sub_f32 v137, v137, v153
    v_lshlrev_b32 v152, 16, v145
    v_and_b32 v153, 0xffff0000, v145
    v_sub_f32 v138, v138, v152
    v_sub_f32 v139, v139, v153
    v_lshlrev_b32 v152, 16, v146
    v_and_b32 v153, 0xffff0000, v146
    v_sub_f32 v140, v140, v152
    v_sub_f32 v141, v141, v153
    v_lshlrev_b32 v152, 16, v147
    v_and_b32 v153, 0xffff0000, v147
    v_sub_f32 v142, v142, v152
    v_sub_f32 v143, v143, v153
    v_cvt_pk_bf16_f32 v148, v136, v137
    v_cvt_pk_bf16_f32 v149, v138, v139
    v_cvt_pk_bf16_f32 v150, v140, v141
    v_cvt_pk_bf16_f32 v151, v142, v143
    s_lshl_b32 s37, s44, 12
    s_add_u32 s37, s37, 116736
    v_add_u32 v132, s37, v254
    ds_write_b128 v132, v[144:147]
    ds_write_b128 v132, v[148:151] offset:1024
    v_add_u32 v131, 32, v131
    v_lshlrev_b32 v132, 5, v129
    v_mad_u32_u24 v133, v128, v131, v132
    v_mad_u32_u24 v136, v128, 0, v133
    v_mad_u32_u24 v137, v128, 1, v133
    v_mad_u32_u24 v138, v128, 2, v133
    v_mad_u32_u24 v139, v128, 3, v133
    v_mad_u32_u24 v140, v128, 4, v133
    v_mad_u32_u24 v141, v128, 5, v133
    v_mad_u32_u24 v142, v128, 6, v133
    v_mad_u32_u24 v143, v128, 7, v133
    v_and_b32 v136, 127, v136
    v_and_b32 v137, 127, v137
    v_and_b32 v138, 127, v138
    v_and_b32 v139, 127, v139
    v_and_b32 v140, 127, v140
    v_and_b32 v141, 127, v141
    v_and_b32 v142, 127, v142
    v_and_b32 v143, 127, v143
    v_cvt_f32_u32 v136, v136
    v_cvt_f32_u32 v137, v137
    v_cvt_f32_u32 v138, v138
    v_cvt_f32_u32 v139, v139
    v_cvt_f32_u32 v140, v140
    v_cvt_f32_u32 v141, v141
    v_cvt_f32_u32 v142, v142
    v_cvt_f32_u32 v143, v143
    v_mul_f32 v136, 0x3c000000, v136
    v_mul_f32 v137, 0x3c000000, v137
    v_mul_f32 v138, 0x3c000000, v138
    v_mul_f32 v139, 0x3c000000, v139
    v_mul_f32 v140, 0x3c000000, v140
    v_mul_f32 v141, 0x3c000000, v141
    v_mul_f32 v142, 0x3c000000, v142
    v_mul_f32 v143, 0x3c000000, v143
    v_cos_f32 v136, v136
    v_cos_f32 v137, v137
    v_cos_f32 v138, v138
    v_cos_f32 v139, v139
    v_cos_f32 v140, v140
    v_cos_f32 v141, v141
    v_cos_f32 v142, v142
    v_cos_f32 v143, v143
    s_nop 0
    v_cvt_pk_bf16_f32 v144, v136, v137
    v_cvt_pk_bf16_f32 v145, v138, v139
    v_cvt_pk_bf16_f32 v146, v140, v141
    v_cvt_pk_bf16_f32 v147, v142, v143
    v_lshlrev_b32 v152, 16, v144
    v_and_b32 v153, 0xffff0000, v144
    v_sub_f32 v136, v136, v152
    v_sub_f32 v137, v137, v153
    v_lshlrev_b32 v152, 16, v145
    v_and_b32 v153, 0xffff0000, v145
    v_sub_f32 v138, v138, v152
    v_sub_f32 v139, v139, v153
    v_lshlrev_b32 v152, 16, v146
    v_and_b32 v153, 0xffff0000, v146
    v_sub_f32 v140, v140, v152
    v_sub_f32 v141, v141, v153
    v_lshlrev_b32 v152, 16, v147
    v_and_b32 v153, 0xffff0000, v147
    v_sub_f32 v142, v142, v152
    v_sub_f32 v143, v143, v153
    v_cvt_pk_bf16_f32 v148, v136, v137
    v_cvt_pk_bf16_f32 v149, v138, v139
    v_cvt_pk_bf16_f32 v150, v140, v141
    v_cvt_pk_bf16_f32 v151, v142, v143
    s_lshl_b32 s37, s44, 12
    s_add_u32 s37, s37, 118784
    v_add_u32 v132, s37, v254
    ds_write_b128 v132, v[144:147]
    ds_write_b128 v132, v[148:151] offset:1024
K12_TB:
    s_waitcnt lgkmcnt(0)
    s_barrier
    v_add_u32 v255, 116736, v254
    ds_read_b128 v[160:163], v255 offset:0
    ds_read_b128 v[192:195], v255 offset:1024
    ds_read_b128 v[164:167], v255 offset:2048
    ds_read_b128 v[196:199], v255 offset:3072
    ds_read_b128 v[168:171], v255 offset:4096
    ds_read_b128 v[200:203], v255 offset:5120
    ds_read_b128 v[172:175], v255 offset:6144
    ds_read_b128 v[204:207], v255 offset:7168
    s_waitcnt lgkmcnt(0)
    ds_read_b128 v[176:179], v255 offset:8192
    ds_read_b128 v[208:211], v255 offset:9216
    ds_read_b128 v[180:183], v255 offset:10240
    ds_read_b128 v[212:215], v255 offset:11264
    ds_read_b128 v[184:187], v255 offset:12288
    ds_read_b128 v[216:219], v255 offset:13312
    ds_read_b128 v[188:191], v255 offset:14336
    ds_read_b128 v[220:223], v255 offset:15360
    ds_read_b128 v[224:227], v255 offset:16384
    ds_read_b128 v[228:231], v255 offset:17408
    ds_read_b128 v[232:235], v255 offset:18432
    ds_read_b128 v[236:239], v255 offset:19456
    s_waitcnt lgkmcnt(0)
    s_barrier
    s_waitcnt vmcnt(0) lgkmcnt(0)
    s_mov_b32 s41, -1
    s_mov_b32 s34, -1
K12_PROD:
    s_mov_b32 s37, 131072
K12_TW:
    v_mov_b32 v240, 155648
    ds_read_b32 v240, v240
    s_waitcnt lgkmcnt(0)
    v_cmp_gt_u32 vcc, 2, v240
    s_sub_u32 s37, s37, 1
    s_cmp_eq_u32 s37, 0
    s_cbranch_scc1 K12_TX
    s_cbranch_vccz K12_TX
    s_sleep 2
    s_branch K12_TW
K12_TX:
    v_lshrrev_b32 v128, 4, v254
    v_lshlrev_b32 v129, 11, v128
    v_lshrrev_b32 v130, 1, v128
    v_lshlrev_b32 v130, 20, v130
    v_and_b32 v131, 1, v128
    v_lshl_add_u32 v130, v131, 7, v130
    s_mov_b32 s45, s27
    s_mov_b32 s46, s30
    s_add_u32 s47, s40, 1
K12_TCH0:
    s_xor_b32 s48, s47, s20
    s_and_b32 s48, s48, 1
    s_cmp_eq_u32 s48, 0
    s_cbranch_scc1 K12_TCHW0
    s_mul_i32 s36, s47, 85
    s_add_u32 s36, s36, s2
    s_and_b32 s36, s36, 255
    s_mul_hi_u32 s37, s36, 0x55555556
    s_mul_i32 s38, s37, 3
    s_cmp_eq_u32 s38, s36
    s_cselect_b32 s27, 1, 0
    s_cmp_lt_u32 s37, 78
    s_cselect_b32 s27, s27, 0
    s_add_u32 s37, s37, 89
    s_cmp_eq_u32 s21, 0
    s_cselect_b32 s30, s24, s37
    s_cselect_b32 s27, 1, s27
    s_cmp_eq_u32 s27, 0
    s_cbranch_scc1 K12_TCHN0
    s_lshl_b32 s36, s47, 8
    s_mul_i32 s37, s30, 98304
    s_add_u32 s36, s36, s37
    buffer_load_dword v244, v129, s[4:7], s36 offen
    buffer_load_dword v245, v129, s[4:7], s36 offen offset:128
    s_branch K12_TCHN0
K12_TCHW0:
    s_lshl_b32 s36, s47, 7
    s_add_u32 s36, s36, s22
    s_lshr_b32 s37, s36, 9
    s_lshl_b32 s37, s37, 19
    s_and_b32 s36, s36, 511
    s_lshl_b32 s36, s36, 10
    s_add_u32 s36, s36, s37
    s_add_u32 s36, s36, s33
    s_mov_b64 exec, 0xffffffff
    buffer_load_dword v246, v130, s[8:11], s36 offen
    s_mov_b64 exec, -1
K12_TCHN0:
    s_add_u32 s47, s47, 1
    s_cmp_lt_u32 s47, 8
    s_cbranch_scc1 K12_TCH0
    s_mov_b32 s27, s45
    s_mov_b32 s30, s46
    s_cmp_eq_u32 s43, 0
    s_cbranch_scc1 K12_WENTRY
K12_XW:
    s_waitcnt vmcnt(0)
    s_mov_b32 s34, -1
    s_cmp_ge_u32 s41, 8
    s_cbranch_scc1 K12_SG0
    s_lshl_b32 s36, s41, 2
    s_add_u32 s37, s36, 155680
    s_mov_b64 exec, 1
    v_mov_b32 v255, s37
    v_mov_b32 v240, 1
    ds_add_rtn_u32 v240, v255, v240
    s_waitcnt lgkmcnt(0)
    v_readfirstlane_b32 s37, v240
    s_nop 3
    s_cmp_eq_u32 s37, 3
    s_cbranch_scc0 K12_SH0
    s_lshl_b32 s36, s36, 8
    v_mov_b32 v255, 1
    v_mov_b32 v240, s36
    buffer_atomic_add v255, v240, s[60:63], 0 offen sc0 sc1
    s_mov_b32 s34, s41
K12_SH0:
    s_mov_b64 exec, -1
K12_SG0:
    s_cmp_ge_u32 s34, 8
    s_cbranch_scc1 K12_EP1
    s_waitcnt vmcnt(0)
    s_cmp_ge_u32 s34, 8
    s_cbranch_scc1 K12_PB2
    v_readfirstlane_b32 s37, v255
    s_nop 3
    s_cmp_eq_u32 s37, 255
    s_cbranch_scc0 K12_PB2
    s_lshl_b32 s36, s34, 4
    s_add_u32 s36, s36, 16384
    s_mov_b64 exec, 1
    v_mov_b32 v255, 1
    v_mov_b32 v240, s36
    buffer_store_dword v255, v240, s[60:63], 0 offen sc1
    s_mov_b64 exec, -1
K12_PB2:
    s_mov_b32 s34, -1
K12_EP1:
    s_cmp_eq_u32 s27, 0
    s_cbranch_scc1 K12_XP_N
    v_perm_b32 v64, v4, v0, s28
    v_perm_b32 v68, v4, v0, s29
    v_perm_b32 v65, v12, v8, s28
    v_perm_b32 v69, v12, v8, s29
    v_perm_b32 v66, v20, v16, s28
    v_perm_b32 v70, v20, v16, s29
    v_perm_b32 v67, v28, v24, s28
    v_perm_b32 v71, v28, v24, s29
    v_perm_b32 v72, v5, v1, s28
    v_perm_b32 v76, v5, v1, s29
    v_perm_b32 v73, v13, v9, s28
    v_perm_b32 v77, v13, v9, s29
    v_perm_b32 v74, v21, v17, s28
    v_perm_b32 v78, v21, v17, s29
    v_perm_b32 v75, v29, v25, s28
    v_perm_b32 v79, v29, v25, s29
    v_perm_b32 v80, v6, v2, s28
    v_perm_b32 v84, v6, v2, s29
    v_perm_b32 v81, v14, v10, s28
    v_perm_b32 v85, v14, v10, s29
    v_perm_b32 v82, v22, v18, s28
    v_perm_b32 v86, v22, v18, s29
    v_perm_b32 v83, v30, v26, s28
    v_perm_b32 v87, v30, v26, s29
    v_perm_b32 v88, v7, v3, s28
    v_perm_b32 v92, v7, v3, s29
    v_perm_b32 v89, v15, v11, s28
    v_perm_b32 v93, v15, v11, s29
    v_perm_b32 v90, v23, v19, s28
    v_perm_b32 v94, v23, v19, s29
    v_perm_b32 v91, v31, v27, s28
    v_perm_b32 v95, v31, v27, s29
    v_perm_b32 v0, v36, v32, s28
    v_perm_b32 v4, v36, v32, s29
    v_perm_b32 v1, v44, v40, s28
    v_perm_b32 v5, v44, v40, s29
    v_perm_b32 v2, v52, v48, s28
    v_perm_b32 v6, v52, v48, s29
    v_perm_b32 v3, v60, v56, s28
    v_perm_b32 v7, v60, v56, s29
    v_perm_b32 v8, v37, v33, s28
    v_perm_b32 v12, v37, v33, s29
    v_perm_b32 v9, v45, v41, s28
    v_perm_b32 v13, v45, v41, s29
    v_perm_b32 v10, v53, v49, s28
    v_perm_b32 v14, v53, v49, s29
    v_perm_b32 v11, v61, v57, s28
    v_perm_b32 v15, v61, v57, s29
    v_perm_b32 v16, v38, v34, s28
    v_perm_b32 v20, v38, v34, s29
    v_perm_b32 v17, v46, v42, s28
    v_perm_b32 v21, v46, v42, s29
    v_perm_b32 v18, v54, v50, s28
    v_perm_b32 v22, v54, v50, s29
    v_perm_b32 v19, v62, v58, s28
    v_perm_b32 v23, v62, v58, s29
    v_perm_b32 v24, v39, v35, s28
    v_perm_b32 v28, v39, v35, s29
    v_perm_b32 v25, v47, v43, s28
    v_perm_b32 v29, v47, v43, s29
    v_perm_b32 v26, v55, v51, s28
    v_perm_b32 v30, v55, v51, s29
    v_perm_b32 v27, v63, v59, s28
    v_perm_b32 v31, v63, v59, s29
K12_XP_N:
    s_lshl_b32 s36, s40, 3
    s_sub_i32 s36, s36, 24
    s_max_i32 s36, s36, 1
    s_mov_b32 s37, 131072
K12_GL0:
    v_mov_b32 v240, 155648
    ds_read_b32 v240, v240
    s_waitcnt lgkmcnt(0)
    v_cmp_gt_u32 vcc, s36, v240
    s_sub_u32 s37, s37, 1
    s_cmp_eq_u32 s37, 0
    s_cbranch_scc1 K12_GT0
    s_cbranch_vccz K12_GT0
    s_sleep 2
    s_branch K12_GL0
K12_GT0:
    s_lshl_b32 s36, s40, 2
    s_add_u32 s36, s36, 155840
    s_mov_b64 exec, 1
    v_mov_b32 v240, s36
    v_mov_b32 v241, 1
    ds_add_u32 v240, v241
    s_mov_b64 exec, -1
    s_mov_b32 s37, 131072
K12_BL0:
    v_mov_b32 v240, s36
    ds_read_b32 v240, v240
    s_waitcnt lgkmcnt(0)
    v_cmp_gt_u32 vcc, 4, v240
    s_sub_u32 s37, s37, 1
    s_cmp_eq_u32 s37, 0
    s_cbranch_scc1 K12_BT0
    s_cbranch_vccz K12_BT0
    s_sleep 1
    s_branch K12_BL0
K12_BT0:
    s_add_u32 s42, s40, 1
    s_lshl_b32 s36, s42, 7
    s_add_u32 s36, s36, s22
    s_lshr_b32 s37, s36, 9
    s_lshl_b32 s37, s37, 19
    s_and_b32 s36, s36, 511
    s_lshl_b32 s36, s36, 10
    s_add_u32 s36, s36, s37
    s_add_u32 s36, s36, s33
    buffer_load_dwordx4 v[96:99], v250, s[8:11], s36 offen
    s_add_u32 s36, s36, 0x100000
    buffer_load_dwordx4 v[100:103], v250, s[8:11], s36 offen
    s_add_u32 s36, s36, 0x100000
    buffer_load_dwordx4 v[104:107], v250, s[8:11], s36 offen
    s_add_u32 s36, s36, 0x100000
    buffer_load_dwordx4 v[108:111], v250, s[8:11], s36 offen
    s_add_u32 s36, s36, 0x100000
    buffer_load_dwordx4 v[112:115], v250, s[8:11], s36 offen
    s_add_u32 s36, s36, 0x100000
    buffer_load_dwordx4 v[116:119], v250, s[8:11], s36 offen
    s_add_u32 s36, s36, 0x100000
    buffer_load_dwordx4 v[120:123], v250, s[8:11], s36 offen
    s_add_u32 s36, s36, 0x100000
    buffer_load_dwordx4 v[124:127], v250, s[8:11], s36 offen
    s_cmp_eq_u32 s27, 0
    s_cbranch_scc1 K12_XP_E
    s_mul_i32 s39, s40, 85504
    s_add_u32 s39, s39, s31
    s_lshl_b32 s36, s30, 7
    s_add_u32 s39, s39, s36
    v_bfe_u32 v249, v254, 4, 2
    v_bfe_u32 v240, v254, 8, 1
    v_lshl_add_u32 v249, v240, 2, v249
    s_add_u32 s36, s30, 7
    s_cmp_ge_u32 s30, 160
    s_cselect_b32 s36, s36, s30
    s_cmp_eq_u32 s25, 1
    s_cselect_b32 s36, s36, s30
    s_lshr_b32 s36, s36, 1
    s_and_b32 s36, s36, 7
    v_xor_b32 v249, s36, v249
    v_lshl_add_u32 v249, v249, 4, v252
    s_setprio 1
    v_mfma_f32_16x16x32_bf16 v[32:35], v[160:163], v[64:67], 0
    v_mfma_f32_16x16x32_bf16 v[36:39], v[160:163], v[68:71], 0
    v_mfma_f32_16x16x32_bf16 v[40:43], v[160:163], v[72:75], 0
    v_mfma_f32_16x16x32_bf16 v[44:47], v[160:163], v[76:79], 0
    v_mfma_f32_16x16x32_bf16 v[48:51], v[160:163], v[80:83], 0
    v_mfma_f32_16x16x32_bf16 v[52:55], v[160:163], v[84:87], 0
    v_mfma_f32_16x16x32_bf16 v[56:59], v[160:163], v[88:91], 0
    v_mfma_f32_16x16x32_bf16 v[60:63], v[160:163], v[92:95], 0
    v_mfma_f32_16x16x32_bf16 v[32:35], v[192:195], v[64:67], v[32:35]
    v_mfma_f32_16x16x32_bf16 v[36:39], v[192:195], v[68:71], v[36:39]
    v_mfma_f32_16x16x32_bf16 v[40:43], v[192:195], v[72:75], v[40:43]
    v_mfma_f32_16x16x32_bf16 v[44:47], v[192:195], v[76:79], v[44:47]
    v_mfma_f32_16x16x32_bf16 v[48:51], v[192:195], v[80:83], v[48:51]
    v_mfma_f32_16x16x32_bf16 v[52:55], v[192:195], v[84:87], v[52:55]
    v_mfma_f32_16x16x32_bf16 v[56:59], v[192:195], v[88:91], v[56:59]
    v_mfma_f32_16x16x32_bf16 v[60:63], v[192:195], v[92:95], v[60:63]
    v_mfma_f32_16x16x32_bf16 v[32:35], v[164:167], v[0:3], v[32:35]
    v_mfma_f32_16x16x32_bf16 v[36:39], v[164:167], v[4:7], v[36:39]
    v_mfma_f32_16x16x32_bf16 v[40:43], v[164:167], v[8:11], v[40:43]
    v_mfma_f32_16x16x32_bf16 v[44:47], v[164:167], v[12:15], v[44:47]
    v_mfma_f32_16x16x32_bf16 v[48:51], v[164:167], v[16:19], v[48:51]
    v_mfma_f32_16x16x32_bf16 v[52:55], v[164:167], v[20:23], v[52:55]
    v_mfma_f32_16x16x32_bf16 v[56:59], v[164:167], v[24:27], v[56:59]
    v_mfma_f32_16x16x32_bf16 v[60:63], v[164:167], v[28:31], v[60:63]
    v_mfma_f32_16x16x32_bf16 v[32:35], v[196:199], v[0:3], v[32:35]
    v_mfma_f32_16x16x32_bf16 v[36:39], v[196:199], v[4:7], v[36:39]
    v_mfma_f32_16x16x32_bf16 v[40:43], v[196:199], v[8:11], v[40:43]
    v_mfma_f32_16x16x32_bf16 v[44:47], v[196:199], v[12:15], v[44:47]
    v_mfma_f32_16x16x32_bf16 v[48:51], v[196:199], v[16:19], v[48:51]
    v_mfma_f32_16x16x32_bf16 v[52:55], v[196:199], v[20:23], v[52:55]
    v_mfma_f32_16x16x32_bf16 v[56:59], v[196:199], v[24:27], v[56:59]
    v_mfma_f32_16x16x32_bf16 v[60:63], v[196:199], v[28:31], v[60:63]
    s_setprio 0
    s_nop 7
    v_cvt_pk_bf16_f32 v240, v32, v36
    v_cvt_pk_bf16_f32 v241, v40, v44
    v_cvt_pk_bf16_f32 v242, v48, v52
    v_cvt_pk_bf16_f32 v243, v56, v60
    buffer_store_dwordx4 v[240:243], v249, s[12:15], s39 offen sc1
    s_add_u32 s39, s39, 2736128
    v_cvt_pk_bf16_f32 v244, v33, v37
    v_cvt_pk_bf16_f32 v245, v41, v45
    v_cvt_pk_bf16_f32 v246, v49, v53
    v_cvt_pk_bf16_f32 v247, v57, v61
    buffer_store_dwordx4 v[244:247], v249, s[12:15], s39 offen sc1
    s_add_u32 s39, s39, 2736128
    v_cvt_pk_bf16_f32 v240, v34, v38
    v_cvt_pk_bf16_f32 v241, v42, v46
    v_cvt_pk_bf16_f32 v242, v50, v54
    v_cvt_pk_bf16_f32 v243, v58, v62
    buffer_store_dwordx4 v[240:243], v249, s[12:15], s39 offen sc1
    s_add_u32 s39, s39, 2736128
    v_cvt_pk_bf16_f32 v244, v35, v39
    v_cvt_pk_bf16_f32 v245, v43, v47
    v_cvt_pk_bf16_f32 v246, v51, v55
    v_cvt_pk_bf16_f32 v247, v59, v63
    buffer_store_dwordx4 v[244:247], v249, s[12:15], s39 offen sc1
    s_add_u32 s39, s39, 2736128
    s_cmp_lt_u32 s40, 4
    s_cbranch_scc1 K12_UT0
    s_lshl_b32 s36, s40, 3
    s_sub_i32 s36, s36, 22
    s_max_i32 s36, s36, 1
    s_mov_b32 s37, 131072
K12_UL0:
    v_mov_b32 v255, 155648
    ds_read_b32 v255, v255
    s_waitcnt lgkmcnt(0)
    v_cmp_gt_u32 vcc, s36, v255
    s_sub_u32 s37, s37, 1
    s_cmp_eq_u32 s37, 0
    s_cbranch_scc1 K12_UT0
    s_cbranch_vccz K12_UT0
    s_sleep 2
    s_branch K12_UL0
K12_UT0:
    s_setprio 1
    v_mfma_f32_16x16x32_bf16 v[32:35], v[168:171], v[64:67], 0
    v_mfma_f32_16x16x32_bf16 v[36:39], v[168:171], v[68:71], 0
    v_mfma_f32_16x16x32_bf16 v[40:43], v[168:171], v[72:75], 0
    v_mfma_f32_16x16x32_bf16 v[44:47], v[168:171], v[76:79], 0
    v_mfma_f32_16x16x32_bf16 v[48:51], v[168:171], v[80:83], 0
    v_mfma_f32_16x16x32_bf16 v[52:55], v[168:171], v[84:87], 0
    v_mfma_f32_16x16x32_bf16 v[56:59], v[168:171], v[88:91], 0
    v_mfma_f32_16x16x32_bf16 v[60:63], v[168:171], v[92:95], 0
    v_mfma_f32_16x16x32_bf16 v[32:35], v[200:203], v[64:67], v[32:35]
    v_mfma_f32_16x16x32_bf16 v[36:39], v[200:203], v[68:71], v[36:39]
    v_mfma_f32_16x16x32_bf16 v[40:43], v[200:203], v[72:75], v[40:43]
    v_mfma_f32_16x16x32_bf16 v[44:47], v[200:203], v[76:79], v[44:47]
    v_mfma_f32_16x16x32_bf16 v[48:51], v[200:203], v[80:83], v[48:51]
    v_mfma_f32_16x16x32_bf16 v[52:55], v[200:203], v[84:87], v[52:55]
    v_mfma_f32_16x16x32_bf16 v[56:59], v[200:203], v[88:91], v[56:59]
    v_mfma_f32_16x16x32_bf16 v[60:63], v[200:203], v[92:95], v[60:63]
    v_mfma_f32_16x16x32_bf16 v[32:35], v[172:175], v[0:3], v[32:35]
    v_mfma_f32_16x16x32_bf16 v[36:39], v[172:175], v[4:7], v[36:39]
    v_mfma_f32_16x16x32_bf16 v[40:43], v[172:175], v[8:11], v[40:43]
    v_mfma_f32_16x16x32_bf16 v[44:47], v[172:175], v[12:15], v[44:47]
    v_mfma_f32_16x16x32_bf16 v[48:51], v[172:175], v[16:19], v[48:51]
    v_mfma_f32_16x16x32_bf16 v[52:55], v[172:175], v[20:23], v[52:55]
    v_mfma_f32_16x16x32_bf16 v[56:59], v[172:175], v[24:27], v[56:59]
    v_mfma_f32_16x16x32_bf16 v[60:63], v[172:175], v[28:31], v[60:63]
    v_mfma_f32_16x16x32_bf16 v[32:35], v[204:207], v[0:3], v[32:35]
    v_mfma_f32_16x16x32_bf16 v[36:39], v[204:207], v[4:7], v[36:39]
    v_mfma_f32_16x16x32_bf16 v[40:43], v[204:207], v[8:11], v[40:43]
    v_mfma_f32_16x16x32_bf16 v[44:47], v[204:207], v[12:15], v[44:47]
    v_mfma_f32_16x16x32_bf16 v[48:51], v[204:207], v[16:19], v[48:51]
    v_mfma_f32_16x16x32_bf16 v[52:55], v[204:207], v[20:23], v[52:55]
    v_mfma_f32_16x16x32_bf16 v[56:59], v[204:207], v[24:27], v[56:59]
    v_mfma_f32_16x16x32_bf16 v[60:63], v[204:207], v[28:31], v[60:63]
    s_setprio 0
    s_nop 7
    v_cvt_pk_bf16_f32 v240, v32, v36
    v_cvt_pk_bf16_f32 v241, v40, v44
    v_cvt_pk_bf16_f32 v242, v48, v52
    v_cvt_pk_bf16_f32 v243, v56, v60
    buffer_store_dwordx4 v[240:243], v249, s[12:15], s39 offen sc1
    s_add_u32 s39, s39, 2736128
    v_cvt_pk_bf16_f32 v244, v33, v37
    v_cvt_pk_bf16_f32 v245, v41, v45
    v_cvt_pk_bf16_f32 v246, v49, v53
    v_cvt_pk_bf16_f32 v247, v57, v61
    buffer_store_dwordx4 v[244:247], v249, s[12:15], s39 offen sc1
    s_add_u32 s39, s39, 2736128
    v_cvt_pk_bf16_f32 v240, v34, v38
    v_cvt_pk_bf16_f32 v241, v42, v46
    v_cvt_pk_bf16_f32 v242, v50, v54
    v_cvt_pk_bf16_f32 v243, v58, v62
    buffer_store_dwordx4 v[240:243], v249, s[12:15], s39 offen sc1
    s_add_u32 s39, s39, 2736128
    v_cvt_pk_bf16_f32 v244, v35, v39
    v_cvt_pk_bf16_f32 v245, v43, v47
    v_cvt_pk_bf16_f32 v246, v51, v55
    v_cvt_pk_bf16_f32 v247, v59, v63
    buffer_store_dwordx4 v[244:247], v249, s[12:15], s39 offen sc1
    s_add_u32 s39, s39, 2736128
    s_cmp_lt_u32 s40, 4
    s_cbranch_scc1 K12_UT1
    s_lshl_b32 s36, s40, 3
    s_sub_i32 s36, s36, 20
    s_max_i32 s36, s36, 1
    s_mov_b32 s37, 131072
K12_UL1:
    v_mov_b32 v255, 155648
    ds_read_b32 v255, v255
    s_waitcnt lgkmcnt(0)
    v_cmp_gt_u32 vcc, s36, v255
    s_sub_u32 s37, s37, 1
    s_cmp_eq_u32 s37, 0
    s_cbranch_scc1 K12_UT1
    s_cbranch_vccz K12_UT1
    s_sleep 2
    s_branch K12_UL1
K12_UT1:
    s_setprio 1
    v_mfma_f32_16x16x32_bf16 v[32:35], v[176:179], v[64:67], 0
    v_mfma_f32_16x16x32_bf16 v[36:39], v[176:179], v[68:71], 0
    v_mfma_f32_16x16x32_bf16 v[40:43], v[176:179], v[72:75], 0
    v_mfma_f32_16x16x32_bf16 v[44:47], v[176:179], v[76:79], 0
    v_mfma_f32_16x16x32_bf16 v[48:51], v[176:179], v[80:83], 0
    v_mfma_f32_16x16x32_bf16 v[52:55], v[176:179], v[84:87], 0
    v_mfma_f32_16x16x32_bf16 v[56:59], v[176:179], v[88:91], 0
    v_mfma_f32_16x16x32_bf16 v[60:63], v[176:179], v[92:95], 0
    v_mfma_f32_16x16x32_bf16 v[32:35], v[208:211], v[64:67], v[32:35]
    v_mfma_f32_16x16x32_bf16 v[36:39], v[208:211], v[68:71], v[36:39]
    v_mfma_f32_16x16x32_bf16 v[40:43], v[208:211], v[72:75], v[40:43]
    v_mfma_f32_16x16x32_bf16 v[44:47], v[208:211], v[76:79], v[44:47]
    v_mfma_f32_16x16x32_bf16 v[48:51], v[208:211], v[80:83], v[48:51]
    v_mfma_f32_16x16x32_bf16 v[52:55], v[208:211], v[84:87], v[52:55]
    v_mfma_f32_16x16x32_bf16 v[56:59], v[208:211], v[88:91], v[56:59]
    v_mfma_f32_16x16x32_bf16 v[60:63], v[208:211], v[92:95], v[60:63]
    v_mfma_f32_16x16x32_bf16 v[32:35], v[180:183], v[0:3], v[32:35]
    v_mfma_f32_16x16x32_bf16 v[36:39], v[180:183], v[4:7], v[36:39]
    v_mfma_f32_16x16x32_bf16 v[40:43], v[180:183], v[8:11], v[40:43]
    v_mfma_f32_16x16x32_bf16 v[44:47], v[180:183], v[12:15], v[44:47]
    v_mfma_f32_16x16x32_bf16 v[48:51], v[180:183], v[16:19], v[48:51]
    v_mfma_f32_16x16x32_bf16 v[52:55], v[180:183], v[20:23], v[52:55]
    v_mfma_f32_16x16x32_bf16 v[56:59], v[180:183], v[24:27], v[56:59]
    v_mfma_f32_16x16x32_bf16 v[60:63], v[180:183], v[28:31], v[60:63]
    v_mfma_f32_16x16x32_bf16 v[32:35], v[212:215], v[0:3], v[32:35]
    v_mfma_f32_16x16x32_bf16 v[36:39], v[212:215], v[4:7], v[36:39]
    v_mfma_f32_16x16x32_bf16 v[40:43], v[212:215], v[8:11], v[40:43]
    v_mfma_f32_16x16x32_bf16 v[44:47], v[212:215], v[12:15], v[44:47]
    v_mfma_f32_16x16x32_bf16 v[48:51], v[212:215], v[16:19], v[48:51]
    v_mfma_f32_16x16x32_bf16 v[52:55], v[212:215], v[20:23], v[52:55]
    v_mfma_f32_16x16x32_bf16 v[56:59], v[212:215], v[24:27], v[56:59]
    v_mfma_f32_16x16x32_bf16 v[60:63], v[212:215], v[28:31], v[60:63]
    s_setprio 0
    s_nop 7
    v_cvt_pk_bf16_f32 v240, v32, v36
    v_cvt_pk_bf16_f32 v241, v40, v44
    v_cvt_pk_bf16_f32 v242, v48, v52
    v_cvt_pk_bf16_f32 v243, v56, v60
    buffer_store_dwordx4 v[240:243], v249, s[12:15], s39 offen sc1
    s_add_u32 s39, s39, 2736128
    v_cvt_pk_bf16_f32 v244, v33, v37
    v_cvt_pk_bf16_f32 v245, v41, v45
    v_cvt_pk_bf16_f32 v246, v49, v53
    v_cvt_pk_bf16_f32 v247, v57, v61
    buffer_store_dwordx4 v[244:247], v249, s[12:15], s39 offen sc1
    s_add_u32 s39, s39, 2736128
    v_cvt_pk_bf16_f32 v240, v34, v38
    v_cvt_pk_bf16_f32 v241, v42, v46
    v_cvt_pk_bf16_f32 v242, v50, v54
    v_cvt_pk_bf16_f32 v243, v58, v62
    buffer_store_dwordx4 v[240:243], v249, s[12:15], s39 offen sc1
    s_add_u32 s39, s39, 2736128
    v_cvt_pk_bf16_f32 v244, v35, v39
    v_cvt_pk_bf16_f32 v245, v43, v47
    v_cvt_pk_bf16_f32 v246, v51, v55
    v_cvt_pk_bf16_f32 v247, v59, v63
    buffer_store_dwordx4 v[244:247], v249, s[12:15], s39 offen sc1
    s_add_u32 s39, s39, 2736128
    s_cmp_lt_u32 s40, 4
    s_cbranch_scc1 K12_UT2
    s_lshl_b32 s36, s40, 3
    s_sub_i32 s36, s36, 18
    s_max_i32 s36, s36, 1
    s_mov_b32 s37, 131072
K12_UL2:
    v_mov_b32 v255, 155648
    ds_read_b32 v255, v255
    s_waitcnt lgkmcnt(0)
    v_cmp_gt_u32 vcc, s36, v255
    s_sub_u32 s37, s37, 1
    s_cmp_eq_u32 s37, 0
    s_cbranch_scc1 K12_UT2
    s_cbranch_vccz K12_UT2
    s_sleep 2
    s_branch K12_UL2
K12_UT2:
    s_setprio 1
    v_mfma_f32_16x16x32_bf16 v[32:35], v[184:187], v[64:67], 0
    v_mfma_f32_16x16x32_bf16 v[36:39], v[184:187], v[68:71], 0
    v_mfma_f32_16x16x32_bf16 v[40:43], v[184:187], v[72:75], 0
    v_mfma_f32_16x16x32_bf16 v[44:47], v[184:187], v[76:79], 0
    v_mfma_f32_16x16x32_bf16 v[48:51], v[184:187], v[80:83], 0
    v_mfma_f32_16x16x32_bf16 v[52:55], v[184:187], v[84:87], 0
    v_mfma_f32_16x16x32_bf16 v[56:59], v[184:187], v[88:91], 0
    v_mfma_f32_16x16x32_bf16 v[60:63], v[184:187], v[92:95], 0
    v_mfma_f32_16x16x32_bf16 v[32:35], v[216:219], v[64:67], v[32:35]
    v_mfma_f32_16x16x32_bf16 v[36:39], v[216:219], v[68:71], v[36:39]
    v_mfma_f32_16x16x32_bf16 v[40:43], v[216:219], v[72:75], v[40:43]
    v_mfma_f32_16x16x32_bf16 v[44:47], v[216:219], v[76:79], v[44:47]
    v_mfma_f32_16x16x32_bf16 v[48:51], v[216:219], v[80:83], v[48:51]
    v_mfma_f32_16x16x32_bf16 v[52:55], v[216:219], v[84:87], v[52:55]
    v_mfma_f32_16x16x32_bf16 v[56:59], v[216:219], v[88:91], v[56:59]
    v_mfma_f32_16x16x32_bf16 v[60:63], v[216:219], v[92:95], v[60:63]
    v_mfma_f32_16x16x32_bf16 v[32:35], v[188:191], v[0:3], v[32:35]
    v_mfma_f32_16x16x32_bf16 v[36:39], v[188:191], v[4:7], v[36:39]
    v_mfma_f32_16x16x32_bf16 v[40:43], v[188:191], v[8:11], v[40:43]
    v_mfma_f32_16x16x32_bf16 v[44:47], v[188:191], v[12:15], v[44:47]
    v_mfma_f32_16x16x32_bf16 v[48:51], v[188:191], v[16:19], v[48:51]
    v_mfma_f32_16x16x32_bf16 v[52:55], v[188:191], v[20:23], v[52:55]
    v_mfma_f32_16x16x32_bf16 v[56:59], v[188:191], v[24:27], v[56:59]
    v_mfma_f32_16x16x32_bf16 v[60:63], v[188:191], v[28:31], v[60:63]
    v_mfma_f32_16x16x32_bf16 v[32:35], v[220:223], v[0:3], v[32:35]
    v_mfma_f32_16x16x32_bf16 v[36:39], v[220:223], v[4:7], v[36:39]
    v_mfma_f32_16x16x32_bf16 v[40:43], v[220:223], v[8:11], v[40:43]
    v_mfma_f32_16x16x32_bf16 v[44:47], v[220:223], v[12:15], v[44:47]
    v_mfma_f32_16x16x32_bf16 v[48:51], v[220:223], v[16:19], v[48:51]
    v_mfma_f32_16x16x32_bf16 v[52:55], v[220:223], v[20:23], v[52:55]
    v_mfma_f32_16x16x32_bf16 v[56:59], v[220:223], v[24:27], v[56:59]
    v_mfma_f32_16x16x32_bf16 v[60:63], v[220:223], v[28:31], v[60:63]
    s_setprio 0
    s_nop 7
    v_cvt_pk_bf16_f32 v240, v32, v36
    v_cvt_pk_bf16_f32 v241, v40, v44
    v_cvt_pk_bf16_f32 v242, v48, v52
    v_cvt_pk_bf16_f32 v243, v56, v60
    buffer_store_dwordx4 v[240:243], v249, s[12:15], s39 offen sc1
    s_add_u32 s39, s39, 2736128
    v_cvt_pk_bf16_f32 v244, v33, v37
    v_cvt_pk_bf16_f32 v245, v41, v45
    v_cvt_pk_bf16_f32 v246, v49, v53
    v_cvt_pk_bf16_f32 v247, v57, v61
    buffer_store_dwordx4 v[244:247], v249, s[12:15], s39 offen sc1
    s_add_u32 s39, s39, 2736128
    v_cvt_pk_bf16_f32 v240, v34, v38
    v_cvt_pk_bf16_f32 v241, v42, v46
    v_cvt_pk_bf16_f32 v242, v50, v54
    v_cvt_pk_bf16_f32 v243, v58, v62
    buffer_store_dwordx4 v[240:243], v249, s[12:15], s39 offen sc1
    s_add_u32 s39, s39, 2736128
    v_cvt_pk_bf16_f32 v244, v35, v39
    v_cvt_pk_bf16_f32 v245, v43, v47
    v_cvt_pk_bf16_f32 v246, v51, v55
    v_cvt_pk_bf16_f32 v247, v59, v63
    buffer_store_dwordx4 v[244:247], v249, s[12:15], s39 offen sc1
    s_mov_b32 s41, s40
    s_add_u32 s40, s40, 1
    s_cmp_eq_u32 s41, 3
    s_cbranch_scc0 K12_ES3
    s_waitcnt vmcnt(0)
    s_mov_b32 s34, -1
    s_cmp_ge_u32 s41, 8
    s_cbranch_scc1 K12_SG4
    s_lshl_b32 s36, s41, 2
    s_add_u32 s37, s36, 155680
    s_mov_b64 exec, 1
    v_mov_b32 v255, s37
    v_mov_b32 v240, 1
    ds_add_rtn_u32 v240, v255, v240
    s_waitcnt lgkmcnt(0)
    v_readfirstlane_b32 s37, v240
    s_nop 3
    s_cmp_eq_u32 s37, 3
    s_cbranch_scc0 K12_SH4
    s_lshl_b32 s36, s36, 8
    v_mov_b32 v255, 1
    v_mov_b32 v240, s36
    buffer_atomic_add v255, v240, s[60:63], 0 offen sc0 sc1
    s_mov_b32 s34, s41
K12_SH4:
    s_mov_b64 exec, -1
K12_SG4:
    s_waitcnt vmcnt(0)
    s_cmp_ge_u32 s34, 8
    s_cbranch_scc1 K12_PB5
    v_readfirstlane_b32 s37, v255
    s_nop 3
    s_cmp_eq_u32 s37, 255
    s_cbranch_scc0 K12_PB5
    s_lshl_b32 s36, s34, 4
    s_add_u32 s36, s36, 16384
    s_mov_b64 exec, 1
    v_mov_b32 v255, 1
    v_mov_b32 v240, s36
    buffer_store_dword v255, v240, s[60:63], 0 offen sc1
    s_mov_b64 exec, -1
K12_PB5:
    s_mov_b32 s34, -1
    s_mov_b32 s41, -1
K12_ES3:
    s_waitcnt vmcnt(16)
    s_branch K12_XP_F
K12_XP_E:
    s_mov_b32 s41, s40
    s_add_u32 s40, s40, 1
    s_cmp_eq_u32 s41, 3
    s_cbranch_scc0 K12_ES6
    s_waitcnt vmcnt(0)
    s_mov_b32 s34, -1
    s_cmp_ge_u32 s41, 8
    s_cbranch_scc1 K12_SG7
    s_lshl_b32 s36, s41, 2
    s_add_u32 s37, s36, 155680
    s_mov_b64 exec, 1
    v_mov_b32 v255, s37
    v_mov_b32 v240, 1
    ds_add_rtn_u32 v240, v255, v240
    s_waitcnt lgkmcnt(0)
    v_readfirstlane_b32 s37, v240
    s_nop 3
    s_cmp_eq_u32 s37, 3
    s_cbranch_scc0 K12_SH7
    s_lshl_b32 s36, s36, 8
    v_mov_b32 v255, 1
    v_mov_b32 v240, s36
    buffer_atomic_add v255, v240, s[60:63], 0 offen sc0 sc1
    s_mov_b32 s34, s41
K12_SH7:
    s_mov_b64 exec, -1
K12_SG7:
    s_waitcnt vmcnt(0)
    s_cmp_ge_u32 s34, 8
    s_cbranch_scc1 K12_PB8
    v_readfirstlane_b32 s37, v255
    s_nop 3
    s_cmp_eq_u32 s37, 255
    s_cbranch_scc0 K12_PB8
    s_lshl_b32 s36, s34, 4
    s_add_u32 s36, s36, 16384
    s_mov_b64 exec, 1
    v_mov_b32 v255, 1
    v_mov_b32 v240, s36
    buffer_store_dword v255, v240, s[60:63], 0 offen sc1
    s_mov_b64 exec, -1
K12_PB8:
    s_mov_b32 s34, -1
    s_mov_b32 s41, -1
K12_ES6:
    s_waitcnt vmcnt(0)
K12_XP_F:
    s_cmp_ge_u32 s34, 8
    s_cbranch_scc1 K12_PB9
    v_readfirstlane_b32 s37, v255
    s_nop 3
    s_cmp_eq_u32 s37, 255
    s_cbranch_scc0 K12_PB9
    s_lshl_b32 s36, s34, 4
    s_add_u32 s36, s36, 16384
    s_mov_b64 exec, 1
    v_mov_b32 v255, 1
    v_mov_b32 v240, s36
    buffer_store_dword v255, v240, s[60:63], 0 offen sc1
    s_mov_b64 exec, -1
K12_PB9:
    s_cmp_ge_u32 s40, 8
    s_cbranch_scc1 K12_PFIN
K12_WENTRY:
    s_waitcnt vmcnt(0)
    s_mov_b32 s34, -1
    s_cmp_ge_u32 s41, 8
    s_cbranch_scc1 K12_SG10
    s_lshl_b32 s36, s41, 2
    s_add_u32 s37, s36, 155680
    s_mov_b64 exec, 1
    v_mov_b32 v255, s37
    v_mov_b32 v240, 1
    ds_add_rtn_u32 v240, v255, v240
    s_waitcnt lgkmcnt(0)
    v_readfirstlane_b32 s37, v240
    s_nop 3
    s_cmp_eq_u32 s37, 3
    s_cbranch_scc0 K12_SH10
    s_lshl_b32 s36, s36, 8
    v_mov_b32 v255, 1
    v_mov_b32 v240, s36
    buffer_atomic_add v255, v240, s[60:63], 0 offen sc0 sc1
    s_mov_b32 s34, s41
K12_SH10:
    s_mov_b64 exec, -1
K12_SG10:
    s_cmp_ge_u32 s34, 8
    s_cbranch_scc1 K12_EP11
    s_waitcnt vmcnt(0)
    s_cmp_ge_u32 s34, 8
    s_cbranch_scc1 K12_PB12
    v_readfirstlane_b32 s37, v255
    s_nop 3
    s_cmp_eq_u32 s37, 255
    s_cbranch_scc0 K12_PB12
    s_lshl_b32 s36, s34, 4
    s_add_u32 s36, s36, 16384
    s_mov_b64 exec, 1
    v_mov_b32 v255, 1
    v_mov_b32 v240, s36
    buffer_store_dword v255, v240, s[60:63], 0 offen sc1
    s_mov_b64 exec, -1
K12_PB12:
    s_mov_b32 s34, -1
K12_EP11:
    v_perm_b32 v64, v100, v96, s28
    v_perm_b32 v68, v100, v96, s29
    v_perm_b32 v65, v108, v104, s28
    v_perm_b32 v69, v108, v104, s29
    v_perm_b32 v66, v116, v112, s28
    v_perm_b32 v70, v116, v112, s29
    v_perm_b32 v67, v124, v120, s28
    v_perm_b32 v71, v124, v120, s29
    v_perm_b32 v72, v101, v97, s28
    v_perm_b32 v76, v101, v97, s29
    v_perm_b32 v73, v109, v105, s28
    v_perm_b32 v77, v109, v105, s29
    v_perm_b32 v74, v117, v113, s28
    v_perm_b32 v78, v117, v113, s29
    v_perm_b32 v75, v125, v121, s28
    v_perm_b32 v79, v125, v121, s29
    v_perm_b32 v80, v102, v98, s28
    v_perm_b32 v84, v102, v98, s29
    v_perm_b32 v81, v110, v106, s28
    v_perm_b32 v85, v110, v106, s29
    v_perm_b32 v82, v118, v114, s28
    v_perm_b32 v86, v118, v114, s29
    v_perm_b32 v83, v126, v122, s28
    v_perm_b32 v87, v126, v122, s29
    v_perm_b32 v88, v103, v99, s28
    v_perm_b32 v92, v103, v99, s29
    v_perm_b32 v89, v111, v107, s28
    v_perm_b32 v93, v111, v107, s29
    v_perm_b32 v90, v119, v115, s28
    v_perm_b32 v94, v119, v115, s29
    v_perm_b32 v91, v127, v123, s28
    v_perm_b32 v95, v127, v123, s29
    s_lshl_b32 s36, s40, 3
    s_sub_i32 s36, s36, 24
    s_max_i32 s36, s36, 1
    s_mov_b32 s37, 131072
K12_GL1:
    v_mov_b32 v240, 155648
    ds_read_b32 v240, v240
    s_waitcnt lgkmcnt(0)
    v_cmp_gt_u32 vcc, s36, v240
    s_sub_u32 s37, s37, 1
    s_cmp_eq_u32 s37, 0
    s_cbranch_scc1 K12_GT1
    s_cbranch_vccz K12_GT1
    s_sleep 2
    s_branch K12_GL1
K12_GT1:
    s_lshl_b32 s36, s40, 2
    s_add_u32 s36, s36, 155840
    s_mov_b64 exec, 1
    v_mov_b32 v240, s36
    v_mov_b32 v241, 1
    ds_add_u32 v240, v241
    s_mov_b64 exec, -1
    s_mov_b32 s37, 131072
K12_BL1:
    v_mov_b32 v240, s36
    ds_read_b32 v240, v240
    s_waitcnt lgkmcnt(0)
    v_cmp_gt_u32 vcc, 4, v240
    s_sub_u32 s37, s37, 1
    s_cmp_eq_u32 s37, 0
    s_cbranch_scc1 K12_BT1
    s_cbranch_vccz K12_BT1
    s_sleep 1
    s_branch K12_BL1
K12_BT1:
    s_add_u32 s42, s40, 1
    s_mul_i32 s36, s42, 85
    s_add_u32 s36, s36, s2
    s_and_b32 s36, s36, 255
    s_mul_hi_u32 s37, s36, 0x55555556
    s_mul_i32 s38, s37, 3
    s_cmp_eq_u32 s38, s36
    s_cselect_b32 s27, 1, 0
    s_cmp_lt_u32 s37, 78
    s_cselect_b32 s27, s27, 0
    s_add_u32 s37, s37, 89
    s_cmp_eq_u32 s21, 0
    s_cselect_b32 s30, s24, s37
    s_cselect_b32 s27, 1, s27
    s_cmp_eq_u32 s27, 0
    s_cbranch_scc1 K12_WP_N
    s_lshl_b32 s36, s42, 8
    s_mul_i32 s37, s30, 98304
    s_add_u32 s36, s36, s37
    buffer_load_dwordx4 v[0:3], v248, s[4:7], s36 offen
    buffer_load_dwordx4 v[4:7], v248, s[4:7], s36 offen offset:2048
    s_add_u32 s36, s36, 4096
    buffer_load_dwordx4 v[8:11], v248, s[4:7], s36 offen
    buffer_load_dwordx4 v[12:15], v248, s[4:7], s36 offen offset:2048
    s_add_u32 s36, s36, 4096
    buffer_load_dwordx4 v[16:19], v248, s[4:7], s36 offen
    buffer_load_dwordx4 v[20:23], v248, s[4:7], s36 offen offset:2048
    s_add_u32 s36, s36, 4096
    buffer_load_dwordx4 v[24:27], v248, s[4:7], s36 offen
    buffer_load_dwordx4 v[28:31], v248, s[4:7], s36 offen offset:2048
    s_add_u32 s36, s36, 53248
    buffer_load_dwordx4 v[32:35], v248, s[4:7], s36 offen
    buffer_load_dwordx4 v[36:39], v248, s[4:7], s36 offen offset:2048
    s_add_u32 s36, s36, 4096
    buffer_load_dwordx4 v[40:43], v248, s[4:7], s36 offen
    buffer_load_dwordx4 v[44:47], v248, s[4:7], s36 offen offset:2048
    s_add_u32 s36, s36, 4096
    buffer_load_dwordx4 v[48:51], v248, s[4:7], s36 offen
    buffer_load_dwordx4 v[52:55], v248, s[4:7], s36 offen offset:2048
    s_add_u32 s36, s36, 4096
    buffer_load_dwordx4 v[56:59], v248, s[4:7], s36 offen
    buffer_load_dwordx4 v[60:63], v248, s[4:7], s36 offen offset:2048
    s_branch K12_WP_M
K12_WP_N:
K12_WP_M:
    s_lshl_b32 s36, s40, 7
    s_add_u32 s36, s36, s22
    s_and_b32 s37, s36, 3
    s_lshr_b32 s38, s36, 1
    s_and_b32 s38, s38, 4
    s_or_b32 s37, s37, s38
    v_bfe_u32 v253, v254, 5, 3
    v_xor_b32 v253, s37, v253
    v_lshl_add_u32 v253, v253, 5, v251
    s_lshl_b32 s36, s36, 9
    s_add_u32 s39, s36, s32
    s_setprio 1
    v_mfma_f32_16x16x32_bf16 v[128:131], v[224:227], v[64:67], 0
    v_mfma_f32_16x16x32_bf16 v[132:135], v[224:227], v[68:71], 0
    v_mfma_f32_16x16x32_bf16 v[136:139], v[224:227], v[72:75], 0
    v_mfma_f32_16x16x32_bf16 v[140:143], v[224:227], v[76:79], 0
    v_mfma_f32_16x16x32_bf16 v[144:147], v[224:227], v[80:83], 0
    v_mfma_f32_16x16x32_bf16 v[148:151], v[224:227], v[84:87], 0
    v_mfma_f32_16x16x32_bf16 v[152:155], v[224:227], v[88:91], 0
    v_mfma_f32_16x16x32_bf16 v[156:159], v[224:227], v[92:95], 0
    s_setprio 0
    s_nop 7
    v_cvt_pk_bf16_f32 v240, v128, v132
    v_cvt_pk_bf16_f32 v241, v136, v140
    v_cvt_pk_bf16_f32 v242, v144, v148
    v_cvt_pk_bf16_f32 v243, v152, v156
    buffer_store_dwordx4 v[240:243], v253, s[16:19], s39 offen sc1
    s_add_u32 s39, s39, 4194304
    v_cvt_pk_bf16_f32 v244, v129, v133
    v_cvt_pk_bf16_f32 v245, v137, v141
    v_cvt_pk_bf16_f32 v246, v145, v149
    v_cvt_pk_bf16_f32 v247, v153, v157
    buffer_store_dwordx4 v[244:247], v253, s[16:19], s39 offen sc1
    s_add_u32 s39, s39, 4194304
    v_cvt_pk_bf16_f32 v240, v130, v134
    v_cvt_pk_bf16_f32 v241, v138, v142
    v_cvt_pk_bf16_f32 v242, v146, v150
    v_cvt_pk_bf16_f32 v243, v154, v158
    buffer_store_dwordx4 v[240:243], v253, s[16:19], s39 offen sc1
    s_add_u32 s39, s39, 4194304
    v_cvt_pk_bf16_f32 v244, v131, v135
    v_cvt_pk_bf16_f32 v245, v139, v143
    v_cvt_pk_bf16_f32 v246, v147, v151
    v_cvt_pk_bf16_f32 v247, v155, v159
    buffer_store_dwordx4 v[244:247], v253, s[16:19], s39 offen sc1
    s_add_u32 s39, s39, 4194304
    s_cmp_lt_u32 s40, 4
    s_cbranch_scc1 K12_UT3
    s_lshl_b32 s36, s40, 3
    s_sub_i32 s36, s36, 22
    s_max_i32 s36, s36, 1
    s_mov_b32 s37, 131072
K12_UL3:
    v_mov_b32 v255, 155648
    ds_read_b32 v255, v255
    s_waitcnt lgkmcnt(0)
    v_cmp_gt_u32 vcc, s36, v255
    s_sub_u32 s37, s37, 1
    s_cmp_eq_u32 s37, 0
    s_cbranch_scc1 K12_UT3
    s_cbranch_vccz K12_UT3
    s_sleep 2
    s_branch K12_UL3
K12_UT3:
    s_setprio 1
    v_mfma_f32_16x16x32_bf16 v[128:131], v[228:231], v[64:67], 0
    v_mfma_f32_16x16x32_bf16 v[132:135], v[228:231], v[68:71], 0
    v_mfma_f32_16x16x32_bf16 v[136:139], v[228:231], v[72:75], 0
    v_mfma_f32_16x16x32_bf16 v[140:143], v[228:231], v[76:79], 0
    v_mfma_f32_16x16x32_bf16 v[144:147], v[228:231], v[80:83], 0
    v_mfma_f32_16x16x32_bf16 v[148:151], v[228:231], v[84:87], 0
    v_mfma_f32_16x16x32_bf16 v[152:155], v[228:231], v[88:91], 0
    v_mfma_f32_16x16x32_bf16 v[156:159], v[228:231], v[92:95], 0
    s_setprio 0
    s_nop 7
    v_cvt_pk_bf16_f32 v240, v128, v132
    v_cvt_pk_bf16_f32 v241, v136, v140
    v_cvt_pk_bf16_f32 v242, v144, v148
    v_cvt_pk_bf16_f32 v243, v152, v156
    buffer_store_dwordx4 v[240:243], v253, s[16:19], s39 offen sc1
    s_add_u32 s39, s39, 4194304
    v_cvt_pk_bf16_f32 v244, v129, v133
    v_cvt_pk_bf16_f32 v245, v137, v141
    v_cvt_pk_bf16_f32 v246, v145, v149
    v_cvt_pk_bf16_f32 v247, v153, v157
    buffer_store_dwordx4 v[244:247], v253, s[16:19], s39 offen sc1
    s_add_u32 s39, s39, 4194304
    v_cvt_pk_bf16_f32 v240, v130, v134
    v_cvt_pk_bf16_f32 v241, v138, v142
    v_cvt_pk_bf16_f32 v242, v146, v150
    v_cvt_pk_bf16_f32 v243, v154, v158
    buffer_store_dwordx4 v[240:243], v253, s[16:19], s39 offen sc1
    s_add_u32 s39, s39, 4194304
    v_cvt_pk_bf16_f32 v244, v131, v135
    v_cvt_pk_bf16_f32 v245, v139, v143
    v_cvt_pk_bf16_f32 v246, v147, v151
    v_cvt_pk_bf16_f32 v247, v155, v159
    buffer_store_dwordx4 v[244:247], v253, s[16:19], s39 offen sc1
    s_add_u32 s39, s39, 4194304
    s_cmp_lt_u32 s40, 4
    s_cbranch_scc1 K12_UT4
    s_lshl_b32 s36, s40, 3
    s_sub_i32 s36, s36, 20
    s_max_i32 s36, s36, 1
    s_mov_b32 s37, 131072
K12_UL4:
    v_mov_b32 v255, 155648
    ds_read_b32 v255, v255
    s_waitcnt lgkmcnt(0)
    v_cmp_gt_u32 vcc, s36, v255
    s_sub_u32 s37, s37, 1
    s_cmp_eq_u32 s37, 0
    s_cbranch_scc1 K12_UT4
    s_cbranch_vccz K12_UT4
    s_sleep 2
    s_branch K12_UL4
K12_UT4:
    s_setprio 1
    v_mfma_f32_16x16x32_bf16 v[128:131], v[232:235], v[64:67], 0
    v_mfma_f32_16x16x32_bf16 v[132:135], v[232:235], v[68:71], 0
    v_mfma_f32_16x16x32_bf16 v[136:139], v[232:235], v[72:75], 0
    v_mfma_f32_16x16x32_bf16 v[140:143], v[232:235], v[76:79], 0
    v_mfma_f32_16x16x32_bf16 v[144:147], v[232:235], v[80:83], 0
    v_mfma_f32_16x16x32_bf16 v[148:151], v[232:235], v[84:87], 0
    v_mfma_f32_16x16x32_bf16 v[152:155], v[232:235], v[88:91], 0
    v_mfma_f32_16x16x32_bf16 v[156:159], v[232:235], v[92:95], 0
    s_setprio 0
    s_nop 7
    v_cvt_pk_bf16_f32 v240, v128, v132
    v_cvt_pk_bf16_f32 v241, v136, v140
    v_cvt_pk_bf16_f32 v242, v144, v148
    v_cvt_pk_bf16_f32 v243, v152, v156
    buffer_store_dwordx4 v[240:243], v253, s[16:19], s39 offen sc1
    s_add_u32 s39, s39, 4194304
    v_cvt_pk_bf16_f32 v244, v129, v133
    v_cvt_pk_bf16_f32 v245, v137, v141
    v_cvt_pk_bf16_f32 v246, v145, v149
    v_cvt_pk_bf16_f32 v247, v153, v157
    buffer_store_dwordx4 v[244:247], v253, s[16:19], s39 offen sc1
    s_add_u32 s39, s39, 4194304
    v_cvt_pk_bf16_f32 v240, v130, v134
    v_cvt_pk_bf16_f32 v241, v138, v142
    v_cvt_pk_bf16_f32 v242, v146, v150
    v_cvt_pk_bf16_f32 v243, v154, v158
    buffer_store_dwordx4 v[240:243], v253, s[16:19], s39 offen sc1
    s_add_u32 s39, s39, 4194304
    v_cvt_pk_bf16_f32 v244, v131, v135
    v_cvt_pk_bf16_f32 v245, v139, v143
    v_cvt_pk_bf16_f32 v246, v147, v151
    v_cvt_pk_bf16_f32 v247, v155, v159
    buffer_store_dwordx4 v[244:247], v253, s[16:19], s39 offen sc1
    s_add_u32 s39, s39, 4194304
    s_cmp_lt_u32 s40, 4
    s_cbranch_scc1 K12_UT5
    s_lshl_b32 s36, s40, 3
    s_sub_i32 s36, s36, 18
    s_max_i32 s36, s36, 1
    s_mov_b32 s37, 131072
K12_UL5:
    v_mov_b32 v255, 155648
    ds_read_b32 v255, v255
    s_waitcnt lgkmcnt(0)
    v_cmp_gt_u32 vcc, s36, v255
    s_sub_u32 s37, s37, 1
    s_cmp_eq_u32 s37, 0
    s_cbranch_scc1 K12_UT5
    s_cbranch_vccz K12_UT5
    s_sleep 2
    s_branch K12_UL5
K12_UT5:
    s_setprio 1
    v_mfma_f32_16x16x32_bf16 v[128:131], v[236:239], v[64:67], 0
    v_mfma_f32_16x16x32_bf16 v[132:135], v[236:239], v[68:71], 0
    v_mfma_f32_16x16x32_bf16 v[136:139], v[236:239], v[72:75], 0
    v_mfma_f32_16x16x32_bf16 v[140:143], v[236:239], v[76:79], 0
    v_mfma_f32_16x16x32_bf16 v[144:147], v[236:239], v[80:83], 0
    v_mfma_f32_16x16x32_bf16 v[148:151], v[236:239], v[84:87], 0
    v_mfma_f32_16x16x32_bf16 v[152:155], v[236:239], v[88:91], 0
    v_mfma_f32_16x16x32_bf16 v[156:159], v[236:239], v[92:95], 0
    s_setprio 0
    s_nop 7
    v_cvt_pk_bf16_f32 v240, v128, v132
    v_cvt_pk_bf16_f32 v241, v136, v140
    v_cvt_pk_bf16_f32 v242, v144, v148
    v_cvt_pk_bf16_f32 v243, v152, v156
    buffer_store_dwordx4 v[240:243], v253, s[16:19], s39 offen sc1
    s_add_u32 s39, s39, 4194304
    v_cvt_pk_bf16_f32 v244, v129, v133
    v_cvt_pk_bf16_f32 v245, v137, v141
    v_cvt_pk_bf16_f32 v246, v145, v149
    v_cvt_pk_bf16_f32 v247, v153, v157
    buffer_store_dwordx4 v[244:247], v253, s[16:19], s39 offen sc1
    s_add_u32 s39, s39, 4194304
    v_cvt_pk_bf16_f32 v240, v130, v134
    v_cvt_pk_bf16_f32 v241, v138, v142
    v_cvt_pk_bf16_f32 v242, v146, v150
    v_cvt_pk_bf16_f32 v243, v154, v158
    buffer_store_dwordx4 v[240:243], v253, s[16:19], s39 offen sc1
    s_add_u32 s39, s39, 4194304
    v_cvt_pk_bf16_f32 v244, v131, v135
    v_cvt_pk_bf16_f32 v245, v139, v143
    v_cvt_pk_bf16_f32 v246, v147, v151
    v_cvt_pk_bf16_f32 v247, v155, v159
    buffer_store_dwordx4 v[244:247], v253, s[16:19], s39 offen sc1
    s_mov_b32 s41, s40
    s_add_u32 s40, s40, 1
    s_cmp_eq_u32 s41, 3
    s_cbranch_scc0 K12_ES13
    s_waitcnt vmcnt(0)
    s_mov_b32 s34, -1
    s_cmp_ge_u32 s41, 8
    s_cbranch_scc1 K12_SG14
    s_lshl_b32 s36, s41, 2
    s_add_u32 s37, s36, 155680
    s_mov_b64 exec, 1
    v_mov_b32 v255, s37
    v_mov_b32 v240, 1
    ds_add_rtn_u32 v240, v255, v240
    s_waitcnt lgkmcnt(0)
    v_readfirstlane_b32 s37, v240
    s_nop 3
    s_cmp_eq_u32 s37, 3
    s_cbranch_scc0 K12_SH14
    s_lshl_b32 s36, s36, 8
    v_mov_b32 v255, 1
    v_mov_b32 v240, s36
    buffer_atomic_add v255, v240, s[60:63], 0 offen sc0 sc1
    s_mov_b32 s34, s41
K12_SH14:
    s_mov_b64 exec, -1
K12_SG14:
    s_waitcnt vmcnt(0)
    s_cmp_ge_u32 s34, 8
    s_cbranch_scc1 K12_PB15
    v_readfirstlane_b32 s37, v255
    s_nop 3
    s_cmp_eq_u32 s37, 255
    s_cbranch_scc0 K12_PB15
    s_lshl_b32 s36, s34, 4
    s_add_u32 s36, s36, 16384
    s_mov_b64 exec, 1
    v_mov_b32 v255, 1
    v_mov_b32 v240, s36
    buffer_store_dword v255, v240, s[60:63], 0 offen sc1
    s_mov_b64 exec, -1
K12_PB15:
    s_mov_b32 s34, -1
    s_mov_b32 s41, -1
K12_ES13:
    s_waitcnt vmcnt(16)
    s_cmp_ge_u32 s34, 8
    s_cbranch_scc1 K12_PB16
    v_readfirstlane_b32 s37, v255
    s_nop 3
    s_cmp_eq_u32 s37, 255
    s_cbranch_scc0 K12_PB16
    s_lshl_b32 s36, s34, 4
    s_add_u32 s36, s36, 16384
    s_mov_b64 exec, 1
    v_mov_b32 v255, 1
    v_mov_b32 v240, s36
    buffer_store_dword v255, v240, s[60:63], 0 offen sc1
    s_mov_b64 exec, -1
K12_PB16:
    s_cmp_lt_u32 s40, 8
    s_cbranch_scc1 K12_XW
K12_PFIN:
    s_waitcnt vmcnt(0)
    s_mov_b32 s34, -1
    s_cmp_ge_u32 s41, 8
    s_cbranch_scc1 K12_SG17
    s_lshl_b32 s36, s41, 2
    s_add_u32 s37, s36, 155680
    s_mov_b64 exec, 1
    v_mov_b32 v255, s37
    v_mov_b32 v240, 1
    ds_add_rtn_u32 v240, v255, v240
    s_waitcnt lgkmcnt(0)
    v_readfirstlane_b32 s37, v240
    s_nop 3
    s_cmp_eq_u32 s37, 3
    s_cbranch_scc0 K12_SH17
    s_lshl_b32 s36, s36, 8
    v_mov_b32 v255, 1
    v_mov_b32 v240, s36
    buffer_atomic_add v255, v240, s[60:63], 0 offen sc0 sc1
    s_mov_b32 s34, s41
K12_SH17:
    s_mov_b64 exec, -1
K12_SG17:
    s_waitcnt vmcnt(0)
    s_cmp_ge_u32 s34, 8
    s_cbranch_scc1 K12_PB18
    v_readfirstlane_b32 s37, v255
    s_nop 3
    s_cmp_eq_u32 s37, 255
    s_cbranch_scc0 K12_PB18
    s_lshl_b32 s36, s34, 4
    s_add_u32 s36, s36, 16384
    s_mov_b64 exec, 1
    v_mov_b32 v255, 1
    v_mov_b32 v240, s36
    buffer_store_dword v255, v240, s[60:63], 0 offen sc1
    s_mov_b64 exec, -1
K12_PB18:
    s_endpgm
K12_CONS:
    s_and_b32 s6, s2, 7
    s_lshl_b32 s6, s6, 2
    s_lshr_b32 s7, s2, 6
    s_add_u32 s6, s6, s7
    s_mov_b32 s51, s6
    s_mov_b32 s27, s6
    s_lshr_b32 s7, s2, 3
    s_and_b32 s7, s7, 7
    s_lshr_b32 s20, s7, 2
    s_and_b32 s21, s7, 3
    s_lshl_b32 s22, s6, 1
    s_add_u32 s22, s22, s20
    s_lshl_b32 s23, s6, 2
    s_add_u32 s23, s23, s21
    s_mul_i32 s24, s22, 684032
    s_mul_i32 s25, s23, 524288
    s_add_u32 s25, s25, 50331648
    s_mul_i32 s26, s22, 342016
    s_add_u32 s26, s26, 118489088
    s_add_u32 s8, s58, s24
    s_addc_u32 s9, s59, 0
    s_and_b32 s9, s9, 0xffff
    s_mov_b32 s10, 684032
    s_mov_b32 s11, 0x00020000
    s_add_u32 s12, s58, s25
    s_addc_u32 s13, s59, 0
    s_and_b32 s13, s13, 0xffff
    s_mov_b32 s14, 524288
    s_mov_b32 s15, 0x00020000
    s_add_u32 s16, s58, s26
    s_addc_u32 s17, s59, 0
    s_and_b32 s17, s17, 0xffff
    s_mov_b32 s18, 342016
    s_mov_b32 s19, 0x00020000
    s_add_u32 s4, s58, 153108480
    s_addc_u32 s5, s59, 0
    s_and_b32 s5, s5, 0xffff
    s_cmp_eq_u32 s3, 0
    s_cselect_b32 s6, 128, 0
    s_mov_b32 s7, 0x00020000
    s_mov_b32 s46, 155712
    s_cselect_b32 s46, s46, 155776
    s_mov_b32 s47, 155712
    s_cselect_b32 s47, s47, 155744
    s_cselect_b32 s45, 4, 0
    s_mov_b32 s50, s45
    v_and_b32 v8, 15, v2
    v_lshrrev_b32 v9, 4, v2
    v_lshlrev_b32 v1, 4, v2
    s_mul_i32 s30, s3, 5120
    s_mov_b32 s36, s30
    s_lshl_b32 s31, s3, 12
    s_add_u32 s37, s31, 22528
    s_lshr_b32 s28, s3, 1
    s_and_b32 s29, s3, 1
    s_lshl_b32 s33, s29, 9
    s_add_u32 s33, s33, 20480
    s_mul_i32 s38, s28, 896
    s_add_u32 s38, s38, s33
    s_lshl_b32 s34, s51, 1
    s_add_u32 s34, s34, s28
    s_mul_i32 s34, s34, 684032
    s_add_u32 s64, s58, s34
    s_addc_u32 s65, s59, 0
    s_and_b32 s65, s65, 0xffff
    s_mov_b32 s66, 684032
    s_mov_b32 s67, 0x00020000
    s_mov_b32 s44, 0xffffff
    s_cmp_eq_u32 s29, 0
    s_cselect_b32 s44, -1, s44
    s_mov_b32 s45, 0
    v_lshrrev_b32 v10, 1, v8
    v_xor_b32 v10, v10, v9
    v_lshlrev_b32 v10, 4, v10
    v_lshl_add_u32 v2, v8, 7, v10
    v_xor_b32 v3, 64, v2
    v_lshrrev_b32 v10, 2, v8
    v_lshl_add_u32 v11, v9, 3, v10
    v_lshlrev_b32 v11, 9, v11
    v_and_b32 v12, 1, v9
    v_lshl_or_b32 v10, v12, 2, v10
    s_lshl_b32 s28, s3, 1
    v_xor_b32 v10, s28, v10
    v_lshl_add_u32 v11, v10, 5, v11
    v_and_b32 v10, 3, v8
    v_lshl_add_u32 v11, v10, 3, v11
    v_add_u32 v4, 22528, v11
    s_lshl_b32 s28, s20, 5
    v_xor_b32 v4, s28, v4
    v_and_b32 v10, 3, v8
    v_lshlrev_b32 v10, 2, v10
    v_add_u32 v5, 155648, v10
    s_lshl_b32 s28, s3, 2
    s_add_u32 s28, s28, 155648
    v_mov_b32 v7, s28
    s_mov_b32 s35, 0x80008000
    s_mov_b32 s62, 0
    s_mov_b32 s63, 0
    s_mov_b32 s39, 0
    s_add_u32 m0, s39, s36
    s_nop 0
    buffer_load_dwordx4 v1, s[8:11], s30 offen sc1 lds
    buffer_load_dwordx4 v1, s[8:11], s30 offen offset:1024 sc1 lds
    buffer_load_dwordx4 v1, s[8:11], s30 offen offset:2048 sc1 lds
    buffer_load_dwordx4 v1, s[8:11], s30 offen offset:3072 sc1 lds
    s_add_u32 m0, m0, 4096
    s_add_u32 s34, s30, 4096
    buffer_load_dwordx4 v1, s[8:11], s34 offen sc1 lds
    s_add_u32 m0, s39, s37
    s_add_u32 s30, s30, 21376
    buffer_load_dwordx4 v1, s[12:15], s31 offen sc1 lds
    buffer_load_dwordx4 v1, s[12:15], s31 offen offset:1024 sc1 lds
    buffer_load_dwordx4 v1, s[12:15], s31 offen offset:2048 sc1 lds
    buffer_load_dwordx4 v1, s[12:15], s31 offen offset:3072 sc1 lds
    s_add_u32 m0, s39, s38
    s_mov_b64 exec, s[44:45]
    buffer_load_dwordx4 v1, s[64:67], s33 offen sc1 lds
    s_mov_b64 exec, -1
    s_add_u32 s31, s31, 16384
    s_add_u32 s33, s33, 21376
    s_add_u32 s39, s39, 38912
    s_add_u32 m0, s39, s36
    s_nop 0
    buffer_load_dwordx4 v1, s[8:11], s30 offen sc1 lds
    buffer_load_dwordx4 v1, s[8:11], s30 offen offset:1024 sc1 lds
    buffer_load_dwordx4 v1, s[8:11], s30 offen offset:2048 sc1 lds
    buffer_load_dwordx4 v1, s[8:11], s30 offen offset:3072 sc1 lds
    s_add_u32 m0, m0, 4096
    s_add_u32 s34, s30, 4096
    buffer_load_dwordx4 v1, s[8:11], s34 offen sc1 lds
    s_add_u32 m0, s39, s37
    s_add_u32 s30, s30, 21376
    buffer_load_dwordx4 v1, s[12:15], s31 offen sc1 lds
    buffer_load_dwordx4 v1, s[12:15], s31 offen offset:1024 sc1 lds
    buffer_load_dwordx4 v1, s[12:15], s31 offen offset:2048 sc1 lds
    buffer_load_dwordx4 v1, s[12:15], s31 offen offset:3072 sc1 lds
    s_add_u32 m0, s39, s38
    s_mov_b64 exec, s[44:45]
    buffer_load_dwordx4 v1, s[64:67], s33 offen sc1 lds
    s_mov_b64 exec, -1
    s_add_u32 s31, s31, 16384
    s_add_u32 s33, s33, 21376
    s_add_u32 s39, s39, 38912
    s_add_u32 m0, s39, s36
    s_nop 0
    buffer_load_dwordx4 v1, s[8:11], s30 offen sc1 lds
    buffer_load_dwordx4 v1, s[8:11], s30 offen offset:1024 sc1 lds
    buffer_load_dwordx4 v1, s[8:11], s30 offen offset:2048 sc1 lds
    buffer_load_dwordx4 v1, s[8:11], s30 offen offset:3072 sc1 lds
    s_add_u32 m0, m0, 4096
    s_add_u32 s34, s30, 4096
    buffer_load_dwordx4 v1, s[8:11], s34 offen sc1 lds
    s_add_u32 m0, s39, s37
    s_add_u32 s30, s30, 21376
    buffer_load_dwordx4 v1, s[12:15], s31 offen sc1 lds
    buffer_load_dwordx4 v1, s[12:15], s31 offen offset:1024 sc1 lds
    buffer_load_dwordx4 v1, s[12:15], s31 offen offset:2048 sc1 lds
    buffer_load_dwordx4 v1, s[12:15], s31 offen offset:3072 sc1 lds
    s_add_u32 m0, s39, s38
    s_mov_b64 exec, s[44:45]
    buffer_load_dwordx4 v1, s[64:67], s33 offen sc1 lds
    s_mov_b64 exec, -1
    s_add_u32 s31, s31, 16384
    s_add_u32 s33, s33, 21376
    s_add_u32 s39, s39, 38912
    s_mov_b32 m0, s46
    s_mov_b64 exec, 0xff
    buffer_load_dword v1, s[4:7], 0 offen sc1 lds
    s_mov_b64 exec, -1
    v_lshrrev_b32 v9, 4, v1
    v_and_b32 v8, 15, v9
    v_lshrrev_b32 v9, 4, v9
    v_and_b32 v10, 3, v8
    v_lshlrev_b32 v10, 2, v10
    v_lshrrev_b32 v12, 3, v8
    v_lshl_add_u32 v10, v12, 1, v10
    s_lshl_b32 s28, s3, 4
    s_add_u32 s28, s28, 1
    v_add_u32 v10, s28, v10
    v_bfe_u32 v11, v8, 2, 1
    v_and_b32 v13, 1, v9
    v_lshlrev_b32 v13, 3, v13
    v_mul_u32_u24 v14, 96, v11
    v_mad_u32_u24 v15, v10, v13, v14
    v_mad_u32_u24 v16, v10, 0, v15
    v_mad_u32_u24 v17, v10, 1, v15
    v_mad_u32_u24 v18, v10, 2, v15
    v_mad_u32_u24 v19, v10, 3, v15
    v_mad_u32_u24 v20, v10, 4, v15
    v_mad_u32_u24 v21, v10, 5, v15
    v_mad_u32_u24 v22, v10, 6, v15
    v_mad_u32_u24 v23, v10, 7, v15
    v_and_b32 v16, 127, v16
    v_and_b32 v17, 127, v17
    v_and_b32 v18, 127, v18
    v_and_b32 v19, 127, v19
    v_and_b32 v20, 127, v20
    v_and_b32 v21, 127, v21
    v_and_b32 v22, 127, v22
    v_and_b32 v23, 127, v23
    v_cvt_f32_u32 v16, v16
    v_cvt_f32_u32 v17, v17
    v_cvt_f32_u32 v18, v18
    v_cvt_f32_u32 v19, v19
    v_cvt_f32_u32 v20, v20
    v_cvt_f32_u32 v21, v21
    v_cvt_f32_u32 v22, v22
    v_cvt_f32_u32 v23, v23
    v_mul_f32 v16, 0x3c000000, v16
    v_mul_f32 v17, 0x3c000000, v17
    v_mul_f32 v18, 0x3c000000, v18
    v_mul_f32 v19, 0x3c000000, v19
    v_mul_f32 v20, 0x3c000000, v20
    v_mul_f32 v21, 0x3c000000, v21
    v_mul_f32 v22, 0x3c000000, v22
    v_mul_f32 v23, 0x3c000000, v23
    v_cos_f32 v16, v16
    v_cos_f32 v17, v17
    v_cos_f32 v18, v18
    v_cos_f32 v19, v19
    v_cos_f32 v20, v20
    v_cos_f32 v21, v21
    v_cos_f32 v22, v22
    v_cos_f32 v23, v23
    s_nop 0
    v_cvt_pk_bf16_f32 v24, v16, v17
    v_cvt_pk_bf16_f32 v25, v18, v19
    v_cvt_pk_bf16_f32 v26, v20, v21
    v_cvt_pk_bf16_f32 v27, v22, v23
    v_lshlrev_b32 v32, 16, v24
    v_and_b32 v33, 0xffff0000, v24
    v_sub_f32 v16, v16, v32
    v_sub_f32 v17, v17, v33
    v_lshlrev_b32 v32, 16, v25
    v_and_b32 v33, 0xffff0000, v25
    v_sub_f32 v18, v18, v32
    v_sub_f32 v19, v19, v33
    v_lshlrev_b32 v32, 16, v26
    v_and_b32 v33, 0xffff0000, v26
    v_sub_f32 v20, v20, v32
    v_sub_f32 v21, v21, v33
    v_lshlrev_b32 v32, 16, v27
    v_and_b32 v33, 0xffff0000, v27
    v_sub_f32 v22, v22, v32
    v_sub_f32 v23, v23, v33
    v_cvt_pk_bf16_f32 v28, v16, v17
    v_cvt_pk_bf16_f32 v29, v18, v19
    v_cvt_pk_bf16_f32 v30, v20, v21
    v_cvt_pk_bf16_f32 v31, v22, v23
    v_cmp_lt_u32 vcc, 1, v9
    s_lshl_b32 s28, s3, 10
    s_add_u32 s28, s28, 133120
    v_add_u32 v14, s28, v1
    v_cndmask_b32 v24, v24, v28, vcc
    v_cndmask_b32 v25, v25, v29, vcc
    v_cndmask_b32 v26, v26, v30, vcc
    v_cndmask_b32 v27, v27, v31, vcc
    ds_write_b128 v14, v[24:27]
    v_mov_b32 v12, 0
    v_mov_b32 v13, 0
    v_mov_b32 v14, 0
    v_mov_b32 v15, 0
    s_mul_i32 s28, s3, 38912
    s_add_u32 s28, s28, 22272
    v_add_u32 v16, s28, v1
    s_mov_b64 exec, 0xffff
    ds_write_b128 v16, v[12:15]
    s_mov_b64 exec, -1
    s_lshl_b32 s28, s3, 2
    s_add_u32 s28, s28, 155648
    v_mov_b32 v16, s28
    ds_write_b32 v16, v12
    s_lshl_b32 s28, s3, 3
    s_add_u32 s28, s28, 155680
    v_mov_b32 v16, s28
    ds_write_b64 v16, v[12:13]
    s_lshl_b32 s28, s3, 3
    s_add_u32 s28, s28, 155712
    v_mov_b32 v16, s28
    ds_write_b64 v16, v[12:13]
    s_lshl_b32 s28, s3, 3
    s_add_u32 s28, s28, 155840
    v_mov_b32 v16, s28
    ds_write_b64 v16, v[12:13]
    v_mov_b32 v16, 155664
    ds_write_b32 v16, v12
    v_mov_b32 v16, 155744
    v_mov_b32 v17, 1
    ds_write_b32 v16, v17
    s_waitcnt lgkmcnt(0)
    s_barrier
    v_mov_b32 v80, 0
    v_mov_b32 v81, 0
    v_mov_b32 v82, 0
    v_mov_b32 v83, 0
    v_mov_b32 v84, 0
    v_mov_b32 v85, 0
    v_mov_b32 v86, 0
    v_mov_b32 v87, 0
    v_mov_b32 v88, 0
    v_mov_b32 v89, 0
    v_mov_b32 v90, 0
    v_mov_b32 v91, 0
    v_mov_b32 v92, 0
    v_mov_b32 v93, 0
    v_mov_b32 v94, 0
    v_mov_b32 v95, 0
    v_mov_b32 v96, 0
    v_mov_b32 v97, 0
    v_mov_b32 v98, 0
    v_mov_b32 v99, 0
    v_mov_b32 v100, 0
    v_mov_b32 v101, 0
    v_mov_b32 v102, 0
    v_mov_b32 v103, 0
    v_mov_b32 v104, 0
    v_mov_b32 v105, 0
    v_mov_b32 v106, 0
    v_mov_b32 v107, 0
    v_mov_b32 v108, 0
    v_mov_b32 v109, 0
    v_mov_b32 v110, 0
    v_mov_b32 v111, 0
    v_mov_b32 v112, 0
    v_mov_b32 v113, 0
    v_mov_b32 v114, 0
    v_mov_b32 v115, 0
    v_mov_b32 v116, 0
    v_mov_b32 v117, 0
    v_mov_b32 v118, 0
    v_mov_b32 v119, 0
    v_mov_b32 v120, 0
    v_mov_b32 v121, 0
    v_mov_b32 v122, 0
    v_mov_b32 v123, 0
    v_mov_b32 v124, 0
    v_mov_b32 v125, 0
    v_mov_b32 v126, 0
    v_mov_b32 v127, 0
    v_mov_b32 v128, 0
    v_mov_b32 v129, 0
    v_mov_b32 v130, 0
    v_mov_b32 v131, 0
    v_mov_b32 v132, 0
    v_mov_b32 v133, 0
    v_mov_b32 v134, 0
    v_mov_b32 v135, 0
    v_mov_b32 v136, 0
    v_mov_b32 v137, 0
    v_mov_b32 v138, 0
    v_mov_b32 v139, 0
    v_mov_b32 v140, 0
    v_mov_b32 v141, 0
    v_mov_b32 v142, 0
    v_mov_b32 v143, 0
    v_mov_b32 v144, 0
    v_mov_b32 v145, 0
    v_mov_b32 v146, 0
    v_mov_b32 v147, 0
    v_mov_b32 v148, 0
    v_mov_b32 v149, 0
    v_mov_b32 v150, 0
    v_mov_b32 v151, 0
    v_mov_b32 v152, 0
    v_mov_b32 v153, 0
    v_mov_b32 v154, 0
    v_mov_b32 v155, 0
    v_mov_b32 v156, 0
    v_mov_b32 v157, 0
    v_mov_b32 v158, 0
    v_mov_b32 v159, 0
    v_mov_b32 v160, 0
    v_mov_b32 v161, 0
    v_mov_b32 v162, 0
    v_mov_b32 v163, 0
    v_mov_b32 v164, 0
    v_mov_b32 v165, 0
    v_mov_b32 v166, 0
    v_mov_b32 v167, 0
    v_mov_b32 v168, 0
    v_mov_b32 v169, 0
    v_mov_b32 v170, 0
    v_mov_b32 v171, 0
    v_mov_b32 v172, 0
    v_mov_b32 v173, 0
    v_mov_b32 v174, 0
    v_mov_b32 v175, 0
    v_mov_b32 v176, 0
    v_mov_b32 v177, 0
    v_mov_b32 v178, 0
    v_mov_b32 v179, 0
    v_mov_b32 v180, 0
    v_mov_b32 v181, 0
    v_mov_b32 v182, 0
    v_mov_b32 v183, 0
    v_mov_b32 v184, 0
    v_mov_b32 v185, 0
    v_mov_b32 v186, 0
    v_mov_b32 v187, 0
    v_mov_b32 v188, 0
    v_mov_b32 v189, 0
    v_mov_b32 v190, 0
    v_mov_b32 v191, 0
    v_mov_b32 v192, 0
    v_mov_b32 v193, 0
    v_mov_b32 v194, 0
    v_mov_b32 v195, 0
    v_mov_b32 v196, 0
    v_mov_b32 v197, 0
    v_mov_b32 v198, 0
    v_mov_b32 v199, 0
    v_mov_b32 v200, 0
    v_mov_b32 v201, 0
    v_mov_b32 v202, 0
    v_mov_b32 v203, 0
    v_mov_b32 v204, 0
    v_mov_b32 v205, 0
    v_mov_b32 v206, 0
    v_mov_b32 v207, 0
    v_mov_b32 v208, 0
    v_mov_b32 v209, 0
    v_mov_b32 v210, 0
    v_mov_b32 v211, 0
    v_mov_b32 v212, 0
    v_mov_b32 v213, 0
    v_mov_b32 v214, 0
    v_mov_b32 v215, 0
    v_mov_b32 v216, 0
    v_mov_b32 v217, 0
    v_mov_b32 v218, 0
    v_mov_b32 v219, 0
    v_mov_b32 v220, 0
    v_mov_b32 v221, 0
    v_mov_b32 v222, 0
    v_mov_b32 v223, 0
    v_mov_b32 v224, 0
    v_mov_b32 v225, 0
    v_mov_b32 v226, 0
    v_mov_b32 v227, 0
    v_mov_b32 v228, 0
    v_mov_b32 v229, 0
    v_mov_b32 v230, 0
    v_mov_b32 v231, 0
    v_mov_b32 v232, 0
    v_mov_b32 v233, 0
    v_mov_b32 v234, 0
    v_mov_b32 v235, 0
    v_mov_b32 v236, 0
    v_mov_b32 v237, 0
    v_mov_b32 v238, 0
    v_mov_b32 v239, 0
    v_mov_b32 v240, 0
    v_mov_b32 v241, 0
    v_mov_b32 v242, 0
    v_mov_b32 v243, 0
    v_mov_b32 v244, 0
    v_mov_b32 v245, 0
    v_mov_b32 v246, 0
    v_mov_b32 v247, 0
    s_barrier
    s_mov_b32 s40, 2
    v_mov_b32 v0, s40
    s_waitcnt vmcnt(21)
    ds_write_b32 v7, v0
    s_branch K12_S0
K12_Q0:
    ds_read_b64_tr_b16 v[40:41], v4 offset:0
    ds_read_b64_tr_b16 v[42:43], v4 offset:2048
    ds_read_b64_tr_b16 v[44:45], v4 offset:256
    ds_read_b64_tr_b16 v[46:47], v4 offset:2304
    v_xor_b32 v4, 32, v4
    ds_read_b64_tr_b16 v[48:49], v4 offset:0
    ds_read_b64_tr_b16 v[50:51], v4 offset:2048
    ds_read_b64_tr_b16 v[52:53], v4 offset:256
    ds_read_b64_tr_b16 v[54:55], v4 offset:2304
    v_xor_b32 v4, 32, v4
    ds_read_b128 v[8:11], v2 offset:0
    ds_read_b128 v[12:15], v3 offset:0
    ds_read_b128 v[16:19], v2 offset:2048
    ds_read_b128 v[20:23], v3 offset:2048
    ds_read_b128 v[32:35], v2 offset:6144
    ds_read_b128 v[36:39], v3 offset:6144
    ds_read_b32 v68, v5
    s_waitcnt lgkmcnt(7)
    v_xor_b32 v72, s35, v44
    v_xor_b32 v73, s35, v45
    v_xor_b32 v74, s35, v46
    v_xor_b32 v75, s35, v47
    v_xor_b32 v76, s35, v52
    v_xor_b32 v77, s35, v53
    v_xor_b32 v78, s35, v54
    v_xor_b32 v79, s35, v55
    s_mov_b32 s41, 0
    s_mov_b32 s42, 38912
    s_mov_b32 s39, 0
    s_mov_b32 s29, 116736
K12_LOOP:
    s_waitcnt lgkmcnt(2)
    v_mfma_f32_16x16x32_bf16 v[80:83], v[8:11], v[40:43], v[80:83]
    ds_read_b128 v[24:27], v2 offset:4096
    v_xor_b32 v72, s35, v44
    v_xor_b32 v73, s35, v45
    v_mfma_f32_16x16x32_bf16 v[84:87], v[8:11], v[44:47], v[84:87]
    ds_read_b128 v[28:31], v3 offset:4096
    v_xor_b32 v74, s35, v46
    v_xor_b32 v75, s35, v47
    v_mfma_f32_16x16x32_bf16 v[88:91], v[8:11], v[48:51], v[88:91]
    s_waitcnt lgkmcnt(2)
    v_cmp_gt_u32 vcc, s40, v68
    s_add_u32 s49, s39, 2
    s_lshr_b32 s49, s49, 1
    v_xor_b32 v76, s35, v52
    v_xor_b32 v77, s35, v53
    v_mfma_f32_16x16x32_bf16 v[92:95], v[8:11], v[52:55], v[92:95]
    s_cbranch_vccnz K12_S1
K12_Q1:
    s_mul_i32 s48, s49, s50
    s_add_u32 s48, s48, s47
    v_xor_b32 v78, s35, v54
    v_xor_b32 v79, s35, v55
    v_mfma_f32_16x16x32_bf16 v[80:83], v[12:15], v[72:75], v[80:83]
    s_add_u32 m0, s29, s36
    s_nop 0
    buffer_load_dwordx4 v1, s[8:11], s30 offen sc1 lds
    v_mfma_f32_16x16x32_bf16 v[84:87], v[12:15], v[40:43], v[84:87]
    s_cmp_lt_u32 s49, 8
    s_cselect_b32 s48, s48, 155744
    v_mfma_f32_16x16x32_bf16 v[88:91], v[12:15], v[76:79], v[88:91]
    s_cmp_ge_u32 s49, 3
    s_cselect_b32 s48, s48, 155744
    v_mfma_f32_16x16x32_bf16 v[92:95], v[12:15], v[48:51], v[92:95]
    v_mfma_f32_16x16x32_bf16 v[96:99], v[16:19], v[40:43], v[96:99]
    ds_read_b128 v[8:11], v2 offset:8192
    v_mfma_f32_16x16x32_bf16 v[100:103], v[16:19], v[44:47], v[100:103]
    ds_read_b128 v[12:15], v3 offset:8192
    v_mfma_f32_16x16x32_bf16 v[104:107], v[16:19], v[48:51], v[104:107]
    buffer_load_dwordx4 v1, s[8:11], s30 offen offset:1024 sc1 lds
    v_mfma_f32_16x16x32_bf16 v[108:111], v[16:19], v[52:55], v[108:111]
    v_mfma_f32_16x16x32_bf16 v[96:99], v[20:23], v[72:75], v[96:99]
    v_mfma_f32_16x16x32_bf16 v[100:103], v[20:23], v[40:43], v[100:103]
    v_mfma_f32_16x16x32_bf16 v[104:107], v[20:23], v[76:79], v[104:107]
    buffer_load_dwordx4 v1, s[8:11], s30 offen offset:2048 sc1 lds
    v_mfma_f32_16x16x32_bf16 v[108:111], v[20:23], v[48:51], v[108:111]
    s_waitcnt lgkmcnt(2)
    v_mfma_f32_16x16x32_bf16 v[112:115], v[24:27], v[40:43], v[112:115]
    ds_read_b128 v[16:19], v2 offset:10240
    v_mfma_f32_16x16x32_bf16 v[116:119], v[24:27], v[44:47], v[116:119]
    ds_read_b128 v[20:23], v3 offset:10240
    v_mfma_f32_16x16x32_bf16 v[120:123], v[24:27], v[48:51], v[120:123]
    v_mfma_f32_16x16x32_bf16 v[124:127], v[24:27], v[52:55], v[124:127]
    v_mfma_f32_16x16x32_bf16 v[112:115], v[28:31], v[72:75], v[112:115]
    buffer_load_dwordx4 v1, s[8:11], s30 offen offset:3072 sc1 lds
    v_mfma_f32_16x16x32_bf16 v[116:119], v[28:31], v[40:43], v[116:119]
    v_mfma_f32_16x16x32_bf16 v[120:123], v[28:31], v[76:79], v[120:123]
    v_mfma_f32_16x16x32_bf16 v[124:127], v[28:31], v[48:51], v[124:127]
    v_mfma_f32_16x16x32_bf16 v[128:131], v[32:35], v[40:43], v[128:131]
    ds_read_b128 v[24:27], v2 offset:12288
    v_mfma_f32_16x16x32_bf16 v[132:135], v[32:35], v[44:47], v[132:135]
    ds_read_b128 v[28:31], v3 offset:12288
    v_mfma_f32_16x16x32_bf16 v[136:139], v[32:35], v[48:51], v[136:139]
    s_add_u32 m0, m0, 4096
    s_add_u32 s34, s30, 4096
    buffer_load_dwordx4 v1, s[8:11], s34 offen sc1 lds
    v_mfma_f32_16x16x32_bf16 v[140:143], v[32:35], v[52:55], v[140:143]
    v_mfma_f32_16x16x32_bf16 v[128:131], v[36:39], v[72:75], v[128:131]
    v_mfma_f32_16x16x32_bf16 v[132:135], v[36:39], v[40:43], v[132:135]
    v_mfma_f32_16x16x32_bf16 v[136:139], v[36:39], v[76:79], v[136:139]
    s_add_u32 m0, s29, s37
    s_add_u32 s30, s30, 21376
    buffer_load_dwordx4 v1, s[12:15], s31 offen sc1 lds
    v_mfma_f32_16x16x32_bf16 v[140:143], v[36:39], v[48:51], v[140:143]
    s_waitcnt lgkmcnt(4)
    v_mfma_f32_16x16x32_bf16 v[144:147], v[8:11], v[40:43], v[144:147]
    ds_read_b128 v[32:35], v2 offset:14336
    v_mfma_f32_16x16x32_bf16 v[148:151], v[8:11], v[44:47], v[148:151]
    ds_read_b128 v[36:39], v3 offset:14336
    v_mfma_f32_16x16x32_bf16 v[152:155], v[8:11], v[48:51], v[152:155]
    v_mfma_f32_16x16x32_bf16 v[156:159], v[8:11], v[52:55], v[156:159]
    v_mfma_f32_16x16x32_bf16 v[144:147], v[12:15], v[72:75], v[144:147]
    buffer_load_dwordx4 v1, s[12:15], s31 offen offset:1024 sc1 lds
    v_mfma_f32_16x16x32_bf16 v[148:151], v[12:15], v[40:43], v[148:151]
    v_mfma_f32_16x16x32_bf16 v[152:155], v[12:15], v[76:79], v[152:155]
    v_mfma_f32_16x16x32_bf16 v[156:159], v[12:15], v[48:51], v[156:159]
    s_waitcnt lgkmcnt(4)
    v_mfma_f32_16x16x32_bf16 v[160:163], v[16:19], v[40:43], v[160:163]
    ds_read_b128 v[8:11], v2 offset:16384
    v_mfma_f32_16x16x32_bf16 v[164:167], v[16:19], v[44:47], v[164:167]
    ds_read_b128 v[12:15], v3 offset:16384
    v_mfma_f32_16x16x32_bf16 v[168:171], v[16:19], v[48:51], v[168:171]
    buffer_load_dwordx4 v1, s[12:15], s31 offen offset:2048 sc1 lds
    v_mfma_f32_16x16x32_bf16 v[172:175], v[16:19], v[52:55], v[172:175]
    s_add_u32 s40, s40, 1
    s_mov_b32 s51, s40
    v_mov_b32 v0, s40
    v_mfma_f32_16x16x32_bf16 v[160:163], v[20:23], v[72:75], v[160:163]
    s_waitcnt vmcnt(19)
    ds_write_b32 v7, v0
    v_mfma_f32_16x16x32_bf16 v[164:167], v[20:23], v[40:43], v[164:167]
    v_mfma_f32_16x16x32_bf16 v[168:171], v[20:23], v[76:79], v[168:171]
    buffer_load_dwordx4 v1, s[12:15], s31 offen offset:3072 sc1 lds
    v_mfma_f32_16x16x32_bf16 v[172:175], v[20:23], v[48:51], v[172:175]
    s_waitcnt lgkmcnt(5)
    v_mfma_f32_16x16x32_bf16 v[176:179], v[24:27], v[40:43], v[176:179]
    ds_read_b128 v[16:19], v2 offset:18432
    v_mfma_f32_16x16x32_bf16 v[180:183], v[24:27], v[44:47], v[180:183]
    ds_read_b128 v[20:23], v3 offset:18432
    v_mov_b32 v0, s48
    v_mfma_f32_16x16x32_bf16 v[184:187], v[24:27], v[48:51], v[184:187]
    ds_read_b32 v0, v0
    v_mfma_f32_16x16x32_bf16 v[188:191], v[24:27], v[52:55], v[188:191]
    v_mfma_f32_16x16x32_bf16 v[176:179], v[28:31], v[72:75], v[176:179]
    s_add_u32 m0, s29, s38
    s_mov_b64 exec, s[44:45]
    buffer_load_dwordx4 v1, s[64:67], s33 offen sc1 lds
    s_mov_b64 exec, -1
    s_add_u32 s31, s31, 16384
    s_add_u32 s33, s33, 21376
    v_mfma_f32_16x16x32_bf16 v[180:183], v[28:31], v[40:43], v[180:183]
    v_mfma_f32_16x16x32_bf16 v[184:187], v[28:31], v[76:79], v[184:187]
    v_mfma_f32_16x16x32_bf16 v[188:191], v[28:31], v[48:51], v[188:191]
    s_waitcnt lgkmcnt(0)
    v_cmp_eq_u32 vcc, 0, v0
    v_mfma_f32_16x16x32_bf16 v[192:195], v[32:35], v[40:43], v[192:195]
    ds_read_b128 v[24:27], v2 offset:20480
    v_mfma_f32_16x16x32_bf16 v[196:199], v[32:35], v[44:47], v[196:199]
    ds_read_b128 v[28:31], v3 offset:20480
    s_cbranch_vccnz K12_F2
K12_G2:
    v_mfma_f32_16x16x32_bf16 v[200:203], v[32:35], v[48:51], v[200:203]
    s_sub_u32 s43, s42, s41
    s_add_u32 s40, s40, 1
    v_add_u32 v2, s43, v2
    v_mfma_f32_16x16x32_bf16 v[204:207], v[32:35], v[52:55], v[204:207]
    v_add_u32 v3, s43, v3
    v_add_u32 v4, s43, v4
    v_mov_b32 v0, s40
    v_mfma_f32_16x16x32_bf16 v[192:195], v[36:39], v[72:75], v[192:195]
    ds_write_b32 v7, v0
    v_mfma_f32_16x16x32_bf16 v[196:199], v[36:39], v[40:43], v[196:199]
    v_mfma_f32_16x16x32_bf16 v[200:203], v[36:39], v[76:79], v[200:203]
    v_mfma_f32_16x16x32_bf16 v[204:207], v[36:39], v[48:51], v[204:207]
    ds_read_b32 v56, v5
    v_mfma_f32_16x16x32_bf16 v[208:211], v[8:11], v[40:43], v[208:211]
    v_mfma_f32_16x16x32_bf16 v[212:215], v[8:11], v[44:47], v[212:215]
    v_mfma_f32_16x16x32_bf16 v[216:219], v[8:11], v[48:51], v[216:219]
    v_mfma_f32_16x16x32_bf16 v[220:223], v[8:11], v[52:55], v[220:223]
    s_waitcnt lgkmcnt(0)
    v_cmp_gt_u32 vcc, s51, v56
    v_mfma_f32_16x16x32_bf16 v[208:211], v[12:15], v[72:75], v[208:211]
    v_mfma_f32_16x16x32_bf16 v[212:215], v[12:15], v[40:43], v[212:215]
    s_cbranch_vccnz K12_S3
K12_Q3:
    v_mfma_f32_16x16x32_bf16 v[216:219], v[12:15], v[76:79], v[216:219]
    ds_read_b64_tr_b16 v[56:57], v4 offset:0
    v_mfma_f32_16x16x32_bf16 v[220:223], v[12:15], v[48:51], v[220:223]
    ds_read_b64_tr_b16 v[58:59], v4 offset:2048
    v_mfma_f32_16x16x32_bf16 v[224:227], v[16:19], v[40:43], v[224:227]
    ds_read_b64_tr_b16 v[60:61], v4 offset:256
    ds_read_b128 v[8:11], v2 offset:0
    v_mfma_f32_16x16x32_bf16 v[228:231], v[16:19], v[44:47], v[228:231]
    ds_read_b64_tr_b16 v[62:63], v4 offset:2304
    ds_read_b128 v[12:15], v3 offset:0
    v_mfma_f32_16x16x32_bf16 v[232:235], v[16:19], v[48:51], v[232:235]
    v_xor_b32 v4, 32, v4
    ds_read_b128 v[32:35], v2 offset:6144
    v_mfma_f32_16x16x32_bf16 v[236:239], v[16:19], v[52:55], v[236:239]
    ds_read_b64_tr_b16 v[64:65], v4 offset:0
    ds_read_b128 v[36:39], v3 offset:6144
    v_mfma_f32_16x16x32_bf16 v[224:227], v[20:23], v[72:75], v[224:227]
    ds_read_b64_tr_b16 v[66:67], v4 offset:2048
    ds_read_b32 v52, v5
    v_mfma_f32_16x16x32_bf16 v[228:231], v[20:23], v[40:43], v[228:231]
    ds_read_b64_tr_b16 v[68:69], v4 offset:256
    ds_read_b64_tr_b16 v[70:71], v4 offset:2304
    v_xor_b32 v4, 32, v4
    v_mfma_f32_16x16x32_bf16 v[232:235], v[20:23], v[76:79], v[232:235]
    v_mfma_f32_16x16x32_bf16 v[236:239], v[20:23], v[48:51], v[236:239]
    v_mfma_f32_16x16x32_bf16 v[240:243], v[24:27], v[40:43], v[240:243]
    ds_read_b128 v[16:19], v2 offset:2048
    v_mfma_f32_16x16x32_bf16 v[244:247], v[24:27], v[44:47], v[244:247]
    ds_read_b128 v[20:23], v3 offset:2048
    v_mfma_f32_16x16x32_bf16 v[240:243], v[28:31], v[72:75], v[240:243]
    s_mov_b32 s29, s41
    s_mov_b32 s41, s42
    s_add_u32 s42, s42, 38912
    v_mfma_f32_16x16x32_bf16 v[244:247], v[28:31], v[40:43], v[244:247]
    s_cmp_eq_u32 s42, 155648
    s_cselect_b32 s42, 0, s42
    s_waitcnt lgkmcnt(2)
    v_mfma_f32_16x16x32_bf16 v[80:83], v[8:11], v[56:59], v[80:83]
    ds_read_b128 v[24:27], v2 offset:4096
    v_xor_b32 v72, s35, v60
    v_xor_b32 v73, s35, v61
    v_mfma_f32_16x16x32_bf16 v[84:87], v[8:11], v[60:63], v[84:87]
    ds_read_b128 v[28:31], v3 offset:4096
    v_xor_b32 v74, s35, v62
    v_xor_b32 v75, s35, v63
    v_mfma_f32_16x16x32_bf16 v[88:91], v[8:11], v[64:67], v[88:91]
    s_waitcnt lgkmcnt(2)
    v_cmp_gt_u32 vcc, s40, v52
    v_xor_b32 v76, s35, v68
    v_xor_b32 v77, s35, v69
    v_mfma_f32_16x16x32_bf16 v[92:95], v[8:11], v[68:71], v[92:95]
    s_cbranch_vccnz K12_S4
K12_Q4:
    v_xor_b32 v78, s35, v70
    v_xor_b32 v79, s35, v71
    v_mfma_f32_16x16x32_bf16 v[80:83], v[12:15], v[72:75], v[80:83]
    s_add_u32 m0, s29, s36
    s_nop 0
    buffer_load_dwordx4 v1, s[8:11], s30 offen sc1 lds
    v_mfma_f32_16x16x32_bf16 v[84:87], v[12:15], v[56:59], v[84:87]
    v_mfma_f32_16x16x32_bf16 v[88:91], v[12:15], v[76:79], v[88:91]
    v_mfma_f32_16x16x32_bf16 v[92:95], v[12:15], v[64:67], v[92:95]
    v_mfma_f32_16x16x32_bf16 v[96:99], v[16:19], v[56:59], v[96:99]
    ds_read_b128 v[8:11], v2 offset:8192
    v_mfma_f32_16x16x32_bf16 v[100:103], v[16:19], v[60:63], v[100:103]
    ds_read_b128 v[12:15], v3 offset:8192
    v_mfma_f32_16x16x32_bf16 v[104:107], v[16:19], v[64:67], v[104:107]
    buffer_load_dwordx4 v1, s[8:11], s30 offen offset:1024 sc1 lds
    v_mfma_f32_16x16x32_bf16 v[108:111], v[16:19], v[68:71], v[108:111]
    v_mfma_f32_16x16x32_bf16 v[96:99], v[20:23], v[72:75], v[96:99]
    v_mfma_f32_16x16x32_bf16 v[100:103], v[20:23], v[56:59], v[100:103]
    v_mfma_f32_16x16x32_bf16 v[104:107], v[20:23], v[76:79], v[104:107]
    buffer_load_dwordx4 v1, s[8:11], s30 offen offset:2048 sc1 lds
    v_mfma_f32_16x16x32_bf16 v[108:111], v[20:23], v[64:67], v[108:111]
    s_waitcnt lgkmcnt(2)
    v_mfma_f32_16x16x32_bf16 v[112:115], v[24:27], v[56:59], v[112:115]
    ds_read_b128 v[16:19], v2 offset:10240
    v_mfma_f32_16x16x32_bf16 v[116:119], v[24:27], v[60:63], v[116:119]
    ds_read_b128 v[20:23], v3 offset:10240
    v_mfma_f32_16x16x32_bf16 v[120:123], v[24:27], v[64:67], v[120:123]
    v_mfma_f32_16x16x32_bf16 v[124:127], v[24:27], v[68:71], v[124:127]
    v_mfma_f32_16x16x32_bf16 v[112:115], v[28:31], v[72:75], v[112:115]
    buffer_load_dwordx4 v1, s[8:11], s30 offen offset:3072 sc1 lds
    v_mfma_f32_16x16x32_bf16 v[116:119], v[28:31], v[56:59], v[116:119]
    v_mfma_f32_16x16x32_bf16 v[120:123], v[28:31], v[76:79], v[120:123]
    v_mfma_f32_16x16x32_bf16 v[124:127], v[28:31], v[64:67], v[124:127]
    v_mfma_f32_16x16x32_bf16 v[128:131], v[32:35], v[56:59], v[128:131]
    ds_read_b128 v[24:27], v2 offset:12288
    v_mfma_f32_16x16x32_bf16 v[132:135], v[32:35], v[60:63], v[132:135]
    ds_read_b128 v[28:31], v3 offset:12288
    v_mfma_f32_16x16x32_bf16 v[136:139], v[32:35], v[64:67], v[136:139]
    s_add_u32 m0, m0, 4096
    s_add_u32 s34, s30, 4096
    buffer_load_dwordx4 v1, s[8:11], s34 offen sc1 lds
    v_mfma_f32_16x16x32_bf16 v[140:143], v[32:35], v[68:71], v[140:143]
    v_mfma_f32_16x16x32_bf16 v[128:131], v[36:39], v[72:75], v[128:131]
    v_mfma_f32_16x16x32_bf16 v[132:135], v[36:39], v[56:59], v[132:135]
    v_mfma_f32_16x16x32_bf16 v[136:139], v[36:39], v[76:79], v[136:139]
    s_add_u32 m0, s29, s37
    s_add_u32 s30, s30, 21376
    buffer_load_dwordx4 v1, s[12:15], s31 offen sc1 lds
    v_mfma_f32_16x16x32_bf16 v[140:143], v[36:39], v[64:67], v[140:143]
    s_waitcnt lgkmcnt(4)
    v_mfma_f32_16x16x32_bf16 v[144:147], v[8:11], v[56:59], v[144:147]
    ds_read_b128 v[32:35], v2 offset:14336
    v_mfma_f32_16x16x32_bf16 v[148:151], v[8:11], v[60:63], v[148:151]
    ds_read_b128 v[36:39], v3 offset:14336
    v_mfma_f32_16x16x32_bf16 v[152:155], v[8:11], v[64:67], v[152:155]
    v_mfma_f32_16x16x32_bf16 v[156:159], v[8:11], v[68:71], v[156:159]
    v_mfma_f32_16x16x32_bf16 v[144:147], v[12:15], v[72:75], v[144:147]
    buffer_load_dwordx4 v1, s[12:15], s31 offen offset:1024 sc1 lds
    v_mfma_f32_16x16x32_bf16 v[148:151], v[12:15], v[56:59], v[148:151]
    v_mfma_f32_16x16x32_bf16 v[152:155], v[12:15], v[76:79], v[152:155]
    v_mfma_f32_16x16x32_bf16 v[156:159], v[12:15], v[64:67], v[156:159]
    s_waitcnt lgkmcnt(4)
    v_mfma_f32_16x16x32_bf16 v[160:163], v[16:19], v[56:59], v[160:163]
    ds_read_b128 v[8:11], v2 offset:16384
    v_mfma_f32_16x16x32_bf16 v[164:167], v[16:19], v[60:63], v[164:167]
    ds_read_b128 v[12:15], v3 offset:16384
    v_mfma_f32_16x16x32_bf16 v[168:171], v[16:19], v[64:67], v[168:171]
    buffer_load_dwordx4 v1, s[12:15], s31 offen offset:2048 sc1 lds
    v_mfma_f32_16x16x32_bf16 v[172:175], v[16:19], v[68:71], v[172:175]
    s_add_u32 s40, s40, 1
    s_mov_b32 s51, s40
    v_mov_b32 v0, s40
    v_mfma_f32_16x16x32_bf16 v[160:163], v[20:23], v[72:75], v[160:163]
    s_waitcnt vmcnt(19)
    ds_write_b32 v7, v0
    v_mfma_f32_16x16x32_bf16 v[164:167], v[20:23], v[56:59], v[164:167]
    v_mfma_f32_16x16x32_bf16 v[168:171], v[20:23], v[76:79], v[168:171]
    buffer_load_dwordx4 v1, s[12:15], s31 offen offset:3072 sc1 lds
    v_mfma_f32_16x16x32_bf16 v[172:175], v[20:23], v[64:67], v[172:175]
    s_waitcnt lgkmcnt(5)
    v_mfma_f32_16x16x32_bf16 v[176:179], v[24:27], v[56:59], v[176:179]
    ds_read_b128 v[16:19], v2 offset:18432
    v_mfma_f32_16x16x32_bf16 v[180:183], v[24:27], v[60:63], v[180:183]
    ds_read_b128 v[20:23], v3 offset:18432
    v_mfma_f32_16x16x32_bf16 v[184:187], v[24:27], v[64:67], v[184:187]
    v_mfma_f32_16x16x32_bf16 v[188:191], v[24:27], v[68:71], v[188:191]
    v_mfma_f32_16x16x32_bf16 v[176:179], v[28:31], v[72:75], v[176:179]
    s_add_u32 m0, s29, s38
    s_mov_b64 exec, s[44:45]
    buffer_load_dwordx4 v1, s[64:67], s33 offen sc1 lds
    s_mov_b64 exec, -1
    s_add_u32 s31, s31, 16384
    s_add_u32 s33, s33, 21376
    v_mfma_f32_16x16x32_bf16 v[180:183], v[28:31], v[56:59], v[180:183]
    v_mfma_f32_16x16x32_bf16 v[184:187], v[28:31], v[76:79], v[184:187]
    s_mov_b32 m0, s46
    s_mov_b64 exec, 0xff
    buffer_load_dword v1, s[4:7], 0 offen sc1 lds
    s_mov_b64 exec, -1
    v_mfma_f32_16x16x32_bf16 v[188:191], v[28:31], v[64:67], v[188:191]
    s_waitcnt lgkmcnt(5)
    v_mfma_f32_16x16x32_bf16 v[192:195], v[32:35], v[56:59], v[192:195]
    ds_read_b128 v[24:27], v2 offset:20480
    v_mfma_f32_16x16x32_bf16 v[196:199], v[32:35], v[60:63], v[196:199]
    ds_read_b128 v[28:31], v3 offset:20480
    v_mfma_f32_16x16x32_bf16 v[200:203], v[32:35], v[64:67], v[200:203]
    s_sub_u32 s43, s42, s41
    s_add_u32 s40, s40, 1
    v_add_u32 v2, s43, v2
    v_mfma_f32_16x16x32_bf16 v[204:207], v[32:35], v[68:71], v[204:207]
    v_add_u32 v3, s43, v3
    v_add_u32 v4, s43, v4
    v_mov_b32 v0, s40
    v_mfma_f32_16x16x32_bf16 v[192:195], v[36:39], v[72:75], v[192:195]
    ds_write_b32 v7, v0
    v_mfma_f32_16x16x32_bf16 v[196:199], v[36:39], v[56:59], v[196:199]
    v_mfma_f32_16x16x32_bf16 v[200:203], v[36:39], v[76:79], v[200:203]
    v_mfma_f32_16x16x32_bf16 v[204:207], v[36:39], v[64:67], v[204:207]
    ds_read_b32 v40, v5
    s_waitcnt lgkmcnt(7)
    v_mfma_f32_16x16x32_bf16 v[208:211], v[8:11], v[56:59], v[208:211]
    v_mfma_f32_16x16x32_bf16 v[212:215], v[8:11], v[60:63], v[212:215]
    v_mfma_f32_16x16x32_bf16 v[216:219], v[8:11], v[64:67], v[216:219]
    v_mfma_f32_16x16x32_bf16 v[220:223], v[8:11], v[68:71], v[220:223]
    s_waitcnt lgkmcnt(0)
    v_cmp_gt_u32 vcc, s51, v40
    v_mfma_f32_16x16x32_bf16 v[208:211], v[12:15], v[72:75], v[208:211]
    v_mfma_f32_16x16x32_bf16 v[212:215], v[12:15], v[56:59], v[212:215]
    s_cbranch_vccnz K12_S5
K12_Q5:
    v_mfma_f32_16x16x32_bf16 v[216:219], v[12:15], v[76:79], v[216:219]
    ds_read_b64_tr_b16 v[40:41], v4 offset:0
    v_mfma_f32_16x16x32_bf16 v[220:223], v[12:15], v[64:67], v[220:223]
    ds_read_b64_tr_b16 v[42:43], v4 offset:2048
    v_mfma_f32_16x16x32_bf16 v[224:227], v[16:19], v[56:59], v[224:227]
    ds_read_b64_tr_b16 v[44:45], v4 offset:256
    ds_read_b128 v[8:11], v2 offset:0
    v_mfma_f32_16x16x32_bf16 v[228:231], v[16:19], v[60:63], v[228:231]
    ds_read_b64_tr_b16 v[46:47], v4 offset:2304
    ds_read_b128 v[12:15], v3 offset:0
    v_mfma_f32_16x16x32_bf16 v[232:235], v[16:19], v[64:67], v[232:235]
    v_xor_b32 v4, 32, v4
    ds_read_b128 v[32:35], v2 offset:6144
    v_mfma_f32_16x16x32_bf16 v[236:239], v[16:19], v[68:71], v[236:239]
    ds_read_b64_tr_b16 v[48:49], v4 offset:0
    ds_read_b128 v[36:39], v3 offset:6144
    v_mfma_f32_16x16x32_bf16 v[224:227], v[20:23], v[72:75], v[224:227]
    ds_read_b64_tr_b16 v[50:51], v4 offset:2048
    ds_read_b32 v68, v5
    v_mfma_f32_16x16x32_bf16 v[228:231], v[20:23], v[56:59], v[228:231]
    ds_read_b64_tr_b16 v[52:53], v4 offset:256
    ds_read_b64_tr_b16 v[54:55], v4 offset:2304
    v_xor_b32 v4, 32, v4
    v_mfma_f32_16x16x32_bf16 v[232:235], v[20:23], v[76:79], v[232:235]
    v_mfma_f32_16x16x32_bf16 v[236:239], v[20:23], v[64:67], v[236:239]
    v_mfma_f32_16x16x32_bf16 v[240:243], v[24:27], v[56:59], v[240:243]
    ds_read_b128 v[16:19], v2 offset:2048
    v_mfma_f32_16x16x32_bf16 v[244:247], v[24:27], v[60:63], v[244:247]
    ds_read_b128 v[20:23], v3 offset:2048
    v_mfma_f32_16x16x32_bf16 v[240:243], v[28:31], v[72:75], v[240:243]
    s_mov_b32 s29, s41
    s_mov_b32 s41, s42
    s_add_u32 s42, s42, 38912
    v_mfma_f32_16x16x32_bf16 v[244:247], v[28:31], v[56:59], v[244:247]
    s_cmp_eq_u32 s42, 155648
    s_cselect_b32 s42, 0, s42
    s_add_u32 s39, s39, 1
    s_cmp_lt_u32 s39, 15
    s_cbranch_scc1 K12_LOOP
    s_waitcnt lgkmcnt(2)
    v_mfma_f32_16x16x32_bf16 v[80:83], v[8:11], v[40:43], v[80:83]
    ds_read_b128 v[24:27], v2 offset:4096
    v_xor_b32 v72, s35, v44
    v_xor_b32 v73, s35, v45
    v_mfma_f32_16x16x32_bf16 v[84:87], v[8:11], v[44:47], v[84:87]
    ds_read_b128 v[28:31], v3 offset:4096
    v_xor_b32 v74, s35, v46
    v_xor_b32 v75, s35, v47
    v_mfma_f32_16x16x32_bf16 v[88:91], v[8:11], v[48:51], v[88:91]
    s_waitcnt lgkmcnt(2)
    v_cmp_gt_u32 vcc, s40, v68
    s_add_u32 s49, s39, 2
    s_lshr_b32 s49, s49, 1
    v_xor_b32 v76, s35, v52
    v_xor_b32 v77, s35, v53
    v_mfma_f32_16x16x32_bf16 v[92:95], v[8:11], v[52:55], v[92:95]
    s_cbranch_vccnz K12_S6
K12_Q6:
    s_mul_i32 s48, s49, s50
    s_add_u32 s48, s48, s47
    v_xor_b32 v78, s35, v54
    v_xor_b32 v79, s35, v55
    v_mfma_f32_16x16x32_bf16 v[80:83], v[12:15], v[72:75], v[80:83]
    s_add_u32 m0, s29, s36
    s_nop 0
    buffer_load_dwordx4 v1, s[8:11], s30 offen sc1 lds
    v_mfma_f32_16x16x32_bf16 v[84:87], v[12:15], v[40:43], v[84:87]
    s_cmp_lt_u32 s49, 8
    s_cselect_b32 s48, s48, 155744
    v_mfma_f32_16x16x32_bf16 v[88:91], v[12:15], v[76:79], v[88:91]
    s_cmp_ge_u32 s49, 3
    s_cselect_b32 s48, s48, 155744
    v_mfma_f32_16x16x32_bf16 v[92:95], v[12:15], v[48:51], v[92:95]
    v_mfma_f32_16x16x32_bf16 v[96:99], v[16:19], v[40:43], v[96:99]
    ds_read_b128 v[8:11], v2 offset:8192
    v_mfma_f32_16x16x32_bf16 v[100:103], v[16:19], v[44:47], v[100:103]
    ds_read_b128 v[12:15], v3 offset:8192
    v_mfma_f32_16x16x32_bf16 v[104:107], v[16:19], v[48:51], v[104:107]
    buffer_load_dwordx4 v1, s[8:11], s30 offen offset:1024 sc1 lds
    v_mfma_f32_16x16x32_bf16 v[108:111], v[16:19], v[52:55], v[108:111]
    v_mfma_f32_16x16x32_bf16 v[96:99], v[20:23], v[72:75], v[96:99]
    v_mfma_f32_16x16x32_bf16 v[100:103], v[20:23], v[40:43], v[100:103]
    v_mfma_f32_16x16x32_bf16 v[104:107], v[20:23], v[76:79], v[104:107]
    buffer_load_dwordx4 v1, s[8:11], s30 offen offset:2048 sc1 lds
    v_mfma_f32_16x16x32_bf16 v[108:111], v[20:23], v[48:51], v[108:111]
    s_waitcnt lgkmcnt(2)
    v_mfma_f32_16x16x32_bf16 v[112:115], v[24:27], v[40:43], v[112:115]
    ds_read_b128 v[16:19], v2 offset:10240
    v_mfma_f32_16x16x32_bf16 v[116:119], v[24:27], v[44:47], v[116:119]
    ds_read_b128 v[20:23], v3 offset:10240
    v_mfma_f32_16x16x32_bf16 v[120:123], v[24:27], v[48:51], v[120:123]
    v_mfma_f32_16x16x32_bf16 v[124:127], v[24:27], v[52:55], v[124:127]
    v_mfma_f32_16x16x32_bf16 v[112:115], v[28:31], v[72:75], v[112:115]
    buffer_load_dwordx4 v1, s[8:11], s30 offen offset:3072 sc1 lds
    v_mfma_f32_16x16x32_bf16 v[116:119], v[28:31], v[40:43], v[116:119]
    v_mfma_f32_16x16x32_bf16 v[120:123], v[28:31], v[76:79], v[120:123]
    v_mfma_f32_16x16x32_bf16 v[124:127], v[28:31], v[48:51], v[124:127]
    v_mfma_f32_16x16x32_bf16 v[128:131], v[32:35], v[40:43], v[128:131]
    ds_read_b128 v[24:27], v2 offset:12288
    v_mfma_f32_16x16x32_bf16 v[132:135], v[32:35], v[44:47], v[132:135]
    ds_read_b128 v[28:31], v3 offset:12288
    v_mfma_f32_16x16x32_bf16 v[136:139], v[32:35], v[48:51], v[136:139]
    s_add_u32 m0, m0, 4096
    s_add_u32 s34, s30, 4096
    buffer_load_dwordx4 v1, s[8:11], s34 offen sc1 lds
    v_mfma_f32_16x16x32_bf16 v[140:143], v[32:35], v[52:55], v[140:143]
    v_mfma_f32_16x16x32_bf16 v[128:131], v[36:39], v[72:75], v[128:131]
    v_mfma_f32_16x16x32_bf16 v[132:135], v[36:39], v[40:43], v[132:135]
    v_mfma_f32_16x16x32_bf16 v[136:139], v[36:39], v[76:79], v[136:139]
    s_add_u32 m0, s29, s37
    s_add_u32 s30, s30, 21376
    buffer_load_dwordx4 v1, s[12:15], s31 offen sc1 lds
    v_mfma_f32_16x16x32_bf16 v[140:143], v[36:39], v[48:51], v[140:143]
    s_waitcnt lgkmcnt(4)
    v_mfma_f32_16x16x32_bf16 v[144:147], v[8:11], v[40:43], v[144:147]
    ds_read_b128 v[32:35], v2 offset:14336
    v_mfma_f32_16x16x32_bf16 v[148:151], v[8:11], v[44:47], v[148:151]
    ds_read_b128 v[36:39], v3 offset:14336
    v_mfma_f32_16x16x32_bf16 v[152:155], v[8:11], v[48:51], v[152:155]
    v_mfma_f32_16x16x32_bf16 v[156:159], v[8:11], v[52:55], v[156:159]
    v_mfma_f32_16x16x32_bf16 v[144:147], v[12:15], v[72:75], v[144:147]
    buffer_load_dwordx4 v1, s[12:15], s31 offen offset:1024 sc1 lds
    v_mfma_f32_16x16x32_bf16 v[148:151], v[12:15], v[40:43], v[148:151]
    v_mfma_f32_16x16x32_bf16 v[152:155], v[12:15], v[76:79], v[152:155]
    v_mfma_f32_16x16x32_bf16 v[156:159], v[12:15], v[48:51], v[156:159]
    s_waitcnt lgkmcnt(4)
    v_mfma_f32_16x16x32_bf16 v[160:163], v[16:19], v[40:43], v[160:163]
    ds_read_b128 v[8:11], v2 offset:16384
    v_mfma_f32_16x16x32_bf16 v[164:167], v[16:19], v[44:47], v[164:167]
    ds_read_b128 v[12:15], v3 offset:16384
    v_mfma_f32_16x16x32_bf16 v[168:171], v[16:19], v[48:51], v[168:171]
    buffer_load_dwordx4 v1, s[12:15], s31 offen offset:2048 sc1 lds
    v_mfma_f32_16x16x32_bf16 v[172:175], v[16:19], v[52:55], v[172:175]
    s_add_u32 s40, s40, 1
    s_mov_b32 s51, s40
    v_mov_b32 v0, s40
    v_mfma_f32_16x16x32_bf16 v[160:163], v[20:23], v[72:75], v[160:163]
    s_waitcnt vmcnt(19)
    ds_write_b32 v7, v0
    v_mfma_f32_16x16x32_bf16 v[164:167], v[20:23], v[40:43], v[164:167]
    v_mfma_f32_16x16x32_bf16 v[168:171], v[20:23], v[76:79], v[168:171]
    buffer_load_dwordx4 v1, s[12:15], s31 offen offset:3072 sc1 lds
    v_mfma_f32_16x16x32_bf16 v[172:175], v[20:23], v[48:51], v[172:175]
    s_waitcnt lgkmcnt(5)
    v_mfma_f32_16x16x32_bf16 v[176:179], v[24:27], v[40:43], v[176:179]
    ds_read_b128 v[16:19], v2 offset:18432
    v_mfma_f32_16x16x32_bf16 v[180:183], v[24:27], v[44:47], v[180:183]
    ds_read_b128 v[20:23], v3 offset:18432
    v_mov_b32 v0, s48
    v_mfma_f32_16x16x32_bf16 v[184:187], v[24:27], v[48:51], v[184:187]
    ds_read_b32 v0, v0
    v_mfma_f32_16x16x32_bf16 v[188:191], v[24:27], v[52:55], v[188:191]
    v_mfma_f32_16x16x32_bf16 v[176:179], v[28:31], v[72:75], v[176:179]
    s_add_u32 m0, s29, s38
    s_mov_b64 exec, s[44:45]
    buffer_load_dwordx4 v1, s[64:67], s33 offen sc1 lds
    s_mov_b64 exec, -1
    s_add_u32 s31, s31, 16384
    s_add_u32 s33, s33, 21376
    v_mfma_f32_16x16x32_bf16 v[180:183], v[28:31], v[40:43], v[180:183]
    v_mfma_f32_16x16x32_bf16 v[184:187], v[28:31], v[76:79], v[184:187]
    v_mfma_f32_16x16x32_bf16 v[188:191], v[28:31], v[48:51], v[188:191]
    s_waitcnt lgkmcnt(0)
    v_cmp_eq_u32 vcc, 0, v0
    v_mfma_f32_16x16x32_bf16 v[192:195], v[32:35], v[40:43], v[192:195]
    ds_read_b128 v[24:27], v2 offset:20480
    v_mfma_f32_16x16x32_bf16 v[196:199], v[32:35], v[44:47], v[196:199]
    ds_read_b128 v[28:31], v3 offset:20480
    s_cbranch_vccnz K12_F7
K12_G7:
    v_mfma_f32_16x16x32_bf16 v[200:203], v[32:35], v[48:51], v[200:203]
    s_sub_u32 s43, s42, s41
    s_add_u32 s40, s40, 1
    v_add_u32 v2, s43, v2
    v_mfma_f32_16x16x32_bf16 v[204:207], v[32:35], v[52:55], v[204:207]
    v_add_u32 v3, s43, v3
    v_add_u32 v4, s43, v4
    v_mov_b32 v0, s40
    v_mfma_f32_16x16x32_bf16 v[192:195], v[36:39], v[72:75], v[192:195]
    ds_write_b32 v7, v0
    v_mfma_f32_16x16x32_bf16 v[196:199], v[36:39], v[40:43], v[196:199]
    v_mfma_f32_16x16x32_bf16 v[200:203], v[36:39], v[76:79], v[200:203]
    v_mfma_f32_16x16x32_bf16 v[204:207], v[36:39], v[48:51], v[204:207]
    ds_read_b32 v56, v5
    v_mfma_f32_16x16x32_bf16 v[208:211], v[8:11], v[40:43], v[208:211]
    v_mfma_f32_16x16x32_bf16 v[212:215], v[8:11], v[44:47], v[212:215]
    v_mfma_f32_16x16x32_bf16 v[216:219], v[8:11], v[48:51], v[216:219]
    v_mfma_f32_16x16x32_bf16 v[220:223], v[8:11], v[52:55], v[220:223]
    s_waitcnt lgkmcnt(0)
    v_cmp_gt_u32 vcc, s51, v56
    v_mfma_f32_16x16x32_bf16 v[208:211], v[12:15], v[72:75], v[208:211]
    v_mfma_f32_16x16x32_bf16 v[212:215], v[12:15], v[40:43], v[212:215]
    s_cbranch_vccnz K12_S8
K12_Q8:
    v_mfma_f32_16x16x32_bf16 v[216:219], v[12:15], v[76:79], v[216:219]
    ds_read_b64_tr_b16 v[56:57], v4 offset:0
    v_mfma_f32_16x16x32_bf16 v[220:223], v[12:15], v[48:51], v[220:223]
    ds_read_b64_tr_b16 v[58:59], v4 offset:2048
    v_mfma_f32_16x16x32_bf16 v[224:227], v[16:19], v[40:43], v[224:227]
    ds_read_b64_tr_b16 v[60:61], v4 offset:256
    ds_read_b128 v[8:11], v2 offset:0
    v_mfma_f32_16x16x32_bf16 v[228:231], v[16:19], v[44:47], v[228:231]
    ds_read_b64_tr_b16 v[62:63], v4 offset:2304
    ds_read_b128 v[12:15], v3 offset:0
    v_mfma_f32_16x16x32_bf16 v[232:235], v[16:19], v[48:51], v[232:235]
    v_xor_b32 v4, 32, v4
    ds_read_b128 v[32:35], v2 offset:6144
    v_mfma_f32_16x16x32_bf16 v[236:239], v[16:19], v[52:55], v[236:239]
    ds_read_b64_tr_b16 v[64:65], v4 offset:0
    ds_read_b128 v[36:39], v3 offset:6144
    v_mfma_f32_16x16x32_bf16 v[224:227], v[20:23], v[72:75], v[224:227]
    ds_read_b64_tr_b16 v[66:67], v4 offset:2048
    ds_read_b32 v52, v5
    v_mfma_f32_16x16x32_bf16 v[228:231], v[20:23], v[40:43], v[228:231]
    ds_read_b64_tr_b16 v[68:69], v4 offset:256
    ds_read_b64_tr_b16 v[70:71], v4 offset:2304
    v_xor_b32 v4, 32, v4
    v_mfma_f32_16x16x32_bf16 v[232:235], v[20:23], v[76:79], v[232:235]
    v_mfma_f32_16x16x32_bf16 v[236:239], v[20:23], v[48:51], v[236:239]
    v_mfma_f32_16x16x32_bf16 v[240:243], v[24:27], v[40:43], v[240:243]
    ds_read_b128 v[16:19], v2 offset:2048
    v_mfma_f32_16x16x32_bf16 v[244:247], v[24:27], v[44:47], v[244:247]
    ds_read_b128 v[20:23], v3 offset:2048
    v_mfma_f32_16x16x32_bf16 v[240:243], v[28:31], v[72:75], v[240:243]
    s_mov_b32 s29, s41
    s_mov_b32 s41, s42
    s_add_u32 s42, s42, 38912
    v_mfma_f32_16x16x32_bf16 v[244:247], v[28:31], v[40:43], v[244:247]
    s_cmp_eq_u32 s42, 155648
    s_cselect_b32 s42, 0, s42
    s_waitcnt lgkmcnt(2)
    v_mfma_f32_16x16x32_bf16 v[80:83], v[8:11], v[56:59], v[80:83]
    ds_read_b128 v[24:27], v2 offset:4096
    v_xor_b32 v72, s35, v60
    v_xor_b32 v73, s35, v61
    v_mfma_f32_16x16x32_bf16 v[84:87], v[8:11], v[60:63], v[84:87]
    ds_read_b128 v[28:31], v3 offset:4096
    v_xor_b32 v74, s35, v62
    v_xor_b32 v75, s35, v63
    v_mfma_f32_16x16x32_bf16 v[88:91], v[8:11], v[64:67], v[88:91]
    v_xor_b32 v76, s35, v68
    v_xor_b32 v77, s35, v69
    v_mfma_f32_16x16x32_bf16 v[92:95], v[8:11], v[68:71], v[92:95]
    v_xor_b32 v78, s35, v70
    v_xor_b32 v79, s35, v71
    v_mfma_f32_16x16x32_bf16 v[80:83], v[12:15], v[72:75], v[80:83]
    v_lshrrev_b32 v0, 4, v1
    v_and_b32 v5, 15, v0
    v_mfma_f32_16x16x32_bf16 v[84:87], v[12:15], v[56:59], v[84:87]
    v_lshrrev_b32 v0, 4, v0
    s_lshl_b32 s28, s21, 7
    v_mfma_f32_16x16x32_bf16 v[88:91], v[12:15], v[76:79], v[88:91]
    s_lshl_b32 s29, s3, 5
    s_add_u32 s28, s28, s29
    v_mfma_f32_16x16x32_bf16 v[92:95], v[12:15], v[64:67], v[92:95]
    v_add_u32 v5, s28, v5
    v_lshlrev_b32 v5, 2, v5
    s_waitcnt lgkmcnt(2)
    v_mfma_f32_16x16x32_bf16 v[96:99], v[16:19], v[56:59], v[96:99]
    ds_read_b128 v[8:11], v2 offset:8192
    v_lshl_add_u32 v5, v0, 13, v5
    s_lshl_b32 s28, s20, 6
    v_mfma_f32_16x16x32_bf16 v[100:103], v[16:19], v[60:63], v[100:103]
    ds_read_b128 v[12:15], v3 offset:8192
    v_xor_b32 v5, s28, v5
    v_xor_b32 v7, 64, v5
    v_mfma_f32_16x16x32_bf16 v[104:107], v[16:19], v[64:67], v[104:107]
    v_mfma_f32_16x16x32_bf16 v[108:111], v[16:19], v[68:71], v[108:111]
    s_mov_b32 s38, 0
    v_cvt_pk_bf16_f32 v48, v80, v84
    buffer_store_dword v48, v5, s[16:19], s38 offen offset:0 sc1
    v_cvt_pk_bf16_f32 v49, v88, v92
    buffer_store_dword v49, v7, s[16:19], s38 offen offset:0 sc1
    v_mfma_f32_16x16x32_bf16 v[96:99], v[20:23], v[72:75], v[96:99]
    v_cvt_pk_bf16_f32 v50, v81, v85
    buffer_store_dword v50, v5, s[16:19], s38 offen offset:2048 sc1
    v_mfma_f32_16x16x32_bf16 v[100:103], v[20:23], v[56:59], v[100:103]
    v_cvt_pk_bf16_f32 v51, v89, v93
    buffer_store_dword v51, v7, s[16:19], s38 offen offset:2048 sc1
    v_mfma_f32_16x16x32_bf16 v[104:107], v[20:23], v[76:79], v[104:107]
    s_mov_b32 s38, 4096
    v_cvt_pk_bf16_f32 v52, v82, v86
    buffer_store_dword v52, v5, s[16:19], s38 offen offset:0 sc1
    v_cvt_pk_bf16_f32 v53, v90, v94
    buffer_store_dword v53, v7, s[16:19], s38 offen offset:0 sc1
    v_mfma_f32_16x16x32_bf16 v[108:111], v[20:23], v[64:67], v[108:111]
    v_cvt_pk_bf16_f32 v54, v83, v87
    buffer_store_dword v54, v5, s[16:19], s38 offen offset:2048 sc1
    s_waitcnt lgkmcnt(2)
    v_mfma_f32_16x16x32_bf16 v[112:115], v[24:27], v[56:59], v[112:115]
    ds_read_b128 v[16:19], v2 offset:10240
    v_cvt_pk_bf16_f32 v55, v91, v95
    buffer_store_dword v55, v7, s[16:19], s38 offen offset:2048 sc1
    v_mfma_f32_16x16x32_bf16 v[116:119], v[24:27], v[60:63], v[116:119]
    ds_read_b128 v[20:23], v3 offset:10240
    v_mfma_f32_16x16x32_bf16 v[120:123], v[24:27], v[64:67], v[120:123]
    v_mfma_f32_16x16x32_bf16 v[124:127], v[24:27], v[68:71], v[124:127]
    s_mov_b32 s38, 32768
    v_cvt_pk_bf16_f32 v40, v96, v100
    buffer_store_dword v40, v5, s[16:19], s38 offen offset:0 sc1
    v_cvt_pk_bf16_f32 v41, v104, v108
    buffer_store_dword v41, v7, s[16:19], s38 offen offset:0 sc1
    v_mfma_f32_16x16x32_bf16 v[112:115], v[28:31], v[72:75], v[112:115]
    v_cvt_pk_bf16_f32 v42, v97, v101
    buffer_store_dword v42, v5, s[16:19], s38 offen offset:2048 sc1
    v_mfma_f32_16x16x32_bf16 v[116:119], v[28:31], v[56:59], v[116:119]
    v_cvt_pk_bf16_f32 v43, v105, v109
    buffer_store_dword v43, v7, s[16:19], s38 offen offset:2048 sc1
    v_mfma_f32_16x16x32_bf16 v[120:123], v[28:31], v[76:79], v[120:123]
    s_mov_b32 s38, 36864
    v_cvt_pk_bf16_f32 v44, v98, v102
    buffer_store_dword v44, v5, s[16:19], s38 offen offset:0 sc1
    v_cvt_pk_bf16_f32 v45, v106, v110
    buffer_store_dword v45, v7, s[16:19], s38 offen offset:0 sc1
    v_mfma_f32_16x16x32_bf16 v[124:127], v[28:31], v[64:67], v[124:127]
    v_cvt_pk_bf16_f32 v46, v99, v103
    buffer_store_dword v46, v5, s[16:19], s38 offen offset:2048 sc1
    v_mfma_f32_16x16x32_bf16 v[128:131], v[32:35], v[56:59], v[128:131]
    ds_read_b128 v[24:27], v2 offset:12288
    v_cvt_pk_bf16_f32 v47, v107, v111
    buffer_store_dword v47, v7, s[16:19], s38 offen offset:2048 sc1
    v_mfma_f32_16x16x32_bf16 v[132:135], v[32:35], v[60:63], v[132:135]
    ds_read_b128 v[28:31], v3 offset:12288
    v_mfma_f32_16x16x32_bf16 v[136:139], v[32:35], v[64:67], v[136:139]
    v_mfma_f32_16x16x32_bf16 v[140:143], v[32:35], v[68:71], v[140:143]
    s_mov_b32 s38, 65536
    v_cvt_pk_bf16_f32 v48, v112, v116
    buffer_store_dword v48, v5, s[16:19], s38 offen offset:0 sc1
    v_cvt_pk_bf16_f32 v49, v120, v124
    buffer_store_dword v49, v7, s[16:19], s38 offen offset:0 sc1
    v_mfma_f32_16x16x32_bf16 v[128:131], v[36:39], v[72:75], v[128:131]
    v_cvt_pk_bf16_f32 v50, v113, v117
    buffer_store_dword v50, v5, s[16:19], s38 offen offset:2048 sc1
    v_mfma_f32_16x16x32_bf16 v[132:135], v[36:39], v[56:59], v[132:135]
    v_cvt_pk_bf16_f32 v51, v121, v125
    buffer_store_dword v51, v7, s[16:19], s38 offen offset:2048 sc1
    v_mfma_f32_16x16x32_bf16 v[136:139], v[36:39], v[76:79], v[136:139]
    s_mov_b32 s38, 69632
    v_cvt_pk_bf16_f32 v52, v114, v118
    buffer_store_dword v52, v5, s[16:19], s38 offen offset:0 sc1
    v_cvt_pk_bf16_f32 v53, v122, v126
    buffer_store_dword v53, v7, s[16:19], s38 offen offset:0 sc1
    v_mfma_f32_16x16x32_bf16 v[140:143], v[36:39], v[64:67], v[140:143]
    v_cvt_pk_bf16_f32 v54, v115, v119
    buffer_store_dword v54, v5, s[16:19], s38 offen offset:2048 sc1
    s_waitcnt lgkmcnt(4)
    v_mfma_f32_16x16x32_bf16 v[144:147], v[8:11], v[56:59], v[144:147]
    ds_read_b128 v[32:35], v2 offset:14336
    v_cvt_pk_bf16_f32 v55, v123, v127
    buffer_store_dword v55, v7, s[16:19], s38 offen offset:2048 sc1
    v_mfma_f32_16x16x32_bf16 v[148:151], v[8:11], v[60:63], v[148:151]
    ds_read_b128 v[36:39], v3 offset:14336
    v_mfma_f32_16x16x32_bf16 v[152:155], v[8:11], v[64:67], v[152:155]
    v_mfma_f32_16x16x32_bf16 v[156:159], v[8:11], v[68:71], v[156:159]
    s_mov_b32 s38, 98304
    v_cvt_pk_bf16_f32 v40, v128, v132
    buffer_store_dword v40, v5, s[16:19], s38 offen offset:0 sc1
    v_cvt_pk_bf16_f32 v41, v136, v140
    buffer_store_dword v41, v7, s[16:19], s38 offen offset:0 sc1
    v_mfma_f32_16x16x32_bf16 v[144:147], v[12:15], v[72:75], v[144:147]
    v_cvt_pk_bf16_f32 v42, v129, v133
    buffer_store_dword v42, v5, s[16:19], s38 offen offset:2048 sc1
    v_mfma_f32_16x16x32_bf16 v[148:151], v[12:15], v[56:59], v[148:151]
    v_cvt_pk_bf16_f32 v43, v137, v141
    buffer_store_dword v43, v7, s[16:19], s38 offen offset:2048 sc1
    v_mfma_f32_16x16x32_bf16 v[152:155], v[12:15], v[76:79], v[152:155]
    s_mov_b32 s38, 102400
    v_cvt_pk_bf16_f32 v44, v130, v134
    buffer_store_dword v44, v5, s[16:19], s38 offen offset:0 sc1
    v_cvt_pk_bf16_f32 v45, v138, v142
    buffer_store_dword v45, v7, s[16:19], s38 offen offset:0 sc1
    v_mfma_f32_16x16x32_bf16 v[156:159], v[12:15], v[64:67], v[156:159]
    v_cvt_pk_bf16_f32 v46, v131, v135
    buffer_store_dword v46, v5, s[16:19], s38 offen offset:2048 sc1
    s_waitcnt lgkmcnt(4)
    v_mfma_f32_16x16x32_bf16 v[160:163], v[16:19], v[56:59], v[160:163]
    ds_read_b128 v[8:11], v2 offset:16384
    v_cvt_pk_bf16_f32 v47, v139, v143
    buffer_store_dword v47, v7, s[16:19], s38 offen offset:2048 sc1
    v_mfma_f32_16x16x32_bf16 v[164:167], v[16:19], v[60:63], v[164:167]
    ds_read_b128 v[12:15], v3 offset:16384
    v_mfma_f32_16x16x32_bf16 v[168:171], v[16:19], v[64:67], v[168:171]
    v_mfma_f32_16x16x32_bf16 v[172:175], v[16:19], v[68:71], v[172:175]
    s_mov_b32 s38, 131072
    v_cvt_pk_bf16_f32 v48, v144, v148
    buffer_store_dword v48, v5, s[16:19], s38 offen offset:0 sc1
    v_cvt_pk_bf16_f32 v49, v152, v156
    buffer_store_dword v49, v7, s[16:19], s38 offen offset:0 sc1
    v_mfma_f32_16x16x32_bf16 v[160:163], v[20:23], v[72:75], v[160:163]
    v_cvt_pk_bf16_f32 v50, v145, v149
    buffer_store_dword v50, v5, s[16:19], s38 offen offset:2048 sc1
    v_mfma_f32_16x16x32_bf16 v[164:167], v[20:23], v[56:59], v[164:167]
    v_cvt_pk_bf16_f32 v51, v153, v157
    buffer_store_dword v51, v7, s[16:19], s38 offen offset:2048 sc1
    v_mfma_f32_16x16x32_bf16 v[168:171], v[20:23], v[76:79], v[168:171]
    s_mov_b32 s38, 135168
    v_cvt_pk_bf16_f32 v52, v146, v150
    buffer_store_dword v52, v5, s[16:19], s38 offen offset:0 sc1
    v_cvt_pk_bf16_f32 v53, v154, v158
    buffer_store_dword v53, v7, s[16:19], s38 offen offset:0 sc1
    v_mfma_f32_16x16x32_bf16 v[172:175], v[20:23], v[64:67], v[172:175]
    v_cvt_pk_bf16_f32 v54, v147, v151
    buffer_store_dword v54, v5, s[16:19], s38 offen offset:2048 sc1
    s_waitcnt lgkmcnt(4)
    v_mfma_f32_16x16x32_bf16 v[176:179], v[24:27], v[56:59], v[176:179]
    ds_read_b128 v[16:19], v2 offset:18432
    v_cvt_pk_bf16_f32 v55, v155, v159
    buffer_store_dword v55, v7, s[16:19], s38 offen offset:2048 sc1
    v_mfma_f32_16x16x32_bf16 v[180:183], v[24:27], v[60:63], v[180:183]
    ds_read_b128 v[20:23], v3 offset:18432
    v_mfma_f32_16x16x32_bf16 v[184:187], v[24:27], v[64:67], v[184:187]
    v_mfma_f32_16x16x32_bf16 v[188:191], v[24:27], v[68:71], v[188:191]
    s_mov_b32 s38, 163840
    v_cvt_pk_bf16_f32 v40, v160, v164
    buffer_store_dword v40, v5, s[16:19], s38 offen offset:0 sc1
    v_cvt_pk_bf16_f32 v41, v168, v172
    buffer_store_dword v41, v7, s[16:19], s38 offen offset:0 sc1
    v_mfma_f32_16x16x32_bf16 v[176:179], v[28:31], v[72:75], v[176:179]
    v_cvt_pk_bf16_f32 v42, v161, v165
    buffer_store_dword v42, v5, s[16:19], s38 offen offset:2048 sc1
    v_mfma_f32_16x16x32_bf16 v[180:183], v[28:31], v[56:59], v[180:183]
    v_cvt_pk_bf16_f32 v43, v169, v173
    buffer_store_dword v43, v7, s[16:19], s38 offen offset:2048 sc1
    v_mfma_f32_16x16x32_bf16 v[184:187], v[28:31], v[76:79], v[184:187]
    s_mov_b32 s38, 167936
    v_cvt_pk_bf16_f32 v44, v162, v166
    buffer_store_dword v44, v5, s[16:19], s38 offen offset:0 sc1
    v_cvt_pk_bf16_f32 v45, v170, v174
    buffer_store_dword v45, v7, s[16:19], s38 offen offset:0 sc1
    v_mfma_f32_16x16x32_bf16 v[188:191], v[28:31], v[64:67], v[188:191]
    v_cvt_pk_bf16_f32 v46, v163, v167
    buffer_store_dword v46, v5, s[16:19], s38 offen offset:2048 sc1
    s_waitcnt lgkmcnt(4)
    v_mfma_f32_16x16x32_bf16 v[192:195], v[32:35], v[56:59], v[192:195]
    ds_read_b128 v[24:27], v2 offset:20480
    v_cvt_pk_bf16_f32 v47, v171, v175
    buffer_store_dword v47, v7, s[16:19], s38 offen offset:2048 sc1
    v_mfma_f32_16x16x32_bf16 v[196:199], v[32:35], v[60:63], v[196:199]
    ds_read_b128 v[28:31], v3 offset:20480
    v_mfma_f32_16x16x32_bf16 v[200:203], v[32:35], v[64:67], v[200:203]
    v_mfma_f32_16x16x32_bf16 v[204:207], v[32:35], v[68:71], v[204:207]
    s_mov_b32 s38, 196608
    v_cvt_pk_bf16_f32 v48, v176, v180
    buffer_store_dword v48, v5, s[16:19], s38 offen offset:0 sc1
    v_cvt_pk_bf16_f32 v49, v184, v188
    buffer_store_dword v49, v7, s[16:19], s38 offen offset:0 sc1
    v_mfma_f32_16x16x32_bf16 v[192:195], v[36:39], v[72:75], v[192:195]
    v_cvt_pk_bf16_f32 v50, v177, v181
    buffer_store_dword v50, v5, s[16:19], s38 offen offset:2048 sc1
    v_mfma_f32_16x16x32_bf16 v[196:199], v[36:39], v[56:59], v[196:199]
    v_cvt_pk_bf16_f32 v51, v185, v189
    buffer_store_dword v51, v7, s[16:19], s38 offen offset:2048 sc1
    v_mfma_f32_16x16x32_bf16 v[200:203], v[36:39], v[76:79], v[200:203]
    s_mov_b32 s38, 200704
    v_cvt_pk_bf16_f32 v52, v178, v182
    buffer_store_dword v52, v5, s[16:19], s38 offen offset:0 sc1
    v_cvt_pk_bf16_f32 v53, v186, v190
    buffer_store_dword v53, v7, s[16:19], s38 offen offset:0 sc1
    v_mfma_f32_16x16x32_bf16 v[204:207], v[36:39], v[64:67], v[204:207]
    v_cvt_pk_bf16_f32 v54, v179, v183
    buffer_store_dword v54, v5, s[16:19], s38 offen offset:2048 sc1
    s_waitcnt lgkmcnt(4)
    v_mfma_f32_16x16x32_bf16 v[208:211], v[8:11], v[56:59], v[208:211]
    v_cvt_pk_bf16_f32 v55, v187, v191
    buffer_store_dword v55, v7, s[16:19], s38 offen offset:2048 sc1
    v_mfma_f32_16x16x32_bf16 v[212:215], v[8:11], v[60:63], v[212:215]
    v_mfma_f32_16x16x32_bf16 v[216:219], v[8:11], v[64:67], v[216:219]
    v_mfma_f32_16x16x32_bf16 v[220:223], v[8:11], v[68:71], v[220:223]
    s_mov_b32 s38, 229376
    v_cvt_pk_bf16_f32 v40, v192, v196
    buffer_store_dword v40, v5, s[16:19], s38 offen offset:0 sc1
    v_cvt_pk_bf16_f32 v41, v200, v204
    buffer_store_dword v41, v7, s[16:19], s38 offen offset:0 sc1
    v_mfma_f32_16x16x32_bf16 v[208:211], v[12:15], v[72:75], v[208:211]
    v_cvt_pk_bf16_f32 v42, v193, v197
    buffer_store_dword v42, v5, s[16:19], s38 offen offset:2048 sc1
    v_mfma_f32_16x16x32_bf16 v[212:215], v[12:15], v[56:59], v[212:215]
    v_cvt_pk_bf16_f32 v43, v201, v205
    buffer_store_dword v43, v7, s[16:19], s38 offen offset:2048 sc1
    v_mfma_f32_16x16x32_bf16 v[216:219], v[12:15], v[76:79], v[216:219]
    s_mov_b32 s38, 233472
    v_cvt_pk_bf16_f32 v44, v194, v198
    buffer_store_dword v44, v5, s[16:19], s38 offen offset:0 sc1
    v_cvt_pk_bf16_f32 v45, v202, v206
    buffer_store_dword v45, v7, s[16:19], s38 offen offset:0 sc1
    v_mfma_f32_16x16x32_bf16 v[220:223], v[12:15], v[64:67], v[220:223]
    v_cvt_pk_bf16_f32 v46, v195, v199
    buffer_store_dword v46, v5, s[16:19], s38 offen offset:2048 sc1
    s_waitcnt lgkmcnt(2)
    v_mfma_f32_16x16x32_bf16 v[224:227], v[16:19], v[56:59], v[224:227]
    v_cvt_pk_bf16_f32 v47, v203, v207
    buffer_store_dword v47, v7, s[16:19], s38 offen offset:2048 sc1
    v_mfma_f32_16x16x32_bf16 v[228:231], v[16:19], v[60:63], v[228:231]
    v_mfma_f32_16x16x32_bf16 v[232:235], v[16:19], v[64:67], v[232:235]
    v_mfma_f32_16x16x32_bf16 v[236:239], v[16:19], v[68:71], v[236:239]
    s_mov_b32 s38, 262144
    v_cvt_pk_bf16_f32 v48, v208, v212
    buffer_store_dword v48, v5, s[16:19], s38 offen offset:0 sc1
    v_cvt_pk_bf16_f32 v49, v216, v220
    buffer_store_dword v49, v7, s[16:19], s38 offen offset:0 sc1
    v_mfma_f32_16x16x32_bf16 v[224:227], v[20:23], v[72:75], v[224:227]
    v_cvt_pk_bf16_f32 v50, v209, v213
    buffer_store_dword v50, v5, s[16:19], s38 offen offset:2048 sc1
    v_mfma_f32_16x16x32_bf16 v[228:231], v[20:23], v[56:59], v[228:231]
    v_cvt_pk_bf16_f32 v51, v217, v221
    buffer_store_dword v51, v7, s[16:19], s38 offen offset:2048 sc1
    v_mfma_f32_16x16x32_bf16 v[232:235], v[20:23], v[76:79], v[232:235]
    s_mov_b32 s38, 266240
    v_cvt_pk_bf16_f32 v52, v210, v214
    buffer_store_dword v52, v5, s[16:19], s38 offen offset:0 sc1
    v_cvt_pk_bf16_f32 v53, v218, v222
    buffer_store_dword v53, v7, s[16:19], s38 offen offset:0 sc1
    v_mfma_f32_16x16x32_bf16 v[236:239], v[20:23], v[64:67], v[236:239]
    v_cvt_pk_bf16_f32 v54, v211, v215
    buffer_store_dword v54, v5, s[16:19], s38 offen offset:2048 sc1
    s_waitcnt lgkmcnt(0)
    v_mfma_f32_16x16x32_bf16 v[240:243], v[24:27], v[56:59], v[240:243]
    v_cvt_pk_bf16_f32 v55, v219, v223
    buffer_store_dword v55, v7, s[16:19], s38 offen offset:2048 sc1
    v_mfma_f32_16x16x32_bf16 v[244:247], v[24:27], v[60:63], v[244:247]
    v_mfma_f32_16x16x32_bf16 v[240:243], v[28:31], v[72:75], v[240:243]
    v_mfma_f32_16x16x32_bf16 v[244:247], v[28:31], v[56:59], v[244:247]
    s_mov_b32 s38, 294912
    v_cvt_pk_bf16_f32 v40, v224, v228
    buffer_store_dword v40, v5, s[16:19], s38 offen offset:0 sc1
    v_cvt_pk_bf16_f32 v41, v232, v236
    buffer_store_dword v41, v7, s[16:19], s38 offen offset:0 sc1
    v_cvt_pk_bf16_f32 v42, v225, v229
    buffer_store_dword v42, v5, s[16:19], s38 offen offset:2048 sc1
    v_cvt_pk_bf16_f32 v43, v233, v237
    buffer_store_dword v43, v7, s[16:19], s38 offen offset:2048 sc1
    s_mov_b32 s38, 299008
    v_cvt_pk_bf16_f32 v44, v226, v230
    buffer_store_dword v44, v5, s[16:19], s38 offen offset:0 sc1
    v_cvt_pk_bf16_f32 v45, v234, v238
    buffer_store_dword v45, v7, s[16:19], s38 offen offset:0 sc1
    v_cvt_pk_bf16_f32 v46, v227, v231
    buffer_store_dword v46, v5, s[16:19], s38 offen offset:2048 sc1
    v_cvt_pk_bf16_f32 v47, v235, v239
    buffer_store_dword v47, v7, s[16:19], s38 offen offset:2048 sc1
    s_nop 7
    s_lshl_b32 s34, s27, 1
    s_mul_i32 s34, s34, 342016
    s_add_u32 s34, s34, 118489088
    s_add_u32 s64, s58, s34
    s_addc_u32 s65, s59, 0
    s_and_b32 s65, s65, 0xffff
    s_mov_b32 s66, 684032
    s_mov_b32 s67, 0x00020000
    v_lshrrev_b32 v8, 8, v1
    v_lshlrev_b32 v9, 13, v8
    v_sub_u32 v9, v5, v9
    v_lshlrev_b32 v8, 2, v8
    v_add_u32 v8, 160, v8
    v_add_u32 v10, 0, v8
    v_add_u32 v11, 160, v10
    v_cmp_gt_u32 vcc, 167, v10
    s_nop 1
    v_cndmask_b32 v11, v11, v10, vcc
    v_cmp_gt_u32 vcc, 174, v10
    v_mov_b32 v12, 0x7ffff
    s_nop 0
    v_cndmask_b32 v11, v12, v11, vcc
    v_lshl_add_u32 v16, v11, 11, v9
    v_add_u32 v10, 1, v8
    v_add_u32 v11, 160, v10
    v_cmp_gt_u32 vcc, 167, v10
    s_nop 1
    v_cndmask_b32 v11, v11, v10, vcc
    v_cmp_gt_u32 vcc, 174, v10
    v_mov_b32 v12, 0x7ffff
    s_nop 0
    v_cndmask_b32 v11, v12, v11, vcc
    v_lshl_add_u32 v17, v11, 11, v9
    v_add_u32 v10, 2, v8
    v_add_u32 v11, 160, v10
    v_cmp_gt_u32 vcc, 167, v10
    s_nop 1
    v_cndmask_b32 v11, v11, v10, vcc
    v_cmp_gt_u32 vcc, 174, v10
    v_mov_b32 v12, 0x7ffff
    s_nop 0
    v_cndmask_b32 v11, v12, v11, vcc
    v_lshl_add_u32 v18, v11, 11, v9
    v_add_u32 v10, 3, v8
    v_add_u32 v11, 160, v10
    v_cmp_gt_u32 vcc, 167, v10
    s_nop 1
    v_cndmask_b32 v11, v11, v10, vcc
    v_cmp_gt_u32 vcc, 174, v10
    v_mov_b32 v12, 0x7ffff
    s_nop 0
    v_cndmask_b32 v11, v12, v11, vcc
    v_lshl_add_u32 v19, v11, 11, v9
    v_cvt_pk_bf16_f32 v20, v240, v244
    buffer_store_dword v20, v16, s[64:67], 0 offen sc1
    v_cvt_pk_bf16_f32 v21, v241, v245
    buffer_store_dword v21, v17, s[64:67], 0 offen sc1
    v_cvt_pk_bf16_f32 v22, v242, v246
    buffer_store_dword v22, v18, s[64:67], 0 offen sc1
    v_cvt_pk_bf16_f32 v23, v243, v247
    buffer_store_dword v23, v19, s[64:67], 0 offen sc1
    s_endpgm
K12_S0:
    s_mov_b32 s61, 16384
    s_add_u32 s62, s62, 1
K12_S0_L:
    ds_read_b32 v56, v5
    s_waitcnt lgkmcnt(0)
    v_cmp_gt_u32 vcc, s40, v56
    s_sub_u32 s61, s61, 1
    s_cmp_eq_u32 s61, 0
    s_cbranch_scc1 K12_Q0
    s_cbranch_vccz K12_Q0
    s_branch K12_S0_L
K12_S1:
    s_mov_b32 s61, 16384
    s_add_u32 s62, s62, 1
K12_S1_L:
    ds_read_b32 v68, v5
    s_waitcnt lgkmcnt(0)
    v_cmp_gt_u32 vcc, s40, v68
    s_sub_u32 s61, s61, 1
    s_cmp_eq_u32 s61, 0
    s_cbranch_scc1 K12_Q1
    s_cbranch_vccz K12_Q1
    s_branch K12_S1_L
K12_F2:
    s_mov_b32 s61, 16384
    s_add_u32 s63, s63, 1
K12_F2_L:
    s_mov_b32 m0, s46
    s_mov_b64 exec, 0xff
    buffer_load_dword v1, s[4:7], 0 offen sc1 lds
    s_mov_b64 exec, -1
    s_waitcnt vmcnt(0)
    v_mov_b32 v0, s48
    ds_read_b32 v0, v0
    s_waitcnt lgkmcnt(0)
    v_cmp_eq_u32 vcc, 0, v0
    s_sub_u32 s61, s61, 1
    s_cmp_eq_u32 s61, 0
    s_cbranch_scc1 K12_F2_X
    s_cbranch_vccz K12_F2_X
    s_sleep 2
    s_branch K12_F2_L
K12_F2_X:
    s_branch K12_G2
K12_S3:
    s_mov_b32 s61, 16384
    s_add_u32 s62, s62, 1
K12_S3_L:
    ds_read_b32 v56, v5
    s_waitcnt lgkmcnt(0)
    v_cmp_gt_u32 vcc, s51, v56
    s_sub_u32 s61, s61, 1
    s_cmp_eq_u32 s61, 0
    s_cbranch_scc1 K12_Q3
    s_cbranch_vccz K12_Q3
    s_branch K12_S3_L
K12_S4:
    s_mov_b32 s61, 16384
    s_add_u32 s62, s62, 1
K12_S4_L:
    ds_read_b32 v52, v5
    s_waitcnt lgkmcnt(0)
    v_cmp_gt_u32 vcc, s40, v52
    s_sub_u32 s61, s61, 1
    s_cmp_eq_u32 s61, 0
    s_cbranch_scc1 K12_Q4
    s_cbranch_vccz K12_Q4
    s_branch K12_S4_L
K12_S5:
    s_mov_b32 s61, 16384
    s_add_u32 s62, s62, 1
K12_S5_L:
    ds_read_b32 v40, v5
    s_waitcnt lgkmcnt(0)
    v_cmp_gt_u32 vcc, s51, v40
    s_sub_u32 s61, s61, 1
    s_cmp_eq_u32 s61, 0
    s_cbranch_scc1 K12_Q5
    s_cbranch_vccz K12_Q5
    s_branch K12_S5_L
K12_S6:
    s_mov_b32 s61, 16384
    s_add_u32 s62, s62, 1
K12_S6_L:
    ds_read_b32 v68, v5
    s_waitcnt lgkmcnt(0)
    v_cmp_gt_u32 vcc, s40, v68
    s_sub_u32 s61, s61, 1
    s_cmp_eq_u32 s61, 0
    s_cbranch_scc1 K12_Q6
    s_cbranch_vccz K12_Q6
    s_branch K12_S6_L
K12_F7:
    s_mov_b32 s61, 16384
    s_add_u32 s63, s63, 1
K12_F7_L:
    s_mov_b32 m0, s46
    s_mov_b64 exec, 0xff
    buffer_load_dword v1, s[4:7], 0 offen sc1 lds
    s_mov_b64 exec, -1
    s_waitcnt vmcnt(0)
    v_mov_b32 v0, s48
    ds_read_b32 v0, v0
    s_waitcnt lgkmcnt(0)
    v_cmp_eq_u32 vcc, 0, v0
    s_sub_u32 s61, s61, 1
    s_cmp_eq_u32 s61, 0
    s_cbranch_scc1 K12_F7_X
    s_cbranch_vccz K12_F7_X
    s_sleep 2
    s_branch K12_F7_L
K12_F7_X:
    s_branch K12_G7
K12_S8:
    s_mov_b32 s61, 16384
    s_add_u32 s62, s62, 1
K12_S8_L:
    ds_read_b32 v56, v5
    s_waitcnt lgkmcnt(0)
    v_cmp_gt_u32 vcc, s51, v56
    s_sub_u32 s61, s61, 1
    s_cmp_eq_u32 s61, 0
    s_cbranch_scc1 K12_Q8
    s_cbranch_vccz K12_Q8
    s_branch K12_S8_L
K12_END:
    s_endpgm
.p2align 8
.type k34_out_kernel,@function
k34_out_kernel:
    s_cmp_ge_u32 s2, 256
    s_cbranch_scc1 K34_END
    s_load_dwordx2 s[4:5], s[0:1], 48
    s_load_dwordx4 s[40:43], s[0:1], 16
    s_load_dwordx2 s[44:45], s[0:1], 32
    v_lshrrev_b32 v1, 6, v0
    v_and_b32 v2, 63, v0
    v_readfirstlane_b32 s3, v1
    s_and_b32 s6, s2, 15
    s_lshr_b32 s7, s2, 4
    s_lshr_b32 s20, s6, 3
    s_and_b32 s21, s6, 7
    s_mul_i32 s22, s7, 11
    s_mul_i32 s23, s7, 10
    s_add_u32 s23, s23, 7
    s_cmp_lt_u32 s7, 7
    s_cselect_b32 s22, s22, s23
    s_cselect_b32 s23, 11, 10
    s_add_u32 s22, s22, s3
    v_and_b32 v3, 15, v2
    v_lshrrev_b32 v4, 4, v2
    v_lshlrev_b32 v5, 4, v2
    s_mov_b32 s24, 2736128
    v_mul_lo_u32 v6, v4, s24
    v_lshl_add_u32 v6, v3, 4, v6
    s_mul_i32 s25, s20, 167
    s_add_u32 s25, s25, s22
    s_lshl_b32 s25, s25, 11
    s_lshl_b32 s24, s21, 8
    s_add_u32 s25, s25, s24
    s_waitcnt lgkmcnt(0)
    s_add_u32 s8, s4, 118489088
    s_addc_u32 s9, s5, 0
    s_and_b32 s9, s9, 0xffff
    s_mov_b32 s10, 21889024
    s_mov_b32 s11, 0x00020000
    s_add_u32 s12, s4, 153616384
    s_addc_u32 s13, s5, 0
    s_and_b32 s13, s13, 0xffff
    s_mov_b32 s14, 131072
    s_mov_b32 s15, 0x00020000
    s_cmp_lt_u32 s3, s23
    s_cbranch_scc0 K34_NOLOAD
    buffer_load_dwordx4 v[16:19], v6, s[8:11], s25 offen
    s_add_u32 s25, s25, 684032
    buffer_load_dwordx4 v[20:23], v6, s[8:11], s25 offen
    s_add_u32 s25, s25, 684032
    buffer_load_dwordx4 v[24:27], v6, s[8:11], s25 offen
    s_add_u32 s25, s25, 684032
    buffer_load_dwordx4 v[28:31], v6, s[8:11], s25 offen
    s_add_u32 s25, s25, 8892416
    buffer_load_dwordx4 v[32:35], v6, s[8:11], s25 offen
    s_add_u32 s25, s25, 684032
    buffer_load_dwordx4 v[36:39], v6, s[8:11], s25 offen
    s_add_u32 s25, s25, 684032
    buffer_load_dwordx4 v[40:43], v6, s[8:11], s25 offen
    s_add_u32 s25, s25, 684032
    buffer_load_dwordx4 v[44:47], v6, s[8:11], s25 offen
K34_NOLOAD:
    s_cmp_lg_u32 s3, 0
    s_cbranch_scc1 K34_TAB
    s_mov_b32 s16, s40
    s_mov_b32 s17, s41
    s_and_b32 s17, s17, 0xffff
    s_mov_b32 s18, 1024
    s_mov_b32 s19, 0x00020000
    s_mov_b32 s28, s42
    s_mov_b32 s29, s43
    s_and_b32 s29, s29, 0xffff
    s_mov_b32 s30, 1024
    s_mov_b32 s31, 0x00020000
    s_lshl_b32 s24, s21, 7
    v_lshlrev_b32 v8, 1, v2
    buffer_load_ushort v152, v8, s[16:19], s24 offen
    buffer_load_ushort v153, v8, s[28:31], s24 offen
    s_branch K34_TABDONE
K34_TAB:
    s_cmp_ge_u32 s3, 7
    s_cbranch_scc1 K34_TABDONE
    s_sub_u32 s27, s3, 1
    s_lshr_b32 s28, s27, 1
    s_and_b32 s29, s27, 1
    s_lshl_b32 s30, s28, 4
    v_add_u32 v8, s30, v3
    s_lshl_b32 s30, s29, 5
    s_add_u32 s30, s30, 1
    v_lshlrev_b32 v9, 3, v4
    v_add_u32 v9, s30, v9
    v_mul_u32_u24 v9, v8, v9
    v_lshlrev_b32 v8, 1, v8
    v_mad_u32_u24 v48, v8, 0, v9
    v_mad_u32_u24 v49, v8, 0, v9
    v_add_u32 v49, 32, v49
    v_mad_u32_u24 v50, v8, 1, v9
    v_mad_u32_u24 v51, v8, 1, v9
    v_add_u32 v51, 32, v51
    v_mad_u32_u24 v52, v8, 2, v9
    v_mad_u32_u24 v53, v8, 2, v9
    v_add_u32 v53, 32, v53
    v_mad_u32_u24 v54, v8, 3, v9
    v_mad_u32_u24 v55, v8, 3, v9
    v_add_u32 v55, 32, v55
    v_and_b32 v48, 127, v48
    v_and_b32 v49, 127, v49
    v_and_b32 v50, 127, v50
    v_and_b32 v51, 127, v51
    v_and_b32 v52, 127, v52
    v_and_b32 v53, 127, v53
    v_and_b32 v54, 127, v54
    v_and_b32 v55, 127, v55
    v_cvt_f32_u32 v48, v48
    v_cvt_f32_u32 v49, v49
    v_cvt_f32_u32 v50, v50
    v_cvt_f32_u32 v51, v51
    v_cvt_f32_u32 v52, v52
    v_cvt_f32_u32 v53, v53
    v_cvt_f32_u32 v54, v54
    v_cvt_f32_u32 v55, v55
    v_mul_f32 v48, 0x3c000000, v48
    v_mul_f32 v49, 0x3c000000, v49
    v_mul_f32 v50, 0x3c000000, v50
    v_mul_f32 v51, 0x3c000000, v51
    v_mul_f32 v52, 0x3c000000, v52
    v_mul_f32 v53, 0x3c000000, v53
    v_mul_f32 v54, 0x3c000000, v54
    v_mul_f32 v55, 0x3c000000, v55
    v_cos_f32 v48, v48
    v_cos_f32 v49, v49
    v_cos_f32 v50, v50
    v_cos_f32 v51, v51
    v_cos_f32 v52, v52
    v_cos_f32 v53, v53
    v_cos_f32 v54, v54
    v_cos_f32 v55, v55
    s_nop 0
    v_mul_f32 v48, 0x3d000000, v48
    v_mul_f32 v49, 0x3d000000, v49
    v_mul_f32 v50, 0x3d000000, v50
    v_mul_f32 v51, 0x3d000000, v51
    v_mul_f32 v52, 0x3d000000, v52
    v_mul_f32 v53, 0x3d000000, v53
    v_mul_f32 v54, 0x3d000000, v54
    v_mul_f32 v55, 0x3d000000, v55
    v_cvt_pk_bf16_f32 v56, v48, v49
    v_cvt_pk_bf16_f32 v57, v50, v51
    v_cvt_pk_bf16_f32 v58, v52, v53
    v_cvt_pk_bf16_f32 v59, v54, v55
    v_lshlrev_b32 v64, 16, v56
    v_and_b32 v65, 0xffff0000, v56
    v_sub_f32 v48, v48, v64
    v_sub_f32 v49, v49, v65
    v_lshlrev_b32 v64, 16, v57
    v_and_b32 v65, 0xffff0000, v57
    v_sub_f32 v50, v50, v64
    v_sub_f32 v51, v51, v65
    v_lshlrev_b32 v64, 16, v58
    v_and_b32 v65, 0xffff0000, v58
    v_sub_f32 v52, v52, v64
    v_sub_f32 v53, v53, v65
    v_lshlrev_b32 v64, 16, v59
    v_and_b32 v65, 0xffff0000, v59
    v_sub_f32 v54, v54, v64
    v_sub_f32 v55, v55, v65
    v_cvt_pk_bf16_f32 v60, v48, v49
    v_cvt_pk_bf16_f32 v61, v50, v51
    v_cvt_pk_bf16_f32 v62, v52, v53
    v_cvt_pk_bf16_f32 v63, v54, v55
    s_lshl_b32 s30, s27, 11
    v_add_u32 v10, s30, v5
    ds_write_b128 v10, v[56:59]
    ds_write_b128 v10, v[60:63] offset:1024
K34_TABDONE:
    s_waitcnt lgkmcnt(0)
    s_barrier
    s_cmp_lt_u32 s3, s23
    s_cbranch_scc0 K34_IDLE
    ds_read_b128 v[48:51], v5 offset:0
    ds_read_b128 v[52:55], v5 offset:1024
    ds_read_b128 v[56:59], v5 offset:2048
    ds_read_b128 v[60:63], v5 offset:3072
    ds_read_b128 v[64:67], v5 offset:4096
    ds_read_b128 v[68:71], v5 offset:5120
    ds_read_b128 v[72:75], v5 offset:6144
    ds_read_b128 v[76:79], v5 offset:7168
    ds_read_b128 v[80:83], v5 offset:8192
    ds_read_b128 v[84:87], v5 offset:9216
    ds_read_b128 v[88:91], v5 offset:10240
    ds_read_b128 v[92:95], v5 offset:11264
    s_waitcnt vmcnt(0)
    v_swap_b32 v17, v20
    v_swap_b32 v18, v24
    v_swap_b32 v19, v28
    v_swap_b32 v22, v25
    v_swap_b32 v23, v29
    v_swap_b32 v27, v30
    v_swap_b32 v33, v36
    v_swap_b32 v34, v40
    v_swap_b32 v35, v44
    v_swap_b32 v38, v41
    v_swap_b32 v39, v45
    v_swap_b32 v43, v46
    s_waitcnt lgkmcnt(0)
    s_mul_i32 s24, s22, 48
    s_sub_u32 s24, 7985, s24
    s_cmp_ge_u32 s24, 48
    s_cbranch_scc1 K34_FULL
    v_add_u32 v7, 0, v3
    v_cmp_gt_u32 vcc, s24, v7
    s_nop 1
    v_cndmask_b32 v48, 0, v48, vcc
    v_cndmask_b32 v49, 0, v49, vcc
    v_cndmask_b32 v50, 0, v50, vcc
    v_cndmask_b32 v51, 0, v51, vcc
    v_cndmask_b32 v52, 0, v52, vcc
    v_cndmask_b32 v53, 0, v53, vcc
    v_cndmask_b32 v54, 0, v54, vcc
    v_cndmask_b32 v55, 0, v55, vcc
    v_cndmask_b32 v56, 0, v56, vcc
    v_cndmask_b32 v57, 0, v57, vcc
    v_cndmask_b32 v58, 0, v58, vcc
    v_cndmask_b32 v59, 0, v59, vcc
    v_cndmask_b32 v60, 0, v60, vcc
    v_cndmask_b32 v61, 0, v61, vcc
    v_cndmask_b32 v62, 0, v62, vcc
    v_cndmask_b32 v63, 0, v63, vcc
    v_add_u32 v7, 16, v3
    v_cmp_gt_u32 vcc, s24, v7
    s_nop 1
    v_cndmask_b32 v64, 0, v64, vcc
    v_cndmask_b32 v65, 0, v65, vcc
    v_cndmask_b32 v66, 0, v66, vcc
    v_cndmask_b32 v67, 0, v67, vcc
    v_cndmask_b32 v68, 0, v68, vcc
    v_cndmask_b32 v69, 0, v69, vcc
    v_cndmask_b32 v70, 0, v70, vcc
    v_cndmask_b32 v71, 0, v71, vcc
    v_cndmask_b32 v72, 0, v72, vcc
    v_cndmask_b32 v73, 0, v73, vcc
    v_cndmask_b32 v74, 0, v74, vcc
    v_cndmask_b32 v75, 0, v75, vcc
    v_cndmask_b32 v76, 0, v76, vcc
    v_cndmask_b32 v77, 0, v77, vcc
    v_cndmask_b32 v78, 0, v78, vcc
    v_cndmask_b32 v79, 0, v79, vcc
    v_add_u32 v7, 32, v3
    v_cmp_gt_u32 vcc, s24, v7
    s_nop 1
    v_cndmask_b32 v80, 0, v80, vcc
    v_cndmask_b32 v81, 0, v81, vcc
    v_cndmask_b32 v82, 0, v82, vcc
    v_cndmask_b32 v83, 0, v83, vcc
    v_cndmask_b32 v84, 0, v84, vcc
    v_cndmask_b32 v85, 0, v85, vcc
    v_cndmask_b32 v86, 0, v86, vcc
    v_cndmask_b32 v87, 0, v87, vcc
    v_cndmask_b32 v88, 0, v88, vcc
    v_cndmask_b32 v89, 0, v89, vcc
    v_cndmask_b32 v90, 0, v90, vcc
    v_cndmask_b32 v91, 0, v91, vcc
    v_cndmask_b32 v92, 0, v92, vcc
    v_cndmask_b32 v93, 0, v93, vcc
    v_cndmask_b32 v94, 0, v94, vcc
    v_cndmask_b32 v95, 0, v95, vcc
K34_FULL:
    s_nop 1
    v_mfma_f32_16x16x32_bf16 v[96:99], v[48:51], v[16:19], 0
    v_mfma_f32_16x16x32_bf16 v[100:103], v[48:51], v[20:23], 0
    v_mfma_f32_16x16x32_bf16 v[104:107], v[48:51], v[24:27], 0
    v_mfma_f32_16x16x32_bf16 v[108:111], v[48:51], v[28:31], 0
    v_mfma_f32_16x16x32_bf16 v[96:99], v[52:55], v[16:19], v[96:99]
    v_mfma_f32_16x16x32_bf16 v[100:103], v[52:55], v[20:23], v[100:103]
    v_mfma_f32_16x16x32_bf16 v[104:107], v[52:55], v[24:27], v[104:107]
    v_mfma_f32_16x16x32_bf16 v[108:111], v[52:55], v[28:31], v[108:111]
    v_mfma_f32_16x16x32_bf16 v[96:99], v[56:59], v[32:35], v[96:99]
    v_mfma_f32_16x16x32_bf16 v[100:103], v[56:59], v[36:39], v[100:103]
    v_mfma_f32_16x16x32_bf16 v[104:107], v[56:59], v[40:43], v[104:107]
    v_mfma_f32_16x16x32_bf16 v[108:111], v[56:59], v[44:47], v[108:111]
    v_mfma_f32_16x16x32_bf16 v[96:99], v[60:63], v[32:35], v[96:99]
    v_mfma_f32_16x16x32_bf16 v[100:103], v[60:63], v[36:39], v[100:103]
    v_mfma_f32_16x16x32_bf16 v[104:107], v[60:63], v[40:43], v[104:107]
    v_mfma_f32_16x16x32_bf16 v[108:111], v[60:63], v[44:47], v[108:111]
    v_mfma_f32_16x16x32_bf16 v[112:115], v[64:67], v[16:19], 0
    v_mfma_f32_16x16x32_bf16 v[116:119], v[64:67], v[20:23], 0
    v_mfma_f32_16x16x32_bf16 v[120:123], v[64:67], v[24:27], 0
    v_mfma_f32_16x16x32_bf16 v[124:127], v[64:67], v[28:31], 0
    v_mfma_f32_16x16x32_bf16 v[112:115], v[68:71], v[16:19], v[112:115]
    v_mfma_f32_16x16x32_bf16 v[116:119], v[68:71], v[20:23], v[116:119]
    v_mfma_f32_16x16x32_bf16 v[120:123], v[68:71], v[24:27], v[120:123]
    v_mfma_f32_16x16x32_bf16 v[124:127], v[68:71], v[28:31], v[124:127]
    v_mfma_f32_16x16x32_bf16 v[112:115], v[72:75], v[32:35], v[112:115]
    v_mfma_f32_16x16x32_bf16 v[116:119], v[72:75], v[36:39], v[116:119]
    v_mfma_f32_16x16x32_bf16 v[120:123], v[72:75], v[40:43], v[120:123]
    v_mfma_f32_16x16x32_bf16 v[124:127], v[72:75], v[44:47], v[124:127]
    v_mfma_f32_16x16x32_bf16 v[112:115], v[76:79], v[32:35], v[112:115]
    v_mfma_f32_16x16x32_bf16 v[116:119], v[76:79], v[36:39], v[116:119]
    v_mfma_f32_16x16x32_bf16 v[120:123], v[76:79], v[40:43], v[120:123]
    v_mfma_f32_16x16x32_bf16 v[124:127], v[76:79], v[44:47], v[124:127]
    v_mfma_f32_16x16x32_bf16 v[128:131], v[80:83], v[16:19], 0
    v_mfma_f32_16x16x32_bf16 v[132:135], v[80:83], v[20:23], 0
    v_mfma_f32_16x16x32_bf16 v[136:139], v[80:83], v[24:27], 0
    v_mfma_f32_16x16x32_bf16 v[140:143], v[80:83], v[28:31], 0
    v_mfma_f32_16x16x32_bf16 v[128:131], v[84:87], v[16:19], v[128:131]
    v_mfma_f32_16x16x32_bf16 v[132:135], v[84:87], v[20:23], v[132:135]
    v_mfma_f32_16x16x32_bf16 v[136:139], v[84:87], v[24:27], v[136:139]
    v_mfma_f32_16x16x32_bf16 v[140:143], v[84:87], v[28:31], v[140:143]
    v_mfma_f32_16x16x32_bf16 v[128:131], v[88:91], v[32:35], v[128:131]
    v_mfma_f32_16x16x32_bf16 v[132:135], v[88:91], v[36:39], v[132:135]
    v_mfma_f32_16x16x32_bf16 v[136:139], v[88:91], v[40:43], v[136:139]
    v_mfma_f32_16x16x32_bf16 v[140:143], v[88:91], v[44:47], v[140:143]
    v_mfma_f32_16x16x32_bf16 v[128:131], v[92:95], v[32:35], v[128:131]
    v_mfma_f32_16x16x32_bf16 v[132:135], v[92:95], v[36:39], v[132:135]
    v_mfma_f32_16x16x32_bf16 v[136:139], v[92:95], v[40:43], v[136:139]
    v_mfma_f32_16x16x32_bf16 v[140:143], v[92:95], v[44:47], v[140:143]
    s_nop 7
    v_mov_b32 v16, v96
    v_mul_f32 v20, v96, v96
    v_mov_b32 v17, v100
    v_mul_f32 v21, v100, v100
    v_mov_b32 v18, v104
    v_mul_f32 v22, v104, v104
    v_mov_b32 v19, v108
    v_mul_f32 v23, v108, v108
    v_add_f32 v16, v16, v97
    v_fmac_f32 v20, v97, v97
    v_add_f32 v17, v17, v101
    v_fmac_f32 v21, v101, v101
    v_add_f32 v18, v18, v105
    v_fmac_f32 v22, v105, v105
    v_add_f32 v19, v19, v109
    v_fmac_f32 v23, v109, v109
    v_add_f32 v16, v16, v98
    v_fmac_f32 v20, v98, v98
    v_add_f32 v17, v17, v102
    v_fmac_f32 v21, v102, v102
    v_add_f32 v18, v18, v106
    v_fmac_f32 v22, v106, v106
    v_add_f32 v19, v19, v110
    v_fmac_f32 v23, v110, v110
    v_add_f32 v16, v16, v99
    v_fmac_f32 v20, v99, v99
    v_add_f32 v17, v17, v103
    v_fmac_f32 v21, v103, v103
    v_add_f32 v18, v18, v107
    v_fmac_f32 v22, v107, v107
    v_add_f32 v19, v19, v111
    v_fmac_f32 v23, v111, v111
    v_add_f32 v16, v16, v112
    v_fmac_f32 v20, v112, v112
    v_add_f32 v17, v17, v116
    v_fmac_f32 v21, v116, v116
    v_add_f32 v18, v18, v120
    v_fmac_f32 v22, v120, v120
    v_add_f32 v19, v19, v124
    v_fmac_f32 v23, v124, v124
    v_add_f32 v16, v16, v113
    v_fmac_f32 v20, v113, v113
    v_add_f32 v17, v17, v117
    v_fmac_f32 v21, v117, v117
    v_add_f32 v18, v18, v121
    v_fmac_f32 v22, v121, v121
    v_add_f32 v19, v19, v125
    v_fmac_f32 v23, v125, v125
    v_add_f32 v16, v16, v114
    v_fmac_f32 v20, v114, v114
    v_add_f32 v17, v17, v118
    v_fmac_f32 v21, v118, v118
    v_add_f32 v18, v18, v122
    v_fmac_f32 v22, v122, v122
    v_add_f32 v19, v19, v126
    v_fmac_f32 v23, v126, v126
    v_add_f32 v16, v16, v115
    v_fmac_f32 v20, v115, v115
    v_add_f32 v17, v17, v119
    v_fmac_f32 v21, v119, v119
    v_add_f32 v18, v18, v123
    v_fmac_f32 v22, v123, v123
    v_add_f32 v19, v19, v127
    v_fmac_f32 v23, v127, v127
    v_add_f32 v16, v16, v128
    v_fmac_f32 v20, v128, v128
    v_add_f32 v17, v17, v132
    v_fmac_f32 v21, v132, v132
    v_add_f32 v18, v18, v136
    v_fmac_f32 v22, v136, v136
    v_add_f32 v19, v19, v140
    v_fmac_f32 v23, v140, v140
    v_add_f32 v16, v16, v129
    v_fmac_f32 v20, v129, v129
    v_add_f32 v17, v17, v133
    v_fmac_f32 v21, v133, v133
    v_add_f32 v18, v18, v137
    v_fmac_f32 v22, v137, v137
    v_add_f32 v19, v19, v141
    v_fmac_f32 v23, v141, v141
    v_add_f32 v16, v16, v130
    v_fmac_f32 v20, v130, v130
    v_add_f32 v17, v17, v134
    v_fmac_f32 v21, v134, v134
    v_add_f32 v18, v18, v138
    v_fmac_f32 v22, v138, v138
    v_add_f32 v19, v19, v142
    v_fmac_f32 v23, v142, v142
    v_add_f32 v16, v16, v131
    v_fmac_f32 v20, v131, v131
    v_add_f32 v17, v17, v135
    v_fmac_f32 v21, v135, v135
    v_add_f32 v18, v18, v139
    v_fmac_f32 v22, v139, v139
    v_add_f32 v19, v19, v143
    v_fmac_f32 v23, v143, v143
    v_mov_b32 v24, v16
    v_mov_b32 v25, v17
    v_mov_b32 v26, v18
    v_mov_b32 v27, v19
    v_mov_b32 v28, v20
    v_mov_b32 v29, v21
    v_mov_b32 v30, v22
    v_mov_b32 v31, v23
    s_nop 0
    v_permlane32_swap_b32 v16, v24
    v_permlane32_swap_b32 v17, v25
    v_permlane32_swap_b32 v18, v26
    v_permlane32_swap_b32 v19, v27
    v_permlane32_swap_b32 v20, v28
    v_permlane32_swap_b32 v21, v29
    v_permlane32_swap_b32 v22, v30
    v_permlane32_swap_b32 v23, v31
    v_add_f32 v16, v16, v24
    v_add_f32 v17, v17, v25
    v_add_f32 v18, v18, v26
    v_add_f32 v19, v19, v27
    v_add_f32 v20, v20, v28
    v_add_f32 v21, v21, v29
    v_add_f32 v22, v22, v30
    v_add_f32 v23, v23, v31
    v_mov_b32 v24, v16
    v_mov_b32 v25, v17
    v_mov_b32 v26, v18
    v_mov_b32 v27, v19
    v_mov_b32 v28, v20
    v_mov_b32 v29, v21
    v_mov_b32 v30, v22
    v_mov_b32 v31, v23
    s_nop 0
    v_permlane16_swap_b32 v16, v24
    v_permlane16_swap_b32 v17, v25
    v_permlane16_swap_b32 v18, v26
    v_permlane16_swap_b32 v19, v27
    v_permlane16_swap_b32 v20, v28
    v_permlane16_swap_b32 v21, v29
    v_permlane16_swap_b32 v22, v30
    v_permlane16_swap_b32 v23, v31
    v_add_f32 v16, v16, v24
    v_add_f32 v17, v17, v25
    v_add_f32 v18, v18, v26
    v_add_f32 v19, v19, v27
    v_add_f32 v20, v20, v28
    v_add_f32 v21, v21, v29
    v_add_f32 v22, v22, v30
    v_add_f32 v23, v23, v31
    s_branch K34_WR
K34_IDLE:
    v_mov_b32 v16, 0
    v_mov_b32 v17, 0
    v_mov_b32 v18, 0
    v_mov_b32 v19, 0
    v_mov_b32 v20, 0
    v_mov_b32 v21, 0
    v_mov_b32 v22, 0
    v_mov_b32 v23, 0
K34_WR:
    s_lshl_b32 s24, s3, 9
    v_lshlrev_b32 v7, 4, v3
    v_add_u32 v7, s24, v7
    ds_write_b128 v7, v[16:19] offset:12288
    ds_write_b128 v7, v[20:23] offset:12544
    s_waitcnt lgkmcnt(0)
    s_barrier
    s_cmp_lg_u32 s3, 0
    s_cbranch_scc1 K34_WAIT
    v_lshlrev_b32 v7, 2, v2
    ds_read_b32 v16, v7 offset:12288
    ds_read_b32 v17, v7 offset:12800
    ds_read_b32 v18, v7 offset:13312
    ds_read_b32 v19, v7 offset:13824
    ds_read_b32 v20, v7 offset:14336
    ds_read_b32 v21, v7 offset:14848
    ds_read_b32 v22, v7 offset:15360
    ds_read_b32 v23, v7 offset:15872
    ds_read_b32 v24, v7 offset:16384
    ds_read_b32 v25, v7 offset:16896
    ds_read_b32 v26, v7 offset:17408
    ds_read_b32 v27, v7 offset:17920
    s_waitcnt lgkmcnt(0)
    ds_read_b32 v32, v7 offset:12544
    ds_read_b32 v33, v7 offset:13056
    ds_read_b32 v34, v7 offset:13568
    ds_read_b32 v35, v7 offset:14080
    ds_read_b32 v36, v7 offset:14592
    ds_read_b32 v37, v7 offset:15104
    ds_read_b32 v38, v7 offset:15616
    ds_read_b32 v39, v7 offset:16128
    ds_read_b32 v40, v7 offset:16640
    ds_read_b32 v41, v7 offset:17152
    ds_read_b32 v42, v7 offset:17664
    ds_read_b32 v43, v7 offset:18176
    v_add_f32 v16, v16, v17
    v_add_f32 v16, v16, v18
    v_add_f32 v16, v16, v19
    v_add_f32 v16, v16, v20
    v_add_f32 v16, v16, v21
    v_add_f32 v16, v16, v22
    v_add_f32 v16, v16, v23
    v_add_f32 v16, v16, v24
    v_add_f32 v16, v16, v25
    v_add_f32 v16, v16, v26
    v_add_f32 v16, v16, v27
    s_waitcnt lgkmcnt(0)
    v_add_f32 v32, v32, v33
    v_add_f32 v32, v32, v34
    v_add_f32 v32, v32, v35
    v_add_f32 v32, v32, v36
    v_add_f32 v32, v32, v37
    v_add_f32 v32, v32, v38
    v_add_f32 v32, v32, v39
    v_add_f32 v32, v32, v40
    v_add_f32 v32, v32, v41
    v_add_f32 v32, v32, v42
    v_add_f32 v32, v32, v43
    s_lshl_b32 s24, s6, 4
    s_add_u32 s24, s24, s7
    s_lshl_b32 s24, s24, 9
    buffer_store_dword v16, v7, s[12:15], s24 offen sc1
    buffer_store_dword v32, v7, s[12:15], s24 offen offset:256 sc1
    s_mov_b32 s26, 20000
K34_POLL:
    s_lshl_b32 s24, s6, 13
    buffer_load_dword v16, v7, s[12:15], s24 offen offset:0 sc1
    buffer_load_dword v32, v7, s[12:15], s24 offen offset:256 sc1
    buffer_load_dword v17, v7, s[12:15], s24 offen offset:512 sc1
    buffer_load_dword v33, v7, s[12:15], s24 offen offset:768 sc1
    buffer_load_dword v18, v7, s[12:15], s24 offen offset:1024 sc1
    buffer_load_dword v34, v7, s[12:15], s24 offen offset:1280 sc1
    buffer_load_dword v19, v7, s[12:15], s24 offen offset:1536 sc1
    buffer_load_dword v35, v7, s[12:15], s24 offen offset:1792 sc1
    buffer_load_dword v20, v7, s[12:15], s24 offen offset:2048 sc1
    buffer_load_dword v36, v7, s[12:15], s24 offen offset:2304 sc1
    buffer_load_dword v21, v7, s[12:15], s24 offen offset:2560 sc1
    buffer_load_dword v37, v7, s[12:15], s24 offen offset:2816 sc1
    buffer_load_dword v22, v7, s[12:15], s24 offen offset:3072 sc1
    buffer_load_dword v38, v7, s[12:15], s24 offen offset:3328 sc1
    buffer_load_dword v23, v7, s[12:15], s24 offen offset:3584 sc1
    buffer_load_dword v39, v7, s[12:15], s24 offen offset:3840 sc1
    s_add_u32 s24, s24, 4096
    buffer_load_dword v24, v7, s[12:15], s24 offen offset:0 sc1
    buffer_load_dword v40, v7, s[12:15], s24 offen offset:256 sc1
    buffer_load_dword v25, v7, s[12:15], s24 offen offset:512 sc1
    buffer_load_dword v41, v7, s[12:15], s24 offen offset:768 sc1
    buffer_load_dword v26, v7, s[12:15], s24 offen offset:1024 sc1
    buffer_load_dword v42, v7, s[12:15], s24 offen offset:1280 sc1
    buffer_load_dword v27, v7, s[12:15], s24 offen offset:1536 sc1
    buffer_load_dword v43, v7, s[12:15], s24 offen offset:1792 sc1
    buffer_load_dword v28, v7, s[12:15], s24 offen offset:2048 sc1
    buffer_load_dword v44, v7, s[12:15], s24 offen offset:2304 sc1
    buffer_load_dword v29, v7, s[12:15], s24 offen offset:2560 sc1
    buffer_load_dword v45, v7, s[12:15], s24 offen offset:2816 sc1
    buffer_load_dword v30, v7, s[12:15], s24 offen offset:3072 sc1
    buffer_load_dword v46, v7, s[12:15], s24 offen offset:3328 sc1
    buffer_load_dword v31, v7, s[12:15], s24 offen offset:3584 sc1
    buffer_load_dword v47, v7, s[12:15], s24 offen offset:3840 sc1
    s_waitcnt vmcnt(0)
    v_max3_u32 v48, v16, v17, v18
    v_max3_u32 v48, v48, v19, v20
    v_max3_u32 v48, v48, v21, v22
    v_max3_u32 v48, v48, v23, v24
    v_max3_u32 v48, v48, v25, v26
    v_max3_u32 v48, v48, v27, v28
    v_max3_u32 v48, v48, v29, v30
    v_max3_u32 v48, v48, v31, v32
    v_max3_u32 v48, v48, v33, v34
    v_max3_u32 v48, v48, v35, v36
    v_max3_u32 v48, v48, v37, v38
    v_max3_u32 v48, v48, v39, v40
    v_max3_u32 v48, v48, v41, v42
    v_max3_u32 v48, v48, v43, v44
    v_max3_u32 v48, v48, v45, v46
    v_max_u32 v48, v48, v47
    v_cmp_eq_u32 vcc, -1, v48
    s_sub_u32 s26, s26, 1
    s_cmp_eq_u32 s26, 0
    s_cbranch_scc1 K34_GOT
    s_cbranch_vccz K34_GOT
    s_sleep 1
    s_branch K34_POLL
K34_GOT:
    v_add_f32 v16, v16, v24
    v_add_f32 v32, v32, v40
    v_add_f32 v17, v17, v25
    v_add_f32 v33, v33, v41
    v_add_f32 v18, v18, v26
    v_add_f32 v34, v34, v42
    v_add_f32 v19, v19, v27
    v_add_f32 v35, v35, v43
    v_add_f32 v20, v20, v28
    v_add_f32 v36, v36, v44
    v_add_f32 v21, v21, v29
    v_add_f32 v37, v37, v45
    v_add_f32 v22, v22, v30
    v_add_f32 v38, v38, v46
    v_add_f32 v23, v23, v31
    v_add_f32 v39, v39, v47
    v_add_f32 v16, v16, v20
    v_add_f32 v32, v32, v36
    v_add_f32 v17, v17, v21
    v_add_f32 v33, v33, v37
    v_add_f32 v18, v18, v22
    v_add_f32 v34, v34, v38
    v_add_f32 v19, v19, v23
    v_add_f32 v35, v35, v39
    v_add_f32 v16, v16, v18
    v_add_f32 v32, v32, v34
    v_add_f32 v17, v17, v19
    v_add_f32 v33, v33, v35
    v_add_f32 v16, v16, v17
    v_add_f32 v32, v32, v33
    v_mul_f32 v11, 0x39035177, v16
    v_mul_f32 v12, 0x39035177, v32
    v_fma_f32 v12, -v11, v11, v12
    v_max_f32 v12, 0, v12
    v_add_f32 v12, 0x3727c5ac, v12
    v_sqrt_f32 v12, v12
    v_lshlrev_b32 v9, 16, v152
    v_rcp_f32 v12, v12
    v_lshlrev_b32 v10, 16, v153
    v_mul_f32 v9, v9, v12
    v_fma_f32 v10, -v11, v9, v10
    ds_write_b32 v7, v9 offset:18432
    ds_write_b32 v7, v10 offset:18688
    s_waitcnt lgkmcnt(0)
K34_WAIT:
    s_barrier
    s_cmp_lt_u32 s3, s23
    s_cbranch_scc0 K34_END
    v_lshlrev_b32 v7, 4, v3
    ds_read_b128 v[144:147], v7 offset:18432
    ds_read_b128 v[148:151], v7 offset:18688
    s_mul_i32 s24, s20, 8176640
    s_add_u32 s16, s44, s24
    s_addc_u32 s17, s45, 0
    s_and_b32 s17, s17, 0xffff
    s_mov_b32 s18, 8176640
    s_mov_b32 s19, 0x00020000
    v_lshlrev_b32 v7, 12, v4
    v_lshl_add_u32 v7, v3, 3, v7
    s_lshl_b32 s24, s21, 7
    v_add_u32 v7, s24, v7
    s_mul_i32 s25, s22, 49152
    s_mov_b32 s30, 0xc0135761
    s_mov_b32 s31, 0xbdd2d3e8
    v_mov_b32 v15, s30
    s_waitcnt lgkmcnt(0)
    v_fma_f32 v16, v96, v144, v148
    v_fma_f32 v17, v100, v145, v149
    v_fma_f32 v18, v104, v146, v150
    v_fma_f32 v19, v108, v147, v151
    v_fma_f32 v20, v97, v144, v148
    v_fma_f32 v21, v101, v145, v149
    v_fma_f32 v22, v105, v146, v150
    v_fma_f32 v23, v109, v147, v151
    v_mul_f32 v24, v16, v16
    v_mul_f32 v25, v17, v17
    v_mul_f32 v26, v18, v18
    v_mul_f32 v27, v19, v19
    v_mul_f32 v28, v20, v20
    v_mul_f32 v29, v21, v21
    v_mul_f32 v30, v22, v22
    v_mul_f32 v31, v23, v23
    v_fma_f32 v24, v24, s31, v15
    v_fma_f32 v25, v25, s31, v15
    v_fma_f32 v26, v26, s31, v15
    v_fma_f32 v27, v27, s31, v15
    v_fma_f32 v28, v28, s31, v15
    v_fma_f32 v29, v29, s31, v15
    v_fma_f32 v30, v30, s31, v15
    v_fma_f32 v31, v31, s31, v15
    v_mul_f32 v24, v24, v16
    v_mul_f32 v25, v25, v17
    v_mul_f32 v26, v26, v18
    v_mul_f32 v27, v27, v19
    v_mul_f32 v28, v28, v20
    v_mul_f32 v29, v29, v21
    v_mul_f32 v30, v30, v22
    v_mul_f32 v31, v31, v23
    v_exp_f32 v24, v24
    v_exp_f32 v25, v25
    v_exp_f32 v26, v26
    v_exp_f32 v27, v27
    v_exp_f32 v28, v28
    v_exp_f32 v29, v29
    v_exp_f32 v30, v30
    v_exp_f32 v31, v31
    v_add_f32 v24, 1.0, v24
    v_add_f32 v25, 1.0, v25
    v_add_f32 v26, 1.0, v26
    v_add_f32 v27, 1.0, v27
    v_add_f32 v28, 1.0, v28
    v_add_f32 v29, 1.0, v29
    v_add_f32 v30, 1.0, v30
    v_add_f32 v31, 1.0, v31
    v_rcp_f32 v24, v24
    v_rcp_f32 v25, v25
    v_rcp_f32 v26, v26
    v_rcp_f32 v27, v27
    v_rcp_f32 v28, v28
    v_rcp_f32 v29, v29
    v_rcp_f32 v30, v30
    v_rcp_f32 v31, v31
    v_mul_f32 v16, v16, v24
    v_mul_f32 v17, v17, v25
    v_mul_f32 v18, v18, v26
    v_mul_f32 v19, v19, v27
    v_mul_f32 v20, v20, v28
    v_mul_f32 v21, v21, v29
    v_mul_f32 v22, v22, v30
    v_mul_f32 v23, v23, v31
    v_cvt_pk_bf16_f32 v32, v16, v17
    v_cvt_pk_bf16_f32 v33, v18, v19
    buffer_store_dwordx2 v[32:33], v7, s[16:19], s25 offen offset:0 sc1
    v_cvt_pk_bf16_f32 v34, v20, v21
    v_cvt_pk_bf16_f32 v35, v22, v23
    buffer_store_dwordx2 v[34:35], v7, s[16:19], s25 offen offset:1024 sc1
    s_add_u32 s25, s25, 2048
    v_fma_f32 v36, v98, v144, v148
    v_fma_f32 v37, v102, v145, v149
    v_fma_f32 v38, v106, v146, v150
    v_fma_f32 v39, v110, v147, v151
    v_fma_f32 v40, v99, v144, v148
    v_fma_f32 v41, v103, v145, v149
    v_fma_f32 v42, v107, v146, v150
    v_fma_f32 v43, v111, v147, v151
    v_mul_f32 v44, v36, v36
    v_mul_f32 v45, v37, v37
    v_mul_f32 v46, v38, v38
    v_mul_f32 v47, v39, v39
    v_mul_f32 v48, v40, v40
    v_mul_f32 v49, v41, v41
    v_mul_f32 v50, v42, v42
    v_mul_f32 v51, v43, v43
    v_fma_f32 v44, v44, s31, v15
    v_fma_f32 v45, v45, s31, v15
    v_fma_f32 v46, v46, s31, v15
    v_fma_f32 v47, v47, s31, v15
    v_fma_f32 v48, v48, s31, v15
    v_fma_f32 v49, v49, s31, v15
    v_fma_f32 v50, v50, s31, v15
    v_fma_f32 v51, v51, s31, v15
    v_mul_f32 v44, v44, v36
    v_mul_f32 v45, v45, v37
    v_mul_f32 v46, v46, v38
    v_mul_f32 v47, v47, v39
    v_mul_f32 v48, v48, v40
    v_mul_f32 v49, v49, v41
    v_mul_f32 v50, v50, v42
    v_mul_f32 v51, v51, v43
    v_exp_f32 v44, v44
    v_exp_f32 v45, v45
    v_exp_f32 v46, v46
    v_exp_f32 v47, v47
    v_exp_f32 v48, v48
    v_exp_f32 v49, v49
    v_exp_f32 v50, v50
    v_exp_f32 v51, v51
    v_add_f32 v44, 1.0, v44
    v_add_f32 v45, 1.0, v45
    v_add_f32 v46, 1.0, v46
    v_add_f32 v47, 1.0, v47
    v_add_f32 v48, 1.0, v48
    v_add_f32 v49, 1.0, v49
    v_add_f32 v50, 1.0, v50
    v_add_f32 v51, 1.0, v51
    v_rcp_f32 v44, v44
    v_rcp_f32 v45, v45
    v_rcp_f32 v46, v46
    v_rcp_f32 v47, v47
    v_rcp_f32 v48, v48
    v_rcp_f32 v49, v49
    v_rcp_f32 v50, v50
    v_rcp_f32 v51, v51
    v_mul_f32 v36, v36, v44
    v_mul_f32 v37, v37, v45
    v_mul_f32 v38, v38, v46
    v_mul_f32 v39, v39, v47
    v_mul_f32 v40, v40, v48
    v_mul_f32 v41, v41, v49
    v_mul_f32 v42, v42, v50
    v_mul_f32 v43, v43, v51
    v_cvt_pk_bf16_f32 v52, v36, v37
    v_cvt_pk_bf16_f32 v53, v38, v39
    buffer_store_dwordx2 v[52:53], v7, s[16:19], s25 offen offset:0 sc1
    v_cvt_pk_bf16_f32 v54, v40, v41
    v_cvt_pk_bf16_f32 v55, v42, v43
    buffer_store_dwordx2 v[54:55], v7, s[16:19], s25 offen offset:1024 sc1
    s_add_u32 s25, s25, 2048
    s_add_u32 s25, s25, 12288
    v_fma_f32 v16, v112, v144, v148
    v_fma_f32 v17, v116, v145, v149
    v_fma_f32 v18, v120, v146, v150
    v_fma_f32 v19, v124, v147, v151
    v_fma_f32 v20, v113, v144, v148
    v_fma_f32 v21, v117, v145, v149
    v_fma_f32 v22, v121, v146, v150
    v_fma_f32 v23, v125, v147, v151
    v_mul_f32 v24, v16, v16
    v_mul_f32 v25, v17, v17
    v_mul_f32 v26, v18, v18
    v_mul_f32 v27, v19, v19
    v_mul_f32 v28, v20, v20
    v_mul_f32 v29, v21, v21
    v_mul_f32 v30, v22, v22
    v_mul_f32 v31, v23, v23
    v_fma_f32 v24, v24, s31, v15
    v_fma_f32 v25, v25, s31, v15
    v_fma_f32 v26, v26, s31, v15
    v_fma_f32 v27, v27, s31, v15
    v_fma_f32 v28, v28, s31, v15
    v_fma_f32 v29, v29, s31, v15
    v_fma_f32 v30, v30, s31, v15
    v_fma_f32 v31, v31, s31, v15
    v_mul_f32 v24, v24, v16
    v_mul_f32 v25, v25, v17
    v_mul_f32 v26, v26, v18
    v_mul_f32 v27, v27, v19
    v_mul_f32 v28, v28, v20
    v_mul_f32 v29, v29, v21
    v_mul_f32 v30, v30, v22
    v_mul_f32 v31, v31, v23
    v_exp_f32 v24, v24
    v_exp_f32 v25, v25
    v_exp_f32 v26, v26
    v_exp_f32 v27, v27
    v_exp_f32 v28, v28
    v_exp_f32 v29, v29
    v_exp_f32 v30, v30
    v_exp_f32 v31, v31
    v_add_f32 v24, 1.0, v24
    v_add_f32 v25, 1.0, v25
    v_add_f32 v26, 1.0, v26
    v_add_f32 v27, 1.0, v27
    v_add_f32 v28, 1.0, v28
    v_add_f32 v29, 1.0, v29
    v_add_f32 v30, 1.0, v30
    v_add_f32 v31, 1.0, v31
    v_rcp_f32 v24, v24
    v_rcp_f32 v25, v25
    v_rcp_f32 v26, v26
    v_rcp_f32 v27, v27
    v_rcp_f32 v28, v28
    v_rcp_f32 v29, v29
    v_rcp_f32 v30, v30
    v_rcp_f32 v31, v31
    v_mul_f32 v16, v16, v24
    v_mul_f32 v17, v17, v25
    v_mul_f32 v18, v18, v26
    v_mul_f32 v19, v19, v27
    v_mul_f32 v20, v20, v28
    v_mul_f32 v21, v21, v29
    v_mul_f32 v22, v22, v30
    v_mul_f32 v23, v23, v31
    v_cvt_pk_bf16_f32 v32, v16, v17
    v_cvt_pk_bf16_f32 v33, v18, v19
    buffer_store_dwordx2 v[32:33], v7, s[16:19], s25 offen offset:0 sc1
    v_cvt_pk_bf16_f32 v34, v20, v21
    v_cvt_pk_bf16_f32 v35, v22, v23
    buffer_store_dwordx2 v[34:35], v7, s[16:19], s25 offen offset:1024 sc1
    s_add_u32 s25, s25, 2048
    v_fma_f32 v36, v114, v144, v148
    v_fma_f32 v37, v118, v145, v149
    v_fma_f32 v38, v122, v146, v150
    v_fma_f32 v39, v126, v147, v151
    v_fma_f32 v40, v115, v144, v148
    v_fma_f32 v41, v119, v145, v149
    v_fma_f32 v42, v123, v146, v150
    v_fma_f32 v43, v127, v147, v151
    v_mul_f32 v44, v36, v36
    v_mul_f32 v45, v37, v37
    v_mul_f32 v46, v38, v38
    v_mul_f32 v47, v39, v39
    v_mul_f32 v48, v40, v40
    v_mul_f32 v49, v41, v41
    v_mul_f32 v50, v42, v42
    v_mul_f32 v51, v43, v43
    v_fma_f32 v44, v44, s31, v15
    v_fma_f32 v45, v45, s31, v15
    v_fma_f32 v46, v46, s31, v15
    v_fma_f32 v47, v47, s31, v15
    v_fma_f32 v48, v48, s31, v15
    v_fma_f32 v49, v49, s31, v15
    v_fma_f32 v50, v50, s31, v15
    v_fma_f32 v51, v51, s31, v15
    v_mul_f32 v44, v44, v36
    v_mul_f32 v45, v45, v37
    v_mul_f32 v46, v46, v38
    v_mul_f32 v47, v47, v39
    v_mul_f32 v48, v48, v40
    v_mul_f32 v49, v49, v41
    v_mul_f32 v50, v50, v42
    v_mul_f32 v51, v51, v43
    v_exp_f32 v44, v44
    v_exp_f32 v45, v45
    v_exp_f32 v46, v46
    v_exp_f32 v47, v47
    v_exp_f32 v48, v48
    v_exp_f32 v49, v49
    v_exp_f32 v50, v50
    v_exp_f32 v51, v51
    v_add_f32 v44, 1.0, v44
    v_add_f32 v45, 1.0, v45
    v_add_f32 v46, 1.0, v46
    v_add_f32 v47, 1.0, v47
    v_add_f32 v48, 1.0, v48
    v_add_f32 v49, 1.0, v49
    v_add_f32 v50, 1.0, v50
    v_add_f32 v51, 1.0, v51
    v_rcp_f32 v44, v44
    v_rcp_f32 v45, v45
    v_rcp_f32 v46, v46
    v_rcp_f32 v47, v47
    v_rcp_f32 v48, v48
    v_rcp_f32 v49, v49
    v_rcp_f32 v50, v50
    v_rcp_f32 v51, v51
    v_mul_f32 v36, v36, v44
    v_mul_f32 v37, v37, v45
    v_mul_f32 v38, v38, v46
    v_mul_f32 v39, v39, v47
    v_mul_f32 v40, v40, v48
    v_mul_f32 v41, v41, v49
    v_mul_f32 v42, v42, v50
    v_mul_f32 v43, v43, v51
    v_cvt_pk_bf16_f32 v52, v36, v37
    v_cvt_pk_bf16_f32 v53, v38, v39
    buffer_store_dwordx2 v[52:53], v7, s[16:19], s25 offen offset:0 sc1
    v_cvt_pk_bf16_f32 v54, v40, v41
    v_cvt_pk_bf16_f32 v55, v42, v43
    buffer_store_dwordx2 v[54:55], v7, s[16:19], s25 offen offset:1024 sc1
    s_add_u32 s25, s25, 2048
    s_add_u32 s25, s25, 12288
    v_fma_f32 v16, v128, v144, v148
    v_fma_f32 v17, v132, v145, v149
    v_fma_f32 v18, v136, v146, v150
    v_fma_f32 v19, v140, v147, v151
    v_fma_f32 v20, v129, v144, v148
    v_fma_f32 v21, v133, v145, v149
    v_fma_f32 v22, v137, v146, v150
    v_fma_f32 v23, v141, v147, v151
    v_mul_f32 v24, v16, v16
    v_mul_f32 v25, v17, v17
    v_mul_f32 v26, v18, v18
    v_mul_f32 v27, v19, v19
    v_mul_f32 v28, v20, v20
    v_mul_f32 v29, v21, v21
    v_mul_f32 v30, v22, v22
    v_mul_f32 v31, v23, v23
    v_fma_f32 v24, v24, s31, v15
    v_fma_f32 v25, v25, s31, v15
    v_fma_f32 v26, v26, s31, v15
    v_fma_f32 v27, v27, s31, v15
    v_fma_f32 v28, v28, s31, v15
    v_fma_f32 v29, v29, s31, v15
    v_fma_f32 v30, v30, s31, v15
    v_fma_f32 v31, v31, s31, v15
    v_mul_f32 v24, v24, v16
    v_mul_f32 v25, v25, v17
    v_mul_f32 v26, v26, v18
    v_mul_f32 v27, v27, v19
    v_mul_f32 v28, v28, v20
    v_mul_f32 v29, v29, v21
    v_mul_f32 v30, v30, v22
    v_mul_f32 v31, v31, v23
    v_exp_f32 v24, v24
    v_exp_f32 v25, v25
    v_exp_f32 v26, v26
    v_exp_f32 v27, v27
    v_exp_f32 v28, v28
    v_exp_f32 v29, v29
    v_exp_f32 v30, v30
    v_exp_f32 v31, v31
    v_add_f32 v24, 1.0, v24
    v_add_f32 v25, 1.0, v25
    v_add_f32 v26, 1.0, v26
    v_add_f32 v27, 1.0, v27
    v_add_f32 v28, 1.0, v28
    v_add_f32 v29, 1.0, v29
    v_add_f32 v30, 1.0, v30
    v_add_f32 v31, 1.0, v31
    v_rcp_f32 v24, v24
    v_rcp_f32 v25, v25
    v_rcp_f32 v26, v26
    v_rcp_f32 v27, v27
    v_rcp_f32 v28, v28
    v_rcp_f32 v29, v29
    v_rcp_f32 v30, v30
    v_rcp_f32 v31, v31
    v_mul_f32 v16, v16, v24
    v_mul_f32 v17, v17, v25
    v_mul_f32 v18, v18, v26
    v_mul_f32 v19, v19, v27
    v_mul_f32 v20, v20, v28
    v_mul_f32 v21, v21, v29
    v_mul_f32 v22, v22, v30
    v_mul_f32 v23, v23, v31
    v_cvt_pk_bf16_f32 v32, v16, v17
    v_cvt_pk_bf16_f32 v33, v18, v19
    buffer_store_dwordx2 v[32:33], v7, s[16:19], s25 offen offset:0 sc1
    v_cvt_pk_bf16_f32 v34, v20, v21
    v_cvt_pk_bf16_f32 v35, v22, v23
    buffer_store_dwordx2 v[34:35], v7, s[16:19], s25 offen offset:1024 sc1
    s_add_u32 s25, s25, 2048
    v_fma_f32 v36, v130, v144, v148
    v_fma_f32 v37, v134, v145, v149
    v_fma_f32 v38, v138, v146, v150
    v_fma_f32 v39, v142, v147, v151
    v_fma_f32 v40, v131, v144, v148
    v_fma_f32 v41, v135, v145, v149
    v_fma_f32 v42, v139, v146, v150
    v_fma_f32 v43, v143, v147, v151
    v_mul_f32 v44, v36, v36
    v_mul_f32 v45, v37, v37
    v_mul_f32 v46, v38, v38
    v_mul_f32 v47, v39, v39
    v_mul_f32 v48, v40, v40
    v_mul_f32 v49, v41, v41
    v_mul_f32 v50, v42, v42
    v_mul_f32 v51, v43, v43
    v_fma_f32 v44, v44, s31, v15
    v_fma_f32 v45, v45, s31, v15
    v_fma_f32 v46, v46, s31, v15
    v_fma_f32 v47, v47, s31, v15
    v_fma_f32 v48, v48, s31, v15
    v_fma_f32 v49, v49, s31, v15
    v_fma_f32 v50, v50, s31, v15
    v_fma_f32 v51, v51, s31, v15
    v_mul_f32 v44, v44, v36
    v_mul_f32 v45, v45, v37
    v_mul_f32 v46, v46, v38
    v_mul_f32 v47, v47, v39
    v_mul_f32 v48, v48, v40
    v_mul_f32 v49, v49, v41
    v_mul_f32 v50, v50, v42
    v_mul_f32 v51, v51, v43
    v_exp_f32 v44, v44
    v_exp_f32 v45, v45
    v_exp_f32 v46, v46
    v_exp_f32 v47, v47
    v_exp_f32 v48, v48
    v_exp_f32 v49, v49
    v_exp_f32 v50, v50
    v_exp_f32 v51, v51
    v_add_f32 v44, 1.0, v44
    v_add_f32 v45, 1.0, v45
    v_add_f32 v46, 1.0, v46
    v_add_f32 v47, 1.0, v47
    v_add_f32 v48, 1.0, v48
    v_add_f32 v49, 1.0, v49
    v_add_f32 v50, 1.0, v50
    v_add_f32 v51, 1.0, v51
    v_rcp_f32 v44, v44
    v_rcp_f32 v45, v45
    v_rcp_f32 v46, v46
    v_rcp_f32 v47, v47
    v_rcp_f32 v48, v48
    v_rcp_f32 v49, v49
    v_rcp_f32 v50, v50
    v_rcp_f32 v51, v51
    v_mul_f32 v36, v36, v44
    v_mul_f32 v37, v37, v45
    v_mul_f32 v38, v38, v46
    v_mul_f32 v39, v39, v47
    v_mul_f32 v40, v40, v48
    v_mul_f32 v41, v41, v49
    v_mul_f32 v42, v42, v50
    v_mul_f32 v43, v43, v51
    v_cvt_pk_bf16_f32 v52, v36, v37
    v_cvt_pk_bf16_f32 v53, v38, v39
    buffer_store_dwordx2 v[52:53], v7, s[16:19], s25 offen offset:0 sc1
    v_cvt_pk_bf16_f32 v54, v40, v41
    v_cvt_pk_bf16_f32 v55, v42, v43
    buffer_store_dwordx2 v[54:55], v7, s[16:19], s25 offen offset:1024 sc1
    s_add_u32 s25, s25, 2048
    s_add_u32 s25, s25, 12288
K34_END:
    s_endpgm
TEXT_END:
.section .rodata,"a"
.p2align 6
.amdhsa_kernel k1_xform_kernel
  .amdhsa_next_free_vgpr 128
  .amdhsa_next_free_sgpr 96
  .amdhsa_accum_offset 128
  .amdhsa_group_segment_fixed_size 0
  .amdhsa_kernarg_size 56
  .amdhsa_user_sgpr_count 2
  .amdhsa_user_sgpr_kernarg_segment_ptr 1
  .amdhsa_system_sgpr_workgroup_id_x 1
.end_amdhsa_kernel
.p2align 6
.amdhsa_kernel k12_fused_kernel
  .amdhsa_next_free_vgpr 256
  .amdhsa_next_free_sgpr 96
  .amdhsa_accum_offset 256
  .amdhsa_group_segment_fixed_size 0
  .amdhsa_kernarg_size 56
  .amdhsa_user_sgpr_count 2
  .amdhsa_user_sgpr_kernarg_segment_ptr 1
  .amdhsa_system_sgpr_workgroup_id_x 1
.end_amdhsa_kernel
.p2align 6
.amdhsa_kernel k34_out_kernel
  .amdhsa_next_free_vgpr 168
  .amdhsa_next_free_sgpr 96
  .amdhsa_accum_offset 168
  .amdhsa_group_segment_fixed_size 0
  .amdhsa_kernarg_size 56
  .amdhsa_user_sgpr_count 2
  .amdhsa_user_sgpr_kernarg_segment_ptr 1
  .amdhsa_system_sgpr_workgroup_id_x 1
.end_amdhsa_kernel
```

```asm
; @launch kernel=k1_xform_kernel grid=(636,1,1) block=(256,1,1) lds=16384
; @launch kernel=k12_fused_kernel grid=(256,1,1) block=(512,1,1) lds=155872
; @launch kernel=k34_out_kernel grid=(256,1,1) block=(768,1,1) lds=18944
.amdgcn_target "amdgcn-amd-amdhsa--gfx950"
.text
.globl k1_xform_kernel
.globl k12_fused_kernel
.globl k34_out_kernel
.p2align 8
.type k1_xform_kernel,@function
k1_xform_kernel:
    s_cmp_ge_u32 s2, 636
    s_cbranch_scc1 K1_END
    s_load_dwordx4 s[4:7], s[0:1], 0
    s_load_dwordx2 s[8:9], s[0:1], 48
    s_cmp_lt_u32 s2, 8
    s_cbranch_scc0 K1_NOCPF
    s_getpc_b64 s[90:91]
CPF_K1:
    s_sub_u32 s90, s90, CPF_K1-k1_xform_kernel
    s_subb_u32 s91, s91, 0
    v_lshlrev_b32 v8, 7, v0
    v_mov_b32 v11, s91
    v_min_u32 v9, TEXT_END-k1_xform_kernel-4, v8
    v_add_co_u32 v10, vcc, s90, v9
    v_addc_co_u32 v11, vcc, 0, v11, vcc
    global_load_dword v63, v[10:11], off
    v_mov_b32 v11, s91
    v_add_u32 v8, 32768, v8
    v_min_u32 v9, TEXT_END-k1_xform_kernel-4, v8
    v_add_co_u32 v10, vcc, s90, v9
    v_addc_co_u32 v11, vcc, 0, v11, vcc
    global_load_dword v63, v[10:11], off
K1_NOCPF:
    v_lshrrev_b32 v120, 6, v0
    v_and_b32 v121, 63, v0
    v_readfirstlane_b32 s3, v120
    v_and_b32 v122, 15, v121
    v_lshrrev_b32 v123, 4, v121
    s_mov_b32 s28, 0x05040100
    s_mov_b32 s29, 0x07060302
    v_and_b32 v124, 3, v122
    v_lshlrev_b32 v124, 2, v124
    v_lshrrev_b32 v125, 3, v122
    v_lshl_add_u32 v124, v125, 1, v124
    s_lshl_b32 s10, s3, 4
    s_add_u32 s10, s10, 1
    v_add_u32 v124, s10, v124
    v_bfe_u32 v125, v122, 2, 1
    v_lshlrev_b32 v121, 4, v121
    s_waitcnt lgkmcnt(0)
    s_or_b32 s10, s2, s3
    s_cmp_eq_u32 s10, 0
    s_cbranch_scc0 K1_NOCLR
    s_add_u32 s12, s8, 153092096
    s_addc_u32 s13, s9, 0
    s_and_b32 s13, s13, 0xffff
    s_mov_b32 s14, 32768
    s_mov_b32 s15, 0x00020000
    v_lshrrev_b32 v118, 4, v121
    v_lshlrev_b32 v119, 10, v118
    v_mov_b32 v117, 0
    s_mov_b64 exec, 0xffff
    buffer_store_dword v117, v119, s[12:15], 0 offen
    v_lshlrev_b32 v119, 4, v118
    v_add_u32 v119, 16384, v119
    buffer_store_dword v117, v119, s[12:15], 0 offen
    s_mov_b64 exec, -1
K1_NOCLR:
    s_cmp_lt_u32 s2, 32
    s_cbranch_scc0 K1_NOFILL
    s_add_u32 s12, s8, 153616384
    s_addc_u32 s13, s9, 0
    s_and_b32 s13, s13, 0xffff
    s_mov_b32 s14, 131072
    s_mov_b32 s15, 0x00020000
    s_lshl_b32 s10, s2, 2
    s_add_u32 s10, s10, s3
    s_lshl_b32 s10, s10, 10
    v_mov_b32 v112, -1
    v_mov_b32 v113, -1
    v_mov_b32 v114, -1
    v_mov_b32 v115, -1
    buffer_store_dwordx4 v[112:115], v121, s[12:15], s10 offen
K1_NOFILL:
    s_add_u32 s10, s2, 384
    s_sub_u32 s11, s2, 252
    s_cmp_lt_u32 s2, 252
    s_cselect_b32 s2, s10, s11
    s_cmp_lt_u32 s2, 384
    s_cbranch_scc1 K1_W
    s_sub_u32 s11, s2, 384
    s_mul_hi_u32 s13, s11, 1431655766
    s_mul_i32 s12, s13, 3
    s_sub_u32 s12, s11, s12
    s_mov_b32 s11, s13
    s_cmp_ge_u32 s11, 42
    s_cselect_b32 s13, 1, 0
    s_mul_i32 s14, s13, 42
    s_sub_u32 s11, s11, s14
    s_lshl_b32 s11, s11, 2
    s_add_u32 s11, s11, s3
    s_mul_i32 s14, s13, 16384000
    s_add_u32 s16, s4, s14
    s_addc_u32 s17, s5, 0
    s_and_b32 s17, s17, 0xffff
    s_mov_b32 s18, 16384000
    s_mov_b32 s19, 0x00020000
    s_mov_b32 s20, s8
    s_mov_b32 s21, s9
    s_and_b32 s21, s21, 0xffff
    s_mov_b32 s22, 43778048
    s_mov_b32 s23, 0x00020000
    v_lshlrev_b32 v126, 14, v123
    v_lshl_add_u32 v126, v122, 4, v126
    s_mul_i32 s15, s11, 98304
    s_lshl_b32 s24, s12, 8
    s_add_u32 s15, s15, s24
    buffer_load_dwordx4 v[0:3], v126, s[16:19], s15 offen
    buffer_load_dwordx4 v[4:7], v126, s[16:19], s15 offen offset:2048
    s_add_u32 s15, s15, 4096
    buffer_load_dwordx4 v[8:11], v126, s[16:19], s15 offen
    buffer_load_dwordx4 v[12:15], v126, s[16:19], s15 offen offset:2048
    s_add_u32 s15, s15, 4096
    buffer_load_dwordx4 v[16:19], v126, s[16:19], s15 offen
    buffer_load_dwordx4 v[20:23], v126, s[16:19], s15 offen offset:2048
    s_add_u32 s15, s15, 4096
    buffer_load_dwordx4 v[24:27], v126, s[16:19], s15 offen
    buffer_load_dwordx4 v[28:31], v126, s[16:19], s15 offen offset:2048
    s_add_u32 s15, s15, 53248
    buffer_load_dwordx4 v[32:35], v126, s[16:19], s15 offen
    buffer_load_dwordx4 v[36:39], v126, s[16:19], s15 offen offset:2048
    s_add_u32 s15, s15, 4096
    buffer_load_dwordx4 v[40:43], v126, s[16:19], s15 offen
    buffer_load_dwordx4 v[44:47], v126, s[16:19], s15 offen offset:2048
    s_add_u32 s15, s15, 4096
    buffer_load_dwordx4 v[48:51], v126, s[16:19], s15 offen
    buffer_load_dwordx4 v[52:55], v126, s[16:19], s15 offen offset:2048
    s_add_u32 s15, s15, 4096
    buffer_load_dwordx4 v[56:59], v126, s[16:19], s15 offen
    buffer_load_dwordx4 v[60:63], v126, s[16:19], s15 offen offset:2048
    v_lshlrev_b32 v127, 3, v123
    v_lshlrev_b32 v112, 5, v125
    v_mad_u32_u24 v113, v124, v127, v112
    v_mad_u32_u24 v64, v124, 0, v113
    v_mad_u32_u24 v65, v124, 1, v113
    v_mad_u32_u24 v66, v124, 2, v113
    v_mad_u32_u24 v67, v124, 3, v113
    v_mad_u32_u24 v68, v124, 4, v113
    v_mad_u32_u24 v69, v124, 5, v113
    v_mad_u32_u24 v70, v124, 6, v113
    v_mad_u32_u24 v71, v124, 7, v113
    v_and_b32 v64, 127, v64
    v_and_b32 v65, 127, v65
    v_and_b32 v66, 127, v66
    v_and_b32 v67, 127, v67
    v_and_b32 v68, 127, v68
    v_and_b32 v69, 127, v69
    v_and_b32 v70, 127, v70
    v_and_b32 v71, 127, v71
    v_cvt_f32_u32 v64, v64
    v_cvt_f32_u32 v65, v65
    v_cvt_f32_u32 v66, v66
    v_cvt_f32_u32 v67, v67
    v_cvt_f32_u32 v68, v68
    v_cvt_f32_u32 v69, v69
    v_cvt_f32_u32 v70, v70
    v_cvt_f32_u32 v71, v71
    v_mul_f32 v64, 0x3c000000, v64
    v_mul_f32 v65, 0x3c000000, v65
    v_mul_f32 v66, 0x3c000000, v66
    v_mul_f32 v67, 0x3c000000, v67
    v_mul_f32 v68, 0x3c000000, v68
    v_mul_f32 v69, 0x3c000000, v69
    v_mul_f32 v70, 0x3c000000, v70
    v_mul_f32 v71, 0x3c000000, v71
    v_cos_f32 v64, v64
    v_cos_f32 v65, v65
    v_cos_f32 v66, v66
    v_cos_f32 v67, v67
    v_cos_f32 v68, v68
    v_cos_f32 v69, v69
    v_cos_f32 v70, v70
    v_cos_f32 v71, v71
    s_nop 0
    v_cvt_pk_bf16_f32 v72, v64, v65
    v_cvt_pk_bf16_f32 v73, v66, v67
    v_cvt_pk_bf16_f32 v74, v68, v69
    v_cvt_pk_bf16_f32 v75, v70, v71
    v_lshlrev_b32 v80, 16, v72
    v_and_b32 v81, 0xffff0000, v72
    v_sub_f32 v64, v64, v80
    v_sub_f32 v65, v65, v81
    v_lshlrev_b32 v80, 16, v73
    v_and_b32 v81, 0xffff0000, v73
    v_sub_f32 v66, v66, v80
    v_sub_f32 v67, v67, v81
    v_lshlrev_b32 v80, 16, v74
    v_and_b32 v81, 0xffff0000, v74
    v_sub_f32 v68, v68, v80
    v_sub_f32 v69, v69, v81
    v_lshlrev_b32 v80, 16, v75
    v_and_b32 v81, 0xffff0000, v75
    v_sub_f32 v70, v70, v80
    v_sub_f32 v71, v71, v81
    v_cvt_pk_bf16_f32 v76, v64, v65
    v_cvt_pk_bf16_f32 v77, v66, v67
    v_cvt_pk_bf16_f32 v78, v68, v69
    v_cvt_pk_bf16_f32 v79, v70, v71
    s_lshl_b32 s24, s3, 12
    v_add_u32 v114, s24, v121
    ds_write_b128 v114, v[72:75] offset:0
    ds_write_b128 v114, v[76:79] offset:1024
    v_add_u32 v127, 32, v127
    v_lshlrev_b32 v112, 5, v125
    v_mad_u32_u24 v113, v124, v127, v112
    v_mad_u32_u24 v64, v124, 0, v113
    v_mad_u32_u24 v65, v124, 1, v113
    v_mad_u32_u24 v66, v124, 2, v113
    v_mad_u32_u24 v67, v124, 3, v113
    v_mad_u32_u24 v68, v124, 4, v113
    v_mad_u32_u24 v69, v124, 5, v113
    v_mad_u32_u24 v70, v124, 6, v113
    v_mad_u32_u24 v71, v124, 7, v113
    v_and_b32 v64, 127, v64
    v_and_b32 v65, 127, v65
    v_and_b32 v66, 127, v66
    v_and_b32 v67, 127, v67
    v_and_b32 v68, 127, v68
    v_and_b32 v69, 127, v69
    v_and_b32 v70, 127, v70
    v_and_b32 v71, 127, v71
    v_cvt_f32_u32 v64, v64
    v_cvt_f32_u32 v65, v65
    v_cvt_f32_u32 v66, v66
    v_cvt_f32_u32 v67, v67
    v_cvt_f32_u32 v68, v68
    v_cvt_f32_u32 v69, v69
    v_cvt_f32_u32 v70, v70
    v_cvt_f32_u32 v71, v71
    v_mul_f32 v64, 0x3c000000, v64
    v_mul_f32 v65, 0x3c000000, v65
    v_mul_f32 v66, 0x3c000000, v66
    v_mul_f32 v67, 0x3c000000, v67
    v_mul_f32 v68, 0x3c000000, v68
    v_mul_f32 v69, 0x3c000000, v69
    v_mul_f32 v70, 0x3c000000, v70
    v_mul_f32 v71, 0x3c000000, v71
    v_cos_f32 v64, v64
    v_cos_f32 v65, v65
    v_cos_f32 v66, v66
    v_cos_f32 v67, v67
    v_cos_f32 v68, v68
    v_cos_f32 v69, v69
    v_cos_f32 v70, v70
    v_cos_f32 v71, v71
    s_nop 0
    v_cvt_pk_bf16_f32 v72, v64, v65
    v_cvt_pk_bf16_f32 v73, v66, v67
    v_cvt_pk_bf16_f32 v74, v68, v69
    v_cvt_pk_bf16_f32 v75, v70, v71
    v_lshlrev_b32 v80, 16, v72
    v_and_b32 v81, 0xffff0000, v72
    v_sub_f32 v64, v64, v80
    v_sub_f32 v65, v65, v81
    v_lshlrev_b32 v80, 16, v73
    v_and_b32 v81, 0xffff0000, v73
    v_sub_f32 v66, v66, v80
    v_sub_f32 v67, v67, v81
    v_lshlrev_b32 v80, 16, v74
    v_and_b32 v81, 0xffff0000, v74
    v_sub_f32 v68, v68, v80
    v_sub_f32 v69, v69, v81
    v_lshlrev_b32 v80, 16, v75
    v_and_b32 v81, 0xffff0000, v75
    v_sub_f32 v70, v70, v80
    v_sub_f32 v71, v71, v81
    v_cvt_pk_bf16_f32 v76, v64, v65
    v_cvt_pk_bf16_f32 v77, v66, v67
    v_cvt_pk_bf16_f32 v78, v68, v69
    v_cvt_pk_bf16_f32 v79, v70, v71
    s_lshl_b32 s24, s3, 12
    v_add_u32 v114, s24, v121
    ds_write_b128 v114, v[72:75] offset:2048
    ds_write_b128 v114, v[76:79] offset:3072
    v_lshrrev_b32 v112, 1, v123
    s_mov_b32 s24, 1368064
    v_mul_lo_u32 v112, v112, s24
    v_lshrrev_b32 v113, 2, v122
    s_mov_b32 s24, 21376
    v_mul_lo_u32 v113, v113, s24
    v_add_u32 v112, v112, v113
    v_and_b32 v113, 3, v122
    v_and_b32 v114, 1, v123
    v_lshl_add_u32 v113, v114, 2, v113
    s_add_u32 s24, s11, 7
    s_cmp_ge_u32 s11, 160
    s_cselect_b32 s24, s24, s11
    s_cmp_eq_u32 s13, 1
    s_cselect_b32 s24, s24, s11
    s_lshr_b32 s24, s24, 1
    s_and_b32 s24, s24, 7
    v_xor_b32 v113, s24, v113
    v_lshl_add_u32 v120, v113, 4, v112
    s_mul_i32 s25, s13, 684032
    s_mul_i32 s24, s12, 85504
    s_add_u32 s25, s25, s24
    s_lshl_b32 s24, s11, 7
    s_add_u32 s25, s25, s24
    s_waitcnt lgkmcnt(0)
    s_barrier
    s_cmp_ge_u32 s11, 167
    s_cbranch_scc1 K1_END
    s_waitcnt vmcnt(8)
    v_perm_b32 v64, v4, v0, s28
    v_perm_b32 v68, v4, v0, s29
    v_perm_b32 v65, v12, v8, s28
    v_perm_b32 v69, v12, v8, s29
    v_perm_b32 v66, v20, v16, s28
    v_perm_b32 v70, v20, v16, s29
    v_perm_b32 v67, v28, v24, s28
    v_perm_b32 v71, v28, v24, s29
    v_perm_b32 v72, v5, v1, s28
    v_perm_b32 v76, v5, v1, s29
    v_perm_b32 v73, v13, v9, s28
    v_perm_b32 v77, v13, v9, s29
    v_perm_b32 v74, v21, v17, s28
    v_perm_b32 v78, v21, v17, s29
    v_perm_b32 v75, v29, v25, s28
    v_perm_b32 v79, v29, v25, s29
    v_perm_b32 v80, v6, v2, s28
    v_perm_b32 v84, v6, v2, s29
    v_perm_b32 v81, v14, v10, s28
    v_perm_b32 v85, v14, v10, s29
    v_perm_b32 v82, v22, v18, s28
    v_perm_b32 v86, v22, v18, s29
    v_perm_b32 v83, v30, v26, s28
    v_perm_b32 v87, v30, v26, s29
    v_perm_b32 v88, v7, v3, s28
    v_perm_b32 v92, v7, v3, s29
    v_perm_b32 v89, v15, v11, s28
    v_perm_b32 v93, v15, v11, s29
    v_perm_b32 v90, v23, v19, s28
    v_perm_b32 v94, v23, v19, s29
    v_perm_b32 v91, v31, v27, s28
    v_perm_b32 v95, v31, v27, s29
    s_waitcnt vmcnt(0)
    v_perm_b32 v0, v36, v32, s28
    v_perm_b32 v4, v36, v32, s29
    v_perm_b32 v1, v44, v40, s28
    v_perm_b32 v5, v44, v40, s29
    v_perm_b32 v2, v52, v48, s28
    v_perm_b32 v6, v52, v48, s29
    v_perm_b32 v3, v60, v56, s28
    v_perm_b32 v7, v60, v56, s29
    v_perm_b32 v8, v37, v33, s28
    v_perm_b32 v12, v37, v33, s29
    v_perm_b32 v9, v45, v41, s28
    v_perm_b32 v13, v45, v41, s29
    v_perm_b32 v10, v53, v49, s28
    v_perm_b32 v14, v53, v49, s29
    v_perm_b32 v11, v61, v57, s28
    v_perm_b32 v15, v61, v57, s29
    v_perm_b32 v16, v38, v34, s28
    v_perm_b32 v20, v38, v34, s29
    v_perm_b32 v17, v46, v42, s28
    v_perm_b32 v21, v46, v42, s29
    v_perm_b32 v18, v54, v50, s28
    v_perm_b32 v22, v54, v50, s29
    v_perm_b32 v19, v62, v58, s28
    v_perm_b32 v23, v62, v58, s29
    v_perm_b32 v24, v39, v35, s28
    v_perm_b32 v28, v39, v35, s29
    v_perm_b32 v25, v47, v43, s28
    v_perm_b32 v29, v47, v43, s29
    v_perm_b32 v26, v55, v51, s28
    v_perm_b32 v30, v55, v51, s29
    v_perm_b32 v27, v63, v59, s28
    v_perm_b32 v31, v63, v59, s29
    ds_read_b128 v[96:99], v121 offset:0
    ds_read_b128 v[100:103], v121 offset:1024
    ds_read_b128 v[104:107], v121 offset:2048
    ds_read_b128 v[108:111], v121 offset:3072
    s_waitcnt lgkmcnt(3)
    v_mfma_f32_16x16x32_bf16 v[32:35], v[96:99], v[64:67], 0
    v_mfma_f32_16x16x32_bf16 v[36:39], v[96:99], v[68:71], 0
    v_mfma_f32_16x16x32_bf16 v[40:43], v[96:99], v[72:75], 0
    v_mfma_f32_16x16x32_bf16 v[44:47], v[96:99], v[76:79], 0
    v_mfma_f32_16x16x32_bf16 v[48:51], v[96:99], v[80:83], 0
    v_mfma_f32_16x16x32_bf16 v[52:55], v[96:99], v[84:87], 0
    v_mfma_f32_16x16x32_bf16 v[56:59], v[96:99], v[88:91], 0
    v_mfma_f32_16x16x32_bf16 v[60:63], v[96:99], v[92:95], 0
    s_waitcnt lgkmcnt(2)
    v_mfma_f32_16x16x32_bf16 v[32:35], v[100:103], v[64:67], v[32:35]
    v_mfma_f32_16x16x32_bf16 v[36:39], v[100:103], v[68:71], v[36:39]
    v_mfma_f32_16x16x32_bf16 v[40:43], v[100:103], v[72:75], v[40:43]
    v_mfma_f32_16x16x32_bf16 v[44:47], v[100:103], v[76:79], v[44:47]
    v_mfma_f32_16x16x32_bf16 v[48:51], v[100:103], v[80:83], v[48:51]
    v_mfma_f32_16x16x32_bf16 v[52:55], v[100:103], v[84:87], v[52:55]
    v_mfma_f32_16x16x32_bf16 v[56:59], v[100:103], v[88:91], v[56:59]
    v_mfma_f32_16x16x32_bf16 v[60:63], v[100:103], v[92:95], v[60:63]
    s_waitcnt lgkmcnt(1)
    v_mfma_f32_16x16x32_bf16 v[32:35], v[104:107], v[0:3], v[32:35]
    v_mfma_f32_16x16x32_bf16 v[36:39], v[104:107], v[4:7], v[36:39]
    v_mfma_f32_16x16x32_bf16 v[40:43], v[104:107], v[8:11], v[40:43]
    v_mfma_f32_16x16x32_bf16 v[44:47], v[104:107], v[12:15], v[44:47]
    v_mfma_f32_16x16x32_bf16 v[48:51], v[104:107], v[16:19], v[48:51]
    v_mfma_f32_16x16x32_bf16 v[52:55], v[104:107], v[20:23], v[52:55]
    v_mfma_f32_16x16x32_bf16 v[56:59], v[104:107], v[24:27], v[56:59]
    v_mfma_f32_16x16x32_bf16 v[60:63], v[104:107], v[28:31], v[60:63]
    s_waitcnt lgkmcnt(0)
    v_mfma_f32_16x16x32_bf16 v[32:35], v[108:111], v[0:3], v[32:35]
    v_mfma_f32_16x16x32_bf16 v[36:39], v[108:111], v[4:7], v[36:39]
    v_mfma_f32_16x16x32_bf16 v[40:43], v[108:111], v[8:11], v[40:43]
    v_mfma_f32_16x16x32_bf16 v[44:47], v[108:111], v[12:15], v[44:47]
    v_mfma_f32_16x16x32_bf16 v[48:51], v[108:111], v[16:19], v[48:51]
    v_mfma_f32_16x16x32_bf16 v[52:55], v[108:111], v[20:23], v[52:55]
    v_mfma_f32_16x16x32_bf16 v[56:59], v[108:111], v[24:27], v[56:59]
    v_mfma_f32_16x16x32_bf16 v[60:63], v[108:111], v[28:31], v[60:63]
    s_nop 7
    v_cvt_pk_bf16_f32 v112, v32, v36
    v_cvt_pk_bf16_f32 v113, v40, v44
    v_cvt_pk_bf16_f32 v114, v48, v52
    v_cvt_pk_bf16_f32 v115, v56, v60
    buffer_store_dwordx4 v[112:115], v120, s[20:23], s25 offen
    s_add_u32 s25, s25, 2736128
    v_cvt_pk_bf16_f32 v116, v33, v37
    v_cvt_pk_bf16_f32 v117, v41, v45
    v_cvt_pk_bf16_f32 v118, v49, v53
    v_cvt_pk_bf16_f32 v119, v57, v61
    buffer_store_dwordx4 v[116:119], v120, s[20:23], s25 offen
    s_add_u32 s25, s25, 2736128
    v_cvt_pk_bf16_f32 v112, v34, v38
    v_cvt_pk_bf16_f32 v113, v42, v46
    v_cvt_pk_bf16_f32 v114, v50, v54
    v_cvt_pk_bf16_f32 v115, v58, v62
    buffer_store_dwordx4 v[112:115], v120, s[20:23], s25 offen
    s_add_u32 s25, s25, 2736128
    v_cvt_pk_bf16_f32 v116, v35, v39
    v_cvt_pk_bf16_f32 v117, v43, v47
    v_cvt_pk_bf16_f32 v118, v51, v55
    v_cvt_pk_bf16_f32 v119, v59, v63
    buffer_store_dwordx4 v[116:119], v120, s[20:23], s25 offen
    s_add_u32 s25, s25, 2736128
    ds_read_b128 v[96:99], v121 offset:4096
    ds_read_b128 v[100:103], v121 offset:5120
    ds_read_b128 v[104:107], v121 offset:6144
    ds_read_b128 v[108:111], v121 offset:7168
    s_waitcnt lgkmcnt(3)
    v_mfma_f32_16x16x32_bf16 v[32:35], v[96:99], v[64:67], 0
    v_mfma_f32_16x16x32_bf16 v[36:39], v[96:99], v[68:71], 0
    v_mfma_f32_16x16x32_bf16 v[40:43], v[96:99], v[72:75], 0
    v_mfma_f32_16x16x32_bf16 v[44:47], v[96:99], v[76:79], 0
    v_mfma_f32_16x16x32_bf16 v[48:51], v[96:99], v[80:83], 0
    v_mfma_f32_16x16x32_bf16 v[52:55], v[96:99], v[84:87], 0
    v_mfma_f32_16x16x32_bf16 v[56:59], v[96:99], v[88:91], 0
    v_mfma_f32_16x16x32_bf16 v[60:63], v[96:99], v[92:95], 0
    s_waitcnt lgkmcnt(2)
    v_mfma_f32_16x16x32_bf16 v[32:35], v[100:103], v[64:67], v[32:35]
    v_mfma_f32_16x16x32_bf16 v[36:39], v[100:103], v[68:71], v[36:39]
    v_mfma_f32_16x16x32_bf16 v[40:43], v[100:103], v[72:75], v[40:43]
    v_mfma_f32_16x16x32_bf16 v[44:47], v[100:103], v[76:79], v[44:47]
    v_mfma_f32_16x16x32_bf16 v[48:51], v[100:103], v[80:83], v[48:51]
    v_mfma_f32_16x16x32_bf16 v[52:55], v[100:103], v[84:87], v[52:55]
    v_mfma_f32_16x16x32_bf16 v[56:59], v[100:103], v[88:91], v[56:59]
    v_mfma_f32_16x16x32_bf16 v[60:63], v[100:103], v[92:95], v[60:63]
    s_waitcnt lgkmcnt(1)
    v_mfma_f32_16x16x32_bf16 v[32:35], v[104:107], v[0:3], v[32:35]
    v_mfma_f32_16x16x32_bf16 v[36:39], v[104:107], v[4:7], v[36:39]
    v_mfma_f32_16x16x32_bf16 v[40:43], v[104:107], v[8:11], v[40:43]
    v_mfma_f32_16x16x32_bf16 v[44:47], v[104:107], v[12:15], v[44:47]
    v_mfma_f32_16x16x32_bf16 v[48:51], v[104:107], v[16:19], v[48:51]
    v_mfma_f32_16x16x32_bf16 v[52:55], v[104:107], v[20:23], v[52:55]
    v_mfma_f32_16x16x32_bf16 v[56:59], v[104:107], v[24:27], v[56:59]
    v_mfma_f32_16x16x32_bf16 v[60:63], v[104:107], v[28:31], v[60:63]
    s_waitcnt lgkmcnt(0)
    v_mfma_f32_16x16x32_bf16 v[32:35], v[108:111], v[0:3], v[32:35]
    v_mfma_f32_16x16x32_bf16 v[36:39], v[108:111], v[4:7], v[36:39]
    v_mfma_f32_16x16x32_bf16 v[40:43], v[108:111], v[8:11], v[40:43]
    v_mfma_f32_16x16x32_bf16 v[44:47], v[108:111], v[12:15], v[44:47]
    v_mfma_f32_16x16x32_bf16 v[48:51], v[108:111], v[16:19], v[48:51]
    v_mfma_f32_16x16x32_bf16 v[52:55], v[108:111], v[20:23], v[52:55]
    v_mfma_f32_16x16x32_bf16 v[56:59], v[108:111], v[24:27], v[56:59]
    v_mfma_f32_16x16x32_bf16 v[60:63], v[108:111], v[28:31], v[60:63]
    s_nop 7
    v_cvt_pk_bf16_f32 v112, v32, v36
    v_cvt_pk_bf16_f32 v113, v40, v44
    v_cvt_pk_bf16_f32 v114, v48, v52
    v_cvt_pk_bf16_f32 v115, v56, v60
    buffer_store_dwordx4 v[112:115], v120, s[20:23], s25 offen
    s_add_u32 s25, s25, 2736128
    v_cvt_pk_bf16_f32 v116, v33, v37
    v_cvt_pk_bf16_f32 v117, v41, v45
    v_cvt_pk_bf16_f32 v118, v49, v53
    v_cvt_pk_bf16_f32 v119, v57, v61
    buffer_store_dwordx4 v[116:119], v120, s[20:23], s25 offen
    s_add_u32 s25, s25, 2736128
    v_cvt_pk_bf16_f32 v112, v34, v38
    v_cvt_pk_bf16_f32 v113, v42, v46
    v_cvt_pk_bf16_f32 v114, v50, v54
    v_cvt_pk_bf16_f32 v115, v58, v62
    buffer_store_dwordx4 v[112:115], v120, s[20:23], s25 offen
    s_add_u32 s25, s25, 2736128
    v_cvt_pk_bf16_f32 v116, v35, v39
    v_cvt_pk_bf16_f32 v117, v43, v47
    v_cvt_pk_bf16_f32 v118, v51, v55
    v_cvt_pk_bf16_f32 v119, v59, v63
    buffer_store_dwordx4 v[116:119], v120, s[20:23], s25 offen
    s_add_u32 s25, s25, 2736128
    ds_read_b128 v[96:99], v121 offset:8192
    ds_read_b128 v[100:103], v121 offset:9216
    ds_read_b128 v[104:107], v121 offset:10240
    ds_read_b128 v[108:111], v121 offset:11264
    s_waitcnt lgkmcnt(3)
    v_mfma_f32_16x16x32_bf16 v[32:35], v[96:99], v[64:67], 0
    v_mfma_f32_16x16x32_bf16 v[36:39], v[96:99], v[68:71], 0
    v_mfma_f32_16x16x32_bf16 v[40:43], v[96:99], v[72:75], 0
    v_mfma_f32_16x16x32_bf16 v[44:47], v[96:99], v[76:79], 0
    v_mfma_f32_16x16x32_bf16 v[48:51], v[96:99], v[80:83], 0
    v_mfma_f32_16x16x32_bf16 v[52:55], v[96:99], v[84:87], 0
    v_mfma_f32_16x16x32_bf16 v[56:59], v[96:99], v[88:91], 0
    v_mfma_f32_16x16x32_bf16 v[60:63], v[96:99], v[92:95], 0
    s_waitcnt lgkmcnt(2)
    v_mfma_f32_16x16x32_bf16 v[32:35], v[100:103], v[64:67], v[32:35]
    v_mfma_f32_16x16x32_bf16 v[36:39], v[100:103], v[68:71], v[36:39]
    v_mfma_f32_16x16x32_bf16 v[40:43], v[100:103], v[72:75], v[40:43]
    v_mfma_f32_16x16x32_bf16 v[44:47], v[100:103], v[76:79], v[44:47]
    v_mfma_f32_16x16x32_bf16 v[48:51], v[100:103], v[80:83], v[48:51]
    v_mfma_f32_16x16x32_bf16 v[52:55], v[100:103], v[84:87], v[52:55]
    v_mfma_f32_16x16x32_bf16 v[56:59], v[100:103], v[88:91], v[56:59]
    v_mfma_f32_16x16x32_bf16 v[60:63], v[100:103], v[92:95], v[60:63]
    s_waitcnt lgkmcnt(1)
    v_mfma_f32_16x16x32_bf16 v[32:35], v[104:107], v[0:3], v[32:35]
    v_mfma_f32_16x16x32_bf16 v[36:39], v[104:107], v[4:7], v[36:39]
    v_mfma_f32_16x16x32_bf16 v[40:43], v[104:107], v[8:11], v[40:43]
    v_mfma_f32_16x16x32_bf16 v[44:47], v[104:107], v[12:15], v[44:47]
    v_mfma_f32_16x16x32_bf16 v[48:51], v[104:107], v[16:19], v[48:51]
    v_mfma_f32_16x16x32_bf16 v[52:55], v[104:107], v[20:23], v[52:55]
    v_mfma_f32_16x16x32_bf16 v[56:59], v[104:107], v[24:27], v[56:59]
    v_mfma_f32_16x16x32_bf16 v[60:63], v[104:107], v[28:31], v[60:63]
    s_waitcnt lgkmcnt(0)
    v_mfma_f32_16x16x32_bf16 v[32:35], v[108:111], v[0:3], v[32:35]
    v_mfma_f32_16x16x32_bf16 v[36:39], v[108:111], v[4:7], v[36:39]
    v_mfma_f32_16x16x32_bf16 v[40:43], v[108:111], v[8:11], v[40:43]
    v_mfma_f32_16x16x32_bf16 v[44:47], v[108:111], v[12:15], v[44:47]
    v_mfma_f32_16x16x32_bf16 v[48:51], v[108:111], v[16:19], v[48:51]
    v_mfma_f32_16x16x32_bf16 v[52:55], v[108:111], v[20:23], v[52:55]
    v_mfma_f32_16x16x32_bf16 v[56:59], v[108:111], v[24:27], v[56:59]
    v_mfma_f32_16x16x32_bf16 v[60:63], v[108:111], v[28:31], v[60:63]
    s_nop 7
    v_cvt_pk_bf16_f32 v112, v32, v36
    v_cvt_pk_bf16_f32 v113, v40, v44
    v_cvt_pk_bf16_f32 v114, v48, v52
    v_cvt_pk_bf16_f32 v115, v56, v60
    buffer_store_dwordx4 v[112:115], v120, s[20:23], s25 offen
    s_add_u32 s25, s25, 2736128
    v_cvt_pk_bf16_f32 v116, v33, v37
    v_cvt_pk_bf16_f32 v117, v41, v45
    v_cvt_pk_bf16_f32 v118, v49, v53
    v_cvt_pk_bf16_f32 v119, v57, v61
    buffer_store_dwordx4 v[116:119], v120, s[20:23], s25 offen
    s_add_u32 s25, s25, 2736128
    v_cvt_pk_bf16_f32 v112, v34, v38
    v_cvt_pk_bf16_f32 v113, v42, v46
    v_cvt_pk_bf16_f32 v114, v50, v54
    v_cvt_pk_bf16_f32 v115, v58, v62
    buffer_store_dwordx4 v[112:115], v120, s[20:23], s25 offen
    s_add_u32 s25, s25, 2736128
    v_cvt_pk_bf16_f32 v116, v35, v39
    v_cvt_pk_bf16_f32 v117, v43, v47
    v_cvt_pk_bf16_f32 v118, v51, v55
    v_cvt_pk_bf16_f32 v119, v59, v63
    buffer_store_dwordx4 v[116:119], v120, s[20:23], s25 offen
    s_add_u32 s25, s25, 2736128
    ds_read_b128 v[96:99], v121 offset:12288
    ds_read_b128 v[100:103], v121 offset:13312
    ds_read_b128 v[104:107], v121 offset:14336
    ds_read_b128 v[108:111], v121 offset:15360
    s_waitcnt lgkmcnt(3)
    v_mfma_f32_16x16x32_bf16 v[32:35], v[96:99], v[64:67], 0
    v_mfma_f32_16x16x32_bf16 v[36:39], v[96:99], v[68:71], 0
    v_mfma_f32_16x16x32_bf16 v[40:43], v[96:99], v[72:75], 0
    v_mfma_f32_16x16x32_bf16 v[44:47], v[96:99], v[76:79], 0
    v_mfma_f32_16x16x32_bf16 v[48:51], v[96:99], v[80:83], 0
    v_mfma_f32_16x16x32_bf16 v[52:55], v[96:99], v[84:87], 0
    v_mfma_f32_16x16x32_bf16 v[56:59], v[96:99], v[88:91], 0
    v_mfma_f32_16x16x32_bf16 v[60:63], v[96:99], v[92:95], 0
    s_waitcnt lgkmcnt(2)
    v_mfma_f32_16x16x32_bf16 v[32:35], v[100:103], v[64:67], v[32:35]
    v_mfma_f32_16x16x32_bf16 v[36:39], v[100:103], v[68:71], v[36:39]
    v_mfma_f32_16x16x32_bf16 v[40:43], v[100:103], v[72:75], v[40:43]
    v_mfma_f32_16x16x32_bf16 v[44:47], v[100:103], v[76:79], v[44:47]
    v_mfma_f32_16x16x32_bf16 v[48:51], v[100:103], v[80:83], v[48:51]
    v_mfma_f32_16x16x32_bf16 v[52:55], v[100:103], v[84:87], v[52:55]
    v_mfma_f32_16x16x32_bf16 v[56:59], v[100:103], v[88:91], v[56:59]
    v_mfma_f32_16x16x32_bf16 v[60:63], v[100:103], v[92:95], v[60:63]
    s_waitcnt lgkmcnt(1)
    v_mfma_f32_16x16x32_bf16 v[32:35], v[104:107], v[0:3], v[32:35]
    v_mfma_f32_16x16x32_bf16 v[36:39], v[104:107], v[4:7], v[36:39]
    v_mfma_f32_16x16x32_bf16 v[40:43], v[104:107], v[8:11], v[40:43]
    v_mfma_f32_16x16x32_bf16 v[44:47], v[104:107], v[12:15], v[44:47]
    v_mfma_f32_16x16x32_bf16 v[48:51], v[104:107], v[16:19], v[48:51]
    v_mfma_f32_16x16x32_bf16 v[52:55], v[104:107], v[20:23], v[52:55]
    v_mfma_f32_16x16x32_bf16 v[56:59], v[104:107], v[24:27], v[56:59]
    v_mfma_f32_16x16x32_bf16 v[60:63], v[104:107], v[28:31], v[60:63]
    s_waitcnt lgkmcnt(0)
    v_mfma_f32_16x16x32_bf16 v[32:35], v[108:111], v[0:3], v[32:35]
    v_mfma_f32_16x16x32_bf16 v[36:39], v[108:111], v[4:7], v[36:39]
    v_mfma_f32_16x16x32_bf16 v[40:43], v[108:111], v[8:11], v[40:43]
    v_mfma_f32_16x16x32_bf16 v[44:47], v[108:111], v[12:15], v[44:47]
    v_mfma_f32_16x16x32_bf16 v[48:51], v[108:111], v[16:19], v[48:51]
    v_mfma_f32_16x16x32_bf16 v[52:55], v[108:111], v[20:23], v[52:55]
    v_mfma_f32_16x16x32_bf16 v[56:59], v[108:111], v[24:27], v[56:59]
    v_mfma_f32_16x16x32_bf16 v[60:63], v[108:111], v[28:31], v[60:63]
    s_nop 7
    v_cvt_pk_bf16_f32 v112, v32, v36
    v_cvt_pk_bf16_f32 v113, v40, v44
    v_cvt_pk_bf16_f32 v114, v48, v52
    v_cvt_pk_bf16_f32 v115, v56, v60
    buffer_store_dwordx4 v[112:115], v120, s[20:23], s25 offen
    s_add_u32 s25, s25, 2736128
    v_cvt_pk_bf16_f32 v116, v33, v37
    v_cvt_pk_bf16_f32 v117, v41, v45
    v_cvt_pk_bf16_f32 v118, v49, v53
    v_cvt_pk_bf16_f32 v119, v57, v61
    buffer_store_dwordx4 v[116:119], v120, s[20:23], s25 offen
    s_add_u32 s25, s25, 2736128
    v_cvt_pk_bf16_f32 v112, v34, v38
    v_cvt_pk_bf16_f32 v113, v42, v46
    v_cvt_pk_bf16_f32 v114, v50, v54
    v_cvt_pk_bf16_f32 v115, v58, v62
    buffer_store_dwordx4 v[112:115], v120, s[20:23], s25 offen
    s_add_u32 s25, s25, 2736128
    v_cvt_pk_bf16_f32 v116, v35, v39
    v_cvt_pk_bf16_f32 v117, v43, v47
    v_cvt_pk_bf16_f32 v118, v51, v55
    v_cvt_pk_bf16_f32 v119, v59, v63
    buffer_store_dwordx4 v[116:119], v120, s[20:23], s25 offen
    s_endpgm
K1_W:
    s_mov_b32 s16, s6
    s_mov_b32 s17, s7
    s_and_b32 s17, s17, 0xffff
    s_mov_b32 s18, 16252928
    s_mov_b32 s19, 0x00020000
    s_add_u32 s20, s8, 50331648
    s_addc_u32 s21, s9, 0
    s_and_b32 s21, s21, 0xffff
    s_mov_b32 s22, 67108864
    s_mov_b32 s23, 0x00020000
    s_mul_i32 s11, s2, 1
    s_lshr_b32 s12, s11, 9
    s_and_b32 s13, s11, 511
    s_lshl_b32 s14, s12, 19
    s_lshl_b32 s15, s13, 10
    s_add_u32 s14, s14, s15
    s_lshl_b32 s15, s3, 8
    s_add_u32 s14, s14, s15
    v_and_b32 v126, 1, v123
    v_lshlrev_b32 v126, 23, v126
    v_lshl_add_u32 v126, v122, 4, v126
    s_mov_b32 s15, s14
    buffer_load_dwordx4 v[0:3], v126, s[16:19], s15 offen
    s_add_u32 s15, s15, 0x100000
    buffer_load_dwordx4 v[4:7], v126, s[16:19], s15 offen
    s_add_u32 s15, s15, 0x100000
    buffer_load_dwordx4 v[8:11], v126, s[16:19], s15 offen
    s_add_u32 s15, s15, 0x100000
    buffer_load_dwordx4 v[12:15], v126, s[16:19], s15 offen
    s_add_u32 s15, s15, 0x100000
    buffer_load_dwordx4 v[16:19], v126, s[16:19], s15 offen
    s_add_u32 s15, s15, 0x100000
    buffer_load_dwordx4 v[20:23], v126, s[16:19], s15 offen
    s_add_u32 s15, s15, 0x100000
    buffer_load_dwordx4 v[24:27], v126, s[16:19], s15 offen
    s_add_u32 s15, s15, 0x100000
    buffer_load_dwordx4 v[28:31], v126, s[16:19], s15 offen
    v_and_b32 v127, 1, v123
    v_lshlrev_b32 v127, 3, v127
    v_mul_u32_u24 v112, 96, v125
    v_mad_u32_u24 v113, v124, v127, v112
    v_mad_u32_u24 v64, v124, 0, v113
    v_mad_u32_u24 v65, v124, 1, v113
    v_mad_u32_u24 v66, v124, 2, v113
    v_mad_u32_u24 v67, v124, 3, v113
    v_mad_u32_u24 v68, v124, 4, v113
    v_mad_u32_u24 v69, v124, 5, v113
    v_mad_u32_u24 v70, v124, 6, v113
    v_mad_u32_u24 v71, v124, 7, v113
    v_and_b32 v64, 127, v64
    v_and_b32 v65, 127, v65
    v_and_b32 v66, 127, v66
    v_and_b32 v67, 127, v67
    v_and_b32 v68, 127, v68
    v_and_b32 v69, 127, v69
    v_and_b32 v70, 127, v70
    v_and_b32 v71, 127, v71
    v_cvt_f32_u32 v64, v64
    v_cvt_f32_u32 v65, v65
    v_cvt_f32_u32 v66, v66
    v_cvt_f32_u32 v67, v67
    v_cvt_f32_u32 v68, v68
    v_cvt_f32_u32 v69, v69
    v_cvt_f32_u32 v70, v70
    v_cvt_f32_u32 v71, v71
    v_mul_f32 v64, 0x3c000000, v64
    v_mul_f32 v65, 0x3c000000, v65
    v_mul_f32 v66, 0x3c000000, v66
    v_mul_f32 v67, 0x3c000000, v67
    v_mul_f32 v68, 0x3c000000, v68
    v_mul_f32 v69, 0x3c000000, v69
    v_mul_f32 v70, 0x3c000000, v70
    v_mul_f32 v71, 0x3c000000, v71
    v_cos_f32 v64, v64
    v_cos_f32 v65, v65
    v_cos_f32 v66, v66
    v_cos_f32 v67, v67
    v_cos_f32 v68, v68
    v_cos_f32 v69, v69
    v_cos_f32 v70, v70
    v_cos_f32 v71, v71
    s_nop 0
    v_cvt_pk_bf16_f32 v72, v64, v65
    v_cvt_pk_bf16_f32 v73, v66, v67
    v_cvt_pk_bf16_f32 v74, v68, v69
    v_cvt_pk_bf16_f32 v75, v70, v71
    v_lshlrev_b32 v80, 16, v72
    v_and_b32 v81, 0xffff0000, v72
    v_sub_f32 v64, v64, v80
    v_sub_f32 v65, v65, v81
    v_lshlrev_b32 v80, 16, v73
    v_and_b32 v81, 0xffff0000, v73
    v_sub_f32 v66, v66, v80
    v_sub_f32 v67, v67, v81
    v_lshlrev_b32 v80, 16, v74
    v_and_b32 v81, 0xffff0000, v74
    v_sub_f32 v68, v68, v80
    v_sub_f32 v69, v69, v81
    v_lshlrev_b32 v80, 16, v75
    v_and_b32 v81, 0xffff0000, v75
    v_sub_f32 v70, v70, v80
    v_sub_f32 v71, v71, v81
    v_cvt_pk_bf16_f32 v76, v64, v65
    v_cvt_pk_bf16_f32 v77, v66, v67
    v_cvt_pk_bf16_f32 v78, v68, v69
    v_cvt_pk_bf16_f32 v79, v70, v71
    v_cmp_lt_u32 vcc, 1, v123
    s_lshl_b32 s24, s3, 10
    v_add_u32 v114, s24, v121
    v_cndmask_b32 v72, v72, v76, vcc
    v_cndmask_b32 v73, v73, v77, vcc
    v_cndmask_b32 v74, v74, v78, vcc
    v_cndmask_b32 v75, v75, v79, vcc
    ds_write_b128 v114, v[72:75]
    v_lshrrev_b32 v112, 1, v123
    s_mov_b32 s24, 2097152
    v_mul_lo_u32 v112, v112, s24
    v_and_b32 v113, 1, v123
    v_lshl_add_u32 v112, v113, 8, v112
    v_and_b32 v113, 1, v122
    v_lshl_add_u32 v124, v113, 4, v112
    v_lshrrev_b32 v125, 1, v122
    s_mul_i32 s26, s3, 524288
    s_lshl_b32 s24, s11, 9
    s_add_u32 s26, s26, s24
    s_waitcnt lgkmcnt(0)
    s_barrier
    ds_read_b128 v[96:99], v121 offset:0
    ds_read_b128 v[100:103], v121 offset:1024
    ds_read_b128 v[104:107], v121 offset:2048
    ds_read_b128 v[108:111], v121 offset:3072
    s_mov_b32 s27, 0
    s_waitcnt vmcnt(0) lgkmcnt(0)
K1_W_LOOP:
    s_add_u32 s24, s11, s27
    s_and_b32 s30, s24, 3
    s_lshr_b32 s24, s24, 1
    s_and_b32 s24, s24, 4
    s_or_b32 s30, s30, s24
    v_xor_b32 v112, s30, v125
    v_lshl_add_u32 v120, v112, 5, v124
    s_lshl_b32 s25, s27, 9
    s_add_u32 s25, s25, s26
    v_perm_b32 v32, v4, v0, s28
    v_perm_b32 v36, v4, v0, s29
    v_perm_b32 v33, v12, v8, s28
    v_perm_b32 v37, v12, v8, s29
    v_perm_b32 v34, v20, v16, s28
    v_perm_b32 v38, v20, v16, s29
    v_perm_b32 v35, v28, v24, s28
    v_perm_b32 v39, v28, v24, s29
    v_perm_b32 v40, v5, v1, s28
    v_perm_b32 v44, v5, v1, s29
    v_perm_b32 v41, v13, v9, s28
    v_perm_b32 v45, v13, v9, s29
    v_perm_b32 v42, v21, v17, s28
    v_perm_b32 v46, v21, v17, s29
    v_perm_b32 v43, v29, v25, s28
    v_perm_b32 v47, v29, v25, s29
    v_perm_b32 v48, v6, v2, s28
    v_perm_b32 v52, v6, v2, s29
    v_perm_b32 v49, v14, v10, s28
    v_perm_b32 v53, v14, v10, s29
    v_perm_b32 v50, v22, v18, s28
    v_perm_b32 v54, v22, v18, s29
    v_perm_b32 v51, v30, v26, s28
    v_perm_b32 v55, v30, v26, s29
    v_perm_b32 v56, v7, v3, s28
    v_perm_b32 v60, v7, v3, s29
    v_perm_b32 v57, v15, v11, s28
    v_perm_b32 v61, v15, v11, s29
    v_perm_b32 v58, v23, v19, s28
    v_perm_b32 v62, v23, v19, s29
    v_perm_b32 v59, v31, v27, s28
    v_perm_b32 v63, v31, v27, s29
    s_add_u32 s27, s27, 1
    s_add_u32 s14, s14, 1024
    s_cmp_ge_u32 s27, 1
    s_cbranch_scc1 K1_W_NOLOAD
    s_mov_b32 s15, s14
    buffer_load_dwordx4 v[0:3], v126, s[16:19], s15 offen
    s_add_u32 s15, s15, 0x100000
    buffer_load_dwordx4 v[4:7], v126, s[16:19], s15 offen
    s_add_u32 s15, s15, 0x100000
    buffer_load_dwordx4 v[8:11], v126, s[16:19], s15 offen
    s_add_u32 s15, s15, 0x100000
    buffer_load_dwordx4 v[12:15], v126, s[16:19], s15 offen
    s_add_u32 s15, s15, 0x100000
    buffer_load_dwordx4 v[16:19], v126, s[16:19], s15 offen
    s_add_u32 s15, s15, 0x100000
    buffer_load_dwordx4 v[20:23], v126, s[16:19], s15 offen
    s_add_u32 s15, s15, 0x100000
    buffer_load_dwordx4 v[24:27], v126, s[16:19], s15 offen
    s_add_u32 s15, s15, 0x100000
    buffer_load_dwordx4 v[28:31], v126, s[16:19], s15 offen
K1_W_NOLOAD:
    v_mfma_f32_16x16x32_bf16 v[64:67], v[96:99], v[32:35], 0
    v_mfma_f32_16x16x32_bf16 v[68:71], v[96:99], v[36:39], 0
    v_mfma_f32_16x16x32_bf16 v[72:75], v[96:99], v[40:43], 0
    v_mfma_f32_16x16x32_bf16 v[76:79], v[96:99], v[44:47], 0
    v_mfma_f32_16x16x32_bf16 v[80:83], v[96:99], v[48:51], 0
    v_mfma_f32_16x16x32_bf16 v[84:87], v[96:99], v[52:55], 0
    v_mfma_f32_16x16x32_bf16 v[88:91], v[96:99], v[56:59], 0
    v_mfma_f32_16x16x32_bf16 v[92:95], v[96:99], v[60:63], 0
    s_nop 7
    v_cvt_pk_bf16_f32 v112, v64, v68
    v_cvt_pk_bf16_f32 v113, v72, v76
    v_cvt_pk_bf16_f32 v114, v80, v84
    v_cvt_pk_bf16_f32 v115, v88, v92
    buffer_store_dwordx4 v[112:115], v120, s[20:23], s25 offen
    s_add_u32 s25, s25, 4194304
    v_cvt_pk_bf16_f32 v116, v65, v69
    v_cvt_pk_bf16_f32 v117, v73, v77
    v_cvt_pk_bf16_f32 v118, v81, v85
    v_cvt_pk_bf16_f32 v119, v89, v93
    buffer_store_dwordx4 v[116:119], v120, s[20:23], s25 offen
    s_add_u32 s25, s25, 4194304
    v_cvt_pk_bf16_f32 v112, v66, v70
    v_cvt_pk_bf16_f32 v113, v74, v78
    v_cvt_pk_bf16_f32 v114, v82, v86
    v_cvt_pk_bf16_f32 v115, v90, v94
    buffer_store_dwordx4 v[112:115], v120, s[20:23], s25 offen
    s_add_u32 s25, s25, 4194304
    v_cvt_pk_bf16_f32 v116, v67, v71
    v_cvt_pk_bf16_f32 v117, v75, v79
    v_cvt_pk_bf16_f32 v118, v83, v87
    v_cvt_pk_bf16_f32 v119, v91, v95
    buffer_store_dwordx4 v[116:119], v120, s[20:23], s25 offen
    s_add_u32 s25, s25, 4194304
    v_mfma_f32_16x16x32_bf16 v[64:67], v[100:103], v[32:35], 0
    v_mfma_f32_16x16x32_bf16 v[68:71], v[100:103], v[36:39], 0
    v_mfma_f32_16x16x32_bf16 v[72:75], v[100:103], v[40:43], 0
    v_mfma_f32_16x16x32_bf16 v[76:79], v[100:103], v[44:47], 0
    v_mfma_f32_16x16x32_bf16 v[80:83], v[100:103], v[48:51], 0
    v_mfma_f32_16x16x32_bf16 v[84:87], v[100:103], v[52:55], 0
    v_mfma_f32_16x16x32_bf16 v[88:91], v[100:103], v[56:59], 0
    v_mfma_f32_16x16x32_bf16 v[92:95], v[100:103], v[60:63], 0
    s_nop 7
    v_cvt_pk_bf16_f32 v112, v64, v68
    v_cvt_pk_bf16_f32 v113, v72, v76
    v_cvt_pk_bf16_f32 v114, v80, v84
    v_cvt_pk_bf16_f32 v115, v88, v92
    buffer_store_dwordx4 v[112:115], v120, s[20:23], s25 offen
    s_add_u32 s25, s25, 4194304
    v_cvt_pk_bf16_f32 v116, v65, v69
    v_cvt_pk_bf16_f32 v117, v73, v77
    v_cvt_pk_bf16_f32 v118, v81, v85
    v_cvt_pk_bf16_f32 v119, v89, v93
    buffer_store_dwordx4 v[116:119], v120, s[20:23], s25 offen
    s_add_u32 s25, s25, 4194304
    v_cvt_pk_bf16_f32 v112, v66, v70
    v_cvt_pk_bf16_f32 v113, v74, v78
    v_cvt_pk_bf16_f32 v114, v82, v86
    v_cvt_pk_bf16_f32 v115, v90, v94
    buffer_store_dwordx4 v[112:115], v120, s[20:23], s25 offen
    s_add_u32 s25, s25, 4194304
    v_cvt_pk_bf16_f32 v116, v67, v71
    v_cvt_pk_bf16_f32 v117, v75, v79
    v_cvt_pk_bf16_f32 v118, v83, v87
    v_cvt_pk_bf16_f32 v119, v91, v95
    buffer_store_dwordx4 v[116:119], v120, s[20:23], s25 offen
    s_add_u32 s25, s25, 4194304
    v_mfma_f32_16x16x32_bf16 v[64:67], v[104:107], v[32:35], 0
    v_mfma_f32_16x16x32_bf16 v[68:71], v[104:107], v[36:39], 0
    v_mfma_f32_16x16x32_bf16 v[72:75], v[104:107], v[40:43], 0
    v_mfma_f32_16x16x32_bf16 v[76:79], v[104:107], v[44:47], 0
    v_mfma_f32_16x16x32_bf16 v[80:83], v[104:107], v[48:51], 0
    v_mfma_f32_16x16x32_bf16 v[84:87], v[104:107], v[52:55], 0
    v_mfma_f32_16x16x32_bf16 v[88:91], v[104:107], v[56:59], 0
    v_mfma_f32_16x16x32_bf16 v[92:95], v[104:107], v[60:63], 0
    s_nop 7
    v_cvt_pk_bf16_f32 v112, v64, v68
    v_cvt_pk_bf16_f32 v113, v72, v76
    v_cvt_pk_bf16_f32 v114, v80, v84
    v_cvt_pk_bf16_f32 v115, v88, v92
    buffer_store_dwordx4 v[112:115], v120, s[20:23], s25 offen
    s_add_u32 s25, s25, 4194304
    v_cvt_pk_bf16_f32 v116, v65, v69
    v_cvt_pk_bf16_f32 v117, v73, v77
    v_cvt_pk_bf16_f32 v118, v81, v85
    v_cvt_pk_bf16_f32 v119, v89, v93
    buffer_store_dwordx4 v[116:119], v120, s[20:23], s25 offen
    s_add_u32 s25, s25, 4194304
    v_cvt_pk_bf16_f32 v112, v66, v70
    v_cvt_pk_bf16_f32 v113, v74, v78
    v_cvt_pk_bf16_f32 v114, v82, v86
    v_cvt_pk_bf16_f32 v115, v90, v94
    buffer_store_dwordx4 v[112:115], v120, s[20:23], s25 offen
    s_add_u32 s25, s25, 4194304
    v_cvt_pk_bf16_f32 v116, v67, v71
    v_cvt_pk_bf16_f32 v117, v75, v79
    v_cvt_pk_bf16_f32 v118, v83, v87
    v_cvt_pk_bf16_f32 v119, v91, v95
    buffer_store_dwordx4 v[116:119], v120, s[20:23], s25 offen
    s_add_u32 s25, s25, 4194304
    v_mfma_f32_16x16x32_bf16 v[64:67], v[108:111], v[32:35], 0
    v_mfma_f32_16x16x32_bf16 v[68:71], v[108:111], v[36:39], 0
    v_mfma_f32_16x16x32_bf16 v[72:75], v[108:111], v[40:43], 0
    v_mfma_f32_16x16x32_bf16 v[76:79], v[108:111], v[44:47], 0
    v_mfma_f32_16x16x32_bf16 v[80:83], v[108:111], v[48:51], 0
    v_mfma_f32_16x16x32_bf16 v[84:87], v[108:111], v[52:55], 0
    v_mfma_f32_16x16x32_bf16 v[88:91], v[108:111], v[56:59], 0
    v_mfma_f32_16x16x32_bf16 v[92:95], v[108:111], v[60:63], 0
    s_nop 7
    v_cvt_pk_bf16_f32 v112, v64, v68
    v_cvt_pk_bf16_f32 v113, v72, v76
    v_cvt_pk_bf16_f32 v114, v80, v84
    v_cvt_pk_bf16_f32 v115, v88, v92
    buffer_store_dwordx4 v[112:115], v120, s[20:23], s25 offen
    s_add_u32 s25, s25, 4194304
    v_cvt_pk_bf16_f32 v116, v65, v69
    v_cvt_pk_bf16_f32 v117, v73, v77
    v_cvt_pk_bf16_f32 v118, v81, v85
    v_cvt_pk_bf16_f32 v119, v89, v93
    buffer_store_dwordx4 v[116:119], v120, s[20:23], s25 offen
    s_add_u32 s25, s25, 4194304
    v_cvt_pk_bf16_f32 v112, v66, v70
    v_cvt_pk_bf16_f32 v113, v74, v78
    v_cvt_pk_bf16_f32 v114, v82, v86
    v_cvt_pk_bf16_f32 v115, v90, v94
    buffer_store_dwordx4 v[112:115], v120, s[20:23], s25 offen
    s_add_u32 s25, s25, 4194304
    v_cvt_pk_bf16_f32 v116, v67, v71
    v_cvt_pk_bf16_f32 v117, v75, v79
    v_cvt_pk_bf16_f32 v118, v83, v87
    v_cvt_pk_bf16_f32 v119, v91, v95
    buffer_store_dwordx4 v[116:119], v120, s[20:23], s25 offen
    s_waitcnt vmcnt(16)
    s_cmp_lt_u32 s27, 1
    s_cbranch_scc1 K1_W_LOOP
K1_END:
    s_endpgm
.p2align 8
.type k12_fused_kernel,@function
k12_fused_kernel:
    s_cmp_ge_u32 s2, 256
    s_cbranch_scc1 K12_END
    s_load_dwordx4 s[52:55], s[0:1], 0
    s_load_dwordx4 s[56:59], s[0:1], 40
    s_getpc_b64 s[90:91]
CPF_K12:
    s_sub_u32 s90, s90, CPF_K12-k12_fused_kernel
    s_subb_u32 s91, s91, 0
    v_lshlrev_b32 v8, 7, v0
    v_mov_b32 v11, s91
    v_min_u32 v9, TEXT_END-k12_fused_kernel-4, v8
    v_add_co_u32 v10, vcc, s90, v9
    v_addc_co_u32 v11, vcc, 0, v11, vcc
    global_load_dword v63, v[10:11], off
    v_lshrrev_b32 v1, 6, v0
    v_and_b32 v2, 63, v0
    v_readfirstlane_b32 s3, v1
    s_waitcnt lgkmcnt(0)
    s_cmp_lt_u32 s3, 4
    s_cbranch_scc1 K12_CONS
    v_and_b32 v64, 15, v2
    v_lshrrev_b32 v65, 4, v2
    v_lshlrev_b32 v254, 4, v2
    s_and_b32 s44, s3, 3
    s_and_b32 s20, s44, 1
    s_lshr_b32 s21, s44, 1
    s_lshl_b32 s22, s2, 1
    s_add_u32 s22, s22, s21
    s_and_b32 s23, s22, 3
    s_lshr_b32 s22, s22, 2
    s_and_b32 s24, s2, 7
    s_lshl_b32 s24, s24, 5
    s_lshr_b32 s25, s2, 3
    s_add_u32 s24, s24, s25
    s_cmp_ge_u32 s24, 167
    s_cselect_b32 s25, 1, 0
    s_mul_i32 s26, s25, 167
    s_sub_u32 s24, s24, s26
    s_mov_b32 s49, s25
    s_cmp_eq_u32 s21, 0
    s_cselect_b32 s25, s25, 1
    s_mul_i32 s26, s25, 16384000
    s_add_u32 s4, s52, s26
    s_addc_u32 s5, s53, 0
    s_and_b32 s5, s5, 0xffff
    s_mov_b32 s6, 16384000
    s_mov_b32 s7, 0x00020000
    s_mov_b32 s8, s54
    s_mov_b32 s9, s55
    s_and_b32 s9, s9, 0xffff
    s_mov_b32 s10, 16252928
    s_mov_b32 s11, 0x00020000
    s_mov_b32 s12, s58
    s_mov_b32 s13, s59
    s_and_b32 s13, s13, 0xffff
    s_mov_b32 s14, 43778048
    s_mov_b32 s15, 0x00020000
    s_add_u32 s16, s58, 50331648
    s_addc_u32 s17, s59, 0
    s_and_b32 s17, s17, 0xffff
    s_mov_b32 s18, 67108864
    s_mov_b32 s19, 0x00020000
    s_add_u32 s60, s58, 153092096
    s_addc_u32 s61, s59, 0
    s_and_b32 s61, s61, 0xffff
    s_mov_b32 s62, 32768
    s_mov_b32 s63, 0x00020000
    s_mov_b32 s28, 0x05040100
    s_mov_b32 s29, 0x07060302
    v_lshlrev_b32 v248, 14, v65
    v_lshl_add_u32 v248, v64, 4, v248
    v_and_b32 v250, 1, v65
    v_lshlrev_b32 v250, 23, v250
    v_lshl_add_u32 v250, v64, 4, v250
    v_lshrrev_b32 v66, 1, v65
    s_mov_b32 s26, 1368064
    v_mul_lo_u32 v66, v66, s26
    v_lshrrev_b32 v67, 2, v64
    s_mov_b32 s26, 21376
    v_mul_lo_u32 v67, v67, s26
    v_add_u32 v66, v66, v67
    v_mov_b32 v252, v66
    v_lshrrev_b32 v66, 1, v65
    s_mov_b32 s26, 2097152
    v_mul_lo_u32 v66, v66, s26
    v_and_b32 v67, 1, v65
    v_lshl_add_u32 v66, v67, 8, v66
    v_and_b32 v67, 1, v64
    v_lshl_add_u32 v251, v67, 4, v66
    s_mul_i32 s31, s25, 684032
    s_mul_i32 s32, s23, 524288
    s_lshl_b32 s33, s23, 8
    s_mov_b32 s40, 3
    s_xor_b32 s43, s40, s20
    s_and_b32 s43, s43, 1
    s_mul_i32 s36, s40, 85
    s_add_u32 s36, s36, s2
    s_and_b32 s36, s36, 255
    s_mul_hi_u32 s37, s36, 0x55555556
    s_mul_i32 s38, s37, 3
    s_cmp_eq_u32 s38, s36
    s_cselect_b32 s27, 1, 0
    s_cmp_lt_u32 s37, 78
    s_cselect_b32 s27, s27, 0
    s_add_u32 s37, s37, 89
    s_add_u32 s26, s21, 1
    s_cmp_eq_u32 s27, 1
    s_cselect_b32 s26, 0, s26
    s_and_b32 s36, s27, s21
    s_cselect_b32 s30, s37, s24
    s_cselect_b32 s25, 1, s49
    s_mov_b32 s27, 1
    s_cmp_eq_u32 s43, 0
    s_cbranch_scc0 K12_PL1
    s_lshl_b32 s36, s40, 7
    s_add_u32 s36, s36, s22
    s_lshr_b32 s37, s36, 9
    s_lshl_b32 s37, s37, 19
    s_and_b32 s36, s36, 511
    s_lshl_b32 s36, s36, 10
    s_add_u32 s36, s36, s37
    s_add_u32 s36, s36, s33
    buffer_load_dwordx4 v[96:99], v250, s[8:11], s36 offen
    s_add_u32 s36, s36, 0x100000
    buffer_load_dwordx4 v[100:103], v250, s[8:11], s36 offen
    s_add_u32 s36, s36, 0x100000
    buffer_load_dwordx4 v[104:107], v250, s[8:11], s36 offen
    s_add_u32 s36, s36, 0x100000
    buffer_load_dwordx4 v[108:111], v250, s[8:11], s36 offen
    s_add_u32 s36, s36, 0x100000
    buffer_load_dwordx4 v[112:115], v250, s[8:11], s36 offen
    s_add_u32 s36, s36, 0x100000
    buffer_load_dwordx4 v[116:119], v250, s[8:11], s36 offen
    s_add_u32 s36, s36, 0x100000
    buffer_load_dwordx4 v[120:123], v250, s[8:11], s36 offen
    s_add_u32 s36, s36, 0x100000
    buffer_load_dwordx4 v[124:127], v250, s[8:11], s36 offen
    s_branch K12_PL2
K12_PL1:
    s_cmp_eq_u32 s27, 0
    s_cbranch_scc1 K12_PL2
    s_mul_i32 s36, s25, 16384000
    s_add_u32 s4, s52, s36
    s_addc_u32 s5, s53, 0
    s_and_b32 s5, s5, 0xffff
    s_lshl_b32 s36, s40, 8
    s_mul_i32 s37, s30, 98304
    s_add_u32 s36, s36, s37
    buffer_load_dwordx4 v[0:3], v248, s[4:7], s36 offen
    buffer_load_dwordx4 v[4:7], v248, s[4:7], s36 offen offset:2048
    s_add_u32 s36, s36, 4096
    buffer_load_dwordx4 v[8:11], v248, s[4:7], s36 offen
    buffer_load_dwordx4 v[12:15], v248, s[4:7], s36 offen offset:2048
    s_add_u32 s36, s36, 4096
    buffer_load_dwordx4 v[16:19], v248, s[4:7], s36 offen
    buffer_load_dwordx4 v[20:23], v248, s[4:7], s36 offen offset:2048
    s_add_u32 s36, s36, 4096
    buffer_load_dwordx4 v[24:27], v248, s[4:7], s36 offen
    buffer_load_dwordx4 v[28:31], v248, s[4:7], s36 offen offset:2048
    s_add_u32 s36, s36, 53248
    buffer_load_dwordx4 v[32:35], v248, s[4:7], s36 offen
    buffer_load_dwordx4 v[36:39], v248, s[4:7], s36 offen offset:2048
    s_add_u32 s36, s36, 4096
    buffer_load_dwordx4 v[40:43], v248, s[4:7], s36 offen
    buffer_load_dwordx4 v[44:47], v248, s[4:7], s36 offen offset:2048
    s_add_u32 s36, s36, 4096
    buffer_load_dwordx4 v[48:51], v248, s[4:7], s36 offen
    buffer_load_dwordx4 v[52:55], v248, s[4:7], s36 offen offset:2048
    s_add_u32 s36, s36, 4096
    buffer_load_dwordx4 v[56:59], v248, s[4:7], s36 offen
    buffer_load_dwordx4 v[60:63], v248, s[4:7], s36 offen offset:2048
K12_PL2:
    v_and_b32 v128, 3, v64
    v_lshlrev_b32 v128, 2, v128
    v_lshrrev_b32 v130, 3, v64
    v_lshl_add_u32 v128, v130, 1, v128
    s_lshl_b32 s36, s44, 4
    s_add_u32 s36, s36, 1
    v_add_u32 v128, s36, v128
    v_bfe_u32 v129, v64, 2, 1
    v_lshlrev_b32 v131, 3, v65
    v_lshlrev_b32 v132, 5, v129
    v_mad_u32_u24 v133, v128, v131, v132
    v_mad_u32_u24 v136, v128, 0, v133
    v_mad_u32_u24 v137, v128, 1, v133
    v_mad_u32_u24 v138, v128, 2, v133
    v_mad_u32_u24 v139, v128, 3, v133
    v_mad_u32_u24 v140, v128, 4, v133
    v_mad_u32_u24 v141, v128, 5, v133
    v_mad_u32_u24 v142, v128, 6, v133
    v_mad_u32_u24 v143, v128, 7, v133
    v_and_b32 v136, 127, v136
    v_and_b32 v137, 127, v137
    v_and_b32 v138, 127, v138
    v_and_b32 v139, 127, v139
    v_and_b32 v140, 127, v140
    v_and_b32 v141, 127, v141
    v_and_b32 v142, 127, v142
    v_and_b32 v143, 127, v143
    v_cvt_f32_u32 v136, v136
    v_cvt_f32_u32 v137, v137
    v_cvt_f32_u32 v138, v138
    v_cvt_f32_u32 v139, v139
    v_cvt_f32_u32 v140, v140
    v_cvt_f32_u32 v141, v141
    v_cvt_f32_u32 v142, v142
    v_cvt_f32_u32 v143, v143
    v_mul_f32 v136, 0x3c000000, v136
    v_mul_f32 v137, 0x3c000000, v137
    v_mul_f32 v138, 0x3c000000, v138
    v_mul_f32 v139, 0x3c000000, v139
    v_mul_f32 v140, 0x3c000000, v140
    v_mul_f32 v141, 0x3c000000, v141
    v_mul_f32 v142, 0x3c000000, v142
    v_mul_f32 v143, 0x3c000000, v143
    v_cos_f32 v136, v136
    v_cos_f32 v137, v137
    v_cos_f32 v138, v138
    v_cos_f32 v139, v139
    v_cos_f32 v140, v140
    v_cos_f32 v141, v141
    v_cos_f32 v142, v142
    v_cos_f32 v143, v143
    s_nop 0
    v_cvt_pk_bf16_f32 v144, v136, v137
    v_cvt_pk_bf16_f32 v145, v138, v139
    v_cvt_pk_bf16_f32 v146, v140, v141
    v_cvt_pk_bf16_f32 v147, v142, v143
    v_lshlrev_b32 v152, 16, v144
    v_and_b32 v153, 0xffff0000, v144
    v_sub_f32 v136, v136, v152
    v_sub_f32 v137, v137, v153
    v_lshlrev_b32 v152, 16, v145
    v_and_b32 v153, 0xffff0000, v145
    v_sub_f32 v138, v138, v152
    v_sub_f32 v139, v139, v153
    v_lshlrev_b32 v152, 16, v146
    v_and_b32 v153, 0xffff0000, v146
    v_sub_f32 v140, v140, v152
    v_sub_f32 v141, v141, v153
    v_lshlrev_b32 v152, 16, v147
    v_and_b32 v153, 0xffff0000, v147
    v_sub_f32 v142, v142, v152
    v_sub_f32 v143, v143, v153
    v_cvt_pk_bf16_f32 v148, v136, v137
    v_cvt_pk_bf16_f32 v149, v138, v139
    v_cvt_pk_bf16_f32 v150, v140, v141
    v_cvt_pk_bf16_f32 v151, v142, v143
    s_lshl_b32 s37, s44, 12
    s_add_u32 s37, s37, 116736
    v_add_u32 v132, s37, v254
    ds_write_b128 v132, v[144:147]
    ds_write_b128 v132, v[148:151] offset:1024
    v_add_u32 v131, 32, v131
    v_lshlrev_b32 v132, 5, v129
    v_mad_u32_u24 v133, v128, v131, v132
    v_mad_u32_u24 v136, v128, 0, v133
    v_mad_u32_u24 v137, v128, 1, v133
    v_mad_u32_u24 v138, v128, 2, v133
    v_mad_u32_u24 v139, v128, 3, v133
    v_mad_u32_u24 v140, v128, 4, v133
    v_mad_u32_u24 v141, v128, 5, v133
    v_mad_u32_u24 v142, v128, 6, v133
    v_mad_u32_u24 v143, v128, 7, v133
    v_and_b32 v136, 127, v136
    v_and_b32 v137, 127, v137
    v_and_b32 v138, 127, v138
    v_and_b32 v139, 127, v139
    v_and_b32 v140, 127, v140
    v_and_b32 v141, 127, v141
    v_and_b32 v142, 127, v142
    v_and_b32 v143, 127, v143
    v_cvt_f32_u32 v136, v136
    v_cvt_f32_u32 v137, v137
    v_cvt_f32_u32 v138, v138
    v_cvt_f32_u32 v139, v139
    v_cvt_f32_u32 v140, v140
    v_cvt_f32_u32 v141, v141
    v_cvt_f32_u32 v142, v142
    v_cvt_f32_u32 v143, v143
    v_mul_f32 v136, 0x3c000000, v136
    v_mul_f32 v137, 0x3c000000, v137
    v_mul_f32 v138, 0x3c000000, v138
    v_mul_f32 v139, 0x3c000000, v139
    v_mul_f32 v140, 0x3c000000, v140
    v_mul_f32 v141, 0x3c000000, v141
    v_mul_f32 v142, 0x3c000000, v142
    v_mul_f32 v143, 0x3c000000, v143
    v_cos_f32 v136, v136
    v_cos_f32 v137, v137
    v_cos_f32 v138, v138
    v_cos_f32 v139, v139
    v_cos_f32 v140, v140
    v_cos_f32 v141, v141
    v_cos_f32 v142, v142
    v_cos_f32 v143, v143
    s_nop 0
    v_cvt_pk_bf16_f32 v144, v136, v137
    v_cvt_pk_bf16_f32 v145, v138, v139
    v_cvt_pk_bf16_f32 v146, v140, v141
    v_cvt_pk_bf16_f32 v147, v142, v143
    v_lshlrev_b32 v152, 16, v144
    v_and_b32 v153, 0xffff0000, v144
    v_sub_f32 v136, v136, v152
    v_sub_f32 v137, v137, v153
    v_lshlrev_b32 v152, 16, v145
    v_and_b32 v153, 0xffff0000, v145
    v_sub_f32 v138, v138, v152
    v_sub_f32 v139, v139, v153
    v_lshlrev_b32 v152, 16, v146
    v_and_b32 v153, 0xffff0000, v146
    v_sub_f32 v140, v140, v152
    v_sub_f32 v141, v141, v153
    v_lshlrev_b32 v152, 16, v147
    v_and_b32 v153, 0xffff0000, v147
    v_sub_f32 v142, v142, v152
    v_sub_f32 v143, v143, v153
    v_cvt_pk_bf16_f32 v148, v136, v137
    v_cvt_pk_bf16_f32 v149, v138, v139
    v_cvt_pk_bf16_f32 v150, v140, v141
    v_cvt_pk_bf16_f32 v151, v142, v143
    s_lshl_b32 s37, s44, 12
    s_add_u32 s37, s37, 118784
    v_add_u32 v132, s37, v254
    ds_write_b128 v132, v[144:147]
    ds_write_b128 v132, v[148:151] offset:1024
K12_TB:
    s_waitcnt lgkmcnt(0)
    s_barrier
    v_add_u32 v255, 116736, v254
    ds_read_b128 v[160:163], v255 offset:0
    ds_read_b128 v[192:195], v255 offset:1024
    ds_read_b128 v[164:167], v255 offset:2048
    ds_read_b128 v[196:199], v255 offset:3072
    ds_read_b128 v[168:171], v255 offset:4096
    ds_read_b128 v[200:203], v255 offset:5120
    ds_read_b128 v[172:175], v255 offset:6144
    ds_read_b128 v[204:207], v255 offset:7168
    s_waitcnt lgkmcnt(0)
    ds_read_b128 v[176:179], v255 offset:8192
    ds_read_b128 v[208:211], v255 offset:9216
    ds_read_b128 v[180:183], v255 offset:10240
    ds_read_b128 v[212:215], v255 offset:11264
    ds_read_b128 v[184:187], v255 offset:12288
    ds_read_b128 v[216:219], v255 offset:13312
    ds_read_b128 v[188:191], v255 offset:14336
    ds_read_b128 v[220:223], v255 offset:15360
    ds_read_b128 v[224:227], v255 offset:16384
    ds_read_b128 v[228:231], v255 offset:17408
    ds_read_b128 v[232:235], v255 offset:18432
    ds_read_b128 v[236:239], v255 offset:19456
    s_waitcnt lgkmcnt(0)
    s_barrier
    s_waitcnt vmcnt(0) lgkmcnt(0)
    s_mov_b32 s41, -1
    s_mov_b32 s34, -1
K12_PROD:
    s_mov_b32 s37, 131072
K12_TW:
    v_mov_b32 v240, 155648
    ds_read_b32 v240, v240
    s_waitcnt lgkmcnt(0)
    v_cmp_gt_u32 vcc, 2, v240
    s_sub_u32 s37, s37, 1
    s_cmp_eq_u32 s37, 0
    s_cbranch_scc1 K12_TX
    s_cbranch_vccz K12_TX
    s_sleep 2
    s_branch K12_TW
K12_TX:
    v_lshrrev_b32 v128, 4, v254
    v_lshlrev_b32 v129, 11, v128
    v_lshrrev_b32 v130, 1, v128
    v_lshlrev_b32 v130, 20, v130
    v_and_b32 v131, 1, v128
    v_lshl_add_u32 v130, v131, 7, v130
    s_mov_b32 s45, s27
    s_mov_b32 s46, s30
    s_mov_b32 s50, s25
    s_mov_b32 s51, s26
    s_add_u32 s47, s40, 1
K12_TCH0:
    s_xor_b32 s48, s47, s20
    s_and_b32 s48, s48, 1
    s_cmp_eq_u32 s48, 0
    s_cbranch_scc1 K12_TCHW0
    s_mul_i32 s36, s47, 85
    s_add_u32 s36, s36, s2
    s_and_b32 s36, s36, 255
    s_mul_hi_u32 s37, s36, 0x55555556
    s_mul_i32 s38, s37, 3
    s_cmp_eq_u32 s38, s36
    s_cselect_b32 s27, 1, 0
    s_cmp_lt_u32 s37, 78
    s_cselect_b32 s27, s27, 0
    s_add_u32 s37, s37, 89
    s_add_u32 s26, s21, 1
    s_cmp_eq_u32 s27, 1
    s_cselect_b32 s26, 0, s26
    s_and_b32 s36, s27, s21
    s_cselect_b32 s30, s37, s24
    s_cselect_b32 s25, 1, s49
    s_mov_b32 s27, 1
    s_cmp_eq_u32 s26, 2
    s_cbranch_scc1 K12_TCHN0
    s_mul_i32 s36, s25, 16384000
    s_add_u32 s4, s52, s36
    s_addc_u32 s5, s53, 0
    s_and_b32 s5, s5, 0xffff
    s_lshl_b32 s36, s47, 8
    s_mul_i32 s37, s30, 98304
    s_add_u32 s36, s36, s37
    buffer_load_dword v244, v129, s[4:7], s36 offen
    buffer_load_dword v245, v129, s[4:7], s36 offen offset:128
    s_branch K12_TCHN0
K12_TCHW0:
    s_lshl_b32 s36, s47, 7
    s_add_u32 s36, s36, s22
    s_lshr_b32 s37, s36, 9
    s_lshl_b32 s37, s37, 19
    s_and_b32 s36, s36, 511
    s_lshl_b32 s36, s36, 10
    s_add_u32 s36, s36, s37
    s_add_u32 s36, s36, s33
    s_mov_b64 exec, 0xffffffff
    buffer_load_dword v246, v130, s[8:11], s36 offen
    s_mov_b64 exec, -1
K12_TCHN0:
    s_add_u32 s47, s47, 1
    s_cmp_lt_u32 s47, 8
    s_cbranch_scc1 K12_TCH0
    s_mov_b32 s27, s45
    s_mov_b32 s30, s46
    s_mov_b32 s25, s50
    s_mov_b32 s26, s51
    s_cmp_eq_u32 s43, 0
    s_cbranch_scc1 K12_WENTRY
K12_XW:
    s_waitcnt vmcnt(0)
    s_mov_b32 s34, -1
    s_cmp_ge_u32 s41, 8
    s_cbranch_scc1 K12_SG0
    s_lshl_b32 s36, s41, 2
    s_add_u32 s37, s36, 155680
    s_mov_b64 exec, 1
    v_mov_b32 v255, s37
    v_mov_b32 v240, 1
    ds_add_rtn_u32 v240, v255, v240
    s_waitcnt lgkmcnt(0)
    v_readfirstlane_b32 s37, v240
    s_nop 3
    s_cmp_eq_u32 s37, 3
    s_cbranch_scc0 K12_SH0
    s_lshl_b32 s36, s36, 8
    v_mov_b32 v255, 1
    v_mov_b32 v240, s36
    buffer_atomic_add v255, v240, s[60:63], 0 offen sc0 sc1
    s_mov_b32 s34, s41
K12_SH0:
    s_mov_b64 exec, -1
K12_SG0:
    s_cmp_ge_u32 s34, 8
    s_cbranch_scc1 K12_EP1
    s_waitcnt vmcnt(0)
    s_cmp_ge_u32 s34, 8
    s_cbranch_scc1 K12_PB2
    v_readfirstlane_b32 s37, v255
    s_nop 3
    s_cmp_eq_u32 s37, 255
    s_cbranch_scc0 K12_PB2
    s_lshl_b32 s36, s34, 4
    s_add_u32 s36, s36, 16384
    s_mov_b64 exec, 1
    v_mov_b32 v255, 1
    v_mov_b32 v240, s36
    buffer_store_dword v255, v240, s[60:63], 0 offen sc1
    s_mov_b64 exec, -1
K12_PB2:
    s_mov_b32 s34, -1
K12_EP1:
    s_cmp_eq_u32 s27, 0
    s_cbranch_scc1 K12_XP_N
    v_perm_b32 v64, v4, v0, s28
    v_perm_b32 v68, v4, v0, s29
    v_perm_b32 v65, v12, v8, s28
    v_perm_b32 v69, v12, v8, s29
    v_perm_b32 v66, v20, v16, s28
    v_perm_b32 v70, v20, v16, s29
    v_perm_b32 v67, v28, v24, s28
    v_perm_b32 v71, v28, v24, s29
    v_perm_b32 v72, v5, v1, s28
    v_perm_b32 v76, v5, v1, s29
    v_perm_b32 v73, v13, v9, s28
    v_perm_b32 v77, v13, v9, s29
    v_perm_b32 v74, v21, v17, s28
    v_perm_b32 v78, v21, v17, s29
    v_perm_b32 v75, v29, v25, s28
    v_perm_b32 v79, v29, v25, s29
    v_perm_b32 v80, v6, v2, s28
    v_perm_b32 v84, v6, v2, s29
    v_perm_b32 v81, v14, v10, s28
    v_perm_b32 v85, v14, v10, s29
    v_perm_b32 v82, v22, v18, s28
    v_perm_b32 v86, v22, v18, s29
    v_perm_b32 v83, v30, v26, s28
    v_perm_b32 v87, v30, v26, s29
    v_perm_b32 v88, v7, v3, s28
    v_perm_b32 v92, v7, v3, s29
    v_perm_b32 v89, v15, v11, s28
    v_perm_b32 v93, v15, v11, s29
    v_perm_b32 v90, v23, v19, s28
    v_perm_b32 v94, v23, v19, s29
    v_perm_b32 v91, v31, v27, s28
    v_perm_b32 v95, v31, v27, s29
    v_perm_b32 v0, v36, v32, s28
    v_perm_b32 v4, v36, v32, s29
    v_perm_b32 v1, v44, v40, s28
    v_perm_b32 v5, v44, v40, s29
    v_perm_b32 v2, v52, v48, s28
    v_perm_b32 v6, v52, v48, s29
    v_perm_b32 v3, v60, v56, s28
    v_perm_b32 v7, v60, v56, s29
    v_perm_b32 v8, v37, v33, s28
    v_perm_b32 v12, v37, v33, s29
    v_perm_b32 v9, v45, v41, s28
    v_perm_b32 v13, v45, v41, s29
    v_perm_b32 v10, v53, v49, s28
    v_perm_b32 v14, v53, v49, s29
    v_perm_b32 v11, v61, v57, s28
    v_perm_b32 v15, v61, v57, s29
    v_perm_b32 v16, v38, v34, s28
    v_perm_b32 v20, v38, v34, s29
    v_perm_b32 v17, v46, v42, s28
    v_perm_b32 v21, v46, v42, s29
    v_perm_b32 v18, v54, v50, s28
    v_perm_b32 v22, v54, v50, s29
    v_perm_b32 v19, v62, v58, s28
    v_perm_b32 v23, v62, v58, s29
    v_perm_b32 v24, v39, v35, s28
    v_perm_b32 v28, v39, v35, s29
    v_perm_b32 v25, v47, v43, s28
    v_perm_b32 v29, v47, v43, s29
    v_perm_b32 v26, v55, v51, s28
    v_perm_b32 v30, v55, v51, s29
    v_perm_b32 v27, v63, v59, s28
    v_perm_b32 v31, v63, v59, s29
K12_XP_N:
    s_lshl_b32 s36, s40, 3
    s_sub_i32 s36, s36, 24
    s_max_i32 s36, s36, 1
    s_mov_b32 s37, 131072
K12_GL0:
    v_mov_b32 v240, 155648
    ds_read_b32 v240, v240
    s_waitcnt lgkmcnt(0)
    v_cmp_gt_u32 vcc, s36, v240
    s_sub_u32 s37, s37, 1
    s_cmp_eq_u32 s37, 0
    s_cbranch_scc1 K12_GT0
    s_cbranch_vccz K12_GT0
    s_sleep 2
    s_branch K12_GL0
K12_GT0:
    s_lshl_b32 s36, s40, 2
    s_add_u32 s36, s36, 155840
    s_mov_b64 exec, 1
    v_mov_b32 v240, s36
    v_mov_b32 v241, 1
    ds_add_u32 v240, v241
    s_mov_b64 exec, -1
    s_mov_b32 s37, 131072
K12_BL0:
    v_mov_b32 v240, s36
    ds_read_b32 v240, v240
    s_waitcnt lgkmcnt(0)
    v_cmp_gt_u32 vcc, 4, v240
    s_sub_u32 s37, s37, 1
    s_cmp_eq_u32 s37, 0
    s_cbranch_scc1 K12_BT0
    s_cbranch_vccz K12_BT0
    s_sleep 1
    s_branch K12_BL0
K12_BT0:
    s_add_u32 s42, s40, 1
    s_lshl_b32 s36, s42, 7
    s_add_u32 s36, s36, s22
    s_lshr_b32 s37, s36, 9
    s_lshl_b32 s37, s37, 19
    s_and_b32 s36, s36, 511
    s_lshl_b32 s36, s36, 10
    s_add_u32 s36, s36, s37
    s_add_u32 s36, s36, s33
    buffer_load_dwordx4 v[96:99], v250, s[8:11], s36 offen
    s_add_u32 s36, s36, 0x100000
    buffer_load_dwordx4 v[100:103], v250, s[8:11], s36 offen
    s_add_u32 s36, s36, 0x100000
    buffer_load_dwordx4 v[104:107], v250, s[8:11], s36 offen
    s_add_u32 s36, s36, 0x100000
    buffer_load_dwordx4 v[108:111], v250, s[8:11], s36 offen
    s_add_u32 s36, s36, 0x100000
    buffer_load_dwordx4 v[112:115], v250, s[8:11], s36 offen
    s_add_u32 s36, s36, 0x100000
    buffer_load_dwordx4 v[116:119], v250, s[8:11], s36 offen
    s_add_u32 s36, s36, 0x100000
    buffer_load_dwordx4 v[120:123], v250, s[8:11], s36 offen
    s_add_u32 s36, s36, 0x100000
    buffer_load_dwordx4 v[124:127], v250, s[8:11], s36 offen
    s_cmp_eq_u32 s27, 0
    s_cbranch_scc1 K12_XP_E
    s_mul_i32 s31, s25, 684032
    s_mul_i32 s39, s40, 85504
    s_add_u32 s39, s39, s31
    s_lshl_b32 s36, s30, 7
    s_add_u32 s39, s39, s36
    v_bfe_u32 v249, v254, 4, 2
    v_bfe_u32 v240, v254, 8, 1
    v_lshl_add_u32 v249, v240, 2, v249
    s_add_u32 s36, s30, 7
    s_cmp_ge_u32 s30, 160
    s_cselect_b32 s36, s36, s30
    s_cmp_eq_u32 s25, 1
    s_cselect_b32 s36, s36, s30
    s_lshr_b32 s36, s36, 1
    s_and_b32 s36, s36, 7
    v_xor_b32 v249, s36, v249
    v_lshl_add_u32 v249, v249, 4, v252
    s_cmp_eq_u32 s26, 2
    s_cselect_b32 s36, 21889024, 0
    s_add_u32 s39, s39, s36
    s_cmp_eq_u32 s26, 2
    s_cbranch_scc1 K12_XS1595_HI
    s_setprio 1
    v_mfma_f32_16x16x32_bf16 v[32:35], v[160:163], v[64:67], 0
    v_mfma_f32_16x16x32_bf16 v[36:39], v[160:163], v[68:71], 0
    v_mfma_f32_16x16x32_bf16 v[40:43], v[160:163], v[72:75], 0
    v_mfma_f32_16x16x32_bf16 v[44:47], v[160:163], v[76:79], 0
    v_mfma_f32_16x16x32_bf16 v[48:51], v[160:163], v[80:83], 0
    v_mfma_f32_16x16x32_bf16 v[52:55], v[160:163], v[84:87], 0
    v_mfma_f32_16x16x32_bf16 v[56:59], v[160:163], v[88:91], 0
    v_mfma_f32_16x16x32_bf16 v[60:63], v[160:163], v[92:95], 0
    v_mfma_f32_16x16x32_bf16 v[32:35], v[192:195], v[64:67], v[32:35]
    v_mfma_f32_16x16x32_bf16 v[36:39], v[192:195], v[68:71], v[36:39]
    v_mfma_f32_16x16x32_bf16 v[40:43], v[192:195], v[72:75], v[40:43]
    v_mfma_f32_16x16x32_bf16 v[44:47], v[192:195], v[76:79], v[44:47]
    v_mfma_f32_16x16x32_bf16 v[48:51], v[192:195], v[80:83], v[48:51]
    v_mfma_f32_16x16x32_bf16 v[52:55], v[192:195], v[84:87], v[52:55]
    v_mfma_f32_16x16x32_bf16 v[56:59], v[192:195], v[88:91], v[56:59]
    v_mfma_f32_16x16x32_bf16 v[60:63], v[192:195], v[92:95], v[60:63]
    v_mfma_f32_16x16x32_bf16 v[32:35], v[164:167], v[0:3], v[32:35]
    v_mfma_f32_16x16x32_bf16 v[36:39], v[164:167], v[4:7], v[36:39]
    v_mfma_f32_16x16x32_bf16 v[40:43], v[164:167], v[8:11], v[40:43]
    v_mfma_f32_16x16x32_bf16 v[44:47], v[164:167], v[12:15], v[44:47]
    v_mfma_f32_16x16x32_bf16 v[48:51], v[164:167], v[16:19], v[48:51]
    v_mfma_f32_16x16x32_bf16 v[52:55], v[164:167], v[20:23], v[52:55]
    v_mfma_f32_16x16x32_bf16 v[56:59], v[164:167], v[24:27], v[56:59]
    v_mfma_f32_16x16x32_bf16 v[60:63], v[164:167], v[28:31], v[60:63]
    v_mfma_f32_16x16x32_bf16 v[32:35], v[196:199], v[0:3], v[32:35]
    v_mfma_f32_16x16x32_bf16 v[36:39], v[196:199], v[4:7], v[36:39]
    v_mfma_f32_16x16x32_bf16 v[40:43], v[196:199], v[8:11], v[40:43]
    v_mfma_f32_16x16x32_bf16 v[44:47], v[196:199], v[12:15], v[44:47]
    v_mfma_f32_16x16x32_bf16 v[48:51], v[196:199], v[16:19], v[48:51]
    v_mfma_f32_16x16x32_bf16 v[52:55], v[196:199], v[20:23], v[52:55]
    v_mfma_f32_16x16x32_bf16 v[56:59], v[196:199], v[24:27], v[56:59]
    v_mfma_f32_16x16x32_bf16 v[60:63], v[196:199], v[28:31], v[60:63]
    s_setprio 0
    s_nop 7
    v_cvt_pk_bf16_f32 v240, v32, v36
    v_cvt_pk_bf16_f32 v241, v40, v44
    v_cvt_pk_bf16_f32 v242, v48, v52
    v_cvt_pk_bf16_f32 v243, v56, v60
    buffer_store_dwordx4 v[240:243], v249, s[12:15], s39 offen sc1
    s_add_u32 s39, s39, 2736128
    v_cvt_pk_bf16_f32 v244, v33, v37
    v_cvt_pk_bf16_f32 v245, v41, v45
    v_cvt_pk_bf16_f32 v246, v49, v53
    v_cvt_pk_bf16_f32 v247, v57, v61
    buffer_store_dwordx4 v[244:247], v249, s[12:15], s39 offen sc1
    s_add_u32 s39, s39, 2736128
    v_cvt_pk_bf16_f32 v240, v34, v38
    v_cvt_pk_bf16_f32 v241, v42, v46
    v_cvt_pk_bf16_f32 v242, v50, v54
    v_cvt_pk_bf16_f32 v243, v58, v62
    buffer_store_dwordx4 v[240:243], v249, s[12:15], s39 offen sc1
    s_add_u32 s39, s39, 2736128
    v_cvt_pk_bf16_f32 v244, v35, v39
    v_cvt_pk_bf16_f32 v245, v43, v47
    v_cvt_pk_bf16_f32 v246, v51, v55
    v_cvt_pk_bf16_f32 v247, v59, v63
    buffer_store_dwordx4 v[244:247], v249, s[12:15], s39 offen sc1
    s_add_u32 s39, s39, 2736128
    s_cmp_lg_u32 s26, 1
    s_cbranch_scc1 K12_UT0
    s_cmp_lt_u32 s40, 4
    s_cbranch_scc1 K12_UT0
    s_lshl_b32 s36, s40, 3
    s_sub_i32 s36, s36, 20
    s_max_i32 s36, s36, 1
    s_mov_b32 s37, 131072
K12_UL0:
    v_mov_b32 v255, 155648
    ds_read_b32 v255, v255
    s_waitcnt lgkmcnt(0)
    v_cmp_gt_u32 vcc, s36, v255
    s_sub_u32 s37, s37, 1
    s_cmp_eq_u32 s37, 0
    s_cbranch_scc1 K12_UT0
    s_cbranch_vccz K12_UT0
    s_sleep 2
    s_branch K12_UL0
K12_UT0:
    s_setprio 1
    v_mfma_f32_16x16x32_bf16 v[32:35], v[168:171], v[64:67], 0
    v_mfma_f32_16x16x32_bf16 v[36:39], v[168:171], v[68:71], 0
    v_mfma_f32_16x16x32_bf16 v[40:43], v[168:171], v[72:75], 0
    v_mfma_f32_16x16x32_bf16 v[44:47], v[168:171], v[76:79], 0
    v_mfma_f32_16x16x32_bf16 v[48:51], v[168:171], v[80:83], 0
    v_mfma_f32_16x16x32_bf16 v[52:55], v[168:171], v[84:87], 0
    v_mfma_f32_16x16x32_bf16 v[56:59], v[168:171], v[88:91], 0
    v_mfma_f32_16x16x32_bf16 v[60:63], v[168:171], v[92:95], 0
    v_mfma_f32_16x16x32_bf16 v[32:35], v[200:203], v[64:67], v[32:35]
    v_mfma_f32_16x16x32_bf16 v[36:39], v[200:203], v[68:71], v[36:39]
    v_mfma_f32_16x16x32_bf16 v[40:43], v[200:203], v[72:75], v[40:43]
    v_mfma_f32_16x16x32_bf16 v[44:47], v[200:203], v[76:79], v[44:47]
    v_mfma_f32_16x16x32_bf16 v[48:51], v[200:203], v[80:83], v[48:51]
    v_mfma_f32_16x16x32_bf16 v[52:55], v[200:203], v[84:87], v[52:55]
    v_mfma_f32_16x16x32_bf16 v[56:59], v[200:203], v[88:91], v[56:59]
    v_mfma_f32_16x16x32_bf16 v[60:63], v[200:203], v[92:95], v[60:63]
    v_mfma_f32_16x16x32_bf16 v[32:35], v[172:175], v[0:3], v[32:35]
    v_mfma_f32_16x16x32_bf16 v[36:39], v[172:175], v[4:7], v[36:39]
    v_mfma_f32_16x16x32_bf16 v[40:43], v[172:175], v[8:11], v[40:43]
    v_mfma_f32_16x16x32_bf16 v[44:47], v[172:175], v[12:15], v[44:47]
    v_mfma_f32_16x16x32_bf16 v[48:51], v[172:175], v[16:19], v[48:51]
    v_mfma_f32_16x16x32_bf16 v[52:55], v[172:175], v[20:23], v[52:55]
    v_mfma_f32_16x16x32_bf16 v[56:59], v[172:175], v[24:27], v[56:59]
    v_mfma_f32_16x16x32_bf16 v[60:63], v[172:175], v[28:31], v[60:63]
    v_mfma_f32_16x16x32_bf16 v[32:35], v[204:207], v[0:3], v[32:35]
    v_mfma_f32_16x16x32_bf16 v[36:39], v[204:207], v[4:7], v[36:39]
    v_mfma_f32_16x16x32_bf16 v[40:43], v[204:207], v[8:11], v[40:43]
    v_mfma_f32_16x16x32_bf16 v[44:47], v[204:207], v[12:15], v[44:47]
    v_mfma_f32_16x16x32_bf16 v[48:51], v[204:207], v[16:19], v[48:51]
    v_mfma_f32_16x16x32_bf16 v[52:55], v[204:207], v[20:23], v[52:55]
    v_mfma_f32_16x16x32_bf16 v[56:59], v[204:207], v[24:27], v[56:59]
    v_mfma_f32_16x16x32_bf16 v[60:63], v[204:207], v[28:31], v[60:63]
    s_setprio 0
    s_nop 7
    v_cvt_pk_bf16_f32 v240, v32, v36
    v_cvt_pk_bf16_f32 v241, v40, v44
    v_cvt_pk_bf16_f32 v242, v48, v52
    v_cvt_pk_bf16_f32 v243, v56, v60
    buffer_store_dwordx4 v[240:243], v249, s[12:15], s39 offen sc1
    s_add_u32 s39, s39, 2736128
    v_cvt_pk_bf16_f32 v244, v33, v37
    v_cvt_pk_bf16_f32 v245, v41, v45
    v_cvt_pk_bf16_f32 v246, v49, v53
    v_cvt_pk_bf16_f32 v247, v57, v61
    buffer_store_dwordx4 v[244:247], v249, s[12:15], s39 offen sc1
    s_add_u32 s39, s39, 2736128
    v_cvt_pk_bf16_f32 v240, v34, v38
    v_cvt_pk_bf16_f32 v241, v42, v46
    v_cvt_pk_bf16_f32 v242, v50, v54
    v_cvt_pk_bf16_f32 v243, v58, v62
    buffer_store_dwordx4 v[240:243], v249, s[12:15], s39 offen sc1
    s_add_u32 s39, s39, 2736128
    v_cvt_pk_bf16_f32 v244, v35, v39
    v_cvt_pk_bf16_f32 v245, v43, v47
    v_cvt_pk_bf16_f32 v246, v51, v55
    v_cvt_pk_bf16_f32 v247, v59, v63
    buffer_store_dwordx4 v[244:247], v249, s[12:15], s39 offen sc1
    s_add_u32 s39, s39, 2736128
    s_cmp_eq_u32 s26, 1
    s_cbranch_scc1 K12_XS1595_END
    s_cmp_lg_u32 s26, 0
    s_cbranch_scc1 K12_UT1
    s_cmp_lt_u32 s40, 4
    s_cbranch_scc1 K12_UT1
    s_lshl_b32 s36, s40, 3
    s_sub_i32 s36, s36, 20
    s_max_i32 s36, s36, 1
    s_mov_b32 s37, 131072
K12_UL1:
    v_mov_b32 v255, 155648
    ds_read_b32 v255, v255
    s_waitcnt lgkmcnt(0)
    v_cmp_gt_u32 vcc, s36, v255
    s_sub_u32 s37, s37, 1
    s_cmp_eq_u32 s37, 0
    s_cbranch_scc1 K12_UT1
    s_cbranch_vccz K12_UT1
    s_sleep 2
    s_branch K12_UL1
K12_UT1:
K12_XS1595_HI:
    s_setprio 1
    v_mfma_f32_16x16x32_bf16 v[32:35], v[176:179], v[64:67], 0
    v_mfma_f32_16x16x32_bf16 v[36:39], v[176:179], v[68:71], 0
    v_mfma_f32_16x16x32_bf16 v[40:43], v[176:179], v[72:75], 0
    v_mfma_f32_16x16x32_bf16 v[44:47], v[176:179], v[76:79], 0
    v_mfma_f32_16x16x32_bf16 v[48:51], v[176:179], v[80:83], 0
    v_mfma_f32_16x16x32_bf16 v[52:55], v[176:179], v[84:87], 0
    v_mfma_f32_16x16x32_bf16 v[56:59], v[176:179], v[88:91], 0
    v_mfma_f32_16x16x32_bf16 v[60:63], v[176:179], v[92:95], 0
    v_mfma_f32_16x16x32_bf16 v[32:35], v[208:211], v[64:67], v[32:35]
    v_mfma_f32_16x16x32_bf16 v[36:39], v[208:211], v[68:71], v[36:39]
    v_mfma_f32_16x16x32_bf16 v[40:43], v[208:211], v[72:75], v[40:43]
    v_mfma_f32_16x16x32_bf16 v[44:47], v[208:211], v[76:79], v[44:47]
    v_mfma_f32_16x16x32_bf16 v[48:51], v[208:211], v[80:83], v[48:51]
    v_mfma_f32_16x16x32_bf16 v[52:55], v[208:211], v[84:87], v[52:55]
    v_mfma_f32_16x16x32_bf16 v[56:59], v[208:211], v[88:91], v[56:59]
    v_mfma_f32_16x16x32_bf16 v[60:63], v[208:211], v[92:95], v[60:63]
    v_mfma_f32_16x16x32_bf16 v[32:35], v[180:183], v[0:3], v[32:35]
    v_mfma_f32_16x16x32_bf16 v[36:39], v[180:183], v[4:7], v[36:39]
    v_mfma_f32_16x16x32_bf16 v[40:43], v[180:183], v[8:11], v[40:43]
    v_mfma_f32_16x16x32_bf16 v[44:47], v[180:183], v[12:15], v[44:47]
    v_mfma_f32_16x16x32_bf16 v[48:51], v[180:183], v[16:19], v[48:51]
    v_mfma_f32_16x16x32_bf16 v[52:55], v[180:183], v[20:23], v[52:55]
    v_mfma_f32_16x16x32_bf16 v[56:59], v[180:183], v[24:27], v[56:59]
    v_mfma_f32_16x16x32_bf16 v[60:63], v[180:183], v[28:31], v[60:63]
    v_mfma_f32_16x16x32_bf16 v[32:35], v[212:215], v[0:3], v[32:35]
    v_mfma_f32_16x16x32_bf16 v[36:39], v[212:215], v[4:7], v[36:39]
    v_mfma_f32_16x16x32_bf16 v[40:43], v[212:215], v[8:11], v[40:43]
    v_mfma_f32_16x16x32_bf16 v[44:47], v[212:215], v[12:15], v[44:47]
    v_mfma_f32_16x16x32_bf16 v[48:51], v[212:215], v[16:19], v[48:51]
    v_mfma_f32_16x16x32_bf16 v[52:55], v[212:215], v[20:23], v[52:55]
    v_mfma_f32_16x16x32_bf16 v[56:59], v[212:215], v[24:27], v[56:59]
    v_mfma_f32_16x16x32_bf16 v[60:63], v[212:215], v[28:31], v[60:63]
    s_setprio 0
    s_nop 7
    v_cvt_pk_bf16_f32 v240, v32, v36
    v_cvt_pk_bf16_f32 v241, v40, v44
    v_cvt_pk_bf16_f32 v242, v48, v52
    v_cvt_pk_bf16_f32 v243, v56, v60
    buffer_store_dwordx4 v[240:243], v249, s[12:15], s39 offen sc1
    s_add_u32 s39, s39, 2736128
    v_cvt_pk_bf16_f32 v244, v33, v37
    v_cvt_pk_bf16_f32 v245, v41, v45
    v_cvt_pk_bf16_f32 v246, v49, v53
    v_cvt_pk_bf16_f32 v247, v57, v61
    buffer_store_dwordx4 v[244:247], v249, s[12:15], s39 offen sc1
    s_add_u32 s39, s39, 2736128
    v_cvt_pk_bf16_f32 v240, v34, v38
    v_cvt_pk_bf16_f32 v241, v42, v46
    v_cvt_pk_bf16_f32 v242, v50, v54
    v_cvt_pk_bf16_f32 v243, v58, v62
    buffer_store_dwordx4 v[240:243], v249, s[12:15], s39 offen sc1
    s_add_u32 s39, s39, 2736128
    v_cvt_pk_bf16_f32 v244, v35, v39
    v_cvt_pk_bf16_f32 v245, v43, v47
    v_cvt_pk_bf16_f32 v246, v51, v55
    v_cvt_pk_bf16_f32 v247, v59, v63
    buffer_store_dwordx4 v[244:247], v249, s[12:15], s39 offen sc1
    s_add_u32 s39, s39, 2736128
    s_cmp_lg_u32 s26, 2
    s_cbranch_scc1 K12_UT2
    s_cmp_lt_u32 s40, 4
    s_cbranch_scc1 K12_UT2
    s_lshl_b32 s36, s40, 3
    s_sub_i32 s36, s36, 20
    s_max_i32 s36, s36, 1
    s_mov_b32 s37, 131072
K12_UL2:
    v_mov_b32 v255, 155648
    ds_read_b32 v255, v255
    s_waitcnt lgkmcnt(0)
    v_cmp_gt_u32 vcc, s36, v255
    s_sub_u32 s37, s37, 1
    s_cmp_eq_u32 s37, 0
    s_cbranch_scc1 K12_UT2
    s_cbranch_vccz K12_UT2
    s_sleep 2
    s_branch K12_UL2
K12_UT2:
    s_setprio 1
    v_mfma_f32_16x16x32_bf16 v[32:35], v[184:187], v[64:67], 0
    v_mfma_f32_16x16x32_bf16 v[36:39], v[184:187], v[68:71], 0
    v_mfma_f32_16x16x32_bf16 v[40:43], v[184:187], v[72:75], 0
    v_mfma_f32_16x16x32_bf16 v[44:47], v[184:187], v[76:79], 0
    v_mfma_f32_16x16x32_bf16 v[48:51], v[184:187], v[80:83], 0
    v_mfma_f32_16x16x32_bf16 v[52:55], v[184:187], v[84:87], 0
    v_mfma_f32_16x16x32_bf16 v[56:59], v[184:187], v[88:91], 0
    v_mfma_f32_16x16x32_bf16 v[60:63], v[184:187], v[92:95], 0
    v_mfma_f32_16x16x32_bf16 v[32:35], v[216:219], v[64:67], v[32:35]
    v_mfma_f32_16x16x32_bf16 v[36:39], v[216:219], v[68:71], v[36:39]
    v_mfma_f32_16x16x32_bf16 v[40:43], v[216:219], v[72:75], v[40:43]
    v_mfma_f32_16x16x32_bf16 v[44:47], v[216:219], v[76:79], v[44:47]
    v_mfma_f32_16x16x32_bf16 v[48:51], v[216:219], v[80:83], v[48:51]
    v_mfma_f32_16x16x32_bf16 v[52:55], v[216:219], v[84:87], v[52:55]
    v_mfma_f32_16x16x32_bf16 v[56:59], v[216:219], v[88:91], v[56:59]
    v_mfma_f32_16x16x32_bf16 v[60:63], v[216:219], v[92:95], v[60:63]
    v_mfma_f32_16x16x32_bf16 v[32:35], v[188:191], v[0:3], v[32:35]
    v_mfma_f32_16x16x32_bf16 v[36:39], v[188:191], v[4:7], v[36:39]
    v_mfma_f32_16x16x32_bf16 v[40:43], v[188:191], v[8:11], v[40:43]
    v_mfma_f32_16x16x32_bf16 v[44:47], v[188:191], v[12:15], v[44:47]
    v_mfma_f32_16x16x32_bf16 v[48:51], v[188:191], v[16:19], v[48:51]
    v_mfma_f32_16x16x32_bf16 v[52:55], v[188:191], v[20:23], v[52:55]
    v_mfma_f32_16x16x32_bf16 v[56:59], v[188:191], v[24:27], v[56:59]
    v_mfma_f32_16x16x32_bf16 v[60:63], v[188:191], v[28:31], v[60:63]
    v_mfma_f32_16x16x32_bf16 v[32:35], v[220:223], v[0:3], v[32:35]
    v_mfma_f32_16x16x32_bf16 v[36:39], v[220:223], v[4:7], v[36:39]
    v_mfma_f32_16x16x32_bf16 v[40:43], v[220:223], v[8:11], v[40:43]
    v_mfma_f32_16x16x32_bf16 v[44:47], v[220:223], v[12:15], v[44:47]
    v_mfma_f32_16x16x32_bf16 v[48:51], v[220:223], v[16:19], v[48:51]
    v_mfma_f32_16x16x32_bf16 v[52:55], v[220:223], v[20:23], v[52:55]
    v_mfma_f32_16x16x32_bf16 v[56:59], v[220:223], v[24:27], v[56:59]
    v_mfma_f32_16x16x32_bf16 v[60:63], v[220:223], v[28:31], v[60:63]
    s_setprio 0
    s_nop 7
    v_cvt_pk_bf16_f32 v240, v32, v36
    v_cvt_pk_bf16_f32 v241, v40, v44
    v_cvt_pk_bf16_f32 v242, v48, v52
    v_cvt_pk_bf16_f32 v243, v56, v60
    buffer_store_dwordx4 v[240:243], v249, s[12:15], s39 offen sc1
    s_add_u32 s39, s39, 2736128
    v_cvt_pk_bf16_f32 v244, v33, v37
    v_cvt_pk_bf16_f32 v245, v41, v45
    v_cvt_pk_bf16_f32 v246, v49, v53
    v_cvt_pk_bf16_f32 v247, v57, v61
    buffer_store_dwordx4 v[244:247], v249, s[12:15], s39 offen sc1
    s_add_u32 s39, s39, 2736128
    v_cvt_pk_bf16_f32 v240, v34, v38
    v_cvt_pk_bf16_f32 v241, v42, v46
    v_cvt_pk_bf16_f32 v242, v50, v54
    v_cvt_pk_bf16_f32 v243, v58, v62
    buffer_store_dwordx4 v[240:243], v249, s[12:15], s39 offen sc1
    s_add_u32 s39, s39, 2736128
    v_cvt_pk_bf16_f32 v244, v35, v39
    v_cvt_pk_bf16_f32 v245, v43, v47
    v_cvt_pk_bf16_f32 v246, v51, v55
    v_cvt_pk_bf16_f32 v247, v59, v63
    buffer_store_dwordx4 v[244:247], v249, s[12:15], s39 offen sc1
K12_XS1595_END:
    s_mov_b32 s41, s40
    s_add_u32 s40, s40, 1
    s_cmp_eq_u32 s41, 3
    s_cbranch_scc0 K12_ES3
    s_waitcnt vmcnt(0)
    s_mov_b32 s34, -1
    s_cmp_ge_u32 s41, 8
    s_cbranch_scc1 K12_SG4
    s_lshl_b32 s36, s41, 2
    s_add_u32 s37, s36, 155680
    s_mov_b64 exec, 1
    v_mov_b32 v255, s37
    v_mov_b32 v240, 1
    ds_add_rtn_u32 v240, v255, v240
    s_waitcnt lgkmcnt(0)
    v_readfirstlane_b32 s37, v240
    s_nop 3
    s_cmp_eq_u32 s37, 3
    s_cbranch_scc0 K12_SH4
    s_lshl_b32 s36, s36, 8
    v_mov_b32 v255, 1
    v_mov_b32 v240, s36
    buffer_atomic_add v255, v240, s[60:63], 0 offen sc0 sc1
    s_mov_b32 s34, s41
K12_SH4:
    s_mov_b64 exec, -1
K12_SG4:
    s_waitcnt vmcnt(0)
    s_cmp_ge_u32 s34, 8
    s_cbranch_scc1 K12_PB5
    v_readfirstlane_b32 s37, v255
    s_nop 3
    s_cmp_eq_u32 s37, 255
    s_cbranch_scc0 K12_PB5
    s_lshl_b32 s36, s34, 4
    s_add_u32 s36, s36, 16384
    s_mov_b64 exec, 1
    v_mov_b32 v255, 1
    v_mov_b32 v240, s36
    buffer_store_dword v255, v240, s[60:63], 0 offen sc1
    s_mov_b64 exec, -1
K12_PB5:
    s_mov_b32 s34, -1
    s_mov_b32 s41, -1
K12_ES3:
    s_waitcnt vmcnt(8)
    s_branch K12_XP_F
K12_XP_E:
    s_mov_b32 s41, s40
    s_add_u32 s40, s40, 1
    s_cmp_eq_u32 s41, 3
    s_cbranch_scc0 K12_ES6
    s_waitcnt vmcnt(0)
    s_mov_b32 s34, -1
    s_cmp_ge_u32 s41, 8
    s_cbranch_scc1 K12_SG7
    s_lshl_b32 s36, s41, 2
    s_add_u32 s37, s36, 155680
    s_mov_b64 exec, 1
    v_mov_b32 v255, s37
    v_mov_b32 v240, 1
    ds_add_rtn_u32 v240, v255, v240
    s_waitcnt lgkmcnt(0)
    v_readfirstlane_b32 s37, v240
    s_nop 3
    s_cmp_eq_u32 s37, 3
    s_cbranch_scc0 K12_SH7
    s_lshl_b32 s36, s36, 8
    v_mov_b32 v255, 1
    v_mov_b32 v240, s36
    buffer_atomic_add v255, v240, s[60:63], 0 offen sc0 sc1
    s_mov_b32 s34, s41
K12_SH7:
    s_mov_b64 exec, -1
K12_SG7:
    s_waitcnt vmcnt(0)
    s_cmp_ge_u32 s34, 8
    s_cbranch_scc1 K12_PB8
    v_readfirstlane_b32 s37, v255
    s_nop 3
    s_cmp_eq_u32 s37, 255
    s_cbranch_scc0 K12_PB8
    s_lshl_b32 s36, s34, 4
    s_add_u32 s36, s36, 16384
    s_mov_b64 exec, 1
    v_mov_b32 v255, 1
    v_mov_b32 v240, s36
    buffer_store_dword v255, v240, s[60:63], 0 offen sc1
    s_mov_b64 exec, -1
K12_PB8:
    s_mov_b32 s34, -1
    s_mov_b32 s41, -1
K12_ES6:
    s_waitcnt vmcnt(0)
K12_XP_F:
    s_cmp_ge_u32 s34, 8
    s_cbranch_scc1 K12_PB9
    v_readfirstlane_b32 s37, v255
    s_nop 3
    s_cmp_eq_u32 s37, 255
    s_cbranch_scc0 K12_PB9
    s_lshl_b32 s36, s34, 4
    s_add_u32 s36, s36, 16384
    s_mov_b64 exec, 1
    v_mov_b32 v255, 1
    v_mov_b32 v240, s36
    buffer_store_dword v255, v240, s[60:63], 0 offen sc1
    s_mov_b64 exec, -1
K12_PB9:
    s_cmp_ge_u32 s40, 8
    s_cbranch_scc1 K12_PFIN
K12_WENTRY:
    s_waitcnt vmcnt(0)
    s_mov_b32 s34, -1
    s_cmp_ge_u32 s41, 8
    s_cbranch_scc1 K12_SG10
    s_lshl_b32 s36, s41, 2
    s_add_u32 s37, s36, 155680
    s_mov_b64 exec, 1
    v_mov_b32 v255, s37
    v_mov_b32 v240, 1
    ds_add_rtn_u32 v240, v255, v240
    s_waitcnt lgkmcnt(0)
    v_readfirstlane_b32 s37, v240
    s_nop 3
    s_cmp_eq_u32 s37, 3
    s_cbranch_scc0 K12_SH10
    s_lshl_b32 s36, s36, 8
    v_mov_b32 v255, 1
    v_mov_b32 v240, s36
    buffer_atomic_add v255, v240, s[60:63], 0 offen sc0 sc1
    s_mov_b32 s34, s41
K12_SH10:
    s_mov_b64 exec, -1
K12_SG10:
    s_cmp_ge_u32 s34, 8
    s_cbranch_scc1 K12_EP11
    s_waitcnt vmcnt(0)
    s_cmp_ge_u32 s34, 8
    s_cbranch_scc1 K12_PB12
    v_readfirstlane_b32 s37, v255
    s_nop 3
    s_cmp_eq_u32 s37, 255
    s_cbranch_scc0 K12_PB12
    s_lshl_b32 s36, s34, 4
    s_add_u32 s36, s36, 16384
    s_mov_b64 exec, 1
    v_mov_b32 v255, 1
    v_mov_b32 v240, s36
    buffer_store_dword v255, v240, s[60:63], 0 offen sc1
    s_mov_b64 exec, -1
K12_PB12:
    s_mov_b32 s34, -1
K12_EP11:
    v_perm_b32 v64, v100, v96, s28
    v_perm_b32 v68, v100, v96, s29
    v_perm_b32 v65, v108, v104, s28
    v_perm_b32 v69, v108, v104, s29
    v_perm_b32 v66, v116, v112, s28
    v_perm_b32 v70, v116, v112, s29
    v_perm_b32 v67, v124, v120, s28
    v_perm_b32 v71, v124, v120, s29
    v_perm_b32 v72, v101, v97, s28
    v_perm_b32 v76, v101, v97, s29
    v_perm_b32 v73, v109, v105, s28
    v_perm_b32 v77, v109, v105, s29
    v_perm_b32 v74, v117, v113, s28
    v_perm_b32 v78, v117, v113, s29
    v_perm_b32 v75, v125, v121, s28
    v_perm_b32 v79, v125, v121, s29
    v_perm_b32 v80, v102, v98, s28
    v_perm_b32 v84, v102, v98, s29
    v_perm_b32 v81, v110, v106, s28
    v_perm_b32 v85, v110, v106, s29
    v_perm_b32 v82, v118, v114, s28
    v_perm_b32 v86, v118, v114, s29
    v_perm_b32 v83, v126, v122, s28
    v_perm_b32 v87, v126, v122, s29
    v_perm_b32 v88, v103, v99, s28
    v_perm_b32 v92, v103, v99, s29
    v_perm_b32 v89, v111, v107, s28
    v_perm_b32 v93, v111, v107, s29
    v_perm_b32 v90, v119, v115, s28
    v_perm_b32 v94, v119, v115, s29
    v_perm_b32 v91, v127, v123, s28
    v_perm_b32 v95, v127, v123, s29
    s_lshl_b32 s36, s40, 3
    s_sub_i32 s36, s36, 24
    s_max_i32 s36, s36, 1
    s_mov_b32 s37, 131072
K12_GL1:
    v_mov_b32 v240, 155648
    ds_read_b32 v240, v240
    s_waitcnt lgkmcnt(0)
    v_cmp_gt_u32 vcc, s36, v240
    s_sub_u32 s37, s37, 1
    s_cmp_eq_u32 s37, 0
    s_cbranch_scc1 K12_GT1
    s_cbranch_vccz K12_GT1
    s_sleep 2
    s_branch K12_GL1
K12_GT1:
    s_lshl_b32 s36, s40, 2
    s_add_u32 s36, s36, 155840
    s_mov_b64 exec, 1
    v_mov_b32 v240, s36
    v_mov_b32 v241, 1
    ds_add_u32 v240, v241
    s_mov_b64 exec, -1
    s_mov_b32 s37, 131072
K12_BL1:
    v_mov_b32 v240, s36
    ds_read_b32 v240, v240
    s_waitcnt lgkmcnt(0)
    v_cmp_gt_u32 vcc, 4, v240
    s_sub_u32 s37, s37, 1
    s_cmp_eq_u32 s37, 0
    s_cbranch_scc1 K12_BT1
    s_cbranch_vccz K12_BT1
    s_sleep 1
    s_branch K12_BL1
K12_BT1:
    s_add_u32 s42, s40, 1
    s_mul_i32 s36, s42, 85
    s_add_u32 s36, s36, s2
    s_and_b32 s36, s36, 255
    s_mul_hi_u32 s37, s36, 0x55555556
    s_mul_i32 s38, s37, 3
    s_cmp_eq_u32 s38, s36
    s_cselect_b32 s27, 1, 0
    s_cmp_lt_u32 s37, 78
    s_cselect_b32 s27, s27, 0
    s_add_u32 s37, s37, 89
    s_add_u32 s26, s21, 1
    s_cmp_eq_u32 s27, 1
    s_cselect_b32 s26, 0, s26
    s_and_b32 s36, s27, s21
    s_cselect_b32 s30, s37, s24
    s_cselect_b32 s25, 1, s49
    s_mov_b32 s27, 1
    s_cmp_eq_u32 s27, 0
    s_cbranch_scc1 K12_WP_N
    s_mul_i32 s36, s25, 16384000
    s_add_u32 s4, s52, s36
    s_addc_u32 s5, s53, 0
    s_and_b32 s5, s5, 0xffff
    s_lshl_b32 s36, s42, 8
    s_mul_i32 s37, s30, 98304
    s_add_u32 s36, s36, s37
    buffer_load_dwordx4 v[0:3], v248, s[4:7], s36 offen
    buffer_load_dwordx4 v[4:7], v248, s[4:7], s36 offen offset:2048
    s_add_u32 s36, s36, 4096
    buffer_load_dwordx4 v[8:11], v248, s[4:7], s36 offen
    buffer_load_dwordx4 v[12:15], v248, s[4:7], s36 offen offset:2048
    s_add_u32 s36, s36, 4096
    buffer_load_dwordx4 v[16:19], v248, s[4:7], s36 offen
    buffer_load_dwordx4 v[20:23], v248, s[4:7], s36 offen offset:2048
    s_add_u32 s36, s36, 4096
    buffer_load_dwordx4 v[24:27], v248, s[4:7], s36 offen
    buffer_load_dwordx4 v[28:31], v248, s[4:7], s36 offen offset:2048
    s_add_u32 s36, s36, 53248
    buffer_load_dwordx4 v[32:35], v248, s[4:7], s36 offen
    buffer_load_dwordx4 v[36:39], v248, s[4:7], s36 offen offset:2048
    s_add_u32 s36, s36, 4096
    buffer_load_dwordx4 v[40:43], v248, s[4:7], s36 offen
    buffer_load_dwordx4 v[44:47], v248, s[4:7], s36 offen offset:2048
    s_add_u32 s36, s36, 4096
    buffer_load_dwordx4 v[48:51], v248, s[4:7], s36 offen
    buffer_load_dwordx4 v[52:55], v248, s[4:7], s36 offen offset:2048
    s_add_u32 s36, s36, 4096
    buffer_load_dwordx4 v[56:59], v248, s[4:7], s36 offen
    buffer_load_dwordx4 v[60:63], v248, s[4:7], s36 offen offset:2048
    s_branch K12_WP_M
K12_WP_N:
K12_WP_M:
    s_lshl_b32 s36, s40, 7
    s_add_u32 s36, s36, s22
    s_and_b32 s37, s36, 3
    s_lshr_b32 s38, s36, 1
    s_and_b32 s38, s38, 4
    s_or_b32 s37, s37, s38
    v_bfe_u32 v253, v254, 5, 3
    v_xor_b32 v253, s37, v253
    v_lshl_add_u32 v253, v253, 5, v251
    s_lshl_b32 s36, s36, 9
    s_add_u32 s39, s36, s32
    s_setprio 1
    v_mfma_f32_16x16x32_bf16 v[128:131], v[224:227], v[64:67], 0
    v_mfma_f32_16x16x32_bf16 v[132:135], v[224:227], v[68:71], 0
    v_mfma_f32_16x16x32_bf16 v[136:139], v[224:227], v[72:75], 0
    v_mfma_f32_16x16x32_bf16 v[140:143], v[224:227], v[76:79], 0
    v_mfma_f32_16x16x32_bf16 v[144:147], v[224:227], v[80:83], 0
    v_mfma_f32_16x16x32_bf16 v[148:151], v[224:227], v[84:87], 0
    v_mfma_f32_16x16x32_bf16 v[152:155], v[224:227], v[88:91], 0
    v_mfma_f32_16x16x32_bf16 v[156:159], v[224:227], v[92:95], 0
    s_setprio 0
    s_nop 7
    v_cvt_pk_bf16_f32 v240, v128, v132
    v_cvt_pk_bf16_f32 v241, v136, v140
    v_cvt_pk_bf16_f32 v242, v144, v148
    v_cvt_pk_bf16_f32 v243, v152, v156
    buffer_store_dwordx4 v[240:243], v253, s[16:19], s39 offen sc1
    s_add_u32 s39, s39, 4194304
    v_cvt_pk_bf16_f32 v244, v129, v133
    v_cvt_pk_bf16_f32 v245, v137, v141
    v_cvt_pk_bf16_f32 v246, v145, v149
    v_cvt_pk_bf16_f32 v247, v153, v157
    buffer_store_dwordx4 v[244:247], v253, s[16:19], s39 offen sc1
    s_add_u32 s39, s39, 4194304
    v_cvt_pk_bf16_f32 v240, v130, v134
    v_cvt_pk_bf16_f32 v241, v138, v142
    v_cvt_pk_bf16_f32 v242, v146, v150
    v_cvt_pk_bf16_f32 v243, v154, v158
    buffer_store_dwordx4 v[240:243], v253, s[16:19], s39 offen sc1
    s_add_u32 s39, s39, 4194304
    v_cvt_pk_bf16_f32 v244, v131, v135
    v_cvt_pk_bf16_f32 v245, v139, v143
    v_cvt_pk_bf16_f32 v246, v147, v151
    v_cvt_pk_bf16_f32 v247, v155, v159
    buffer_store_dwordx4 v[244:247], v253, s[16:19], s39 offen sc1
    s_add_u32 s39, s39, 4194304
    s_setprio 1
    v_mfma_f32_16x16x32_bf16 v[128:131], v[228:231], v[64:67], 0
    v_mfma_f32_16x16x32_bf16 v[132:135], v[228:231], v[68:71], 0
    v_mfma_f32_16x16x32_bf16 v[136:139], v[228:231], v[72:75], 0
    v_mfma_f32_16x16x32_bf16 v[140:143], v[228:231], v[76:79], 0
    v_mfma_f32_16x16x32_bf16 v[144:147], v[228:231], v[80:83], 0
    v_mfma_f32_16x16x32_bf16 v[148:151], v[228:231], v[84:87], 0
    v_mfma_f32_16x16x32_bf16 v[152:155], v[228:231], v[88:91], 0
    v_mfma_f32_16x16x32_bf16 v[156:159], v[228:231], v[92:95], 0
    s_setprio 0
    s_nop 7
    v_cvt_pk_bf16_f32 v240, v128, v132
    v_cvt_pk_bf16_f32 v241, v136, v140
    v_cvt_pk_bf16_f32 v242, v144, v148
    v_cvt_pk_bf16_f32 v243, v152, v156
    buffer_store_dwordx4 v[240:243], v253, s[16:19], s39 offen sc1
    s_add_u32 s39, s39, 4194304
    v_cvt_pk_bf16_f32 v244, v129, v133
    v_cvt_pk_bf16_f32 v245, v137, v141
    v_cvt_pk_bf16_f32 v246, v145, v149
    v_cvt_pk_bf16_f32 v247, v153, v157
    buffer_store_dwordx4 v[244:247], v253, s[16:19], s39 offen sc1
    s_add_u32 s39, s39, 4194304
    v_cvt_pk_bf16_f32 v240, v130, v134
    v_cvt_pk_bf16_f32 v241, v138, v142
    v_cvt_pk_bf16_f32 v242, v146, v150
    v_cvt_pk_bf16_f32 v243, v154, v158
    buffer_store_dwordx4 v[240:243], v253, s[16:19], s39 offen sc1
    s_add_u32 s39, s39, 4194304
    v_cvt_pk_bf16_f32 v244, v131, v135
    v_cvt_pk_bf16_f32 v245, v139, v143
    v_cvt_pk_bf16_f32 v246, v147, v151
    v_cvt_pk_bf16_f32 v247, v155, v159
    buffer_store_dwordx4 v[244:247], v253, s[16:19], s39 offen sc1
    s_add_u32 s39, s39, 4194304
    s_cmp_lt_u32 s40, 4
    s_cbranch_scc1 K12_UT3
    s_lshl_b32 s36, s40, 3
    s_sub_i32 s36, s36, 20
    s_max_i32 s36, s36, 1
    s_mov_b32 s37, 131072
K12_UL3:
    v_mov_b32 v255, 155648
    ds_read_b32 v255, v255
    s_waitcnt lgkmcnt(0)
    v_cmp_gt_u32 vcc, s36, v255
    s_sub_u32 s37, s37, 1
    s_cmp_eq_u32 s37, 0
    s_cbranch_scc1 K12_UT3
    s_cbranch_vccz K12_UT3
    s_sleep 2
    s_branch K12_UL3
K12_UT3:
    s_setprio 1
    v_mfma_f32_16x16x32_bf16 v[128:131], v[232:235], v[64:67], 0
    v_mfma_f32_16x16x32_bf16 v[132:135], v[232:235], v[68:71], 0
    v_mfma_f32_16x16x32_bf16 v[136:139], v[232:235], v[72:75], 0
    v_mfma_f32_16x16x32_bf16 v[140:143], v[232:235], v[76:79], 0
    v_mfma_f32_16x16x32_bf16 v[144:147], v[232:235], v[80:83], 0
    v_mfma_f32_16x16x32_bf16 v[148:151], v[232:235], v[84:87], 0
    v_mfma_f32_16x16x32_bf16 v[152:155], v[232:235], v[88:91], 0
    v_mfma_f32_16x16x32_bf16 v[156:159], v[232:235], v[92:95], 0
    s_setprio 0
    s_nop 7
    v_cvt_pk_bf16_f32 v240, v128, v132
    v_cvt_pk_bf16_f32 v241, v136, v140
    v_cvt_pk_bf16_f32 v242, v144, v148
    v_cvt_pk_bf16_f32 v243, v152, v156
    buffer_store_dwordx4 v[240:243], v253, s[16:19], s39 offen sc1
    s_add_u32 s39, s39, 4194304
    v_cvt_pk_bf16_f32 v244, v129, v133
    v_cvt_pk_bf16_f32 v245, v137, v141
    v_cvt_pk_bf16_f32 v246, v145, v149
    v_cvt_pk_bf16_f32 v247, v153, v157
    buffer_store_dwordx4 v[244:247], v253, s[16:19], s39 offen sc1
    s_add_u32 s39, s39, 4194304
    v_cvt_pk_bf16_f32 v240, v130, v134
    v_cvt_pk_bf16_f32 v241, v138, v142
    v_cvt_pk_bf16_f32 v242, v146, v150
    v_cvt_pk_bf16_f32 v243, v154, v158
    buffer_store_dwordx4 v[240:243], v253, s[16:19], s39 offen sc1
    s_add_u32 s39, s39, 4194304
    v_cvt_pk_bf16_f32 v244, v131, v135
    v_cvt_pk_bf16_f32 v245, v139, v143
    v_cvt_pk_bf16_f32 v246, v147, v151
    v_cvt_pk_bf16_f32 v247, v155, v159
    buffer_store_dwordx4 v[244:247], v253, s[16:19], s39 offen sc1
    s_add_u32 s39, s39, 4194304
    s_setprio 1
    v_mfma_f32_16x16x32_bf16 v[128:131], v[236:239], v[64:67], 0
    v_mfma_f32_16x16x32_bf16 v[132:135], v[236:239], v[68:71], 0
    v_mfma_f32_16x16x32_bf16 v[136:139], v[236:239], v[72:75], 0
    v_mfma_f32_16x16x32_bf16 v[140:143], v[236:239], v[76:79], 0
    v_mfma_f32_16x16x32_bf16 v[144:147], v[236:239], v[80:83], 0
    v_mfma_f32_16x16x32_bf16 v[148:151], v[236:239], v[84:87], 0
    v_mfma_f32_16x16x32_bf16 v[152:155], v[236:239], v[88:91], 0
    v_mfma_f32_16x16x32_bf16 v[156:159], v[236:239], v[92:95], 0
    s_setprio 0
    s_nop 7
    v_cvt_pk_bf16_f32 v240, v128, v132
    v_cvt_pk_bf16_f32 v241, v136, v140
    v_cvt_pk_bf16_f32 v242, v144, v148
    v_cvt_pk_bf16_f32 v243, v152, v156
    buffer_store_dwordx4 v[240:243], v253, s[16:19], s39 offen sc1
    s_add_u32 s39, s39, 4194304
    v_cvt_pk_bf16_f32 v244, v129, v133
    v_cvt_pk_bf16_f32 v245, v137, v141
    v_cvt_pk_bf16_f32 v246, v145, v149
    v_cvt_pk_bf16_f32 v247, v153, v157
    buffer_store_dwordx4 v[244:247], v253, s[16:19], s39 offen sc1
    s_add_u32 s39, s39, 4194304
    v_cvt_pk_bf16_f32 v240, v130, v134
    v_cvt_pk_bf16_f32 v241, v138, v142
    v_cvt_pk_bf16_f32 v242, v146, v150
    v_cvt_pk_bf16_f32 v243, v154, v158
    buffer_store_dwordx4 v[240:243], v253, s[16:19], s39 offen sc1
    s_add_u32 s39, s39, 4194304
    v_cvt_pk_bf16_f32 v244, v131, v135
    v_cvt_pk_bf16_f32 v245, v139, v143
    v_cvt_pk_bf16_f32 v246, v147, v151
    v_cvt_pk_bf16_f32 v247, v155, v159
    buffer_store_dwordx4 v[244:247], v253, s[16:19], s39 offen sc1
    s_mov_b32 s41, s40
    s_add_u32 s40, s40, 1
    s_cmp_eq_u32 s41, 3
    s_cbranch_scc0 K12_ES13
    s_waitcnt vmcnt(0)
    s_mov_b32 s34, -1
    s_cmp_ge_u32 s41, 8
    s_cbranch_scc1 K12_SG14
    s_lshl_b32 s36, s41, 2
    s_add_u32 s37, s36, 155680
    s_mov_b64 exec, 1
    v_mov_b32 v255, s37
    v_mov_b32 v240, 1
    ds_add_rtn_u32 v240, v255, v240
    s_waitcnt lgkmcnt(0)
    v_readfirstlane_b32 s37, v240
    s_nop 3
    s_cmp_eq_u32 s37, 3
    s_cbranch_scc0 K12_SH14
    s_lshl_b32 s36, s36, 8
    v_mov_b32 v255, 1
    v_mov_b32 v240, s36
    buffer_atomic_add v255, v240, s[60:63], 0 offen sc0 sc1
    s_mov_b32 s34, s41
K12_SH14:
    s_mov_b64 exec, -1
K12_SG14:
    s_waitcnt vmcnt(0)
    s_cmp_ge_u32 s34, 8
    s_cbranch_scc1 K12_PB15
    v_readfirstlane_b32 s37, v255
    s_nop 3
    s_cmp_eq_u32 s37, 255
    s_cbranch_scc0 K12_PB15
    s_lshl_b32 s36, s34, 4
    s_add_u32 s36, s36, 16384
    s_mov_b64 exec, 1
    v_mov_b32 v255, 1
    v_mov_b32 v240, s36
    buffer_store_dword v255, v240, s[60:63], 0 offen sc1
    s_mov_b64 exec, -1
K12_PB15:
    s_mov_b32 s34, -1
    s_mov_b32 s41, -1
K12_ES13:
    s_waitcnt vmcnt(16)
    s_cmp_ge_u32 s34, 8
    s_cbranch_scc1 K12_PB16
    v_readfirstlane_b32 s37, v255
    s_nop 3
    s_cmp_eq_u32 s37, 255
    s_cbranch_scc0 K12_PB16
    s_lshl_b32 s36, s34, 4
    s_add_u32 s36, s36, 16384
    s_mov_b64 exec, 1
    v_mov_b32 v255, 1
    v_mov_b32 v240, s36
    buffer_store_dword v255, v240, s[60:63], 0 offen sc1
    s_mov_b64 exec, -1
K12_PB16:
    s_cmp_lt_u32 s40, 8
    s_cbranch_scc1 K12_XW
K12_PFIN:
    s_waitcnt vmcnt(0)
    s_mov_b32 s34, -1
    s_cmp_ge_u32 s41, 8
    s_cbranch_scc1 K12_SG17
    s_lshl_b32 s36, s41, 2
    s_add_u32 s37, s36, 155680
    s_mov_b64 exec, 1
    v_mov_b32 v255, s37
    v_mov_b32 v240, 1
    ds_add_rtn_u32 v240, v255, v240
    s_waitcnt lgkmcnt(0)
    v_readfirstlane_b32 s37, v240
    s_nop 3
    s_cmp_eq_u32 s37, 3
    s_cbranch_scc0 K12_SH17
    s_lshl_b32 s36, s36, 8
    v_mov_b32 v255, 1
    v_mov_b32 v240, s36
    buffer_atomic_add v255, v240, s[60:63], 0 offen sc0 sc1
    s_mov_b32 s34, s41
K12_SH17:
    s_mov_b64 exec, -1
K12_SG17:
    s_waitcnt vmcnt(0)
    s_cmp_ge_u32 s34, 8
    s_cbranch_scc1 K12_PB18
    v_readfirstlane_b32 s37, v255
    s_nop 3
    s_cmp_eq_u32 s37, 255
    s_cbranch_scc0 K12_PB18
    s_lshl_b32 s36, s34, 4
    s_add_u32 s36, s36, 16384
    s_mov_b64 exec, 1
    v_mov_b32 v255, 1
    v_mov_b32 v240, s36
    buffer_store_dword v255, v240, s[60:63], 0 offen sc1
    s_mov_b64 exec, -1
K12_PB18:
    s_endpgm
K12_CONS:
    s_and_b32 s6, s2, 7
    s_lshl_b32 s6, s6, 2
    s_lshr_b32 s7, s2, 6
    s_add_u32 s6, s6, s7
    s_mov_b32 s51, s6
    s_mov_b32 s27, s6
    s_lshr_b32 s7, s2, 3
    s_and_b32 s7, s7, 7
    s_lshr_b32 s20, s7, 2
    s_and_b32 s21, s7, 3
    s_lshl_b32 s22, s6, 1
    s_add_u32 s22, s22, s20
    s_lshl_b32 s23, s6, 2
    s_add_u32 s23, s23, s21
    s_mul_i32 s24, s22, 684032
    s_mul_i32 s25, s23, 524288
    s_add_u32 s25, s25, 50331648
    s_mul_i32 s26, s22, 342016
    s_add_u32 s26, s26, 118489088
    s_add_u32 s8, s58, s24
    s_addc_u32 s9, s59, 0
    s_and_b32 s9, s9, 0xffff
    s_mov_b32 s10, 684032
    s_mov_b32 s11, 0x00020000
    s_add_u32 s12, s58, s25
    s_addc_u32 s13, s59, 0
    s_and_b32 s13, s13, 0xffff
    s_mov_b32 s14, 524288
    s_mov_b32 s15, 0x00020000
    s_add_u32 s16, s58, s26
    s_addc_u32 s17, s59, 0
    s_and_b32 s17, s17, 0xffff
    s_mov_b32 s18, 342016
    s_mov_b32 s19, 0x00020000
    s_add_u32 s4, s58, 153108480
    s_addc_u32 s5, s59, 0
    s_and_b32 s5, s5, 0xffff
    s_cmp_eq_u32 s3, 0
    s_cselect_b32 s6, 128, 0
    s_mov_b32 s7, 0x00020000
    s_mov_b32 s46, 155712
    s_cselect_b32 s46, s46, 155776
    s_mov_b32 s47, 155712
    s_cselect_b32 s47, s47, 155744
    s_cselect_b32 s45, 4, 0
    s_mov_b32 s50, s45
    v_and_b32 v8, 15, v2
    v_lshrrev_b32 v9, 4, v2
    v_lshlrev_b32 v1, 4, v2
    s_mul_i32 s30, s3, 5120
    s_mov_b32 s36, s30
    s_lshl_b32 s31, s3, 12
    s_add_u32 s37, s31, 22528
    s_lshr_b32 s28, s3, 1
    s_and_b32 s29, s3, 1
    s_lshl_b32 s33, s29, 9
    s_add_u32 s33, s33, 20480
    s_mul_i32 s38, s28, 896
    s_add_u32 s38, s38, s33
    s_lshl_b32 s34, s51, 1
    s_add_u32 s34, s34, s28
    s_mul_i32 s34, s34, 684032
    s_add_u32 s64, s58, s34
    s_addc_u32 s65, s59, 0
    s_and_b32 s65, s65, 0xffff
    s_mov_b32 s66, 684032
    s_mov_b32 s67, 0x00020000
    s_mov_b32 s44, 0xffffff
    s_cmp_eq_u32 s29, 0
    s_cselect_b32 s44, -1, s44
    s_mov_b32 s45, 0
    v_lshrrev_b32 v10, 1, v8
    v_xor_b32 v10, v10, v9
    v_lshlrev_b32 v10, 4, v10
    v_lshl_add_u32 v2, v8, 7, v10
    v_xor_b32 v3, 64, v2
    v_lshrrev_b32 v10, 2, v8
    v_lshl_add_u32 v11, v9, 3, v10
    v_lshlrev_b32 v11, 9, v11
    v_and_b32 v12, 1, v9
    v_lshl_or_b32 v10, v12, 2, v10
    s_lshl_b32 s28, s3, 1
    v_xor_b32 v10, s28, v10
    v_lshl_add_u32 v11, v10, 5, v11
    v_and_b32 v10, 3, v8
    v_lshl_add_u32 v11, v10, 3, v11
    v_add_u32 v4, 22528, v11
    s_lshl_b32 s28, s20, 5
    v_xor_b32 v4, s28, v4
    v_and_b32 v10, 3, v8
    v_lshlrev_b32 v10, 2, v10
    v_add_u32 v5, 155648, v10
    s_lshl_b32 s28, s3, 2
    s_add_u32 s28, s28, 155648
    v_mov_b32 v7, s28
    s_mov_b32 s35, 0x80008000
    s_mov_b32 s62, 0
    s_mov_b32 s63, 0
    s_mov_b32 s39, 0
    s_add_u32 m0, s39, s36
    s_nop 0
    buffer_load_dwordx4 v1, s[8:11], s30 offen sc1 lds
    buffer_load_dwordx4 v1, s[8:11], s30 offen offset:1024 sc1 lds
    buffer_load_dwordx4 v1, s[8:11], s30 offen offset:2048 sc1 lds
    buffer_load_dwordx4 v1, s[8:11], s30 offen offset:3072 sc1 lds
    s_add_u32 m0, m0, 4096
    s_add_u32 s34, s30, 4096
    buffer_load_dwordx4 v1, s[8:11], s34 offen sc1 lds
    s_add_u32 m0, s39, s37
    s_add_u32 s30, s30, 21376
    buffer_load_dwordx4 v1, s[12:15], s31 offen sc1 lds
    buffer_load_dwordx4 v1, s[12:15], s31 offen offset:1024 sc1 lds
    buffer_load_dwordx4 v1, s[12:15], s31 offen offset:2048 sc1 lds
    buffer_load_dwordx4 v1, s[12:15], s31 offen offset:3072 sc1 lds
    s_add_u32 m0, s39, s38
    s_mov_b64 exec, s[44:45]
    buffer_load_dwordx4 v1, s[64:67], s33 offen sc1 lds
    s_mov_b64 exec, -1
    s_add_u32 s31, s31, 16384
    s_add_u32 s33, s33, 21376
    s_add_u32 s39, s39, 38912
    s_add_u32 m0, s39, s36
    s_nop 0
    buffer_load_dwordx4 v1, s[8:11], s30 offen sc1 lds
    buffer_load_dwordx4 v1, s[8:11], s30 offen offset:1024 sc1 lds
    buffer_load_dwordx4 v1, s[8:11], s30 offen offset:2048 sc1 lds
    buffer_load_dwordx4 v1, s[8:11], s30 offen offset:3072 sc1 lds
    s_add_u32 m0, m0, 4096
    s_add_u32 s34, s30, 4096
    buffer_load_dwordx4 v1, s[8:11], s34 offen sc1 lds
    s_add_u32 m0, s39, s37
    s_add_u32 s30, s30, 21376
    buffer_load_dwordx4 v1, s[12:15], s31 offen sc1 lds
    buffer_load_dwordx4 v1, s[12:15], s31 offen offset:1024 sc1 lds
    buffer_load_dwordx4 v1, s[12:15], s31 offen offset:2048 sc1 lds
    buffer_load_dwordx4 v1, s[12:15], s31 offen offset:3072 sc1 lds
    s_add_u32 m0, s39, s38
    s_mov_b64 exec, s[44:45]
    buffer_load_dwordx4 v1, s[64:67], s33 offen sc1 lds
    s_mov_b64 exec, -1
    s_add_u32 s31, s31, 16384
    s_add_u32 s33, s33, 21376
    s_add_u32 s39, s39, 38912
    s_add_u32 m0, s39, s36
    s_nop 0
    buffer_load_dwordx4 v1, s[8:11], s30 offen sc1 lds
    buffer_load_dwordx4 v1, s[8:11], s30 offen offset:1024 sc1 lds
    buffer_load_dwordx4 v1, s[8:11], s30 offen offset:2048 sc1 lds
    buffer_load_dwordx4 v1, s[8:11], s30 offen offset:3072 sc1 lds
    s_add_u32 m0, m0, 4096
    s_add_u32 s34, s30, 4096
    buffer_load_dwordx4 v1, s[8:11], s34 offen sc1 lds
    s_add_u32 m0, s39, s37
    s_add_u32 s30, s30, 21376
    buffer_load_dwordx4 v1, s[12:15], s31 offen sc1 lds
    buffer_load_dwordx4 v1, s[12:15], s31 offen offset:1024 sc1 lds
    buffer_load_dwordx4 v1, s[12:15], s31 offen offset:2048 sc1 lds
    buffer_load_dwordx4 v1, s[12:15], s31 offen offset:3072 sc1 lds
    s_add_u32 m0, s39, s38
    s_mov_b64 exec, s[44:45]
    buffer_load_dwordx4 v1, s[64:67], s33 offen sc1 lds
    s_mov_b64 exec, -1
    s_add_u32 s31, s31, 16384
    s_add_u32 s33, s33, 21376
    s_add_u32 s39, s39, 38912
    s_mov_b32 m0, s46
    s_mov_b64 exec, 0xff
    buffer_load_dword v1, s[4:7], 0 offen sc1 lds
    s_mov_b64 exec, -1
    v_lshrrev_b32 v9, 4, v1
    v_and_b32 v8, 15, v9
    v_lshrrev_b32 v9, 4, v9
    v_and_b32 v10, 3, v8
    v_lshlrev_b32 v10, 2, v10
    v_lshrrev_b32 v12, 3, v8
    v_lshl_add_u32 v10, v12, 1, v10
    s_lshl_b32 s28, s3, 4
    s_add_u32 s28, s28, 1
    v_add_u32 v10, s28, v10
    v_bfe_u32 v11, v8, 2, 1
    v_and_b32 v13, 1, v9
    v_lshlrev_b32 v13, 3, v13
    v_mul_u32_u24 v14, 96, v11
    v_mad_u32_u24 v15, v10, v13, v14
    v_mad_u32_u24 v16, v10, 0, v15
    v_mad_u32_u24 v17, v10, 1, v15
    v_mad_u32_u24 v18, v10, 2, v15
    v_mad_u32_u24 v19, v10, 3, v15
    v_mad_u32_u24 v20, v10, 4, v15
    v_mad_u32_u24 v21, v10, 5, v15
    v_mad_u32_u24 v22, v10, 6, v15
    v_mad_u32_u24 v23, v10, 7, v15
    v_and_b32 v16, 127, v16
    v_and_b32 v17, 127, v17
    v_and_b32 v18, 127, v18
    v_and_b32 v19, 127, v19
    v_and_b32 v20, 127, v20
    v_and_b32 v21, 127, v21
    v_and_b32 v22, 127, v22
    v_and_b32 v23, 127, v23
    v_cvt_f32_u32 v16, v16
    v_cvt_f32_u32 v17, v17
    v_cvt_f32_u32 v18, v18
    v_cvt_f32_u32 v19, v19
    v_cvt_f32_u32 v20, v20
    v_cvt_f32_u32 v21, v21
    v_cvt_f32_u32 v22, v22
    v_cvt_f32_u32 v23, v23
    v_mul_f32 v16, 0x3c000000, v16
    v_mul_f32 v17, 0x3c000000, v17
    v_mul_f32 v18, 0x3c000000, v18
    v_mul_f32 v19, 0x3c000000, v19
    v_mul_f32 v20, 0x3c000000, v20
    v_mul_f32 v21, 0x3c000000, v21
    v_mul_f32 v22, 0x3c000000, v22
    v_mul_f32 v23, 0x3c000000, v23
    v_cos_f32 v16, v16
    v_cos_f32 v17, v17
    v_cos_f32 v18, v18
    v_cos_f32 v19, v19
    v_cos_f32 v20, v20
    v_cos_f32 v21, v21
    v_cos_f32 v22, v22
    v_cos_f32 v23, v23
    s_nop 0
    v_cvt_pk_bf16_f32 v24, v16, v17
    v_cvt_pk_bf16_f32 v25, v18, v19
    v_cvt_pk_bf16_f32 v26, v20, v21
    v_cvt_pk_bf16_f32 v27, v22, v23
    v_lshlrev_b32 v32, 16, v24
    v_and_b32 v33, 0xffff0000, v24
    v_sub_f32 v16, v16, v32
    v_sub_f32 v17, v17, v33
    v_lshlrev_b32 v32, 16, v25
    v_and_b32 v33, 0xffff0000, v25
    v_sub_f32 v18, v18, v32
    v_sub_f32 v19, v19, v33
    v_lshlrev_b32 v32, 16, v26
    v_and_b32 v33, 0xffff0000, v26
    v_sub_f32 v20, v20, v32
    v_sub_f32 v21, v21, v33
    v_lshlrev_b32 v32, 16, v27
    v_and_b32 v33, 0xffff0000, v27
    v_sub_f32 v22, v22, v32
    v_sub_f32 v23, v23, v33
    v_cvt_pk_bf16_f32 v28, v16, v17
    v_cvt_pk_bf16_f32 v29, v18, v19
    v_cvt_pk_bf16_f32 v30, v20, v21
    v_cvt_pk_bf16_f32 v31, v22, v23
    v_cmp_lt_u32 vcc, 1, v9
    s_lshl_b32 s28, s3, 10
    s_add_u32 s28, s28, 133120
    v_add_u32 v14, s28, v1
    v_cndmask_b32 v24, v24, v28, vcc
    v_cndmask_b32 v25, v25, v29, vcc
    v_cndmask_b32 v26, v26, v30, vcc
    v_cndmask_b32 v27, v27, v31, vcc
    ds_write_b128 v14, v[24:27]
    v_mov_b32 v12, 0
    v_mov_b32 v13, 0
    v_mov_b32 v14, 0
    v_mov_b32 v15, 0
    s_mul_i32 s28, s3, 38912
    s_add_u32 s28, s28, 22272
    v_add_u32 v16, s28, v1
    s_mov_b64 exec, 0xffff
    ds_write_b128 v16, v[12:15]
    s_mov_b64 exec, -1
    s_lshl_b32 s28, s3, 2
    s_add_u32 s28, s28, 155648
    v_mov_b32 v16, s28
    ds_write_b32 v16, v12
    s_lshl_b32 s28, s3, 3
    s_add_u32 s28, s28, 155680
    v_mov_b32 v16, s28
    ds_write_b64 v16, v[12:13]
    s_lshl_b32 s28, s3, 3
    s_add_u32 s28, s28, 155712
    v_mov_b32 v16, s28
    ds_write_b64 v16, v[12:13]
    s_lshl_b32 s28, s3, 3
    s_add_u32 s28, s28, 155840
    v_mov_b32 v16, s28
    ds_write_b64 v16, v[12:13]
    v_mov_b32 v16, 155664
    ds_write_b32 v16, v12
    v_mov_b32 v16, 155744
    v_mov_b32 v17, 1
    ds_write_b32 v16, v17
    s_waitcnt lgkmcnt(0)
    s_barrier
    v_mov_b32 v80, 0
    v_mov_b32 v81, 0
    v_mov_b32 v82, 0
    v_mov_b32 v83, 0
    v_mov_b32 v84, 0
    v_mov_b32 v85, 0
    v_mov_b32 v86, 0
    v_mov_b32 v87, 0
    v_mov_b32 v88, 0
    v_mov_b32 v89, 0
    v_mov_b32 v90, 0
    v_mov_b32 v91, 0
    v_mov_b32 v92, 0
    v_mov_b32 v93, 0
    v_mov_b32 v94, 0
    v_mov_b32 v95, 0
    v_mov_b32 v96, 0
    v_mov_b32 v97, 0
    v_mov_b32 v98, 0
    v_mov_b32 v99, 0
    v_mov_b32 v100, 0
    v_mov_b32 v101, 0
    v_mov_b32 v102, 0
    v_mov_b32 v103, 0
    v_mov_b32 v104, 0
    v_mov_b32 v105, 0
    v_mov_b32 v106, 0
    v_mov_b32 v107, 0
    v_mov_b32 v108, 0
    v_mov_b32 v109, 0
    v_mov_b32 v110, 0
    v_mov_b32 v111, 0
    v_mov_b32 v112, 0
    v_mov_b32 v113, 0
    v_mov_b32 v114, 0
    v_mov_b32 v115, 0
    v_mov_b32 v116, 0
    v_mov_b32 v117, 0
    v_mov_b32 v118, 0
    v_mov_b32 v119, 0
    v_mov_b32 v120, 0
    v_mov_b32 v121, 0
    v_mov_b32 v122, 0
    v_mov_b32 v123, 0
    v_mov_b32 v124, 0
    v_mov_b32 v125, 0
    v_mov_b32 v126, 0
    v_mov_b32 v127, 0
    v_mov_b32 v128, 0
    v_mov_b32 v129, 0
    v_mov_b32 v130, 0
    v_mov_b32 v131, 0
    v_mov_b32 v132, 0
    v_mov_b32 v133, 0
    v_mov_b32 v134, 0
    v_mov_b32 v135, 0
    v_mov_b32 v136, 0
    v_mov_b32 v137, 0
    v_mov_b32 v138, 0
    v_mov_b32 v139, 0
    v_mov_b32 v140, 0
    v_mov_b32 v141, 0
    v_mov_b32 v142, 0
    v_mov_b32 v143, 0
    v_mov_b32 v144, 0
    v_mov_b32 v145, 0
    v_mov_b32 v146, 0
    v_mov_b32 v147, 0
    v_mov_b32 v148, 0
    v_mov_b32 v149, 0
    v_mov_b32 v150, 0
    v_mov_b32 v151, 0
    v_mov_b32 v152, 0
    v_mov_b32 v153, 0
    v_mov_b32 v154, 0
    v_mov_b32 v155, 0
    v_mov_b32 v156, 0
    v_mov_b32 v157, 0
    v_mov_b32 v158, 0
    v_mov_b32 v159, 0
    v_mov_b32 v160, 0
    v_mov_b32 v161, 0
    v_mov_b32 v162, 0
    v_mov_b32 v163, 0
    v_mov_b32 v164, 0
    v_mov_b32 v165, 0
    v_mov_b32 v166, 0
    v_mov_b32 v167, 0
    v_mov_b32 v168, 0
    v_mov_b32 v169, 0
    v_mov_b32 v170, 0
    v_mov_b32 v171, 0
    v_mov_b32 v172, 0
    v_mov_b32 v173, 0
    v_mov_b32 v174, 0
    v_mov_b32 v175, 0
    v_mov_b32 v176, 0
    v_mov_b32 v177, 0
    v_mov_b32 v178, 0
    v_mov_b32 v179, 0
    v_mov_b32 v180, 0
    v_mov_b32 v181, 0
    v_mov_b32 v182, 0
    v_mov_b32 v183, 0
    v_mov_b32 v184, 0
    v_mov_b32 v185, 0
    v_mov_b32 v186, 0
    v_mov_b32 v187, 0
    v_mov_b32 v188, 0
    v_mov_b32 v189, 0
    v_mov_b32 v190, 0
    v_mov_b32 v191, 0
    v_mov_b32 v192, 0
    v_mov_b32 v193, 0
    v_mov_b32 v194, 0
    v_mov_b32 v195, 0
    v_mov_b32 v196, 0
    v_mov_b32 v197, 0
    v_mov_b32 v198, 0
    v_mov_b32 v199, 0
    v_mov_b32 v200, 0
    v_mov_b32 v201, 0
    v_mov_b32 v202, 0
    v_mov_b32 v203, 0
    v_mov_b32 v204, 0
    v_mov_b32 v205, 0
    v_mov_b32 v206, 0
    v_mov_b32 v207, 0
    v_mov_b32 v208, 0
    v_mov_b32 v209, 0
    v_mov_b32 v210, 0
    v_mov_b32 v211, 0
    v_mov_b32 v212, 0
    v_mov_b32 v213, 0
    v_mov_b32 v214, 0
    v_mov_b32 v215, 0
    v_mov_b32 v216, 0
    v_mov_b32 v217, 0
    v_mov_b32 v218, 0
    v_mov_b32 v219, 0
    v_mov_b32 v220, 0
    v_mov_b32 v221, 0
    v_mov_b32 v222, 0
    v_mov_b32 v223, 0
    v_mov_b32 v224, 0
    v_mov_b32 v225, 0
    v_mov_b32 v226, 0
    v_mov_b32 v227, 0
    v_mov_b32 v228, 0
    v_mov_b32 v229, 0
    v_mov_b32 v230, 0
    v_mov_b32 v231, 0
    v_mov_b32 v232, 0
    v_mov_b32 v233, 0
    v_mov_b32 v234, 0
    v_mov_b32 v235, 0
    v_mov_b32 v236, 0
    v_mov_b32 v237, 0
    v_mov_b32 v238, 0
    v_mov_b32 v239, 0
    v_mov_b32 v240, 0
    v_mov_b32 v241, 0
    v_mov_b32 v242, 0
    v_mov_b32 v243, 0
    v_mov_b32 v244, 0
    v_mov_b32 v245, 0
    v_mov_b32 v246, 0
    v_mov_b32 v247, 0
    s_barrier
    s_mov_b32 s40, 2
    v_mov_b32 v0, s40
    s_waitcnt vmcnt(21)
    ds_write_b32 v7, v0
    s_branch K12_S0
K12_Q0:
    ds_read_b64_tr_b16 v[40:41], v4 offset:0
    ds_read_b64_tr_b16 v[42:43], v4 offset:2048
    ds_read_b64_tr_b16 v[44:45], v4 offset:256
    ds_read_b64_tr_b16 v[46:47], v4 offset:2304
    v_xor_b32 v4, 32, v4
    ds_read_b64_tr_b16 v[48:49], v4 offset:0
    ds_read_b64_tr_b16 v[50:51], v4 offset:2048
    ds_read_b64_tr_b16 v[52:53], v4 offset:256
    ds_read_b64_tr_b16 v[54:55], v4 offset:2304
    v_xor_b32 v4, 32, v4
    ds_read_b128 v[8:11], v2 offset:0
    ds_read_b128 v[12:15], v3 offset:0
    ds_read_b128 v[16:19], v2 offset:2048
    ds_read_b128 v[20:23], v3 offset:2048
    ds_read_b128 v[32:35], v2 offset:6144
    ds_read_b128 v[36:39], v3 offset:6144
    ds_read_b32 v68, v5
    s_waitcnt lgkmcnt(7)
    v_xor_b32 v72, s35, v44
    v_xor_b32 v73, s35, v45
    v_xor_b32 v74, s35, v46
    v_xor_b32 v75, s35, v47
    v_xor_b32 v76, s35, v52
    v_xor_b32 v77, s35, v53
    v_xor_b32 v78, s35, v54
    v_xor_b32 v79, s35, v55
    s_mov_b32 s41, 0
    s_mov_b32 s42, 38912
    s_mov_b32 s39, 0
    s_mov_b32 s29, 116736
K12_LOOP:
    s_waitcnt lgkmcnt(2)
    v_mfma_f32_16x16x32_bf16 v[80:83], v[8:11], v[40:43], v[80:83]
    ds_read_b128 v[24:27], v2 offset:4096
    v_xor_b32 v72, s35, v44
    v_xor_b32 v73, s35, v45
    v_mfma_f32_16x16x32_bf16 v[84:87], v[8:11], v[44:47], v[84:87]
    ds_read_b128 v[28:31], v3 offset:4096
    v_xor_b32 v74, s35, v46
    v_xor_b32 v75, s35, v47
    v_mfma_f32_16x16x32_bf16 v[88:91], v[8:11], v[48:51], v[88:91]
    s_waitcnt lgkmcnt(2)
    v_cmp_gt_u32 vcc, s40, v68
    s_add_u32 s49, s39, 2
    s_lshr_b32 s49, s49, 1
    v_xor_b32 v76, s35, v52
    v_xor_b32 v77, s35, v53
    v_mfma_f32_16x16x32_bf16 v[92:95], v[8:11], v[52:55], v[92:95]
    s_cbranch_vccnz K12_S1
K12_Q1:
    s_mul_i32 s48, s49, s50
    s_add_u32 s48, s48, s47
    v_xor_b32 v78, s35, v54
    v_xor_b32 v79, s35, v55
    v_mfma_f32_16x16x32_bf16 v[80:83], v[12:15], v[72:75], v[80:83]
    s_add_u32 m0, s29, s36
    s_nop 0
    buffer_load_dwordx4 v1, s[8:11], s30 offen sc1 lds
    v_mfma_f32_16x16x32_bf16 v[84:87], v[12:15], v[40:43], v[84:87]
    s_cmp_lt_u32 s49, 8
    s_cselect_b32 s48, s48, 155744
    v_mfma_f32_16x16x32_bf16 v[88:91], v[12:15], v[76:79], v[88:91]
    s_cmp_ge_u32 s49, 3
    s_cselect_b32 s48, s48, 155744
    v_mfma_f32_16x16x32_bf16 v[92:95], v[12:15], v[48:51], v[92:95]
    v_mfma_f32_16x16x32_bf16 v[96:99], v[16:19], v[40:43], v[96:99]
    ds_read_b128 v[8:11], v2 offset:8192
    v_mfma_f32_16x16x32_bf16 v[100:103], v[16:19], v[44:47], v[100:103]
    ds_read_b128 v[12:15], v3 offset:8192
    v_mfma_f32_16x16x32_bf16 v[104:107], v[16:19], v[48:51], v[104:107]
    buffer_load_dwordx4 v1, s[8:11], s30 offen offset:1024 sc1 lds
    v_mfma_f32_16x16x32_bf16 v[108:111], v[16:19], v[52:55], v[108:111]
    v_mfma_f32_16x16x32_bf16 v[96:99], v[20:23], v[72:75], v[96:99]
    v_mfma_f32_16x16x32_bf16 v[100:103], v[20:23], v[40:43], v[100:103]
    v_mfma_f32_16x16x32_bf16 v[104:107], v[20:23], v[76:79], v[104:107]
    buffer_load_dwordx4 v1, s[8:11], s30 offen offset:2048 sc1 lds
    v_mfma_f32_16x16x32_bf16 v[108:111], v[20:23], v[48:51], v[108:111]
    s_waitcnt lgkmcnt(2)
    v_mfma_f32_16x16x32_bf16 v[112:115], v[24:27], v[40:43], v[112:115]
    ds_read_b128 v[16:19], v2 offset:10240
    v_mfma_f32_16x16x32_bf16 v[116:119], v[24:27], v[44:47], v[116:119]
    ds_read_b128 v[20:23], v3 offset:10240
    v_mfma_f32_16x16x32_bf16 v[120:123], v[24:27], v[48:51], v[120:123]
    v_mfma_f32_16x16x32_bf16 v[124:127], v[24:27], v[52:55], v[124:127]
    v_mfma_f32_16x16x32_bf16 v[112:115], v[28:31], v[72:75], v[112:115]
    buffer_load_dwordx4 v1, s[8:11], s30 offen offset:3072 sc1 lds
    v_mfma_f32_16x16x32_bf16 v[116:119], v[28:31], v[40:43], v[116:119]
    v_mfma_f32_16x16x32_bf16 v[120:123], v[28:31], v[76:79], v[120:123]
    v_mfma_f32_16x16x32_bf16 v[124:127], v[28:31], v[48:51], v[124:127]
    v_mfma_f32_16x16x32_bf16 v[128:131], v[32:35], v[40:43], v[128:131]
    ds_read_b128 v[24:27], v2 offset:12288
    v_mfma_f32_16x16x32_bf16 v[132:135], v[32:35], v[44:47], v[132:135]
    ds_read_b128 v[28:31], v3 offset:12288
    v_mfma_f32_16x16x32_bf16 v[136:139], v[32:35], v[48:51], v[136:139]
    s_add_u32 m0, m0, 4096
    s_add_u32 s34, s30, 4096
    buffer_load_dwordx4 v1, s[8:11], s34 offen sc1 lds
    v_mfma_f32_16x16x32_bf16 v[140:143], v[32:35], v[52:55], v[140:143]
    v_mfma_f32_16x16x32_bf16 v[128:131], v[36:39], v[72:75], v[128:131]
    v_mfma_f32_16x16x32_bf16 v[132:135], v[36:39], v[40:43], v[132:135]
    v_mfma_f32_16x16x32_bf16 v[136:139], v[36:39], v[76:79], v[136:139]
    s_add_u32 m0, s29, s37
    s_add_u32 s30, s30, 21376
    buffer_load_dwordx4 v1, s[12:15], s31 offen sc1 lds
    v_mfma_f32_16x16x32_bf16 v[140:143], v[36:39], v[48:51], v[140:143]
    s_waitcnt lgkmcnt(4)
    v_mfma_f32_16x16x32_bf16 v[144:147], v[8:11], v[40:43], v[144:147]
    ds_read_b128 v[32:35], v2 offset:14336
    v_mfma_f32_16x16x32_bf16 v[148:151], v[8:11], v[44:47], v[148:151]
    ds_read_b128 v[36:39], v3 offset:14336
    v_mfma_f32_16x16x32_bf16 v[152:155], v[8:11], v[48:51], v[152:155]
    v_mfma_f32_16x16x32_bf16 v[156:159], v[8:11], v[52:55], v[156:159]
    v_mfma_f32_16x16x32_bf16 v[144:147], v[12:15], v[72:75], v[144:147]
    buffer_load_dwordx4 v1, s[12:15], s31 offen offset:1024 sc1 lds
    v_mfma_f32_16x16x32_bf16 v[148:151], v[12:15], v[40:43], v[148:151]
    v_mfma_f32_16x16x32_bf16 v[152:155], v[12:15], v[76:79], v[152:155]
    v_mfma_f32_16x16x32_bf16 v[156:159], v[12:15], v[48:51], v[156:159]
    s_waitcnt lgkmcnt(4)
    v_mfma_f32_16x16x32_bf16 v[160:163], v[16:19], v[40:43], v[160:163]
    ds_read_b128 v[8:11], v2 offset:16384
    v_mfma_f32_16x16x32_bf16 v[164:167], v[16:19], v[44:47], v[164:167]
    ds_read_b128 v[12:15], v3 offset:16384
    v_mfma_f32_16x16x32_bf16 v[168:171], v[16:19], v[48:51], v[168:171]
    buffer_load_dwordx4 v1, s[12:15], s31 offen offset:2048 sc1 lds
    v_mfma_f32_16x16x32_bf16 v[172:175], v[16:19], v[52:55], v[172:175]
    s_add_u32 s40, s40, 1
    s_mov_b32 s51, s40
    v_mov_b32 v0, s40
    v_mfma_f32_16x16x32_bf16 v[160:163], v[20:23], v[72:75], v[160:163]
    s_waitcnt vmcnt(19)
    ds_write_b32 v7, v0
    v_mfma_f32_16x16x32_bf16 v[164:167], v[20:23], v[40:43], v[164:167]
    v_mfma_f32_16x16x32_bf16 v[168:171], v[20:23], v[76:79], v[168:171]
    buffer_load_dwordx4 v1, s[12:15], s31 offen offset:3072 sc1 lds
    v_mfma_f32_16x16x32_bf16 v[172:175], v[20:23], v[48:51], v[172:175]
    s_waitcnt lgkmcnt(5)
    v_mfma_f32_16x16x32_bf16 v[176:179], v[24:27], v[40:43], v[176:179]
    ds_read_b128 v[16:19], v2 offset:18432
    v_mfma_f32_16x16x32_bf16 v[180:183], v[24:27], v[44:47], v[180:183]
    ds_read_b128 v[20:23], v3 offset:18432
    v_mov_b32 v0, s48
    v_mfma_f32_16x16x32_bf16 v[184:187], v[24:27], v[48:51], v[184:187]
    ds_read_b32 v0, v0
    v_mfma_f32_16x16x32_bf16 v[188:191], v[24:27], v[52:55], v[188:191]
    v_mfma_f32_16x16x32_bf16 v[176:179], v[28:31], v[72:75], v[176:179]
    s_add_u32 m0, s29, s38
    s_mov_b64 exec, s[44:45]
    buffer_load_dwordx4 v1, s[64:67], s33 offen sc1 lds
    s_mov_b64 exec, -1
    s_add_u32 s31, s31, 16384
    s_add_u32 s33, s33, 21376
    v_mfma_f32_16x16x32_bf16 v[180:183], v[28:31], v[40:43], v[180:183]
    v_mfma_f32_16x16x32_bf16 v[184:187], v[28:31], v[76:79], v[184:187]
    v_mfma_f32_16x16x32_bf16 v[188:191], v[28:31], v[48:51], v[188:191]
    s_waitcnt lgkmcnt(0)
    v_cmp_eq_u32 vcc, 0, v0
    v_mfma_f32_16x16x32_bf16 v[192:195], v[32:35], v[40:43], v[192:195]
    ds_read_b128 v[24:27], v2 offset:20480
    v_mfma_f32_16x16x32_bf16 v[196:199], v[32:35], v[44:47], v[196:199]
    ds_read_b128 v[28:31], v3 offset:20480
    s_cbranch_vccnz K12_F2
K12_G2:
    v_mfma_f32_16x16x32_bf16 v[200:203], v[32:35], v[48:51], v[200:203]
    s_sub_u32 s43, s42, s41
    s_add_u32 s40, s40, 1
    v_add_u32 v2, s43, v2
    v_mfma_f32_16x16x32_bf16 v[204:207], v[32:35], v[52:55], v[204:207]
    v_add_u32 v3, s43, v3
    v_add_u32 v4, s43, v4
    v_mov_b32 v0, s40
    v_mfma_f32_16x16x32_bf16 v[192:195], v[36:39], v[72:75], v[192:195]
    ds_write_b32 v7, v0
    v_mfma_f32_16x16x32_bf16 v[196:199], v[36:39], v[40:43], v[196:199]
    v_mfma_f32_16x16x32_bf16 v[200:203], v[36:39], v[76:79], v[200:203]
    v_mfma_f32_16x16x32_bf16 v[204:207], v[36:39], v[48:51], v[204:207]
    ds_read_b32 v56, v5
    v_mfma_f32_16x16x32_bf16 v[208:211], v[8:11], v[40:43], v[208:211]
    v_mfma_f32_16x16x32_bf16 v[212:215], v[8:11], v[44:47], v[212:215]
    v_mfma_f32_16x16x32_bf16 v[216:219], v[8:11], v[48:51], v[216:219]
    v_mfma_f32_16x16x32_bf16 v[220:223], v[8:11], v[52:55], v[220:223]
    s_waitcnt lgkmcnt(0)
    v_cmp_gt_u32 vcc, s51, v56
    v_mfma_f32_16x16x32_bf16 v[208:211], v[12:15], v[72:75], v[208:211]
    v_mfma_f32_16x16x32_bf16 v[212:215], v[12:15], v[40:43], v[212:215]
    s_cbranch_vccnz K12_S3
K12_Q3:
    v_mfma_f32_16x16x32_bf16 v[216:219], v[12:15], v[76:79], v[216:219]
    ds_read_b64_tr_b16 v[56:57], v4 offset:0
    v_mfma_f32_16x16x32_bf16 v[220:223], v[12:15], v[48:51], v[220:223]
    ds_read_b64_tr_b16 v[58:59], v4 offset:2048
    v_mfma_f32_16x16x32_bf16 v[224:227], v[16:19], v[40:43], v[224:227]
    ds_read_b64_tr_b16 v[60:61], v4 offset:256
    ds_read_b128 v[8:11], v2 offset:0
    v_mfma_f32_16x16x32_bf16 v[228:231], v[16:19], v[44:47], v[228:231]
    ds_read_b64_tr_b16 v[62:63], v4 offset:2304
    ds_read_b128 v[12:15], v3 offset:0
    v_mfma_f32_16x16x32_bf16 v[232:235], v[16:19], v[48:51], v[232:235]
    v_xor_b32 v4, 32, v4
    ds_read_b128 v[32:35], v2 offset:6144
    v_mfma_f32_16x16x32_bf16 v[236:239], v[16:19], v[52:55], v[236:239]
    ds_read_b64_tr_b16 v[64:65], v4 offset:0
    ds_read_b128 v[36:39], v3 offset:6144
    v_mfma_f32_16x16x32_bf16 v[224:227], v[20:23], v[72:75], v[224:227]
    ds_read_b64_tr_b16 v[66:67], v4 offset:2048
    ds_read_b32 v52, v5
    v_mfma_f32_16x16x32_bf16 v[228:231], v[20:23], v[40:43], v[228:231]
    ds_read_b64_tr_b16 v[68:69], v4 offset:256
    ds_read_b64_tr_b16 v[70:71], v4 offset:2304
    v_xor_b32 v4, 32, v4
    v_mfma_f32_16x16x32_bf16 v[232:235], v[20:23], v[76:79], v[232:235]
    v_mfma_f32_16x16x32_bf16 v[236:239], v[20:23], v[48:51], v[236:239]
    v_mfma_f32_16x16x32_bf16 v[240:243], v[24:27], v[40:43], v[240:243]
    ds_read_b128 v[16:19], v2 offset:2048
    v_mfma_f32_16x16x32_bf16 v[244:247], v[24:27], v[44:47], v[244:247]
    ds_read_b128 v[20:23], v3 offset:2048
    v_mfma_f32_16x16x32_bf16 v[240:243], v[28:31], v[72:75], v[240:243]
    s_mov_b32 s29, s41
    s_mov_b32 s41, s42
    s_add_u32 s42, s42, 38912
    v_mfma_f32_16x16x32_bf16 v[244:247], v[28:31], v[40:43], v[244:247]
    s_cmp_eq_u32 s42, 155648
    s_cselect_b32 s42, 0, s42
    s_waitcnt lgkmcnt(2)
    v_mfma_f32_16x16x32_bf16 v[80:83], v[8:11], v[56:59], v[80:83]
    ds_read_b128 v[24:27], v2 offset:4096
    v_xor_b32 v72, s35, v60
    v_xor_b32 v73, s35, v61
    v_mfma_f32_16x16x32_bf16 v[84:87], v[8:11], v[60:63], v[84:87]
    ds_read_b128 v[28:31], v3 offset:4096
    v_xor_b32 v74, s35, v62
    v_xor_b32 v75, s35, v63
    v_mfma_f32_16x16x32_bf16 v[88:91], v[8:11], v[64:67], v[88:91]
    s_waitcnt lgkmcnt(2)
    v_cmp_gt_u32 vcc, s40, v52
    v_xor_b32 v76, s35, v68
    v_xor_b32 v77, s35, v69
    v_mfma_f32_16x16x32_bf16 v[92:95], v[8:11], v[68:71], v[92:95]
    s_cbranch_vccnz K12_S4
K12_Q4:
    v_xor_b32 v78, s35, v70
    v_xor_b32 v79, s35, v71
    v_mfma_f32_16x16x32_bf16 v[80:83], v[12:15], v[72:75], v[80:83]
    s_add_u32 m0, s29, s36
    s_nop 0
    buffer_load_dwordx4 v1, s[8:11], s30 offen sc1 lds
    v_mfma_f32_16x16x32_bf16 v[84:87], v[12:15], v[56:59], v[84:87]
    v_mfma_f32_16x16x32_bf16 v[88:91], v[12:15], v[76:79], v[88:91]
    v_mfma_f32_16x16x32_bf16 v[92:95], v[12:15], v[64:67], v[92:95]
    v_mfma_f32_16x16x32_bf16 v[96:99], v[16:19], v[56:59], v[96:99]
    ds_read_b128 v[8:11], v2 offset:8192
    v_mfma_f32_16x16x32_bf16 v[100:103], v[16:19], v[60:63], v[100:103]
    ds_read_b128 v[12:15], v3 offset:8192
    v_mfma_f32_16x16x32_bf16 v[104:107], v[16:19], v[64:67], v[104:107]
    buffer_load_dwordx4 v1, s[8:11], s30 offen offset:1024 sc1 lds
    v_mfma_f32_16x16x32_bf16 v[108:111], v[16:19], v[68:71], v[108:111]
    v_mfma_f32_16x16x32_bf16 v[96:99], v[20:23], v[72:75], v[96:99]
    v_mfma_f32_16x16x32_bf16 v[100:103], v[20:23], v[56:59], v[100:103]
    v_mfma_f32_16x16x32_bf16 v[104:107], v[20:23], v[76:79], v[104:107]
    buffer_load_dwordx4 v1, s[8:11], s30 offen offset:2048 sc1 lds
    v_mfma_f32_16x16x32_bf16 v[108:111], v[20:23], v[64:67], v[108:111]
    s_waitcnt lgkmcnt(2)
    v_mfma_f32_16x16x32_bf16 v[112:115], v[24:27], v[56:59], v[112:115]
    ds_read_b128 v[16:19], v2 offset:10240
    v_mfma_f32_16x16x32_bf16 v[116:119], v[24:27], v[60:63], v[116:119]
    ds_read_b128 v[20:23], v3 offset:10240
    v_mfma_f32_16x16x32_bf16 v[120:123], v[24:27], v[64:67], v[120:123]
    v_mfma_f32_16x16x32_bf16 v[124:127], v[24:27], v[68:71], v[124:127]
    v_mfma_f32_16x16x32_bf16 v[112:115], v[28:31], v[72:75], v[112:115]
    buffer_load_dwordx4 v1, s[8:11], s30 offen offset:3072 sc1 lds
    v_mfma_f32_16x16x32_bf16 v[116:119], v[28:31], v[56:59], v[116:119]
    v_mfma_f32_16x16x32_bf16 v[120:123], v[28:31], v[76:79], v[120:123]
    v_mfma_f32_16x16x32_bf16 v[124:127], v[28:31], v[64:67], v[124:127]
    v_mfma_f32_16x16x32_bf16 v[128:131], v[32:35], v[56:59], v[128:131]
    ds_read_b128 v[24:27], v2 offset:12288
    v_mfma_f32_16x16x32_bf16 v[132:135], v[32:35], v[60:63], v[132:135]
    ds_read_b128 v[28:31], v3 offset:12288
    v_mfma_f32_16x16x32_bf16 v[136:139], v[32:35], v[64:67], v[136:139]
    s_add_u32 m0, m0, 4096
    s_add_u32 s34, s30, 4096
    buffer_load_dwordx4 v1, s[8:11], s34 offen sc1 lds
    v_mfma_f32_16x16x32_bf16 v[140:143], v[32:35], v[68:71], v[140:143]
    v_mfma_f32_16x16x32_bf16 v[128:131], v[36:39], v[72:75], v[128:131]
    v_mfma_f32_16x16x32_bf16 v[132:135], v[36:39], v[56:59], v[132:135]
    v_mfma_f32_16x16x32_bf16 v[136:139], v[36:39], v[76:79], v[136:139]
    s_add_u32 m0, s29, s37
    s_add_u32 s30, s30, 21376
    buffer_load_dwordx4 v1, s[12:15], s31 offen sc1 lds
    v_mfma_f32_16x16x32_bf16 v[140:143], v[36:39], v[64:67], v[140:143]
    s_waitcnt lgkmcnt(4)
    v_mfma_f32_16x16x32_bf16 v[144:147], v[8:11], v[56:59], v[144:147]
    ds_read_b128 v[32:35], v2 offset:14336
    v_mfma_f32_16x16x32_bf16 v[148:151], v[8:11], v[60:63], v[148:151]
    ds_read_b128 v[36:39], v3 offset:14336
    v_mfma_f32_16x16x32_bf16 v[152:155], v[8:11], v[64:67], v[152:155]
    v_mfma_f32_16x16x32_bf16 v[156:159], v[8:11], v[68:71], v[156:159]
    v_mfma_f32_16x16x32_bf16 v[144:147], v[12:15], v[72:75], v[144:147]
    buffer_load_dwordx4 v1, s[12:15], s31 offen offset:1024 sc1 lds
    v_mfma_f32_16x16x32_bf16 v[148:151], v[12:15], v[56:59], v[148:151]
    v_mfma_f32_16x16x32_bf16 v[152:155], v[12:15], v[76:79], v[152:155]
    v_mfma_f32_16x16x32_bf16 v[156:159], v[12:15], v[64:67], v[156:159]
    s_waitcnt lgkmcnt(4)
    v_mfma_f32_16x16x32_bf16 v[160:163], v[16:19], v[56:59], v[160:163]
    ds_read_b128 v[8:11], v2 offset:16384
    v_mfma_f32_16x16x32_bf16 v[164:167], v[16:19], v[60:63], v[164:167]
    ds_read_b128 v[12:15], v3 offset:16384
    v_mfma_f32_16x16x32_bf16 v[168:171], v[16:19], v[64:67], v[168:171]
    buffer_load_dwordx4 v1, s[12:15], s31 offen offset:2048 sc1 lds
    v_mfma_f32_16x16x32_bf16 v[172:175], v[16:19], v[68:71], v[172:175]
    s_add_u32 s40, s40, 1
    s_mov_b32 s51, s40
    v_mov_b32 v0, s40
    v_mfma_f32_16x16x32_bf16 v[160:163], v[20:23], v[72:75], v[160:163]
    s_waitcnt vmcnt(19)
    ds_write_b32 v7, v0
    v_mfma_f32_16x16x32_bf16 v[164:167], v[20:23], v[56:59], v[164:167]
    v_mfma_f32_16x16x32_bf16 v[168:171], v[20:23], v[76:79], v[168:171]
    buffer_load_dwordx4 v1, s[12:15], s31 offen offset:3072 sc1 lds
    v_mfma_f32_16x16x32_bf16 v[172:175], v[20:23], v[64:67], v[172:175]
    s_waitcnt lgkmcnt(5)
    v_mfma_f32_16x16x32_bf16 v[176:179], v[24:27], v[56:59], v[176:179]
    ds_read_b128 v[16:19], v2 offset:18432
    v_mfma_f32_16x16x32_bf16 v[180:183], v[24:27], v[60:63], v[180:183]
    ds_read_b128 v[20:23], v3 offset:18432
    v_mfma_f32_16x16x32_bf16 v[184:187], v[24:27], v[64:67], v[184:187]
    v_mfma_f32_16x16x32_bf16 v[188:191], v[24:27], v[68:71], v[188:191]
    v_mfma_f32_16x16x32_bf16 v[176:179], v[28:31], v[72:75], v[176:179]
    s_add_u32 m0, s29, s38
    s_mov_b64 exec, s[44:45]
    buffer_load_dwordx4 v1, s[64:67], s33 offen sc1 lds
    s_mov_b64 exec, -1
    s_add_u32 s31, s31, 16384
    s_add_u32 s33, s33, 21376
    v_mfma_f32_16x16x32_bf16 v[180:183], v[28:31], v[56:59], v[180:183]
    v_mfma_f32_16x16x32_bf16 v[184:187], v[28:31], v[76:79], v[184:187]
    s_mov_b32 m0, s46
    s_mov_b64 exec, 0xff
    buffer_load_dword v1, s[4:7], 0 offen sc1 lds
    s_mov_b64 exec, -1
    v_mfma_f32_16x16x32_bf16 v[188:191], v[28:31], v[64:67], v[188:191]
    s_waitcnt lgkmcnt(5)
    v_mfma_f32_16x16x32_bf16 v[192:195], v[32:35], v[56:59], v[192:195]
    ds_read_b128 v[24:27], v2 offset:20480
    v_mfma_f32_16x16x32_bf16 v[196:199], v[32:35], v[60:63], v[196:199]
    ds_read_b128 v[28:31], v3 offset:20480
    v_mfma_f32_16x16x32_bf16 v[200:203], v[32:35], v[64:67], v[200:203]
    s_sub_u32 s43, s42, s41
    s_add_u32 s40, s40, 1
    v_add_u32 v2, s43, v2
    v_mfma_f32_16x16x32_bf16 v[204:207], v[32:35], v[68:71], v[204:207]
    v_add_u32 v3, s43, v3
    v_add_u32 v4, s43, v4
    v_mov_b32 v0, s40
    v_mfma_f32_16x16x32_bf16 v[192:195], v[36:39], v[72:75], v[192:195]
    ds_write_b32 v7, v0
    v_mfma_f32_16x16x32_bf16 v[196:199], v[36:39], v[56:59], v[196:199]
    v_mfma_f32_16x16x32_bf16 v[200:203], v[36:39], v[76:79], v[200:203]
    v_mfma_f32_16x16x32_bf16 v[204:207], v[36:39], v[64:67], v[204:207]
    ds_read_b32 v40, v5
    s_waitcnt lgkmcnt(7)
    v_mfma_f32_16x16x32_bf16 v[208:211], v[8:11], v[56:59], v[208:211]
    v_mfma_f32_16x16x32_bf16 v[212:215], v[8:11], v[60:63], v[212:215]
    v_mfma_f32_16x16x32_bf16 v[216:219], v[8:11], v[64:67], v[216:219]
    v_mfma_f32_16x16x32_bf16 v[220:223], v[8:11], v[68:71], v[220:223]
    s_waitcnt lgkmcnt(0)
    v_cmp_gt_u32 vcc, s51, v40
    v_mfma_f32_16x16x32_bf16 v[208:211], v[12:15], v[72:75], v[208:211]
    v_mfma_f32_16x16x32_bf16 v[212:215], v[12:15], v[56:59], v[212:215]
    s_cbranch_vccnz K12_S5
K12_Q5:
    v_mfma_f32_16x16x32_bf16 v[216:219], v[12:15], v[76:79], v[216:219]
    ds_read_b64_tr_b16 v[40:41], v4 offset:0
    v_mfma_f32_16x16x32_bf16 v[220:223], v[12:15], v[64:67], v[220:223]
    ds_read_b64_tr_b16 v[42:43], v4 offset:2048
    v_mfma_f32_16x16x32_bf16 v[224:227], v[16:19], v[56:59], v[224:227]
    ds_read_b64_tr_b16 v[44:45], v4 offset:256
    ds_read_b128 v[8:11], v2 offset:0
    v_mfma_f32_16x16x32_bf16 v[228:231], v[16:19], v[60:63], v[228:231]
    ds_read_b64_tr_b16 v[46:47], v4 offset:2304
    ds_read_b128 v[12:15], v3 offset:0
    v_mfma_f32_16x16x32_bf16 v[232:235], v[16:19], v[64:67], v[232:235]
    v_xor_b32 v4, 32, v4
    ds_read_b128 v[32:35], v2 offset:6144
    v_mfma_f32_16x16x32_bf16 v[236:239], v[16:19], v[68:71], v[236:239]
    ds_read_b64_tr_b16 v[48:49], v4 offset:0
    ds_read_b128 v[36:39], v3 offset:6144
    v_mfma_f32_16x16x32_bf16 v[224:227], v[20:23], v[72:75], v[224:227]
    ds_read_b64_tr_b16 v[50:51], v4 offset:2048
    ds_read_b32 v68, v5
    v_mfma_f32_16x16x32_bf16 v[228:231], v[20:23], v[56:59], v[228:231]
    ds_read_b64_tr_b16 v[52:53], v4 offset:256
    ds_read_b64_tr_b16 v[54:55], v4 offset:2304
    v_xor_b32 v4, 32, v4
    v_mfma_f32_16x16x32_bf16 v[232:235], v[20:23], v[76:79], v[232:235]
    v_mfma_f32_16x16x32_bf16 v[236:239], v[20:23], v[64:67], v[236:239]
    v_mfma_f32_16x16x32_bf16 v[240:243], v[24:27], v[56:59], v[240:243]
    ds_read_b128 v[16:19], v2 offset:2048
    v_mfma_f32_16x16x32_bf16 v[244:247], v[24:27], v[60:63], v[244:247]
    ds_read_b128 v[20:23], v3 offset:2048
    v_mfma_f32_16x16x32_bf16 v[240:243], v[28:31], v[72:75], v[240:243]
    s_mov_b32 s29, s41
    s_mov_b32 s41, s42
    s_add_u32 s42, s42, 38912
    v_mfma_f32_16x16x32_bf16 v[244:247], v[28:31], v[56:59], v[244:247]
    s_cmp_eq_u32 s42, 155648
    s_cselect_b32 s42, 0, s42
    s_add_u32 s39, s39, 1
    s_cmp_lt_u32 s39, 15
    s_cbranch_scc1 K12_LOOP
    s_waitcnt lgkmcnt(2)
    v_mfma_f32_16x16x32_bf16 v[80:83], v[8:11], v[40:43], v[80:83]
    ds_read_b128 v[24:27], v2 offset:4096
    v_xor_b32 v72, s35, v44
    v_xor_b32 v73, s35, v45
    v_mfma_f32_16x16x32_bf16 v[84:87], v[8:11], v[44:47], v[84:87]
    ds_read_b128 v[28:31], v3 offset:4096
    v_xor_b32 v74, s35, v46
    v_xor_b32 v75, s35, v47
    v_mfma_f32_16x16x32_bf16 v[88:91], v[8:11], v[48:51], v[88:91]
    s_waitcnt lgkmcnt(2)
    v_cmp_gt_u32 vcc, s40, v68
    s_add_u32 s49, s39, 2
    s_lshr_b32 s49, s49, 1
    v_xor_b32 v76, s35, v52
    v_xor_b32 v77, s35, v53
    v_mfma_f32_16x16x32_bf16 v[92:95], v[8:11], v[52:55], v[92:95]
    s_cbranch_vccnz K12_S6
K12_Q6:
    s_mul_i32 s48, s49, s50
    s_add_u32 s48, s48, s47
    v_xor_b32 v78, s35, v54
    v_xor_b32 v79, s35, v55
    v_mfma_f32_16x16x32_bf16 v[80:83], v[12:15], v[72:75], v[80:83]
    s_add_u32 m0, s29, s36
    s_nop 0
    buffer_load_dwordx4 v1, s[8:11], s30 offen sc1 lds
    v_mfma_f32_16x16x32_bf16 v[84:87], v[12:15], v[40:43], v[84:87]
    s_cmp_lt_u32 s49, 8
    s_cselect_b32 s48, s48, 155744
    v_mfma_f32_16x16x32_bf16 v[88:91], v[12:15], v[76:79], v[88:91]
    s_cmp_ge_u32 s49, 3
    s_cselect_b32 s48, s48, 155744
    v_mfma_f32_16x16x32_bf16 v[92:95], v[12:15], v[48:51], v[92:95]
    v_mfma_f32_16x16x32_bf16 v[96:99], v[16:19], v[40:43], v[96:99]
    ds_read_b128 v[8:11], v2 offset:8192
    v_mfma_f32_16x16x32_bf16 v[100:103], v[16:19], v[44:47], v[100:103]
    ds_read_b128 v[12:15], v3 offset:8192
    v_mfma_f32_16x16x32_bf16 v[104:107], v[16:19], v[48:51], v[104:107]
    buffer_load_dwordx4 v1, s[8:11], s30 offen offset:1024 sc1 lds
    v_mfma_f32_16x16x32_bf16 v[108:111], v[16:19], v[52:55], v[108:111]
    v_mfma_f32_16x16x32_bf16 v[96:99], v[20:23], v[72:75], v[96:99]
    v_mfma_f32_16x16x32_bf16 v[100:103], v[20:23], v[40:43], v[100:103]
    v_mfma_f32_16x16x32_bf16 v[104:107], v[20:23], v[76:79], v[104:107]
    buffer_load_dwordx4 v1, s[8:11], s30 offen offset:2048 sc1 lds
    v_mfma_f32_16x16x32_bf16 v[108:111], v[20:23], v[48:51], v[108:111]
    s_waitcnt lgkmcnt(2)
    v_mfma_f32_16x16x32_bf16 v[112:115], v[24:27], v[40:43], v[112:115]
    ds_read_b128 v[16:19], v2 offset:10240
    v_mfma_f32_16x16x32_bf16 v[116:119], v[24:27], v[44:47], v[116:119]
    ds_read_b128 v[20:23], v3 offset:10240
    v_mfma_f32_16x16x32_bf16 v[120:123], v[24:27], v[48:51], v[120:123]
    v_mfma_f32_16x16x32_bf16 v[124:127], v[24:27], v[52:55], v[124:127]
    v_mfma_f32_16x16x32_bf16 v[112:115], v[28:31], v[72:75], v[112:115]
    buffer_load_dwordx4 v1, s[8:11], s30 offen offset:3072 sc1 lds
    v_mfma_f32_16x16x32_bf16 v[116:119], v[28:31], v[40:43], v[116:119]
    v_mfma_f32_16x16x32_bf16 v[120:123], v[28:31], v[76:79], v[120:123]
    v_mfma_f32_16x16x32_bf16 v[124:127], v[28:31], v[48:51], v[124:127]
    v_mfma_f32_16x16x32_bf16 v[128:131], v[32:35], v[40:43], v[128:131]
    ds_read_b128 v[24:27], v2 offset:12288
    v_mfma_f32_16x16x32_bf16 v[132:135], v[32:35], v[44:47], v[132:135]
    ds_read_b128 v[28:31], v3 offset:12288
    v_mfma_f32_16x16x32_bf16 v[136:139], v[32:35], v[48:51], v[136:139]
    s_add_u32 m0, m0, 4096
    s_add_u32 s34, s30, 4096
    buffer_load_dwordx4 v1, s[8:11], s34 offen sc1 lds
    v_mfma_f32_16x16x32_bf16 v[140:143], v[32:35], v[52:55], v[140:143]
    v_mfma_f32_16x16x32_bf16 v[128:131], v[36:39], v[72:75], v[128:131]
    v_mfma_f32_16x16x32_bf16 v[132:135], v[36:39], v[40:43], v[132:135]
    v_mfma_f32_16x16x32_bf16 v[136:139], v[36:39], v[76:79], v[136:139]
    s_add_u32 m0, s29, s37
    s_add_u32 s30, s30, 21376
    buffer_load_dwordx4 v1, s[12:15], s31 offen sc1 lds
    v_mfma_f32_16x16x32_bf16 v[140:143], v[36:39], v[48:51], v[140:143]
    s_waitcnt lgkmcnt(4)
    v_mfma_f32_16x16x32_bf16 v[144:147], v[8:11], v[40:43], v[144:147]
    ds_read_b128 v[32:35], v2 offset:14336
    v_mfma_f32_16x16x32_bf16 v[148:151], v[8:11], v[44:47], v[148:151]
    ds_read_b128 v[36:39], v3 offset:14336
    v_mfma_f32_16x16x32_bf16 v[152:155], v[8:11], v[48:51], v[152:155]
    v_mfma_f32_16x16x32_bf16 v[156:159], v[8:11], v[52:55], v[156:159]
    v_mfma_f32_16x16x32_bf16 v[144:147], v[12:15], v[72:75], v[144:147]
    buffer_load_dwordx4 v1, s[12:15], s31 offen offset:1024 sc1 lds
    v_mfma_f32_16x16x32_bf16 v[148:151], v[12:15], v[40:43], v[148:151]
    v_mfma_f32_16x16x32_bf16 v[152:155], v[12:15], v[76:79], v[152:155]
    v_mfma_f32_16x16x32_bf16 v[156:159], v[12:15], v[48:51], v[156:159]
    s_waitcnt lgkmcnt(4)
    v_mfma_f32_16x16x32_bf16 v[160:163], v[16:19], v[40:43], v[160:163]
    ds_read_b128 v[8:11], v2 offset:16384
    v_mfma_f32_16x16x32_bf16 v[164:167], v[16:19], v[44:47], v[164:167]
    ds_read_b128 v[12:15], v3 offset:16384
    v_mfma_f32_16x16x32_bf16 v[168:171], v[16:19], v[48:51], v[168:171]
    buffer_load_dwordx4 v1, s[12:15], s31 offen offset:2048 sc1 lds
    v_mfma_f32_16x16x32_bf16 v[172:175], v[16:19], v[52:55], v[172:175]
    s_add_u32 s40, s40, 1
    s_mov_b32 s51, s40
    v_mov_b32 v0, s40
    v_mfma_f32_16x16x32_bf16 v[160:163], v[20:23], v[72:75], v[160:163]
    s_waitcnt vmcnt(19)
    ds_write_b32 v7, v0
    v_mfma_f32_16x16x32_bf16 v[164:167], v[20:23], v[40:43], v[164:167]
    v_mfma_f32_16x16x32_bf16 v[168:171], v[20:23], v[76:79], v[168:171]
    buffer_load_dwordx4 v1, s[12:15], s31 offen offset:3072 sc1 lds
    v_mfma_f32_16x16x32_bf16 v[172:175], v[20:23], v[48:51], v[172:175]
    s_waitcnt lgkmcnt(5)
    v_mfma_f32_16x16x32_bf16 v[176:179], v[24:27], v[40:43], v[176:179]
    ds_read_b128 v[16:19], v2 offset:18432
    v_mfma_f32_16x16x32_bf16 v[180:183], v[24:27], v[44:47], v[180:183]
    ds_read_b128 v[20:23], v3 offset:18432
    v_mov_b32 v0, s48
    v_mfma_f32_16x16x32_bf16 v[184:187], v[24:27], v[48:51], v[184:187]
    ds_read_b32 v0, v0
    v_mfma_f32_16x16x32_bf16 v[188:191], v[24:27], v[52:55], v[188:191]
    v_mfma_f32_16x16x32_bf16 v[176:179], v[28:31], v[72:75], v[176:179]
    s_add_u32 m0, s29, s38
    s_mov_b64 exec, s[44:45]
    buffer_load_dwordx4 v1, s[64:67], s33 offen sc1 lds
    s_mov_b64 exec, -1
    s_add_u32 s31, s31, 16384
    s_add_u32 s33, s33, 21376
    v_mfma_f32_16x16x32_bf16 v[180:183], v[28:31], v[40:43], v[180:183]
    v_mfma_f32_16x16x32_bf16 v[184:187], v[28:31], v[76:79], v[184:187]
    v_mfma_f32_16x16x32_bf16 v[188:191], v[28:31], v[48:51], v[188:191]
    s_waitcnt lgkmcnt(0)
    v_cmp_eq_u32 vcc, 0, v0
    v_mfma_f32_16x16x32_bf16 v[192:195], v[32:35], v[40:43], v[192:195]
    ds_read_b128 v[24:27], v2 offset:20480
    v_mfma_f32_16x16x32_bf16 v[196:199], v[32:35], v[44:47], v[196:199]
    ds_read_b128 v[28:31], v3 offset:20480
    s_cbranch_vccnz K12_F7
K12_G7:
    v_mfma_f32_16x16x32_bf16 v[200:203], v[32:35], v[48:51], v[200:203]
    s_sub_u32 s43, s42, s41
    s_add_u32 s40, s40, 1
    v_add_u32 v2, s43, v2
    v_mfma_f32_16x16x32_bf16 v[204:207], v[32:35], v[52:55], v[204:207]
    v_add_u32 v3, s43, v3
    v_add_u32 v4, s43, v4
    v_mov_b32 v0, s40
    v_mfma_f32_16x16x32_bf16 v[192:195], v[36:39], v[72:75], v[192:195]
    ds_write_b32 v7, v0
    v_mfma_f32_16x16x32_bf16 v[196:199], v[36:39], v[40:43], v[196:199]
    v_mfma_f32_16x16x32_bf16 v[200:203], v[36:39], v[76:79], v[200:203]
    v_mfma_f32_16x16x32_bf16 v[204:207], v[36:39], v[48:51], v[204:207]
    ds_read_b32 v56, v5
    v_mfma_f32_16x16x32_bf16 v[208:211], v[8:11], v[40:43], v[208:211]
    v_mfma_f32_16x16x32_bf16 v[212:215], v[8:11], v[44:47], v[212:215]
    v_mfma_f32_16x16x32_bf16 v[216:219], v[8:11], v[48:51], v[216:219]
    v_mfma_f32_16x16x32_bf16 v[220:223], v[8:11], v[52:55], v[220:223]
    s_waitcnt lgkmcnt(0)
    v_cmp_gt_u32 vcc, s51, v56
    v_mfma_f32_16x16x32_bf16 v[208:211], v[12:15], v[72:75], v[208:211]
    v_mfma_f32_16x16x32_bf16 v[212:215], v[12:15], v[40:43], v[212:215]
    s_cbranch_vccnz K12_S8
K12_Q8:
    v_mfma_f32_16x16x32_bf16 v[216:219], v[12:15], v[76:79], v[216:219]
    ds_read_b64_tr_b16 v[56:57], v4 offset:0
    v_mfma_f32_16x16x32_bf16 v[220:223], v[12:15], v[48:51], v[220:223]
    ds_read_b64_tr_b16 v[58:59], v4 offset:2048
    v_mfma_f32_16x16x32_bf16 v[224:227], v[16:19], v[40:43], v[224:227]
    ds_read_b64_tr_b16 v[60:61], v4 offset:256
    ds_read_b128 v[8:11], v2 offset:0
    v_mfma_f32_16x16x32_bf16 v[228:231], v[16:19], v[44:47], v[228:231]
    ds_read_b64_tr_b16 v[62:63], v4 offset:2304
    ds_read_b128 v[12:15], v3 offset:0
    v_mfma_f32_16x16x32_bf16 v[232:235], v[16:19], v[48:51], v[232:235]
    v_xor_b32 v4, 32, v4
    ds_read_b128 v[32:35], v2 offset:6144
    v_mfma_f32_16x16x32_bf16 v[236:239], v[16:19], v[52:55], v[236:239]
    ds_read_b64_tr_b16 v[64:65], v4 offset:0
    ds_read_b128 v[36:39], v3 offset:6144
    v_mfma_f32_16x16x32_bf16 v[224:227], v[20:23], v[72:75], v[224:227]
    ds_read_b64_tr_b16 v[66:67], v4 offset:2048
    ds_read_b32 v52, v5
    v_mfma_f32_16x16x32_bf16 v[228:231], v[20:23], v[40:43], v[228:231]
    ds_read_b64_tr_b16 v[68:69], v4 offset:256
    ds_read_b64_tr_b16 v[70:71], v4 offset:2304
    v_xor_b32 v4, 32, v4
    v_mfma_f32_16x16x32_bf16 v[232:235], v[20:23], v[76:79], v[232:235]
    v_mfma_f32_16x16x32_bf16 v[236:239], v[20:23], v[48:51], v[236:239]
    v_mfma_f32_16x16x32_bf16 v[240:243], v[24:27], v[40:43], v[240:243]
    ds_read_b128 v[16:19], v2 offset:2048
    v_mfma_f32_16x16x32_bf16 v[244:247], v[24:27], v[44:47], v[244:247]
    ds_read_b128 v[20:23], v3 offset:2048
    v_mfma_f32_16x16x32_bf16 v[240:243], v[28:31], v[72:75], v[240:243]
    s_mov_b32 s29, s41
    s_mov_b32 s41, s42
    s_add_u32 s42, s42, 38912
    v_mfma_f32_16x16x32_bf16 v[244:247], v[28:31], v[40:43], v[244:247]
    s_cmp_eq_u32 s42, 155648
    s_cselect_b32 s42, 0, s42
    s_waitcnt lgkmcnt(2)
    v_mfma_f32_16x16x32_bf16 v[80:83], v[8:11], v[56:59], v[80:83]
    ds_read_b128 v[24:27], v2 offset:4096
    v_xor_b32 v72, s35, v60
    v_xor_b32 v73, s35, v61
    v_mfma_f32_16x16x32_bf16 v[84:87], v[8:11], v[60:63], v[84:87]
    ds_read_b128 v[28:31], v3 offset:4096
    v_xor_b32 v74, s35, v62
    v_xor_b32 v75, s35, v63
    v_mfma_f32_16x16x32_bf16 v[88:91], v[8:11], v[64:67], v[88:91]
    v_xor_b32 v76, s35, v68
    v_xor_b32 v77, s35, v69
    v_mfma_f32_16x16x32_bf16 v[92:95], v[8:11], v[68:71], v[92:95]
    v_xor_b32 v78, s35, v70
    v_xor_b32 v79, s35, v71
    v_mfma_f32_16x16x32_bf16 v[80:83], v[12:15], v[72:75], v[80:83]
    v_lshrrev_b32 v0, 4, v1
    v_and_b32 v5, 15, v0
    v_mfma_f32_16x16x32_bf16 v[84:87], v[12:15], v[56:59], v[84:87]
    v_lshrrev_b32 v0, 4, v0
    s_lshl_b32 s28, s21, 7
    v_mfma_f32_16x16x32_bf16 v[88:91], v[12:15], v[76:79], v[88:91]
    s_lshl_b32 s29, s3, 5
    s_add_u32 s28, s28, s29
    v_mfma_f32_16x16x32_bf16 v[92:95], v[12:15], v[64:67], v[92:95]
    v_add_u32 v5, s28, v5
    v_lshlrev_b32 v5, 2, v5
    s_waitcnt lgkmcnt(2)
    v_mfma_f32_16x16x32_bf16 v[96:99], v[16:19], v[56:59], v[96:99]
    ds_read_b128 v[8:11], v2 offset:8192
    v_lshl_add_u32 v5, v0, 13, v5
    s_lshl_b32 s28, s20, 6
    v_mfma_f32_16x16x32_bf16 v[100:103], v[16:19], v[60:63], v[100:103]
    ds_read_b128 v[12:15], v3 offset:8192
    v_xor_b32 v5, s28, v5
    v_xor_b32 v7, 64, v5
    v_mfma_f32_16x16x32_bf16 v[104:107], v[16:19], v[64:67], v[104:107]
    v_mfma_f32_16x16x32_bf16 v[108:111], v[16:19], v[68:71], v[108:111]
    s_mov_b32 s38, 0
    v_cvt_pk_bf16_f32 v48, v80, v84
    buffer_store_dword v48, v5, s[16:19], s38 offen offset:0 sc1
    v_cvt_pk_bf16_f32 v49, v88, v92
    buffer_store_dword v49, v7, s[16:19], s38 offen offset:0 sc1
    v_mfma_f32_16x16x32_bf16 v[96:99], v[20:23], v[72:75], v[96:99]
    v_cvt_pk_bf16_f32 v50, v81, v85
    buffer_store_dword v50, v5, s[16:19], s38 offen offset:2048 sc1
    v_mfma_f32_16x16x32_bf16 v[100:103], v[20:23], v[56:59], v[100:103]
    v_cvt_pk_bf16_f32 v51, v89, v93
    buffer_store_dword v51, v7, s[16:19], s38 offen offset:2048 sc1
    v_mfma_f32_16x16x32_bf16 v[104:107], v[20:23], v[76:79], v[104:107]
    s_mov_b32 s38, 4096
    v_cvt_pk_bf16_f32 v52, v82, v86
    buffer_store_dword v52, v5, s[16:19], s38 offen offset:0 sc1
    v_cvt_pk_bf16_f32 v53, v90, v94
    buffer_store_dword v53, v7, s[16:19], s38 offen offset:0 sc1
    v_mfma_f32_16x16x32_bf16 v[108:111], v[20:23], v[64:67], v[108:111]
    v_cvt_pk_bf16_f32 v54, v83, v87
    buffer_store_dword v54, v5, s[16:19], s38 offen offset:2048 sc1
    s_waitcnt lgkmcnt(2)
    v_mfma_f32_16x16x32_bf16 v[112:115], v[24:27], v[56:59], v[112:115]
    ds_read_b128 v[16:19], v2 offset:10240
    v_cvt_pk_bf16_f32 v55, v91, v95
    buffer_store_dword v55, v7, s[16:19], s38 offen offset:2048 sc1
    v_mfma_f32_16x16x32_bf16 v[116:119], v[24:27], v[60:63], v[116:119]
    ds_read_b128 v[20:23], v3 offset:10240
    v_mfma_f32_16x16x32_bf16 v[120:123], v[24:27], v[64:67], v[120:123]
    v_mfma_f32_16x16x32_bf16 v[124:127], v[24:27], v[68:71], v[124:127]
    s_mov_b32 s38, 32768
    v_cvt_pk_bf16_f32 v40, v96, v100
    buffer_store_dword v40, v5, s[16:19], s38 offen offset:0 sc1
    v_cvt_pk_bf16_f32 v41, v104, v108
    buffer_store_dword v41, v7, s[16:19], s38 offen offset:0 sc1
    v_mfma_f32_16x16x32_bf16 v[112:115], v[28:31], v[72:75], v[112:115]
    v_cvt_pk_bf16_f32 v42, v97, v101
    buffer_store_dword v42, v5, s[16:19], s38 offen offset:2048 sc1
    v_mfma_f32_16x16x32_bf16 v[116:119], v[28:31], v[56:59], v[116:119]
    v_cvt_pk_bf16_f32 v43, v105, v109
    buffer_store_dword v43, v7, s[16:19], s38 offen offset:2048 sc1
    v_mfma_f32_16x16x32_bf16 v[120:123], v[28:31], v[76:79], v[120:123]
    s_mov_b32 s38, 36864
    v_cvt_pk_bf16_f32 v44, v98, v102
    buffer_store_dword v44, v5, s[16:19], s38 offen offset:0 sc1
    v_cvt_pk_bf16_f32 v45, v106, v110
    buffer_store_dword v45, v7, s[16:19], s38 offen offset:0 sc1
    v_mfma_f32_16x16x32_bf16 v[124:127], v[28:31], v[64:67], v[124:127]
    v_cvt_pk_bf16_f32 v46, v99, v103
    buffer_store_dword v46, v5, s[16:19], s38 offen offset:2048 sc1
    v_mfma_f32_16x16x32_bf16 v[128:131], v[32:35], v[56:59], v[128:131]
    ds_read_b128 v[24:27], v2 offset:12288
    v_cvt_pk_bf16_f32 v47, v107, v111
    buffer_store_dword v47, v7, s[16:19], s38 offen offset:2048 sc1
    v_mfma_f32_16x16x32_bf16 v[132:135], v[32:35], v[60:63], v[132:135]
    ds_read_b128 v[28:31], v3 offset:12288
    v_mfma_f32_16x16x32_bf16 v[136:139], v[32:35], v[64:67], v[136:139]
    v_mfma_f32_16x16x32_bf16 v[140:143], v[32:35], v[68:71], v[140:143]
    s_mov_b32 s38, 65536
    v_cvt_pk_bf16_f32 v48, v112, v116
    buffer_store_dword v48, v5, s[16:19], s38 offen offset:0 sc1
    v_cvt_pk_bf16_f32 v49, v120, v124
    buffer_store_dword v49, v7, s[16:19], s38 offen offset:0 sc1
    v_mfma_f32_16x16x32_bf16 v[128:131], v[36:39], v[72:75], v[128:131]
    v_cvt_pk_bf16_f32 v50, v113, v117
    buffer_store_dword v50, v5, s[16:19], s38 offen offset:2048 sc1
    v_mfma_f32_16x16x32_bf16 v[132:135], v[36:39], v[56:59], v[132:135]
    v_cvt_pk_bf16_f32 v51, v121, v125
    buffer_store_dword v51, v7, s[16:19], s38 offen offset:2048 sc1
    v_mfma_f32_16x16x32_bf16 v[136:139], v[36:39], v[76:79], v[136:139]
    s_mov_b32 s38, 69632
    v_cvt_pk_bf16_f32 v52, v114, v118
    buffer_store_dword v52, v5, s[16:19], s38 offen offset:0 sc1
    v_cvt_pk_bf16_f32 v53, v122, v126
    buffer_store_dword v53, v7, s[16:19], s38 offen offset:0 sc1
    v_mfma_f32_16x16x32_bf16 v[140:143], v[36:39], v[64:67], v[140:143]
    v_cvt_pk_bf16_f32 v54, v115, v119
    buffer_store_dword v54, v5, s[16:19], s38 offen offset:2048 sc1
    s_waitcnt lgkmcnt(4)
    v_mfma_f32_16x16x32_bf16 v[144:147], v[8:11], v[56:59], v[144:147]
    ds_read_b128 v[32:35], v2 offset:14336
    v_cvt_pk_bf16_f32 v55, v123, v127
    buffer_store_dword v55, v7, s[16:19], s38 offen offset:2048 sc1
    v_mfma_f32_16x16x32_bf16 v[148:151], v[8:11], v[60:63], v[148:151]
    ds_read_b128 v[36:39], v3 offset:14336
    v_mfma_f32_16x16x32_bf16 v[152:155], v[8:11], v[64:67], v[152:155]
    v_mfma_f32_16x16x32_bf16 v[156:159], v[8:11], v[68:71], v[156:159]
    s_mov_b32 s38, 98304
    v_cvt_pk_bf16_f32 v40, v128, v132
    buffer_store_dword v40, v5, s[16:19], s38 offen offset:0 sc1
    v_cvt_pk_bf16_f32 v41, v136, v140
    buffer_store_dword v41, v7, s[16:19], s38 offen offset:0 sc1
    v_mfma_f32_16x16x32_bf16 v[144:147], v[12:15], v[72:75], v[144:147]
    v_cvt_pk_bf16_f32 v42, v129, v133
    buffer_store_dword v42, v5, s[16:19], s38 offen offset:2048 sc1
    v_mfma_f32_16x16x32_bf16 v[148:151], v[12:15], v[56:59], v[148:151]
    v_cvt_pk_bf16_f32 v43, v137, v141
    buffer_store_dword v43, v7, s[16:19], s38 offen offset:2048 sc1
    v_mfma_f32_16x16x32_bf16 v[152:155], v[12:15], v[76:79], v[152:155]
    s_mov_b32 s38, 102400
    v_cvt_pk_bf16_f32 v44, v130, v134
    buffer_store_dword v44, v5, s[16:19], s38 offen offset:0 sc1
    v_cvt_pk_bf16_f32 v45, v138, v142
    buffer_store_dword v45, v7, s[16:19], s38 offen offset:0 sc1
    v_mfma_f32_16x16x32_bf16 v[156:159], v[12:15], v[64:67], v[156:159]
    v_cvt_pk_bf16_f32 v46, v131, v135
    buffer_store_dword v46, v5, s[16:19], s38 offen offset:2048 sc1
    s_waitcnt lgkmcnt(4)
    v_mfma_f32_16x16x32_bf16 v[160:163], v[16:19], v[56:59], v[160:163]
    ds_read_b128 v[8:11], v2 offset:16384
    v_cvt_pk_bf16_f32 v47, v139, v143
    buffer_store_dword v47, v7, s[16:19], s38 offen offset:2048 sc1
    v_mfma_f32_16x16x32_bf16 v[164:167], v[16:19], v[60:63], v[164:167]
    ds_read_b128 v[12:15], v3 offset:16384
    v_mfma_f32_16x16x32_bf16 v[168:171], v[16:19], v[64:67], v[168:171]
    v_mfma_f32_16x16x32_bf16 v[172:175], v[16:19], v[68:71], v[172:175]
    s_mov_b32 s38, 131072
    v_cvt_pk_bf16_f32 v48, v144, v148
    buffer_store_dword v48, v5, s[16:19], s38 offen offset:0 sc1
    v_cvt_pk_bf16_f32 v49, v152, v156
    buffer_store_dword v49, v7, s[16:19], s38 offen offset:0 sc1
    v_mfma_f32_16x16x32_bf16 v[160:163], v[20:23], v[72:75], v[160:163]
    v_cvt_pk_bf16_f32 v50, v145, v149
    buffer_store_dword v50, v5, s[16:19], s38 offen offset:2048 sc1
    v_mfma_f32_16x16x32_bf16 v[164:167], v[20:23], v[56:59], v[164:167]
    v_cvt_pk_bf16_f32 v51, v153, v157
    buffer_store_dword v51, v7, s[16:19], s38 offen offset:2048 sc1
    v_mfma_f32_16x16x32_bf16 v[168:171], v[20:23], v[76:79], v[168:171]
    s_mov_b32 s38, 135168
    v_cvt_pk_bf16_f32 v52, v146, v150
    buffer_store_dword v52, v5, s[16:19], s38 offen offset:0 sc1
    v_cvt_pk_bf16_f32 v53, v154, v158
    buffer_store_dword v53, v7, s[16:19], s38 offen offset:0 sc1
    v_mfma_f32_16x16x32_bf16 v[172:175], v[20:23], v[64:67], v[172:175]
    v_cvt_pk_bf16_f32 v54, v147, v151
    buffer_store_dword v54, v5, s[16:19], s38 offen offset:2048 sc1
    s_waitcnt lgkmcnt(4)
    v_mfma_f32_16x16x32_bf16 v[176:179], v[24:27], v[56:59], v[176:179]
    ds_read_b128 v[16:19], v2 offset:18432
    v_cvt_pk_bf16_f32 v55, v155, v159
    buffer_store_dword v55, v7, s[16:19], s38 offen offset:2048 sc1
    v_mfma_f32_16x16x32_bf16 v[180:183], v[24:27], v[60:63], v[180:183]
    ds_read_b128 v[20:23], v3 offset:18432
    v_mfma_f32_16x16x32_bf16 v[184:187], v[24:27], v[64:67], v[184:187]
    v_mfma_f32_16x16x32_bf16 v[188:191], v[24:27], v[68:71], v[188:191]
    s_mov_b32 s38, 163840
    v_cvt_pk_bf16_f32 v40, v160, v164
    buffer_store_dword v40, v5, s[16:19], s38 offen offset:0 sc1
    v_cvt_pk_bf16_f32 v41, v168, v172
    buffer_store_dword v41, v7, s[16:19], s38 offen offset:0 sc1
    v_mfma_f32_16x16x32_bf16 v[176:179], v[28:31], v[72:75], v[176:179]
    v_cvt_pk_bf16_f32 v42, v161, v165
    buffer_store_dword v42, v5, s[16:19], s38 offen offset:2048 sc1
    v_mfma_f32_16x16x32_bf16 v[180:183], v[28:31], v[56:59], v[180:183]
    v_cvt_pk_bf16_f32 v43, v169, v173
    buffer_store_dword v43, v7, s[16:19], s38 offen offset:2048 sc1
    v_mfma_f32_16x16x32_bf16 v[184:187], v[28:31], v[76:79], v[184:187]
    s_mov_b32 s38, 167936
    v_cvt_pk_bf16_f32 v44, v162, v166
    buffer_store_dword v44, v5, s[16:19], s38 offen offset:0 sc1
    v_cvt_pk_bf16_f32 v45, v170, v174
    buffer_store_dword v45, v7, s[16:19], s38 offen offset:0 sc1
    v_mfma_f32_16x16x32_bf16 v[188:191], v[28:31], v[64:67], v[188:191]
    v_cvt_pk_bf16_f32 v46, v163, v167
    buffer_store_dword v46, v5, s[16:19], s38 offen offset:2048 sc1
    s_waitcnt lgkmcnt(4)
    v_mfma_f32_16x16x32_bf16 v[192:195], v[32:35], v[56:59], v[192:195]
    ds_read_b128 v[24:27], v2 offset:20480
    v_cvt_pk_bf16_f32 v47, v171, v175
    buffer_store_dword v47, v7, s[16:19], s38 offen offset:2048 sc1
    v_mfma_f32_16x16x32_bf16 v[196:199], v[32:35], v[60:63], v[196:199]
    ds_read_b128 v[28:31], v3 offset:20480
    v_mfma_f32_16x16x32_bf16 v[200:203], v[32:35], v[64:67], v[200:203]
    v_mfma_f32_16x16x32_bf16 v[204:207], v[32:35], v[68:71], v[204:207]
    s_mov_b32 s38, 196608
    v_cvt_pk_bf16_f32 v48, v176, v180
    buffer_store_dword v48, v5, s[16:19], s38 offen offset:0 sc1
    v_cvt_pk_bf16_f32 v49, v184, v188
    buffer_store_dword v49, v7, s[16:19], s38 offen offset:0 sc1
    v_mfma_f32_16x16x32_bf16 v[192:195], v[36:39], v[72:75], v[192:195]
    v_cvt_pk_bf16_f32 v50, v177, v181
    buffer_store_dword v50, v5, s[16:19], s38 offen offset:2048 sc1
    v_mfma_f32_16x16x32_bf16 v[196:199], v[36:39], v[56:59], v[196:199]
    v_cvt_pk_bf16_f32 v51, v185, v189
    buffer_store_dword v51, v7, s[16:19], s38 offen offset:2048 sc1
    v_mfma_f32_16x16x32_bf16 v[200:203], v[36:39], v[76:79], v[200:203]
    s_mov_b32 s38, 200704
    v_cvt_pk_bf16_f32 v52, v178, v182
    buffer_store_dword v52, v5, s[16:19], s38 offen offset:0 sc1
    v_cvt_pk_bf16_f32 v53, v186, v190
    buffer_store_dword v53, v7, s[16:19], s38 offen offset:0 sc1
    v_mfma_f32_16x16x32_bf16 v[204:207], v[36:39], v[64:67], v[204:207]
    v_cvt_pk_bf16_f32 v54, v179, v183
    buffer_store_dword v54, v5, s[16:19], s38 offen offset:2048 sc1
    s_waitcnt lgkmcnt(4)
    v_mfma_f32_16x16x32_bf16 v[208:211], v[8:11], v[56:59], v[208:211]
    v_cvt_pk_bf16_f32 v55, v187, v191
    buffer_store_dword v55, v7, s[16:19], s38 offen offset:2048 sc1
    v_mfma_f32_16x16x32_bf16 v[212:215], v[8:11], v[60:63], v[212:215]
    v_mfma_f32_16x16x32_bf16 v[216:219], v[8:11], v[64:67], v[216:219]
    v_mfma_f32_16x16x32_bf16 v[220:223], v[8:11], v[68:71], v[220:223]
    s_mov_b32 s38, 229376
    v_cvt_pk_bf16_f32 v40, v192, v196
    buffer_store_dword v40, v5, s[16:19], s38 offen offset:0 sc1
    v_cvt_pk_bf16_f32 v41, v200, v204
    buffer_store_dword v41, v7, s[16:19], s38 offen offset:0 sc1
    v_mfma_f32_16x16x32_bf16 v[208:211], v[12:15], v[72:75], v[208:211]
    v_cvt_pk_bf16_f32 v42, v193, v197
    buffer_store_dword v42, v5, s[16:19], s38 offen offset:2048 sc1
    v_mfma_f32_16x16x32_bf16 v[212:215], v[12:15], v[56:59], v[212:215]
    v_cvt_pk_bf16_f32 v43, v201, v205
    buffer_store_dword v43, v7, s[16:19], s38 offen offset:2048 sc1
    v_mfma_f32_16x16x32_bf16 v[216:219], v[12:15], v[76:79], v[216:219]
    s_mov_b32 s38, 233472
    v_cvt_pk_bf16_f32 v44, v194, v198
    buffer_store_dword v44, v5, s[16:19], s38 offen offset:0 sc1
    v_cvt_pk_bf16_f32 v45, v202, v206
    buffer_store_dword v45, v7, s[16:19], s38 offen offset:0 sc1
    v_mfma_f32_16x16x32_bf16 v[220:223], v[12:15], v[64:67], v[220:223]
    v_cvt_pk_bf16_f32 v46, v195, v199
    buffer_store_dword v46, v5, s[16:19], s38 offen offset:2048 sc1
    s_waitcnt lgkmcnt(2)
    v_mfma_f32_16x16x32_bf16 v[224:227], v[16:19], v[56:59], v[224:227]
    v_cvt_pk_bf16_f32 v47, v203, v207
    buffer_store_dword v47, v7, s[16:19], s38 offen offset:2048 sc1
    v_mfma_f32_16x16x32_bf16 v[228:231], v[16:19], v[60:63], v[228:231]
    v_mfma_f32_16x16x32_bf16 v[232:235], v[16:19], v[64:67], v[232:235]
    v_mfma_f32_16x16x32_bf16 v[236:239], v[16:19], v[68:71], v[236:239]
    s_mov_b32 s38, 262144
    v_cvt_pk_bf16_f32 v48, v208, v212
    buffer_store_dword v48, v5, s[16:19], s38 offen offset:0 sc1
    v_cvt_pk_bf16_f32 v49, v216, v220
    buffer_store_dword v49, v7, s[16:19], s38 offen offset:0 sc1
    v_mfma_f32_16x16x32_bf16 v[224:227], v[20:23], v[72:75], v[224:227]
    v_cvt_pk_bf16_f32 v50, v209, v213
    buffer_store_dword v50, v5, s[16:19], s38 offen offset:2048 sc1
    v_mfma_f32_16x16x32_bf16 v[228:231], v[20:23], v[56:59], v[228:231]
    v_cvt_pk_bf16_f32 v51, v217, v221
    buffer_store_dword v51, v7, s[16:19], s38 offen offset:2048 sc1
    v_mfma_f32_16x16x32_bf16 v[232:235], v[20:23], v[76:79], v[232:235]
    s_mov_b32 s38, 266240
    v_cvt_pk_bf16_f32 v52, v210, v214
    buffer_store_dword v52, v5, s[16:19], s38 offen offset:0 sc1
    v_cvt_pk_bf16_f32 v53, v218, v222
    buffer_store_dword v53, v7, s[16:19], s38 offen offset:0 sc1
    v_mfma_f32_16x16x32_bf16 v[236:239], v[20:23], v[64:67], v[236:239]
    v_cvt_pk_bf16_f32 v54, v211, v215
    buffer_store_dword v54, v5, s[16:19], s38 offen offset:2048 sc1
    s_waitcnt lgkmcnt(0)
    v_mfma_f32_16x16x32_bf16 v[240:243], v[24:27], v[56:59], v[240:243]
    v_cvt_pk_bf16_f32 v55, v219, v223
    buffer_store_dword v55, v7, s[16:19], s38 offen offset:2048 sc1
    v_mfma_f32_16x16x32_bf16 v[244:247], v[24:27], v[60:63], v[244:247]
    v_mfma_f32_16x16x32_bf16 v[240:243], v[28:31], v[72:75], v[240:243]
    v_mfma_f32_16x16x32_bf16 v[244:247], v[28:31], v[56:59], v[244:247]
    s_mov_b32 s38, 294912
    v_cvt_pk_bf16_f32 v40, v224, v228
    buffer_store_dword v40, v5, s[16:19], s38 offen offset:0 sc1
    v_cvt_pk_bf16_f32 v41, v232, v236
    buffer_store_dword v41, v7, s[16:19], s38 offen offset:0 sc1
    v_cvt_pk_bf16_f32 v42, v225, v229
    buffer_store_dword v42, v5, s[16:19], s38 offen offset:2048 sc1
    v_cvt_pk_bf16_f32 v43, v233, v237
    buffer_store_dword v43, v7, s[16:19], s38 offen offset:2048 sc1
    s_mov_b32 s38, 299008
    v_cvt_pk_bf16_f32 v44, v226, v230
    buffer_store_dword v44, v5, s[16:19], s38 offen offset:0 sc1
    v_cvt_pk_bf16_f32 v45, v234, v238
    buffer_store_dword v45, v7, s[16:19], s38 offen offset:0 sc1
    v_cvt_pk_bf16_f32 v46, v227, v231
    buffer_store_dword v46, v5, s[16:19], s38 offen offset:2048 sc1
    v_cvt_pk_bf16_f32 v47, v235, v239
    buffer_store_dword v47, v7, s[16:19], s38 offen offset:2048 sc1
    s_nop 7
    s_lshl_b32 s34, s27, 1
    s_mul_i32 s34, s34, 342016
    s_add_u32 s34, s34, 118489088
    s_add_u32 s64, s58, s34
    s_addc_u32 s65, s59, 0
    s_and_b32 s65, s65, 0xffff
    s_mov_b32 s66, 684032
    s_mov_b32 s67, 0x00020000
    v_lshrrev_b32 v8, 8, v1
    v_lshlrev_b32 v9, 13, v8
    v_sub_u32 v9, v5, v9
    v_lshlrev_b32 v8, 2, v8
    v_add_u32 v8, 160, v8
    v_add_u32 v10, 0, v8
    v_add_u32 v11, 160, v10
    v_cmp_gt_u32 vcc, 167, v10
    s_nop 1
    v_cndmask_b32 v11, v11, v10, vcc
    v_cmp_gt_u32 vcc, 174, v10
    v_mov_b32 v12, 0x7ffff
    s_nop 0
    v_cndmask_b32 v11, v12, v11, vcc
    v_lshl_add_u32 v16, v11, 11, v9
    v_add_u32 v10, 1, v8
    v_add_u32 v11, 160, v10
    v_cmp_gt_u32 vcc, 167, v10
    s_nop 1
    v_cndmask_b32 v11, v11, v10, vcc
    v_cmp_gt_u32 vcc, 174, v10
    v_mov_b32 v12, 0x7ffff
    s_nop 0
    v_cndmask_b32 v11, v12, v11, vcc
    v_lshl_add_u32 v17, v11, 11, v9
    v_add_u32 v10, 2, v8
    v_add_u32 v11, 160, v10
    v_cmp_gt_u32 vcc, 167, v10
    s_nop 1
    v_cndmask_b32 v11, v11, v10, vcc
    v_cmp_gt_u32 vcc, 174, v10
    v_mov_b32 v12, 0x7ffff
    s_nop 0
    v_cndmask_b32 v11, v12, v11, vcc
    v_lshl_add_u32 v18, v11, 11, v9
    v_add_u32 v10, 3, v8
    v_add_u32 v11, 160, v10
    v_cmp_gt_u32 vcc, 167, v10
    s_nop 1
    v_cndmask_b32 v11, v11, v10, vcc
    v_cmp_gt_u32 vcc, 174, v10
    v_mov_b32 v12, 0x7ffff
    s_nop 0
    v_cndmask_b32 v11, v12, v11, vcc
    v_lshl_add_u32 v19, v11, 11, v9
    v_cvt_pk_bf16_f32 v20, v240, v244
    buffer_store_dword v20, v16, s[64:67], 0 offen sc1
    v_cvt_pk_bf16_f32 v21, v241, v245
    buffer_store_dword v21, v17, s[64:67], 0 offen sc1
    v_cvt_pk_bf16_f32 v22, v242, v246
    buffer_store_dword v22, v18, s[64:67], 0 offen sc1
    v_cvt_pk_bf16_f32 v23, v243, v247
    buffer_store_dword v23, v19, s[64:67], 0 offen sc1
    s_endpgm
K12_S0:
    s_mov_b32 s61, 16384
    s_add_u32 s62, s62, 1
K12_S0_L:
    ds_read_b32 v56, v5
    s_waitcnt lgkmcnt(0)
    v_cmp_gt_u32 vcc, s40, v56
    s_sub_u32 s61, s61, 1
    s_cmp_eq_u32 s61, 0
    s_cbranch_scc1 K12_Q0
    s_cbranch_vccz K12_Q0
    s_branch K12_S0_L
K12_S1:
    s_mov_b32 s61, 16384
    s_add_u32 s62, s62, 1
K12_S1_L:
    ds_read_b32 v68, v5
    s_waitcnt lgkmcnt(0)
    v_cmp_gt_u32 vcc, s40, v68
    s_sub_u32 s61, s61, 1
    s_cmp_eq_u32 s61, 0
    s_cbranch_scc1 K12_Q1
    s_cbranch_vccz K12_Q1
    s_branch K12_S1_L
K12_F2:
    s_mov_b32 s61, 16384
    s_add_u32 s63, s63, 1
K12_F2_L:
    s_mov_b32 m0, s46
    s_mov_b64 exec, 0xff
    buffer_load_dword v1, s[4:7], 0 offen sc1 lds
    s_mov_b64 exec, -1
    s_waitcnt vmcnt(0)
    v_mov_b32 v0, s48
    ds_read_b32 v0, v0
    s_waitcnt lgkmcnt(0)
    v_cmp_eq_u32 vcc, 0, v0
    s_sub_u32 s61, s61, 1
    s_cmp_eq_u32 s61, 0
    s_cbranch_scc1 K12_F2_X
    s_cbranch_vccz K12_F2_X
    s_sleep 2
    s_branch K12_F2_L
K12_F2_X:
    s_branch K12_G2
K12_S3:
    s_mov_b32 s61, 16384
    s_add_u32 s62, s62, 1
K12_S3_L:
    ds_read_b32 v56, v5
    s_waitcnt lgkmcnt(0)
    v_cmp_gt_u32 vcc, s51, v56
    s_sub_u32 s61, s61, 1
    s_cmp_eq_u32 s61, 0
    s_cbranch_scc1 K12_Q3
    s_cbranch_vccz K12_Q3
    s_branch K12_S3_L
K12_S4:
    s_mov_b32 s61, 16384
    s_add_u32 s62, s62, 1
K12_S4_L:
    ds_read_b32 v52, v5
    s_waitcnt lgkmcnt(0)
    v_cmp_gt_u32 vcc, s40, v52
    s_sub_u32 s61, s61, 1
    s_cmp_eq_u32 s61, 0
    s_cbranch_scc1 K12_Q4
    s_cbranch_vccz K12_Q4
    s_branch K12_S4_L
K12_S5:
    s_mov_b32 s61, 16384
    s_add_u32 s62, s62, 1
K12_S5_L:
    ds_read_b32 v40, v5
    s_waitcnt lgkmcnt(0)
    v_cmp_gt_u32 vcc, s51, v40
    s_sub_u32 s61, s61, 1
    s_cmp_eq_u32 s61, 0
    s_cbranch_scc1 K12_Q5
    s_cbranch_vccz K12_Q5
    s_branch K12_S5_L
K12_S6:
    s_mov_b32 s61, 16384
    s_add_u32 s62, s62, 1
K12_S6_L:
    ds_read_b32 v68, v5
    s_waitcnt lgkmcnt(0)
    v_cmp_gt_u32 vcc, s40, v68
    s_sub_u32 s61, s61, 1
    s_cmp_eq_u32 s61, 0
    s_cbranch_scc1 K12_Q6
    s_cbranch_vccz K12_Q6
    s_branch K12_S6_L
K12_F7:
    s_mov_b32 s61, 16384
    s_add_u32 s63, s63, 1
K12_F7_L:
    s_mov_b32 m0, s46
    s_mov_b64 exec, 0xff
    buffer_load_dword v1, s[4:7], 0 offen sc1 lds
    s_mov_b64 exec, -1
    s_waitcnt vmcnt(0)
    v_mov_b32 v0, s48
    ds_read_b32 v0, v0
    s_waitcnt lgkmcnt(0)
    v_cmp_eq_u32 vcc, 0, v0
    s_sub_u32 s61, s61, 1
    s_cmp_eq_u32 s61, 0
    s_cbranch_scc1 K12_F7_X
    s_cbranch_vccz K12_F7_X
    s_sleep 2
    s_branch K12_F7_L
K12_F7_X:
    s_branch K12_G7
K12_S8:
    s_mov_b32 s61, 16384
    s_add_u32 s62, s62, 1
K12_S8_L:
    ds_read_b32 v56, v5
    s_waitcnt lgkmcnt(0)
    v_cmp_gt_u32 vcc, s51, v56
    s_sub_u32 s61, s61, 1
    s_cmp_eq_u32 s61, 0
    s_cbranch_scc1 K12_Q8
    s_cbranch_vccz K12_Q8
    s_branch K12_S8_L
K12_END:
    s_endpgm
.p2align 8
.type k34_out_kernel,@function
k34_out_kernel:
    s_cmp_ge_u32 s2, 256
    s_cbranch_scc1 K34_END
    s_load_dwordx2 s[4:5], s[0:1], 48
    s_load_dwordx4 s[40:43], s[0:1], 16
    s_load_dwordx2 s[44:45], s[0:1], 32
    v_lshrrev_b32 v1, 6, v0
    v_and_b32 v2, 63, v0
    v_readfirstlane_b32 s3, v1
    s_and_b32 s6, s2, 15
    s_lshr_b32 s7, s2, 4
    s_lshr_b32 s20, s6, 3
    s_and_b32 s21, s6, 7
    s_mul_i32 s22, s7, 11
    s_mul_i32 s23, s7, 10
    s_add_u32 s23, s23, 7
    s_cmp_lt_u32 s7, 7
    s_cselect_b32 s22, s22, s23
    s_cselect_b32 s23, 11, 10
    s_add_u32 s22, s22, s3
    v_and_b32 v3, 15, v2
    v_lshrrev_b32 v4, 4, v2
    v_lshlrev_b32 v5, 4, v2
    s_mov_b32 s24, 2736128
    v_mul_lo_u32 v6, v4, s24
    v_lshl_add_u32 v6, v3, 4, v6
    s_mul_i32 s25, s20, 167
    s_add_u32 s25, s25, s22
    s_lshl_b32 s25, s25, 11
    s_lshl_b32 s24, s21, 8
    s_add_u32 s25, s25, s24
    s_waitcnt lgkmcnt(0)
    s_add_u32 s8, s4, 118489088
    s_addc_u32 s9, s5, 0
    s_and_b32 s9, s9, 0xffff
    s_mov_b32 s10, 21889024
    s_mov_b32 s11, 0x00020000
    s_add_u32 s12, s4, 153616384
    s_addc_u32 s13, s5, 0
    s_and_b32 s13, s13, 0xffff
    s_mov_b32 s14, 131072
    s_mov_b32 s15, 0x00020000
    s_cmp_lt_u32 s3, s23
    s_cbranch_scc0 K34_NOLOAD
    buffer_load_dwordx4 v[16:19], v6, s[8:11], s25 offen
    s_add_u32 s25, s25, 684032
    buffer_load_dwordx4 v[20:23], v6, s[8:11], s25 offen
    s_add_u32 s25, s25, 684032
    buffer_load_dwordx4 v[24:27], v6, s[8:11], s25 offen
    s_add_u32 s25, s25, 684032
    buffer_load_dwordx4 v[28:31], v6, s[8:11], s25 offen
    s_add_u32 s25, s25, 8892416
    buffer_load_dwordx4 v[32:35], v6, s[8:11], s25 offen
    s_add_u32 s25, s25, 684032
    buffer_load_dwordx4 v[36:39], v6, s[8:11], s25 offen
    s_add_u32 s25, s25, 684032
    buffer_load_dwordx4 v[40:43], v6, s[8:11], s25 offen
    s_add_u32 s25, s25, 684032
    buffer_load_dwordx4 v[44:47], v6, s[8:11], s25 offen
K34_NOLOAD:
    s_cmp_lg_u32 s3, 0
    s_cbranch_scc1 K34_TAB
    s_mov_b32 s16, s40
    s_mov_b32 s17, s41
    s_and_b32 s17, s17, 0xffff
    s_mov_b32 s18, 1024
    s_mov_b32 s19, 0x00020000
    s_mov_b32 s28, s42
    s_mov_b32 s29, s43
    s_and_b32 s29, s29, 0xffff
    s_mov_b32 s30, 1024
    s_mov_b32 s31, 0x00020000
    s_lshl_b32 s24, s21, 7
    v_lshlrev_b32 v8, 1, v2
    buffer_load_ushort v152, v8, s[16:19], s24 offen
    buffer_load_ushort v153, v8, s[28:31], s24 offen
    s_branch K34_TABDONE
K34_TAB:
    s_cmp_ge_u32 s3, 7
    s_cbranch_scc1 K34_TABDONE
    s_sub_u32 s27, s3, 1
    s_lshr_b32 s28, s27, 1
    s_and_b32 s29, s27, 1
    s_lshl_b32 s30, s28, 4
    v_add_u32 v8, s30, v3
    s_lshl_b32 s30, s29, 5
    s_add_u32 s30, s30, 1
    v_lshlrev_b32 v9, 3, v4
    v_add_u32 v9, s30, v9
    v_mul_u32_u24 v9, v8, v9
    v_lshlrev_b32 v8, 1, v8
    v_mad_u32_u24 v48, v8, 0, v9
    v_mad_u32_u24 v49, v8, 0, v9
    v_add_u32 v49, 32, v49
    v_mad_u32_u24 v50, v8, 1, v9
    v_mad_u32_u24 v51, v8, 1, v9
    v_add_u32 v51, 32, v51
    v_mad_u32_u24 v52, v8, 2, v9
    v_mad_u32_u24 v53, v8, 2, v9
    v_add_u32 v53, 32, v53
    v_mad_u32_u24 v54, v8, 3, v9
    v_mad_u32_u24 v55, v8, 3, v9
    v_add_u32 v55, 32, v55
    v_and_b32 v48, 127, v48
    v_and_b32 v49, 127, v49
    v_and_b32 v50, 127, v50
    v_and_b32 v51, 127, v51
    v_and_b32 v52, 127, v52
    v_and_b32 v53, 127, v53
    v_and_b32 v54, 127, v54
    v_and_b32 v55, 127, v55
    v_cvt_f32_u32 v48, v48
    v_cvt_f32_u32 v49, v49
    v_cvt_f32_u32 v50, v50
    v_cvt_f32_u32 v51, v51
    v_cvt_f32_u32 v52, v52
    v_cvt_f32_u32 v53, v53
    v_cvt_f32_u32 v54, v54
    v_cvt_f32_u32 v55, v55
    v_mul_f32 v48, 0x3c000000, v48
    v_mul_f32 v49, 0x3c000000, v49
    v_mul_f32 v50, 0x3c000000, v50
    v_mul_f32 v51, 0x3c000000, v51
    v_mul_f32 v52, 0x3c000000, v52
    v_mul_f32 v53, 0x3c000000, v53
    v_mul_f32 v54, 0x3c000000, v54
    v_mul_f32 v55, 0x3c000000, v55
    v_cos_f32 v48, v48
    v_cos_f32 v49, v49
    v_cos_f32 v50, v50
    v_cos_f32 v51, v51
    v_cos_f32 v52, v52
    v_cos_f32 v53, v53
    v_cos_f32 v54, v54
    v_cos_f32 v55, v55
    s_nop 0
    v_mul_f32 v48, 0x3d000000, v48
    v_mul_f32 v49, 0x3d000000, v49
    v_mul_f32 v50, 0x3d000000, v50
    v_mul_f32 v51, 0x3d000000, v51
    v_mul_f32 v52, 0x3d000000, v52
    v_mul_f32 v53, 0x3d000000, v53
    v_mul_f32 v54, 0x3d000000, v54
    v_mul_f32 v55, 0x3d000000, v55
    v_cvt_pk_bf16_f32 v56, v48, v49
    v_cvt_pk_bf16_f32 v57, v50, v51
    v_cvt_pk_bf16_f32 v58, v52, v53
    v_cvt_pk_bf16_f32 v59, v54, v55
    v_lshlrev_b32 v64, 16, v56
    v_and_b32 v65, 0xffff0000, v56
    v_sub_f32 v48, v48, v64
    v_sub_f32 v49, v49, v65
    v_lshlrev_b32 v64, 16, v57
    v_and_b32 v65, 0xffff0000, v57
    v_sub_f32 v50, v50, v64
    v_sub_f32 v51, v51, v65
    v_lshlrev_b32 v64, 16, v58
    v_and_b32 v65, 0xffff0000, v58
    v_sub_f32 v52, v52, v64
    v_sub_f32 v53, v53, v65
    v_lshlrev_b32 v64, 16, v59
    v_and_b32 v65, 0xffff0000, v59
    v_sub_f32 v54, v54, v64
    v_sub_f32 v55, v55, v65
    v_cvt_pk_bf16_f32 v60, v48, v49
    v_cvt_pk_bf16_f32 v61, v50, v51
    v_cvt_pk_bf16_f32 v62, v52, v53
    v_cvt_pk_bf16_f32 v63, v54, v55
    s_lshl_b32 s30, s27, 11
    v_add_u32 v10, s30, v5
    ds_write_b128 v10, v[56:59]
    ds_write_b128 v10, v[60:63] offset:1024
K34_TABDONE:
    s_waitcnt lgkmcnt(0)
    s_barrier
    s_cmp_lt_u32 s3, s23
    s_cbranch_scc0 K34_IDLE
    ds_read_b128 v[48:51], v5 offset:0
    ds_read_b128 v[52:55], v5 offset:1024
    ds_read_b128 v[56:59], v5 offset:2048
    ds_read_b128 v[60:63], v5 offset:3072
    ds_read_b128 v[64:67], v5 offset:4096
    ds_read_b128 v[68:71], v5 offset:5120
    ds_read_b128 v[72:75], v5 offset:6144
    ds_read_b128 v[76:79], v5 offset:7168
    ds_read_b128 v[80:83], v5 offset:8192
    ds_read_b128 v[84:87], v5 offset:9216
    ds_read_b128 v[88:91], v5 offset:10240
    ds_read_b128 v[92:95], v5 offset:11264
    s_waitcnt vmcnt(0)
    v_swap_b32 v17, v20
    v_swap_b32 v18, v24
    v_swap_b32 v19, v28
    v_swap_b32 v22, v25
    v_swap_b32 v23, v29
    v_swap_b32 v27, v30
    v_swap_b32 v33, v36
    v_swap_b32 v34, v40
    v_swap_b32 v35, v44
    v_swap_b32 v38, v41
    v_swap_b32 v39, v45
    v_swap_b32 v43, v46
    s_waitcnt lgkmcnt(0)
    s_mul_i32 s24, s22, 48
    s_sub_u32 s24, 7985, s24
    s_cmp_ge_u32 s24, 48
    s_cbranch_scc1 K34_FULL
    v_add_u32 v7, 0, v3
    v_cmp_gt_u32 vcc, s24, v7
    s_nop 1
    v_cndmask_b32 v48, 0, v48, vcc
    v_cndmask_b32 v49, 0, v49, vcc
    v_cndmask_b32 v50, 0, v50, vcc
    v_cndmask_b32 v51, 0, v51, vcc
    v_cndmask_b32 v52, 0, v52, vcc
    v_cndmask_b32 v53, 0, v53, vcc
    v_cndmask_b32 v54, 0, v54, vcc
    v_cndmask_b32 v55, 0, v55, vcc
    v_cndmask_b32 v56, 0, v56, vcc
    v_cndmask_b32 v57, 0, v57, vcc
    v_cndmask_b32 v58, 0, v58, vcc
    v_cndmask_b32 v59, 0, v59, vcc
    v_cndmask_b32 v60, 0, v60, vcc
    v_cndmask_b32 v61, 0, v61, vcc
    v_cndmask_b32 v62, 0, v62, vcc
    v_cndmask_b32 v63, 0, v63, vcc
    v_add_u32 v7, 16, v3
    v_cmp_gt_u32 vcc, s24, v7
    s_nop 1
    v_cndmask_b32 v64, 0, v64, vcc
    v_cndmask_b32 v65, 0, v65, vcc
    v_cndmask_b32 v66, 0, v66, vcc
    v_cndmask_b32 v67, 0, v67, vcc
    v_cndmask_b32 v68, 0, v68, vcc
    v_cndmask_b32 v69, 0, v69, vcc
    v_cndmask_b32 v70, 0, v70, vcc
    v_cndmask_b32 v71, 0, v71, vcc
    v_cndmask_b32 v72, 0, v72, vcc
    v_cndmask_b32 v73, 0, v73, vcc
    v_cndmask_b32 v74, 0, v74, vcc
    v_cndmask_b32 v75, 0, v75, vcc
    v_cndmask_b32 v76, 0, v76, vcc
    v_cndmask_b32 v77, 0, v77, vcc
    v_cndmask_b32 v78, 0, v78, vcc
    v_cndmask_b32 v79, 0, v79, vcc
    v_add_u32 v7, 32, v3
    v_cmp_gt_u32 vcc, s24, v7
    s_nop 1
    v_cndmask_b32 v80, 0, v80, vcc
    v_cndmask_b32 v81, 0, v81, vcc
    v_cndmask_b32 v82, 0, v82, vcc
    v_cndmask_b32 v83, 0, v83, vcc
    v_cndmask_b32 v84, 0, v84, vcc
    v_cndmask_b32 v85, 0, v85, vcc
    v_cndmask_b32 v86, 0, v86, vcc
    v_cndmask_b32 v87, 0, v87, vcc
    v_cndmask_b32 v88, 0, v88, vcc
    v_cndmask_b32 v89, 0, v89, vcc
    v_cndmask_b32 v90, 0, v90, vcc
    v_cndmask_b32 v91, 0, v91, vcc
    v_cndmask_b32 v92, 0, v92, vcc
    v_cndmask_b32 v93, 0, v93, vcc
    v_cndmask_b32 v94, 0, v94, vcc
    v_cndmask_b32 v95, 0, v95, vcc
K34_FULL:
    s_nop 1
    v_mfma_f32_16x16x32_bf16 v[96:99], v[48:51], v[16:19], 0
    v_mfma_f32_16x16x32_bf16 v[100:103], v[48:51], v[20:23], 0
    v_mfma_f32_16x16x32_bf16 v[104:107], v[48:51], v[24:27], 0
    v_mfma_f32_16x16x32_bf16 v[108:111], v[48:51], v[28:31], 0
    v_mfma_f32_16x16x32_bf16 v[96:99], v[52:55], v[16:19], v[96:99]
    v_mfma_f32_16x16x32_bf16 v[100:103], v[52:55], v[20:23], v[100:103]
    v_mfma_f32_16x16x32_bf16 v[104:107], v[52:55], v[24:27], v[104:107]
    v_mfma_f32_16x16x32_bf16 v[108:111], v[52:55], v[28:31], v[108:111]
    v_mfma_f32_16x16x32_bf16 v[96:99], v[56:59], v[32:35], v[96:99]
    v_mfma_f32_16x16x32_bf16 v[100:103], v[56:59], v[36:39], v[100:103]
    v_mfma_f32_16x16x32_bf16 v[104:107], v[56:59], v[40:43], v[104:107]
    v_mfma_f32_16x16x32_bf16 v[108:111], v[56:59], v[44:47], v[108:111]
    v_mfma_f32_16x16x32_bf16 v[96:99], v[60:63], v[32:35], v[96:99]
    v_mfma_f32_16x16x32_bf16 v[100:103], v[60:63], v[36:39], v[100:103]
    v_mfma_f32_16x16x32_bf16 v[104:107], v[60:63], v[40:43], v[104:107]
    v_mfma_f32_16x16x32_bf16 v[108:111], v[60:63], v[44:47], v[108:111]
    v_mfma_f32_16x16x32_bf16 v[112:115], v[64:67], v[16:19], 0
    v_mfma_f32_16x16x32_bf16 v[116:119], v[64:67], v[20:23], 0
    v_mfma_f32_16x16x32_bf16 v[120:123], v[64:67], v[24:27], 0
    v_mfma_f32_16x16x32_bf16 v[124:127], v[64:67], v[28:31], 0
    v_mfma_f32_16x16x32_bf16 v[112:115], v[68:71], v[16:19], v[112:115]
    v_mfma_f32_16x16x32_bf16 v[116:119], v[68:71], v[20:23], v[116:119]
    v_mfma_f32_16x16x32_bf16 v[120:123], v[68:71], v[24:27], v[120:123]
    v_mfma_f32_16x16x32_bf16 v[124:127], v[68:71], v[28:31], v[124:127]
    v_mfma_f32_16x16x32_bf16 v[112:115], v[72:75], v[32:35], v[112:115]
    v_mfma_f32_16x16x32_bf16 v[116:119], v[72:75], v[36:39], v[116:119]
    v_mfma_f32_16x16x32_bf16 v[120:123], v[72:75], v[40:43], v[120:123]
    v_mfma_f32_16x16x32_bf16 v[124:127], v[72:75], v[44:47], v[124:127]
    v_mfma_f32_16x16x32_bf16 v[112:115], v[76:79], v[32:35], v[112:115]
    v_mfma_f32_16x16x32_bf16 v[116:119], v[76:79], v[36:39], v[116:119]
    v_mfma_f32_16x16x32_bf16 v[120:123], v[76:79], v[40:43], v[120:123]
    v_mfma_f32_16x16x32_bf16 v[124:127], v[76:79], v[44:47], v[124:127]
    v_mfma_f32_16x16x32_bf16 v[128:131], v[80:83], v[16:19], 0
    v_mfma_f32_16x16x32_bf16 v[132:135], v[80:83], v[20:23], 0
    v_mfma_f32_16x16x32_bf16 v[136:139], v[80:83], v[24:27], 0
    v_mfma_f32_16x16x32_bf16 v[140:143], v[80:83], v[28:31], 0
    v_mfma_f32_16x16x32_bf16 v[128:131], v[84:87], v[16:19], v[128:131]
    v_mfma_f32_16x16x32_bf16 v[132:135], v[84:87], v[20:23], v[132:135]
    v_mfma_f32_16x16x32_bf16 v[136:139], v[84:87], v[24:27], v[136:139]
    v_mfma_f32_16x16x32_bf16 v[140:143], v[84:87], v[28:31], v[140:143]
    v_mfma_f32_16x16x32_bf16 v[128:131], v[88:91], v[32:35], v[128:131]
    v_mfma_f32_16x16x32_bf16 v[132:135], v[88:91], v[36:39], v[132:135]
    v_mfma_f32_16x16x32_bf16 v[136:139], v[88:91], v[40:43], v[136:139]
    v_mfma_f32_16x16x32_bf16 v[140:143], v[88:91], v[44:47], v[140:143]
    v_mfma_f32_16x16x32_bf16 v[128:131], v[92:95], v[32:35], v[128:131]
    v_mfma_f32_16x16x32_bf16 v[132:135], v[92:95], v[36:39], v[132:135]
    v_mfma_f32_16x16x32_bf16 v[136:139], v[92:95], v[40:43], v[136:139]
    v_mfma_f32_16x16x32_bf16 v[140:143], v[92:95], v[44:47], v[140:143]
    s_nop 7
    v_mov_b32 v16, v96
    v_mul_f32 v20, v96, v96
    v_mov_b32 v17, v100
    v_mul_f32 v21, v100, v100
    v_mov_b32 v18, v104
    v_mul_f32 v22, v104, v104
    v_mov_b32 v19, v108
    v_mul_f32 v23, v108, v108
    v_add_f32 v16, v16, v97
    v_fmac_f32 v20, v97, v97
    v_add_f32 v17, v17, v101
    v_fmac_f32 v21, v101, v101
    v_add_f32 v18, v18, v105
    v_fmac_f32 v22, v105, v105
    v_add_f32 v19, v19, v109
    v_fmac_f32 v23, v109, v109
    v_add_f32 v16, v16, v98
    v_fmac_f32 v20, v98, v98
    v_add_f32 v17, v17, v102
    v_fmac_f32 v21, v102, v102
    v_add_f32 v18, v18, v106
    v_fmac_f32 v22, v106, v106
    v_add_f32 v19, v19, v110
    v_fmac_f32 v23, v110, v110
    v_add_f32 v16, v16, v99
    v_fmac_f32 v20, v99, v99
    v_add_f32 v17, v17, v103
    v_fmac_f32 v21, v103, v103
    v_add_f32 v18, v18, v107
    v_fmac_f32 v22, v107, v107
    v_add_f32 v19, v19, v111
    v_fmac_f32 v23, v111, v111
    v_add_f32 v16, v16, v112
    v_fmac_f32 v20, v112, v112
    v_add_f32 v17, v17, v116
    v_fmac_f32 v21, v116, v116
    v_add_f32 v18, v18, v120
    v_fmac_f32 v22, v120, v120
    v_add_f32 v19, v19, v124
    v_fmac_f32 v23, v124, v124
    v_add_f32 v16, v16, v113
    v_fmac_f32 v20, v113, v113
    v_add_f32 v17, v17, v117
    v_fmac_f32 v21, v117, v117
    v_add_f32 v18, v18, v121
    v_fmac_f32 v22, v121, v121
    v_add_f32 v19, v19, v125
    v_fmac_f32 v23, v125, v125
    v_add_f32 v16, v16, v114
    v_fmac_f32 v20, v114, v114
    v_add_f32 v17, v17, v118
    v_fmac_f32 v21, v118, v118
    v_add_f32 v18, v18, v122
    v_fmac_f32 v22, v122, v122
    v_add_f32 v19, v19, v126
    v_fmac_f32 v23, v126, v126
    v_add_f32 v16, v16, v115
    v_fmac_f32 v20, v115, v115
    v_add_f32 v17, v17, v119
    v_fmac_f32 v21, v119, v119
    v_add_f32 v18, v18, v123
    v_fmac_f32 v22, v123, v123
    v_add_f32 v19, v19, v127
    v_fmac_f32 v23, v127, v127
    v_add_f32 v16, v16, v128
    v_fmac_f32 v20, v128, v128
    v_add_f32 v17, v17, v132
    v_fmac_f32 v21, v132, v132
    v_add_f32 v18, v18, v136
    v_fmac_f32 v22, v136, v136
    v_add_f32 v19, v19, v140
    v_fmac_f32 v23, v140, v140
    v_add_f32 v16, v16, v129
    v_fmac_f32 v20, v129, v129
    v_add_f32 v17, v17, v133
    v_fmac_f32 v21, v133, v133
    v_add_f32 v18, v18, v137
    v_fmac_f32 v22, v137, v137
    v_add_f32 v19, v19, v141
    v_fmac_f32 v23, v141, v141
    v_add_f32 v16, v16, v130
    v_fmac_f32 v20, v130, v130
    v_add_f32 v17, v17, v134
    v_fmac_f32 v21, v134, v134
    v_add_f32 v18, v18, v138
    v_fmac_f32 v22, v138, v138
    v_add_f32 v19, v19, v142
    v_fmac_f32 v23, v142, v142
    v_add_f32 v16, v16, v131
    v_fmac_f32 v20, v131, v131
    v_add_f32 v17, v17, v135
    v_fmac_f32 v21, v135, v135
    v_add_f32 v18, v18, v139
    v_fmac_f32 v22, v139, v139
    v_add_f32 v19, v19, v143
    v_fmac_f32 v23, v143, v143
    v_mov_b32 v24, v16
    v_mov_b32 v25, v17
    v_mov_b32 v26, v18
    v_mov_b32 v27, v19
    v_mov_b32 v28, v20
    v_mov_b32 v29, v21
    v_mov_b32 v30, v22
    v_mov_b32 v31, v23
    s_nop 0
    v_permlane32_swap_b32 v16, v24
    v_permlane32_swap_b32 v17, v25
    v_permlane32_swap_b32 v18, v26
    v_permlane32_swap_b32 v19, v27
    v_permlane32_swap_b32 v20, v28
    v_permlane32_swap_b32 v21, v29
    v_permlane32_swap_b32 v22, v30
    v_permlane32_swap_b32 v23, v31
    v_add_f32 v16, v16, v24
    v_add_f32 v17, v17, v25
    v_add_f32 v18, v18, v26
    v_add_f32 v19, v19, v27
    v_add_f32 v20, v20, v28
    v_add_f32 v21, v21, v29
    v_add_f32 v22, v22, v30
    v_add_f32 v23, v23, v31
    v_mov_b32 v24, v16
    v_mov_b32 v25, v17
    v_mov_b32 v26, v18
    v_mov_b32 v27, v19
    v_mov_b32 v28, v20
    v_mov_b32 v29, v21
    v_mov_b32 v30, v22
    v_mov_b32 v31, v23
    s_nop 0
    v_permlane16_swap_b32 v16, v24
    v_permlane16_swap_b32 v17, v25
    v_permlane16_swap_b32 v18, v26
    v_permlane16_swap_b32 v19, v27
    v_permlane16_swap_b32 v20, v28
    v_permlane16_swap_b32 v21, v29
    v_permlane16_swap_b32 v22, v30
    v_permlane16_swap_b32 v23, v31
    v_add_f32 v16, v16, v24
    v_add_f32 v17, v17, v25
    v_add_f32 v18, v18, v26
    v_add_f32 v19, v19, v27
    v_add_f32 v20, v20, v28
    v_add_f32 v21, v21, v29
    v_add_f32 v22, v22, v30
    v_add_f32 v23, v23, v31
    s_branch K34_WR
K34_IDLE:
    v_mov_b32 v16, 0
    v_mov_b32 v17, 0
    v_mov_b32 v18, 0
    v_mov_b32 v19, 0
    v_mov_b32 v20, 0
    v_mov_b32 v21, 0
    v_mov_b32 v22, 0
    v_mov_b32 v23, 0
K34_WR:
    s_lshl_b32 s24, s3, 9
    v_lshlrev_b32 v7, 4, v3
    v_add_u32 v7, s24, v7
    ds_write_b128 v7, v[16:19] offset:12288
    ds_write_b128 v7, v[20:23] offset:12544
    s_waitcnt lgkmcnt(0)
    s_barrier
    s_cmp_lg_u32 s3, 0
    s_cbranch_scc1 K34_WAIT
    v_lshlrev_b32 v7, 2, v2
    ds_read_b32 v16, v7 offset:12288
    ds_read_b32 v17, v7 offset:12800
    ds_read_b32 v18, v7 offset:13312
    ds_read_b32 v19, v7 offset:13824
    ds_read_b32 v20, v7 offset:14336
    ds_read_b32 v21, v7 offset:14848
    ds_read_b32 v22, v7 offset:15360
    ds_read_b32 v23, v7 offset:15872
    ds_read_b32 v24, v7 offset:16384
    ds_read_b32 v25, v7 offset:16896
    ds_read_b32 v26, v7 offset:17408
    ds_read_b32 v27, v7 offset:17920
    s_waitcnt lgkmcnt(0)
    ds_read_b32 v32, v7 offset:12544
    ds_read_b32 v33, v7 offset:13056
    ds_read_b32 v34, v7 offset:13568
    ds_read_b32 v35, v7 offset:14080
    ds_read_b32 v36, v7 offset:14592
    ds_read_b32 v37, v7 offset:15104
    ds_read_b32 v38, v7 offset:15616
    ds_read_b32 v39, v7 offset:16128
    ds_read_b32 v40, v7 offset:16640
    ds_read_b32 v41, v7 offset:17152
    ds_read_b32 v42, v7 offset:17664
    ds_read_b32 v43, v7 offset:18176
    v_add_f32 v16, v16, v17
    v_add_f32 v16, v16, v18
    v_add_f32 v16, v16, v19
    v_add_f32 v16, v16, v20
    v_add_f32 v16, v16, v21
    v_add_f32 v16, v16, v22
    v_add_f32 v16, v16, v23
    v_add_f32 v16, v16, v24
    v_add_f32 v16, v16, v25
    v_add_f32 v16, v16, v26
    v_add_f32 v16, v16, v27
    s_waitcnt lgkmcnt(0)
    v_add_f32 v32, v32, v33
    v_add_f32 v32, v32, v34
    v_add_f32 v32, v32, v35
    v_add_f32 v32, v32, v36
    v_add_f32 v32, v32, v37
    v_add_f32 v32, v32, v38
    v_add_f32 v32, v32, v39
    v_add_f32 v32, v32, v40
    v_add_f32 v32, v32, v41
    v_add_f32 v32, v32, v42
    v_add_f32 v32, v32, v43
    s_lshl_b32 s24, s6, 4
    s_add_u32 s24, s24, s7
    s_lshl_b32 s24, s24, 9
    buffer_store_dword v16, v7, s[12:15], s24 offen sc1
    buffer_store_dword v32, v7, s[12:15], s24 offen offset:256 sc1
    s_mov_b32 s26, 20000
K34_POLL:
    s_lshl_b32 s24, s6, 13
    buffer_load_dword v16, v7, s[12:15], s24 offen offset:0 sc1
    buffer_load_dword v32, v7, s[12:15], s24 offen offset:256 sc1
    buffer_load_dword v17, v7, s[12:15], s24 offen offset:512 sc1
    buffer_load_dword v33, v7, s[12:15], s24 offen offset:768 sc1
    buffer_load_dword v18, v7, s[12:15], s24 offen offset:1024 sc1
    buffer_load_dword v34, v7, s[12:15], s24 offen offset:1280 sc1
    buffer_load_dword v19, v7, s[12:15], s24 offen offset:1536 sc1
    buffer_load_dword v35, v7, s[12:15], s24 offen offset:1792 sc1
    buffer_load_dword v20, v7, s[12:15], s24 offen offset:2048 sc1
    buffer_load_dword v36, v7, s[12:15], s24 offen offset:2304 sc1
    buffer_load_dword v21, v7, s[12:15], s24 offen offset:2560 sc1
    buffer_load_dword v37, v7, s[12:15], s24 offen offset:2816 sc1
    buffer_load_dword v22, v7, s[12:15], s24 offen offset:3072 sc1
    buffer_load_dword v38, v7, s[12:15], s24 offen offset:3328 sc1
    buffer_load_dword v23, v7, s[12:15], s24 offen offset:3584 sc1
    buffer_load_dword v39, v7, s[12:15], s24 offen offset:3840 sc1
    s_add_u32 s24, s24, 4096
    buffer_load_dword v24, v7, s[12:15], s24 offen offset:0 sc1
    buffer_load_dword v40, v7, s[12:15], s24 offen offset:256 sc1
    buffer_load_dword v25, v7, s[12:15], s24 offen offset:512 sc1
    buffer_load_dword v41, v7, s[12:15], s24 offen offset:768 sc1
    buffer_load_dword v26, v7, s[12:15], s24 offen offset:1024 sc1
    buffer_load_dword v42, v7, s[12:15], s24 offen offset:1280 sc1
    buffer_load_dword v27, v7, s[12:15], s24 offen offset:1536 sc1
    buffer_load_dword v43, v7, s[12:15], s24 offen offset:1792 sc1
    buffer_load_dword v28, v7, s[12:15], s24 offen offset:2048 sc1
    buffer_load_dword v44, v7, s[12:15], s24 offen offset:2304 sc1
    buffer_load_dword v29, v7, s[12:15], s24 offen offset:2560 sc1
    buffer_load_dword v45, v7, s[12:15], s24 offen offset:2816 sc1
    buffer_load_dword v30, v7, s[12:15], s24 offen offset:3072 sc1
    buffer_load_dword v46, v7, s[12:15], s24 offen offset:3328 sc1
    buffer_load_dword v31, v7, s[12:15], s24 offen offset:3584 sc1
    buffer_load_dword v47, v7, s[12:15], s24 offen offset:3840 sc1
    s_waitcnt vmcnt(0)
    v_max3_u32 v48, v16, v17, v18
    v_max3_u32 v48, v48, v19, v20
    v_max3_u32 v48, v48, v21, v22
    v_max3_u32 v48, v48, v23, v24
    v_max3_u32 v48, v48, v25, v26
    v_max3_u32 v48, v48, v27, v28
    v_max3_u32 v48, v48, v29, v30
    v_max3_u32 v48, v48, v31, v32
    v_max3_u32 v48, v48, v33, v34
    v_max3_u32 v48, v48, v35, v36
    v_max3_u32 v48, v48, v37, v38
    v_max3_u32 v48, v48, v39, v40
    v_max3_u32 v48, v48, v41, v42
    v_max3_u32 v48, v48, v43, v44
    v_max3_u32 v48, v48, v45, v46
    v_max_u32 v48, v48, v47
    v_cmp_eq_u32 vcc, -1, v48
    s_sub_u32 s26, s26, 1
    s_cmp_eq_u32 s26, 0
    s_cbranch_scc1 K34_GOT
    s_cbranch_vccz K34_GOT
    s_sleep 1
    s_branch K34_POLL
K34_GOT:
    v_add_f32 v16, v16, v24
    v_add_f32 v32, v32, v40
    v_add_f32 v17, v17, v25
    v_add_f32 v33, v33, v41
    v_add_f32 v18, v18, v26
    v_add_f32 v34, v34, v42
    v_add_f32 v19, v19, v27
    v_add_f32 v35, v35, v43
    v_add_f32 v20, v20, v28
    v_add_f32 v36, v36, v44
    v_add_f32 v21, v21, v29
    v_add_f32 v37, v37, v45
    v_add_f32 v22, v22, v30
    v_add_f32 v38, v38, v46
    v_add_f32 v23, v23, v31
    v_add_f32 v39, v39, v47
    v_add_f32 v16, v16, v20
    v_add_f32 v32, v32, v36
    v_add_f32 v17, v17, v21
    v_add_f32 v33, v33, v37
    v_add_f32 v18, v18, v22
    v_add_f32 v34, v34, v38
    v_add_f32 v19, v19, v23
    v_add_f32 v35, v35, v39
    v_add_f32 v16, v16, v18
    v_add_f32 v32, v32, v34
    v_add_f32 v17, v17, v19
    v_add_f32 v33, v33, v35
    v_add_f32 v16, v16, v17
    v_add_f32 v32, v32, v33
    v_mul_f32 v11, 0x39035177, v16
    v_mul_f32 v12, 0x39035177, v32
    v_fma_f32 v12, -v11, v11, v12
    v_max_f32 v12, 0, v12
    v_add_f32 v12, 0x3727c5ac, v12
    v_sqrt_f32 v12, v12
    v_lshlrev_b32 v9, 16, v152
    v_rcp_f32 v12, v12
    v_lshlrev_b32 v10, 16, v153
    v_mul_f32 v9, v9, v12
    v_fma_f32 v10, -v11, v9, v10
    ds_write_b32 v7, v9 offset:18432
    ds_write_b32 v7, v10 offset:18688
    s_waitcnt lgkmcnt(0)
K34_WAIT:
    s_barrier
    s_cmp_lt_u32 s3, s23
    s_cbranch_scc0 K34_END
    v_lshlrev_b32 v7, 4, v3
    ds_read_b128 v[144:147], v7 offset:18432
    ds_read_b128 v[148:151], v7 offset:18688
    s_mul_i32 s24, s20, 8176640
    s_add_u32 s16, s44, s24
    s_addc_u32 s17, s45, 0
    s_and_b32 s17, s17, 0xffff
    s_mov_b32 s18, 8176640
    s_mov_b32 s19, 0x00020000
    v_lshlrev_b32 v7, 12, v4
    v_lshl_add_u32 v7, v3, 3, v7
    s_lshl_b32 s24, s21, 7
    v_add_u32 v7, s24, v7
    s_mul_i32 s25, s22, 49152
    s_mov_b32 s30, 0xc0135761
    s_mov_b32 s31, 0xbdd2d3e8
    v_mov_b32 v15, s30
    s_waitcnt lgkmcnt(0)
    v_fma_f32 v16, v96, v144, v148
    v_fma_f32 v17, v100, v145, v149
    v_fma_f32 v18, v104, v146, v150
    v_fma_f32 v19, v108, v147, v151
    v_fma_f32 v20, v97, v144, v148
    v_fma_f32 v21, v101, v145, v149
    v_fma_f32 v22, v105, v146, v150
    v_fma_f32 v23, v109, v147, v151
    v_mul_f32 v24, v16, v16
    v_mul_f32 v25, v17, v17
    v_mul_f32 v26, v18, v18
    v_mul_f32 v27, v19, v19
    v_mul_f32 v28, v20, v20
    v_mul_f32 v29, v21, v21
    v_mul_f32 v30, v22, v22
    v_mul_f32 v31, v23, v23
    v_fma_f32 v24, v24, s31, v15
    v_fma_f32 v25, v25, s31, v15
    v_fma_f32 v26, v26, s31, v15
    v_fma_f32 v27, v27, s31, v15
    v_fma_f32 v28, v28, s31, v15
    v_fma_f32 v29, v29, s31, v15
    v_fma_f32 v30, v30, s31, v15
    v_fma_f32 v31, v31, s31, v15
    v_mul_f32 v24, v24, v16
    v_mul_f32 v25, v25, v17
    v_mul_f32 v26, v26, v18
    v_mul_f32 v27, v27, v19
    v_mul_f32 v28, v28, v20
    v_mul_f32 v29, v29, v21
    v_mul_f32 v30, v30, v22
    v_mul_f32 v31, v31, v23
    v_exp_f32 v24, v24
    v_exp_f32 v25, v25
    v_exp_f32 v26, v26
    v_exp_f32 v27, v27
    v_exp_f32 v28, v28
    v_exp_f32 v29, v29
    v_exp_f32 v30, v30
    v_exp_f32 v31, v31
    v_add_f32 v24, 1.0, v24
    v_add_f32 v25, 1.0, v25
    v_add_f32 v26, 1.0, v26
    v_add_f32 v27, 1.0, v27
    v_add_f32 v28, 1.0, v28
    v_add_f32 v29, 1.0, v29
    v_add_f32 v30, 1.0, v30
    v_add_f32 v31, 1.0, v31
    v_rcp_f32 v24, v24
    v_rcp_f32 v25, v25
    v_rcp_f32 v26, v26
    v_rcp_f32 v27, v27
    v_rcp_f32 v28, v28
    v_rcp_f32 v29, v29
    v_rcp_f32 v30, v30
    v_rcp_f32 v31, v31
    v_mul_f32 v16, v16, v24
    v_mul_f32 v17, v17, v25
    v_mul_f32 v18, v18, v26
    v_mul_f32 v19, v19, v27
    v_mul_f32 v20, v20, v28
    v_mul_f32 v21, v21, v29
    v_mul_f32 v22, v22, v30
    v_mul_f32 v23, v23, v31
    v_cvt_pk_bf16_f32 v32, v16, v17
    v_cvt_pk_bf16_f32 v33, v18, v19
    buffer_store_dwordx2 v[32:33], v7, s[16:19], s25 offen offset:0 sc1
    v_cvt_pk_bf16_f32 v34, v20, v21
    v_cvt_pk_bf16_f32 v35, v22, v23
    buffer_store_dwordx2 v[34:35], v7, s[16:19], s25 offen offset:1024 sc1
    s_add_u32 s25, s25, 2048
    v_fma_f32 v36, v98, v144, v148
    v_fma_f32 v37, v102, v145, v149
    v_fma_f32 v38, v106, v146, v150
    v_fma_f32 v39, v110, v147, v151
    v_fma_f32 v40, v99, v144, v148
    v_fma_f32 v41, v103, v145, v149
    v_fma_f32 v42, v107, v146, v150
    v_fma_f32 v43, v111, v147, v151
    v_mul_f32 v44, v36, v36
    v_mul_f32 v45, v37, v37
    v_mul_f32 v46, v38, v38
    v_mul_f32 v47, v39, v39
    v_mul_f32 v48, v40, v40
    v_mul_f32 v49, v41, v41
    v_mul_f32 v50, v42, v42
    v_mul_f32 v51, v43, v43
    v_fma_f32 v44, v44, s31, v15
    v_fma_f32 v45, v45, s31, v15
    v_fma_f32 v46, v46, s31, v15
    v_fma_f32 v47, v47, s31, v15
    v_fma_f32 v48, v48, s31, v15
    v_fma_f32 v49, v49, s31, v15
    v_fma_f32 v50, v50, s31, v15
    v_fma_f32 v51, v51, s31, v15
    v_mul_f32 v44, v44, v36
    v_mul_f32 v45, v45, v37
    v_mul_f32 v46, v46, v38
    v_mul_f32 v47, v47, v39
    v_mul_f32 v48, v48, v40
    v_mul_f32 v49, v49, v41
    v_mul_f32 v50, v50, v42
    v_mul_f32 v51, v51, v43
    v_exp_f32 v44, v44
    v_exp_f32 v45, v45
    v_exp_f32 v46, v46
    v_exp_f32 v47, v47
    v_exp_f32 v48, v48
    v_exp_f32 v49, v49
    v_exp_f32 v50, v50
    v_exp_f32 v51, v51
    v_add_f32 v44, 1.0, v44
    v_add_f32 v45, 1.0, v45
    v_add_f32 v46, 1.0, v46
    v_add_f32 v47, 1.0, v47
    v_add_f32 v48, 1.0, v48
    v_add_f32 v49, 1.0, v49
    v_add_f32 v50, 1.0, v50
    v_add_f32 v51, 1.0, v51
    v_rcp_f32 v44, v44
    v_rcp_f32 v45, v45
    v_rcp_f32 v46, v46
    v_rcp_f32 v47, v47
    v_rcp_f32 v48, v48
    v_rcp_f32 v49, v49
    v_rcp_f32 v50, v50
    v_rcp_f32 v51, v51
    v_mul_f32 v36, v36, v44
    v_mul_f32 v37, v37, v45
    v_mul_f32 v38, v38, v46
    v_mul_f32 v39, v39, v47
    v_mul_f32 v40, v40, v48
    v_mul_f32 v41, v41, v49
    v_mul_f32 v42, v42, v50
    v_mul_f32 v43, v43, v51
    v_cvt_pk_bf16_f32 v52, v36, v37
    v_cvt_pk_bf16_f32 v53, v38, v39
    buffer_store_dwordx2 v[52:53], v7, s[16:19], s25 offen offset:0 sc1
    v_cvt_pk_bf16_f32 v54, v40, v41
    v_cvt_pk_bf16_f32 v55, v42, v43
    buffer_store_dwordx2 v[54:55], v7, s[16:19], s25 offen offset:1024 sc1
    s_add_u32 s25, s25, 2048
    s_add_u32 s25, s25, 12288
    v_fma_f32 v16, v112, v144, v148
    v_fma_f32 v17, v116, v145, v149
    v_fma_f32 v18, v120, v146, v150
    v_fma_f32 v19, v124, v147, v151
    v_fma_f32 v20, v113, v144, v148
    v_fma_f32 v21, v117, v145, v149
    v_fma_f32 v22, v121, v146, v150
    v_fma_f32 v23, v125, v147, v151
    v_mul_f32 v24, v16, v16
    v_mul_f32 v25, v17, v17
    v_mul_f32 v26, v18, v18
    v_mul_f32 v27, v19, v19
    v_mul_f32 v28, v20, v20
    v_mul_f32 v29, v21, v21
    v_mul_f32 v30, v22, v22
    v_mul_f32 v31, v23, v23
    v_fma_f32 v24, v24, s31, v15
    v_fma_f32 v25, v25, s31, v15
    v_fma_f32 v26, v26, s31, v15
    v_fma_f32 v27, v27, s31, v15
    v_fma_f32 v28, v28, s31, v15
    v_fma_f32 v29, v29, s31, v15
    v_fma_f32 v30, v30, s31, v15
    v_fma_f32 v31, v31, s31, v15
    v_mul_f32 v24, v24, v16
    v_mul_f32 v25, v25, v17
    v_mul_f32 v26, v26, v18
    v_mul_f32 v27, v27, v19
    v_mul_f32 v28, v28, v20
    v_mul_f32 v29, v29, v21
    v_mul_f32 v30, v30, v22
    v_mul_f32 v31, v31, v23
    v_exp_f32 v24, v24
    v_exp_f32 v25, v25
    v_exp_f32 v26, v26
    v_exp_f32 v27, v27
    v_exp_f32 v28, v28
    v_exp_f32 v29, v29
    v_exp_f32 v30, v30
    v_exp_f32 v31, v31
    v_add_f32 v24, 1.0, v24
    v_add_f32 v25, 1.0, v25
    v_add_f32 v26, 1.0, v26
    v_add_f32 v27, 1.0, v27
    v_add_f32 v28, 1.0, v28
    v_add_f32 v29, 1.0, v29
    v_add_f32 v30, 1.0, v30
    v_add_f32 v31, 1.0, v31
    v_rcp_f32 v24, v24
    v_rcp_f32 v25, v25
    v_rcp_f32 v26, v26
    v_rcp_f32 v27, v27
    v_rcp_f32 v28, v28
    v_rcp_f32 v29, v29
    v_rcp_f32 v30, v30
    v_rcp_f32 v31, v31
    v_mul_f32 v16, v16, v24
    v_mul_f32 v17, v17, v25
    v_mul_f32 v18, v18, v26
    v_mul_f32 v19, v19, v27
    v_mul_f32 v20, v20, v28
    v_mul_f32 v21, v21, v29
    v_mul_f32 v22, v22, v30
    v_mul_f32 v23, v23, v31
    v_cvt_pk_bf16_f32 v32, v16, v17
    v_cvt_pk_bf16_f32 v33, v18, v19
    buffer_store_dwordx2 v[32:33], v7, s[16:19], s25 offen offset:0 sc1
    v_cvt_pk_bf16_f32 v34, v20, v21
    v_cvt_pk_bf16_f32 v35, v22, v23
    buffer_store_dwordx2 v[34:35], v7, s[16:19], s25 offen offset:1024 sc1
    s_add_u32 s25, s25, 2048
    v_fma_f32 v36, v114, v144, v148
    v_fma_f32 v37, v118, v145, v149
    v_fma_f32 v38, v122, v146, v150
    v_fma_f32 v39, v126, v147, v151
    v_fma_f32 v40, v115, v144, v148
    v_fma_f32 v41, v119, v145, v149
    v_fma_f32 v42, v123, v146, v150
    v_fma_f32 v43, v127, v147, v151
    v_mul_f32 v44, v36, v36
    v_mul_f32 v45, v37, v37
    v_mul_f32 v46, v38, v38
    v_mul_f32 v47, v39, v39
    v_mul_f32 v48, v40, v40
    v_mul_f32 v49, v41, v41
    v_mul_f32 v50, v42, v42
    v_mul_f32 v51, v43, v43
    v_fma_f32 v44, v44, s31, v15
    v_fma_f32 v45, v45, s31, v15
    v_fma_f32 v46, v46, s31, v15
    v_fma_f32 v47, v47, s31, v15
    v_fma_f32 v48, v48, s31, v15
    v_fma_f32 v49, v49, s31, v15
    v_fma_f32 v50, v50, s31, v15
    v_fma_f32 v51, v51, s31, v15
    v_mul_f32 v44, v44, v36
    v_mul_f32 v45, v45, v37
    v_mul_f32 v46, v46, v38
    v_mul_f32 v47, v47, v39
    v_mul_f32 v48, v48, v40
    v_mul_f32 v49, v49, v41
    v_mul_f32 v50, v50, v42
    v_mul_f32 v51, v51, v43
    v_exp_f32 v44, v44
    v_exp_f32 v45, v45
    v_exp_f32 v46, v46
    v_exp_f32 v47, v47
    v_exp_f32 v48, v48
    v_exp_f32 v49, v49
    v_exp_f32 v50, v50
    v_exp_f32 v51, v51
    v_add_f32 v44, 1.0, v44
    v_add_f32 v45, 1.0, v45
    v_add_f32 v46, 1.0, v46
    v_add_f32 v47, 1.0, v47
    v_add_f32 v48, 1.0, v48
    v_add_f32 v49, 1.0, v49
    v_add_f32 v50, 1.0, v50
    v_add_f32 v51, 1.0, v51
    v_rcp_f32 v44, v44
    v_rcp_f32 v45, v45
    v_rcp_f32 v46, v46
    v_rcp_f32 v47, v47
    v_rcp_f32 v48, v48
    v_rcp_f32 v49, v49
    v_rcp_f32 v50, v50
    v_rcp_f32 v51, v51
    v_mul_f32 v36, v36, v44
    v_mul_f32 v37, v37, v45
    v_mul_f32 v38, v38, v46
    v_mul_f32 v39, v39, v47
    v_mul_f32 v40, v40, v48
    v_mul_f32 v41, v41, v49
    v_mul_f32 v42, v42, v50
    v_mul_f32 v43, v43, v51
    v_cvt_pk_bf16_f32 v52, v36, v37
    v_cvt_pk_bf16_f32 v53, v38, v39
    buffer_store_dwordx2 v[52:53], v7, s[16:19], s25 offen offset:0 sc1
    v_cvt_pk_bf16_f32 v54, v40, v41
    v_cvt_pk_bf16_f32 v55, v42, v43
    buffer_store_dwordx2 v[54:55], v7, s[16:19], s25 offen offset:1024 sc1
    s_add_u32 s25, s25, 2048
    s_add_u32 s25, s25, 12288
    v_fma_f32 v16, v128, v144, v148
    v_fma_f32 v17, v132, v145, v149
    v_fma_f32 v18, v136, v146, v150
    v_fma_f32 v19, v140, v147, v151
    v_fma_f32 v20, v129, v144, v148
    v_fma_f32 v21, v133, v145, v149
    v_fma_f32 v22, v137, v146, v150
    v_fma_f32 v23, v141, v147, v151
    v_mul_f32 v24, v16, v16
    v_mul_f32 v25, v17, v17
    v_mul_f32 v26, v18, v18
    v_mul_f32 v27, v19, v19
    v_mul_f32 v28, v20, v20
    v_mul_f32 v29, v21, v21
    v_mul_f32 v30, v22, v22
    v_mul_f32 v31, v23, v23
    v_fma_f32 v24, v24, s31, v15
    v_fma_f32 v25, v25, s31, v15
    v_fma_f32 v26, v26, s31, v15
    v_fma_f32 v27, v27, s31, v15
    v_fma_f32 v28, v28, s31, v15
    v_fma_f32 v29, v29, s31, v15
    v_fma_f32 v30, v30, s31, v15
    v_fma_f32 v31, v31, s31, v15
    v_mul_f32 v24, v24, v16
    v_mul_f32 v25, v25, v17
    v_mul_f32 v26, v26, v18
    v_mul_f32 v27, v27, v19
    v_mul_f32 v28, v28, v20
    v_mul_f32 v29, v29, v21
    v_mul_f32 v30, v30, v22
    v_mul_f32 v31, v31, v23
    v_exp_f32 v24, v24
    v_exp_f32 v25, v25
    v_exp_f32 v26, v26
    v_exp_f32 v27, v27
    v_exp_f32 v28, v28
    v_exp_f32 v29, v29
    v_exp_f32 v30, v30
    v_exp_f32 v31, v31
    v_add_f32 v24, 1.0, v24
    v_add_f32 v25, 1.0, v25
    v_add_f32 v26, 1.0, v26
    v_add_f32 v27, 1.0, v27
    v_add_f32 v28, 1.0, v28
    v_add_f32 v29, 1.0, v29
    v_add_f32 v30, 1.0, v30
    v_add_f32 v31, 1.0, v31
    v_rcp_f32 v24, v24
    v_rcp_f32 v25, v25
    v_rcp_f32 v26, v26
    v_rcp_f32 v27, v27
    v_rcp_f32 v28, v28
    v_rcp_f32 v29, v29
    v_rcp_f32 v30, v30
    v_rcp_f32 v31, v31
    v_mul_f32 v16, v16, v24
    v_mul_f32 v17, v17, v25
    v_mul_f32 v18, v18, v26
    v_mul_f32 v19, v19, v27
    v_mul_f32 v20, v20, v28
    v_mul_f32 v21, v21, v29
    v_mul_f32 v22, v22, v30
    v_mul_f32 v23, v23, v31
    v_cvt_pk_bf16_f32 v32, v16, v17
    v_cvt_pk_bf16_f32 v33, v18, v19
    buffer_store_dwordx2 v[32:33], v7, s[16:19], s25 offen offset:0 sc1
    v_cvt_pk_bf16_f32 v34, v20, v21
    v_cvt_pk_bf16_f32 v35, v22, v23
    buffer_store_dwordx2 v[34:35], v7, s[16:19], s25 offen offset:1024 sc1
    s_add_u32 s25, s25, 2048
    v_fma_f32 v36, v130, v144, v148
    v_fma_f32 v37, v134, v145, v149
    v_fma_f32 v38, v138, v146, v150
    v_fma_f32 v39, v142, v147, v151
    v_fma_f32 v40, v131, v144, v148
    v_fma_f32 v41, v135, v145, v149
    v_fma_f32 v42, v139, v146, v150
    v_fma_f32 v43, v143, v147, v151
    v_mul_f32 v44, v36, v36
    v_mul_f32 v45, v37, v37
    v_mul_f32 v46, v38, v38
    v_mul_f32 v47, v39, v39
    v_mul_f32 v48, v40, v40
    v_mul_f32 v49, v41, v41
    v_mul_f32 v50, v42, v42
    v_mul_f32 v51, v43, v43
    v_fma_f32 v44, v44, s31, v15
    v_fma_f32 v45, v45, s31, v15
    v_fma_f32 v46, v46, s31, v15
    v_fma_f32 v47, v47, s31, v15
    v_fma_f32 v48, v48, s31, v15
    v_fma_f32 v49, v49, s31, v15
    v_fma_f32 v50, v50, s31, v15
    v_fma_f32 v51, v51, s31, v15
    v_mul_f32 v44, v44, v36
    v_mul_f32 v45, v45, v37
    v_mul_f32 v46, v46, v38
    v_mul_f32 v47, v47, v39
    v_mul_f32 v48, v48, v40
    v_mul_f32 v49, v49, v41
    v_mul_f32 v50, v50, v42
    v_mul_f32 v51, v51, v43
    v_exp_f32 v44, v44
    v_exp_f32 v45, v45
    v_exp_f32 v46, v46
    v_exp_f32 v47, v47
    v_exp_f32 v48, v48
    v_exp_f32 v49, v49
    v_exp_f32 v50, v50
    v_exp_f32 v51, v51
    v_add_f32 v44, 1.0, v44
    v_add_f32 v45, 1.0, v45
    v_add_f32 v46, 1.0, v46
    v_add_f32 v47, 1.0, v47
    v_add_f32 v48, 1.0, v48
    v_add_f32 v49, 1.0, v49
    v_add_f32 v50, 1.0, v50
    v_add_f32 v51, 1.0, v51
    v_rcp_f32 v44, v44
    v_rcp_f32 v45, v45
    v_rcp_f32 v46, v46
    v_rcp_f32 v47, v47
    v_rcp_f32 v48, v48
    v_rcp_f32 v49, v49
    v_rcp_f32 v50, v50
    v_rcp_f32 v51, v51
    v_mul_f32 v36, v36, v44
    v_mul_f32 v37, v37, v45
    v_mul_f32 v38, v38, v46
    v_mul_f32 v39, v39, v47
    v_mul_f32 v40, v40, v48
    v_mul_f32 v41, v41, v49
    v_mul_f32 v42, v42, v50
    v_mul_f32 v43, v43, v51
    v_cvt_pk_bf16_f32 v52, v36, v37
    v_cvt_pk_bf16_f32 v53, v38, v39
    buffer_store_dwordx2 v[52:53], v7, s[16:19], s25 offen offset:0 sc1
    v_cvt_pk_bf16_f32 v54, v40, v41
    v_cvt_pk_bf16_f32 v55, v42, v43
    buffer_store_dwordx2 v[54:55], v7, s[16:19], s25 offen offset:1024 sc1
    s_add_u32 s25, s25, 2048
    s_add_u32 s25, s25, 12288
K34_END:
    s_endpgm
TEXT_END:
.section .rodata,"a"
.p2align 6
.amdhsa_kernel k1_xform_kernel
  .amdhsa_next_free_vgpr 128
  .amdhsa_next_free_sgpr 96
  .amdhsa_accum_offset 128
  .amdhsa_group_segment_fixed_size 0
  .amdhsa_kernarg_size 56
  .amdhsa_user_sgpr_count 2
  .amdhsa_user_sgpr_kernarg_segment_ptr 1
  .amdhsa_system_sgpr_workgroup_id_x 1
.end_amdhsa_kernel
.p2align 6
.amdhsa_kernel k12_fused_kernel
  .amdhsa_next_free_vgpr 256
  .amdhsa_next_free_sgpr 96
  .amdhsa_accum_offset 256
  .amdhsa_group_segment_fixed_size 0
  .amdhsa_kernarg_size 56
  .amdhsa_user_sgpr_count 2
  .amdhsa_user_sgpr_kernarg_segment_ptr 1
  .amdhsa_system_sgpr_workgroup_id_x 1
.end_amdhsa_kernel
.p2align 6
.amdhsa_kernel k34_out_kernel
  .amdhsa_next_free_vgpr 168
  .amdhsa_next_free_sgpr 96
  .amdhsa_accum_offset 168
  .amdhsa_group_segment_fixed_size 0
  .amdhsa_kernarg_size 56
  .amdhsa_user_sgpr_count 2
  .amdhsa_user_sgpr_kernarg_segment_ptr 1
  .amdhsa_system_sgpr_workgroup_id_x 1
.end_amdhsa_kernel
```

```asm
; @launch kernel=k1_xform_kernel grid=(636,1,1) block=(256,1,1) lds=16384
; @launch kernel=k12_fused_kernel grid=(256,1,1) block=(512,1,1) lds=155872
; @launch kernel=k34_out_kernel grid=(256,1,1) block=(768,1,1) lds=18944
.amdgcn_target "amdgcn-amd-amdhsa--gfx950"
.text
.globl k1_xform_kernel
.globl k12_fused_kernel
.globl k34_out_kernel
.p2align 8
.type k1_xform_kernel,@function
k1_xform_kernel:
    s_cmp_ge_u32 s2, 636
    s_cbranch_scc1 K1_END
    s_load_dwordx4 s[4:7], s[0:1], 0
    s_load_dwordx2 s[8:9], s[0:1], 48
    s_cmp_lt_u32 s2, 8
    s_cbranch_scc0 K1_NOCPF
    s_getpc_b64 s[90:91]
CPF_K1:
    s_sub_u32 s90, s90, CPF_K1-k1_xform_kernel
    s_subb_u32 s91, s91, 0
    v_lshlrev_b32 v8, 7, v0
    v_mov_b32 v11, s91
    v_min_u32 v9, TEXT_END-k1_xform_kernel-4, v8
    v_add_co_u32 v10, vcc, s90, v9
    v_addc_co_u32 v11, vcc, 0, v11, vcc
    global_load_dword v63, v[10:11], off
    v_mov_b32 v11, s91
    v_add_u32 v8, 32768, v8
    v_min_u32 v9, TEXT_END-k1_xform_kernel-4, v8
    v_add_co_u32 v10, vcc, s90, v9
    v_addc_co_u32 v11, vcc, 0, v11, vcc
    global_load_dword v63, v[10:11], off
K1_NOCPF:
    v_lshrrev_b32 v120, 6, v0
    v_and_b32 v121, 63, v0
    v_readfirstlane_b32 s3, v120
    v_and_b32 v122, 15, v121
    v_lshrrev_b32 v123, 4, v121
    s_mov_b32 s28, 0x05040100
    s_mov_b32 s29, 0x07060302
    v_and_b32 v124, 3, v122
    v_lshlrev_b32 v124, 2, v124
    v_lshrrev_b32 v125, 3, v122
    v_lshl_add_u32 v124, v125, 1, v124
    s_lshl_b32 s10, s3, 4
    s_add_u32 s10, s10, 1
    v_add_u32 v124, s10, v124
    v_bfe_u32 v125, v122, 2, 1
    v_lshlrev_b32 v121, 4, v121
    s_waitcnt lgkmcnt(0)
    s_or_b32 s10, s2, s3
    s_cmp_eq_u32 s10, 0
    s_cbranch_scc0 K1_NOCLR
    s_add_u32 s12, s8, 153092096
    s_addc_u32 s13, s9, 0
    s_and_b32 s13, s13, 0xffff
    s_mov_b32 s14, 32768
    s_mov_b32 s15, 0x00020000
    v_lshrrev_b32 v118, 4, v121
    v_lshlrev_b32 v119, 10, v118
    v_mov_b32 v117, 0
    s_mov_b64 exec, 0xffff
    buffer_store_dword v117, v119, s[12:15], 0 offen
    v_lshlrev_b32 v119, 4, v118
    v_add_u32 v119, 16384, v119
    buffer_store_dword v117, v119, s[12:15], 0 offen
    s_mov_b64 exec, -1
K1_NOCLR:
    s_cmp_lt_u32 s2, 32
    s_cbranch_scc0 K1_NOFILL
    s_add_u32 s12, s8, 153616384
    s_addc_u32 s13, s9, 0
    s_and_b32 s13, s13, 0xffff
    s_mov_b32 s14, 131072
    s_mov_b32 s15, 0x00020000
    s_lshl_b32 s10, s2, 2
    s_add_u32 s10, s10, s3
    s_lshl_b32 s10, s10, 10
    v_mov_b32 v112, -1
    v_mov_b32 v113, -1
    v_mov_b32 v114, -1
    v_mov_b32 v115, -1
    buffer_store_dwordx4 v[112:115], v121, s[12:15], s10 offen
K1_NOFILL:
    s_add_u32 s10, s2, 384
    s_sub_u32 s11, s2, 252
    s_cmp_lt_u32 s2, 252
    s_cselect_b32 s2, s10, s11
    s_cmp_lt_u32 s2, 384
    s_cbranch_scc1 K1_W
    s_sub_u32 s11, s2, 384
    s_mul_hi_u32 s13, s11, 1431655766
    s_mul_i32 s12, s13, 3
    s_sub_u32 s12, s11, s12
    s_mov_b32 s11, s13
    s_cmp_ge_u32 s11, 42
    s_cselect_b32 s13, 1, 0
    s_mul_i32 s14, s13, 42
    s_sub_u32 s11, s11, s14
    s_lshl_b32 s11, s11, 2
    s_add_u32 s11, s11, s3
    s_mul_i32 s14, s13, 16384000
    s_add_u32 s16, s4, s14
    s_addc_u32 s17, s5, 0
    s_and_b32 s17, s17, 0xffff
    s_mov_b32 s18, 16384000
    s_mov_b32 s19, 0x00020000
    s_mov_b32 s20, s8
    s_mov_b32 s21, s9
    s_and_b32 s21, s21, 0xffff
    s_mov_b32 s22, 43778048
    s_mov_b32 s23, 0x00020000
    v_lshlrev_b32 v126, 14, v123
    v_lshl_add_u32 v126, v122, 4, v126
    s_mul_i32 s15, s11, 98304
    s_lshl_b32 s24, s12, 8
    s_add_u32 s15, s15, s24
    buffer_load_dwordx4 v[0:3], v126, s[16:19], s15 offen
    buffer_load_dwordx4 v[4:7], v126, s[16:19], s15 offen offset:2048
    s_add_u32 s15, s15, 4096
    buffer_load_dwordx4 v[8:11], v126, s[16:19], s15 offen
    buffer_load_dwordx4 v[12:15], v126, s[16:19], s15 offen offset:2048
    s_add_u32 s15, s15, 4096
    buffer_load_dwordx4 v[16:19], v126, s[16:19], s15 offen
    buffer_load_dwordx4 v[20:23], v126, s[16:19], s15 offen offset:2048
    s_add_u32 s15, s15, 4096
    buffer_load_dwordx4 v[24:27], v126, s[16:19], s15 offen
    buffer_load_dwordx4 v[28:31], v126, s[16:19], s15 offen offset:2048
    s_add_u32 s15, s15, 53248
    buffer_load_dwordx4 v[32:35], v126, s[16:19], s15 offen
    buffer_load_dwordx4 v[36:39], v126, s[16:19], s15 offen offset:2048
    s_add_u32 s15, s15, 4096
    buffer_load_dwordx4 v[40:43], v126, s[16:19], s15 offen
    buffer_load_dwordx4 v[44:47], v126, s[16:19], s15 offen offset:2048
    s_add_u32 s15, s15, 4096
    buffer_load_dwordx4 v[48:51], v126, s[16:19], s15 offen
    buffer_load_dwordx4 v[52:55], v126, s[16:19], s15 offen offset:2048
    s_add_u32 s15, s15, 4096
    buffer_load_dwordx4 v[56:59], v126, s[16:19], s15 offen
    buffer_load_dwordx4 v[60:63], v126, s[16:19], s15 offen offset:2048
    v_lshlrev_b32 v127, 3, v123
    v_lshlrev_b32 v112, 5, v125
    v_mad_u32_u24 v113, v124, v127, v112
    v_mad_u32_u24 v64, v124, 0, v113
    v_mad_u32_u24 v65, v124, 1, v113
    v_mad_u32_u24 v66, v124, 2, v113
    v_mad_u32_u24 v67, v124, 3, v113
    v_mad_u32_u24 v68, v124, 4, v113
    v_mad_u32_u24 v69, v124, 5, v113
    v_mad_u32_u24 v70, v124, 6, v113
    v_mad_u32_u24 v71, v124, 7, v113
    v_and_b32 v64, 127, v64
    v_and_b32 v65, 127, v65
    v_and_b32 v66, 127, v66
    v_and_b32 v67, 127, v67
    v_and_b32 v68, 127, v68
    v_and_b32 v69, 127, v69
    v_and_b32 v70, 127, v70
    v_and_b32 v71, 127, v71
    v_cvt_f32_u32 v64, v64
    v_cvt_f32_u32 v65, v65
    v_cvt_f32_u32 v66, v66
    v_cvt_f32_u32 v67, v67
    v_cvt_f32_u32 v68, v68
    v_cvt_f32_u32 v69, v69
    v_cvt_f32_u32 v70, v70
    v_cvt_f32_u32 v71, v71
    v_mul_f32 v64, 0x3c000000, v64
    v_mul_f32 v65, 0x3c000000, v65
    v_mul_f32 v66, 0x3c000000, v66
    v_mul_f32 v67, 0x3c000000, v67
    v_mul_f32 v68, 0x3c000000, v68
    v_mul_f32 v69, 0x3c000000, v69
    v_mul_f32 v70, 0x3c000000, v70
    v_mul_f32 v71, 0x3c000000, v71
    v_cos_f32 v64, v64
    v_cos_f32 v65, v65
    v_cos_f32 v66, v66
    v_cos_f32 v67, v67
    v_cos_f32 v68, v68
    v_cos_f32 v69, v69
    v_cos_f32 v70, v70
    v_cos_f32 v71, v71
    s_nop 0
    v_cvt_pk_bf16_f32 v72, v64, v65
    v_cvt_pk_bf16_f32 v73, v66, v67
    v_cvt_pk_bf16_f32 v74, v68, v69
    v_cvt_pk_bf16_f32 v75, v70, v71
    v_lshlrev_b32 v80, 16, v72
    v_and_b32 v81, 0xffff0000, v72
    v_sub_f32 v64, v64, v80
    v_sub_f32 v65, v65, v81
    v_lshlrev_b32 v80, 16, v73
    v_and_b32 v81, 0xffff0000, v73
    v_sub_f32 v66, v66, v80
    v_sub_f32 v67, v67, v81
    v_lshlrev_b32 v80, 16, v74
    v_and_b32 v81, 0xffff0000, v74
    v_sub_f32 v68, v68, v80
    v_sub_f32 v69, v69, v81
    v_lshlrev_b32 v80, 16, v75
    v_and_b32 v81, 0xffff0000, v75
    v_sub_f32 v70, v70, v80
    v_sub_f32 v71, v71, v81
    v_cvt_pk_bf16_f32 v76, v64, v65
    v_cvt_pk_bf16_f32 v77, v66, v67
    v_cvt_pk_bf16_f32 v78, v68, v69
    v_cvt_pk_bf16_f32 v79, v70, v71
    s_lshl_b32 s24, s3, 12
    v_add_u32 v114, s24, v121
    ds_write_b128 v114, v[72:75] offset:0
    ds_write_b128 v114, v[76:79] offset:1024
    v_add_u32 v127, 32, v127
    v_lshlrev_b32 v112, 5, v125
    v_mad_u32_u24 v113, v124, v127, v112
    v_mad_u32_u24 v64, v124, 0, v113
    v_mad_u32_u24 v65, v124, 1, v113
    v_mad_u32_u24 v66, v124, 2, v113
    v_mad_u32_u24 v67, v124, 3, v113
    v_mad_u32_u24 v68, v124, 4, v113
    v_mad_u32_u24 v69, v124, 5, v113
    v_mad_u32_u24 v70, v124, 6, v113
    v_mad_u32_u24 v71, v124, 7, v113
    v_and_b32 v64, 127, v64
    v_and_b32 v65, 127, v65
    v_and_b32 v66, 127, v66
    v_and_b32 v67, 127, v67
    v_and_b32 v68, 127, v68
    v_and_b32 v69, 127, v69
    v_and_b32 v70, 127, v70
    v_and_b32 v71, 127, v71
    v_cvt_f32_u32 v64, v64
    v_cvt_f32_u32 v65, v65
    v_cvt_f32_u32 v66, v66
    v_cvt_f32_u32 v67, v67
    v_cvt_f32_u32 v68, v68
    v_cvt_f32_u32 v69, v69
    v_cvt_f32_u32 v70, v70
    v_cvt_f32_u32 v71, v71
    v_mul_f32 v64, 0x3c000000, v64
    v_mul_f32 v65, 0x3c000000, v65
    v_mul_f32 v66, 0x3c000000, v66
    v_mul_f32 v67, 0x3c000000, v67
    v_mul_f32 v68, 0x3c000000, v68
    v_mul_f32 v69, 0x3c000000, v69
    v_mul_f32 v70, 0x3c000000, v70
    v_mul_f32 v71, 0x3c000000, v71
    v_cos_f32 v64, v64
    v_cos_f32 v65, v65
    v_cos_f32 v66, v66
    v_cos_f32 v67, v67
    v_cos_f32 v68, v68
    v_cos_f32 v69, v69
    v_cos_f32 v70, v70
    v_cos_f32 v71, v71
    s_nop 0
    v_cvt_pk_bf16_f32 v72, v64, v65
    v_cvt_pk_bf16_f32 v73, v66, v67
    v_cvt_pk_bf16_f32 v74, v68, v69
    v_cvt_pk_bf16_f32 v75, v70, v71
    v_lshlrev_b32 v80, 16, v72
    v_and_b32 v81, 0xffff0000, v72
    v_sub_f32 v64, v64, v80
    v_sub_f32 v65, v65, v81
    v_lshlrev_b32 v80, 16, v73
    v_and_b32 v81, 0xffff0000, v73
    v_sub_f32 v66, v66, v80
    v_sub_f32 v67, v67, v81
    v_lshlrev_b32 v80, 16, v74
    v_and_b32 v81, 0xffff0000, v74
    v_sub_f32 v68, v68, v80
    v_sub_f32 v69, v69, v81
    v_lshlrev_b32 v80, 16, v75
    v_and_b32 v81, 0xffff0000, v75
    v_sub_f32 v70, v70, v80
    v_sub_f32 v71, v71, v81
    v_cvt_pk_bf16_f32 v76, v64, v65
    v_cvt_pk_bf16_f32 v77, v66, v67
    v_cvt_pk_bf16_f32 v78, v68, v69
    v_cvt_pk_bf16_f32 v79, v70, v71
    s_lshl_b32 s24, s3, 12
    v_add_u32 v114, s24, v121
    ds_write_b128 v114, v[72:75] offset:2048
    ds_write_b128 v114, v[76:79] offset:3072
    v_lshrrev_b32 v112, 1, v123
    s_mov_b32 s24, 1368064
    v_mul_lo_u32 v112, v112, s24
    v_lshrrev_b32 v113, 2, v122
    s_mov_b32 s24, 21376
    v_mul_lo_u32 v113, v113, s24
    v_add_u32 v112, v112, v113
    v_and_b32 v113, 3, v122
    v_and_b32 v114, 1, v123
    v_lshl_add_u32 v113, v114, 2, v113
    s_add_u32 s24, s11, 7
    s_cmp_ge_u32 s11, 160
    s_cselect_b32 s24, s24, s11
    s_cmp_eq_u32 s13, 1
    s_cselect_b32 s24, s24, s11
    s_lshr_b32 s24, s24, 1
    s_and_b32 s24, s24, 7
    v_xor_b32 v113, s24, v113
    v_lshl_add_u32 v120, v113, 4, v112
    s_mul_i32 s25, s13, 684032
    s_mul_i32 s24, s12, 85504
    s_add_u32 s25, s25, s24
    s_lshl_b32 s24, s11, 7
    s_add_u32 s25, s25, s24
    s_waitcnt lgkmcnt(0)
    s_barrier
    s_cmp_ge_u32 s11, 167
    s_cbranch_scc1 K1_END
    s_waitcnt vmcnt(8)
    v_perm_b32 v64, v4, v0, s28
    v_perm_b32 v68, v4, v0, s29
    v_perm_b32 v65, v12, v8, s28
    v_perm_b32 v69, v12, v8, s29
    v_perm_b32 v66, v20, v16, s28
    v_perm_b32 v70, v20, v16, s29
    v_perm_b32 v67, v28, v24, s28
    v_perm_b32 v71, v28, v24, s29
    v_perm_b32 v72, v5, v1, s28
    v_perm_b32 v76, v5, v1, s29
    v_perm_b32 v73, v13, v9, s28
    v_perm_b32 v77, v13, v9, s29
    v_perm_b32 v74, v21, v17, s28
    v_perm_b32 v78, v21, v17, s29
    v_perm_b32 v75, v29, v25, s28
    v_perm_b32 v79, v29, v25, s29
    v_perm_b32 v80, v6, v2, s28
    v_perm_b32 v84, v6, v2, s29
    v_perm_b32 v81, v14, v10, s28
    v_perm_b32 v85, v14, v10, s29
    v_perm_b32 v82, v22, v18, s28
    v_perm_b32 v86, v22, v18, s29
    v_perm_b32 v83, v30, v26, s28
    v_perm_b32 v87, v30, v26, s29
    v_perm_b32 v88, v7, v3, s28
    v_perm_b32 v92, v7, v3, s29
    v_perm_b32 v89, v15, v11, s28
    v_perm_b32 v93, v15, v11, s29
    v_perm_b32 v90, v23, v19, s28
    v_perm_b32 v94, v23, v19, s29
    v_perm_b32 v91, v31, v27, s28
    v_perm_b32 v95, v31, v27, s29
    s_waitcnt vmcnt(0)
    v_perm_b32 v0, v36, v32, s28
    v_perm_b32 v4, v36, v32, s29
    v_perm_b32 v1, v44, v40, s28
    v_perm_b32 v5, v44, v40, s29
    v_perm_b32 v2, v52, v48, s28
    v_perm_b32 v6, v52, v48, s29
    v_perm_b32 v3, v60, v56, s28
    v_perm_b32 v7, v60, v56, s29
    v_perm_b32 v8, v37, v33, s28
    v_perm_b32 v12, v37, v33, s29
    v_perm_b32 v9, v45, v41, s28
    v_perm_b32 v13, v45, v41, s29
    v_perm_b32 v10, v53, v49, s28
    v_perm_b32 v14, v53, v49, s29
    v_perm_b32 v11, v61, v57, s28
    v_perm_b32 v15, v61, v57, s29
    v_perm_b32 v16, v38, v34, s28
    v_perm_b32 v20, v38, v34, s29
    v_perm_b32 v17, v46, v42, s28
    v_perm_b32 v21, v46, v42, s29
    v_perm_b32 v18, v54, v50, s28
    v_perm_b32 v22, v54, v50, s29
    v_perm_b32 v19, v62, v58, s28
    v_perm_b32 v23, v62, v58, s29
    v_perm_b32 v24, v39, v35, s28
    v_perm_b32 v28, v39, v35, s29
    v_perm_b32 v25, v47, v43, s28
    v_perm_b32 v29, v47, v43, s29
    v_perm_b32 v26, v55, v51, s28
    v_perm_b32 v30, v55, v51, s29
    v_perm_b32 v27, v63, v59, s28
    v_perm_b32 v31, v63, v59, s29
    ds_read_b128 v[96:99], v121 offset:0
    ds_read_b128 v[100:103], v121 offset:1024
    ds_read_b128 v[104:107], v121 offset:2048
    ds_read_b128 v[108:111], v121 offset:3072
    s_waitcnt lgkmcnt(3)
    v_mfma_f32_16x16x32_bf16 v[32:35], v[96:99], v[64:67], 0
    v_mfma_f32_16x16x32_bf16 v[36:39], v[96:99], v[68:71], 0
    v_mfma_f32_16x16x32_bf16 v[40:43], v[96:99], v[72:75], 0
    v_mfma_f32_16x16x32_bf16 v[44:47], v[96:99], v[76:79], 0
    v_mfma_f32_16x16x32_bf16 v[48:51], v[96:99], v[80:83], 0
    v_mfma_f32_16x16x32_bf16 v[52:55], v[96:99], v[84:87], 0
    v_mfma_f32_16x16x32_bf16 v[56:59], v[96:99], v[88:91], 0
    v_mfma_f32_16x16x32_bf16 v[60:63], v[96:99], v[92:95], 0
    s_waitcnt lgkmcnt(2)
    v_mfma_f32_16x16x32_bf16 v[32:35], v[100:103], v[64:67], v[32:35]
    v_mfma_f32_16x16x32_bf16 v[36:39], v[100:103], v[68:71], v[36:39]
    v_mfma_f32_16x16x32_bf16 v[40:43], v[100:103], v[72:75], v[40:43]
    v_mfma_f32_16x16x32_bf16 v[44:47], v[100:103], v[76:79], v[44:47]
    v_mfma_f32_16x16x32_bf16 v[48:51], v[100:103], v[80:83], v[48:51]
    v_mfma_f32_16x16x32_bf16 v[52:55], v[100:103], v[84:87], v[52:55]
    v_mfma_f32_16x16x32_bf16 v[56:59], v[100:103], v[88:91], v[56:59]
    v_mfma_f32_16x16x32_bf16 v[60:63], v[100:103], v[92:95], v[60:63]
    s_waitcnt lgkmcnt(1)
    v_mfma_f32_16x16x32_bf16 v[32:35], v[104:107], v[0:3], v[32:35]
    v_mfma_f32_16x16x32_bf16 v[36:39], v[104:107], v[4:7], v[36:39]
    v_mfma_f32_16x16x32_bf16 v[40:43], v[104:107], v[8:11], v[40:43]
    v_mfma_f32_16x16x32_bf16 v[44:47], v[104:107], v[12:15], v[44:47]
    v_mfma_f32_16x16x32_bf16 v[48:51], v[104:107], v[16:19], v[48:51]
    v_mfma_f32_16x16x32_bf16 v[52:55], v[104:107], v[20:23], v[52:55]
    v_mfma_f32_16x16x32_bf16 v[56:59], v[104:107], v[24:27], v[56:59]
    v_mfma_f32_16x16x32_bf16 v[60:63], v[104:107], v[28:31], v[60:63]
    s_waitcnt lgkmcnt(0)
    v_mfma_f32_16x16x32_bf16 v[32:35], v[108:111], v[0:3], v[32:35]
    v_mfma_f32_16x16x32_bf16 v[36:39], v[108:111], v[4:7], v[36:39]
    v_mfma_f32_16x16x32_bf16 v[40:43], v[108:111], v[8:11], v[40:43]
    v_mfma_f32_16x16x32_bf16 v[44:47], v[108:111], v[12:15], v[44:47]
    v_mfma_f32_16x16x32_bf16 v[48:51], v[108:111], v[16:19], v[48:51]
    v_mfma_f32_16x16x32_bf16 v[52:55], v[108:111], v[20:23], v[52:55]
    v_mfma_f32_16x16x32_bf16 v[56:59], v[108:111], v[24:27], v[56:59]
    v_mfma_f32_16x16x32_bf16 v[60:63], v[108:111], v[28:31], v[60:63]
    s_nop 7
    v_cvt_pk_bf16_f32 v112, v32, v36
    v_cvt_pk_bf16_f32 v113, v40, v44
    v_cvt_pk_bf16_f32 v114, v48, v52
    v_cvt_pk_bf16_f32 v115, v56, v60
    buffer_store_dwordx4 v[112:115], v120, s[20:23], s25 offen
    s_add_u32 s25, s25, 2736128
    v_cvt_pk_bf16_f32 v116, v33, v37
    v_cvt_pk_bf16_f32 v117, v41, v45
    v_cvt_pk_bf16_f32 v118, v49, v53
    v_cvt_pk_bf16_f32 v119, v57, v61
    buffer_store_dwordx4 v[116:119], v120, s[20:23], s25 offen
    s_add_u32 s25, s25, 2736128
    v_cvt_pk_bf16_f32 v112, v34, v38
    v_cvt_pk_bf16_f32 v113, v42, v46
    v_cvt_pk_bf16_f32 v114, v50, v54
    v_cvt_pk_bf16_f32 v115, v58, v62
    buffer_store_dwordx4 v[112:115], v120, s[20:23], s25 offen
    s_add_u32 s25, s25, 2736128
    v_cvt_pk_bf16_f32 v116, v35, v39
    v_cvt_pk_bf16_f32 v117, v43, v47
    v_cvt_pk_bf16_f32 v118, v51, v55
    v_cvt_pk_bf16_f32 v119, v59, v63
    buffer_store_dwordx4 v[116:119], v120, s[20:23], s25 offen
    s_add_u32 s25, s25, 2736128
    ds_read_b128 v[96:99], v121 offset:4096
    ds_read_b128 v[100:103], v121 offset:5120
    ds_read_b128 v[104:107], v121 offset:6144
    ds_read_b128 v[108:111], v121 offset:7168
    s_waitcnt lgkmcnt(3)
    v_mfma_f32_16x16x32_bf16 v[32:35], v[96:99], v[64:67], 0
    v_mfma_f32_16x16x32_bf16 v[36:39], v[96:99], v[68:71], 0
    v_mfma_f32_16x16x32_bf16 v[40:43], v[96:99], v[72:75], 0
    v_mfma_f32_16x16x32_bf16 v[44:47], v[96:99], v[76:79], 0
    v_mfma_f32_16x16x32_bf16 v[48:51], v[96:99], v[80:83], 0
    v_mfma_f32_16x16x32_bf16 v[52:55], v[96:99], v[84:87], 0
    v_mfma_f32_16x16x32_bf16 v[56:59], v[96:99], v[88:91], 0
    v_mfma_f32_16x16x32_bf16 v[60:63], v[96:99], v[92:95], 0
    s_waitcnt lgkmcnt(2)
    v_mfma_f32_16x16x32_bf16 v[32:35], v[100:103], v[64:67], v[32:35]
    v_mfma_f32_16x16x32_bf16 v[36:39], v[100:103], v[68:71], v[36:39]
    v_mfma_f32_16x16x32_bf16 v[40:43], v[100:103], v[72:75], v[40:43]
    v_mfma_f32_16x16x32_bf16 v[44:47], v[100:103], v[76:79], v[44:47]
    v_mfma_f32_16x16x32_bf16 v[48:51], v[100:103], v[80:83], v[48:51]
    v_mfma_f32_16x16x32_bf16 v[52:55], v[100:103], v[84:87], v[52:55]
    v_mfma_f32_16x16x32_bf16 v[56:59], v[100:103], v[88:91], v[56:59]
    v_mfma_f32_16x16x32_bf16 v[60:63], v[100:103], v[92:95], v[60:63]
    s_waitcnt lgkmcnt(1)
    v_mfma_f32_16x16x32_bf16 v[32:35], v[104:107], v[0:3], v[32:35]
    v_mfma_f32_16x16x32_bf16 v[36:39], v[104:107], v[4:7], v[36:39]
    v_mfma_f32_16x16x32_bf16 v[40:43], v[104:107], v[8:11], v[40:43]
    v_mfma_f32_16x16x32_bf16 v[44:47], v[104:107], v[12:15], v[44:47]
    v_mfma_f32_16x16x32_bf16 v[48:51], v[104:107], v[16:19], v[48:51]
    v_mfma_f32_16x16x32_bf16 v[52:55], v[104:107], v[20:23], v[52:55]
    v_mfma_f32_16x16x32_bf16 v[56:59], v[104:107], v[24:27], v[56:59]
    v_mfma_f32_16x16x32_bf16 v[60:63], v[104:107], v[28:31], v[60:63]
    s_waitcnt lgkmcnt(0)
    v_mfma_f32_16x16x32_bf16 v[32:35], v[108:111], v[0:3], v[32:35]
    v_mfma_f32_16x16x32_bf16 v[36:39], v[108:111], v[4:7], v[36:39]
    v_mfma_f32_16x16x32_bf16 v[40:43], v[108:111], v[8:11], v[40:43]
    v_mfma_f32_16x16x32_bf16 v[44:47], v[108:111], v[12:15], v[44:47]
    v_mfma_f32_16x16x32_bf16 v[48:51], v[108:111], v[16:19], v[48:51]
    v_mfma_f32_16x16x32_bf16 v[52:55], v[108:111], v[20:23], v[52:55]
    v_mfma_f32_16x16x32_bf16 v[56:59], v[108:111], v[24:27], v[56:59]
    v_mfma_f32_16x16x32_bf16 v[60:63], v[108:111], v[28:31], v[60:63]
    s_nop 7
    v_cvt_pk_bf16_f32 v112, v32, v36
    v_cvt_pk_bf16_f32 v113, v40, v44
    v_cvt_pk_bf16_f32 v114, v48, v52
    v_cvt_pk_bf16_f32 v115, v56, v60
    buffer_store_dwordx4 v[112:115], v120, s[20:23], s25 offen
    s_add_u32 s25, s25, 2736128
    v_cvt_pk_bf16_f32 v116, v33, v37
    v_cvt_pk_bf16_f32 v117, v41, v45
    v_cvt_pk_bf16_f32 v118, v49, v53
    v_cvt_pk_bf16_f32 v119, v57, v61
    buffer_store_dwordx4 v[116:119], v120, s[20:23], s25 offen
    s_add_u32 s25, s25, 2736128
    v_cvt_pk_bf16_f32 v112, v34, v38
    v_cvt_pk_bf16_f32 v113, v42, v46
    v_cvt_pk_bf16_f32 v114, v50, v54
    v_cvt_pk_bf16_f32 v115, v58, v62
    buffer_store_dwordx4 v[112:115], v120, s[20:23], s25 offen
    s_add_u32 s25, s25, 2736128
    v_cvt_pk_bf16_f32 v116, v35, v39
    v_cvt_pk_bf16_f32 v117, v43, v47
    v_cvt_pk_bf16_f32 v118, v51, v55
    v_cvt_pk_bf16_f32 v119, v59, v63
    buffer_store_dwordx4 v[116:119], v120, s[20:23], s25 offen
    s_add_u32 s25, s25, 2736128
    ds_read_b128 v[96:99], v121 offset:8192
    ds_read_b128 v[100:103], v121 offset:9216
    ds_read_b128 v[104:107], v121 offset:10240
    ds_read_b128 v[108:111], v121 offset:11264
    s_waitcnt lgkmcnt(3)
    v_mfma_f32_16x16x32_bf16 v[32:35], v[96:99], v[64:67], 0
    v_mfma_f32_16x16x32_bf16 v[36:39], v[96:99], v[68:71], 0
    v_mfma_f32_16x16x32_bf16 v[40:43], v[96:99], v[72:75], 0
    v_mfma_f32_16x16x32_bf16 v[44:47], v[96:99], v[76:79], 0
    v_mfma_f32_16x16x32_bf16 v[48:51], v[96:99], v[80:83], 0
    v_mfma_f32_16x16x32_bf16 v[52:55], v[96:99], v[84:87], 0
    v_mfma_f32_16x16x32_bf16 v[56:59], v[96:99], v[88:91], 0
    v_mfma_f32_16x16x32_bf16 v[60:63], v[96:99], v[92:95], 0
    s_waitcnt lgkmcnt(2)
    v_mfma_f32_16x16x32_bf16 v[32:35], v[100:103], v[64:67], v[32:35]
    v_mfma_f32_16x16x32_bf16 v[36:39], v[100:103], v[68:71], v[36:39]
    v_mfma_f32_16x16x32_bf16 v[40:43], v[100:103], v[72:75], v[40:43]
    v_mfma_f32_16x16x32_bf16 v[44:47], v[100:103], v[76:79], v[44:47]
    v_mfma_f32_16x16x32_bf16 v[48:51], v[100:103], v[80:83], v[48:51]
    v_mfma_f32_16x16x32_bf16 v[52:55], v[100:103], v[84:87], v[52:55]
    v_mfma_f32_16x16x32_bf16 v[56:59], v[100:103], v[88:91], v[56:59]
    v_mfma_f32_16x16x32_bf16 v[60:63], v[100:103], v[92:95], v[60:63]
    s_waitcnt lgkmcnt(1)
    v_mfma_f32_16x16x32_bf16 v[32:35], v[104:107], v[0:3], v[32:35]
    v_mfma_f32_16x16x32_bf16 v[36:39], v[104:107], v[4:7], v[36:39]
    v_mfma_f32_16x16x32_bf16 v[40:43], v[104:107], v[8:11], v[40:43]
    v_mfma_f32_16x16x32_bf16 v[44:47], v[104:107], v[12:15], v[44:47]
    v_mfma_f32_16x16x32_bf16 v[48:51], v[104:107], v[16:19], v[48:51]
    v_mfma_f32_16x16x32_bf16 v[52:55], v[104:107], v[20:23], v[52:55]
    v_mfma_f32_16x16x32_bf16 v[56:59], v[104:107], v[24:27], v[56:59]
    v_mfma_f32_16x16x32_bf16 v[60:63], v[104:107], v[28:31], v[60:63]
    s_waitcnt lgkmcnt(0)
    v_mfma_f32_16x16x32_bf16 v[32:35], v[108:111], v[0:3], v[32:35]
    v_mfma_f32_16x16x32_bf16 v[36:39], v[108:111], v[4:7], v[36:39]
    v_mfma_f32_16x16x32_bf16 v[40:43], v[108:111], v[8:11], v[40:43]
    v_mfma_f32_16x16x32_bf16 v[44:47], v[108:111], v[12:15], v[44:47]
    v_mfma_f32_16x16x32_bf16 v[48:51], v[108:111], v[16:19], v[48:51]
    v_mfma_f32_16x16x32_bf16 v[52:55], v[108:111], v[20:23], v[52:55]
    v_mfma_f32_16x16x32_bf16 v[56:59], v[108:111], v[24:27], v[56:59]
    v_mfma_f32_16x16x32_bf16 v[60:63], v[108:111], v[28:31], v[60:63]
    s_nop 7
    v_cvt_pk_bf16_f32 v112, v32, v36
    v_cvt_pk_bf16_f32 v113, v40, v44
    v_cvt_pk_bf16_f32 v114, v48, v52
    v_cvt_pk_bf16_f32 v115, v56, v60
    buffer_store_dwordx4 v[112:115], v120, s[20:23], s25 offen
    s_add_u32 s25, s25, 2736128
    v_cvt_pk_bf16_f32 v116, v33, v37
    v_cvt_pk_bf16_f32 v117, v41, v45
    v_cvt_pk_bf16_f32 v118, v49, v53
    v_cvt_pk_bf16_f32 v119, v57, v61
    buffer_store_dwordx4 v[116:119], v120, s[20:23], s25 offen
    s_add_u32 s25, s25, 2736128
    v_cvt_pk_bf16_f32 v112, v34, v38
    v_cvt_pk_bf16_f32 v113, v42, v46
    v_cvt_pk_bf16_f32 v114, v50, v54
    v_cvt_pk_bf16_f32 v115, v58, v62
    buffer_store_dwordx4 v[112:115], v120, s[20:23], s25 offen
    s_add_u32 s25, s25, 2736128
    v_cvt_pk_bf16_f32 v116, v35, v39
    v_cvt_pk_bf16_f32 v117, v43, v47
    v_cvt_pk_bf16_f32 v118, v51, v55
    v_cvt_pk_bf16_f32 v119, v59, v63
    buffer_store_dwordx4 v[116:119], v120, s[20:23], s25 offen
    s_add_u32 s25, s25, 2736128
    ds_read_b128 v[96:99], v121 offset:12288
    ds_read_b128 v[100:103], v121 offset:13312
    ds_read_b128 v[104:107], v121 offset:14336
    ds_read_b128 v[108:111], v121 offset:15360
    s_waitcnt lgkmcnt(3)
    v_mfma_f32_16x16x32_bf16 v[32:35], v[96:99], v[64:67], 0
    v_mfma_f32_16x16x32_bf16 v[36:39], v[96:99], v[68:71], 0
    v_mfma_f32_16x16x32_bf16 v[40:43], v[96:99], v[72:75], 0
    v_mfma_f32_16x16x32_bf16 v[44:47], v[96:99], v[76:79], 0
    v_mfma_f32_16x16x32_bf16 v[48:51], v[96:99], v[80:83], 0
    v_mfma_f32_16x16x32_bf16 v[52:55], v[96:99], v[84:87], 0
    v_mfma_f32_16x16x32_bf16 v[56:59], v[96:99], v[88:91], 0
    v_mfma_f32_16x16x32_bf16 v[60:63], v[96:99], v[92:95], 0
    s_waitcnt lgkmcnt(2)
    v_mfma_f32_16x16x32_bf16 v[32:35], v[100:103], v[64:67], v[32:35]
    v_mfma_f32_16x16x32_bf16 v[36:39], v[100:103], v[68:71], v[36:39]
    v_mfma_f32_16x16x32_bf16 v[40:43], v[100:103], v[72:75], v[40:43]
    v_mfma_f32_16x16x32_bf16 v[44:47], v[100:103], v[76:79], v[44:47]
    v_mfma_f32_16x16x32_bf16 v[48:51], v[100:103], v[80:83], v[48:51]
    v_mfma_f32_16x16x32_bf16 v[52:55], v[100:103], v[84:87], v[52:55]
    v_mfma_f32_16x16x32_bf16 v[56:59], v[100:103], v[88:91], v[56:59]
    v_mfma_f32_16x16x32_bf16 v[60:63], v[100:103], v[92:95], v[60:63]
    s_waitcnt lgkmcnt(1)
    v_mfma_f32_16x16x32_bf16 v[32:35], v[104:107], v[0:3], v[32:35]
    v_mfma_f32_16x16x32_bf16 v[36:39], v[104:107], v[4:7], v[36:39]
    v_mfma_f32_16x16x32_bf16 v[40:43], v[104:107], v[8:11], v[40:43]
    v_mfma_f32_16x16x32_bf16 v[44:47], v[104:107], v[12:15], v[44:47]
    v_mfma_f32_16x16x32_bf16 v[48:51], v[104:107], v[16:19], v[48:51]
    v_mfma_f32_16x16x32_bf16 v[52:55], v[104:107], v[20:23], v[52:55]
    v_mfma_f32_16x16x32_bf16 v[56:59], v[104:107], v[24:27], v[56:59]
    v_mfma_f32_16x16x32_bf16 v[60:63], v[104:107], v[28:31], v[60:63]
    s_waitcnt lgkmcnt(0)
    v_mfma_f32_16x16x32_bf16 v[32:35], v[108:111], v[0:3], v[32:35]
    v_mfma_f32_16x16x32_bf16 v[36:39], v[108:111], v[4:7], v[36:39]
    v_mfma_f32_16x16x32_bf16 v[40:43], v[108:111], v[8:11], v[40:43]
    v_mfma_f32_16x16x32_bf16 v[44:47], v[108:111], v[12:15], v[44:47]
    v_mfma_f32_16x16x32_bf16 v[48:51], v[108:111], v[16:19], v[48:51]
    v_mfma_f32_16x16x32_bf16 v[52:55], v[108:111], v[20:23], v[52:55]
    v_mfma_f32_16x16x32_bf16 v[56:59], v[108:111], v[24:27], v[56:59]
    v_mfma_f32_16x16x32_bf16 v[60:63], v[108:111], v[28:31], v[60:63]
    s_nop 7
    v_cvt_pk_bf16_f32 v112, v32, v36
    v_cvt_pk_bf16_f32 v113, v40, v44
    v_cvt_pk_bf16_f32 v114, v48, v52
    v_cvt_pk_bf16_f32 v115, v56, v60
    buffer_store_dwordx4 v[112:115], v120, s[20:23], s25 offen
    s_add_u32 s25, s25, 2736128
    v_cvt_pk_bf16_f32 v116, v33, v37
    v_cvt_pk_bf16_f32 v117, v41, v45
    v_cvt_pk_bf16_f32 v118, v49, v53
    v_cvt_pk_bf16_f32 v119, v57, v61
    buffer_store_dwordx4 v[116:119], v120, s[20:23], s25 offen
    s_add_u32 s25, s25, 2736128
    v_cvt_pk_bf16_f32 v112, v34, v38
    v_cvt_pk_bf16_f32 v113, v42, v46
    v_cvt_pk_bf16_f32 v114, v50, v54
    v_cvt_pk_bf16_f32 v115, v58, v62
    buffer_store_dwordx4 v[112:115], v120, s[20:23], s25 offen
    s_add_u32 s25, s25, 2736128
    v_cvt_pk_bf16_f32 v116, v35, v39
    v_cvt_pk_bf16_f32 v117, v43, v47
    v_cvt_pk_bf16_f32 v118, v51, v55
    v_cvt_pk_bf16_f32 v119, v59, v63
    buffer_store_dwordx4 v[116:119], v120, s[20:23], s25 offen
    s_endpgm
K1_W:
    s_mov_b32 s16, s6
    s_mov_b32 s17, s7
    s_and_b32 s17, s17, 0xffff
    s_mov_b32 s18, 16252928
    s_mov_b32 s19, 0x00020000
    s_add_u32 s20, s8, 50331648
    s_addc_u32 s21, s9, 0
    s_and_b32 s21, s21, 0xffff
    s_mov_b32 s22, 67108864
    s_mov_b32 s23, 0x00020000
    s_mul_i32 s11, s2, 1
    s_lshr_b32 s12, s11, 9
    s_and_b32 s13, s11, 511
    s_lshl_b32 s14, s12, 19
    s_lshl_b32 s15, s13, 10
    s_add_u32 s14, s14, s15
    s_lshl_b32 s15, s3, 8
    s_add_u32 s14, s14, s15
    v_and_b32 v126, 1, v123
    v_lshlrev_b32 v126, 23, v126
    v_lshl_add_u32 v126, v122, 4, v126
    s_mov_b32 s15, s14
    buffer_load_dwordx4 v[0:3], v126, s[16:19], s15 offen
    s_add_u32 s15, s15, 0x100000
    buffer_load_dwordx4 v[4:7], v126, s[16:19], s15 offen
    s_add_u32 s15, s15, 0x100000
    buffer_load_dwordx4 v[8:11], v126, s[16:19], s15 offen
    s_add_u32 s15, s15, 0x100000
    buffer_load_dwordx4 v[12:15], v126, s[16:19], s15 offen
    s_add_u32 s15, s15, 0x100000
    buffer_load_dwordx4 v[16:19], v126, s[16:19], s15 offen
    s_add_u32 s15, s15, 0x100000
    buffer_load_dwordx4 v[20:23], v126, s[16:19], s15 offen
    s_add_u32 s15, s15, 0x100000
    buffer_load_dwordx4 v[24:27], v126, s[16:19], s15 offen
    s_add_u32 s15, s15, 0x100000
    buffer_load_dwordx4 v[28:31], v126, s[16:19], s15 offen
    v_and_b32 v127, 1, v123
    v_lshlrev_b32 v127, 3, v127
    v_mul_u32_u24 v112, 96, v125
    v_mad_u32_u24 v113, v124, v127, v112
    v_mad_u32_u24 v64, v124, 0, v113
    v_mad_u32_u24 v65, v124, 1, v113
    v_mad_u32_u24 v66, v124, 2, v113
    v_mad_u32_u24 v67, v124, 3, v113
    v_mad_u32_u24 v68, v124, 4, v113
    v_mad_u32_u24 v69, v124, 5, v113
    v_mad_u32_u24 v70, v124, 6, v113
    v_mad_u32_u24 v71, v124, 7, v113
    v_and_b32 v64, 127, v64
    v_and_b32 v65, 127, v65
    v_and_b32 v66, 127, v66
    v_and_b32 v67, 127, v67
    v_and_b32 v68, 127, v68
    v_and_b32 v69, 127, v69
    v_and_b32 v70, 127, v70
    v_and_b32 v71, 127, v71
    v_cvt_f32_u32 v64, v64
    v_cvt_f32_u32 v65, v65
    v_cvt_f32_u32 v66, v66
    v_cvt_f32_u32 v67, v67
    v_cvt_f32_u32 v68, v68
    v_cvt_f32_u32 v69, v69
    v_cvt_f32_u32 v70, v70
    v_cvt_f32_u32 v71, v71
    v_mul_f32 v64, 0x3c000000, v64
    v_mul_f32 v65, 0x3c000000, v65
    v_mul_f32 v66, 0x3c000000, v66
    v_mul_f32 v67, 0x3c000000, v67
    v_mul_f32 v68, 0x3c000000, v68
    v_mul_f32 v69, 0x3c000000, v69
    v_mul_f32 v70, 0x3c000000, v70
    v_mul_f32 v71, 0x3c000000, v71
    v_cos_f32 v64, v64
    v_cos_f32 v65, v65
    v_cos_f32 v66, v66
    v_cos_f32 v67, v67
    v_cos_f32 v68, v68
    v_cos_f32 v69, v69
    v_cos_f32 v70, v70
    v_cos_f32 v71, v71
    s_nop 0
    v_cvt_pk_bf16_f32 v72, v64, v65
    v_cvt_pk_bf16_f32 v73, v66, v67
    v_cvt_pk_bf16_f32 v74, v68, v69
    v_cvt_pk_bf16_f32 v75, v70, v71
    v_lshlrev_b32 v80, 16, v72
    v_and_b32 v81, 0xffff0000, v72
    v_sub_f32 v64, v64, v80
    v_sub_f32 v65, v65, v81
    v_lshlrev_b32 v80, 16, v73
    v_and_b32 v81, 0xffff0000, v73
    v_sub_f32 v66, v66, v80
    v_sub_f32 v67, v67, v81
    v_lshlrev_b32 v80, 16, v74
    v_and_b32 v81, 0xffff0000, v74
    v_sub_f32 v68, v68, v80
    v_sub_f32 v69, v69, v81
    v_lshlrev_b32 v80, 16, v75
    v_and_b32 v81, 0xffff0000, v75
    v_sub_f32 v70, v70, v80
    v_sub_f32 v71, v71, v81
    v_cvt_pk_bf16_f32 v76, v64, v65
    v_cvt_pk_bf16_f32 v77, v66, v67
    v_cvt_pk_bf16_f32 v78, v68, v69
    v_cvt_pk_bf16_f32 v79, v70, v71
    v_cmp_lt_u32 vcc, 1, v123
    s_lshl_b32 s24, s3, 10
    v_add_u32 v114, s24, v121
    v_cndmask_b32 v72, v72, v76, vcc
    v_cndmask_b32 v73, v73, v77, vcc
    v_cndmask_b32 v74, v74, v78, vcc
    v_cndmask_b32 v75, v75, v79, vcc
    ds_write_b128 v114, v[72:75]
    v_lshrrev_b32 v112, 1, v123
    s_mov_b32 s24, 2097152
    v_mul_lo_u32 v112, v112, s24
    v_and_b32 v113, 1, v123
    v_lshl_add_u32 v112, v113, 8, v112
    v_and_b32 v113, 1, v122
    v_lshl_add_u32 v124, v113, 4, v112
    v_lshrrev_b32 v125, 1, v122
    s_mul_i32 s26, s3, 524288
    s_lshl_b32 s24, s11, 9
    s_add_u32 s26, s26, s24
    s_waitcnt lgkmcnt(0)
    s_barrier
    ds_read_b128 v[96:99], v121 offset:0
    ds_read_b128 v[100:103], v121 offset:1024
    ds_read_b128 v[104:107], v121 offset:2048
    ds_read_b128 v[108:111], v121 offset:3072
    s_mov_b32 s27, 0
    s_waitcnt vmcnt(0) lgkmcnt(0)
K1_W_LOOP:
    s_add_u32 s24, s11, s27
    s_and_b32 s30, s24, 3
    s_lshr_b32 s24, s24, 1
    s_and_b32 s24, s24, 4
    s_or_b32 s30, s30, s24
    v_xor_b32 v112, s30, v125
    v_lshl_add_u32 v120, v112, 5, v124
    s_lshl_b32 s25, s27, 9
    s_add_u32 s25, s25, s26
    v_perm_b32 v32, v4, v0, s28
    v_perm_b32 v36, v4, v0, s29
    v_perm_b32 v33, v12, v8, s28
    v_perm_b32 v37, v12, v8, s29
    v_perm_b32 v34, v20, v16, s28
    v_perm_b32 v38, v20, v16, s29
    v_perm_b32 v35, v28, v24, s28
    v_perm_b32 v39, v28, v24, s29
    v_perm_b32 v40, v5, v1, s28
    v_perm_b32 v44, v5, v1, s29
    v_perm_b32 v41, v13, v9, s28
    v_perm_b32 v45, v13, v9, s29
    v_perm_b32 v42, v21, v17, s28
    v_perm_b32 v46, v21, v17, s29
    v_perm_b32 v43, v29, v25, s28
    v_perm_b32 v47, v29, v25, s29
    v_perm_b32 v48, v6, v2, s28
    v_perm_b32 v52, v6, v2, s29
    v_perm_b32 v49, v14, v10, s28
    v_perm_b32 v53, v14, v10, s29
    v_perm_b32 v50, v22, v18, s28
    v_perm_b32 v54, v22, v18, s29
    v_perm_b32 v51, v30, v26, s28
    v_perm_b32 v55, v30, v26, s29
    v_perm_b32 v56, v7, v3, s28
    v_perm_b32 v60, v7, v3, s29
    v_perm_b32 v57, v15, v11, s28
    v_perm_b32 v61, v15, v11, s29
    v_perm_b32 v58, v23, v19, s28
    v_perm_b32 v62, v23, v19, s29
    v_perm_b32 v59, v31, v27, s28
    v_perm_b32 v63, v31, v27, s29
    s_add_u32 s27, s27, 1
    s_add_u32 s14, s14, 1024
    s_cmp_ge_u32 s27, 1
    s_cbranch_scc1 K1_W_NOLOAD
    s_mov_b32 s15, s14
    buffer_load_dwordx4 v[0:3], v126, s[16:19], s15 offen
    s_add_u32 s15, s15, 0x100000
    buffer_load_dwordx4 v[4:7], v126, s[16:19], s15 offen
    s_add_u32 s15, s15, 0x100000
    buffer_load_dwordx4 v[8:11], v126, s[16:19], s15 offen
    s_add_u32 s15, s15, 0x100000
    buffer_load_dwordx4 v[12:15], v126, s[16:19], s15 offen
    s_add_u32 s15, s15, 0x100000
    buffer_load_dwordx4 v[16:19], v126, s[16:19], s15 offen
    s_add_u32 s15, s15, 0x100000
    buffer_load_dwordx4 v[20:23], v126, s[16:19], s15 offen
    s_add_u32 s15, s15, 0x100000
    buffer_load_dwordx4 v[24:27], v126, s[16:19], s15 offen
    s_add_u32 s15, s15, 0x100000
    buffer_load_dwordx4 v[28:31], v126, s[16:19], s15 offen
K1_W_NOLOAD:
    v_mfma_f32_16x16x32_bf16 v[64:67], v[96:99], v[32:35], 0
    v_mfma_f32_16x16x32_bf16 v[68:71], v[96:99], v[36:39], 0
    v_mfma_f32_16x16x32_bf16 v[72:75], v[96:99], v[40:43], 0
    v_mfma_f32_16x16x32_bf16 v[76:79], v[96:99], v[44:47], 0
    v_mfma_f32_16x16x32_bf16 v[80:83], v[96:99], v[48:51], 0
    v_mfma_f32_16x16x32_bf16 v[84:87], v[96:99], v[52:55], 0
    v_mfma_f32_16x16x32_bf16 v[88:91], v[96:99], v[56:59], 0
    v_mfma_f32_16x16x32_bf16 v[92:95], v[96:99], v[60:63], 0
    s_nop 7
    v_cvt_pk_bf16_f32 v112, v64, v68
    v_cvt_pk_bf16_f32 v113, v72, v76
    v_cvt_pk_bf16_f32 v114, v80, v84
    v_cvt_pk_bf16_f32 v115, v88, v92
    buffer_store_dwordx4 v[112:115], v120, s[20:23], s25 offen
    s_add_u32 s25, s25, 4194304
    v_cvt_pk_bf16_f32 v116, v65, v69
    v_cvt_pk_bf16_f32 v117, v73, v77
    v_cvt_pk_bf16_f32 v118, v81, v85
    v_cvt_pk_bf16_f32 v119, v89, v93
    buffer_store_dwordx4 v[116:119], v120, s[20:23], s25 offen
    s_add_u32 s25, s25, 4194304
    v_cvt_pk_bf16_f32 v112, v66, v70
    v_cvt_pk_bf16_f32 v113, v74, v78
    v_cvt_pk_bf16_f32 v114, v82, v86
    v_cvt_pk_bf16_f32 v115, v90, v94
    buffer_store_dwordx4 v[112:115], v120, s[20:23], s25 offen
    s_add_u32 s25, s25, 4194304
    v_cvt_pk_bf16_f32 v116, v67, v71
    v_cvt_pk_bf16_f32 v117, v75, v79
    v_cvt_pk_bf16_f32 v118, v83, v87
    v_cvt_pk_bf16_f32 v119, v91, v95
    buffer_store_dwordx4 v[116:119], v120, s[20:23], s25 offen
    s_add_u32 s25, s25, 4194304
    v_mfma_f32_16x16x32_bf16 v[64:67], v[100:103], v[32:35], 0
    v_mfma_f32_16x16x32_bf16 v[68:71], v[100:103], v[36:39], 0
    v_mfma_f32_16x16x32_bf16 v[72:75], v[100:103], v[40:43], 0
    v_mfma_f32_16x16x32_bf16 v[76:79], v[100:103], v[44:47], 0
    v_mfma_f32_16x16x32_bf16 v[80:83], v[100:103], v[48:51], 0
    v_mfma_f32_16x16x32_bf16 v[84:87], v[100:103], v[52:55], 0
    v_mfma_f32_16x16x32_bf16 v[88:91], v[100:103], v[56:59], 0
    v_mfma_f32_16x16x32_bf16 v[92:95], v[100:103], v[60:63], 0
    s_nop 7
    v_cvt_pk_bf16_f32 v112, v64, v68
    v_cvt_pk_bf16_f32 v113, v72, v76
    v_cvt_pk_bf16_f32 v114, v80, v84
    v_cvt_pk_bf16_f32 v115, v88, v92
    buffer_store_dwordx4 v[112:115], v120, s[20:23], s25 offen
    s_add_u32 s25, s25, 4194304
    v_cvt_pk_bf16_f32 v116, v65, v69
    v_cvt_pk_bf16_f32 v117, v73, v77
    v_cvt_pk_bf16_f32 v118, v81, v85
    v_cvt_pk_bf16_f32 v119, v89, v93
    buffer_store_dwordx4 v[116:119], v120, s[20:23], s25 offen
    s_add_u32 s25, s25, 4194304
    v_cvt_pk_bf16_f32 v112, v66, v70
    v_cvt_pk_bf16_f32 v113, v74, v78
    v_cvt_pk_bf16_f32 v114, v82, v86
    v_cvt_pk_bf16_f32 v115, v90, v94
    buffer_store_dwordx4 v[112:115], v120, s[20:23], s25 offen
    s_add_u32 s25, s25, 4194304
    v_cvt_pk_bf16_f32 v116, v67, v71
    v_cvt_pk_bf16_f32 v117, v75, v79
    v_cvt_pk_bf16_f32 v118, v83, v87
    v_cvt_pk_bf16_f32 v119, v91, v95
    buffer_store_dwordx4 v[116:119], v120, s[20:23], s25 offen
    s_add_u32 s25, s25, 4194304
    v_mfma_f32_16x16x32_bf16 v[64:67], v[104:107], v[32:35], 0
    v_mfma_f32_16x16x32_bf16 v[68:71], v[104:107], v[36:39], 0
    v_mfma_f32_16x16x32_bf16 v[72:75], v[104:107], v[40:43], 0
    v_mfma_f32_16x16x32_bf16 v[76:79], v[104:107], v[44:47], 0
    v_mfma_f32_16x16x32_bf16 v[80:83], v[104:107], v[48:51], 0
    v_mfma_f32_16x16x32_bf16 v[84:87], v[104:107], v[52:55], 0
    v_mfma_f32_16x16x32_bf16 v[88:91], v[104:107], v[56:59], 0
    v_mfma_f32_16x16x32_bf16 v[92:95], v[104:107], v[60:63], 0
    s_nop 7
    v_cvt_pk_bf16_f32 v112, v64, v68
    v_cvt_pk_bf16_f32 v113, v72, v76
    v_cvt_pk_bf16_f32 v114, v80, v84
    v_cvt_pk_bf16_f32 v115, v88, v92
    buffer_store_dwordx4 v[112:115], v120, s[20:23], s25 offen
    s_add_u32 s25, s25, 4194304
    v_cvt_pk_bf16_f32 v116, v65, v69
    v_cvt_pk_bf16_f32 v117, v73, v77
    v_cvt_pk_bf16_f32 v118, v81, v85
    v_cvt_pk_bf16_f32 v119, v89, v93
    buffer_store_dwordx4 v[116:119], v120, s[20:23], s25 offen
    s_add_u32 s25, s25, 4194304
    v_cvt_pk_bf16_f32 v112, v66, v70
    v_cvt_pk_bf16_f32 v113, v74, v78
    v_cvt_pk_bf16_f32 v114, v82, v86
    v_cvt_pk_bf16_f32 v115, v90, v94
    buffer_store_dwordx4 v[112:115], v120, s[20:23], s25 offen
    s_add_u32 s25, s25, 4194304
    v_cvt_pk_bf16_f32 v116, v67, v71
    v_cvt_pk_bf16_f32 v117, v75, v79
    v_cvt_pk_bf16_f32 v118, v83, v87
    v_cvt_pk_bf16_f32 v119, v91, v95
    buffer_store_dwordx4 v[116:119], v120, s[20:23], s25 offen
    s_add_u32 s25, s25, 4194304
    v_mfma_f32_16x16x32_bf16 v[64:67], v[108:111], v[32:35], 0
    v_mfma_f32_16x16x32_bf16 v[68:71], v[108:111], v[36:39], 0
    v_mfma_f32_16x16x32_bf16 v[72:75], v[108:111], v[40:43], 0
    v_mfma_f32_16x16x32_bf16 v[76:79], v[108:111], v[44:47], 0
    v_mfma_f32_16x16x32_bf16 v[80:83], v[108:111], v[48:51], 0
    v_mfma_f32_16x16x32_bf16 v[84:87], v[108:111], v[52:55], 0
    v_mfma_f32_16x16x32_bf16 v[88:91], v[108:111], v[56:59], 0
    v_mfma_f32_16x16x32_bf16 v[92:95], v[108:111], v[60:63], 0
    s_nop 7
    v_cvt_pk_bf16_f32 v112, v64, v68
    v_cvt_pk_bf16_f32 v113, v72, v76
    v_cvt_pk_bf16_f32 v114, v80, v84
    v_cvt_pk_bf16_f32 v115, v88, v92
    buffer_store_dwordx4 v[112:115], v120, s[20:23], s25 offen
    s_add_u32 s25, s25, 4194304
    v_cvt_pk_bf16_f32 v116, v65, v69
    v_cvt_pk_bf16_f32 v117, v73, v77
    v_cvt_pk_bf16_f32 v118, v81, v85
    v_cvt_pk_bf16_f32 v119, v89, v93
    buffer_store_dwordx4 v[116:119], v120, s[20:23], s25 offen
    s_add_u32 s25, s25, 4194304
    v_cvt_pk_bf16_f32 v112, v66, v70
    v_cvt_pk_bf16_f32 v113, v74, v78
    v_cvt_pk_bf16_f32 v114, v82, v86
    v_cvt_pk_bf16_f32 v115, v90, v94
    buffer_store_dwordx4 v[112:115], v120, s[20:23], s25 offen
    s_add_u32 s25, s25, 4194304
    v_cvt_pk_bf16_f32 v116, v67, v71
    v_cvt_pk_bf16_f32 v117, v75, v79
    v_cvt_pk_bf16_f32 v118, v83, v87
    v_cvt_pk_bf16_f32 v119, v91, v95
    buffer_store_dwordx4 v[116:119], v120, s[20:23], s25 offen
    s_waitcnt vmcnt(16)
    s_cmp_lt_u32 s27, 1
    s_cbranch_scc1 K1_W_LOOP
K1_END:
    s_endpgm
.p2align 8
.type k12_fused_kernel,@function
k12_fused_kernel:
    s_cmp_ge_u32 s2, 256
    s_cbranch_scc1 K12_END
    s_load_dwordx4 s[52:55], s[0:1], 0
    s_load_dwordx4 s[56:59], s[0:1], 40
    s_getpc_b64 s[90:91]
CPF_K12:
    s_sub_u32 s90, s90, CPF_K12-k12_fused_kernel
    s_subb_u32 s91, s91, 0
    v_lshlrev_b32 v8, 7, v0
    v_mov_b32 v11, s91
    v_min_u32 v9, TEXT_END-k12_fused_kernel-4, v8
    v_add_co_u32 v10, vcc, s90, v9
    v_addc_co_u32 v11, vcc, 0, v11, vcc
    global_load_dword v63, v[10:11], off
    v_lshrrev_b32 v1, 6, v0
    v_and_b32 v2, 63, v0
    v_readfirstlane_b32 s3, v1
    s_waitcnt lgkmcnt(0)
    s_cmp_lt_u32 s3, 4
    s_cbranch_scc1 K12_CONS
    v_and_b32 v64, 15, v2
    v_lshrrev_b32 v65, 4, v2
    v_lshlrev_b32 v254, 4, v2
    s_and_b32 s44, s3, 3
    s_and_b32 s20, s44, 1
    s_lshr_b32 s21, s44, 1
    s_lshl_b32 s22, s2, 1
    s_add_u32 s22, s22, s21
    s_and_b32 s23, s22, 3
    s_lshr_b32 s22, s22, 2
    s_and_b32 s24, s2, 7
    s_lshl_b32 s24, s24, 5
    s_lshr_b32 s25, s2, 3
    s_add_u32 s24, s24, s25
    s_cmp_ge_u32 s24, 167
    s_cselect_b32 s25, 1, 0
    s_mul_i32 s26, s25, 167
    s_sub_u32 s24, s24, s26
    s_mov_b32 s49, s25
    s_cmp_eq_u32 s21, 0
    s_cselect_b32 s25, s25, 1
    s_mul_i32 s26, s25, 16384000
    s_add_u32 s4, s52, s26
    s_addc_u32 s5, s53, 0
    s_and_b32 s5, s5, 0xffff
    s_mov_b32 s6, 16384000
    s_mov_b32 s7, 0x00020000
    s_mov_b32 s8, s54
    s_mov_b32 s9, s55
    s_and_b32 s9, s9, 0xffff
    s_mov_b32 s10, 16252928
    s_mov_b32 s11, 0x00020000
    s_mov_b32 s12, s58
    s_mov_b32 s13, s59
    s_and_b32 s13, s13, 0xffff
    s_mov_b32 s14, 43778048
    s_mov_b32 s15, 0x00020000
    s_add_u32 s16, s58, 50331648
    s_addc_u32 s17, s59, 0
    s_and_b32 s17, s17, 0xffff
    s_mov_b32 s18, 67108864
    s_mov_b32 s19, 0x00020000
    s_add_u32 s60, s58, 153092096
    s_addc_u32 s61, s59, 0
    s_and_b32 s61, s61, 0xffff
    s_mov_b32 s62, 32768
    s_mov_b32 s63, 0x00020000
    s_mov_b32 s28, 0x05040100
    s_mov_b32 s29, 0x07060302
    v_lshlrev_b32 v248, 14, v65
    v_lshl_add_u32 v248, v64, 4, v248
    v_and_b32 v250, 1, v65
    v_lshlrev_b32 v250, 23, v250
    v_lshl_add_u32 v250, v64, 4, v250
    v_lshrrev_b32 v66, 1, v65
    s_mov_b32 s26, 1368064
    v_mul_lo_u32 v66, v66, s26
    v_lshrrev_b32 v67, 2, v64
    s_mov_b32 s26, 21376
    v_mul_lo_u32 v67, v67, s26
    v_add_u32 v66, v66, v67
    v_mov_b32 v252, v66
    v_lshrrev_b32 v66, 1, v65
    s_mov_b32 s26, 2097152
    v_mul_lo_u32 v66, v66, s26
    v_and_b32 v67, 1, v65
    v_lshl_add_u32 v66, v67, 8, v66
    v_and_b32 v67, 1, v64
    v_lshl_add_u32 v251, v67, 4, v66
    s_mul_i32 s31, s25, 684032
    s_mul_i32 s32, s23, 524288
    s_lshl_b32 s33, s23, 8
    s_mov_b32 s40, 3
    s_xor_b32 s43, s40, s20
    s_and_b32 s43, s43, 1
    s_mul_i32 s36, s40, 85
    s_add_u32 s36, s36, s2
    s_and_b32 s36, s36, 255
    s_mul_hi_u32 s37, s36, 0x55555556
    s_mul_i32 s38, s37, 3
    s_cmp_eq_u32 s38, s36
    s_cselect_b32 s27, 1, 0
    s_cmp_lt_u32 s37, 78
    s_cselect_b32 s27, s27, 0
    s_add_u32 s37, s37, 89
    s_add_u32 s26, s21, 1
    s_cmp_eq_u32 s27, 1
    s_cselect_b32 s26, 0, s26
    s_and_b32 s36, s27, s21
    s_cselect_b32 s30, s37, s24
    s_cselect_b32 s25, 1, s49
    s_mov_b32 s27, 1
    s_cmp_eq_u32 s43, 0
    s_cbranch_scc0 K12_PL1
    s_lshl_b32 s36, s40, 7
    s_add_u32 s36, s36, s22
    s_lshr_b32 s37, s36, 9
    s_lshl_b32 s37, s37, 19
    s_and_b32 s36, s36, 511
    s_lshl_b32 s36, s36, 10
    s_add_u32 s36, s36, s37
    s_add_u32 s36, s36, s33
    buffer_load_dwordx4 v[96:99], v250, s[8:11], s36 offen
    s_add_u32 s36, s36, 0x100000
    buffer_load_dwordx4 v[100:103], v250, s[8:11], s36 offen
    s_add_u32 s36, s36, 0x100000
    buffer_load_dwordx4 v[104:107], v250, s[8:11], s36 offen
    s_add_u32 s36, s36, 0x100000
    buffer_load_dwordx4 v[108:111], v250, s[8:11], s36 offen
    s_add_u32 s36, s36, 0x100000
    buffer_load_dwordx4 v[112:115], v250, s[8:11], s36 offen
    s_add_u32 s36, s36, 0x100000
    buffer_load_dwordx4 v[116:119], v250, s[8:11], s36 offen
    s_add_u32 s36, s36, 0x100000
    buffer_load_dwordx4 v[120:123], v250, s[8:11], s36 offen
    s_add_u32 s36, s36, 0x100000
    buffer_load_dwordx4 v[124:127], v250, s[8:11], s36 offen
    s_branch K12_PL2
K12_PL1:
    s_cmp_eq_u32 s27, 0
    s_cbranch_scc1 K12_PL2
    s_mul_i32 s36, s25, 16384000
    s_add_u32 s4, s52, s36
    s_addc_u32 s5, s53, 0
    s_and_b32 s5, s5, 0xffff
    s_lshl_b32 s36, s40, 8
    s_mul_i32 s37, s30, 98304
    s_add_u32 s36, s36, s37
    buffer_load_dwordx4 v[0:3], v248, s[4:7], s36 offen
    buffer_load_dwordx4 v[4:7], v248, s[4:7], s36 offen offset:2048
    s_add_u32 s36, s36, 4096
    buffer_load_dwordx4 v[8:11], v248, s[4:7], s36 offen
    buffer_load_dwordx4 v[12:15], v248, s[4:7], s36 offen offset:2048
    s_add_u32 s36, s36, 4096
    buffer_load_dwordx4 v[16:19], v248, s[4:7], s36 offen
    buffer_load_dwordx4 v[20:23], v248, s[4:7], s36 offen offset:2048
    s_add_u32 s36, s36, 4096
    buffer_load_dwordx4 v[24:27], v248, s[4:7], s36 offen
    buffer_load_dwordx4 v[28:31], v248, s[4:7], s36 offen offset:2048
    s_add_u32 s36, s36, 53248
    buffer_load_dwordx4 v[32:35], v248, s[4:7], s36 offen
    buffer_load_dwordx4 v[36:39], v248, s[4:7], s36 offen offset:2048
    s_add_u32 s36, s36, 4096
    buffer_load_dwordx4 v[40:43], v248, s[4:7], s36 offen
    buffer_load_dwordx4 v[44:47], v248, s[4:7], s36 offen offset:2048
    s_add_u32 s36, s36, 4096
    buffer_load_dwordx4 v[48:51], v248, s[4:7], s36 offen
    buffer_load_dwordx4 v[52:55], v248, s[4:7], s36 offen offset:2048
    s_add_u32 s36, s36, 4096
    buffer_load_dwordx4 v[56:59], v248, s[4:7], s36 offen
    buffer_load_dwordx4 v[60:63], v248, s[4:7], s36 offen offset:2048
K12_PL2:
    v_and_b32 v128, 3, v64
    v_lshlrev_b32 v128, 2, v128
    v_lshrrev_b32 v130, 3, v64
    v_lshl_add_u32 v128, v130, 1, v128
    s_lshl_b32 s36, s44, 4
    s_add_u32 s36, s36, 1
    v_add_u32 v128, s36, v128
    v_bfe_u32 v129, v64, 2, 1
    v_lshlrev_b32 v131, 3, v65
    v_lshlrev_b32 v132, 5, v129
    v_mad_u32_u24 v133, v128, v131, v132
    v_mad_u32_u24 v136, v128, 0, v133
    v_mad_u32_u24 v137, v128, 1, v133
    v_mad_u32_u24 v138, v128, 2, v133
    v_mad_u32_u24 v139, v128, 3, v133
    v_mad_u32_u24 v140, v128, 4, v133
    v_mad_u32_u24 v141, v128, 5, v133
    v_mad_u32_u24 v142, v128, 6, v133
    v_mad_u32_u24 v143, v128, 7, v133
    v_and_b32 v136, 127, v136
    v_and_b32 v137, 127, v137
    v_and_b32 v138, 127, v138
    v_and_b32 v139, 127, v139
    v_and_b32 v140, 127, v140
    v_and_b32 v141, 127, v141
    v_and_b32 v142, 127, v142
    v_and_b32 v143, 127, v143
    v_cvt_f32_u32 v136, v136
    v_cvt_f32_u32 v137, v137
    v_cvt_f32_u32 v138, v138
    v_cvt_f32_u32 v139, v139
    v_cvt_f32_u32 v140, v140
    v_cvt_f32_u32 v141, v141
    v_cvt_f32_u32 v142, v142
    v_cvt_f32_u32 v143, v143
    v_mul_f32 v136, 0x3c000000, v136
    v_mul_f32 v137, 0x3c000000, v137
    v_mul_f32 v138, 0x3c000000, v138
    v_mul_f32 v139, 0x3c000000, v139
    v_mul_f32 v140, 0x3c000000, v140
    v_mul_f32 v141, 0x3c000000, v141
    v_mul_f32 v142, 0x3c000000, v142
    v_mul_f32 v143, 0x3c000000, v143
    v_cos_f32 v136, v136
    v_cos_f32 v137, v137
    v_cos_f32 v138, v138
    v_cos_f32 v139, v139
    v_cos_f32 v140, v140
    v_cos_f32 v141, v141
    v_cos_f32 v142, v142
    v_cos_f32 v143, v143
    s_nop 0
    v_cvt_pk_bf16_f32 v144, v136, v137
    v_cvt_pk_bf16_f32 v145, v138, v139
    v_cvt_pk_bf16_f32 v146, v140, v141
    v_cvt_pk_bf16_f32 v147, v142, v143
    v_lshlrev_b32 v152, 16, v144
    v_and_b32 v153, 0xffff0000, v144
    v_sub_f32 v136, v136, v152
    v_sub_f32 v137, v137, v153
    v_lshlrev_b32 v152, 16, v145
    v_and_b32 v153, 0xffff0000, v145
    v_sub_f32 v138, v138, v152
    v_sub_f32 v139, v139, v153
    v_lshlrev_b32 v152, 16, v146
    v_and_b32 v153, 0xffff0000, v146
    v_sub_f32 v140, v140, v152
    v_sub_f32 v141, v141, v153
    v_lshlrev_b32 v152, 16, v147
    v_and_b32 v153, 0xffff0000, v147
    v_sub_f32 v142, v142, v152
    v_sub_f32 v143, v143, v153
    v_cvt_pk_bf16_f32 v148, v136, v137
    v_cvt_pk_bf16_f32 v149, v138, v139
    v_cvt_pk_bf16_f32 v150, v140, v141
    v_cvt_pk_bf16_f32 v151, v142, v143
    s_lshl_b32 s37, s44, 12
    s_add_u32 s37, s37, 116736
    v_add_u32 v132, s37, v254
    ds_write_b128 v132, v[144:147]
    ds_write_b128 v132, v[148:151] offset:1024
    v_add_u32 v131, 32, v131
    v_lshlrev_b32 v132, 5, v129
    v_mad_u32_u24 v133, v128, v131, v132
    v_mad_u32_u24 v136, v128, 0, v133
    v_mad_u32_u24 v137, v128, 1, v133
    v_mad_u32_u24 v138, v128, 2, v133
    v_mad_u32_u24 v139, v128, 3, v133
    v_mad_u32_u24 v140, v128, 4, v133
    v_mad_u32_u24 v141, v128, 5, v133
    v_mad_u32_u24 v142, v128, 6, v133
    v_mad_u32_u24 v143, v128, 7, v133
    v_and_b32 v136, 127, v136
    v_and_b32 v137, 127, v137
    v_and_b32 v138, 127, v138
    v_and_b32 v139, 127, v139
    v_and_b32 v140, 127, v140
    v_and_b32 v141, 127, v141
    v_and_b32 v142, 127, v142
    v_and_b32 v143, 127, v143
    v_cvt_f32_u32 v136, v136
    v_cvt_f32_u32 v137, v137
    v_cvt_f32_u32 v138, v138
    v_cvt_f32_u32 v139, v139
    v_cvt_f32_u32 v140, v140
    v_cvt_f32_u32 v141, v141
    v_cvt_f32_u32 v142, v142
    v_cvt_f32_u32 v143, v143
    v_mul_f32 v136, 0x3c000000, v136
    v_mul_f32 v137, 0x3c000000, v137
    v_mul_f32 v138, 0x3c000000, v138
    v_mul_f32 v139, 0x3c000000, v139
    v_mul_f32 v140, 0x3c000000, v140
    v_mul_f32 v141, 0x3c000000, v141
    v_mul_f32 v142, 0x3c000000, v142
    v_mul_f32 v143, 0x3c000000, v143
    v_cos_f32 v136, v136
    v_cos_f32 v137, v137
    v_cos_f32 v138, v138
    v_cos_f32 v139, v139
    v_cos_f32 v140, v140
    v_cos_f32 v141, v141
    v_cos_f32 v142, v142
    v_cos_f32 v143, v143
    s_nop 0
    v_cvt_pk_bf16_f32 v144, v136, v137
    v_cvt_pk_bf16_f32 v145, v138, v139
    v_cvt_pk_bf16_f32 v146, v140, v141
    v_cvt_pk_bf16_f32 v147, v142, v143
    v_lshlrev_b32 v152, 16, v144
    v_and_b32 v153, 0xffff0000, v144
    v_sub_f32 v136, v136, v152
    v_sub_f32 v137, v137, v153
    v_lshlrev_b32 v152, 16, v145
    v_and_b32 v153, 0xffff0000, v145
    v_sub_f32 v138, v138, v152
    v_sub_f32 v139, v139, v153
    v_lshlrev_b32 v152, 16, v146
    v_and_b32 v153, 0xffff0000, v146
    v_sub_f32 v140, v140, v152
    v_sub_f32 v141, v141, v153
    v_lshlrev_b32 v152, 16, v147
    v_and_b32 v153, 0xffff0000, v147
    v_sub_f32 v142, v142, v152
    v_sub_f32 v143, v143, v153
    v_cvt_pk_bf16_f32 v148, v136, v137
    v_cvt_pk_bf16_f32 v149, v138, v139
    v_cvt_pk_bf16_f32 v150, v140, v141
    v_cvt_pk_bf16_f32 v151, v142, v143
    s_lshl_b32 s37, s44, 12
    s_add_u32 s37, s37, 118784
    v_add_u32 v132, s37, v254
    ds_write_b128 v132, v[144:147]
    ds_write_b128 v132, v[148:151] offset:1024
K12_TB:
    s_waitcnt lgkmcnt(0)
    s_barrier
    v_add_u32 v255, 116736, v254
    ds_read_b128 v[160:163], v255 offset:0
    ds_read_b128 v[192:195], v255 offset:1024
    ds_read_b128 v[164:167], v255 offset:2048
    ds_read_b128 v[196:199], v255 offset:3072
    ds_read_b128 v[168:171], v255 offset:4096
    ds_read_b128 v[200:203], v255 offset:5120
    ds_read_b128 v[172:175], v255 offset:6144
    ds_read_b128 v[204:207], v255 offset:7168
    s_waitcnt lgkmcnt(0)
    ds_read_b128 v[176:179], v255 offset:8192
    ds_read_b128 v[208:211], v255 offset:9216
    ds_read_b128 v[180:183], v255 offset:10240
    ds_read_b128 v[212:215], v255 offset:11264
    ds_read_b128 v[184:187], v255 offset:12288
    ds_read_b128 v[216:219], v255 offset:13312
    ds_read_b128 v[188:191], v255 offset:14336
    ds_read_b128 v[220:223], v255 offset:15360
    ds_read_b128 v[224:227], v255 offset:16384
    ds_read_b128 v[228:231], v255 offset:17408
    ds_read_b128 v[232:235], v255 offset:18432
    ds_read_b128 v[236:239], v255 offset:19456
    s_waitcnt lgkmcnt(0)
    s_barrier
    s_waitcnt vmcnt(0) lgkmcnt(0)
    s_mov_b32 s41, -1
    s_mov_b32 s34, -1
K12_PROD:
    s_mov_b32 s37, 131072
K12_TW:
    v_mov_b32 v240, 155648
    ds_read_b32 v240, v240
    s_waitcnt lgkmcnt(0)
    v_cmp_gt_u32 vcc, 2, v240
    s_sub_u32 s37, s37, 1
    s_cmp_eq_u32 s37, 0
    s_cbranch_scc1 K12_TX
    s_cbranch_vccz K12_TX
    s_sleep 2
    s_branch K12_TW
K12_TX:
    v_lshrrev_b32 v128, 4, v254
    v_lshlrev_b32 v129, 11, v128
    v_lshrrev_b32 v130, 1, v128
    v_lshlrev_b32 v130, 20, v130
    v_and_b32 v131, 1, v128
    v_lshl_add_u32 v130, v131, 7, v130
    s_mov_b32 s45, s27
    s_mov_b32 s46, s30
    s_mov_b32 s50, s25
    s_mov_b32 s51, s26
    s_add_u32 s47, s40, 1
K12_TCH0:
    s_xor_b32 s48, s47, s20
    s_and_b32 s48, s48, 1
    s_cmp_eq_u32 s48, 0
    s_cbranch_scc1 K12_TCHW0
    s_mul_i32 s36, s47, 85
    s_add_u32 s36, s36, s2
    s_and_b32 s36, s36, 255
    s_mul_hi_u32 s37, s36, 0x55555556
    s_mul_i32 s38, s37, 3
    s_cmp_eq_u32 s38, s36
    s_cselect_b32 s27, 1, 0
    s_cmp_lt_u32 s37, 78
    s_cselect_b32 s27, s27, 0
    s_add_u32 s37, s37, 89
    s_add_u32 s26, s21, 1
    s_cmp_eq_u32 s27, 1
    s_cselect_b32 s26, 0, s26
    s_and_b32 s36, s27, s21
    s_cselect_b32 s30, s37, s24
    s_cselect_b32 s25, 1, s49
    s_mov_b32 s27, 1
    s_cmp_eq_u32 s26, 2
    s_cbranch_scc1 K12_TCHN0
    s_cmp_eq_u32 s27, 0
    s_cbranch_scc1 K12_TCHN0
    s_mul_i32 s36, s25, 16384000
    s_add_u32 s4, s52, s36
    s_addc_u32 s5, s53, 0
    s_and_b32 s5, s5, 0xffff
    s_lshl_b32 s36, s47, 8
    s_mul_i32 s37, s30, 98304
    s_add_u32 s36, s36, s37
    buffer_load_dword v244, v129, s[4:7], s36 offen
    buffer_load_dword v245, v129, s[4:7], s36 offen offset:128
    s_branch K12_TCHN0
K12_TCHW0:
    s_lshl_b32 s36, s47, 7
    s_add_u32 s36, s36, s22
    s_lshr_b32 s37, s36, 9
    s_lshl_b32 s37, s37, 19
    s_and_b32 s36, s36, 511
    s_lshl_b32 s36, s36, 10
    s_add_u32 s36, s36, s37
    s_add_u32 s36, s36, s33
    s_mov_b64 exec, 0xffffffff
    buffer_load_dword v246, v130, s[8:11], s36 offen
    s_mov_b64 exec, -1
K12_TCHN0:
    s_add_u32 s47, s47, 1
    s_cmp_lt_u32 s47, 8
    s_cbranch_scc1 K12_TCH0
    s_mov_b32 s27, s45
    s_mov_b32 s30, s46
    s_mov_b32 s25, s50
    s_mov_b32 s26, s51
    s_cmp_eq_u32 s43, 0
    s_cbranch_scc1 K12_WENTRY
K12_XW:
    s_waitcnt vmcnt(0)
    s_mov_b32 s34, -1
    s_cmp_ge_u32 s41, 8
    s_cbranch_scc1 K12_SG0
    s_lshl_b32 s36, s41, 2
    s_add_u32 s37, s36, 155680
    s_mov_b64 exec, 1
    v_mov_b32 v255, s37
    v_mov_b32 v240, 1
    ds_add_rtn_u32 v240, v255, v240
    s_waitcnt lgkmcnt(0)
    v_readfirstlane_b32 s37, v240
    s_nop 3
    s_cmp_eq_u32 s37, 3
    s_cbranch_scc0 K12_SH0
    s_lshl_b32 s36, s36, 8
    v_mov_b32 v255, 1
    v_mov_b32 v240, s36
    buffer_atomic_add v255, v240, s[60:63], 0 offen sc0 sc1
    s_mov_b32 s34, s41
K12_SH0:
    s_mov_b64 exec, -1
K12_SG0:
    s_cmp_ge_u32 s34, 8
    s_cbranch_scc1 K12_EP1
    s_waitcnt vmcnt(0)
    s_cmp_ge_u32 s34, 8
    s_cbranch_scc1 K12_PB2
    v_readfirstlane_b32 s37, v255
    s_nop 3
    s_cmp_eq_u32 s37, 255
    s_cbranch_scc0 K12_PB2
    s_lshl_b32 s36, s34, 4
    s_add_u32 s36, s36, 16384
    s_mov_b64 exec, 1
    v_mov_b32 v255, 1
    v_mov_b32 v240, s36
    buffer_store_dword v255, v240, s[60:63], 0 offen sc1
    s_mov_b64 exec, -1
K12_PB2:
    s_mov_b32 s34, -1
K12_EP1:
    s_cmp_eq_u32 s27, 0
    s_cbranch_scc1 K12_XP_N
    v_perm_b32 v64, v4, v0, s28
    v_perm_b32 v68, v4, v0, s29
    v_perm_b32 v65, v12, v8, s28
    v_perm_b32 v69, v12, v8, s29
    v_perm_b32 v66, v20, v16, s28
    v_perm_b32 v70, v20, v16, s29
    v_perm_b32 v67, v28, v24, s28
    v_perm_b32 v71, v28, v24, s29
    v_perm_b32 v72, v5, v1, s28
    v_perm_b32 v76, v5, v1, s29
    v_perm_b32 v73, v13, v9, s28
    v_perm_b32 v77, v13, v9, s29
    v_perm_b32 v74, v21, v17, s28
    v_perm_b32 v78, v21, v17, s29
    v_perm_b32 v75, v29, v25, s28
    v_perm_b32 v79, v29, v25, s29
    v_perm_b32 v80, v6, v2, s28
    v_perm_b32 v84, v6, v2, s29
    v_perm_b32 v81, v14, v10, s28
    v_perm_b32 v85, v14, v10, s29
    v_perm_b32 v82, v22, v18, s28
    v_perm_b32 v86, v22, v18, s29
    v_perm_b32 v83, v30, v26, s28
    v_perm_b32 v87, v30, v26, s29
    v_perm_b32 v88, v7, v3, s28
    v_perm_b32 v92, v7, v3, s29
    v_perm_b32 v89, v15, v11, s28
    v_perm_b32 v93, v15, v11, s29
    v_perm_b32 v90, v23, v19, s28
    v_perm_b32 v94, v23, v19, s29
    v_perm_b32 v91, v31, v27, s28
    v_perm_b32 v95, v31, v27, s29
    v_perm_b32 v0, v36, v32, s28
    v_perm_b32 v4, v36, v32, s29
    v_perm_b32 v1, v44, v40, s28
    v_perm_b32 v5, v44, v40, s29
    v_perm_b32 v2, v52, v48, s28
    v_perm_b32 v6, v52, v48, s29
    v_perm_b32 v3, v60, v56, s28
    v_perm_b32 v7, v60, v56, s29
    v_perm_b32 v8, v37, v33, s28
    v_perm_b32 v12, v37, v33, s29
    v_perm_b32 v9, v45, v41, s28
    v_perm_b32 v13, v45, v41, s29
    v_perm_b32 v10, v53, v49, s28
    v_perm_b32 v14, v53, v49, s29
    v_perm_b32 v11, v61, v57, s28
    v_perm_b32 v15, v61, v57, s29
    v_perm_b32 v16, v38, v34, s28
    v_perm_b32 v20, v38, v34, s29
    v_perm_b32 v17, v46, v42, s28
    v_perm_b32 v21, v46, v42, s29
    v_perm_b32 v18, v54, v50, s28
    v_perm_b32 v22, v54, v50, s29
    v_perm_b32 v19, v62, v58, s28
    v_perm_b32 v23, v62, v58, s29
    v_perm_b32 v24, v39, v35, s28
    v_perm_b32 v28, v39, v35, s29
    v_perm_b32 v25, v47, v43, s28
    v_perm_b32 v29, v47, v43, s29
    v_perm_b32 v26, v55, v51, s28
    v_perm_b32 v30, v55, v51, s29
    v_perm_b32 v27, v63, v59, s28
    v_perm_b32 v31, v63, v59, s29
K12_XP_N:
    s_lshl_b32 s36, s40, 3
    s_sub_i32 s36, s36, 24
    s_max_i32 s36, s36, 1
    s_mov_b32 s37, 131072
K12_GL0:
    v_mov_b32 v240, 155648
    ds_read_b32 v240, v240
    s_waitcnt lgkmcnt(0)
    v_cmp_gt_u32 vcc, s36, v240
    s_sub_u32 s37, s37, 1
    s_cmp_eq_u32 s37, 0
    s_cbranch_scc1 K12_GT0
    s_cbranch_vccz K12_GT0
    s_sleep 2
    s_branch K12_GL0
K12_GT0:
    s_lshl_b32 s36, s40, 2
    s_add_u32 s36, s36, 155840
    s_mov_b64 exec, 1
    v_mov_b32 v240, s36
    v_mov_b32 v241, 1
    ds_add_u32 v240, v241
    s_mov_b64 exec, -1
    s_mov_b32 s37, 131072
K12_BL0:
    v_mov_b32 v240, s36
    ds_read_b32 v240, v240
    s_waitcnt lgkmcnt(0)
    v_cmp_gt_u32 vcc, 4, v240
    s_sub_u32 s37, s37, 1
    s_cmp_eq_u32 s37, 0
    s_cbranch_scc1 K12_BT0
    s_cbranch_vccz K12_BT0
    s_sleep 1
    s_branch K12_BL0
K12_BT0:
    s_add_u32 s42, s40, 1
    s_lshl_b32 s36, s42, 7
    s_add_u32 s36, s36, s22
    s_lshr_b32 s37, s36, 9
    s_lshl_b32 s37, s37, 19
    s_and_b32 s36, s36, 511
    s_lshl_b32 s36, s36, 10
    s_add_u32 s36, s36, s37
    s_add_u32 s36, s36, s33
    buffer_load_dwordx4 v[96:99], v250, s[8:11], s36 offen
    s_add_u32 s36, s36, 0x100000
    buffer_load_dwordx4 v[100:103], v250, s[8:11], s36 offen
    s_add_u32 s36, s36, 0x100000
    buffer_load_dwordx4 v[104:107], v250, s[8:11], s36 offen
    s_add_u32 s36, s36, 0x100000
    buffer_load_dwordx4 v[108:111], v250, s[8:11], s36 offen
    s_add_u32 s36, s36, 0x100000
    buffer_load_dwordx4 v[112:115], v250, s[8:11], s36 offen
    s_add_u32 s36, s36, 0x100000
    buffer_load_dwordx4 v[116:119], v250, s[8:11], s36 offen
    s_add_u32 s36, s36, 0x100000
    buffer_load_dwordx4 v[120:123], v250, s[8:11], s36 offen
    s_add_u32 s36, s36, 0x100000
    buffer_load_dwordx4 v[124:127], v250, s[8:11], s36 offen
    s_cmp_eq_u32 s27, 0
    s_cbranch_scc1 K12_XP_E
    s_mul_i32 s31, s25, 684032
    s_mul_i32 s39, s40, 85504
    s_add_u32 s39, s39, s31
    s_lshl_b32 s36, s30, 7
    s_add_u32 s39, s39, s36
    v_bfe_u32 v249, v254, 4, 2
    v_bfe_u32 v240, v254, 8, 1
    v_lshl_add_u32 v249, v240, 2, v249
    s_add_u32 s36, s30, 7
    s_cmp_ge_u32 s30, 160
    s_cselect_b32 s36, s36, s30
    s_cmp_eq_u32 s25, 1
    s_cselect_b32 s36, s36, s30
    s_lshr_b32 s36, s36, 1
    s_and_b32 s36, s36, 7
    v_xor_b32 v249, s36, v249
    v_lshl_add_u32 v249, v249, 4, v252
    s_cmp_eq_u32 s26, 2
    s_cselect_b32 s36, 21889024, 0
    s_add_u32 s39, s39, s36
    s_cmp_eq_u32 s26, 2
    s_cbranch_scc1 K12_XS1597_HI
    s_setprio 1
    v_mfma_f32_16x16x32_bf16 v[32:35], v[160:163], v[64:67], 0
    v_mfma_f32_16x16x32_bf16 v[36:39], v[160:163], v[68:71], 0
    v_mfma_f32_16x16x32_bf16 v[40:43], v[160:163], v[72:75], 0
    v_mfma_f32_16x16x32_bf16 v[44:47], v[160:163], v[76:79], 0
    v_mfma_f32_16x16x32_bf16 v[48:51], v[160:163], v[80:83], 0
    v_mfma_f32_16x16x32_bf16 v[52:55], v[160:163], v[84:87], 0
    v_mfma_f32_16x16x32_bf16 v[56:59], v[160:163], v[88:91], 0
    v_mfma_f32_16x16x32_bf16 v[60:63], v[160:163], v[92:95], 0
    v_mfma_f32_16x16x32_bf16 v[32:35], v[192:195], v[64:67], v[32:35]
    v_mfma_f32_16x16x32_bf16 v[36:39], v[192:195], v[68:71], v[36:39]
    v_mfma_f32_16x16x32_bf16 v[40:43], v[192:195], v[72:75], v[40:43]
    v_mfma_f32_16x16x32_bf16 v[44:47], v[192:195], v[76:79], v[44:47]
    v_mfma_f32_16x16x32_bf16 v[48:51], v[192:195], v[80:83], v[48:51]
    v_mfma_f32_16x16x32_bf16 v[52:55], v[192:195], v[84:87], v[52:55]
    v_mfma_f32_16x16x32_bf16 v[56:59], v[192:195], v[88:91], v[56:59]
    v_mfma_f32_16x16x32_bf16 v[60:63], v[192:195], v[92:95], v[60:63]
    v_mfma_f32_16x16x32_bf16 v[32:35], v[164:167], v[0:3], v[32:35]
    v_mfma_f32_16x16x32_bf16 v[36:39], v[164:167], v[4:7], v[36:39]
    v_mfma_f32_16x16x32_bf16 v[40:43], v[164:167], v[8:11], v[40:43]
    v_mfma_f32_16x16x32_bf16 v[44:47], v[164:167], v[12:15], v[44:47]
    v_mfma_f32_16x16x32_bf16 v[48:51], v[164:167], v[16:19], v[48:51]
    v_mfma_f32_16x16x32_bf16 v[52:55], v[164:167], v[20:23], v[52:55]
    v_mfma_f32_16x16x32_bf16 v[56:59], v[164:167], v[24:27], v[56:59]
    v_mfma_f32_16x16x32_bf16 v[60:63], v[164:167], v[28:31], v[60:63]
    v_mfma_f32_16x16x32_bf16 v[32:35], v[196:199], v[0:3], v[32:35]
    v_mfma_f32_16x16x32_bf16 v[36:39], v[196:199], v[4:7], v[36:39]
    v_mfma_f32_16x16x32_bf16 v[40:43], v[196:199], v[8:11], v[40:43]
    v_mfma_f32_16x16x32_bf16 v[44:47], v[196:199], v[12:15], v[44:47]
    v_mfma_f32_16x16x32_bf16 v[48:51], v[196:199], v[16:19], v[48:51]
    v_mfma_f32_16x16x32_bf16 v[52:55], v[196:199], v[20:23], v[52:55]
    v_mfma_f32_16x16x32_bf16 v[56:59], v[196:199], v[24:27], v[56:59]
    v_mfma_f32_16x16x32_bf16 v[60:63], v[196:199], v[28:31], v[60:63]
    s_setprio 0
    s_nop 7
    v_cvt_pk_bf16_f32 v240, v32, v36
    v_cvt_pk_bf16_f32 v241, v40, v44
    v_cvt_pk_bf16_f32 v242, v48, v52
    v_cvt_pk_bf16_f32 v243, v56, v60
    buffer_store_dwordx4 v[240:243], v249, s[12:15], s39 offen sc1
    s_add_u32 s39, s39, 2736128
    v_cvt_pk_bf16_f32 v244, v33, v37
    v_cvt_pk_bf16_f32 v245, v41, v45
    v_cvt_pk_bf16_f32 v246, v49, v53
    v_cvt_pk_bf16_f32 v247, v57, v61
    buffer_store_dwordx4 v[244:247], v249, s[12:15], s39 offen sc1
    s_add_u32 s39, s39, 2736128
    v_cvt_pk_bf16_f32 v240, v34, v38
    v_cvt_pk_bf16_f32 v241, v42, v46
    v_cvt_pk_bf16_f32 v242, v50, v54
    v_cvt_pk_bf16_f32 v243, v58, v62
    buffer_store_dwordx4 v[240:243], v249, s[12:15], s39 offen sc1
    s_add_u32 s39, s39, 2736128
    v_cvt_pk_bf16_f32 v244, v35, v39
    v_cvt_pk_bf16_f32 v245, v43, v47
    v_cvt_pk_bf16_f32 v246, v51, v55
    v_cvt_pk_bf16_f32 v247, v59, v63
    buffer_store_dwordx4 v[244:247], v249, s[12:15], s39 offen sc1
    s_add_u32 s39, s39, 2736128
    s_cmp_lg_u32 s26, 1
    s_cbranch_scc1 K12_UT0
    s_cmp_lt_u32 s40, 4
    s_cbranch_scc1 K12_UT0
    s_lshl_b32 s36, s40, 3
    s_sub_i32 s36, s36, 20
    s_max_i32 s36, s36, 1
    s_mov_b32 s37, 131072
K12_UL0:
    v_mov_b32 v255, 155648
    ds_read_b32 v255, v255
    s_waitcnt lgkmcnt(0)
    v_cmp_gt_u32 vcc, s36, v255
    s_sub_u32 s37, s37, 1
    s_cmp_eq_u32 s37, 0
    s_cbranch_scc1 K12_UT0
    s_cbranch_vccz K12_UT0
    s_sleep 2
    s_branch K12_UL0
K12_UT0:
    s_setprio 1
    v_mfma_f32_16x16x32_bf16 v[32:35], v[168:171], v[64:67], 0
    v_mfma_f32_16x16x32_bf16 v[36:39], v[168:171], v[68:71], 0
    v_mfma_f32_16x16x32_bf16 v[40:43], v[168:171], v[72:75], 0
    v_mfma_f32_16x16x32_bf16 v[44:47], v[168:171], v[76:79], 0
    v_mfma_f32_16x16x32_bf16 v[48:51], v[168:171], v[80:83], 0
    v_mfma_f32_16x16x32_bf16 v[52:55], v[168:171], v[84:87], 0
    v_mfma_f32_16x16x32_bf16 v[56:59], v[168:171], v[88:91], 0
    v_mfma_f32_16x16x32_bf16 v[60:63], v[168:171], v[92:95], 0
    v_mfma_f32_16x16x32_bf16 v[32:35], v[200:203], v[64:67], v[32:35]
    v_mfma_f32_16x16x32_bf16 v[36:39], v[200:203], v[68:71], v[36:39]
    v_mfma_f32_16x16x32_bf16 v[40:43], v[200:203], v[72:75], v[40:43]
    v_mfma_f32_16x16x32_bf16 v[44:47], v[200:203], v[76:79], v[44:47]
    v_mfma_f32_16x16x32_bf16 v[48:51], v[200:203], v[80:83], v[48:51]
    v_mfma_f32_16x16x32_bf16 v[52:55], v[200:203], v[84:87], v[52:55]
    v_mfma_f32_16x16x32_bf16 v[56:59], v[200:203], v[88:91], v[56:59]
    v_mfma_f32_16x16x32_bf16 v[60:63], v[200:203], v[92:95], v[60:63]
    v_mfma_f32_16x16x32_bf16 v[32:35], v[172:175], v[0:3], v[32:35]
    v_mfma_f32_16x16x32_bf16 v[36:39], v[172:175], v[4:7], v[36:39]
    v_mfma_f32_16x16x32_bf16 v[40:43], v[172:175], v[8:11], v[40:43]
    v_mfma_f32_16x16x32_bf16 v[44:47], v[172:175], v[12:15], v[44:47]
    v_mfma_f32_16x16x32_bf16 v[48:51], v[172:175], v[16:19], v[48:51]
    v_mfma_f32_16x16x32_bf16 v[52:55], v[172:175], v[20:23], v[52:55]
    v_mfma_f32_16x16x32_bf16 v[56:59], v[172:175], v[24:27], v[56:59]
    v_mfma_f32_16x16x32_bf16 v[60:63], v[172:175], v[28:31], v[60:63]
    v_mfma_f32_16x16x32_bf16 v[32:35], v[204:207], v[0:3], v[32:35]
    v_mfma_f32_16x16x32_bf16 v[36:39], v[204:207], v[4:7], v[36:39]
    v_mfma_f32_16x16x32_bf16 v[40:43], v[204:207], v[8:11], v[40:43]
    v_mfma_f32_16x16x32_bf16 v[44:47], v[204:207], v[12:15], v[44:47]
    v_mfma_f32_16x16x32_bf16 v[48:51], v[204:207], v[16:19], v[48:51]
    v_mfma_f32_16x16x32_bf16 v[52:55], v[204:207], v[20:23], v[52:55]
    v_mfma_f32_16x16x32_bf16 v[56:59], v[204:207], v[24:27], v[56:59]
    v_mfma_f32_16x16x32_bf16 v[60:63], v[204:207], v[28:31], v[60:63]
    s_setprio 0
    s_nop 7
    v_cvt_pk_bf16_f32 v240, v32, v36
    v_cvt_pk_bf16_f32 v241, v40, v44
    v_cvt_pk_bf16_f32 v242, v48, v52
    v_cvt_pk_bf16_f32 v243, v56, v60
    buffer_store_dwordx4 v[240:243], v249, s[12:15], s39 offen sc1
    s_add_u32 s39, s39, 2736128
    v_cvt_pk_bf16_f32 v244, v33, v37
    v_cvt_pk_bf16_f32 v245, v41, v45
    v_cvt_pk_bf16_f32 v246, v49, v53
    v_cvt_pk_bf16_f32 v247, v57, v61
    buffer_store_dwordx4 v[244:247], v249, s[12:15], s39 offen sc1
    s_add_u32 s39, s39, 2736128
    v_cvt_pk_bf16_f32 v240, v34, v38
    v_cvt_pk_bf16_f32 v241, v42, v46
    v_cvt_pk_bf16_f32 v242, v50, v54
    v_cvt_pk_bf16_f32 v243, v58, v62
    buffer_store_dwordx4 v[240:243], v249, s[12:15], s39 offen sc1
    s_add_u32 s39, s39, 2736128
    v_cvt_pk_bf16_f32 v244, v35, v39
    v_cvt_pk_bf16_f32 v245, v43, v47
    v_cvt_pk_bf16_f32 v246, v51, v55
    v_cvt_pk_bf16_f32 v247, v59, v63
    buffer_store_dwordx4 v[244:247], v249, s[12:15], s39 offen sc1
    s_add_u32 s39, s39, 2736128
    s_cmp_eq_u32 s26, 1
    s_cbranch_scc1 K12_XS1597_END
    s_cmp_lg_u32 s26, 0
    s_cbranch_scc1 K12_UT1
    s_cmp_lt_u32 s40, 4
    s_cbranch_scc1 K12_UT1
    s_lshl_b32 s36, s40, 3
    s_sub_i32 s36, s36, 20
    s_max_i32 s36, s36, 1
    s_mov_b32 s37, 131072
K12_UL1:
    v_mov_b32 v255, 155648
    ds_read_b32 v255, v255
    s_waitcnt lgkmcnt(0)
    v_cmp_gt_u32 vcc, s36, v255
    s_sub_u32 s37, s37, 1
    s_cmp_eq_u32 s37, 0
    s_cbranch_scc1 K12_UT1
    s_cbranch_vccz K12_UT1
    s_sleep 2
    s_branch K12_UL1
K12_UT1:
K12_XS1597_HI:
    s_setprio 1
    v_mfma_f32_16x16x32_bf16 v[32:35], v[176:179], v[64:67], 0
    v_mfma_f32_16x16x32_bf16 v[36:39], v[176:179], v[68:71], 0
    v_mfma_f32_16x16x32_bf16 v[40:43], v[176:179], v[72:75], 0
    v_mfma_f32_16x16x32_bf16 v[44:47], v[176:179], v[76:79], 0
    v_mfma_f32_16x16x32_bf16 v[48:51], v[176:179], v[80:83], 0
    v_mfma_f32_16x16x32_bf16 v[52:55], v[176:179], v[84:87], 0
    v_mfma_f32_16x16x32_bf16 v[56:59], v[176:179], v[88:91], 0
    v_mfma_f32_16x16x32_bf16 v[60:63], v[176:179], v[92:95], 0
    v_mfma_f32_16x16x32_bf16 v[32:35], v[208:211], v[64:67], v[32:35]
    v_mfma_f32_16x16x32_bf16 v[36:39], v[208:211], v[68:71], v[36:39]
    v_mfma_f32_16x16x32_bf16 v[40:43], v[208:211], v[72:75], v[40:43]
    v_mfma_f32_16x16x32_bf16 v[44:47], v[208:211], v[76:79], v[44:47]
    v_mfma_f32_16x16x32_bf16 v[48:51], v[208:211], v[80:83], v[48:51]
    v_mfma_f32_16x16x32_bf16 v[52:55], v[208:211], v[84:87], v[52:55]
    v_mfma_f32_16x16x32_bf16 v[56:59], v[208:211], v[88:91], v[56:59]
    v_mfma_f32_16x16x32_bf16 v[60:63], v[208:211], v[92:95], v[60:63]
    v_mfma_f32_16x16x32_bf16 v[32:35], v[180:183], v[0:3], v[32:35]
    v_mfma_f32_16x16x32_bf16 v[36:39], v[180:183], v[4:7], v[36:39]
    v_mfma_f32_16x16x32_bf16 v[40:43], v[180:183], v[8:11], v[40:43]
    v_mfma_f32_16x16x32_bf16 v[44:47], v[180:183], v[12:15], v[44:47]
    v_mfma_f32_16x16x32_bf16 v[48:51], v[180:183], v[16:19], v[48:51]
    v_mfma_f32_16x16x32_bf16 v[52:55], v[180:183], v[20:23], v[52:55]
    v_mfma_f32_16x16x32_bf16 v[56:59], v[180:183], v[24:27], v[56:59]
    v_mfma_f32_16x16x32_bf16 v[60:63], v[180:183], v[28:31], v[60:63]
    v_mfma_f32_16x16x32_bf16 v[32:35], v[212:215], v[0:3], v[32:35]
    v_mfma_f32_16x16x32_bf16 v[36:39], v[212:215], v[4:7], v[36:39]
    v_mfma_f32_16x16x32_bf16 v[40:43], v[212:215], v[8:11], v[40:43]
    v_mfma_f32_16x16x32_bf16 v[44:47], v[212:215], v[12:15], v[44:47]
    v_mfma_f32_16x16x32_bf16 v[48:51], v[212:215], v[16:19], v[48:51]
    v_mfma_f32_16x16x32_bf16 v[52:55], v[212:215], v[20:23], v[52:55]
    v_mfma_f32_16x16x32_bf16 v[56:59], v[212:215], v[24:27], v[56:59]
    v_mfma_f32_16x16x32_bf16 v[60:63], v[212:215], v[28:31], v[60:63]
    s_setprio 0
    s_nop 7
    v_cvt_pk_bf16_f32 v240, v32, v36
    v_cvt_pk_bf16_f32 v241, v40, v44
    v_cvt_pk_bf16_f32 v242, v48, v52
    v_cvt_pk_bf16_f32 v243, v56, v60
    buffer_store_dwordx4 v[240:243], v249, s[12:15], s39 offen sc1
    s_add_u32 s39, s39, 2736128
    v_cvt_pk_bf16_f32 v244, v33, v37
    v_cvt_pk_bf16_f32 v245, v41, v45
    v_cvt_pk_bf16_f32 v246, v49, v53
    v_cvt_pk_bf16_f32 v247, v57, v61
    buffer_store_dwordx4 v[244:247], v249, s[12:15], s39 offen sc1
    s_add_u32 s39, s39, 2736128
    v_cvt_pk_bf16_f32 v240, v34, v38
    v_cvt_pk_bf16_f32 v241, v42, v46
    v_cvt_pk_bf16_f32 v242, v50, v54
    v_cvt_pk_bf16_f32 v243, v58, v62
    buffer_store_dwordx4 v[240:243], v249, s[12:15], s39 offen sc1
    s_add_u32 s39, s39, 2736128
    v_cvt_pk_bf16_f32 v244, v35, v39
    v_cvt_pk_bf16_f32 v245, v43, v47
    v_cvt_pk_bf16_f32 v246, v51, v55
    v_cvt_pk_bf16_f32 v247, v59, v63
    buffer_store_dwordx4 v[244:247], v249, s[12:15], s39 offen sc1
    s_add_u32 s39, s39, 2736128
    s_cmp_lg_u32 s26, 2
    s_cbranch_scc1 K12_UT2
    s_cmp_lt_u32 s40, 4
    s_cbranch_scc1 K12_UT2
    s_lshl_b32 s36, s40, 3
    s_sub_i32 s36, s36, 20
    s_max_i32 s36, s36, 1
    s_mov_b32 s37, 131072
K12_UL2:
    v_mov_b32 v255, 155648
    ds_read_b32 v255, v255
    s_waitcnt lgkmcnt(0)
    v_cmp_gt_u32 vcc, s36, v255
    s_sub_u32 s37, s37, 1
    s_cmp_eq_u32 s37, 0
    s_cbranch_scc1 K12_UT2
    s_cbranch_vccz K12_UT2
    s_sleep 2
    s_branch K12_UL2
K12_UT2:
    s_setprio 1
    v_mfma_f32_16x16x32_bf16 v[32:35], v[184:187], v[64:67], 0
    v_mfma_f32_16x16x32_bf16 v[36:39], v[184:187], v[68:71], 0
    v_mfma_f32_16x16x32_bf16 v[40:43], v[184:187], v[72:75], 0
    v_mfma_f32_16x16x32_bf16 v[44:47], v[184:187], v[76:79], 0
    v_mfma_f32_16x16x32_bf16 v[48:51], v[184:187], v[80:83], 0
    v_mfma_f32_16x16x32_bf16 v[52:55], v[184:187], v[84:87], 0
    v_mfma_f32_16x16x32_bf16 v[56:59], v[184:187], v[88:91], 0
    v_mfma_f32_16x16x32_bf16 v[60:63], v[184:187], v[92:95], 0
    v_mfma_f32_16x16x32_bf16 v[32:35], v[216:219], v[64:67], v[32:35]
    v_mfma_f32_16x16x32_bf16 v[36:39], v[216:219], v[68:71], v[36:39]
    v_mfma_f32_16x16x32_bf16 v[40:43], v[216:219], v[72:75], v[40:43]
    v_mfma_f32_16x16x32_bf16 v[44:47], v[216:219], v[76:79], v[44:47]
    v_mfma_f32_16x16x32_bf16 v[48:51], v[216:219], v[80:83], v[48:51]
    v_mfma_f32_16x16x32_bf16 v[52:55], v[216:219], v[84:87], v[52:55]
    v_mfma_f32_16x16x32_bf16 v[56:59], v[216:219], v[88:91], v[56:59]
    v_mfma_f32_16x16x32_bf16 v[60:63], v[216:219], v[92:95], v[60:63]
    v_mfma_f32_16x16x32_bf16 v[32:35], v[188:191], v[0:3], v[32:35]
    v_mfma_f32_16x16x32_bf16 v[36:39], v[188:191], v[4:7], v[36:39]
    v_mfma_f32_16x16x32_bf16 v[40:43], v[188:191], v[8:11], v[40:43]
    v_mfma_f32_16x16x32_bf16 v[44:47], v[188:191], v[12:15], v[44:47]
    v_mfma_f32_16x16x32_bf16 v[48:51], v[188:191], v[16:19], v[48:51]
    v_mfma_f32_16x16x32_bf16 v[52:55], v[188:191], v[20:23], v[52:55]
    v_mfma_f32_16x16x32_bf16 v[56:59], v[188:191], v[24:27], v[56:59]
    v_mfma_f32_16x16x32_bf16 v[60:63], v[188:191], v[28:31], v[60:63]
    v_mfma_f32_16x16x32_bf16 v[32:35], v[220:223], v[0:3], v[32:35]
    v_mfma_f32_16x16x32_bf16 v[36:39], v[220:223], v[4:7], v[36:39]
    v_mfma_f32_16x16x32_bf16 v[40:43], v[220:223], v[8:11], v[40:43]
    v_mfma_f32_16x16x32_bf16 v[44:47], v[220:223], v[12:15], v[44:47]
    v_mfma_f32_16x16x32_bf16 v[48:51], v[220:223], v[16:19], v[48:51]
    v_mfma_f32_16x16x32_bf16 v[52:55], v[220:223], v[20:23], v[52:55]
    v_mfma_f32_16x16x32_bf16 v[56:59], v[220:223], v[24:27], v[56:59]
    v_mfma_f32_16x16x32_bf16 v[60:63], v[220:223], v[28:31], v[60:63]
    s_setprio 0
    s_nop 7
    v_cvt_pk_bf16_f32 v240, v32, v36
    v_cvt_pk_bf16_f32 v241, v40, v44
    v_cvt_pk_bf16_f32 v242, v48, v52
    v_cvt_pk_bf16_f32 v243, v56, v60
    buffer_store_dwordx4 v[240:243], v249, s[12:15], s39 offen sc1
    s_add_u32 s39, s39, 2736128
    v_cvt_pk_bf16_f32 v244, v33, v37
    v_cvt_pk_bf16_f32 v245, v41, v45
    v_cvt_pk_bf16_f32 v246, v49, v53
    v_cvt_pk_bf16_f32 v247, v57, v61
    buffer_store_dwordx4 v[244:247], v249, s[12:15], s39 offen sc1
    s_add_u32 s39, s39, 2736128
    v_cvt_pk_bf16_f32 v240, v34, v38
    v_cvt_pk_bf16_f32 v241, v42, v46
    v_cvt_pk_bf16_f32 v242, v50, v54
    v_cvt_pk_bf16_f32 v243, v58, v62
    buffer_store_dwordx4 v[240:243], v249, s[12:15], s39 offen sc1
    s_add_u32 s39, s39, 2736128
    v_cvt_pk_bf16_f32 v244, v35, v39
    v_cvt_pk_bf16_f32 v245, v43, v47
    v_cvt_pk_bf16_f32 v246, v51, v55
    v_cvt_pk_bf16_f32 v247, v59, v63
    buffer_store_dwordx4 v[244:247], v249, s[12:15], s39 offen sc1
K12_XS1597_END:
    s_mov_b32 s41, s40
    s_add_u32 s40, s40, 1
    s_cmp_eq_u32 s41, 3
    s_cbranch_scc0 K12_ES3
    s_waitcnt vmcnt(0)
    s_mov_b32 s34, -1
    s_cmp_ge_u32 s41, 8
    s_cbranch_scc1 K12_SG4
    s_lshl_b32 s36, s41, 2
    s_add_u32 s37, s36, 155680
    s_mov_b64 exec, 1
    v_mov_b32 v255, s37
    v_mov_b32 v240, 1
    ds_add_rtn_u32 v240, v255, v240
    s_waitcnt lgkmcnt(0)
    v_readfirstlane_b32 s37, v240
    s_nop 3
    s_cmp_eq_u32 s37, 3
    s_cbranch_scc0 K12_SH4
    s_lshl_b32 s36, s36, 8
    v_mov_b32 v255, 1
    v_mov_b32 v240, s36
    buffer_atomic_add v255, v240, s[60:63], 0 offen sc0 sc1
    s_mov_b32 s34, s41
K12_SH4:
    s_mov_b64 exec, -1
K12_SG4:
    s_waitcnt vmcnt(0)
    s_cmp_ge_u32 s34, 8
    s_cbranch_scc1 K12_PB5
    v_readfirstlane_b32 s37, v255
    s_nop 3
    s_cmp_eq_u32 s37, 255
    s_cbranch_scc0 K12_PB5
    s_lshl_b32 s36, s34, 4
    s_add_u32 s36, s36, 16384
    s_mov_b64 exec, 1
    v_mov_b32 v255, 1
    v_mov_b32 v240, s36
    buffer_store_dword v255, v240, s[60:63], 0 offen sc1
    s_mov_b64 exec, -1
K12_PB5:
    s_mov_b32 s34, -1
    s_mov_b32 s41, -1
K12_ES3:
    s_waitcnt vmcnt(8)
    s_branch K12_XP_F
K12_XP_E:
    s_mov_b32 s41, s40
    s_add_u32 s40, s40, 1
    s_cmp_eq_u32 s41, 3
    s_cbranch_scc0 K12_ES6
    s_waitcnt vmcnt(0)
    s_mov_b32 s34, -1
    s_cmp_ge_u32 s41, 8
    s_cbranch_scc1 K12_SG7
    s_lshl_b32 s36, s41, 2
    s_add_u32 s37, s36, 155680
    s_mov_b64 exec, 1
    v_mov_b32 v255, s37
    v_mov_b32 v240, 1
    ds_add_rtn_u32 v240, v255, v240
    s_waitcnt lgkmcnt(0)
    v_readfirstlane_b32 s37, v240
    s_nop 3
    s_cmp_eq_u32 s37, 3
    s_cbranch_scc0 K12_SH7
    s_lshl_b32 s36, s36, 8
    v_mov_b32 v255, 1
    v_mov_b32 v240, s36
    buffer_atomic_add v255, v240, s[60:63], 0 offen sc0 sc1
    s_mov_b32 s34, s41
K12_SH7:
    s_mov_b64 exec, -1
K12_SG7:
    s_waitcnt vmcnt(0)
    s_cmp_ge_u32 s34, 8
    s_cbranch_scc1 K12_PB8
    v_readfirstlane_b32 s37, v255
    s_nop 3
    s_cmp_eq_u32 s37, 255
    s_cbranch_scc0 K12_PB8
    s_lshl_b32 s36, s34, 4
    s_add_u32 s36, s36, 16384
    s_mov_b64 exec, 1
    v_mov_b32 v255, 1
    v_mov_b32 v240, s36
    buffer_store_dword v255, v240, s[60:63], 0 offen sc1
    s_mov_b64 exec, -1
K12_PB8:
    s_mov_b32 s34, -1
    s_mov_b32 s41, -1
K12_ES6:
    s_waitcnt vmcnt(0)
K12_XP_F:
    s_cmp_ge_u32 s34, 8
    s_cbranch_scc1 K12_PB9
    v_readfirstlane_b32 s37, v255
    s_nop 3
    s_cmp_eq_u32 s37, 255
    s_cbranch_scc0 K12_PB9
    s_lshl_b32 s36, s34, 4
    s_add_u32 s36, s36, 16384
    s_mov_b64 exec, 1
    v_mov_b32 v255, 1
    v_mov_b32 v240, s36
    buffer_store_dword v255, v240, s[60:63], 0 offen sc1
    s_mov_b64 exec, -1
K12_PB9:
    s_cmp_ge_u32 s40, 8
    s_cbranch_scc1 K12_PFIN
K12_WENTRY:
    s_waitcnt vmcnt(0)
    s_mov_b32 s34, -1
    s_cmp_ge_u32 s41, 8
    s_cbranch_scc1 K12_SG10
    s_lshl_b32 s36, s41, 2
    s_add_u32 s37, s36, 155680
    s_mov_b64 exec, 1
    v_mov_b32 v255, s37
    v_mov_b32 v240, 1
    ds_add_rtn_u32 v240, v255, v240
    s_waitcnt lgkmcnt(0)
    v_readfirstlane_b32 s37, v240
    s_nop 3
    s_cmp_eq_u32 s37, 3
    s_cbranch_scc0 K12_SH10
    s_lshl_b32 s36, s36, 8
    v_mov_b32 v255, 1
    v_mov_b32 v240, s36
    buffer_atomic_add v255, v240, s[60:63], 0 offen sc0 sc1
    s_mov_b32 s34, s41
K12_SH10:
    s_mov_b64 exec, -1
K12_SG10:
    s_cmp_ge_u32 s34, 8
    s_cbranch_scc1 K12_EP11
    s_waitcnt vmcnt(0)
    s_cmp_ge_u32 s34, 8
    s_cbranch_scc1 K12_PB12
    v_readfirstlane_b32 s37, v255
    s_nop 3
    s_cmp_eq_u32 s37, 255
    s_cbranch_scc0 K12_PB12
    s_lshl_b32 s36, s34, 4
    s_add_u32 s36, s36, 16384
    s_mov_b64 exec, 1
    v_mov_b32 v255, 1
    v_mov_b32 v240, s36
    buffer_store_dword v255, v240, s[60:63], 0 offen sc1
    s_mov_b64 exec, -1
K12_PB12:
    s_mov_b32 s34, -1
K12_EP11:
    v_perm_b32 v64, v100, v96, s28
    v_perm_b32 v68, v100, v96, s29
    v_perm_b32 v65, v108, v104, s28
    v_perm_b32 v69, v108, v104, s29
    v_perm_b32 v66, v116, v112, s28
    v_perm_b32 v70, v116, v112, s29
    v_perm_b32 v67, v124, v120, s28
    v_perm_b32 v71, v124, v120, s29
    v_perm_b32 v72, v101, v97, s28
    v_perm_b32 v76, v101, v97, s29
    v_perm_b32 v73, v109, v105, s28
    v_perm_b32 v77, v109, v105, s29
    v_perm_b32 v74, v117, v113, s28
    v_perm_b32 v78, v117, v113, s29
    v_perm_b32 v75, v125, v121, s28
    v_perm_b32 v79, v125, v121, s29
    v_perm_b32 v80, v102, v98, s28
    v_perm_b32 v84, v102, v98, s29
    v_perm_b32 v81, v110, v106, s28
    v_perm_b32 v85, v110, v106, s29
    v_perm_b32 v82, v118, v114, s28
    v_perm_b32 v86, v118, v114, s29
    v_perm_b32 v83, v126, v122, s28
    v_perm_b32 v87, v126, v122, s29
    v_perm_b32 v88, v103, v99, s28
    v_perm_b32 v92, v103, v99, s29
    v_perm_b32 v89, v111, v107, s28
    v_perm_b32 v93, v111, v107, s29
    v_perm_b32 v90, v119, v115, s28
    v_perm_b32 v94, v119, v115, s29
    v_perm_b32 v91, v127, v123, s28
    v_perm_b32 v95, v127, v123, s29
    s_lshl_b32 s36, s40, 3
    s_sub_i32 s36, s36, 24
    s_max_i32 s36, s36, 1
    s_mov_b32 s37, 131072
K12_GL1:
    v_mov_b32 v240, 155648
    ds_read_b32 v240, v240
    s_waitcnt lgkmcnt(0)
    v_cmp_gt_u32 vcc, s36, v240
    s_sub_u32 s37, s37, 1
    s_cmp_eq_u32 s37, 0
    s_cbranch_scc1 K12_GT1
    s_cbranch_vccz K12_GT1
    s_sleep 2
    s_branch K12_GL1
K12_GT1:
    s_lshl_b32 s36, s40, 2
    s_add_u32 s36, s36, 155840
    s_mov_b64 exec, 1
    v_mov_b32 v240, s36
    v_mov_b32 v241, 1
    ds_add_u32 v240, v241
    s_mov_b64 exec, -1
    s_mov_b32 s37, 131072
K12_BL1:
    v_mov_b32 v240, s36
    ds_read_b32 v240, v240
    s_waitcnt lgkmcnt(0)
    v_cmp_gt_u32 vcc, 4, v240
    s_sub_u32 s37, s37, 1
    s_cmp_eq_u32 s37, 0
    s_cbranch_scc1 K12_BT1
    s_cbranch_vccz K12_BT1
    s_sleep 1
    s_branch K12_BL1
K12_BT1:
    s_add_u32 s42, s40, 1
    s_mul_i32 s36, s42, 85
    s_add_u32 s36, s36, s2
    s_and_b32 s36, s36, 255
    s_mul_hi_u32 s37, s36, 0x55555556
    s_mul_i32 s38, s37, 3
    s_cmp_eq_u32 s38, s36
    s_cselect_b32 s27, 1, 0
    s_cmp_lt_u32 s37, 78
    s_cselect_b32 s27, s27, 0
    s_add_u32 s37, s37, 89
    s_add_u32 s26, s21, 1
    s_cmp_eq_u32 s27, 1
    s_cselect_b32 s26, 0, s26
    s_and_b32 s36, s27, s21
    s_cselect_b32 s30, s37, s24
    s_cselect_b32 s25, 1, s49
    s_mov_b32 s27, 1
    s_cmp_eq_u32 s27, 0
    s_cbranch_scc1 K12_WP_N
    s_mul_i32 s36, s25, 16384000
    s_add_u32 s4, s52, s36
    s_addc_u32 s5, s53, 0
    s_and_b32 s5, s5, 0xffff
    s_lshl_b32 s36, s42, 8
    s_mul_i32 s37, s30, 98304
    s_add_u32 s36, s36, s37
    buffer_load_dwordx4 v[0:3], v248, s[4:7], s36 offen
    buffer_load_dwordx4 v[4:7], v248, s[4:7], s36 offen offset:2048
    s_add_u32 s36, s36, 4096
    buffer_load_dwordx4 v[8:11], v248, s[4:7], s36 offen
    buffer_load_dwordx4 v[12:15], v248, s[4:7], s36 offen offset:2048
    s_add_u32 s36, s36, 4096
    buffer_load_dwordx4 v[16:19], v248, s[4:7], s36 offen
    buffer_load_dwordx4 v[20:23], v248, s[4:7], s36 offen offset:2048
    s_add_u32 s36, s36, 4096
    buffer_load_dwordx4 v[24:27], v248, s[4:7], s36 offen
    buffer_load_dwordx4 v[28:31], v248, s[4:7], s36 offen offset:2048
    s_add_u32 s36, s36, 53248
    buffer_load_dwordx4 v[32:35], v248, s[4:7], s36 offen
    buffer_load_dwordx4 v[36:39], v248, s[4:7], s36 offen offset:2048
    s_add_u32 s36, s36, 4096
    buffer_load_dwordx4 v[40:43], v248, s[4:7], s36 offen
    buffer_load_dwordx4 v[44:47], v248, s[4:7], s36 offen offset:2048
    s_add_u32 s36, s36, 4096
    buffer_load_dwordx4 v[48:51], v248, s[4:7], s36 offen
    buffer_load_dwordx4 v[52:55], v248, s[4:7], s36 offen offset:2048
    s_add_u32 s36, s36, 4096
    buffer_load_dwordx4 v[56:59], v248, s[4:7], s36 offen
    buffer_load_dwordx4 v[60:63], v248, s[4:7], s36 offen offset:2048
    s_branch K12_WP_M
K12_WP_N:
K12_WP_M:
    s_lshl_b32 s36, s40, 7
    s_add_u32 s36, s36, s22
    s_and_b32 s37, s36, 3
    s_lshr_b32 s38, s36, 1
    s_and_b32 s38, s38, 4
    s_or_b32 s37, s37, s38
    v_bfe_u32 v253, v254, 5, 3
    v_xor_b32 v253, s37, v253
    v_lshl_add_u32 v253, v253, 5, v251
    s_lshl_b32 s36, s36, 9
    s_add_u32 s39, s36, s32
    s_setprio 1
    v_mfma_f32_16x16x32_bf16 v[128:131], v[224:227], v[64:67], 0
    v_mfma_f32_16x16x32_bf16 v[132:135], v[224:227], v[68:71], 0
    v_mfma_f32_16x16x32_bf16 v[136:139], v[224:227], v[72:75], 0
    v_mfma_f32_16x16x32_bf16 v[140:143], v[224:227], v[76:79], 0
    v_mfma_f32_16x16x32_bf16 v[144:147], v[224:227], v[80:83], 0
    v_mfma_f32_16x16x32_bf16 v[148:151], v[224:227], v[84:87], 0
    v_mfma_f32_16x16x32_bf16 v[152:155], v[224:227], v[88:91], 0
    v_mfma_f32_16x16x32_bf16 v[156:159], v[224:227], v[92:95], 0
    s_setprio 0
    s_nop 7
    v_cvt_pk_bf16_f32 v240, v128, v132
    v_cvt_pk_bf16_f32 v241, v136, v140
    v_cvt_pk_bf16_f32 v242, v144, v148
    v_cvt_pk_bf16_f32 v243, v152, v156
    buffer_store_dwordx4 v[240:243], v253, s[16:19], s39 offen sc1
    s_add_u32 s39, s39, 4194304
    v_cvt_pk_bf16_f32 v244, v129, v133
    v_cvt_pk_bf16_f32 v245, v137, v141
    v_cvt_pk_bf16_f32 v246, v145, v149
    v_cvt_pk_bf16_f32 v247, v153, v157
    buffer_store_dwordx4 v[244:247], v253, s[16:19], s39 offen sc1
    s_add_u32 s39, s39, 4194304
    v_cvt_pk_bf16_f32 v240, v130, v134
    v_cvt_pk_bf16_f32 v241, v138, v142
    v_cvt_pk_bf16_f32 v242, v146, v150
    v_cvt_pk_bf16_f32 v243, v154, v158
    buffer_store_dwordx4 v[240:243], v253, s[16:19], s39 offen sc1
    s_add_u32 s39, s39, 4194304
    v_cvt_pk_bf16_f32 v244, v131, v135
    v_cvt_pk_bf16_f32 v245, v139, v143
    v_cvt_pk_bf16_f32 v246, v147, v151
    v_cvt_pk_bf16_f32 v247, v155, v159
    buffer_store_dwordx4 v[244:247], v253, s[16:19], s39 offen sc1
    s_add_u32 s39, s39, 4194304
    s_setprio 1
    v_mfma_f32_16x16x32_bf16 v[128:131], v[228:231], v[64:67], 0
    v_mfma_f32_16x16x32_bf16 v[132:135], v[228:231], v[68:71], 0
    v_mfma_f32_16x16x32_bf16 v[136:139], v[228:231], v[72:75], 0
    v_mfma_f32_16x16x32_bf16 v[140:143], v[228:231], v[76:79], 0
    v_mfma_f32_16x16x32_bf16 v[144:147], v[228:231], v[80:83], 0
    v_mfma_f32_16x16x32_bf16 v[148:151], v[228:231], v[84:87], 0
    v_mfma_f32_16x16x32_bf16 v[152:155], v[228:231], v[88:91], 0
    v_mfma_f32_16x16x32_bf16 v[156:159], v[228:231], v[92:95], 0
    s_setprio 0
    s_nop 7
    v_cvt_pk_bf16_f32 v240, v128, v132
    v_cvt_pk_bf16_f32 v241, v136, v140
    v_cvt_pk_bf16_f32 v242, v144, v148
    v_cvt_pk_bf16_f32 v243, v152, v156
    buffer_store_dwordx4 v[240:243], v253, s[16:19], s39 offen sc1
    s_add_u32 s39, s39, 4194304
    v_cvt_pk_bf16_f32 v244, v129, v133
    v_cvt_pk_bf16_f32 v245, v137, v141
    v_cvt_pk_bf16_f32 v246, v145, v149
    v_cvt_pk_bf16_f32 v247, v153, v157
    buffer_store_dwordx4 v[244:247], v253, s[16:19], s39 offen sc1
    s_add_u32 s39, s39, 4194304
    v_cvt_pk_bf16_f32 v240, v130, v134
    v_cvt_pk_bf16_f32 v241, v138, v142
    v_cvt_pk_bf16_f32 v242, v146, v150
    v_cvt_pk_bf16_f32 v243, v154, v158
    buffer_store_dwordx4 v[240:243], v253, s[16:19], s39 offen sc1
    s_add_u32 s39, s39, 4194304
    v_cvt_pk_bf16_f32 v244, v131, v135
    v_cvt_pk_bf16_f32 v245, v139, v143
    v_cvt_pk_bf16_f32 v246, v147, v151
    v_cvt_pk_bf16_f32 v247, v155, v159
    buffer_store_dwordx4 v[244:247], v253, s[16:19], s39 offen sc1
    s_add_u32 s39, s39, 4194304
    s_cmp_lt_u32 s40, 4
    s_cbranch_scc1 K12_UT3
    s_lshl_b32 s36, s40, 3
    s_sub_i32 s36, s36, 20
    s_max_i32 s36, s36, 1
    s_mov_b32 s37, 131072
K12_UL3:
    v_mov_b32 v255, 155648
    ds_read_b32 v255, v255
    s_waitcnt lgkmcnt(0)
    v_cmp_gt_u32 vcc, s36, v255
    s_sub_u32 s37, s37, 1
    s_cmp_eq_u32 s37, 0
    s_cbranch_scc1 K12_UT3
    s_cbranch_vccz K12_UT3
    s_sleep 2
    s_branch K12_UL3
K12_UT3:
    s_setprio 1
    v_mfma_f32_16x16x32_bf16 v[128:131], v[232:235], v[64:67], 0
    v_mfma_f32_16x16x32_bf16 v[132:135], v[232:235], v[68:71], 0
    v_mfma_f32_16x16x32_bf16 v[136:139], v[232:235], v[72:75], 0
    v_mfma_f32_16x16x32_bf16 v[140:143], v[232:235], v[76:79], 0
    v_mfma_f32_16x16x32_bf16 v[144:147], v[232:235], v[80:83], 0
    v_mfma_f32_16x16x32_bf16 v[148:151], v[232:235], v[84:87], 0
    v_mfma_f32_16x16x32_bf16 v[152:155], v[232:235], v[88:91], 0
    v_mfma_f32_16x16x32_bf16 v[156:159], v[232:235], v[92:95], 0
    s_setprio 0
    s_nop 7
    v_cvt_pk_bf16_f32 v240, v128, v132
    v_cvt_pk_bf16_f32 v241, v136, v140
    v_cvt_pk_bf16_f32 v242, v144, v148
    v_cvt_pk_bf16_f32 v243, v152, v156
    buffer_store_dwordx4 v[240:243], v253, s[16:19], s39 offen sc1
    s_add_u32 s39, s39, 4194304
    v_cvt_pk_bf16_f32 v244, v129, v133
    v_cvt_pk_bf16_f32 v245, v137, v141
    v_cvt_pk_bf16_f32 v246, v145, v149
    v_cvt_pk_bf16_f32 v247, v153, v157
    buffer_store_dwordx4 v[244:247], v253, s[16:19], s39 offen sc1
    s_add_u32 s39, s39, 4194304
    v_cvt_pk_bf16_f32 v240, v130, v134
    v_cvt_pk_bf16_f32 v241, v138, v142
    v_cvt_pk_bf16_f32 v242, v146, v150
    v_cvt_pk_bf16_f32 v243, v154, v158
    buffer_store_dwordx4 v[240:243], v253, s[16:19], s39 offen sc1
    s_add_u32 s39, s39, 4194304
    v_cvt_pk_bf16_f32 v244, v131, v135
    v_cvt_pk_bf16_f32 v245, v139, v143
    v_cvt_pk_bf16_f32 v246, v147, v151
    v_cvt_pk_bf16_f32 v247, v155, v159
    buffer_store_dwordx4 v[244:247], v253, s[16:19], s39 offen sc1
    s_add_u32 s39, s39, 4194304
    s_setprio 1
    v_mfma_f32_16x16x32_bf16 v[128:131], v[236:239], v[64:67], 0
    v_mfma_f32_16x16x32_bf16 v[132:135], v[236:239], v[68:71], 0
    v_mfma_f32_16x16x32_bf16 v[136:139], v[236:239], v[72:75], 0
    v_mfma_f32_16x16x32_bf16 v[140:143], v[236:239], v[76:79], 0
    v_mfma_f32_16x16x32_bf16 v[144:147], v[236:239], v[80:83], 0
    v_mfma_f32_16x16x32_bf16 v[148:151], v[236:239], v[84:87], 0
    v_mfma_f32_16x16x32_bf16 v[152:155], v[236:239], v[88:91], 0
    v_mfma_f32_16x16x32_bf16 v[156:159], v[236:239], v[92:95], 0
    s_setprio 0
    s_nop 7
    v_cvt_pk_bf16_f32 v240, v128, v132
    v_cvt_pk_bf16_f32 v241, v136, v140
    v_cvt_pk_bf16_f32 v242, v144, v148
    v_cvt_pk_bf16_f32 v243, v152, v156
    buffer_store_dwordx4 v[240:243], v253, s[16:19], s39 offen sc1
    s_add_u32 s39, s39, 4194304
    v_cvt_pk_bf16_f32 v244, v129, v133
    v_cvt_pk_bf16_f32 v245, v137, v141
    v_cvt_pk_bf16_f32 v246, v145, v149
    v_cvt_pk_bf16_f32 v247, v153, v157
    buffer_store_dwordx4 v[244:247], v253, s[16:19], s39 offen sc1
    s_add_u32 s39, s39, 4194304
    v_cvt_pk_bf16_f32 v240, v130, v134
    v_cvt_pk_bf16_f32 v241, v138, v142
    v_cvt_pk_bf16_f32 v242, v146, v150
    v_cvt_pk_bf16_f32 v243, v154, v158
    buffer_store_dwordx4 v[240:243], v253, s[16:19], s39 offen sc1
    s_add_u32 s39, s39, 4194304
    v_cvt_pk_bf16_f32 v244, v131, v135
    v_cvt_pk_bf16_f32 v245, v139, v143
    v_cvt_pk_bf16_f32 v246, v147, v151
    v_cvt_pk_bf16_f32 v247, v155, v159
    buffer_store_dwordx4 v[244:247], v253, s[16:19], s39 offen sc1
    s_mov_b32 s41, s40
    s_add_u32 s40, s40, 1
    s_cmp_eq_u32 s41, 3
    s_cbranch_scc0 K12_ES13
    s_waitcnt vmcnt(0)
    s_mov_b32 s34, -1
    s_cmp_ge_u32 s41, 8
    s_cbranch_scc1 K12_SG14
    s_lshl_b32 s36, s41, 2
    s_add_u32 s37, s36, 155680
    s_mov_b64 exec, 1
    v_mov_b32 v255, s37
    v_mov_b32 v240, 1
    ds_add_rtn_u32 v240, v255, v240
    s_waitcnt lgkmcnt(0)
    v_readfirstlane_b32 s37, v240
    s_nop 3
    s_cmp_eq_u32 s37, 3
    s_cbranch_scc0 K12_SH14
    s_lshl_b32 s36, s36, 8
    v_mov_b32 v255, 1
    v_mov_b32 v240, s36
    buffer_atomic_add v255, v240, s[60:63], 0 offen sc0 sc1
    s_mov_b32 s34, s41
K12_SH14:
    s_mov_b64 exec, -1
K12_SG14:
    s_waitcnt vmcnt(0)
    s_cmp_ge_u32 s34, 8
    s_cbranch_scc1 K12_PB15
    v_readfirstlane_b32 s37, v255
    s_nop 3
    s_cmp_eq_u32 s37, 255
    s_cbranch_scc0 K12_PB15
    s_lshl_b32 s36, s34, 4
    s_add_u32 s36, s36, 16384
    s_mov_b64 exec, 1
    v_mov_b32 v255, 1
    v_mov_b32 v240, s36
    buffer_store_dword v255, v240, s[60:63], 0 offen sc1
    s_mov_b64 exec, -1
K12_PB15:
    s_mov_b32 s34, -1
    s_mov_b32 s41, -1
K12_ES13:
    s_waitcnt vmcnt(16)
    s_cmp_ge_u32 s34, 8
    s_cbranch_scc1 K12_PB16
    v_readfirstlane_b32 s37, v255
    s_nop 3
    s_cmp_eq_u32 s37, 255
    s_cbranch_scc0 K12_PB16
    s_lshl_b32 s36, s34, 4
    s_add_u32 s36, s36, 16384
    s_mov_b64 exec, 1
    v_mov_b32 v255, 1
    v_mov_b32 v240, s36
    buffer_store_dword v255, v240, s[60:63], 0 offen sc1
    s_mov_b64 exec, -1
K12_PB16:
    s_cmp_lt_u32 s40, 8
    s_cbranch_scc1 K12_XW
K12_PFIN:
    s_waitcnt vmcnt(0)
    s_mov_b32 s34, -1
    s_cmp_ge_u32 s41, 8
    s_cbranch_scc1 K12_SG17
    s_lshl_b32 s36, s41, 2
    s_add_u32 s37, s36, 155680
    s_mov_b64 exec, 1
    v_mov_b32 v255, s37
    v_mov_b32 v240, 1
    ds_add_rtn_u32 v240, v255, v240
    s_waitcnt lgkmcnt(0)
    v_readfirstlane_b32 s37, v240
    s_nop 3
    s_cmp_eq_u32 s37, 3
    s_cbranch_scc0 K12_SH17
    s_lshl_b32 s36, s36, 8
    v_mov_b32 v255, 1
    v_mov_b32 v240, s36
    buffer_atomic_add v255, v240, s[60:63], 0 offen sc0 sc1
    s_mov_b32 s34, s41
K12_SH17:
    s_mov_b64 exec, -1
K12_SG17:
    s_waitcnt vmcnt(0)
    s_cmp_ge_u32 s34, 8
    s_cbranch_scc1 K12_PB18
    v_readfirstlane_b32 s37, v255
    s_nop 3
    s_cmp_eq_u32 s37, 255
    s_cbranch_scc0 K12_PB18
    s_lshl_b32 s36, s34, 4
    s_add_u32 s36, s36, 16384
    s_mov_b64 exec, 1
    v_mov_b32 v255, 1
    v_mov_b32 v240, s36
    buffer_store_dword v255, v240, s[60:63], 0 offen sc1
    s_mov_b64 exec, -1
K12_PB18:
    s_endpgm
K12_CONS:
    s_and_b32 s6, s2, 7
    s_lshl_b32 s6, s6, 2
    s_lshr_b32 s7, s2, 6
    s_add_u32 s6, s6, s7
    s_mov_b32 s51, s6
    s_mov_b32 s27, s6
    s_lshr_b32 s7, s2, 3
    s_and_b32 s7, s7, 7
    s_lshr_b32 s20, s7, 2
    s_and_b32 s21, s7, 3
    s_lshl_b32 s22, s6, 1
    s_add_u32 s22, s22, s20
    s_lshl_b32 s23, s6, 2
    s_add_u32 s23, s23, s21
    s_mul_i32 s24, s22, 684032
    s_mul_i32 s25, s23, 524288
    s_add_u32 s25, s25, 50331648
    s_mul_i32 s26, s22, 342016
    s_add_u32 s26, s26, 118489088
    s_add_u32 s8, s58, s24
    s_addc_u32 s9, s59, 0
    s_and_b32 s9, s9, 0xffff
    s_mov_b32 s10, 684032
    s_mov_b32 s11, 0x00020000
    s_add_u32 s12, s58, s25
    s_addc_u32 s13, s59, 0
    s_and_b32 s13, s13, 0xffff
    s_mov_b32 s14, 524288
    s_mov_b32 s15, 0x00020000
    s_add_u32 s16, s58, s26
    s_addc_u32 s17, s59, 0
    s_and_b32 s17, s17, 0xffff
    s_mov_b32 s18, 342016
    s_mov_b32 s19, 0x00020000
    s_add_u32 s4, s58, 153108480
    s_addc_u32 s5, s59, 0
    s_and_b32 s5, s5, 0xffff
    s_cmp_eq_u32 s3, 0
    s_cselect_b32 s6, 128, 0
    s_mov_b32 s7, 0x00020000
    s_mov_b32 s46, 155712
    s_cselect_b32 s46, s46, 155776
    s_mov_b32 s47, 155712
    s_cselect_b32 s47, s47, 155744
    s_cselect_b32 s45, 4, 0
    s_mov_b32 s50, s45
    v_and_b32 v8, 15, v2
    v_lshrrev_b32 v9, 4, v2
    v_lshlrev_b32 v1, 4, v2
    s_mul_i32 s30, s3, 5120
    s_mov_b32 s36, s30
    s_lshl_b32 s31, s3, 12
    s_add_u32 s37, s31, 22528
    s_lshr_b32 s28, s3, 1
    s_and_b32 s29, s3, 1
    s_lshl_b32 s33, s29, 9
    s_add_u32 s33, s33, 20480
    s_mul_i32 s38, s28, 896
    s_add_u32 s38, s38, s33
    s_lshl_b32 s34, s51, 1
    s_add_u32 s34, s34, s28
    s_mul_i32 s34, s34, 684032
    s_add_u32 s64, s58, s34
    s_addc_u32 s65, s59, 0
    s_and_b32 s65, s65, 0xffff
    s_mov_b32 s66, 684032
    s_mov_b32 s67, 0x00020000
    s_mov_b32 s44, 0xffffff
    s_cmp_eq_u32 s29, 0
    s_cselect_b32 s44, -1, s44
    s_mov_b32 s45, 0
    v_lshrrev_b32 v10, 1, v8
    v_xor_b32 v10, v10, v9
    v_lshlrev_b32 v10, 4, v10
    v_lshl_add_u32 v2, v8, 7, v10
    v_xor_b32 v3, 64, v2
    v_lshrrev_b32 v10, 2, v8
    v_lshl_add_u32 v11, v9, 3, v10
    v_lshlrev_b32 v11, 9, v11
    v_and_b32 v12, 1, v9
    v_lshl_or_b32 v10, v12, 2, v10
    s_lshl_b32 s28, s3, 1
    v_xor_b32 v10, s28, v10
    v_lshl_add_u32 v11, v10, 5, v11
    v_and_b32 v10, 3, v8
    v_lshl_add_u32 v11, v10, 3, v11
    v_add_u32 v4, 22528, v11
    s_lshl_b32 s28, s20, 5
    v_xor_b32 v4, s28, v4
    v_and_b32 v10, 3, v8
    v_lshlrev_b32 v10, 2, v10
    v_add_u32 v5, 155648, v10
    s_lshl_b32 s28, s3, 2
    s_add_u32 s28, s28, 155648
    v_mov_b32 v7, s28
    s_mov_b32 s35, 0x80008000
    s_mov_b32 s62, 0
    s_mov_b32 s63, 0
    s_mov_b32 s39, 0
    s_add_u32 m0, s39, s36
    s_nop 0
    buffer_load_dwordx4 v1, s[8:11], s30 offen sc1 lds
    buffer_load_dwordx4 v1, s[8:11], s30 offen offset:1024 sc1 lds
    buffer_load_dwordx4 v1, s[8:11], s30 offen offset:2048 sc1 lds
    buffer_load_dwordx4 v1, s[8:11], s30 offen offset:3072 sc1 lds
    s_add_u32 m0, m0, 4096
    s_add_u32 s34, s30, 4096
    buffer_load_dwordx4 v1, s[8:11], s34 offen sc1 lds
    s_add_u32 m0, s39, s37
    s_add_u32 s30, s30, 21376
    buffer_load_dwordx4 v1, s[12:15], s31 offen sc1 lds
    buffer_load_dwordx4 v1, s[12:15], s31 offen offset:1024 sc1 lds
    buffer_load_dwordx4 v1, s[12:15], s31 offen offset:2048 sc1 lds
    buffer_load_dwordx4 v1, s[12:15], s31 offen offset:3072 sc1 lds
    s_add_u32 m0, s39, s38
    s_mov_b64 exec, s[44:45]
    buffer_load_dwordx4 v1, s[64:67], s33 offen sc1 lds
    s_mov_b64 exec, -1
    s_add_u32 s31, s31, 16384
    s_add_u32 s33, s33, 21376
    s_add_u32 s39, s39, 38912
    s_add_u32 m0, s39, s36
    s_nop 0
    buffer_load_dwordx4 v1, s[8:11], s30 offen sc1 lds
    buffer_load_dwordx4 v1, s[8:11], s30 offen offset:1024 sc1 lds
    buffer_load_dwordx4 v1, s[8:11], s30 offen offset:2048 sc1 lds
    buffer_load_dwordx4 v1, s[8:11], s30 offen offset:3072 sc1 lds
    s_add_u32 m0, m0, 4096
    s_add_u32 s34, s30, 4096
    buffer_load_dwordx4 v1, s[8:11], s34 offen sc1 lds
    s_add_u32 m0, s39, s37
    s_add_u32 s30, s30, 21376
    buffer_load_dwordx4 v1, s[12:15], s31 offen sc1 lds
    buffer_load_dwordx4 v1, s[12:15], s31 offen offset:1024 sc1 lds
    buffer_load_dwordx4 v1, s[12:15], s31 offen offset:2048 sc1 lds
    buffer_load_dwordx4 v1, s[12:15], s31 offen offset:3072 sc1 lds
    s_add_u32 m0, s39, s38
    s_mov_b64 exec, s[44:45]
    buffer_load_dwordx4 v1, s[64:67], s33 offen sc1 lds
    s_mov_b64 exec, -1
    s_add_u32 s31, s31, 16384
    s_add_u32 s33, s33, 21376
    s_add_u32 s39, s39, 38912
    s_add_u32 m0, s39, s36
    s_nop 0
    buffer_load_dwordx4 v1, s[8:11], s30 offen sc1 lds
    buffer_load_dwordx4 v1, s[8:11], s30 offen offset:1024 sc1 lds
    buffer_load_dwordx4 v1, s[8:11], s30 offen offset:2048 sc1 lds
    buffer_load_dwordx4 v1, s[8:11], s30 offen offset:3072 sc1 lds
    s_add_u32 m0, m0, 4096
    s_add_u32 s34, s30, 4096
    buffer_load_dwordx4 v1, s[8:11], s34 offen sc1 lds
    s_add_u32 m0, s39, s37
    s_add_u32 s30, s30, 21376
    buffer_load_dwordx4 v1, s[12:15], s31 offen sc1 lds
    buffer_load_dwordx4 v1, s[12:15], s31 offen offset:1024 sc1 lds
    buffer_load_dwordx4 v1, s[12:15], s31 offen offset:2048 sc1 lds
    buffer_load_dwordx4 v1, s[12:15], s31 offen offset:3072 sc1 lds
    s_add_u32 m0, s39, s38
    s_mov_b64 exec, s[44:45]
    buffer_load_dwordx4 v1, s[64:67], s33 offen sc1 lds
    s_mov_b64 exec, -1
    s_add_u32 s31, s31, 16384
    s_add_u32 s33, s33, 21376
    s_add_u32 s39, s39, 38912
    s_mov_b32 m0, s46
    s_mov_b64 exec, 0xff
    buffer_load_dword v1, s[4:7], 0 offen sc1 lds
    s_mov_b64 exec, -1
    v_lshrrev_b32 v9, 4, v1
    v_and_b32 v8, 15, v9
    v_lshrrev_b32 v9, 4, v9
    v_and_b32 v10, 3, v8
    v_lshlrev_b32 v10, 2, v10
    v_lshrrev_b32 v12, 3, v8
    v_lshl_add_u32 v10, v12, 1, v10
    s_lshl_b32 s28, s3, 4
    s_add_u32 s28, s28, 1
    v_add_u32 v10, s28, v10
    v_bfe_u32 v11, v8, 2, 1
    v_and_b32 v13, 1, v9
    v_lshlrev_b32 v13, 3, v13
    v_mul_u32_u24 v14, 96, v11
    v_mad_u32_u24 v15, v10, v13, v14
    v_mad_u32_u24 v16, v10, 0, v15
    v_mad_u32_u24 v17, v10, 1, v15
    v_mad_u32_u24 v18, v10, 2, v15
    v_mad_u32_u24 v19, v10, 3, v15
    v_mad_u32_u24 v20, v10, 4, v15
    v_mad_u32_u24 v21, v10, 5, v15
    v_mad_u32_u24 v22, v10, 6, v15
    v_mad_u32_u24 v23, v10, 7, v15
    v_and_b32 v16, 127, v16
    v_and_b32 v17, 127, v17
    v_and_b32 v18, 127, v18
    v_and_b32 v19, 127, v19
    v_and_b32 v20, 127, v20
    v_and_b32 v21, 127, v21
    v_and_b32 v22, 127, v22
    v_and_b32 v23, 127, v23
    v_cvt_f32_u32 v16, v16
    v_cvt_f32_u32 v17, v17
    v_cvt_f32_u32 v18, v18
    v_cvt_f32_u32 v19, v19
    v_cvt_f32_u32 v20, v20
    v_cvt_f32_u32 v21, v21
    v_cvt_f32_u32 v22, v22
    v_cvt_f32_u32 v23, v23
    v_mul_f32 v16, 0x3c000000, v16
    v_mul_f32 v17, 0x3c000000, v17
    v_mul_f32 v18, 0x3c000000, v18
    v_mul_f32 v19, 0x3c000000, v19
    v_mul_f32 v20, 0x3c000000, v20
    v_mul_f32 v21, 0x3c000000, v21
    v_mul_f32 v22, 0x3c000000, v22
    v_mul_f32 v23, 0x3c000000, v23
    v_cos_f32 v16, v16
    v_cos_f32 v17, v17
    v_cos_f32 v18, v18
    v_cos_f32 v19, v19
    v_cos_f32 v20, v20
    v_cos_f32 v21, v21
    v_cos_f32 v22, v22
    v_cos_f32 v23, v23
    s_nop 0
    v_cvt_pk_bf16_f32 v24, v16, v17
    v_cvt_pk_bf16_f32 v25, v18, v19
    v_cvt_pk_bf16_f32 v26, v20, v21
    v_cvt_pk_bf16_f32 v27, v22, v23
    v_lshlrev_b32 v32, 16, v24
    v_and_b32 v33, 0xffff0000, v24
    v_sub_f32 v16, v16, v32
    v_sub_f32 v17, v17, v33
    v_lshlrev_b32 v32, 16, v25
    v_and_b32 v33, 0xffff0000, v25
    v_sub_f32 v18, v18, v32
    v_sub_f32 v19, v19, v33
    v_lshlrev_b32 v32, 16, v26
    v_and_b32 v33, 0xffff0000, v26
    v_sub_f32 v20, v20, v32
    v_sub_f32 v21, v21, v33
    v_lshlrev_b32 v32, 16, v27
    v_and_b32 v33, 0xffff0000, v27
    v_sub_f32 v22, v22, v32
    v_sub_f32 v23, v23, v33
    v_cvt_pk_bf16_f32 v28, v16, v17
    v_cvt_pk_bf16_f32 v29, v18, v19
    v_cvt_pk_bf16_f32 v30, v20, v21
    v_cvt_pk_bf16_f32 v31, v22, v23
    v_cmp_lt_u32 vcc, 1, v9
    s_lshl_b32 s28, s3, 10
    s_add_u32 s28, s28, 133120
    v_add_u32 v14, s28, v1
    v_cndmask_b32 v24, v24, v28, vcc
    v_cndmask_b32 v25, v25, v29, vcc
    v_cndmask_b32 v26, v26, v30, vcc
    v_cndmask_b32 v27, v27, v31, vcc
    ds_write_b128 v14, v[24:27]
    v_mov_b32 v12, 0
    v_mov_b32 v13, 0
    v_mov_b32 v14, 0
    v_mov_b32 v15, 0
    s_mul_i32 s28, s3, 38912
    s_add_u32 s28, s28, 22272
    v_add_u32 v16, s28, v1
    s_mov_b64 exec, 0xffff
    ds_write_b128 v16, v[12:15]
    s_mov_b64 exec, -1
    s_lshl_b32 s28, s3, 2
    s_add_u32 s28, s28, 155648
    v_mov_b32 v16, s28
    ds_write_b32 v16, v12
    s_lshl_b32 s28, s3, 3
    s_add_u32 s28, s28, 155680
    v_mov_b32 v16, s28
    ds_write_b64 v16, v[12:13]
    s_lshl_b32 s28, s3, 3
    s_add_u32 s28, s28, 155712
    v_mov_b32 v16, s28
    ds_write_b64 v16, v[12:13]
    s_lshl_b32 s28, s3, 3
    s_add_u32 s28, s28, 155840
    v_mov_b32 v16, s28
    ds_write_b64 v16, v[12:13]
    v_mov_b32 v16, 155664
    ds_write_b32 v16, v12
    v_mov_b32 v16, 155744
    v_mov_b32 v17, 1
    ds_write_b32 v16, v17
    s_waitcnt lgkmcnt(0)
    s_barrier
    v_mov_b32 v80, 0
    v_mov_b32 v81, 0
    v_mov_b32 v82, 0
    v_mov_b32 v83, 0
    v_mov_b32 v84, 0
    v_mov_b32 v85, 0
    v_mov_b32 v86, 0
    v_mov_b32 v87, 0
    v_mov_b32 v88, 0
    v_mov_b32 v89, 0
    v_mov_b32 v90, 0
    v_mov_b32 v91, 0
    v_mov_b32 v92, 0
    v_mov_b32 v93, 0
    v_mov_b32 v94, 0
    v_mov_b32 v95, 0
    v_mov_b32 v96, 0
    v_mov_b32 v97, 0
    v_mov_b32 v98, 0
    v_mov_b32 v99, 0
    v_mov_b32 v100, 0
    v_mov_b32 v101, 0
    v_mov_b32 v102, 0
    v_mov_b32 v103, 0
    v_mov_b32 v104, 0
    v_mov_b32 v105, 0
    v_mov_b32 v106, 0
    v_mov_b32 v107, 0
    v_mov_b32 v108, 0
    v_mov_b32 v109, 0
    v_mov_b32 v110, 0
    v_mov_b32 v111, 0
    v_mov_b32 v112, 0
    v_mov_b32 v113, 0
    v_mov_b32 v114, 0
    v_mov_b32 v115, 0
    v_mov_b32 v116, 0
    v_mov_b32 v117, 0
    v_mov_b32 v118, 0
    v_mov_b32 v119, 0
    v_mov_b32 v120, 0
    v_mov_b32 v121, 0
    v_mov_b32 v122, 0
    v_mov_b32 v123, 0
    v_mov_b32 v124, 0
    v_mov_b32 v125, 0
    v_mov_b32 v126, 0
    v_mov_b32 v127, 0
    v_mov_b32 v128, 0
    v_mov_b32 v129, 0
    v_mov_b32 v130, 0
    v_mov_b32 v131, 0
    v_mov_b32 v132, 0
    v_mov_b32 v133, 0
    v_mov_b32 v134, 0
    v_mov_b32 v135, 0
    v_mov_b32 v136, 0
    v_mov_b32 v137, 0
    v_mov_b32 v138, 0
    v_mov_b32 v139, 0
    v_mov_b32 v140, 0
    v_mov_b32 v141, 0
    v_mov_b32 v142, 0
    v_mov_b32 v143, 0
    v_mov_b32 v144, 0
    v_mov_b32 v145, 0
    v_mov_b32 v146, 0
    v_mov_b32 v147, 0
    v_mov_b32 v148, 0
    v_mov_b32 v149, 0
    v_mov_b32 v150, 0
    v_mov_b32 v151, 0
    v_mov_b32 v152, 0
    v_mov_b32 v153, 0
    v_mov_b32 v154, 0
    v_mov_b32 v155, 0
    v_mov_b32 v156, 0
    v_mov_b32 v157, 0
    v_mov_b32 v158, 0
    v_mov_b32 v159, 0
    v_mov_b32 v160, 0
    v_mov_b32 v161, 0
    v_mov_b32 v162, 0
    v_mov_b32 v163, 0
    v_mov_b32 v164, 0
    v_mov_b32 v165, 0
    v_mov_b32 v166, 0
    v_mov_b32 v167, 0
    v_mov_b32 v168, 0
    v_mov_b32 v169, 0
    v_mov_b32 v170, 0
    v_mov_b32 v171, 0
    v_mov_b32 v172, 0
    v_mov_b32 v173, 0
    v_mov_b32 v174, 0
    v_mov_b32 v175, 0
    v_mov_b32 v176, 0
    v_mov_b32 v177, 0
    v_mov_b32 v178, 0
    v_mov_b32 v179, 0
    v_mov_b32 v180, 0
    v_mov_b32 v181, 0
    v_mov_b32 v182, 0
    v_mov_b32 v183, 0
    v_mov_b32 v184, 0
    v_mov_b32 v185, 0
    v_mov_b32 v186, 0
    v_mov_b32 v187, 0
    v_mov_b32 v188, 0
    v_mov_b32 v189, 0
    v_mov_b32 v190, 0
    v_mov_b32 v191, 0
    v_mov_b32 v192, 0
    v_mov_b32 v193, 0
    v_mov_b32 v194, 0
    v_mov_b32 v195, 0
    v_mov_b32 v196, 0
    v_mov_b32 v197, 0
    v_mov_b32 v198, 0
    v_mov_b32 v199, 0
    v_mov_b32 v200, 0
    v_mov_b32 v201, 0
    v_mov_b32 v202, 0
    v_mov_b32 v203, 0
    v_mov_b32 v204, 0
    v_mov_b32 v205, 0
    v_mov_b32 v206, 0
    v_mov_b32 v207, 0
    v_mov_b32 v208, 0
    v_mov_b32 v209, 0
    v_mov_b32 v210, 0
    v_mov_b32 v211, 0
    v_mov_b32 v212, 0
    v_mov_b32 v213, 0
    v_mov_b32 v214, 0
    v_mov_b32 v215, 0
    v_mov_b32 v216, 0
    v_mov_b32 v217, 0
    v_mov_b32 v218, 0
    v_mov_b32 v219, 0
    v_mov_b32 v220, 0
    v_mov_b32 v221, 0
    v_mov_b32 v222, 0
    v_mov_b32 v223, 0
    v_mov_b32 v224, 0
    v_mov_b32 v225, 0
    v_mov_b32 v226, 0
    v_mov_b32 v227, 0
    v_mov_b32 v228, 0
    v_mov_b32 v229, 0
    v_mov_b32 v230, 0
    v_mov_b32 v231, 0
    v_mov_b32 v232, 0
    v_mov_b32 v233, 0
    v_mov_b32 v234, 0
    v_mov_b32 v235, 0
    v_mov_b32 v236, 0
    v_mov_b32 v237, 0
    v_mov_b32 v238, 0
    v_mov_b32 v239, 0
    v_mov_b32 v240, 0
    v_mov_b32 v241, 0
    v_mov_b32 v242, 0
    v_mov_b32 v243, 0
    v_mov_b32 v244, 0
    v_mov_b32 v245, 0
    v_mov_b32 v246, 0
    v_mov_b32 v247, 0
    s_barrier
    s_mov_b32 s40, 2
    v_mov_b32 v0, s40
    s_waitcnt vmcnt(21)
    ds_write_b32 v7, v0
    s_branch K12_S0
K12_Q0:
    ds_read_b64_tr_b16 v[40:41], v4 offset:0
    ds_read_b64_tr_b16 v[42:43], v4 offset:2048
    ds_read_b64_tr_b16 v[44:45], v4 offset:256
    ds_read_b64_tr_b16 v[46:47], v4 offset:2304
    v_xor_b32 v4, 32, v4
    ds_read_b64_tr_b16 v[48:49], v4 offset:0
    ds_read_b64_tr_b16 v[50:51], v4 offset:2048
    ds_read_b64_tr_b16 v[52:53], v4 offset:256
    ds_read_b64_tr_b16 v[54:55], v4 offset:2304
    v_xor_b32 v4, 32, v4
    ds_read_b128 v[8:11], v2 offset:0
    ds_read_b128 v[12:15], v3 offset:0
    ds_read_b128 v[16:19], v2 offset:2048
    ds_read_b128 v[20:23], v3 offset:2048
    ds_read_b128 v[32:35], v2 offset:6144
    ds_read_b128 v[36:39], v3 offset:6144
    ds_read_b32 v68, v5
    s_waitcnt lgkmcnt(7)
    v_xor_b32 v72, s35, v44
    v_xor_b32 v73, s35, v45
    v_xor_b32 v74, s35, v46
    v_xor_b32 v75, s35, v47
    v_xor_b32 v76, s35, v52
    v_xor_b32 v77, s35, v53
    v_xor_b32 v78, s35, v54
    v_xor_b32 v79, s35, v55
    s_mov_b32 s41, 0
    s_mov_b32 s42, 38912
    s_mov_b32 s39, 0
    s_mov_b32 s29, 116736
K12_LOOP:
    s_waitcnt lgkmcnt(2)
    v_mfma_f32_16x16x32_bf16 v[80:83], v[8:11], v[40:43], v[80:83]
    ds_read_b128 v[24:27], v2 offset:4096
    v_xor_b32 v72, s35, v44
    v_xor_b32 v73, s35, v45
    v_mfma_f32_16x16x32_bf16 v[84:87], v[8:11], v[44:47], v[84:87]
    ds_read_b128 v[28:31], v3 offset:4096
    v_xor_b32 v74, s35, v46
    v_xor_b32 v75, s35, v47
    v_mfma_f32_16x16x32_bf16 v[88:91], v[8:11], v[48:51], v[88:91]
    s_waitcnt lgkmcnt(2)
    v_cmp_gt_u32 vcc, s40, v68
    s_add_u32 s49, s39, 2
    s_lshr_b32 s49, s49, 1
    v_xor_b32 v76, s35, v52
    v_xor_b32 v77, s35, v53
    v_mfma_f32_16x16x32_bf16 v[92:95], v[8:11], v[52:55], v[92:95]
    s_cbranch_vccnz K12_S1
K12_Q1:
    s_mul_i32 s48, s49, s50
    s_add_u32 s48, s48, s47
    v_xor_b32 v78, s35, v54
    v_xor_b32 v79, s35, v55
    v_mfma_f32_16x16x32_bf16 v[80:83], v[12:15], v[72:75], v[80:83]
    s_add_u32 m0, s29, s36
    s_nop 0
    buffer_load_dwordx4 v1, s[8:11], s30 offen sc1 lds
    v_mfma_f32_16x16x32_bf16 v[84:87], v[12:15], v[40:43], v[84:87]
    s_cmp_lt_u32 s49, 8
    s_cselect_b32 s48, s48, 155744
    v_mfma_f32_16x16x32_bf16 v[88:91], v[12:15], v[76:79], v[88:91]
    s_cmp_ge_u32 s49, 3
    s_cselect_b32 s48, s48, 155744
    v_mfma_f32_16x16x32_bf16 v[92:95], v[12:15], v[48:51], v[92:95]
    v_mfma_f32_16x16x32_bf16 v[96:99], v[16:19], v[40:43], v[96:99]
    ds_read_b128 v[8:11], v2 offset:8192
    v_mfma_f32_16x16x32_bf16 v[100:103], v[16:19], v[44:47], v[100:103]
    ds_read_b128 v[12:15], v3 offset:8192
    v_mfma_f32_16x16x32_bf16 v[104:107], v[16:19], v[48:51], v[104:107]
    buffer_load_dwordx4 v1, s[8:11], s30 offen offset:1024 sc1 lds
    v_mfma_f32_16x16x32_bf16 v[108:111], v[16:19], v[52:55], v[108:111]
    v_mfma_f32_16x16x32_bf16 v[96:99], v[20:23], v[72:75], v[96:99]
    v_mfma_f32_16x16x32_bf16 v[100:103], v[20:23], v[40:43], v[100:103]
    v_mfma_f32_16x16x32_bf16 v[104:107], v[20:23], v[76:79], v[104:107]
    buffer_load_dwordx4 v1, s[8:11], s30 offen offset:2048 sc1 lds
    v_mfma_f32_16x16x32_bf16 v[108:111], v[20:23], v[48:51], v[108:111]
    s_waitcnt lgkmcnt(2)
    v_mfma_f32_16x16x32_bf16 v[112:115], v[24:27], v[40:43], v[112:115]
    ds_read_b128 v[16:19], v2 offset:10240
    v_mfma_f32_16x16x32_bf16 v[116:119], v[24:27], v[44:47], v[116:119]
    ds_read_b128 v[20:23], v3 offset:10240
    v_mfma_f32_16x16x32_bf16 v[120:123], v[24:27], v[48:51], v[120:123]
    v_mfma_f32_16x16x32_bf16 v[124:127], v[24:27], v[52:55], v[124:127]
    v_mfma_f32_16x16x32_bf16 v[112:115], v[28:31], v[72:75], v[112:115]
    buffer_load_dwordx4 v1, s[8:11], s30 offen offset:3072 sc1 lds
    v_mfma_f32_16x16x32_bf16 v[116:119], v[28:31], v[40:43], v[116:119]
    v_mfma_f32_16x16x32_bf16 v[120:123], v[28:31], v[76:79], v[120:123]
    v_mfma_f32_16x16x32_bf16 v[124:127], v[28:31], v[48:51], v[124:127]
    v_mfma_f32_16x16x32_bf16 v[128:131], v[32:35], v[40:43], v[128:131]
    ds_read_b128 v[24:27], v2 offset:12288
    v_mfma_f32_16x16x32_bf16 v[132:135], v[32:35], v[44:47], v[132:135]
    ds_read_b128 v[28:31], v3 offset:12288
    v_mfma_f32_16x16x32_bf16 v[136:139], v[32:35], v[48:51], v[136:139]
    s_add_u32 m0, m0, 4096
    s_add_u32 s34, s30, 4096
    buffer_load_dwordx4 v1, s[8:11], s34 offen sc1 lds
    v_mfma_f32_16x16x32_bf16 v[140:143], v[32:35], v[52:55], v[140:143]
    v_mfma_f32_16x16x32_bf16 v[128:131], v[36:39], v[72:75], v[128:131]
    v_mfma_f32_16x16x32_bf16 v[132:135], v[36:39], v[40:43], v[132:135]
    v_mfma_f32_16x16x32_bf16 v[136:139], v[36:39], v[76:79], v[136:139]
    s_add_u32 m0, s29, s37
    s_add_u32 s30, s30, 21376
    buffer_load_dwordx4 v1, s[12:15], s31 offen sc1 lds
    v_mfma_f32_16x16x32_bf16 v[140:143], v[36:39], v[48:51], v[140:143]
    s_waitcnt lgkmcnt(4)
    v_mfma_f32_16x16x32_bf16 v[144:147], v[8:11], v[40:43], v[144:147]
    ds_read_b128 v[32:35], v2 offset:14336
    v_mfma_f32_16x16x32_bf16 v[148:151], v[8:11], v[44:47], v[148:151]
    ds_read_b128 v[36:39], v3 offset:14336
    v_mfma_f32_16x16x32_bf16 v[152:155], v[8:11], v[48:51], v[152:155]
    v_mfma_f32_16x16x32_bf16 v[156:159], v[8:11], v[52:55], v[156:159]
    v_mfma_f32_16x16x32_bf16 v[144:147], v[12:15], v[72:75], v[144:147]
    buffer_load_dwordx4 v1, s[12:15], s31 offen offset:1024 sc1 lds
    v_mfma_f32_16x16x32_bf16 v[148:151], v[12:15], v[40:43], v[148:151]
    v_mfma_f32_16x16x32_bf16 v[152:155], v[12:15], v[76:79], v[152:155]
    v_mfma_f32_16x16x32_bf16 v[156:159], v[12:15], v[48:51], v[156:159]
    s_waitcnt lgkmcnt(4)
    v_mfma_f32_16x16x32_bf16 v[160:163], v[16:19], v[40:43], v[160:163]
    ds_read_b128 v[8:11], v2 offset:16384
    v_mfma_f32_16x16x32_bf16 v[164:167], v[16:19], v[44:47], v[164:167]
    ds_read_b128 v[12:15], v3 offset:16384
    v_mfma_f32_16x16x32_bf16 v[168:171], v[16:19], v[48:51], v[168:171]
    buffer_load_dwordx4 v1, s[12:15], s31 offen offset:2048 sc1 lds
    v_mfma_f32_16x16x32_bf16 v[172:175], v[16:19], v[52:55], v[172:175]
    s_add_u32 s40, s40, 1
    s_mov_b32 s51, s40
    v_mov_b32 v0, s40
    v_mfma_f32_16x16x32_bf16 v[160:163], v[20:23], v[72:75], v[160:163]
    s_waitcnt vmcnt(19)
    ds_write_b32 v7, v0
    v_mfma_f32_16x16x32_bf16 v[164:167], v[20:23], v[40:43], v[164:167]
    v_mfma_f32_16x16x32_bf16 v[168:171], v[20:23], v[76:79], v[168:171]
    buffer_load_dwordx4 v1, s[12:15], s31 offen offset:3072 sc1 lds
    v_mfma_f32_16x16x32_bf16 v[172:175], v[20:23], v[48:51], v[172:175]
    s_waitcnt lgkmcnt(5)
    v_mfma_f32_16x16x32_bf16 v[176:179], v[24:27], v[40:43], v[176:179]
    ds_read_b128 v[16:19], v2 offset:18432
    v_mfma_f32_16x16x32_bf16 v[180:183], v[24:27], v[44:47], v[180:183]
    ds_read_b128 v[20:23], v3 offset:18432
    v_mov_b32 v0, s48
    v_mfma_f32_16x16x32_bf16 v[184:187], v[24:27], v[48:51], v[184:187]
    ds_read_b32 v0, v0
    v_mfma_f32_16x16x32_bf16 v[188:191], v[24:27], v[52:55], v[188:191]
    v_mfma_f32_16x16x32_bf16 v[176:179], v[28:31], v[72:75], v[176:179]
    s_add_u32 m0, s29, s38
    s_mov_b64 exec, s[44:45]
    buffer_load_dwordx4 v1, s[64:67], s33 offen sc1 lds
    s_mov_b64 exec, -1
    s_add_u32 s31, s31, 16384
    s_add_u32 s33, s33, 21376
    v_mfma_f32_16x16x32_bf16 v[180:183], v[28:31], v[40:43], v[180:183]
    v_mfma_f32_16x16x32_bf16 v[184:187], v[28:31], v[76:79], v[184:187]
    v_mfma_f32_16x16x32_bf16 v[188:191], v[28:31], v[48:51], v[188:191]
    s_waitcnt lgkmcnt(0)
    v_cmp_eq_u32 vcc, 0, v0
    v_mfma_f32_16x16x32_bf16 v[192:195], v[32:35], v[40:43], v[192:195]
    ds_read_b128 v[24:27], v2 offset:20480
    v_mfma_f32_16x16x32_bf16 v[196:199], v[32:35], v[44:47], v[196:199]
    ds_read_b128 v[28:31], v3 offset:20480
    s_cbranch_vccnz K12_F2
K12_G2:
    v_mfma_f32_16x16x32_bf16 v[200:203], v[32:35], v[48:51], v[200:203]
    s_sub_u32 s43, s42, s41
    s_add_u32 s40, s40, 1
    v_add_u32 v2, s43, v2
    v_mfma_f32_16x16x32_bf16 v[204:207], v[32:35], v[52:55], v[204:207]
    v_add_u32 v3, s43, v3
    v_add_u32 v4, s43, v4
    v_mov_b32 v0, s40
    v_mfma_f32_16x16x32_bf16 v[192:195], v[36:39], v[72:75], v[192:195]
    ds_write_b32 v7, v0
    v_mfma_f32_16x16x32_bf16 v[196:199], v[36:39], v[40:43], v[196:199]
    v_mfma_f32_16x16x32_bf16 v[200:203], v[36:39], v[76:79], v[200:203]
    v_mfma_f32_16x16x32_bf16 v[204:207], v[36:39], v[48:51], v[204:207]
    ds_read_b32 v56, v5
    v_mfma_f32_16x16x32_bf16 v[208:211], v[8:11], v[40:43], v[208:211]
    v_mfma_f32_16x16x32_bf16 v[212:215], v[8:11], v[44:47], v[212:215]
    v_mfma_f32_16x16x32_bf16 v[216:219], v[8:11], v[48:51], v[216:219]
    v_mfma_f32_16x16x32_bf16 v[220:223], v[8:11], v[52:55], v[220:223]
    s_waitcnt lgkmcnt(0)
    v_cmp_gt_u32 vcc, s51, v56
    v_mfma_f32_16x16x32_bf16 v[208:211], v[12:15], v[72:75], v[208:211]
    v_mfma_f32_16x16x32_bf16 v[212:215], v[12:15], v[40:43], v[212:215]
    s_cbranch_vccnz K12_S3
K12_Q3:
    v_mfma_f32_16x16x32_bf16 v[216:219], v[12:15], v[76:79], v[216:219]
    ds_read_b64_tr_b16 v[56:57], v4 offset:0
    v_mfma_f32_16x16x32_bf16 v[220:223], v[12:15], v[48:51], v[220:223]
    ds_read_b64_tr_b16 v[58:59], v4 offset:2048
    v_mfma_f32_16x16x32_bf16 v[224:227], v[16:19], v[40:43], v[224:227]
    ds_read_b64_tr_b16 v[60:61], v4 offset:256
    ds_read_b128 v[8:11], v2 offset:0
    v_mfma_f32_16x16x32_bf16 v[228:231], v[16:19], v[44:47], v[228:231]
    ds_read_b64_tr_b16 v[62:63], v4 offset:2304
    ds_read_b128 v[12:15], v3 offset:0
    v_mfma_f32_16x16x32_bf16 v[232:235], v[16:19], v[48:51], v[232:235]
    v_xor_b32 v4, 32, v4
    ds_read_b128 v[32:35], v2 offset:6144
    v_mfma_f32_16x16x32_bf16 v[236:239], v[16:19], v[52:55], v[236:239]
    ds_read_b64_tr_b16 v[64:65], v4 offset:0
    ds_read_b128 v[36:39], v3 offset:6144
    v_mfma_f32_16x16x32_bf16 v[224:227], v[20:23], v[72:75], v[224:227]
    ds_read_b64_tr_b16 v[66:67], v4 offset:2048
    ds_read_b32 v52, v5
    v_mfma_f32_16x16x32_bf16 v[228:231], v[20:23], v[40:43], v[228:231]
    ds_read_b64_tr_b16 v[68:69], v4 offset:256
    ds_read_b64_tr_b16 v[70:71], v4 offset:2304
    v_xor_b32 v4, 32, v4
    v_mfma_f32_16x16x32_bf16 v[232:235], v[20:23], v[76:79], v[232:235]
    v_mfma_f32_16x16x32_bf16 v[236:239], v[20:23], v[48:51], v[236:239]
    v_mfma_f32_16x16x32_bf16 v[240:243], v[24:27], v[40:43], v[240:243]
    ds_read_b128 v[16:19], v2 offset:2048
    v_mfma_f32_16x16x32_bf16 v[244:247], v[24:27], v[44:47], v[244:247]
    ds_read_b128 v[20:23], v3 offset:2048
    v_mfma_f32_16x16x32_bf16 v[240:243], v[28:31], v[72:75], v[240:243]
    s_mov_b32 s29, s41
    s_mov_b32 s41, s42
    s_add_u32 s42, s42, 38912
    v_mfma_f32_16x16x32_bf16 v[244:247], v[28:31], v[40:43], v[244:247]
    s_cmp_eq_u32 s42, 155648
    s_cselect_b32 s42, 0, s42
    s_waitcnt lgkmcnt(2)
    v_mfma_f32_16x16x32_bf16 v[80:83], v[8:11], v[56:59], v[80:83]
    ds_read_b128 v[24:27], v2 offset:4096
    v_xor_b32 v72, s35, v60
    v_xor_b32 v73, s35, v61
    v_mfma_f32_16x16x32_bf16 v[84:87], v[8:11], v[60:63], v[84:87]
    ds_read_b128 v[28:31], v3 offset:4096
    v_xor_b32 v74, s35, v62
    v_xor_b32 v75, s35, v63
    v_mfma_f32_16x16x32_bf16 v[88:91], v[8:11], v[64:67], v[88:91]
    s_waitcnt lgkmcnt(2)
    v_cmp_gt_u32 vcc, s40, v52
    v_xor_b32 v76, s35, v68
    v_xor_b32 v77, s35, v69
    v_mfma_f32_16x16x32_bf16 v[92:95], v[8:11], v[68:71], v[92:95]
    s_cbranch_vccnz K12_S4
K12_Q4:
    v_xor_b32 v78, s35, v70
    v_xor_b32 v79, s35, v71
    v_mfma_f32_16x16x32_bf16 v[80:83], v[12:15], v[72:75], v[80:83]
    s_add_u32 m0, s29, s36
    s_nop 0
    buffer_load_dwordx4 v1, s[8:11], s30 offen sc1 lds
    v_mfma_f32_16x16x32_bf16 v[84:87], v[12:15], v[56:59], v[84:87]
    v_mfma_f32_16x16x32_bf16 v[88:91], v[12:15], v[76:79], v[88:91]
    v_mfma_f32_16x16x32_bf16 v[92:95], v[12:15], v[64:67], v[92:95]
    v_mfma_f32_16x16x32_bf16 v[96:99], v[16:19], v[56:59], v[96:99]
    ds_read_b128 v[8:11], v2 offset:8192
    v_mfma_f32_16x16x32_bf16 v[100:103], v[16:19], v[60:63], v[100:103]
    ds_read_b128 v[12:15], v3 offset:8192
    v_mfma_f32_16x16x32_bf16 v[104:107], v[16:19], v[64:67], v[104:107]
    buffer_load_dwordx4 v1, s[8:11], s30 offen offset:1024 sc1 lds
    v_mfma_f32_16x16x32_bf16 v[108:111], v[16:19], v[68:71], v[108:111]
    v_mfma_f32_16x16x32_bf16 v[96:99], v[20:23], v[72:75], v[96:99]
    v_mfma_f32_16x16x32_bf16 v[100:103], v[20:23], v[56:59], v[100:103]
    v_mfma_f32_16x16x32_bf16 v[104:107], v[20:23], v[76:79], v[104:107]
    buffer_load_dwordx4 v1, s[8:11], s30 offen offset:2048 sc1 lds
    v_mfma_f32_16x16x32_bf16 v[108:111], v[20:23], v[64:67], v[108:111]
    s_waitcnt lgkmcnt(2)
    v_mfma_f32_16x16x32_bf16 v[112:115], v[24:27], v[56:59], v[112:115]
    ds_read_b128 v[16:19], v2 offset:10240
    v_mfma_f32_16x16x32_bf16 v[116:119], v[24:27], v[60:63], v[116:119]
    ds_read_b128 v[20:23], v3 offset:10240
    v_mfma_f32_16x16x32_bf16 v[120:123], v[24:27], v[64:67], v[120:123]
    v_mfma_f32_16x16x32_bf16 v[124:127], v[24:27], v[68:71], v[124:127]
    v_mfma_f32_16x16x32_bf16 v[112:115], v[28:31], v[72:75], v[112:115]
    buffer_load_dwordx4 v1, s[8:11], s30 offen offset:3072 sc1 lds
    v_mfma_f32_16x16x32_bf16 v[116:119], v[28:31], v[56:59], v[116:119]
    v_mfma_f32_16x16x32_bf16 v[120:123], v[28:31], v[76:79], v[120:123]
    v_mfma_f32_16x16x32_bf16 v[124:127], v[28:31], v[64:67], v[124:127]
    v_mfma_f32_16x16x32_bf16 v[128:131], v[32:35], v[56:59], v[128:131]
    ds_read_b128 v[24:27], v2 offset:12288
    v_mfma_f32_16x16x32_bf16 v[132:135], v[32:35], v[60:63], v[132:135]
    ds_read_b128 v[28:31], v3 offset:12288
    v_mfma_f32_16x16x32_bf16 v[136:139], v[32:35], v[64:67], v[136:139]
    s_add_u32 m0, m0, 4096
    s_add_u32 s34, s30, 4096
    buffer_load_dwordx4 v1, s[8:11], s34 offen sc1 lds
    v_mfma_f32_16x16x32_bf16 v[140:143], v[32:35], v[68:71], v[140:143]
    v_mfma_f32_16x16x32_bf16 v[128:131], v[36:39], v[72:75], v[128:131]
    v_mfma_f32_16x16x32_bf16 v[132:135], v[36:39], v[56:59], v[132:135]
    v_mfma_f32_16x16x32_bf16 v[136:139], v[36:39], v[76:79], v[136:139]
    s_add_u32 m0, s29, s37
    s_add_u32 s30, s30, 21376
    buffer_load_dwordx4 v1, s[12:15], s31 offen sc1 lds
    v_mfma_f32_16x16x32_bf16 v[140:143], v[36:39], v[64:67], v[140:143]
    s_waitcnt lgkmcnt(4)
    v_mfma_f32_16x16x32_bf16 v[144:147], v[8:11], v[56:59], v[144:147]
    ds_read_b128 v[32:35], v2 offset:14336
    v_mfma_f32_16x16x32_bf16 v[148:151], v[8:11], v[60:63], v[148:151]
    ds_read_b128 v[36:39], v3 offset:14336
    v_mfma_f32_16x16x32_bf16 v[152:155], v[8:11], v[64:67], v[152:155]
    v_mfma_f32_16x16x32_bf16 v[156:159], v[8:11], v[68:71], v[156:159]
    v_mfma_f32_16x16x32_bf16 v[144:147], v[12:15], v[72:75], v[144:147]
    buffer_load_dwordx4 v1, s[12:15], s31 offen offset:1024 sc1 lds
    v_mfma_f32_16x16x32_bf16 v[148:151], v[12:15], v[56:59], v[148:151]
    v_mfma_f32_16x16x32_bf16 v[152:155], v[12:15], v[76:79], v[152:155]
    v_mfma_f32_16x16x32_bf16 v[156:159], v[12:15], v[64:67], v[156:159]
    s_waitcnt lgkmcnt(4)
    v_mfma_f32_16x16x32_bf16 v[160:163], v[16:19], v[56:59], v[160:163]
    ds_read_b128 v[8:11], v2 offset:16384
    v_mfma_f32_16x16x32_bf16 v[164:167], v[16:19], v[60:63], v[164:167]
    ds_read_b128 v[12:15], v3 offset:16384
    v_mfma_f32_16x16x32_bf16 v[168:171], v[16:19], v[64:67], v[168:171]
    buffer_load_dwordx4 v1, s[12:15], s31 offen offset:2048 sc1 lds
    v_mfma_f32_16x16x32_bf16 v[172:175], v[16:19], v[68:71], v[172:175]
    s_add_u32 s40, s40, 1
    s_mov_b32 s51, s40
    v_mov_b32 v0, s40
    v_mfma_f32_16x16x32_bf16 v[160:163], v[20:23], v[72:75], v[160:163]
    s_waitcnt vmcnt(19)
    ds_write_b32 v7, v0
    v_mfma_f32_16x16x32_bf16 v[164:167], v[20:23], v[56:59], v[164:167]
    v_mfma_f32_16x16x32_bf16 v[168:171], v[20:23], v[76:79], v[168:171]
    buffer_load_dwordx4 v1, s[12:15], s31 offen offset:3072 sc1 lds
    v_mfma_f32_16x16x32_bf16 v[172:175], v[20:23], v[64:67], v[172:175]
    s_waitcnt lgkmcnt(5)
    v_mfma_f32_16x16x32_bf16 v[176:179], v[24:27], v[56:59], v[176:179]
    ds_read_b128 v[16:19], v2 offset:18432
    v_mfma_f32_16x16x32_bf16 v[180:183], v[24:27], v[60:63], v[180:183]
    ds_read_b128 v[20:23], v3 offset:18432
    v_mfma_f32_16x16x32_bf16 v[184:187], v[24:27], v[64:67], v[184:187]
    v_mfma_f32_16x16x32_bf16 v[188:191], v[24:27], v[68:71], v[188:191]
    v_mfma_f32_16x16x32_bf16 v[176:179], v[28:31], v[72:75], v[176:179]
    s_add_u32 m0, s29, s38
    s_mov_b64 exec, s[44:45]
    buffer_load_dwordx4 v1, s[64:67], s33 offen sc1 lds
    s_mov_b64 exec, -1
    s_add_u32 s31, s31, 16384
    s_add_u32 s33, s33, 21376
    v_mfma_f32_16x16x32_bf16 v[180:183], v[28:31], v[56:59], v[180:183]
    v_mfma_f32_16x16x32_bf16 v[184:187], v[28:31], v[76:79], v[184:187]
    s_mov_b32 m0, s46
    s_mov_b64 exec, 0xff
    buffer_load_dword v1, s[4:7], 0 offen sc1 lds
    s_mov_b64 exec, -1
    v_mfma_f32_16x16x32_bf16 v[188:191], v[28:31], v[64:67], v[188:191]
    s_waitcnt lgkmcnt(5)
    v_mfma_f32_16x16x32_bf16 v[192:195], v[32:35], v[56:59], v[192:195]
    ds_read_b128 v[24:27], v2 offset:20480
    v_mfma_f32_16x16x32_bf16 v[196:199], v[32:35], v[60:63], v[196:199]
    ds_read_b128 v[28:31], v3 offset:20480
    v_mfma_f32_16x16x32_bf16 v[200:203], v[32:35], v[64:67], v[200:203]
    s_sub_u32 s43, s42, s41
    s_add_u32 s40, s40, 1
    v_add_u32 v2, s43, v2
    v_mfma_f32_16x16x32_bf16 v[204:207], v[32:35], v[68:71], v[204:207]
    v_add_u32 v3, s43, v3
    v_add_u32 v4, s43, v4
    v_mov_b32 v0, s40
    v_mfma_f32_16x16x32_bf16 v[192:195], v[36:39], v[72:75], v[192:195]
    ds_write_b32 v7, v0
    v_mfma_f32_16x16x32_bf16 v[196:199], v[36:39], v[56:59], v[196:199]
    v_mfma_f32_16x16x32_bf16 v[200:203], v[36:39], v[76:79], v[200:203]
    v_mfma_f32_16x16x32_bf16 v[204:207], v[36:39], v[64:67], v[204:207]
    ds_read_b32 v40, v5
    s_waitcnt lgkmcnt(7)
    v_mfma_f32_16x16x32_bf16 v[208:211], v[8:11], v[56:59], v[208:211]
    v_mfma_f32_16x16x32_bf16 v[212:215], v[8:11], v[60:63], v[212:215]
    v_mfma_f32_16x16x32_bf16 v[216:219], v[8:11], v[64:67], v[216:219]
    v_mfma_f32_16x16x32_bf16 v[220:223], v[8:11], v[68:71], v[220:223]
    s_waitcnt lgkmcnt(0)
    v_cmp_gt_u32 vcc, s51, v40
    v_mfma_f32_16x16x32_bf16 v[208:211], v[12:15], v[72:75], v[208:211]
    v_mfma_f32_16x16x32_bf16 v[212:215], v[12:15], v[56:59], v[212:215]
    s_cbranch_vccnz K12_S5
K12_Q5:
    v_mfma_f32_16x16x32_bf16 v[216:219], v[12:15], v[76:79], v[216:219]
    ds_read_b64_tr_b16 v[40:41], v4 offset:0
    v_mfma_f32_16x16x32_bf16 v[220:223], v[12:15], v[64:67], v[220:223]
    ds_read_b64_tr_b16 v[42:43], v4 offset:2048
    v_mfma_f32_16x16x32_bf16 v[224:227], v[16:19], v[56:59], v[224:227]
    ds_read_b64_tr_b16 v[44:45], v4 offset:256
    ds_read_b128 v[8:11], v2 offset:0
    v_mfma_f32_16x16x32_bf16 v[228:231], v[16:19], v[60:63], v[228:231]
    ds_read_b64_tr_b16 v[46:47], v4 offset:2304
    ds_read_b128 v[12:15], v3 offset:0
    v_mfma_f32_16x16x32_bf16 v[232:235], v[16:19], v[64:67], v[232:235]
    v_xor_b32 v4, 32, v4
    ds_read_b128 v[32:35], v2 offset:6144
    v_mfma_f32_16x16x32_bf16 v[236:239], v[16:19], v[68:71], v[236:239]
    ds_read_b64_tr_b16 v[48:49], v4 offset:0
    ds_read_b128 v[36:39], v3 offset:6144
    v_mfma_f32_16x16x32_bf16 v[224:227], v[20:23], v[72:75], v[224:227]
    ds_read_b64_tr_b16 v[50:51], v4 offset:2048
    ds_read_b32 v68, v5
    v_mfma_f32_16x16x32_bf16 v[228:231], v[20:23], v[56:59], v[228:231]
    ds_read_b64_tr_b16 v[52:53], v4 offset:256
    ds_read_b64_tr_b16 v[54:55], v4 offset:2304
    v_xor_b32 v4, 32, v4
    v_mfma_f32_16x16x32_bf16 v[232:235], v[20:23], v[76:79], v[232:235]
    v_mfma_f32_16x16x32_bf16 v[236:239], v[20:23], v[64:67], v[236:239]
    v_mfma_f32_16x16x32_bf16 v[240:243], v[24:27], v[56:59], v[240:243]
    ds_read_b128 v[16:19], v2 offset:2048
    v_mfma_f32_16x16x32_bf16 v[244:247], v[24:27], v[60:63], v[244:247]
    ds_read_b128 v[20:23], v3 offset:2048
    v_mfma_f32_16x16x32_bf16 v[240:243], v[28:31], v[72:75], v[240:243]
    s_mov_b32 s29, s41
    s_mov_b32 s41, s42
    s_add_u32 s42, s42, 38912
    v_mfma_f32_16x16x32_bf16 v[244:247], v[28:31], v[56:59], v[244:247]
    s_cmp_eq_u32 s42, 155648
    s_cselect_b32 s42, 0, s42
    s_add_u32 s39, s39, 1
    s_cmp_lt_u32 s39, 15
    s_cbranch_scc1 K12_LOOP
    s_waitcnt lgkmcnt(2)
    v_mfma_f32_16x16x32_bf16 v[80:83], v[8:11], v[40:43], v[80:83]
    ds_read_b128 v[24:27], v2 offset:4096
    v_xor_b32 v72, s35, v44
    v_xor_b32 v73, s35, v45
    v_mfma_f32_16x16x32_bf16 v[84:87], v[8:11], v[44:47], v[84:87]
    ds_read_b128 v[28:31], v3 offset:4096
    v_xor_b32 v74, s35, v46
    v_xor_b32 v75, s35, v47
    v_mfma_f32_16x16x32_bf16 v[88:91], v[8:11], v[48:51], v[88:91]
    s_waitcnt lgkmcnt(2)
    v_cmp_gt_u32 vcc, s40, v68
    s_add_u32 s49, s39, 2
    s_lshr_b32 s49, s49, 1
    v_xor_b32 v76, s35, v52
    v_xor_b32 v77, s35, v53
    v_mfma_f32_16x16x32_bf16 v[92:95], v[8:11], v[52:55], v[92:95]
    s_cbranch_vccnz K12_S6
K12_Q6:
    s_mul_i32 s48, s49, s50
    s_add_u32 s48, s48, s47
    v_xor_b32 v78, s35, v54
    v_xor_b32 v79, s35, v55
    v_mfma_f32_16x16x32_bf16 v[80:83], v[12:15], v[72:75], v[80:83]
    s_add_u32 m0, s29, s36
    s_nop 0
    buffer_load_dwordx4 v1, s[8:11], s30 offen sc1 lds
    v_mfma_f32_16x16x32_bf16 v[84:87], v[12:15], v[40:43], v[84:87]
    s_cmp_lt_u32 s49, 8
    s_cselect_b32 s48, s48, 155744
    v_mfma_f32_16x16x32_bf16 v[88:91], v[12:15], v[76:79], v[88:91]
    s_cmp_ge_u32 s49, 3
    s_cselect_b32 s48, s48, 155744
    v_mfma_f32_16x16x32_bf16 v[92:95], v[12:15], v[48:51], v[92:95]
    v_mfma_f32_16x16x32_bf16 v[96:99], v[16:19], v[40:43], v[96:99]
    ds_read_b128 v[8:11], v2 offset:8192
    v_mfma_f32_16x16x32_bf16 v[100:103], v[16:19], v[44:47], v[100:103]
    ds_read_b128 v[12:15], v3 offset:8192
    v_mfma_f32_16x16x32_bf16 v[104:107], v[16:19], v[48:51], v[104:107]
    buffer_load_dwordx4 v1, s[8:11], s30 offen offset:1024 sc1 lds
    v_mfma_f32_16x16x32_bf16 v[108:111], v[16:19], v[52:55], v[108:111]
    v_mfma_f32_16x16x32_bf16 v[96:99], v[20:23], v[72:75], v[96:99]
    v_mfma_f32_16x16x32_bf16 v[100:103], v[20:23], v[40:43], v[100:103]
    v_mfma_f32_16x16x32_bf16 v[104:107], v[20:23], v[76:79], v[104:107]
    buffer_load_dwordx4 v1, s[8:11], s30 offen offset:2048 sc1 lds
    v_mfma_f32_16x16x32_bf16 v[108:111], v[20:23], v[48:51], v[108:111]
    s_waitcnt lgkmcnt(2)
    v_mfma_f32_16x16x32_bf16 v[112:115], v[24:27], v[40:43], v[112:115]
    ds_read_b128 v[16:19], v2 offset:10240
    v_mfma_f32_16x16x32_bf16 v[116:119], v[24:27], v[44:47], v[116:119]
    ds_read_b128 v[20:23], v3 offset:10240
    v_mfma_f32_16x16x32_bf16 v[120:123], v[24:27], v[48:51], v[120:123]
    v_mfma_f32_16x16x32_bf16 v[124:127], v[24:27], v[52:55], v[124:127]
    v_mfma_f32_16x16x32_bf16 v[112:115], v[28:31], v[72:75], v[112:115]
    buffer_load_dwordx4 v1, s[8:11], s30 offen offset:3072 sc1 lds
    v_mfma_f32_16x16x32_bf16 v[116:119], v[28:31], v[40:43], v[116:119]
    v_mfma_f32_16x16x32_bf16 v[120:123], v[28:31], v[76:79], v[120:123]
    v_mfma_f32_16x16x32_bf16 v[124:127], v[28:31], v[48:51], v[124:127]
    v_mfma_f32_16x16x32_bf16 v[128:131], v[32:35], v[40:43], v[128:131]
    ds_read_b128 v[24:27], v2 offset:12288
    v_mfma_f32_16x16x32_bf16 v[132:135], v[32:35], v[44:47], v[132:135]
    ds_read_b128 v[28:31], v3 offset:12288
    v_mfma_f32_16x16x32_bf16 v[136:139], v[32:35], v[48:51], v[136:139]
    s_add_u32 m0, m0, 4096
    s_add_u32 s34, s30, 4096
    buffer_load_dwordx4 v1, s[8:11], s34 offen sc1 lds
    v_mfma_f32_16x16x32_bf16 v[140:143], v[32:35], v[52:55], v[140:143]
    v_mfma_f32_16x16x32_bf16 v[128:131], v[36:39], v[72:75], v[128:131]
    v_mfma_f32_16x16x32_bf16 v[132:135], v[36:39], v[40:43], v[132:135]
    v_mfma_f32_16x16x32_bf16 v[136:139], v[36:39], v[76:79], v[136:139]
    s_add_u32 m0, s29, s37
    s_add_u32 s30, s30, 21376
    buffer_load_dwordx4 v1, s[12:15], s31 offen sc1 lds
    v_mfma_f32_16x16x32_bf16 v[140:143], v[36:39], v[48:51], v[140:143]
    s_waitcnt lgkmcnt(4)
    v_mfma_f32_16x16x32_bf16 v[144:147], v[8:11], v[40:43], v[144:147]
    ds_read_b128 v[32:35], v2 offset:14336
    v_mfma_f32_16x16x32_bf16 v[148:151], v[8:11], v[44:47], v[148:151]
    ds_read_b128 v[36:39], v3 offset:14336
    v_mfma_f32_16x16x32_bf16 v[152:155], v[8:11], v[48:51], v[152:155]
    v_mfma_f32_16x16x32_bf16 v[156:159], v[8:11], v[52:55], v[156:159]
    v_mfma_f32_16x16x32_bf16 v[144:147], v[12:15], v[72:75], v[144:147]
    buffer_load_dwordx4 v1, s[12:15], s31 offen offset:1024 sc1 lds
    v_mfma_f32_16x16x32_bf16 v[148:151], v[12:15], v[40:43], v[148:151]
    v_mfma_f32_16x16x32_bf16 v[152:155], v[12:15], v[76:79], v[152:155]
    v_mfma_f32_16x16x32_bf16 v[156:159], v[12:15], v[48:51], v[156:159]
    s_waitcnt lgkmcnt(4)
    v_mfma_f32_16x16x32_bf16 v[160:163], v[16:19], v[40:43], v[160:163]
    ds_read_b128 v[8:11], v2 offset:16384
    v_mfma_f32_16x16x32_bf16 v[164:167], v[16:19], v[44:47], v[164:167]
    ds_read_b128 v[12:15], v3 offset:16384
    v_mfma_f32_16x16x32_bf16 v[168:171], v[16:19], v[48:51], v[168:171]
    buffer_load_dwordx4 v1, s[12:15], s31 offen offset:2048 sc1 lds
    v_mfma_f32_16x16x32_bf16 v[172:175], v[16:19], v[52:55], v[172:175]
    s_add_u32 s40, s40, 1
    s_mov_b32 s51, s40
    v_mov_b32 v0, s40
    v_mfma_f32_16x16x32_bf16 v[160:163], v[20:23], v[72:75], v[160:163]
    s_waitcnt vmcnt(19)
    ds_write_b32 v7, v0
    v_mfma_f32_16x16x32_bf16 v[164:167], v[20:23], v[40:43], v[164:167]
    v_mfma_f32_16x16x32_bf16 v[168:171], v[20:23], v[76:79], v[168:171]
    buffer_load_dwordx4 v1, s[12:15], s31 offen offset:3072 sc1 lds
    v_mfma_f32_16x16x32_bf16 v[172:175], v[20:23], v[48:51], v[172:175]
    s_waitcnt lgkmcnt(5)
    v_mfma_f32_16x16x32_bf16 v[176:179], v[24:27], v[40:43], v[176:179]
    ds_read_b128 v[16:19], v2 offset:18432
    v_mfma_f32_16x16x32_bf16 v[180:183], v[24:27], v[44:47], v[180:183]
    ds_read_b128 v[20:23], v3 offset:18432
    v_mov_b32 v0, s48
    v_mfma_f32_16x16x32_bf16 v[184:187], v[24:27], v[48:51], v[184:187]
    ds_read_b32 v0, v0
    v_mfma_f32_16x16x32_bf16 v[188:191], v[24:27], v[52:55], v[188:191]
    v_mfma_f32_16x16x32_bf16 v[176:179], v[28:31], v[72:75], v[176:179]
    s_add_u32 m0, s29, s38
    s_mov_b64 exec, s[44:45]
    buffer_load_dwordx4 v1, s[64:67], s33 offen sc1 lds
    s_mov_b64 exec, -1
    s_add_u32 s31, s31, 16384
    s_add_u32 s33, s33, 21376
    v_mfma_f32_16x16x32_bf16 v[180:183], v[28:31], v[40:43], v[180:183]
    v_mfma_f32_16x16x32_bf16 v[184:187], v[28:31], v[76:79], v[184:187]
    v_mfma_f32_16x16x32_bf16 v[188:191], v[28:31], v[48:51], v[188:191]
    s_waitcnt lgkmcnt(0)
    v_cmp_eq_u32 vcc, 0, v0
    v_mfma_f32_16x16x32_bf16 v[192:195], v[32:35], v[40:43], v[192:195]
    ds_read_b128 v[24:27], v2 offset:20480
    v_mfma_f32_16x16x32_bf16 v[196:199], v[32:35], v[44:47], v[196:199]
    ds_read_b128 v[28:31], v3 offset:20480
    s_cbranch_vccnz K12_F7
K12_G7:
    v_mfma_f32_16x16x32_bf16 v[200:203], v[32:35], v[48:51], v[200:203]
    s_sub_u32 s43, s42, s41
    s_add_u32 s40, s40, 1
    v_add_u32 v2, s43, v2
    v_mfma_f32_16x16x32_bf16 v[204:207], v[32:35], v[52:55], v[204:207]
    v_add_u32 v3, s43, v3
    v_add_u32 v4, s43, v4
    v_mov_b32 v0, s40
    v_mfma_f32_16x16x32_bf16 v[192:195], v[36:39], v[72:75], v[192:195]
    ds_write_b32 v7, v0
    v_mfma_f32_16x16x32_bf16 v[196:199], v[36:39], v[40:43], v[196:199]
    v_mfma_f32_16x16x32_bf16 v[200:203], v[36:39], v[76:79], v[200:203]
    v_mfma_f32_16x16x32_bf16 v[204:207], v[36:39], v[48:51], v[204:207]
    ds_read_b32 v56, v5
    v_mfma_f32_16x16x32_bf16 v[208:211], v[8:11], v[40:43], v[208:211]
    v_mfma_f32_16x16x32_bf16 v[212:215], v[8:11], v[44:47], v[212:215]
    v_mfma_f32_16x16x32_bf16 v[216:219], v[8:11], v[48:51], v[216:219]
    v_mfma_f32_16x16x32_bf16 v[220:223], v[8:11], v[52:55], v[220:223]
    s_waitcnt lgkmcnt(0)
    v_cmp_gt_u32 vcc, s51, v56
    v_mfma_f32_16x16x32_bf16 v[208:211], v[12:15], v[72:75], v[208:211]
    v_mfma_f32_16x16x32_bf16 v[212:215], v[12:15], v[40:43], v[212:215]
    s_cbranch_vccnz K12_S8
K12_Q8:
    v_mfma_f32_16x16x32_bf16 v[216:219], v[12:15], v[76:79], v[216:219]
    ds_read_b64_tr_b16 v[56:57], v4 offset:0
    v_mfma_f32_16x16x32_bf16 v[220:223], v[12:15], v[48:51], v[220:223]
    ds_read_b64_tr_b16 v[58:59], v4 offset:2048
    v_mfma_f32_16x16x32_bf16 v[224:227], v[16:19], v[40:43], v[224:227]
    ds_read_b64_tr_b16 v[60:61], v4 offset:256
    ds_read_b128 v[8:11], v2 offset:0
    v_mfma_f32_16x16x32_bf16 v[228:231], v[16:19], v[44:47], v[228:231]
    ds_read_b64_tr_b16 v[62:63], v4 offset:2304
    ds_read_b128 v[12:15], v3 offset:0
    v_mfma_f32_16x16x32_bf16 v[232:235], v[16:19], v[48:51], v[232:235]
    v_xor_b32 v4, 32, v4
    ds_read_b128 v[32:35], v2 offset:6144
    v_mfma_f32_16x16x32_bf16 v[236:239], v[16:19], v[52:55], v[236:239]
    ds_read_b64_tr_b16 v[64:65], v4 offset:0
    ds_read_b128 v[36:39], v3 offset:6144
    v_mfma_f32_16x16x32_bf16 v[224:227], v[20:23], v[72:75], v[224:227]
    ds_read_b64_tr_b16 v[66:67], v4 offset:2048
    ds_read_b32 v52, v5
    v_mfma_f32_16x16x32_bf16 v[228:231], v[20:23], v[40:43], v[228:231]
    ds_read_b64_tr_b16 v[68:69], v4 offset:256
    ds_read_b64_tr_b16 v[70:71], v4 offset:2304
    v_xor_b32 v4, 32, v4
    v_mfma_f32_16x16x32_bf16 v[232:235], v[20:23], v[76:79], v[232:235]
    v_mfma_f32_16x16x32_bf16 v[236:239], v[20:23], v[48:51], v[236:239]
    v_mfma_f32_16x16x32_bf16 v[240:243], v[24:27], v[40:43], v[240:243]
    ds_read_b128 v[16:19], v2 offset:2048
    v_mfma_f32_16x16x32_bf16 v[244:247], v[24:27], v[44:47], v[244:247]
    ds_read_b128 v[20:23], v3 offset:2048
    v_mfma_f32_16x16x32_bf16 v[240:243], v[28:31], v[72:75], v[240:243]
    s_mov_b32 s29, s41
    s_mov_b32 s41, s42
    s_add_u32 s42, s42, 38912
    v_mfma_f32_16x16x32_bf16 v[244:247], v[28:31], v[40:43], v[244:247]
    s_cmp_eq_u32 s42, 155648
    s_cselect_b32 s42, 0, s42
    s_waitcnt lgkmcnt(2)
    v_mfma_f32_16x16x32_bf16 v[80:83], v[8:11], v[56:59], v[80:83]
    ds_read_b128 v[24:27], v2 offset:4096
    v_xor_b32 v72, s35, v60
    v_xor_b32 v73, s35, v61
    v_mfma_f32_16x16x32_bf16 v[84:87], v[8:11], v[60:63], v[84:87]
    ds_read_b128 v[28:31], v3 offset:4096
    v_xor_b32 v74, s35, v62
    v_xor_b32 v75, s35, v63
    v_mfma_f32_16x16x32_bf16 v[88:91], v[8:11], v[64:67], v[88:91]
    v_xor_b32 v76, s35, v68
    v_xor_b32 v77, s35, v69
    v_mfma_f32_16x16x32_bf16 v[92:95], v[8:11], v[68:71], v[92:95]
    v_xor_b32 v78, s35, v70
    v_xor_b32 v79, s35, v71
    v_mfma_f32_16x16x32_bf16 v[80:83], v[12:15], v[72:75], v[80:83]
    v_lshrrev_b32 v0, 4, v1
    v_and_b32 v5, 15, v0
    v_mfma_f32_16x16x32_bf16 v[84:87], v[12:15], v[56:59], v[84:87]
    v_lshrrev_b32 v0, 4, v0
    s_lshl_b32 s28, s21, 7
    v_mfma_f32_16x16x32_bf16 v[88:91], v[12:15], v[76:79], v[88:91]
    s_lshl_b32 s29, s3, 5
    s_add_u32 s28, s28, s29
    v_mfma_f32_16x16x32_bf16 v[92:95], v[12:15], v[64:67], v[92:95]
    v_add_u32 v5, s28, v5
    v_lshlrev_b32 v5, 2, v5
    s_waitcnt lgkmcnt(2)
    v_mfma_f32_16x16x32_bf16 v[96:99], v[16:19], v[56:59], v[96:99]
    ds_read_b128 v[8:11], v2 offset:8192
    v_lshl_add_u32 v5, v0, 13, v5
    s_lshl_b32 s28, s20, 6
    v_mfma_f32_16x16x32_bf16 v[100:103], v[16:19], v[60:63], v[100:103]
    ds_read_b128 v[12:15], v3 offset:8192
    v_xor_b32 v5, s28, v5
    v_xor_b32 v7, 64, v5
    v_mfma_f32_16x16x32_bf16 v[104:107], v[16:19], v[64:67], v[104:107]
    v_mfma_f32_16x16x32_bf16 v[108:111], v[16:19], v[68:71], v[108:111]
    s_mov_b32 s38, 0
    v_cvt_pk_bf16_f32 v48, v80, v84
    buffer_store_dword v48, v5, s[16:19], s38 offen offset:0 sc1
    v_cvt_pk_bf16_f32 v49, v88, v92
    buffer_store_dword v49, v7, s[16:19], s38 offen offset:0 sc1
    v_mfma_f32_16x16x32_bf16 v[96:99], v[20:23], v[72:75], v[96:99]
    v_cvt_pk_bf16_f32 v50, v81, v85
    buffer_store_dword v50, v5, s[16:19], s38 offen offset:2048 sc1
    v_mfma_f32_16x16x32_bf16 v[100:103], v[20:23], v[56:59], v[100:103]
    v_cvt_pk_bf16_f32 v51, v89, v93
    buffer_store_dword v51, v7, s[16:19], s38 offen offset:2048 sc1
    v_mfma_f32_16x16x32_bf16 v[104:107], v[20:23], v[76:79], v[104:107]
    s_mov_b32 s38, 4096
    v_cvt_pk_bf16_f32 v52, v82, v86
    buffer_store_dword v52, v5, s[16:19], s38 offen offset:0 sc1
    v_cvt_pk_bf16_f32 v53, v90, v94
    buffer_store_dword v53, v7, s[16:19], s38 offen offset:0 sc1
    v_mfma_f32_16x16x32_bf16 v[108:111], v[20:23], v[64:67], v[108:111]
    v_cvt_pk_bf16_f32 v54, v83, v87
    buffer_store_dword v54, v5, s[16:19], s38 offen offset:2048 sc1
    s_waitcnt lgkmcnt(2)
    v_mfma_f32_16x16x32_bf16 v[112:115], v[24:27], v[56:59], v[112:115]
    ds_read_b128 v[16:19], v2 offset:10240
    v_cvt_pk_bf16_f32 v55, v91, v95
    buffer_store_dword v55, v7, s[16:19], s38 offen offset:2048 sc1
    v_mfma_f32_16x16x32_bf16 v[116:119], v[24:27], v[60:63], v[116:119]
    ds_read_b128 v[20:23], v3 offset:10240
    v_mfma_f32_16x16x32_bf16 v[120:123], v[24:27], v[64:67], v[120:123]
    v_mfma_f32_16x16x32_bf16 v[124:127], v[24:27], v[68:71], v[124:127]
    s_mov_b32 s38, 32768
    v_cvt_pk_bf16_f32 v40, v96, v100
    buffer_store_dword v40, v5, s[16:19], s38 offen offset:0 sc1
    v_cvt_pk_bf16_f32 v41, v104, v108
    buffer_store_dword v41, v7, s[16:19], s38 offen offset:0 sc1
    v_mfma_f32_16x16x32_bf16 v[112:115], v[28:31], v[72:75], v[112:115]
    v_cvt_pk_bf16_f32 v42, v97, v101
    buffer_store_dword v42, v5, s[16:19], s38 offen offset:2048 sc1
    v_mfma_f32_16x16x32_bf16 v[116:119], v[28:31], v[56:59], v[116:119]
    v_cvt_pk_bf16_f32 v43, v105, v109
    buffer_store_dword v43, v7, s[16:19], s38 offen offset:2048 sc1
    v_mfma_f32_16x16x32_bf16 v[120:123], v[28:31], v[76:79], v[120:123]
    s_mov_b32 s38, 36864
    v_cvt_pk_bf16_f32 v44, v98, v102
    buffer_store_dword v44, v5, s[16:19], s38 offen offset:0 sc1
    v_cvt_pk_bf16_f32 v45, v106, v110
    buffer_store_dword v45, v7, s[16:19], s38 offen offset:0 sc1
    v_mfma_f32_16x16x32_bf16 v[124:127], v[28:31], v[64:67], v[124:127]
    v_cvt_pk_bf16_f32 v46, v99, v103
    buffer_store_dword v46, v5, s[16:19], s38 offen offset:2048 sc1
    v_mfma_f32_16x16x32_bf16 v[128:131], v[32:35], v[56:59], v[128:131]
    ds_read_b128 v[24:27], v2 offset:12288
    v_cvt_pk_bf16_f32 v47, v107, v111
    buffer_store_dword v47, v7, s[16:19], s38 offen offset:2048 sc1
    v_mfma_f32_16x16x32_bf16 v[132:135], v[32:35], v[60:63], v[132:135]
    ds_read_b128 v[28:31], v3 offset:12288
    v_mfma_f32_16x16x32_bf16 v[136:139], v[32:35], v[64:67], v[136:139]
    v_mfma_f32_16x16x32_bf16 v[140:143], v[32:35], v[68:71], v[140:143]
    s_mov_b32 s38, 65536
    v_cvt_pk_bf16_f32 v48, v112, v116
    buffer_store_dword v48, v5, s[16:19], s38 offen offset:0 sc1
    v_cvt_pk_bf16_f32 v49, v120, v124
    buffer_store_dword v49, v7, s[16:19], s38 offen offset:0 sc1
    v_mfma_f32_16x16x32_bf16 v[128:131], v[36:39], v[72:75], v[128:131]
    v_cvt_pk_bf16_f32 v50, v113, v117
    buffer_store_dword v50, v5, s[16:19], s38 offen offset:2048 sc1
    v_mfma_f32_16x16x32_bf16 v[132:135], v[36:39], v[56:59], v[132:135]
    v_cvt_pk_bf16_f32 v51, v121, v125
    buffer_store_dword v51, v7, s[16:19], s38 offen offset:2048 sc1
    v_mfma_f32_16x16x32_bf16 v[136:139], v[36:39], v[76:79], v[136:139]
    s_mov_b32 s38, 69632
    v_cvt_pk_bf16_f32 v52, v114, v118
    buffer_store_dword v52, v5, s[16:19], s38 offen offset:0 sc1
    v_cvt_pk_bf16_f32 v53, v122, v126
    buffer_store_dword v53, v7, s[16:19], s38 offen offset:0 sc1
    v_mfma_f32_16x16x32_bf16 v[140:143], v[36:39], v[64:67], v[140:143]
    v_cvt_pk_bf16_f32 v54, v115, v119
    buffer_store_dword v54, v5, s[16:19], s38 offen offset:2048 sc1
    s_waitcnt lgkmcnt(4)
    v_mfma_f32_16x16x32_bf16 v[144:147], v[8:11], v[56:59], v[144:147]
    ds_read_b128 v[32:35], v2 offset:14336
    v_cvt_pk_bf16_f32 v55, v123, v127
    buffer_store_dword v55, v7, s[16:19], s38 offen offset:2048 sc1
    v_mfma_f32_16x16x32_bf16 v[148:151], v[8:11], v[60:63], v[148:151]
    ds_read_b128 v[36:39], v3 offset:14336
    v_mfma_f32_16x16x32_bf16 v[152:155], v[8:11], v[64:67], v[152:155]
    v_mfma_f32_16x16x32_bf16 v[156:159], v[8:11], v[68:71], v[156:159]
    s_mov_b32 s38, 98304
    v_cvt_pk_bf16_f32 v40, v128, v132
    buffer_store_dword v40, v5, s[16:19], s38 offen offset:0 sc1
    v_cvt_pk_bf16_f32 v41, v136, v140
    buffer_store_dword v41, v7, s[16:19], s38 offen offset:0 sc1
    v_mfma_f32_16x16x32_bf16 v[144:147], v[12:15], v[72:75], v[144:147]
    v_cvt_pk_bf16_f32 v42, v129, v133
    buffer_store_dword v42, v5, s[16:19], s38 offen offset:2048 sc1
    v_mfma_f32_16x16x32_bf16 v[148:151], v[12:15], v[56:59], v[148:151]
    v_cvt_pk_bf16_f32 v43, v137, v141
    buffer_store_dword v43, v7, s[16:19], s38 offen offset:2048 sc1
    v_mfma_f32_16x16x32_bf16 v[152:155], v[12:15], v[76:79], v[152:155]
    s_mov_b32 s38, 102400
    v_cvt_pk_bf16_f32 v44, v130, v134
    buffer_store_dword v44, v5, s[16:19], s38 offen offset:0 sc1
    v_cvt_pk_bf16_f32 v45, v138, v142
    buffer_store_dword v45, v7, s[16:19], s38 offen offset:0 sc1
    v_mfma_f32_16x16x32_bf16 v[156:159], v[12:15], v[64:67], v[156:159]
    v_cvt_pk_bf16_f32 v46, v131, v135
    buffer_store_dword v46, v5, s[16:19], s38 offen offset:2048 sc1
    s_waitcnt lgkmcnt(4)
    v_mfma_f32_16x16x32_bf16 v[160:163], v[16:19], v[56:59], v[160:163]
    ds_read_b128 v[8:11], v2 offset:16384
    v_cvt_pk_bf16_f32 v47, v139, v143
    buffer_store_dword v47, v7, s[16:19], s38 offen offset:2048 sc1
    v_mfma_f32_16x16x32_bf16 v[164:167], v[16:19], v[60:63], v[164:167]
    ds_read_b128 v[12:15], v3 offset:16384
    v_mfma_f32_16x16x32_bf16 v[168:171], v[16:19], v[64:67], v[168:171]
    v_mfma_f32_16x16x32_bf16 v[172:175], v[16:19], v[68:71], v[172:175]
    s_mov_b32 s38, 131072
    v_cvt_pk_bf16_f32 v48, v144, v148
    buffer_store_dword v48, v5, s[16:19], s38 offen offset:0 sc1
    v_cvt_pk_bf16_f32 v49, v152, v156
    buffer_store_dword v49, v7, s[16:19], s38 offen offset:0 sc1
    v_mfma_f32_16x16x32_bf16 v[160:163], v[20:23], v[72:75], v[160:163]
    v_cvt_pk_bf16_f32 v50, v145, v149
    buffer_store_dword v50, v5, s[16:19], s38 offen offset:2048 sc1
    v_mfma_f32_16x16x32_bf16 v[164:167], v[20:23], v[56:59], v[164:167]
    v_cvt_pk_bf16_f32 v51, v153, v157
    buffer_store_dword v51, v7, s[16:19], s38 offen offset:2048 sc1
    v_mfma_f32_16x16x32_bf16 v[168:171], v[20:23], v[76:79], v[168:171]
    s_mov_b32 s38, 135168
    v_cvt_pk_bf16_f32 v52, v146, v150
    buffer_store_dword v52, v5, s[16:19], s38 offen offset:0 sc1
    v_cvt_pk_bf16_f32 v53, v154, v158
    buffer_store_dword v53, v7, s[16:19], s38 offen offset:0 sc1
    v_mfma_f32_16x16x32_bf16 v[172:175], v[20:23], v[64:67], v[172:175]
    v_cvt_pk_bf16_f32 v54, v147, v151
    buffer_store_dword v54, v5, s[16:19], s38 offen offset:2048 sc1
    s_waitcnt lgkmcnt(4)
    v_mfma_f32_16x16x32_bf16 v[176:179], v[24:27], v[56:59], v[176:179]
    ds_read_b128 v[16:19], v2 offset:18432
    v_cvt_pk_bf16_f32 v55, v155, v159
    buffer_store_dword v55, v7, s[16:19], s38 offen offset:2048 sc1
    v_mfma_f32_16x16x32_bf16 v[180:183], v[24:27], v[60:63], v[180:183]
    ds_read_b128 v[20:23], v3 offset:18432
    v_mfma_f32_16x16x32_bf16 v[184:187], v[24:27], v[64:67], v[184:187]
    v_mfma_f32_16x16x32_bf16 v[188:191], v[24:27], v[68:71], v[188:191]
    s_mov_b32 s38, 163840
    v_cvt_pk_bf16_f32 v40, v160, v164
    buffer_store_dword v40, v5, s[16:19], s38 offen offset:0 sc1
    v_cvt_pk_bf16_f32 v41, v168, v172
    buffer_store_dword v41, v7, s[16:19], s38 offen offset:0 sc1
    v_mfma_f32_16x16x32_bf16 v[176:179], v[28:31], v[72:75], v[176:179]
    v_cvt_pk_bf16_f32 v42, v161, v165
    buffer_store_dword v42, v5, s[16:19], s38 offen offset:2048 sc1
    v_mfma_f32_16x16x32_bf16 v[180:183], v[28:31], v[56:59], v[180:183]
    v_cvt_pk_bf16_f32 v43, v169, v173
    buffer_store_dword v43, v7, s[16:19], s38 offen offset:2048 sc1
    v_mfma_f32_16x16x32_bf16 v[184:187], v[28:31], v[76:79], v[184:187]
    s_mov_b32 s38, 167936
    v_cvt_pk_bf16_f32 v44, v162, v166
    buffer_store_dword v44, v5, s[16:19], s38 offen offset:0 sc1
    v_cvt_pk_bf16_f32 v45, v170, v174
    buffer_store_dword v45, v7, s[16:19], s38 offen offset:0 sc1
    v_mfma_f32_16x16x32_bf16 v[188:191], v[28:31], v[64:67], v[188:191]
    v_cvt_pk_bf16_f32 v46, v163, v167
    buffer_store_dword v46, v5, s[16:19], s38 offen offset:2048 sc1
    s_waitcnt lgkmcnt(4)
    v_mfma_f32_16x16x32_bf16 v[192:195], v[32:35], v[56:59], v[192:195]
    ds_read_b128 v[24:27], v2 offset:20480
    v_cvt_pk_bf16_f32 v47, v171, v175
    buffer_store_dword v47, v7, s[16:19], s38 offen offset:2048 sc1
    v_mfma_f32_16x16x32_bf16 v[196:199], v[32:35], v[60:63], v[196:199]
    ds_read_b128 v[28:31], v3 offset:20480
    v_mfma_f32_16x16x32_bf16 v[200:203], v[32:35], v[64:67], v[200:203]
    v_mfma_f32_16x16x32_bf16 v[204:207], v[32:35], v[68:71], v[204:207]
    s_mov_b32 s38, 196608
    v_cvt_pk_bf16_f32 v48, v176, v180
    buffer_store_dword v48, v5, s[16:19], s38 offen offset:0 sc1
    v_cvt_pk_bf16_f32 v49, v184, v188
    buffer_store_dword v49, v7, s[16:19], s38 offen offset:0 sc1
    v_mfma_f32_16x16x32_bf16 v[192:195], v[36:39], v[72:75], v[192:195]
    v_cvt_pk_bf16_f32 v50, v177, v181
    buffer_store_dword v50, v5, s[16:19], s38 offen offset:2048 sc1
    v_mfma_f32_16x16x32_bf16 v[196:199], v[36:39], v[56:59], v[196:199]
    v_cvt_pk_bf16_f32 v51, v185, v189
    buffer_store_dword v51, v7, s[16:19], s38 offen offset:2048 sc1
    v_mfma_f32_16x16x32_bf16 v[200:203], v[36:39], v[76:79], v[200:203]
    s_mov_b32 s38, 200704
    v_cvt_pk_bf16_f32 v52, v178, v182
    buffer_store_dword v52, v5, s[16:19], s38 offen offset:0 sc1
    v_cvt_pk_bf16_f32 v53, v186, v190
    buffer_store_dword v53, v7, s[16:19], s38 offen offset:0 sc1
    v_mfma_f32_16x16x32_bf16 v[204:207], v[36:39], v[64:67], v[204:207]
    v_cvt_pk_bf16_f32 v54, v179, v183
    buffer_store_dword v54, v5, s[16:19], s38 offen offset:2048 sc1
    s_waitcnt lgkmcnt(4)
    v_mfma_f32_16x16x32_bf16 v[208:211], v[8:11], v[56:59], v[208:211]
    v_cvt_pk_bf16_f32 v55, v187, v191
    buffer_store_dword v55, v7, s[16:19], s38 offen offset:2048 sc1
    v_mfma_f32_16x16x32_bf16 v[212:215], v[8:11], v[60:63], v[212:215]
    v_mfma_f32_16x16x32_bf16 v[216:219], v[8:11], v[64:67], v[216:219]
    v_mfma_f32_16x16x32_bf16 v[220:223], v[8:11], v[68:71], v[220:223]
    s_mov_b32 s38, 229376
    v_cvt_pk_bf16_f32 v40, v192, v196
    buffer_store_dword v40, v5, s[16:19], s38 offen offset:0 sc1
    v_cvt_pk_bf16_f32 v41, v200, v204
    buffer_store_dword v41, v7, s[16:19], s38 offen offset:0 sc1
    v_mfma_f32_16x16x32_bf16 v[208:211], v[12:15], v[72:75], v[208:211]
    v_cvt_pk_bf16_f32 v42, v193, v197
    buffer_store_dword v42, v5, s[16:19], s38 offen offset:2048 sc1
    v_mfma_f32_16x16x32_bf16 v[212:215], v[12:15], v[56:59], v[212:215]
    v_cvt_pk_bf16_f32 v43, v201, v205
    buffer_store_dword v43, v7, s[16:19], s38 offen offset:2048 sc1
    v_mfma_f32_16x16x32_bf16 v[216:219], v[12:15], v[76:79], v[216:219]
    s_mov_b32 s38, 233472
    v_cvt_pk_bf16_f32 v44, v194, v198
    buffer_store_dword v44, v5, s[16:19], s38 offen offset:0 sc1
    v_cvt_pk_bf16_f32 v45, v202, v206
    buffer_store_dword v45, v7, s[16:19], s38 offen offset:0 sc1
    v_mfma_f32_16x16x32_bf16 v[220:223], v[12:15], v[64:67], v[220:223]
    v_cvt_pk_bf16_f32 v46, v195, v199
    buffer_store_dword v46, v5, s[16:19], s38 offen offset:2048 sc1
    s_waitcnt lgkmcnt(2)
    v_mfma_f32_16x16x32_bf16 v[224:227], v[16:19], v[56:59], v[224:227]
    v_cvt_pk_bf16_f32 v47, v203, v207
    buffer_store_dword v47, v7, s[16:19], s38 offen offset:2048 sc1
    v_mfma_f32_16x16x32_bf16 v[228:231], v[16:19], v[60:63], v[228:231]
    v_mfma_f32_16x16x32_bf16 v[232:235], v[16:19], v[64:67], v[232:235]
    v_mfma_f32_16x16x32_bf16 v[236:239], v[16:19], v[68:71], v[236:239]
    s_mov_b32 s38, 262144
    v_cvt_pk_bf16_f32 v48, v208, v212
    buffer_store_dword v48, v5, s[16:19], s38 offen offset:0 sc1
    v_cvt_pk_bf16_f32 v49, v216, v220
    buffer_store_dword v49, v7, s[16:19], s38 offen offset:0 sc1
    v_mfma_f32_16x16x32_bf16 v[224:227], v[20:23], v[72:75], v[224:227]
    v_cvt_pk_bf16_f32 v50, v209, v213
    buffer_store_dword v50, v5, s[16:19], s38 offen offset:2048 sc1
    v_mfma_f32_16x16x32_bf16 v[228:231], v[20:23], v[56:59], v[228:231]
    v_cvt_pk_bf16_f32 v51, v217, v221
    buffer_store_dword v51, v7, s[16:19], s38 offen offset:2048 sc1
    v_mfma_f32_16x16x32_bf16 v[232:235], v[20:23], v[76:79], v[232:235]
    s_mov_b32 s38, 266240
    v_cvt_pk_bf16_f32 v52, v210, v214
    buffer_store_dword v52, v5, s[16:19], s38 offen offset:0 sc1
    v_cvt_pk_bf16_f32 v53, v218, v222
    buffer_store_dword v53, v7, s[16:19], s38 offen offset:0 sc1
    v_mfma_f32_16x16x32_bf16 v[236:239], v[20:23], v[64:67], v[236:239]
    v_cvt_pk_bf16_f32 v54, v211, v215
    buffer_store_dword v54, v5, s[16:19], s38 offen offset:2048 sc1
    s_waitcnt lgkmcnt(0)
    v_mfma_f32_16x16x32_bf16 v[240:243], v[24:27], v[56:59], v[240:243]
    v_cvt_pk_bf16_f32 v55, v219, v223
    buffer_store_dword v55, v7, s[16:19], s38 offen offset:2048 sc1
    v_mfma_f32_16x16x32_bf16 v[244:247], v[24:27], v[60:63], v[244:247]
    v_mfma_f32_16x16x32_bf16 v[240:243], v[28:31], v[72:75], v[240:243]
    v_mfma_f32_16x16x32_bf16 v[244:247], v[28:31], v[56:59], v[244:247]
    s_mov_b32 s38, 294912
    v_cvt_pk_bf16_f32 v40, v224, v228
    buffer_store_dword v40, v5, s[16:19], s38 offen offset:0 sc1
    v_cvt_pk_bf16_f32 v41, v232, v236
    buffer_store_dword v41, v7, s[16:19], s38 offen offset:0 sc1
    v_cvt_pk_bf16_f32 v42, v225, v229
    buffer_store_dword v42, v5, s[16:19], s38 offen offset:2048 sc1
    v_cvt_pk_bf16_f32 v43, v233, v237
    buffer_store_dword v43, v7, s[16:19], s38 offen offset:2048 sc1
    s_mov_b32 s38, 299008
    v_cvt_pk_bf16_f32 v44, v226, v230
    buffer_store_dword v44, v5, s[16:19], s38 offen offset:0 sc1
    v_cvt_pk_bf16_f32 v45, v234, v238
    buffer_store_dword v45, v7, s[16:19], s38 offen offset:0 sc1
    v_cvt_pk_bf16_f32 v46, v227, v231
    buffer_store_dword v46, v5, s[16:19], s38 offen offset:2048 sc1
    v_cvt_pk_bf16_f32 v47, v235, v239
    buffer_store_dword v47, v7, s[16:19], s38 offen offset:2048 sc1
    s_nop 7
    s_lshl_b32 s34, s27, 1
    s_mul_i32 s34, s34, 342016
    s_add_u32 s34, s34, 118489088
    s_add_u32 s64, s58, s34
    s_addc_u32 s65, s59, 0
    s_and_b32 s65, s65, 0xffff
    s_mov_b32 s66, 684032
    s_mov_b32 s67, 0x00020000
    v_lshrrev_b32 v8, 8, v1
    v_lshlrev_b32 v9, 13, v8
    v_sub_u32 v9, v5, v9
    v_lshlrev_b32 v8, 2, v8
    v_add_u32 v8, 160, v8
    v_add_u32 v10, 0, v8
    v_add_u32 v11, 160, v10
    v_cmp_gt_u32 vcc, 167, v10
    s_nop 1
    v_cndmask_b32 v11, v11, v10, vcc
    v_cmp_gt_u32 vcc, 174, v10
    v_mov_b32 v12, 0x7ffff
    s_nop 0
    v_cndmask_b32 v11, v12, v11, vcc
    v_lshl_add_u32 v16, v11, 11, v9
    v_add_u32 v10, 1, v8
    v_add_u32 v11, 160, v10
    v_cmp_gt_u32 vcc, 167, v10
    s_nop 1
    v_cndmask_b32 v11, v11, v10, vcc
    v_cmp_gt_u32 vcc, 174, v10
    v_mov_b32 v12, 0x7ffff
    s_nop 0
    v_cndmask_b32 v11, v12, v11, vcc
    v_lshl_add_u32 v17, v11, 11, v9
    v_add_u32 v10, 2, v8
    v_add_u32 v11, 160, v10
    v_cmp_gt_u32 vcc, 167, v10
    s_nop 1
    v_cndmask_b32 v11, v11, v10, vcc
    v_cmp_gt_u32 vcc, 174, v10
    v_mov_b32 v12, 0x7ffff
    s_nop 0
    v_cndmask_b32 v11, v12, v11, vcc
    v_lshl_add_u32 v18, v11, 11, v9
    v_add_u32 v10, 3, v8
    v_add_u32 v11, 160, v10
    v_cmp_gt_u32 vcc, 167, v10
    s_nop 1
    v_cndmask_b32 v11, v11, v10, vcc
    v_cmp_gt_u32 vcc, 174, v10
    v_mov_b32 v12, 0x7ffff
    s_nop 0
    v_cndmask_b32 v11, v12, v11, vcc
    v_lshl_add_u32 v19, v11, 11, v9
    v_cvt_pk_bf16_f32 v20, v240, v244
    buffer_store_dword v20, v16, s[64:67], 0 offen sc1
    v_cvt_pk_bf16_f32 v21, v241, v245
    buffer_store_dword v21, v17, s[64:67], 0 offen sc1
    v_cvt_pk_bf16_f32 v22, v242, v246
    buffer_store_dword v22, v18, s[64:67], 0 offen sc1
    v_cvt_pk_bf16_f32 v23, v243, v247
    buffer_store_dword v23, v19, s[64:67], 0 offen sc1
    s_endpgm
K12_S0:
    s_mov_b32 s61, 16384
    s_add_u32 s62, s62, 1
K12_S0_L:
    ds_read_b32 v56, v5
    s_waitcnt lgkmcnt(0)
    v_cmp_gt_u32 vcc, s40, v56
    s_sub_u32 s61, s61, 1
    s_cmp_eq_u32 s61, 0
    s_cbranch_scc1 K12_Q0
    s_cbranch_vccz K12_Q0
    s_branch K12_S0_L
K12_S1:
    s_mov_b32 s61, 16384
    s_add_u32 s62, s62, 1
K12_S1_L:
    ds_read_b32 v68, v5
    s_waitcnt lgkmcnt(0)
    v_cmp_gt_u32 vcc, s40, v68
    s_sub_u32 s61, s61, 1
    s_cmp_eq_u32 s61, 0
    s_cbranch_scc1 K12_Q1
    s_cbranch_vccz K12_Q1
    s_branch K12_S1_L
K12_F2:
    s_mov_b32 s61, 16384
    s_add_u32 s63, s63, 1
K12_F2_L:
    s_mov_b32 m0, s46
    s_mov_b64 exec, 0xff
    buffer_load_dword v1, s[4:7], 0 offen sc1 lds
    s_mov_b64 exec, -1
    s_waitcnt vmcnt(0)
    v_mov_b32 v0, s48
    ds_read_b32 v0, v0
    s_waitcnt lgkmcnt(0)
    v_cmp_eq_u32 vcc, 0, v0
    s_sub_u32 s61, s61, 1
    s_cmp_eq_u32 s61, 0
    s_cbranch_scc1 K12_F2_X
    s_cbranch_vccz K12_F2_X
    s_sleep 2
    s_branch K12_F2_L
K12_F2_X:
    s_branch K12_G2
K12_S3:
    s_mov_b32 s61, 16384
    s_add_u32 s62, s62, 1
K12_S3_L:
    ds_read_b32 v56, v5
    s_waitcnt lgkmcnt(0)
    v_cmp_gt_u32 vcc, s51, v56
    s_sub_u32 s61, s61, 1
    s_cmp_eq_u32 s61, 0
    s_cbranch_scc1 K12_Q3
    s_cbranch_vccz K12_Q3
    s_branch K12_S3_L
K12_S4:
    s_mov_b32 s61, 16384
    s_add_u32 s62, s62, 1
K12_S4_L:
    ds_read_b32 v52, v5
    s_waitcnt lgkmcnt(0)
    v_cmp_gt_u32 vcc, s40, v52
    s_sub_u32 s61, s61, 1
    s_cmp_eq_u32 s61, 0
    s_cbranch_scc1 K12_Q4
    s_cbranch_vccz K12_Q4
    s_branch K12_S4_L
K12_S5:
    s_mov_b32 s61, 16384
    s_add_u32 s62, s62, 1
K12_S5_L:
    ds_read_b32 v40, v5
    s_waitcnt lgkmcnt(0)
    v_cmp_gt_u32 vcc, s51, v40
    s_sub_u32 s61, s61, 1
    s_cmp_eq_u32 s61, 0
    s_cbranch_scc1 K12_Q5
    s_cbranch_vccz K12_Q5
    s_branch K12_S5_L
K12_S6:
    s_mov_b32 s61, 16384
    s_add_u32 s62, s62, 1
K12_S6_L:
    ds_read_b32 v68, v5
    s_waitcnt lgkmcnt(0)
    v_cmp_gt_u32 vcc, s40, v68
    s_sub_u32 s61, s61, 1
    s_cmp_eq_u32 s61, 0
    s_cbranch_scc1 K12_Q6
    s_cbranch_vccz K12_Q6
    s_branch K12_S6_L
K12_F7:
    s_mov_b32 s61, 16384
    s_add_u32 s63, s63, 1
K12_F7_L:
    s_mov_b32 m0, s46
    s_mov_b64 exec, 0xff
    buffer_load_dword v1, s[4:7], 0 offen sc1 lds
    s_mov_b64 exec, -1
    s_waitcnt vmcnt(0)
    v_mov_b32 v0, s48
    ds_read_b32 v0, v0
    s_waitcnt lgkmcnt(0)
    v_cmp_eq_u32 vcc, 0, v0
    s_sub_u32 s61, s61, 1
    s_cmp_eq_u32 s61, 0
    s_cbranch_scc1 K12_F7_X
    s_cbranch_vccz K12_F7_X
    s_sleep 2
    s_branch K12_F7_L
K12_F7_X:
    s_branch K12_G7
K12_S8:
    s_mov_b32 s61, 16384
    s_add_u32 s62, s62, 1
K12_S8_L:
    ds_read_b32 v56, v5
    s_waitcnt lgkmcnt(0)
    v_cmp_gt_u32 vcc, s51, v56
    s_sub_u32 s61, s61, 1
    s_cmp_eq_u32 s61, 0
    s_cbranch_scc1 K12_Q8
    s_cbranch_vccz K12_Q8
    s_branch K12_S8_L
K12_END:
    s_endpgm
.p2align 8
.type k34_out_kernel,@function
k34_out_kernel:
    s_cmp_ge_u32 s2, 256
    s_cbranch_scc1 K34_END
    s_load_dwordx2 s[4:5], s[0:1], 48
    s_load_dwordx4 s[40:43], s[0:1], 16
    s_load_dwordx2 s[44:45], s[0:1], 32
    v_lshrrev_b32 v1, 6, v0
    v_and_b32 v2, 63, v0
    v_readfirstlane_b32 s3, v1
    s_and_b32 s6, s2, 15
    s_lshr_b32 s7, s2, 4
    s_lshr_b32 s20, s6, 3
    s_and_b32 s21, s6, 7
    s_mul_i32 s22, s7, 11
    s_mul_i32 s23, s7, 10
    s_add_u32 s23, s23, 7
    s_cmp_lt_u32 s7, 7
    s_cselect_b32 s22, s22, s23
    s_cselect_b32 s23, 11, 10
    s_add_u32 s22, s22, s3
    v_and_b32 v3, 15, v2
    v_lshrrev_b32 v4, 4, v2
    v_lshlrev_b32 v5, 4, v2
    s_mov_b32 s24, 2736128
    v_mul_lo_u32 v6, v4, s24
    v_lshl_add_u32 v6, v3, 4, v6
    s_mul_i32 s25, s20, 167
    s_add_u32 s25, s25, s22
    s_lshl_b32 s25, s25, 11
    s_lshl_b32 s24, s21, 8
    s_add_u32 s25, s25, s24
    s_waitcnt lgkmcnt(0)
    s_add_u32 s8, s4, 118489088
    s_addc_u32 s9, s5, 0
    s_and_b32 s9, s9, 0xffff
    s_mov_b32 s10, 21889024
    s_mov_b32 s11, 0x00020000
    s_add_u32 s12, s4, 153616384
    s_addc_u32 s13, s5, 0
    s_and_b32 s13, s13, 0xffff
    s_mov_b32 s14, 131072
    s_mov_b32 s15, 0x00020000
    s_cmp_lt_u32 s3, s23
    s_cbranch_scc0 K34_NOLOAD
    buffer_load_dwordx4 v[16:19], v6, s[8:11], s25 offen
    s_add_u32 s25, s25, 684032
    buffer_load_dwordx4 v[20:23], v6, s[8:11], s25 offen
    s_add_u32 s25, s25, 684032
    buffer_load_dwordx4 v[24:27], v6, s[8:11], s25 offen
    s_add_u32 s25, s25, 684032
    buffer_load_dwordx4 v[28:31], v6, s[8:11], s25 offen
    s_add_u32 s25, s25, 8892416
    buffer_load_dwordx4 v[32:35], v6, s[8:11], s25 offen
    s_add_u32 s25, s25, 684032
    buffer_load_dwordx4 v[36:39], v6, s[8:11], s25 offen
    s_add_u32 s25, s25, 684032
    buffer_load_dwordx4 v[40:43], v6, s[8:11], s25 offen
    s_add_u32 s25, s25, 684032
    buffer_load_dwordx4 v[44:47], v6, s[8:11], s25 offen
K34_NOLOAD:
    s_cmp_lg_u32 s3, 0
    s_cbranch_scc1 K34_TAB
    s_mov_b32 s16, s40
    s_mov_b32 s17, s41
    s_and_b32 s17, s17, 0xffff
    s_mov_b32 s18, 1024
    s_mov_b32 s19, 0x00020000
    s_mov_b32 s28, s42
    s_mov_b32 s29, s43
    s_and_b32 s29, s29, 0xffff
    s_mov_b32 s30, 1024
    s_mov_b32 s31, 0x00020000
    s_lshl_b32 s24, s21, 7
    v_lshlrev_b32 v8, 1, v2
    buffer_load_ushort v152, v8, s[16:19], s24 offen
    buffer_load_ushort v153, v8, s[28:31], s24 offen
    s_branch K34_TABDONE
K34_TAB:
    s_cmp_ge_u32 s3, 7
    s_cbranch_scc1 K34_TABDONE
    s_sub_u32 s27, s3, 1
    s_lshr_b32 s28, s27, 1
    s_and_b32 s29, s27, 1
    s_lshl_b32 s30, s28, 4
    v_add_u32 v8, s30, v3
    s_lshl_b32 s30, s29, 5
    s_add_u32 s30, s30, 1
    v_lshlrev_b32 v9, 3, v4
    v_add_u32 v9, s30, v9
    v_mul_u32_u24 v9, v8, v9
    v_lshlrev_b32 v8, 1, v8
    v_mad_u32_u24 v48, v8, 0, v9
    v_mad_u32_u24 v49, v8, 0, v9
    v_add_u32 v49, 32, v49
    v_mad_u32_u24 v50, v8, 1, v9
    v_mad_u32_u24 v51, v8, 1, v9
    v_add_u32 v51, 32, v51
    v_mad_u32_u24 v52, v8, 2, v9
    v_mad_u32_u24 v53, v8, 2, v9
    v_add_u32 v53, 32, v53
    v_mad_u32_u24 v54, v8, 3, v9
    v_mad_u32_u24 v55, v8, 3, v9
    v_add_u32 v55, 32, v55
    v_and_b32 v48, 127, v48
    v_and_b32 v49, 127, v49
    v_and_b32 v50, 127, v50
    v_and_b32 v51, 127, v51
    v_and_b32 v52, 127, v52
    v_and_b32 v53, 127, v53
    v_and_b32 v54, 127, v54
    v_and_b32 v55, 127, v55
    v_cvt_f32_u32 v48, v48
    v_cvt_f32_u32 v49, v49
    v_cvt_f32_u32 v50, v50
    v_cvt_f32_u32 v51, v51
    v_cvt_f32_u32 v52, v52
    v_cvt_f32_u32 v53, v53
    v_cvt_f32_u32 v54, v54
    v_cvt_f32_u32 v55, v55
    v_mul_f32 v48, 0x3c000000, v48
    v_mul_f32 v49, 0x3c000000, v49
    v_mul_f32 v50, 0x3c000000, v50
    v_mul_f32 v51, 0x3c000000, v51
    v_mul_f32 v52, 0x3c000000, v52
    v_mul_f32 v53, 0x3c000000, v53
    v_mul_f32 v54, 0x3c000000, v54
    v_mul_f32 v55, 0x3c000000, v55
    v_cos_f32 v48, v48
    v_cos_f32 v49, v49
    v_cos_f32 v50, v50
    v_cos_f32 v51, v51
    v_cos_f32 v52, v52
    v_cos_f32 v53, v53
    v_cos_f32 v54, v54
    v_cos_f32 v55, v55
    s_nop 0
    v_mul_f32 v48, 0x3d000000, v48
    v_mul_f32 v49, 0x3d000000, v49
    v_mul_f32 v50, 0x3d000000, v50
    v_mul_f32 v51, 0x3d000000, v51
    v_mul_f32 v52, 0x3d000000, v52
    v_mul_f32 v53, 0x3d000000, v53
    v_mul_f32 v54, 0x3d000000, v54
    v_mul_f32 v55, 0x3d000000, v55
    v_cvt_pk_bf16_f32 v56, v48, v49
    v_cvt_pk_bf16_f32 v57, v50, v51
    v_cvt_pk_bf16_f32 v58, v52, v53
    v_cvt_pk_bf16_f32 v59, v54, v55
    v_lshlrev_b32 v64, 16, v56
    v_and_b32 v65, 0xffff0000, v56
    v_sub_f32 v48, v48, v64
    v_sub_f32 v49, v49, v65
    v_lshlrev_b32 v64, 16, v57
    v_and_b32 v65, 0xffff0000, v57
    v_sub_f32 v50, v50, v64
    v_sub_f32 v51, v51, v65
    v_lshlrev_b32 v64, 16, v58
    v_and_b32 v65, 0xffff0000, v58
    v_sub_f32 v52, v52, v64
    v_sub_f32 v53, v53, v65
    v_lshlrev_b32 v64, 16, v59
    v_and_b32 v65, 0xffff0000, v59
    v_sub_f32 v54, v54, v64
    v_sub_f32 v55, v55, v65
    v_cvt_pk_bf16_f32 v60, v48, v49
    v_cvt_pk_bf16_f32 v61, v50, v51
    v_cvt_pk_bf16_f32 v62, v52, v53
    v_cvt_pk_bf16_f32 v63, v54, v55
    s_lshl_b32 s30, s27, 11
    v_add_u32 v10, s30, v5
    ds_write_b128 v10, v[56:59]
    ds_write_b128 v10, v[60:63] offset:1024
K34_TABDONE:
    s_waitcnt lgkmcnt(0)
    s_barrier
    s_cmp_lt_u32 s3, s23
    s_cbranch_scc0 K34_IDLE
    ds_read_b128 v[48:51], v5 offset:0
    ds_read_b128 v[52:55], v5 offset:1024
    ds_read_b128 v[56:59], v5 offset:2048
    ds_read_b128 v[60:63], v5 offset:3072
    ds_read_b128 v[64:67], v5 offset:4096
    ds_read_b128 v[68:71], v5 offset:5120
    ds_read_b128 v[72:75], v5 offset:6144
    ds_read_b128 v[76:79], v5 offset:7168
    ds_read_b128 v[80:83], v5 offset:8192
    ds_read_b128 v[84:87], v5 offset:9216
    ds_read_b128 v[88:91], v5 offset:10240
    ds_read_b128 v[92:95], v5 offset:11264
    s_waitcnt vmcnt(0)
    v_swap_b32 v17, v20
    v_swap_b32 v18, v24
    v_swap_b32 v19, v28
    v_swap_b32 v22, v25
    v_swap_b32 v23, v29
    v_swap_b32 v27, v30
    v_swap_b32 v33, v36
    v_swap_b32 v34, v40
    v_swap_b32 v35, v44
    v_swap_b32 v38, v41
    v_swap_b32 v39, v45
    v_swap_b32 v43, v46
    s_waitcnt lgkmcnt(0)
    s_mul_i32 s24, s22, 48
    s_sub_u32 s24, 7985, s24
    s_cmp_ge_u32 s24, 48
    s_cbranch_scc1 K34_FULL
    v_add_u32 v7, 0, v3
    v_cmp_gt_u32 vcc, s24, v7
    s_nop 1
    v_cndmask_b32 v48, 0, v48, vcc
    v_cndmask_b32 v49, 0, v49, vcc
    v_cndmask_b32 v50, 0, v50, vcc
    v_cndmask_b32 v51, 0, v51, vcc
    v_cndmask_b32 v52, 0, v52, vcc
    v_cndmask_b32 v53, 0, v53, vcc
    v_cndmask_b32 v54, 0, v54, vcc
    v_cndmask_b32 v55, 0, v55, vcc
    v_cndmask_b32 v56, 0, v56, vcc
    v_cndmask_b32 v57, 0, v57, vcc
    v_cndmask_b32 v58, 0, v58, vcc
    v_cndmask_b32 v59, 0, v59, vcc
    v_cndmask_b32 v60, 0, v60, vcc
    v_cndmask_b32 v61, 0, v61, vcc
    v_cndmask_b32 v62, 0, v62, vcc
    v_cndmask_b32 v63, 0, v63, vcc
    v_add_u32 v7, 16, v3
    v_cmp_gt_u32 vcc, s24, v7
    s_nop 1
    v_cndmask_b32 v64, 0, v64, vcc
    v_cndmask_b32 v65, 0, v65, vcc
    v_cndmask_b32 v66, 0, v66, vcc
    v_cndmask_b32 v67, 0, v67, vcc
    v_cndmask_b32 v68, 0, v68, vcc
    v_cndmask_b32 v69, 0, v69, vcc
    v_cndmask_b32 v70, 0, v70, vcc
    v_cndmask_b32 v71, 0, v71, vcc
    v_cndmask_b32 v72, 0, v72, vcc
    v_cndmask_b32 v73, 0, v73, vcc
    v_cndmask_b32 v74, 0, v74, vcc
    v_cndmask_b32 v75, 0, v75, vcc
    v_cndmask_b32 v76, 0, v76, vcc
    v_cndmask_b32 v77, 0, v77, vcc
    v_cndmask_b32 v78, 0, v78, vcc
    v_cndmask_b32 v79, 0, v79, vcc
    v_add_u32 v7, 32, v3
    v_cmp_gt_u32 vcc, s24, v7
    s_nop 1
    v_cndmask_b32 v80, 0, v80, vcc
    v_cndmask_b32 v81, 0, v81, vcc
    v_cndmask_b32 v82, 0, v82, vcc
    v_cndmask_b32 v83, 0, v83, vcc
    v_cndmask_b32 v84, 0, v84, vcc
    v_cndmask_b32 v85, 0, v85, vcc
    v_cndmask_b32 v86, 0, v86, vcc
    v_cndmask_b32 v87, 0, v87, vcc
    v_cndmask_b32 v88, 0, v88, vcc
    v_cndmask_b32 v89, 0, v89, vcc
    v_cndmask_b32 v90, 0, v90, vcc
    v_cndmask_b32 v91, 0, v91, vcc
    v_cndmask_b32 v92, 0, v92, vcc
    v_cndmask_b32 v93, 0, v93, vcc
    v_cndmask_b32 v94, 0, v94, vcc
    v_cndmask_b32 v95, 0, v95, vcc
K34_FULL:
    s_nop 1
    v_mfma_f32_16x16x32_bf16 v[96:99], v[48:51], v[16:19], 0
    v_mfma_f32_16x16x32_bf16 v[100:103], v[48:51], v[20:23], 0
    v_mfma_f32_16x16x32_bf16 v[104:107], v[48:51], v[24:27], 0
    v_mfma_f32_16x16x32_bf16 v[108:111], v[48:51], v[28:31], 0
    v_mfma_f32_16x16x32_bf16 v[96:99], v[52:55], v[16:19], v[96:99]
    v_mfma_f32_16x16x32_bf16 v[100:103], v[52:55], v[20:23], v[100:103]
    v_mfma_f32_16x16x32_bf16 v[104:107], v[52:55], v[24:27], v[104:107]
    v_mfma_f32_16x16x32_bf16 v[108:111], v[52:55], v[28:31], v[108:111]
    v_mfma_f32_16x16x32_bf16 v[96:99], v[56:59], v[32:35], v[96:99]
    v_mfma_f32_16x16x32_bf16 v[100:103], v[56:59], v[36:39], v[100:103]
    v_mfma_f32_16x16x32_bf16 v[104:107], v[56:59], v[40:43], v[104:107]
    v_mfma_f32_16x16x32_bf16 v[108:111], v[56:59], v[44:47], v[108:111]
    v_mfma_f32_16x16x32_bf16 v[96:99], v[60:63], v[32:35], v[96:99]
    v_mfma_f32_16x16x32_bf16 v[100:103], v[60:63], v[36:39], v[100:103]
    v_mfma_f32_16x16x32_bf16 v[104:107], v[60:63], v[40:43], v[104:107]
    v_mfma_f32_16x16x32_bf16 v[108:111], v[60:63], v[44:47], v[108:111]
    v_mfma_f32_16x16x32_bf16 v[112:115], v[64:67], v[16:19], 0
    v_mfma_f32_16x16x32_bf16 v[116:119], v[64:67], v[20:23], 0
    v_mfma_f32_16x16x32_bf16 v[120:123], v[64:67], v[24:27], 0
    v_mfma_f32_16x16x32_bf16 v[124:127], v[64:67], v[28:31], 0
    v_mfma_f32_16x16x32_bf16 v[112:115], v[68:71], v[16:19], v[112:115]
    v_mfma_f32_16x16x32_bf16 v[116:119], v[68:71], v[20:23], v[116:119]
    v_mfma_f32_16x16x32_bf16 v[120:123], v[68:71], v[24:27], v[120:123]
    v_mfma_f32_16x16x32_bf16 v[124:127], v[68:71], v[28:31], v[124:127]
    v_mfma_f32_16x16x32_bf16 v[112:115], v[72:75], v[32:35], v[112:115]
    v_mfma_f32_16x16x32_bf16 v[116:119], v[72:75], v[36:39], v[116:119]
    v_mfma_f32_16x16x32_bf16 v[120:123], v[72:75], v[40:43], v[120:123]
    v_mfma_f32_16x16x32_bf16 v[124:127], v[72:75], v[44:47], v[124:127]
    v_mfma_f32_16x16x32_bf16 v[112:115], v[76:79], v[32:35], v[112:115]
    v_mfma_f32_16x16x32_bf16 v[116:119], v[76:79], v[36:39], v[116:119]
    v_mfma_f32_16x16x32_bf16 v[120:123], v[76:79], v[40:43], v[120:123]
    v_mfma_f32_16x16x32_bf16 v[124:127], v[76:79], v[44:47], v[124:127]
    v_mfma_f32_16x16x32_bf16 v[128:131], v[80:83], v[16:19], 0
    v_mfma_f32_16x16x32_bf16 v[132:135], v[80:83], v[20:23], 0
    v_mfma_f32_16x16x32_bf16 v[136:139], v[80:83], v[24:27], 0
    v_mfma_f32_16x16x32_bf16 v[140:143], v[80:83], v[28:31], 0
    v_mfma_f32_16x16x32_bf16 v[128:131], v[84:87], v[16:19], v[128:131]
    v_mfma_f32_16x16x32_bf16 v[132:135], v[84:87], v[20:23], v[132:135]
    v_mfma_f32_16x16x32_bf16 v[136:139], v[84:87], v[24:27], v[136:139]
    v_mfma_f32_16x16x32_bf16 v[140:143], v[84:87], v[28:31], v[140:143]
    v_mfma_f32_16x16x32_bf16 v[128:131], v[88:91], v[32:35], v[128:131]
    v_mfma_f32_16x16x32_bf16 v[132:135], v[88:91], v[36:39], v[132:135]
    v_mfma_f32_16x16x32_bf16 v[136:139], v[88:91], v[40:43], v[136:139]
    v_mfma_f32_16x16x32_bf16 v[140:143], v[88:91], v[44:47], v[140:143]
    v_mfma_f32_16x16x32_bf16 v[128:131], v[92:95], v[32:35], v[128:131]
    v_mfma_f32_16x16x32_bf16 v[132:135], v[92:95], v[36:39], v[132:135]
    v_mfma_f32_16x16x32_bf16 v[136:139], v[92:95], v[40:43], v[136:139]
    v_mfma_f32_16x16x32_bf16 v[140:143], v[92:95], v[44:47], v[140:143]
    s_nop 7
    v_mov_b32 v16, v96
    v_mul_f32 v20, v96, v96
    v_mov_b32 v17, v100
    v_mul_f32 v21, v100, v100
    v_mov_b32 v18, v104
    v_mul_f32 v22, v104, v104
    v_mov_b32 v19, v108
    v_mul_f32 v23, v108, v108
    v_add_f32 v16, v16, v97
    v_fmac_f32 v20, v97, v97
    v_add_f32 v17, v17, v101
    v_fmac_f32 v21, v101, v101
    v_add_f32 v18, v18, v105
    v_fmac_f32 v22, v105, v105
    v_add_f32 v19, v19, v109
    v_fmac_f32 v23, v109, v109
    v_add_f32 v16, v16, v98
    v_fmac_f32 v20, v98, v98
    v_add_f32 v17, v17, v102
    v_fmac_f32 v21, v102, v102
    v_add_f32 v18, v18, v106
    v_fmac_f32 v22, v106, v106
    v_add_f32 v19, v19, v110
    v_fmac_f32 v23, v110, v110
    v_add_f32 v16, v16, v99
    v_fmac_f32 v20, v99, v99
    v_add_f32 v17, v17, v103
    v_fmac_f32 v21, v103, v103
    v_add_f32 v18, v18, v107
    v_fmac_f32 v22, v107, v107
    v_add_f32 v19, v19, v111
    v_fmac_f32 v23, v111, v111
    v_add_f32 v16, v16, v112
    v_fmac_f32 v20, v112, v112
    v_add_f32 v17, v17, v116
    v_fmac_f32 v21, v116, v116
    v_add_f32 v18, v18, v120
    v_fmac_f32 v22, v120, v120
    v_add_f32 v19, v19, v124
    v_fmac_f32 v23, v124, v124
    v_add_f32 v16, v16, v113
    v_fmac_f32 v20, v113, v113
    v_add_f32 v17, v17, v117
    v_fmac_f32 v21, v117, v117
    v_add_f32 v18, v18, v121
    v_fmac_f32 v22, v121, v121
    v_add_f32 v19, v19, v125
    v_fmac_f32 v23, v125, v125
    v_add_f32 v16, v16, v114
    v_fmac_f32 v20, v114, v114
    v_add_f32 v17, v17, v118
    v_fmac_f32 v21, v118, v118
    v_add_f32 v18, v18, v122
    v_fmac_f32 v22, v122, v122
    v_add_f32 v19, v19, v126
    v_fmac_f32 v23, v126, v126
    v_add_f32 v16, v16, v115
    v_fmac_f32 v20, v115, v115
    v_add_f32 v17, v17, v119
    v_fmac_f32 v21, v119, v119
    v_add_f32 v18, v18, v123
    v_fmac_f32 v22, v123, v123
    v_add_f32 v19, v19, v127
    v_fmac_f32 v23, v127, v127
    v_add_f32 v16, v16, v128
    v_fmac_f32 v20, v128, v128
    v_add_f32 v17, v17, v132
    v_fmac_f32 v21, v132, v132
    v_add_f32 v18, v18, v136
    v_fmac_f32 v22, v136, v136
    v_add_f32 v19, v19, v140
    v_fmac_f32 v23, v140, v140
    v_add_f32 v16, v16, v129
    v_fmac_f32 v20, v129, v129
    v_add_f32 v17, v17, v133
    v_fmac_f32 v21, v133, v133
    v_add_f32 v18, v18, v137
    v_fmac_f32 v22, v137, v137
    v_add_f32 v19, v19, v141
    v_fmac_f32 v23, v141, v141
    v_add_f32 v16, v16, v130
    v_fmac_f32 v20, v130, v130
    v_add_f32 v17, v17, v134
    v_fmac_f32 v21, v134, v134
    v_add_f32 v18, v18, v138
    v_fmac_f32 v22, v138, v138
    v_add_f32 v19, v19, v142
    v_fmac_f32 v23, v142, v142
    v_add_f32 v16, v16, v131
    v_fmac_f32 v20, v131, v131
    v_add_f32 v17, v17, v135
    v_fmac_f32 v21, v135, v135
    v_add_f32 v18, v18, v139
    v_fmac_f32 v22, v139, v139
    v_add_f32 v19, v19, v143
    v_fmac_f32 v23, v143, v143
    v_mov_b32 v24, v16
    v_mov_b32 v25, v17
    v_mov_b32 v26, v18
    v_mov_b32 v27, v19
    v_mov_b32 v28, v20
    v_mov_b32 v29, v21
    v_mov_b32 v30, v22
    v_mov_b32 v31, v23
    s_nop 0
    v_permlane32_swap_b32 v16, v24
    v_permlane32_swap_b32 v17, v25
    v_permlane32_swap_b32 v18, v26
    v_permlane32_swap_b32 v19, v27
    v_permlane32_swap_b32 v20, v28
    v_permlane32_swap_b32 v21, v29
    v_permlane32_swap_b32 v22, v30
    v_permlane32_swap_b32 v23, v31
    v_add_f32 v16, v16, v24
    v_add_f32 v17, v17, v25
    v_add_f32 v18, v18, v26
    v_add_f32 v19, v19, v27
    v_add_f32 v20, v20, v28
    v_add_f32 v21, v21, v29
    v_add_f32 v22, v22, v30
    v_add_f32 v23, v23, v31
    v_mov_b32 v24, v16
    v_mov_b32 v25, v17
    v_mov_b32 v26, v18
    v_mov_b32 v27, v19
    v_mov_b32 v28, v20
    v_mov_b32 v29, v21
    v_mov_b32 v30, v22
    v_mov_b32 v31, v23
    s_nop 0
    v_permlane16_swap_b32 v16, v24
    v_permlane16_swap_b32 v17, v25
    v_permlane16_swap_b32 v18, v26
    v_permlane16_swap_b32 v19, v27
    v_permlane16_swap_b32 v20, v28
    v_permlane16_swap_b32 v21, v29
    v_permlane16_swap_b32 v22, v30
    v_permlane16_swap_b32 v23, v31
    v_add_f32 v16, v16, v24
    v_add_f32 v17, v17, v25
    v_add_f32 v18, v18, v26
    v_add_f32 v19, v19, v27
    v_add_f32 v20, v20, v28
    v_add_f32 v21, v21, v29
    v_add_f32 v22, v22, v30
    v_add_f32 v23, v23, v31
    s_branch K34_WR
K34_IDLE:
    v_mov_b32 v16, 0
    v_mov_b32 v17, 0
    v_mov_b32 v18, 0
    v_mov_b32 v19, 0
    v_mov_b32 v20, 0
    v_mov_b32 v21, 0
    v_mov_b32 v22, 0
    v_mov_b32 v23, 0
K34_WR:
    s_lshl_b32 s24, s3, 9
    v_lshlrev_b32 v7, 4, v3
    v_add_u32 v7, s24, v7
    ds_write_b128 v7, v[16:19] offset:12288
    ds_write_b128 v7, v[20:23] offset:12544
    s_waitcnt lgkmcnt(0)
    s_barrier
    s_cmp_lg_u32 s3, 0
    s_cbranch_scc1 K34_WAIT
    v_lshlrev_b32 v7, 2, v2
    ds_read_b32 v16, v7 offset:12288
    ds_read_b32 v17, v7 offset:12800
    ds_read_b32 v18, v7 offset:13312
    ds_read_b32 v19, v7 offset:13824
    ds_read_b32 v20, v7 offset:14336
    ds_read_b32 v21, v7 offset:14848
    ds_read_b32 v22, v7 offset:15360
    ds_read_b32 v23, v7 offset:15872
    ds_read_b32 v24, v7 offset:16384
    ds_read_b32 v25, v7 offset:16896
    ds_read_b32 v26, v7 offset:17408
    ds_read_b32 v27, v7 offset:17920
    s_waitcnt lgkmcnt(0)
    ds_read_b32 v32, v7 offset:12544
    ds_read_b32 v33, v7 offset:13056
    ds_read_b32 v34, v7 offset:13568
    ds_read_b32 v35, v7 offset:14080
    ds_read_b32 v36, v7 offset:14592
    ds_read_b32 v37, v7 offset:15104
    ds_read_b32 v38, v7 offset:15616
    ds_read_b32 v39, v7 offset:16128
    ds_read_b32 v40, v7 offset:16640
    ds_read_b32 v41, v7 offset:17152
    ds_read_b32 v42, v7 offset:17664
    ds_read_b32 v43, v7 offset:18176
    v_add_f32 v16, v16, v17
    v_add_f32 v16, v16, v18
    v_add_f32 v16, v16, v19
    v_add_f32 v16, v16, v20
    v_add_f32 v16, v16, v21
    v_add_f32 v16, v16, v22
    v_add_f32 v16, v16, v23
    v_add_f32 v16, v16, v24
    v_add_f32 v16, v16, v25
    v_add_f32 v16, v16, v26
    v_add_f32 v16, v16, v27
    s_waitcnt lgkmcnt(0)
    v_add_f32 v32, v32, v33
    v_add_f32 v32, v32, v34
    v_add_f32 v32, v32, v35
    v_add_f32 v32, v32, v36
    v_add_f32 v32, v32, v37
    v_add_f32 v32, v32, v38
    v_add_f32 v32, v32, v39
    v_add_f32 v32, v32, v40
    v_add_f32 v32, v32, v41
    v_add_f32 v32, v32, v42
    v_add_f32 v32, v32, v43
    s_lshl_b32 s24, s6, 4
    s_add_u32 s24, s24, s7
    s_lshl_b32 s24, s24, 9
    buffer_store_dword v16, v7, s[12:15], s24 offen sc1
    buffer_store_dword v32, v7, s[12:15], s24 offen offset:256 sc1
    s_mov_b32 s26, 20000
K34_POLL:
    s_lshl_b32 s24, s6, 13
    buffer_load_dword v16, v7, s[12:15], s24 offen offset:0 sc1
    buffer_load_dword v32, v7, s[12:15], s24 offen offset:256 sc1
    buffer_load_dword v17, v7, s[12:15], s24 offen offset:512 sc1
    buffer_load_dword v33, v7, s[12:15], s24 offen offset:768 sc1
    buffer_load_dword v18, v7, s[12:15], s24 offen offset:1024 sc1
    buffer_load_dword v34, v7, s[12:15], s24 offen offset:1280 sc1
    buffer_load_dword v19, v7, s[12:15], s24 offen offset:1536 sc1
    buffer_load_dword v35, v7, s[12:15], s24 offen offset:1792 sc1
    buffer_load_dword v20, v7, s[12:15], s24 offen offset:2048 sc1
    buffer_load_dword v36, v7, s[12:15], s24 offen offset:2304 sc1
    buffer_load_dword v21, v7, s[12:15], s24 offen offset:2560 sc1
    buffer_load_dword v37, v7, s[12:15], s24 offen offset:2816 sc1
    buffer_load_dword v22, v7, s[12:15], s24 offen offset:3072 sc1
    buffer_load_dword v38, v7, s[12:15], s24 offen offset:3328 sc1
    buffer_load_dword v23, v7, s[12:15], s24 offen offset:3584 sc1
    buffer_load_dword v39, v7, s[12:15], s24 offen offset:3840 sc1
    s_add_u32 s24, s24, 4096
    buffer_load_dword v24, v7, s[12:15], s24 offen offset:0 sc1
    buffer_load_dword v40, v7, s[12:15], s24 offen offset:256 sc1
    buffer_load_dword v25, v7, s[12:15], s24 offen offset:512 sc1
    buffer_load_dword v41, v7, s[12:15], s24 offen offset:768 sc1
    buffer_load_dword v26, v7, s[12:15], s24 offen offset:1024 sc1
    buffer_load_dword v42, v7, s[12:15], s24 offen offset:1280 sc1
    buffer_load_dword v27, v7, s[12:15], s24 offen offset:1536 sc1
    buffer_load_dword v43, v7, s[12:15], s24 offen offset:1792 sc1
    buffer_load_dword v28, v7, s[12:15], s24 offen offset:2048 sc1
    buffer_load_dword v44, v7, s[12:15], s24 offen offset:2304 sc1
    buffer_load_dword v29, v7, s[12:15], s24 offen offset:2560 sc1
    buffer_load_dword v45, v7, s[12:15], s24 offen offset:2816 sc1
    buffer_load_dword v30, v7, s[12:15], s24 offen offset:3072 sc1
    buffer_load_dword v46, v7, s[12:15], s24 offen offset:3328 sc1
    buffer_load_dword v31, v7, s[12:15], s24 offen offset:3584 sc1
    buffer_load_dword v47, v7, s[12:15], s24 offen offset:3840 sc1
    s_waitcnt vmcnt(0)
    v_max3_u32 v48, v16, v17, v18
    v_max3_u32 v48, v48, v19, v20
    v_max3_u32 v48, v48, v21, v22
    v_max3_u32 v48, v48, v23, v24
    v_max3_u32 v48, v48, v25, v26
    v_max3_u32 v48, v48, v27, v28
    v_max3_u32 v48, v48, v29, v30
    v_max3_u32 v48, v48, v31, v32
    v_max3_u32 v48, v48, v33, v34
    v_max3_u32 v48, v48, v35, v36
    v_max3_u32 v48, v48, v37, v38
    v_max3_u32 v48, v48, v39, v40
    v_max3_u32 v48, v48, v41, v42
    v_max3_u32 v48, v48, v43, v44
    v_max3_u32 v48, v48, v45, v46
    v_max_u32 v48, v48, v47
    v_cmp_eq_u32 vcc, -1, v48
    s_sub_u32 s26, s26, 1
    s_cmp_eq_u32 s26, 0
    s_cbranch_scc1 K34_GOT
    s_cbranch_vccz K34_GOT
    s_sleep 1
    s_branch K34_POLL
K34_GOT:
    v_add_f32 v16, v16, v24
    v_add_f32 v32, v32, v40
    v_add_f32 v17, v17, v25
    v_add_f32 v33, v33, v41
    v_add_f32 v18, v18, v26
    v_add_f32 v34, v34, v42
    v_add_f32 v19, v19, v27
    v_add_f32 v35, v35, v43
    v_add_f32 v20, v20, v28
    v_add_f32 v36, v36, v44
    v_add_f32 v21, v21, v29
    v_add_f32 v37, v37, v45
    v_add_f32 v22, v22, v30
    v_add_f32 v38, v38, v46
    v_add_f32 v23, v23, v31
    v_add_f32 v39, v39, v47
    v_add_f32 v16, v16, v20
    v_add_f32 v32, v32, v36
    v_add_f32 v17, v17, v21
    v_add_f32 v33, v33, v37
    v_add_f32 v18, v18, v22
    v_add_f32 v34, v34, v38
    v_add_f32 v19, v19, v23
    v_add_f32 v35, v35, v39
    v_add_f32 v16, v16, v18
    v_add_f32 v32, v32, v34
    v_add_f32 v17, v17, v19
    v_add_f32 v33, v33, v35
    v_add_f32 v16, v16, v17
    v_add_f32 v32, v32, v33
    v_mul_f32 v11, 0x39035177, v16
    v_mul_f32 v12, 0x39035177, v32
    v_fma_f32 v12, -v11, v11, v12
    v_max_f32 v12, 0, v12
    v_add_f32 v12, 0x3727c5ac, v12
    v_sqrt_f32 v12, v12
    v_lshlrev_b32 v9, 16, v152
    v_rcp_f32 v12, v12
    v_lshlrev_b32 v10, 16, v153
    v_mul_f32 v9, v9, v12
    v_fma_f32 v10, -v11, v9, v10
    ds_write_b32 v7, v9 offset:18432
    ds_write_b32 v7, v10 offset:18688
    s_waitcnt lgkmcnt(0)
K34_WAIT:
    s_barrier
    s_cmp_lt_u32 s3, s23
    s_cbranch_scc0 K34_END
    v_lshlrev_b32 v7, 4, v3
    ds_read_b128 v[144:147], v7 offset:18432
    ds_read_b128 v[148:151], v7 offset:18688
    s_mul_i32 s24, s20, 8176640
    s_add_u32 s16, s44, s24
    s_addc_u32 s17, s45, 0
    s_and_b32 s17, s17, 0xffff
    s_mov_b32 s18, 8176640
    s_mov_b32 s19, 0x00020000
    v_lshlrev_b32 v7, 12, v4
    v_lshl_add_u32 v7, v3, 3, v7
    s_lshl_b32 s24, s21, 7
    v_add_u32 v7, s24, v7
    s_mul_i32 s25, s22, 49152
    s_mov_b32 s30, 0xc0135761
    s_mov_b32 s31, 0xbdd2d3e8
    v_mov_b32 v15, s30
    s_waitcnt lgkmcnt(0)
    v_fma_f32 v16, v96, v144, v148
    v_fma_f32 v17, v100, v145, v149
    v_fma_f32 v18, v104, v146, v150
    v_fma_f32 v19, v108, v147, v151
    v_fma_f32 v20, v97, v144, v148
    v_fma_f32 v21, v101, v145, v149
    v_fma_f32 v22, v105, v146, v150
    v_fma_f32 v23, v109, v147, v151
    v_mul_f32 v24, v16, v16
    v_mul_f32 v25, v17, v17
    v_mul_f32 v26, v18, v18
    v_mul_f32 v27, v19, v19
    v_mul_f32 v28, v20, v20
    v_mul_f32 v29, v21, v21
    v_mul_f32 v30, v22, v22
    v_mul_f32 v31, v23, v23
    v_fma_f32 v24, v24, s31, v15
    v_fma_f32 v25, v25, s31, v15
    v_fma_f32 v26, v26, s31, v15
    v_fma_f32 v27, v27, s31, v15
    v_fma_f32 v28, v28, s31, v15
    v_fma_f32 v29, v29, s31, v15
    v_fma_f32 v30, v30, s31, v15
    v_fma_f32 v31, v31, s31, v15
    v_mul_f32 v24, v24, v16
    v_mul_f32 v25, v25, v17
    v_mul_f32 v26, v26, v18
    v_mul_f32 v27, v27, v19
    v_mul_f32 v28, v28, v20
    v_mul_f32 v29, v29, v21
    v_mul_f32 v30, v30, v22
    v_mul_f32 v31, v31, v23
    v_exp_f32 v24, v24
    v_exp_f32 v25, v25
    v_exp_f32 v26, v26
    v_exp_f32 v27, v27
    v_exp_f32 v28, v28
    v_exp_f32 v29, v29
    v_exp_f32 v30, v30
    v_exp_f32 v31, v31
    v_add_f32 v24, 1.0, v24
    v_add_f32 v25, 1.0, v25
    v_add_f32 v26, 1.0, v26
    v_add_f32 v27, 1.0, v27
    v_add_f32 v28, 1.0, v28
    v_add_f32 v29, 1.0, v29
    v_add_f32 v30, 1.0, v30
    v_add_f32 v31, 1.0, v31
    v_rcp_f32 v24, v24
    v_rcp_f32 v25, v25
    v_rcp_f32 v26, v26
    v_rcp_f32 v27, v27
    v_rcp_f32 v28, v28
    v_rcp_f32 v29, v29
    v_rcp_f32 v30, v30
    v_rcp_f32 v31, v31
    v_mul_f32 v16, v16, v24
    v_mul_f32 v17, v17, v25
    v_mul_f32 v18, v18, v26
    v_mul_f32 v19, v19, v27
    v_mul_f32 v20, v20, v28
    v_mul_f32 v21, v21, v29
    v_mul_f32 v22, v22, v30
    v_mul_f32 v23, v23, v31
    v_cvt_pk_bf16_f32 v32, v16, v17
    v_cvt_pk_bf16_f32 v33, v18, v19
    buffer_store_dwordx2 v[32:33], v7, s[16:19], s25 offen offset:0 sc1
    v_cvt_pk_bf16_f32 v34, v20, v21
    v_cvt_pk_bf16_f32 v35, v22, v23
    buffer_store_dwordx2 v[34:35], v7, s[16:19], s25 offen offset:1024 sc1
    s_add_u32 s25, s25, 2048
    v_fma_f32 v36, v98, v144, v148
    v_fma_f32 v37, v102, v145, v149
    v_fma_f32 v38, v106, v146, v150
    v_fma_f32 v39, v110, v147, v151
    v_fma_f32 v40, v99, v144, v148
    v_fma_f32 v41, v103, v145, v149
    v_fma_f32 v42, v107, v146, v150
    v_fma_f32 v43, v111, v147, v151
    v_mul_f32 v44, v36, v36
    v_mul_f32 v45, v37, v37
    v_mul_f32 v46, v38, v38
    v_mul_f32 v47, v39, v39
    v_mul_f32 v48, v40, v40
    v_mul_f32 v49, v41, v41
    v_mul_f32 v50, v42, v42
    v_mul_f32 v51, v43, v43
    v_fma_f32 v44, v44, s31, v15
    v_fma_f32 v45, v45, s31, v15
    v_fma_f32 v46, v46, s31, v15
    v_fma_f32 v47, v47, s31, v15
    v_fma_f32 v48, v48, s31, v15
    v_fma_f32 v49, v49, s31, v15
    v_fma_f32 v50, v50, s31, v15
    v_fma_f32 v51, v51, s31, v15
    v_mul_f32 v44, v44, v36
    v_mul_f32 v45, v45, v37
    v_mul_f32 v46, v46, v38
    v_mul_f32 v47, v47, v39
    v_mul_f32 v48, v48, v40
    v_mul_f32 v49, v49, v41
    v_mul_f32 v50, v50, v42
    v_mul_f32 v51, v51, v43
    v_exp_f32 v44, v44
    v_exp_f32 v45, v45
    v_exp_f32 v46, v46
    v_exp_f32 v47, v47
    v_exp_f32 v48, v48
    v_exp_f32 v49, v49
    v_exp_f32 v50, v50
    v_exp_f32 v51, v51
    v_add_f32 v44, 1.0, v44
    v_add_f32 v45, 1.0, v45
    v_add_f32 v46, 1.0, v46
    v_add_f32 v47, 1.0, v47
    v_add_f32 v48, 1.0, v48
    v_add_f32 v49, 1.0, v49
    v_add_f32 v50, 1.0, v50
    v_add_f32 v51, 1.0, v51
    v_rcp_f32 v44, v44
    v_rcp_f32 v45, v45
    v_rcp_f32 v46, v46
    v_rcp_f32 v47, v47
    v_rcp_f32 v48, v48
    v_rcp_f32 v49, v49
    v_rcp_f32 v50, v50
    v_rcp_f32 v51, v51
    v_mul_f32 v36, v36, v44
    v_mul_f32 v37, v37, v45
    v_mul_f32 v38, v38, v46
    v_mul_f32 v39, v39, v47
    v_mul_f32 v40, v40, v48
    v_mul_f32 v41, v41, v49
    v_mul_f32 v42, v42, v50
    v_mul_f32 v43, v43, v51
    v_cvt_pk_bf16_f32 v52, v36, v37
    v_cvt_pk_bf16_f32 v53, v38, v39
    buffer_store_dwordx2 v[52:53], v7, s[16:19], s25 offen offset:0 sc1
    v_cvt_pk_bf16_f32 v54, v40, v41
    v_cvt_pk_bf16_f32 v55, v42, v43
    buffer_store_dwordx2 v[54:55], v7, s[16:19], s25 offen offset:1024 sc1
    s_add_u32 s25, s25, 2048
    s_add_u32 s25, s25, 12288
    v_fma_f32 v16, v112, v144, v148
    v_fma_f32 v17, v116, v145, v149
    v_fma_f32 v18, v120, v146, v150
    v_fma_f32 v19, v124, v147, v151
    v_fma_f32 v20, v113, v144, v148
    v_fma_f32 v21, v117, v145, v149
    v_fma_f32 v22, v121, v146, v150
    v_fma_f32 v23, v125, v147, v151
    v_mul_f32 v24, v16, v16
    v_mul_f32 v25, v17, v17
    v_mul_f32 v26, v18, v18
    v_mul_f32 v27, v19, v19
    v_mul_f32 v28, v20, v20
    v_mul_f32 v29, v21, v21
    v_mul_f32 v30, v22, v22
    v_mul_f32 v31, v23, v23
    v_fma_f32 v24, v24, s31, v15
    v_fma_f32 v25, v25, s31, v15
    v_fma_f32 v26, v26, s31, v15
    v_fma_f32 v27, v27, s31, v15
    v_fma_f32 v28, v28, s31, v15
    v_fma_f32 v29, v29, s31, v15
    v_fma_f32 v30, v30, s31, v15
    v_fma_f32 v31, v31, s31, v15
    v_mul_f32 v24, v24, v16
    v_mul_f32 v25, v25, v17
    v_mul_f32 v26, v26, v18
    v_mul_f32 v27, v27, v19
    v_mul_f32 v28, v28, v20
    v_mul_f32 v29, v29, v21
    v_mul_f32 v30, v30, v22
    v_mul_f32 v31, v31, v23
    v_exp_f32 v24, v24
    v_exp_f32 v25, v25
    v_exp_f32 v26, v26
    v_exp_f32 v27, v27
    v_exp_f32 v28, v28
    v_exp_f32 v29, v29
    v_exp_f32 v30, v30
    v_exp_f32 v31, v31
    v_add_f32 v24, 1.0, v24
    v_add_f32 v25, 1.0, v25
    v_add_f32 v26, 1.0, v26
    v_add_f32 v27, 1.0, v27
    v_add_f32 v28, 1.0, v28
    v_add_f32 v29, 1.0, v29
    v_add_f32 v30, 1.0, v30
    v_add_f32 v31, 1.0, v31
    v_rcp_f32 v24, v24
    v_rcp_f32 v25, v25
    v_rcp_f32 v26, v26
    v_rcp_f32 v27, v27
    v_rcp_f32 v28, v28
    v_rcp_f32 v29, v29
    v_rcp_f32 v30, v30
    v_rcp_f32 v31, v31
    v_mul_f32 v16, v16, v24
    v_mul_f32 v17, v17, v25
    v_mul_f32 v18, v18, v26
    v_mul_f32 v19, v19, v27
    v_mul_f32 v20, v20, v28
    v_mul_f32 v21, v21, v29
    v_mul_f32 v22, v22, v30
    v_mul_f32 v23, v23, v31
    v_cvt_pk_bf16_f32 v32, v16, v17
    v_cvt_pk_bf16_f32 v33, v18, v19
    buffer_store_dwordx2 v[32:33], v7, s[16:19], s25 offen offset:0 sc1
    v_cvt_pk_bf16_f32 v34, v20, v21
    v_cvt_pk_bf16_f32 v35, v22, v23
    buffer_store_dwordx2 v[34:35], v7, s[16:19], s25 offen offset:1024 sc1
    s_add_u32 s25, s25, 2048
    v_fma_f32 v36, v114, v144, v148
    v_fma_f32 v37, v118, v145, v149
    v_fma_f32 v38, v122, v146, v150
    v_fma_f32 v39, v126, v147, v151
    v_fma_f32 v40, v115, v144, v148
    v_fma_f32 v41, v119, v145, v149
    v_fma_f32 v42, v123, v146, v150
    v_fma_f32 v43, v127, v147, v151
    v_mul_f32 v44, v36, v36
    v_mul_f32 v45, v37, v37
    v_mul_f32 v46, v38, v38
    v_mul_f32 v47, v39, v39
    v_mul_f32 v48, v40, v40
    v_mul_f32 v49, v41, v41
    v_mul_f32 v50, v42, v42
    v_mul_f32 v51, v43, v43
    v_fma_f32 v44, v44, s31, v15
    v_fma_f32 v45, v45, s31, v15
    v_fma_f32 v46, v46, s31, v15
    v_fma_f32 v47, v47, s31, v15
    v_fma_f32 v48, v48, s31, v15
    v_fma_f32 v49, v49, s31, v15
    v_fma_f32 v50, v50, s31, v15
    v_fma_f32 v51, v51, s31, v15
    v_mul_f32 v44, v44, v36
    v_mul_f32 v45, v45, v37
    v_mul_f32 v46, v46, v38
    v_mul_f32 v47, v47, v39
    v_mul_f32 v48, v48, v40
    v_mul_f32 v49, v49, v41
    v_mul_f32 v50, v50, v42
    v_mul_f32 v51, v51, v43
    v_exp_f32 v44, v44
    v_exp_f32 v45, v45
    v_exp_f32 v46, v46
    v_exp_f32 v47, v47
    v_exp_f32 v48, v48
    v_exp_f32 v49, v49
    v_exp_f32 v50, v50
    v_exp_f32 v51, v51
    v_add_f32 v44, 1.0, v44
    v_add_f32 v45, 1.0, v45
    v_add_f32 v46, 1.0, v46
    v_add_f32 v47, 1.0, v47
    v_add_f32 v48, 1.0, v48
    v_add_f32 v49, 1.0, v49
    v_add_f32 v50, 1.0, v50
    v_add_f32 v51, 1.0, v51
    v_rcp_f32 v44, v44
    v_rcp_f32 v45, v45
    v_rcp_f32 v46, v46
    v_rcp_f32 v47, v47
    v_rcp_f32 v48, v48
    v_rcp_f32 v49, v49
    v_rcp_f32 v50, v50
    v_rcp_f32 v51, v51
    v_mul_f32 v36, v36, v44
    v_mul_f32 v37, v37, v45
    v_mul_f32 v38, v38, v46
    v_mul_f32 v39, v39, v47
    v_mul_f32 v40, v40, v48
    v_mul_f32 v41, v41, v49
    v_mul_f32 v42, v42, v50
    v_mul_f32 v43, v43, v51
    v_cvt_pk_bf16_f32 v52, v36, v37
    v_cvt_pk_bf16_f32 v53, v38, v39
    buffer_store_dwordx2 v[52:53], v7, s[16:19], s25 offen offset:0 sc1
    v_cvt_pk_bf16_f32 v54, v40, v41
    v_cvt_pk_bf16_f32 v55, v42, v43
    buffer_store_dwordx2 v[54:55], v7, s[16:19], s25 offen offset:1024 sc1
    s_add_u32 s25, s25, 2048
    s_add_u32 s25, s25, 12288
    v_fma_f32 v16, v128, v144, v148
    v_fma_f32 v17, v132, v145, v149
    v_fma_f32 v18, v136, v146, v150
    v_fma_f32 v19, v140, v147, v151
    v_fma_f32 v20, v129, v144, v148
    v_fma_f32 v21, v133, v145, v149
    v_fma_f32 v22, v137, v146, v150
    v_fma_f32 v23, v141, v147, v151
    v_mul_f32 v24, v16, v16
    v_mul_f32 v25, v17, v17
    v_mul_f32 v26, v18, v18
    v_mul_f32 v27, v19, v19
    v_mul_f32 v28, v20, v20
    v_mul_f32 v29, v21, v21
    v_mul_f32 v30, v22, v22
    v_mul_f32 v31, v23, v23
    v_fma_f32 v24, v24, s31, v15
    v_fma_f32 v25, v25, s31, v15
    v_fma_f32 v26, v26, s31, v15
    v_fma_f32 v27, v27, s31, v15
    v_fma_f32 v28, v28, s31, v15
    v_fma_f32 v29, v29, s31, v15
    v_fma_f32 v30, v30, s31, v15
    v_fma_f32 v31, v31, s31, v15
    v_mul_f32 v24, v24, v16
    v_mul_f32 v25, v25, v17
    v_mul_f32 v26, v26, v18
    v_mul_f32 v27, v27, v19
    v_mul_f32 v28, v28, v20
    v_mul_f32 v29, v29, v21
    v_mul_f32 v30, v30, v22
    v_mul_f32 v31, v31, v23
    v_exp_f32 v24, v24
    v_exp_f32 v25, v25
    v_exp_f32 v26, v26
    v_exp_f32 v27, v27
    v_exp_f32 v28, v28
    v_exp_f32 v29, v29
    v_exp_f32 v30, v30
    v_exp_f32 v31, v31
    v_add_f32 v24, 1.0, v24
    v_add_f32 v25, 1.0, v25
    v_add_f32 v26, 1.0, v26
    v_add_f32 v27, 1.0, v27
    v_add_f32 v28, 1.0, v28
    v_add_f32 v29, 1.0, v29
    v_add_f32 v30, 1.0, v30
    v_add_f32 v31, 1.0, v31
    v_rcp_f32 v24, v24
    v_rcp_f32 v25, v25
    v_rcp_f32 v26, v26
    v_rcp_f32 v27, v27
    v_rcp_f32 v28, v28
    v_rcp_f32 v29, v29
    v_rcp_f32 v30, v30
    v_rcp_f32 v31, v31
    v_mul_f32 v16, v16, v24
    v_mul_f32 v17, v17, v25
    v_mul_f32 v18, v18, v26
    v_mul_f32 v19, v19, v27
    v_mul_f32 v20, v20, v28
    v_mul_f32 v21, v21, v29
    v_mul_f32 v22, v22, v30
    v_mul_f32 v23, v23, v31
    v_cvt_pk_bf16_f32 v32, v16, v17
    v_cvt_pk_bf16_f32 v33, v18, v19
    buffer_store_dwordx2 v[32:33], v7, s[16:19], s25 offen offset:0 sc1
    v_cvt_pk_bf16_f32 v34, v20, v21
    v_cvt_pk_bf16_f32 v35, v22, v23
    buffer_store_dwordx2 v[34:35], v7, s[16:19], s25 offen offset:1024 sc1
    s_add_u32 s25, s25, 2048
    v_fma_f32 v36, v130, v144, v148
    v_fma_f32 v37, v134, v145, v149
    v_fma_f32 v38, v138, v146, v150
    v_fma_f32 v39, v142, v147, v151
    v_fma_f32 v40, v131, v144, v148
    v_fma_f32 v41, v135, v145, v149
    v_fma_f32 v42, v139, v146, v150
    v_fma_f32 v43, v143, v147, v151
    v_mul_f32 v44, v36, v36
    v_mul_f32 v45, v37, v37
    v_mul_f32 v46, v38, v38
    v_mul_f32 v47, v39, v39
    v_mul_f32 v48, v40, v40
    v_mul_f32 v49, v41, v41
    v_mul_f32 v50, v42, v42
    v_mul_f32 v51, v43, v43
    v_fma_f32 v44, v44, s31, v15
    v_fma_f32 v45, v45, s31, v15
    v_fma_f32 v46, v46, s31, v15
    v_fma_f32 v47, v47, s31, v15
    v_fma_f32 v48, v48, s31, v15
    v_fma_f32 v49, v49, s31, v15
    v_fma_f32 v50, v50, s31, v15
    v_fma_f32 v51, v51, s31, v15
    v_mul_f32 v44, v44, v36
    v_mul_f32 v45, v45, v37
    v_mul_f32 v46, v46, v38
    v_mul_f32 v47, v47, v39
    v_mul_f32 v48, v48, v40
    v_mul_f32 v49, v49, v41
    v_mul_f32 v50, v50, v42
    v_mul_f32 v51, v51, v43
    v_exp_f32 v44, v44
    v_exp_f32 v45, v45
    v_exp_f32 v46, v46
    v_exp_f32 v47, v47
    v_exp_f32 v48, v48
    v_exp_f32 v49, v49
    v_exp_f32 v50, v50
    v_exp_f32 v51, v51
    v_add_f32 v44, 1.0, v44
    v_add_f32 v45, 1.0, v45
    v_add_f32 v46, 1.0, v46
    v_add_f32 v47, 1.0, v47
    v_add_f32 v48, 1.0, v48
    v_add_f32 v49, 1.0, v49
    v_add_f32 v50, 1.0, v50
    v_add_f32 v51, 1.0, v51
    v_rcp_f32 v44, v44
    v_rcp_f32 v45, v45
    v_rcp_f32 v46, v46
    v_rcp_f32 v47, v47
    v_rcp_f32 v48, v48
    v_rcp_f32 v49, v49
    v_rcp_f32 v50, v50
    v_rcp_f32 v51, v51
    v_mul_f32 v36, v36, v44
    v_mul_f32 v37, v37, v45
    v_mul_f32 v38, v38, v46
    v_mul_f32 v39, v39, v47
    v_mul_f32 v40, v40, v48
    v_mul_f32 v41, v41, v49
    v_mul_f32 v42, v42, v50
    v_mul_f32 v43, v43, v51
    v_cvt_pk_bf16_f32 v52, v36, v37
    v_cvt_pk_bf16_f32 v53, v38, v39
    buffer_store_dwordx2 v[52:53], v7, s[16:19], s25 offen offset:0 sc1
    v_cvt_pk_bf16_f32 v54, v40, v41
    v_cvt_pk_bf16_f32 v55, v42, v43
    buffer_store_dwordx2 v[54:55], v7, s[16:19], s25 offen offset:1024 sc1
    s_add_u32 s25, s25, 2048
    s_add_u32 s25, s25, 12288
K34_END:
    s_endpgm
TEXT_END:
.section .rodata,"a"
.p2align 6
.amdhsa_kernel k1_xform_kernel
  .amdhsa_next_free_vgpr 128
  .amdhsa_next_free_sgpr 96
  .amdhsa_accum_offset 128
  .amdhsa_group_segment_fixed_size 0
  .amdhsa_kernarg_size 56
  .amdhsa_user_sgpr_count 2
  .amdhsa_user_sgpr_kernarg_segment_ptr 1
  .amdhsa_system_sgpr_workgroup_id_x 1
.end_amdhsa_kernel
.p2align 6
.amdhsa_kernel k12_fused_kernel
  .amdhsa_next_free_vgpr 256
  .amdhsa_next_free_sgpr 96
  .amdhsa_accum_offset 256
  .amdhsa_group_segment_fixed_size 0
  .amdhsa_kernarg_size 56
  .amdhsa_user_sgpr_count 2
  .amdhsa_user_sgpr_kernarg_segment_ptr 1
  .amdhsa_system_sgpr_workgroup_id_x 1
.end_amdhsa_kernel
.p2align 6
.amdhsa_kernel k34_out_kernel
  .amdhsa_next_free_vgpr 168
  .amdhsa_next_free_sgpr 96
  .amdhsa_accum_offset 168
  .amdhsa_group_segment_fixed_size 0
  .amdhsa_kernarg_size 56
  .amdhsa_user_sgpr_count 2
  .amdhsa_user_sgpr_kernarg_segment_ptr 1
  .amdhsa_system_sgpr_workgroup_id_x 1
.end_amdhsa_kernel
```

```asm
; @launch kernel=k1_xform_kernel grid=(636,1,1) block=(256,1,1) lds=16384
; @launch kernel=k12_fused_kernel grid=(256,1,1) block=(512,1,1) lds=155872
; @launch kernel=k34_out_kernel grid=(256,1,1) block=(768,1,1) lds=18944
.amdgcn_target "amdgcn-amd-amdhsa--gfx950"
.text
.globl k1_xform_kernel
.globl k12_fused_kernel
.globl k34_out_kernel
.p2align 8
.type k1_xform_kernel,@function
k1_xform_kernel:
    s_cmp_ge_u32 s2, 636
    s_cbranch_scc1 K1_END
    s_load_dwordx4 s[4:7], s[0:1], 0
    s_load_dwordx2 s[8:9], s[0:1], 48
    s_cmp_lt_u32 s2, 8
    s_cbranch_scc0 K1_NOCPF
    s_getpc_b64 s[90:91]
CPF_K1:
    s_sub_u32 s90, s90, CPF_K1-k1_xform_kernel
    s_subb_u32 s91, s91, 0
    v_lshlrev_b32 v8, 7, v0
    v_mov_b32 v11, s91
    v_min_u32 v9, TEXT_END-k1_xform_kernel-4, v8
    v_add_co_u32 v10, vcc, s90, v9
    v_addc_co_u32 v11, vcc, 0, v11, vcc
    global_load_dword v63, v[10:11], off
    v_mov_b32 v11, s91
    v_add_u32 v8, 32768, v8
    v_min_u32 v9, TEXT_END-k1_xform_kernel-4, v8
    v_add_co_u32 v10, vcc, s90, v9
    v_addc_co_u32 v11, vcc, 0, v11, vcc
    global_load_dword v63, v[10:11], off
K1_NOCPF:
    v_lshrrev_b32 v120, 6, v0
    v_and_b32 v121, 63, v0
    v_readfirstlane_b32 s3, v120
    v_and_b32 v122, 15, v121
    v_lshrrev_b32 v123, 4, v121
    s_mov_b32 s28, 0x05040100
    s_mov_b32 s29, 0x07060302
    v_and_b32 v124, 3, v122
    v_lshlrev_b32 v124, 2, v124
    v_lshrrev_b32 v125, 3, v122
    v_lshl_add_u32 v124, v125, 1, v124
    s_lshl_b32 s10, s3, 4
    s_add_u32 s10, s10, 1
    v_add_u32 v124, s10, v124
    v_bfe_u32 v125, v122, 2, 1
    v_lshlrev_b32 v121, 4, v121
    s_waitcnt lgkmcnt(0)
    s_or_b32 s10, s2, s3
    s_cmp_eq_u32 s10, 0
    s_cbranch_scc0 K1_NOCLR
    s_add_u32 s12, s8, 153092096
    s_addc_u32 s13, s9, 0
    s_and_b32 s13, s13, 0xffff
    s_mov_b32 s14, 32768
    s_mov_b32 s15, 0x00020000
    v_lshrrev_b32 v118, 4, v121
    v_lshlrev_b32 v119, 10, v118
    v_mov_b32 v117, 0
    s_mov_b64 exec, 0xffff
    buffer_store_dword v117, v119, s[12:15], 0 offen
    v_lshlrev_b32 v119, 4, v118
    v_add_u32 v119, 16384, v119
    buffer_store_dword v117, v119, s[12:15], 0 offen
    s_mov_b64 exec, -1
K1_NOCLR:
    s_cmp_lt_u32 s2, 32
    s_cbranch_scc0 K1_NOFILL
    s_add_u32 s12, s8, 153616384
    s_addc_u32 s13, s9, 0
    s_and_b32 s13, s13, 0xffff
    s_mov_b32 s14, 131072
    s_mov_b32 s15, 0x00020000
    s_lshl_b32 s10, s2, 2
    s_add_u32 s10, s10, s3
    s_lshl_b32 s10, s10, 10
    v_mov_b32 v112, -1
    v_mov_b32 v113, -1
    v_mov_b32 v114, -1
    v_mov_b32 v115, -1
    buffer_store_dwordx4 v[112:115], v121, s[12:15], s10 offen
K1_NOFILL:
    s_add_u32 s10, s2, 384
    s_sub_u32 s11, s2, 252
    s_cmp_lt_u32 s2, 252
    s_cselect_b32 s2, s10, s11
    s_cmp_lt_u32 s2, 384
    s_cbranch_scc1 K1_W
    s_sub_u32 s11, s2, 384
    s_mul_hi_u32 s13, s11, 1431655766
    s_mul_i32 s12, s13, 3
    s_sub_u32 s12, s11, s12
    s_mov_b32 s11, s13
    s_cmp_ge_u32 s11, 42
    s_cselect_b32 s13, 1, 0
    s_mul_i32 s14, s13, 42
    s_sub_u32 s11, s11, s14
    s_lshl_b32 s11, s11, 2
    s_add_u32 s11, s11, s3
    s_mul_i32 s14, s13, 16384000
    s_add_u32 s16, s4, s14
    s_addc_u32 s17, s5, 0
    s_and_b32 s17, s17, 0xffff
    s_mov_b32 s18, 16384000
    s_mov_b32 s19, 0x00020000
    s_mov_b32 s20, s8
    s_mov_b32 s21, s9
    s_and_b32 s21, s21, 0xffff
    s_mov_b32 s22, 43778048
    s_mov_b32 s23, 0x00020000
    v_lshlrev_b32 v126, 14, v123
    v_lshl_add_u32 v126, v122, 4, v126
    s_mul_i32 s15, s11, 98304
    s_lshl_b32 s24, s12, 8
    s_add_u32 s15, s15, s24
    buffer_load_dwordx4 v[0:3], v126, s[16:19], s15 offen
    buffer_load_dwordx4 v[4:7], v126, s[16:19], s15 offen offset:2048
    s_add_u32 s15, s15, 4096
    buffer_load_dwordx4 v[8:11], v126, s[16:19], s15 offen
    buffer_load_dwordx4 v[12:15], v126, s[16:19], s15 offen offset:2048
    s_add_u32 s15, s15, 4096
    buffer_load_dwordx4 v[16:19], v126, s[16:19], s15 offen
    buffer_load_dwordx4 v[20:23], v126, s[16:19], s15 offen offset:2048
    s_add_u32 s15, s15, 4096
    buffer_load_dwordx4 v[24:27], v126, s[16:19], s15 offen
    buffer_load_dwordx4 v[28:31], v126, s[16:19], s15 offen offset:2048
    s_add_u32 s15, s15, 53248
    buffer_load_dwordx4 v[32:35], v126, s[16:19], s15 offen
    buffer_load_dwordx4 v[36:39], v126, s[16:19], s15 offen offset:2048
    s_add_u32 s15, s15, 4096
    buffer_load_dwordx4 v[40:43], v126, s[16:19], s15 offen
    buffer_load_dwordx4 v[44:47], v126, s[16:19], s15 offen offset:2048
    s_add_u32 s15, s15, 4096
    buffer_load_dwordx4 v[48:51], v126, s[16:19], s15 offen
    buffer_load_dwordx4 v[52:55], v126, s[16:19], s15 offen offset:2048
    s_add_u32 s15, s15, 4096
    buffer_load_dwordx4 v[56:59], v126, s[16:19], s15 offen
    buffer_load_dwordx4 v[60:63], v126, s[16:19], s15 offen offset:2048
    v_lshlrev_b32 v127, 3, v123
    v_lshlrev_b32 v112, 5, v125
    v_mad_u32_u24 v113, v124, v127, v112
    v_mad_u32_u24 v64, v124, 0, v113
    v_mad_u32_u24 v65, v124, 1, v113
    v_mad_u32_u24 v66, v124, 2, v113
    v_mad_u32_u24 v67, v124, 3, v113
    v_mad_u32_u24 v68, v124, 4, v113
    v_mad_u32_u24 v69, v124, 5, v113
    v_mad_u32_u24 v70, v124, 6, v113
    v_mad_u32_u24 v71, v124, 7, v113
    v_and_b32 v64, 127, v64
    v_and_b32 v65, 127, v65
    v_and_b32 v66, 127, v66
    v_and_b32 v67, 127, v67
    v_and_b32 v68, 127, v68
    v_and_b32 v69, 127, v69
    v_and_b32 v70, 127, v70
    v_and_b32 v71, 127, v71
    v_cvt_f32_u32 v64, v64
    v_cvt_f32_u32 v65, v65
    v_cvt_f32_u32 v66, v66
    v_cvt_f32_u32 v67, v67
    v_cvt_f32_u32 v68, v68
    v_cvt_f32_u32 v69, v69
    v_cvt_f32_u32 v70, v70
    v_cvt_f32_u32 v71, v71
    v_mul_f32 v64, 0x3c000000, v64
    v_mul_f32 v65, 0x3c000000, v65
    v_mul_f32 v66, 0x3c000000, v66
    v_mul_f32 v67, 0x3c000000, v67
    v_mul_f32 v68, 0x3c000000, v68
    v_mul_f32 v69, 0x3c000000, v69
    v_mul_f32 v70, 0x3c000000, v70
    v_mul_f32 v71, 0x3c000000, v71
    v_cos_f32 v64, v64
    v_cos_f32 v65, v65
    v_cos_f32 v66, v66
    v_cos_f32 v67, v67
    v_cos_f32 v68, v68
    v_cos_f32 v69, v69
    v_cos_f32 v70, v70
    v_cos_f32 v71, v71
    s_nop 0
    v_cvt_pk_bf16_f32 v72, v64, v65
    v_cvt_pk_bf16_f32 v73, v66, v67
    v_cvt_pk_bf16_f32 v74, v68, v69
    v_cvt_pk_bf16_f32 v75, v70, v71
    v_lshlrev_b32 v80, 16, v72
    v_and_b32 v81, 0xffff0000, v72
    v_sub_f32 v64, v64, v80
    v_sub_f32 v65, v65, v81
    v_lshlrev_b32 v80, 16, v73
    v_and_b32 v81, 0xffff0000, v73
    v_sub_f32 v66, v66, v80
    v_sub_f32 v67, v67, v81
    v_lshlrev_b32 v80, 16, v74
    v_and_b32 v81, 0xffff0000, v74
    v_sub_f32 v68, v68, v80
    v_sub_f32 v69, v69, v81
    v_lshlrev_b32 v80, 16, v75
    v_and_b32 v81, 0xffff0000, v75
    v_sub_f32 v70, v70, v80
    v_sub_f32 v71, v71, v81
    v_cvt_pk_bf16_f32 v76, v64, v65
    v_cvt_pk_bf16_f32 v77, v66, v67
    v_cvt_pk_bf16_f32 v78, v68, v69
    v_cvt_pk_bf16_f32 v79, v70, v71
    s_lshl_b32 s24, s3, 12
    v_add_u32 v114, s24, v121
    ds_write_b128 v114, v[72:75] offset:0
    ds_write_b128 v114, v[76:79] offset:1024
    v_add_u32 v127, 32, v127
    v_lshlrev_b32 v112, 5, v125
    v_mad_u32_u24 v113, v124, v127, v112
    v_mad_u32_u24 v64, v124, 0, v113
    v_mad_u32_u24 v65, v124, 1, v113
    v_mad_u32_u24 v66, v124, 2, v113
    v_mad_u32_u24 v67, v124, 3, v113
    v_mad_u32_u24 v68, v124, 4, v113
    v_mad_u32_u24 v69, v124, 5, v113
    v_mad_u32_u24 v70, v124, 6, v113
    v_mad_u32_u24 v71, v124, 7, v113
    v_and_b32 v64, 127, v64
    v_and_b32 v65, 127, v65
    v_and_b32 v66, 127, v66
    v_and_b32 v67, 127, v67
    v_and_b32 v68, 127, v68
    v_and_b32 v69, 127, v69
    v_and_b32 v70, 127, v70
    v_and_b32 v71, 127, v71
    v_cvt_f32_u32 v64, v64
    v_cvt_f32_u32 v65, v65
    v_cvt_f32_u32 v66, v66
    v_cvt_f32_u32 v67, v67
    v_cvt_f32_u32 v68, v68
    v_cvt_f32_u32 v69, v69
    v_cvt_f32_u32 v70, v70
    v_cvt_f32_u32 v71, v71
    v_mul_f32 v64, 0x3c000000, v64
    v_mul_f32 v65, 0x3c000000, v65
    v_mul_f32 v66, 0x3c000000, v66
    v_mul_f32 v67, 0x3c000000, v67
    v_mul_f32 v68, 0x3c000000, v68
    v_mul_f32 v69, 0x3c000000, v69
    v_mul_f32 v70, 0x3c000000, v70
    v_mul_f32 v71, 0x3c000000, v71
    v_cos_f32 v64, v64
    v_cos_f32 v65, v65
    v_cos_f32 v66, v66
    v_cos_f32 v67, v67
    v_cos_f32 v68, v68
    v_cos_f32 v69, v69
    v_cos_f32 v70, v70
    v_cos_f32 v71, v71
    s_nop 0
    v_cvt_pk_bf16_f32 v72, v64, v65
    v_cvt_pk_bf16_f32 v73, v66, v67
    v_cvt_pk_bf16_f32 v74, v68, v69
    v_cvt_pk_bf16_f32 v75, v70, v71
    v_lshlrev_b32 v80, 16, v72
    v_and_b32 v81, 0xffff0000, v72
    v_sub_f32 v64, v64, v80
    v_sub_f32 v65, v65, v81
    v_lshlrev_b32 v80, 16, v73
    v_and_b32 v81, 0xffff0000, v73
    v_sub_f32 v66, v66, v80
    v_sub_f32 v67, v67, v81
    v_lshlrev_b32 v80, 16, v74
    v_and_b32 v81, 0xffff0000, v74
    v_sub_f32 v68, v68, v80
    v_sub_f32 v69, v69, v81
    v_lshlrev_b32 v80, 16, v75
    v_and_b32 v81, 0xffff0000, v75
    v_sub_f32 v70, v70, v80
    v_sub_f32 v71, v71, v81
    v_cvt_pk_bf16_f32 v76, v64, v65
    v_cvt_pk_bf16_f32 v77, v66, v67
    v_cvt_pk_bf16_f32 v78, v68, v69
    v_cvt_pk_bf16_f32 v79, v70, v71
    s_lshl_b32 s24, s3, 12
    v_add_u32 v114, s24, v121
    ds_write_b128 v114, v[72:75] offset:2048
    ds_write_b128 v114, v[76:79] offset:3072
    v_lshrrev_b32 v112, 1, v123
    s_mov_b32 s24, 1368064
    v_mul_lo_u32 v112, v112, s24
    v_lshrrev_b32 v113, 2, v122
    s_mov_b32 s24, 21376
    v_mul_lo_u32 v113, v113, s24
    v_add_u32 v112, v112, v113
    v_and_b32 v113, 3, v122
    v_and_b32 v114, 1, v123
    v_lshl_add_u32 v113, v114, 2, v113
    s_add_u32 s24, s11, 7
    s_cmp_ge_u32 s11, 160
    s_cselect_b32 s24, s24, s11
    s_cmp_eq_u32 s13, 1
    s_cselect_b32 s24, s24, s11
    s_lshr_b32 s24, s24, 1
    s_and_b32 s24, s24, 7
    v_xor_b32 v113, s24, v113
    v_lshl_add_u32 v120, v113, 4, v112
    s_mul_i32 s25, s13, 684032
    s_mul_i32 s24, s12, 85504
    s_add_u32 s25, s25, s24
    s_lshl_b32 s24, s11, 7
    s_add_u32 s25, s25, s24
    s_waitcnt lgkmcnt(0)
    s_barrier
    s_cmp_ge_u32 s11, 167
    s_cbranch_scc1 K1_END
    s_waitcnt vmcnt(8)
    v_perm_b32 v64, v4, v0, s28
    v_perm_b32 v68, v4, v0, s29
    v_perm_b32 v65, v12, v8, s28
    v_perm_b32 v69, v12, v8, s29
    v_perm_b32 v66, v20, v16, s28
    v_perm_b32 v70, v20, v16, s29
    v_perm_b32 v67, v28, v24, s28
    v_perm_b32 v71, v28, v24, s29
    v_perm_b32 v72, v5, v1, s28
    v_perm_b32 v76, v5, v1, s29
    v_perm_b32 v73, v13, v9, s28
    v_perm_b32 v77, v13, v9, s29
    v_perm_b32 v74, v21, v17, s28
    v_perm_b32 v78, v21, v17, s29
    v_perm_b32 v75, v29, v25, s28
    v_perm_b32 v79, v29, v25, s29
    v_perm_b32 v80, v6, v2, s28
    v_perm_b32 v84, v6, v2, s29
    v_perm_b32 v81, v14, v10, s28
    v_perm_b32 v85, v14, v10, s29
    v_perm_b32 v82, v22, v18, s28
    v_perm_b32 v86, v22, v18, s29
    v_perm_b32 v83, v30, v26, s28
    v_perm_b32 v87, v30, v26, s29
    v_perm_b32 v88, v7, v3, s28
    v_perm_b32 v92, v7, v3, s29
    v_perm_b32 v89, v15, v11, s28
    v_perm_b32 v93, v15, v11, s29
    v_perm_b32 v90, v23, v19, s28
    v_perm_b32 v94, v23, v19, s29
    v_perm_b32 v91, v31, v27, s28
    v_perm_b32 v95, v31, v27, s29
    s_waitcnt vmcnt(0)
    v_perm_b32 v0, v36, v32, s28
    v_perm_b32 v4, v36, v32, s29
    v_perm_b32 v1, v44, v40, s28
    v_perm_b32 v5, v44, v40, s29
    v_perm_b32 v2, v52, v48, s28
    v_perm_b32 v6, v52, v48, s29
    v_perm_b32 v3, v60, v56, s28
    v_perm_b32 v7, v60, v56, s29
    v_perm_b32 v8, v37, v33, s28
    v_perm_b32 v12, v37, v33, s29
    v_perm_b32 v9, v45, v41, s28
    v_perm_b32 v13, v45, v41, s29
    v_perm_b32 v10, v53, v49, s28
    v_perm_b32 v14, v53, v49, s29
    v_perm_b32 v11, v61, v57, s28
    v_perm_b32 v15, v61, v57, s29
    v_perm_b32 v16, v38, v34, s28
    v_perm_b32 v20, v38, v34, s29
    v_perm_b32 v17, v46, v42, s28
    v_perm_b32 v21, v46, v42, s29
    v_perm_b32 v18, v54, v50, s28
    v_perm_b32 v22, v54, v50, s29
    v_perm_b32 v19, v62, v58, s28
    v_perm_b32 v23, v62, v58, s29
    v_perm_b32 v24, v39, v35, s28
    v_perm_b32 v28, v39, v35, s29
    v_perm_b32 v25, v47, v43, s28
    v_perm_b32 v29, v47, v43, s29
    v_perm_b32 v26, v55, v51, s28
    v_perm_b32 v30, v55, v51, s29
    v_perm_b32 v27, v63, v59, s28
    v_perm_b32 v31, v63, v59, s29
    ds_read_b128 v[96:99], v121 offset:0
    ds_read_b128 v[100:103], v121 offset:1024
    ds_read_b128 v[104:107], v121 offset:2048
    ds_read_b128 v[108:111], v121 offset:3072
    s_waitcnt lgkmcnt(3)
    v_mfma_f32_16x16x32_bf16 v[32:35], v[96:99], v[64:67], 0
    v_mfma_f32_16x16x32_bf16 v[36:39], v[96:99], v[68:71], 0
    v_mfma_f32_16x16x32_bf16 v[40:43], v[96:99], v[72:75], 0
    v_mfma_f32_16x16x32_bf16 v[44:47], v[96:99], v[76:79], 0
    v_mfma_f32_16x16x32_bf16 v[48:51], v[96:99], v[80:83], 0
    v_mfma_f32_16x16x32_bf16 v[52:55], v[96:99], v[84:87], 0
    v_mfma_f32_16x16x32_bf16 v[56:59], v[96:99], v[88:91], 0
    v_mfma_f32_16x16x32_bf16 v[60:63], v[96:99], v[92:95], 0
    s_waitcnt lgkmcnt(2)
    v_mfma_f32_16x16x32_bf16 v[32:35], v[100:103], v[64:67], v[32:35]
    v_mfma_f32_16x16x32_bf16 v[36:39], v[100:103], v[68:71], v[36:39]
    v_mfma_f32_16x16x32_bf16 v[40:43], v[100:103], v[72:75], v[40:43]
    v_mfma_f32_16x16x32_bf16 v[44:47], v[100:103], v[76:79], v[44:47]
    v_mfma_f32_16x16x32_bf16 v[48:51], v[100:103], v[80:83], v[48:51]
    v_mfma_f32_16x16x32_bf16 v[52:55], v[100:103], v[84:87], v[52:55]
    v_mfma_f32_16x16x32_bf16 v[56:59], v[100:103], v[88:91], v[56:59]
    v_mfma_f32_16x16x32_bf16 v[60:63], v[100:103], v[92:95], v[60:63]
    s_waitcnt lgkmcnt(1)
    v_mfma_f32_16x16x32_bf16 v[32:35], v[104:107], v[0:3], v[32:35]
    v_mfma_f32_16x16x32_bf16 v[36:39], v[104:107], v[4:7], v[36:39]
    v_mfma_f32_16x16x32_bf16 v[40:43], v[104:107], v[8:11], v[40:43]
    v_mfma_f32_16x16x32_bf16 v[44:47], v[104:107], v[12:15], v[44:47]
    v_mfma_f32_16x16x32_bf16 v[48:51], v[104:107], v[16:19], v[48:51]
    v_mfma_f32_16x16x32_bf16 v[52:55], v[104:107], v[20:23], v[52:55]
    v_mfma_f32_16x16x32_bf16 v[56:59], v[104:107], v[24:27], v[56:59]
    v_mfma_f32_16x16x32_bf16 v[60:63], v[104:107], v[28:31], v[60:63]
    s_waitcnt lgkmcnt(0)
    v_mfma_f32_16x16x32_bf16 v[32:35], v[108:111], v[0:3], v[32:35]
    v_mfma_f32_16x16x32_bf16 v[36:39], v[108:111], v[4:7], v[36:39]
    v_mfma_f32_16x16x32_bf16 v[40:43], v[108:111], v[8:11], v[40:43]
    v_mfma_f32_16x16x32_bf16 v[44:47], v[108:111], v[12:15], v[44:47]
    v_mfma_f32_16x16x32_bf16 v[48:51], v[108:111], v[16:19], v[48:51]
    v_mfma_f32_16x16x32_bf16 v[52:55], v[108:111], v[20:23], v[52:55]
    v_mfma_f32_16x16x32_bf16 v[56:59], v[108:111], v[24:27], v[56:59]
    v_mfma_f32_16x16x32_bf16 v[60:63], v[108:111], v[28:31], v[60:63]
    s_nop 7
    v_cvt_pk_bf16_f32 v112, v32, v36
    v_cvt_pk_bf16_f32 v113, v40, v44
    v_cvt_pk_bf16_f32 v114, v48, v52
    v_cvt_pk_bf16_f32 v115, v56, v60
    buffer_store_dwordx4 v[112:115], v120, s[20:23], s25 offen
    s_add_u32 s25, s25, 2736128
    v_cvt_pk_bf16_f32 v116, v33, v37
    v_cvt_pk_bf16_f32 v117, v41, v45
    v_cvt_pk_bf16_f32 v118, v49, v53
    v_cvt_pk_bf16_f32 v119, v57, v61
    buffer_store_dwordx4 v[116:119], v120, s[20:23], s25 offen
    s_add_u32 s25, s25, 2736128
    v_cvt_pk_bf16_f32 v112, v34, v38
    v_cvt_pk_bf16_f32 v113, v42, v46
    v_cvt_pk_bf16_f32 v114, v50, v54
    v_cvt_pk_bf16_f32 v115, v58, v62
    buffer_store_dwordx4 v[112:115], v120, s[20:23], s25 offen
    s_add_u32 s25, s25, 2736128
    v_cvt_pk_bf16_f32 v116, v35, v39
    v_cvt_pk_bf16_f32 v117, v43, v47
    v_cvt_pk_bf16_f32 v118, v51, v55
    v_cvt_pk_bf16_f32 v119, v59, v63
    buffer_store_dwordx4 v[116:119], v120, s[20:23], s25 offen
    s_add_u32 s25, s25, 2736128
    ds_read_b128 v[96:99], v121 offset:4096
    ds_read_b128 v[100:103], v121 offset:5120
    ds_read_b128 v[104:107], v121 offset:6144
    ds_read_b128 v[108:111], v121 offset:7168
    s_waitcnt lgkmcnt(3)
    v_mfma_f32_16x16x32_bf16 v[32:35], v[96:99], v[64:67], 0
    v_mfma_f32_16x16x32_bf16 v[36:39], v[96:99], v[68:71], 0
    v_mfma_f32_16x16x32_bf16 v[40:43], v[96:99], v[72:75], 0
    v_mfma_f32_16x16x32_bf16 v[44:47], v[96:99], v[76:79], 0
    v_mfma_f32_16x16x32_bf16 v[48:51], v[96:99], v[80:83], 0
    v_mfma_f32_16x16x32_bf16 v[52:55], v[96:99], v[84:87], 0
    v_mfma_f32_16x16x32_bf16 v[56:59], v[96:99], v[88:91], 0
    v_mfma_f32_16x16x32_bf16 v[60:63], v[96:99], v[92:95], 0
    s_waitcnt lgkmcnt(2)
    v_mfma_f32_16x16x32_bf16 v[32:35], v[100:103], v[64:67], v[32:35]
    v_mfma_f32_16x16x32_bf16 v[36:39], v[100:103], v[68:71], v[36:39]
    v_mfma_f32_16x16x32_bf16 v[40:43], v[100:103], v[72:75], v[40:43]
    v_mfma_f32_16x16x32_bf16 v[44:47], v[100:103], v[76:79], v[44:47]
    v_mfma_f32_16x16x32_bf16 v[48:51], v[100:103], v[80:83], v[48:51]
    v_mfma_f32_16x16x32_bf16 v[52:55], v[100:103], v[84:87], v[52:55]
    v_mfma_f32_16x16x32_bf16 v[56:59], v[100:103], v[88:91], v[56:59]
    v_mfma_f32_16x16x32_bf16 v[60:63], v[100:103], v[92:95], v[60:63]
    s_waitcnt lgkmcnt(1)
    v_mfma_f32_16x16x32_bf16 v[32:35], v[104:107], v[0:3], v[32:35]
    v_mfma_f32_16x16x32_bf16 v[36:39], v[104:107], v[4:7], v[36:39]
    v_mfma_f32_16x16x32_bf16 v[40:43], v[104:107], v[8:11], v[40:43]
    v_mfma_f32_16x16x32_bf16 v[44:47], v[104:107], v[12:15], v[44:47]
    v_mfma_f32_16x16x32_bf16 v[48:51], v[104:107], v[16:19], v[48:51]
    v_mfma_f32_16x16x32_bf16 v[52:55], v[104:107], v[20:23], v[52:55]
    v_mfma_f32_16x16x32_bf16 v[56:59], v[104:107], v[24:27], v[56:59]
    v_mfma_f32_16x16x32_bf16 v[60:63], v[104:107], v[28:31], v[60:63]
    s_waitcnt lgkmcnt(0)
    v_mfma_f32_16x16x32_bf16 v[32:35], v[108:111], v[0:3], v[32:35]
    v_mfma_f32_16x16x32_bf16 v[36:39], v[108:111], v[4:7], v[36:39]
    v_mfma_f32_16x16x32_bf16 v[40:43], v[108:111], v[8:11], v[40:43]
    v_mfma_f32_16x16x32_bf16 v[44:47], v[108:111], v[12:15], v[44:47]
    v_mfma_f32_16x16x32_bf16 v[48:51], v[108:111], v[16:19], v[48:51]
    v_mfma_f32_16x16x32_bf16 v[52:55], v[108:111], v[20:23], v[52:55]
    v_mfma_f32_16x16x32_bf16 v[56:59], v[108:111], v[24:27], v[56:59]
    v_mfma_f32_16x16x32_bf16 v[60:63], v[108:111], v[28:31], v[60:63]
    s_nop 7
    v_cvt_pk_bf16_f32 v112, v32, v36
    v_cvt_pk_bf16_f32 v113, v40, v44
    v_cvt_pk_bf16_f32 v114, v48, v52
    v_cvt_pk_bf16_f32 v115, v56, v60
    buffer_store_dwordx4 v[112:115], v120, s[20:23], s25 offen
    s_add_u32 s25, s25, 2736128
    v_cvt_pk_bf16_f32 v116, v33, v37
    v_cvt_pk_bf16_f32 v117, v41, v45
    v_cvt_pk_bf16_f32 v118, v49, v53
    v_cvt_pk_bf16_f32 v119, v57, v61
    buffer_store_dwordx4 v[116:119], v120, s[20:23], s25 offen
    s_add_u32 s25, s25, 2736128
    v_cvt_pk_bf16_f32 v112, v34, v38
    v_cvt_pk_bf16_f32 v113, v42, v46
    v_cvt_pk_bf16_f32 v114, v50, v54
    v_cvt_pk_bf16_f32 v115, v58, v62
    buffer_store_dwordx4 v[112:115], v120, s[20:23], s25 offen
    s_add_u32 s25, s25, 2736128
    v_cvt_pk_bf16_f32 v116, v35, v39
    v_cvt_pk_bf16_f32 v117, v43, v47
    v_cvt_pk_bf16_f32 v118, v51, v55
    v_cvt_pk_bf16_f32 v119, v59, v63
    buffer_store_dwordx4 v[116:119], v120, s[20:23], s25 offen
    s_add_u32 s25, s25, 2736128
    ds_read_b128 v[96:99], v121 offset:8192
    ds_read_b128 v[100:103], v121 offset:9216
    ds_read_b128 v[104:107], v121 offset:10240
    ds_read_b128 v[108:111], v121 offset:11264
    s_waitcnt lgkmcnt(3)
    v_mfma_f32_16x16x32_bf16 v[32:35], v[96:99], v[64:67], 0
    v_mfma_f32_16x16x32_bf16 v[36:39], v[96:99], v[68:71], 0
    v_mfma_f32_16x16x32_bf16 v[40:43], v[96:99], v[72:75], 0
    v_mfma_f32_16x16x32_bf16 v[44:47], v[96:99], v[76:79], 0
    v_mfma_f32_16x16x32_bf16 v[48:51], v[96:99], v[80:83], 0
    v_mfma_f32_16x16x32_bf16 v[52:55], v[96:99], v[84:87], 0
    v_mfma_f32_16x16x32_bf16 v[56:59], v[96:99], v[88:91], 0
    v_mfma_f32_16x16x32_bf16 v[60:63], v[96:99], v[92:95], 0
    s_waitcnt lgkmcnt(2)
    v_mfma_f32_16x16x32_bf16 v[32:35], v[100:103], v[64:67], v[32:35]
    v_mfma_f32_16x16x32_bf16 v[36:39], v[100:103], v[68:71], v[36:39]
    v_mfma_f32_16x16x32_bf16 v[40:43], v[100:103], v[72:75], v[40:43]
    v_mfma_f32_16x16x32_bf16 v[44:47], v[100:103], v[76:79], v[44:47]
    v_mfma_f32_16x16x32_bf16 v[48:51], v[100:103], v[80:83], v[48:51]
    v_mfma_f32_16x16x32_bf16 v[52:55], v[100:103], v[84:87], v[52:55]
    v_mfma_f32_16x16x32_bf16 v[56:59], v[100:103], v[88:91], v[56:59]
    v_mfma_f32_16x16x32_bf16 v[60:63], v[100:103], v[92:95], v[60:63]
    s_waitcnt lgkmcnt(1)
    v_mfma_f32_16x16x32_bf16 v[32:35], v[104:107], v[0:3], v[32:35]
    v_mfma_f32_16x16x32_bf16 v[36:39], v[104:107], v[4:7], v[36:39]
    v_mfma_f32_16x16x32_bf16 v[40:43], v[104:107], v[8:11], v[40:43]
    v_mfma_f32_16x16x32_bf16 v[44:47], v[104:107], v[12:15], v[44:47]
    v_mfma_f32_16x16x32_bf16 v[48:51], v[104:107], v[16:19], v[48:51]
    v_mfma_f32_16x16x32_bf16 v[52:55], v[104:107], v[20:23], v[52:55]
    v_mfma_f32_16x16x32_bf16 v[56:59], v[104:107], v[24:27], v[56:59]
    v_mfma_f32_16x16x32_bf16 v[60:63], v[104:107], v[28:31], v[60:63]
    s_waitcnt lgkmcnt(0)
    v_mfma_f32_16x16x32_bf16 v[32:35], v[108:111], v[0:3], v[32:35]
    v_mfma_f32_16x16x32_bf16 v[36:39], v[108:111], v[4:7], v[36:39]
    v_mfma_f32_16x16x32_bf16 v[40:43], v[108:111], v[8:11], v[40:43]
    v_mfma_f32_16x16x32_bf16 v[44:47], v[108:111], v[12:15], v[44:47]
    v_mfma_f32_16x16x32_bf16 v[48:51], v[108:111], v[16:19], v[48:51]
    v_mfma_f32_16x16x32_bf16 v[52:55], v[108:111], v[20:23], v[52:55]
    v_mfma_f32_16x16x32_bf16 v[56:59], v[108:111], v[24:27], v[56:59]
    v_mfma_f32_16x16x32_bf16 v[60:63], v[108:111], v[28:31], v[60:63]
    s_nop 7
    v_cvt_pk_bf16_f32 v112, v32, v36
    v_cvt_pk_bf16_f32 v113, v40, v44
    v_cvt_pk_bf16_f32 v114, v48, v52
    v_cvt_pk_bf16_f32 v115, v56, v60
    buffer_store_dwordx4 v[112:115], v120, s[20:23], s25 offen
    s_add_u32 s25, s25, 2736128
    v_cvt_pk_bf16_f32 v116, v33, v37
    v_cvt_pk_bf16_f32 v117, v41, v45
    v_cvt_pk_bf16_f32 v118, v49, v53
    v_cvt_pk_bf16_f32 v119, v57, v61
    buffer_store_dwordx4 v[116:119], v120, s[20:23], s25 offen
    s_add_u32 s25, s25, 2736128
    v_cvt_pk_bf16_f32 v112, v34, v38
    v_cvt_pk_bf16_f32 v113, v42, v46
    v_cvt_pk_bf16_f32 v114, v50, v54
    v_cvt_pk_bf16_f32 v115, v58, v62
    buffer_store_dwordx4 v[112:115], v120, s[20:23], s25 offen
    s_add_u32 s25, s25, 2736128
    v_cvt_pk_bf16_f32 v116, v35, v39
    v_cvt_pk_bf16_f32 v117, v43, v47
    v_cvt_pk_bf16_f32 v118, v51, v55
    v_cvt_pk_bf16_f32 v119, v59, v63
    buffer_store_dwordx4 v[116:119], v120, s[20:23], s25 offen
    s_add_u32 s25, s25, 2736128
    ds_read_b128 v[96:99], v121 offset:12288
    ds_read_b128 v[100:103], v121 offset:13312
    ds_read_b128 v[104:107], v121 offset:14336
    ds_read_b128 v[108:111], v121 offset:15360
    s_waitcnt lgkmcnt(3)
    v_mfma_f32_16x16x32_bf16 v[32:35], v[96:99], v[64:67], 0
    v_mfma_f32_16x16x32_bf16 v[36:39], v[96:99], v[68:71], 0
    v_mfma_f32_16x16x32_bf16 v[40:43], v[96:99], v[72:75], 0
    v_mfma_f32_16x16x32_bf16 v[44:47], v[96:99], v[76:79], 0
    v_mfma_f32_16x16x32_bf16 v[48:51], v[96:99], v[80:83], 0
    v_mfma_f32_16x16x32_bf16 v[52:55], v[96:99], v[84:87], 0
    v_mfma_f32_16x16x32_bf16 v[56:59], v[96:99], v[88:91], 0
    v_mfma_f32_16x16x32_bf16 v[60:63], v[96:99], v[92:95], 0
    s_waitcnt lgkmcnt(2)
    v_mfma_f32_16x16x32_bf16 v[32:35], v[100:103], v[64:67], v[32:35]
    v_mfma_f32_16x16x32_bf16 v[36:39], v[100:103], v[68:71], v[36:39]
    v_mfma_f32_16x16x32_bf16 v[40:43], v[100:103], v[72:75], v[40:43]
    v_mfma_f32_16x16x32_bf16 v[44:47], v[100:103], v[76:79], v[44:47]
    v_mfma_f32_16x16x32_bf16 v[48:51], v[100:103], v[80:83], v[48:51]
    v_mfma_f32_16x16x32_bf16 v[52:55], v[100:103], v[84:87], v[52:55]
    v_mfma_f32_16x16x32_bf16 v[56:59], v[100:103], v[88:91], v[56:59]
    v_mfma_f32_16x16x32_bf16 v[60:63], v[100:103], v[92:95], v[60:63]
    s_waitcnt lgkmcnt(1)
    v_mfma_f32_16x16x32_bf16 v[32:35], v[104:107], v[0:3], v[32:35]
    v_mfma_f32_16x16x32_bf16 v[36:39], v[104:107], v[4:7], v[36:39]
    v_mfma_f32_16x16x32_bf16 v[40:43], v[104:107], v[8:11], v[40:43]
    v_mfma_f32_16x16x32_bf16 v[44:47], v[104:107], v[12:15], v[44:47]
    v_mfma_f32_16x16x32_bf16 v[48:51], v[104:107], v[16:19], v[48:51]
    v_mfma_f32_16x16x32_bf16 v[52:55], v[104:107], v[20:23], v[52:55]
    v_mfma_f32_16x16x32_bf16 v[56:59], v[104:107], v[24:27], v[56:59]
    v_mfma_f32_16x16x32_bf16 v[60:63], v[104:107], v[28:31], v[60:63]
    s_waitcnt lgkmcnt(0)
    v_mfma_f32_16x16x32_bf16 v[32:35], v[108:111], v[0:3], v[32:35]
    v_mfma_f32_16x16x32_bf16 v[36:39], v[108:111], v[4:7], v[36:39]
    v_mfma_f32_16x16x32_bf16 v[40:43], v[108:111], v[8:11], v[40:43]
    v_mfma_f32_16x16x32_bf16 v[44:47], v[108:111], v[12:15], v[44:47]
    v_mfma_f32_16x16x32_bf16 v[48:51], v[108:111], v[16:19], v[48:51]
    v_mfma_f32_16x16x32_bf16 v[52:55], v[108:111], v[20:23], v[52:55]
    v_mfma_f32_16x16x32_bf16 v[56:59], v[108:111], v[24:27], v[56:59]
    v_mfma_f32_16x16x32_bf16 v[60:63], v[108:111], v[28:31], v[60:63]
    s_nop 7
    v_cvt_pk_bf16_f32 v112, v32, v36
    v_cvt_pk_bf16_f32 v113, v40, v44
    v_cvt_pk_bf16_f32 v114, v48, v52
    v_cvt_pk_bf16_f32 v115, v56, v60
    buffer_store_dwordx4 v[112:115], v120, s[20:23], s25 offen
    s_add_u32 s25, s25, 2736128
    v_cvt_pk_bf16_f32 v116, v33, v37
    v_cvt_pk_bf16_f32 v117, v41, v45
    v_cvt_pk_bf16_f32 v118, v49, v53
    v_cvt_pk_bf16_f32 v119, v57, v61
    buffer_store_dwordx4 v[116:119], v120, s[20:23], s25 offen
    s_add_u32 s25, s25, 2736128
    v_cvt_pk_bf16_f32 v112, v34, v38
    v_cvt_pk_bf16_f32 v113, v42, v46
    v_cvt_pk_bf16_f32 v114, v50, v54
    v_cvt_pk_bf16_f32 v115, v58, v62
    buffer_store_dwordx4 v[112:115], v120, s[20:23], s25 offen
    s_add_u32 s25, s25, 2736128
    v_cvt_pk_bf16_f32 v116, v35, v39
    v_cvt_pk_bf16_f32 v117, v43, v47
    v_cvt_pk_bf16_f32 v118, v51, v55
    v_cvt_pk_bf16_f32 v119, v59, v63
    buffer_store_dwordx4 v[116:119], v120, s[20:23], s25 offen
    s_endpgm
K1_W:
    s_mov_b32 s16, s6
    s_mov_b32 s17, s7
    s_and_b32 s17, s17, 0xffff
    s_mov_b32 s18, 16252928
    s_mov_b32 s19, 0x00020000
    s_add_u32 s20, s8, 50331648
    s_addc_u32 s21, s9, 0
    s_and_b32 s21, s21, 0xffff
    s_mov_b32 s22, 67108864
    s_mov_b32 s23, 0x00020000
    s_mul_i32 s11, s2, 1
    s_lshr_b32 s12, s11, 9
    s_and_b32 s13, s11, 511
    s_lshl_b32 s14, s12, 19
    s_lshl_b32 s15, s13, 10
    s_add_u32 s14, s14, s15
    s_lshl_b32 s15, s3, 8
    s_add_u32 s14, s14, s15
    v_and_b32 v126, 1, v123
    v_lshlrev_b32 v126, 23, v126
    v_lshl_add_u32 v126, v122, 4, v126
    s_mov_b32 s15, s14
    buffer_load_dwordx4 v[0:3], v126, s[16:19], s15 offen
    s_add_u32 s15, s15, 0x100000
    buffer_load_dwordx4 v[4:7], v126, s[16:19], s15 offen
    s_add_u32 s15, s15, 0x100000
    buffer_load_dwordx4 v[8:11], v126, s[16:19], s15 offen
    s_add_u32 s15, s15, 0x100000
    buffer_load_dwordx4 v[12:15], v126, s[16:19], s15 offen
    s_add_u32 s15, s15, 0x100000
    buffer_load_dwordx4 v[16:19], v126, s[16:19], s15 offen
    s_add_u32 s15, s15, 0x100000
    buffer_load_dwordx4 v[20:23], v126, s[16:19], s15 offen
    s_add_u32 s15, s15, 0x100000
    buffer_load_dwordx4 v[24:27], v126, s[16:19], s15 offen
    s_add_u32 s15, s15, 0x100000
    buffer_load_dwordx4 v[28:31], v126, s[16:19], s15 offen
    v_and_b32 v127, 1, v123
    v_lshlrev_b32 v127, 3, v127
    v_mul_u32_u24 v112, 96, v125
    v_mad_u32_u24 v113, v124, v127, v112
    v_mad_u32_u24 v64, v124, 0, v113
    v_mad_u32_u24 v65, v124, 1, v113
    v_mad_u32_u24 v66, v124, 2, v113
    v_mad_u32_u24 v67, v124, 3, v113
    v_mad_u32_u24 v68, v124, 4, v113
    v_mad_u32_u24 v69, v124, 5, v113
    v_mad_u32_u24 v70, v124, 6, v113
    v_mad_u32_u24 v71, v124, 7, v113
    v_and_b32 v64, 127, v64
    v_and_b32 v65, 127, v65
    v_and_b32 v66, 127, v66
    v_and_b32 v67, 127, v67
    v_and_b32 v68, 127, v68
    v_and_b32 v69, 127, v69
    v_and_b32 v70, 127, v70
    v_and_b32 v71, 127, v71
    v_cvt_f32_u32 v64, v64
    v_cvt_f32_u32 v65, v65
    v_cvt_f32_u32 v66, v66
    v_cvt_f32_u32 v67, v67
    v_cvt_f32_u32 v68, v68
    v_cvt_f32_u32 v69, v69
    v_cvt_f32_u32 v70, v70
    v_cvt_f32_u32 v71, v71
    v_mul_f32 v64, 0x3c000000, v64
    v_mul_f32 v65, 0x3c000000, v65
    v_mul_f32 v66, 0x3c000000, v66
    v_mul_f32 v67, 0x3c000000, v67
    v_mul_f32 v68, 0x3c000000, v68
    v_mul_f32 v69, 0x3c000000, v69
    v_mul_f32 v70, 0x3c000000, v70
    v_mul_f32 v71, 0x3c000000, v71
    v_cos_f32 v64, v64
    v_cos_f32 v65, v65
    v_cos_f32 v66, v66
    v_cos_f32 v67, v67
    v_cos_f32 v68, v68
    v_cos_f32 v69, v69
    v_cos_f32 v70, v70
    v_cos_f32 v71, v71
    s_nop 0
    v_cvt_pk_bf16_f32 v72, v64, v65
    v_cvt_pk_bf16_f32 v73, v66, v67
    v_cvt_pk_bf16_f32 v74, v68, v69
    v_cvt_pk_bf16_f32 v75, v70, v71
    v_lshlrev_b32 v80, 16, v72
    v_and_b32 v81, 0xffff0000, v72
    v_sub_f32 v64, v64, v80
    v_sub_f32 v65, v65, v81
    v_lshlrev_b32 v80, 16, v73
    v_and_b32 v81, 0xffff0000, v73
    v_sub_f32 v66, v66, v80
    v_sub_f32 v67, v67, v81
    v_lshlrev_b32 v80, 16, v74
    v_and_b32 v81, 0xffff0000, v74
    v_sub_f32 v68, v68, v80
    v_sub_f32 v69, v69, v81
    v_lshlrev_b32 v80, 16, v75
    v_and_b32 v81, 0xffff0000, v75
    v_sub_f32 v70, v70, v80
    v_sub_f32 v71, v71, v81
    v_cvt_pk_bf16_f32 v76, v64, v65
    v_cvt_pk_bf16_f32 v77, v66, v67
    v_cvt_pk_bf16_f32 v78, v68, v69
    v_cvt_pk_bf16_f32 v79, v70, v71
    v_cmp_lt_u32 vcc, 1, v123
    s_lshl_b32 s24, s3, 10
    v_add_u32 v114, s24, v121
    v_cndmask_b32 v72, v72, v76, vcc
    v_cndmask_b32 v73, v73, v77, vcc
    v_cndmask_b32 v74, v74, v78, vcc
    v_cndmask_b32 v75, v75, v79, vcc
    ds_write_b128 v114, v[72:75]
    v_lshrrev_b32 v112, 1, v123
    s_mov_b32 s24, 2097152
    v_mul_lo_u32 v112, v112, s24
    v_and_b32 v113, 1, v123
    v_lshl_add_u32 v112, v113, 8, v112
    v_and_b32 v113, 1, v122
    v_lshl_add_u32 v124, v113, 4, v112
    v_lshrrev_b32 v125, 1, v122
    s_mul_i32 s26, s3, 524288
    s_lshl_b32 s24, s11, 9
    s_add_u32 s26, s26, s24
    s_waitcnt lgkmcnt(0)
    s_barrier
    ds_read_b128 v[96:99], v121 offset:0
    ds_read_b128 v[100:103], v121 offset:1024
    ds_read_b128 v[104:107], v121 offset:2048
    ds_read_b128 v[108:111], v121 offset:3072
    s_mov_b32 s27, 0
    s_waitcnt vmcnt(0) lgkmcnt(0)
K1_W_LOOP:
    s_add_u32 s24, s11, s27
    s_and_b32 s30, s24, 3
    s_lshr_b32 s24, s24, 1
    s_and_b32 s24, s24, 4
    s_or_b32 s30, s30, s24
    v_xor_b32 v112, s30, v125
    v_lshl_add_u32 v120, v112, 5, v124
    s_lshl_b32 s25, s27, 9
    s_add_u32 s25, s25, s26
    v_perm_b32 v32, v4, v0, s28
    v_perm_b32 v36, v4, v0, s29
    v_perm_b32 v33, v12, v8, s28
    v_perm_b32 v37, v12, v8, s29
    v_perm_b32 v34, v20, v16, s28
    v_perm_b32 v38, v20, v16, s29
    v_perm_b32 v35, v28, v24, s28
    v_perm_b32 v39, v28, v24, s29
    v_perm_b32 v40, v5, v1, s28
    v_perm_b32 v44, v5, v1, s29
    v_perm_b32 v41, v13, v9, s28
    v_perm_b32 v45, v13, v9, s29
    v_perm_b32 v42, v21, v17, s28
    v_perm_b32 v46, v21, v17, s29
    v_perm_b32 v43, v29, v25, s28
    v_perm_b32 v47, v29, v25, s29
    v_perm_b32 v48, v6, v2, s28
    v_perm_b32 v52, v6, v2, s29
    v_perm_b32 v49, v14, v10, s28
    v_perm_b32 v53, v14, v10, s29
    v_perm_b32 v50, v22, v18, s28
    v_perm_b32 v54, v22, v18, s29
    v_perm_b32 v51, v30, v26, s28
    v_perm_b32 v55, v30, v26, s29
    v_perm_b32 v56, v7, v3, s28
    v_perm_b32 v60, v7, v3, s29
    v_perm_b32 v57, v15, v11, s28
    v_perm_b32 v61, v15, v11, s29
    v_perm_b32 v58, v23, v19, s28
    v_perm_b32 v62, v23, v19, s29
    v_perm_b32 v59, v31, v27, s28
    v_perm_b32 v63, v31, v27, s29
    s_add_u32 s27, s27, 1
    s_add_u32 s14, s14, 1024
    s_cmp_ge_u32 s27, 1
    s_cbranch_scc1 K1_W_NOLOAD
    s_mov_b32 s15, s14
    buffer_load_dwordx4 v[0:3], v126, s[16:19], s15 offen
    s_add_u32 s15, s15, 0x100000
    buffer_load_dwordx4 v[4:7], v126, s[16:19], s15 offen
    s_add_u32 s15, s15, 0x100000
    buffer_load_dwordx4 v[8:11], v126, s[16:19], s15 offen
    s_add_u32 s15, s15, 0x100000
    buffer_load_dwordx4 v[12:15], v126, s[16:19], s15 offen
    s_add_u32 s15, s15, 0x100000
    buffer_load_dwordx4 v[16:19], v126, s[16:19], s15 offen
    s_add_u32 s15, s15, 0x100000
    buffer_load_dwordx4 v[20:23], v126, s[16:19], s15 offen
    s_add_u32 s15, s15, 0x100000
    buffer_load_dwordx4 v[24:27], v126, s[16:19], s15 offen
    s_add_u32 s15, s15, 0x100000
    buffer_load_dwordx4 v[28:31], v126, s[16:19], s15 offen
K1_W_NOLOAD:
    v_mfma_f32_16x16x32_bf16 v[64:67], v[96:99], v[32:35], 0
    v_mfma_f32_16x16x32_bf16 v[68:71], v[96:99], v[36:39], 0
    v_mfma_f32_16x16x32_bf16 v[72:75], v[96:99], v[40:43], 0
    v_mfma_f32_16x16x32_bf16 v[76:79], v[96:99], v[44:47], 0
    v_mfma_f32_16x16x32_bf16 v[80:83], v[96:99], v[48:51], 0
    v_mfma_f32_16x16x32_bf16 v[84:87], v[96:99], v[52:55], 0
    v_mfma_f32_16x16x32_bf16 v[88:91], v[96:99], v[56:59], 0
    v_mfma_f32_16x16x32_bf16 v[92:95], v[96:99], v[60:63], 0
    s_nop 7
    v_cvt_pk_bf16_f32 v112, v64, v68
    v_cvt_pk_bf16_f32 v113, v72, v76
    v_cvt_pk_bf16_f32 v114, v80, v84
    v_cvt_pk_bf16_f32 v115, v88, v92
    buffer_store_dwordx4 v[112:115], v120, s[20:23], s25 offen
    s_add_u32 s25, s25, 4194304
    v_cvt_pk_bf16_f32 v116, v65, v69
    v_cvt_pk_bf16_f32 v117, v73, v77
    v_cvt_pk_bf16_f32 v118, v81, v85
    v_cvt_pk_bf16_f32 v119, v89, v93
    buffer_store_dwordx4 v[116:119], v120, s[20:23], s25 offen
    s_add_u32 s25, s25, 4194304
    v_cvt_pk_bf16_f32 v112, v66, v70
    v_cvt_pk_bf16_f32 v113, v74, v78
    v_cvt_pk_bf16_f32 v114, v82, v86
    v_cvt_pk_bf16_f32 v115, v90, v94
    buffer_store_dwordx4 v[112:115], v120, s[20:23], s25 offen
    s_add_u32 s25, s25, 4194304
    v_cvt_pk_bf16_f32 v116, v67, v71
    v_cvt_pk_bf16_f32 v117, v75, v79
    v_cvt_pk_bf16_f32 v118, v83, v87
    v_cvt_pk_bf16_f32 v119, v91, v95
    buffer_store_dwordx4 v[116:119], v120, s[20:23], s25 offen
    s_add_u32 s25, s25, 4194304
    v_mfma_f32_16x16x32_bf16 v[64:67], v[100:103], v[32:35], 0
    v_mfma_f32_16x16x32_bf16 v[68:71], v[100:103], v[36:39], 0
    v_mfma_f32_16x16x32_bf16 v[72:75], v[100:103], v[40:43], 0
    v_mfma_f32_16x16x32_bf16 v[76:79], v[100:103], v[44:47], 0
    v_mfma_f32_16x16x32_bf16 v[80:83], v[100:103], v[48:51], 0
    v_mfma_f32_16x16x32_bf16 v[84:87], v[100:103], v[52:55], 0
    v_mfma_f32_16x16x32_bf16 v[88:91], v[100:103], v[56:59], 0
    v_mfma_f32_16x16x32_bf16 v[92:95], v[100:103], v[60:63], 0
    s_nop 7
    v_cvt_pk_bf16_f32 v112, v64, v68
    v_cvt_pk_bf16_f32 v113, v72, v76
    v_cvt_pk_bf16_f32 v114, v80, v84
    v_cvt_pk_bf16_f32 v115, v88, v92
    buffer_store_dwordx4 v[112:115], v120, s[20:23], s25 offen
    s_add_u32 s25, s25, 4194304
    v_cvt_pk_bf16_f32 v116, v65, v69
    v_cvt_pk_bf16_f32 v117, v73, v77
    v_cvt_pk_bf16_f32 v118, v81, v85
    v_cvt_pk_bf16_f32 v119, v89, v93
    buffer_store_dwordx4 v[116:119], v120, s[20:23], s25 offen
    s_add_u32 s25, s25, 4194304
    v_cvt_pk_bf16_f32 v112, v66, v70
    v_cvt_pk_bf16_f32 v113, v74, v78
    v_cvt_pk_bf16_f32 v114, v82, v86
    v_cvt_pk_bf16_f32 v115, v90, v94
    buffer_store_dwordx4 v[112:115], v120, s[20:23], s25 offen
    s_add_u32 s25, s25, 4194304
    v_cvt_pk_bf16_f32 v116, v67, v71
    v_cvt_pk_bf16_f32 v117, v75, v79
    v_cvt_pk_bf16_f32 v118, v83, v87
    v_cvt_pk_bf16_f32 v119, v91, v95
    buffer_store_dwordx4 v[116:119], v120, s[20:23], s25 offen
    s_add_u32 s25, s25, 4194304
    v_mfma_f32_16x16x32_bf16 v[64:67], v[104:107], v[32:35], 0
    v_mfma_f32_16x16x32_bf16 v[68:71], v[104:107], v[36:39], 0
    v_mfma_f32_16x16x32_bf16 v[72:75], v[104:107], v[40:43], 0
    v_mfma_f32_16x16x32_bf16 v[76:79], v[104:107], v[44:47], 0
    v_mfma_f32_16x16x32_bf16 v[80:83], v[104:107], v[48:51], 0
    v_mfma_f32_16x16x32_bf16 v[84:87], v[104:107], v[52:55], 0
    v_mfma_f32_16x16x32_bf16 v[88:91], v[104:107], v[56:59], 0
    v_mfma_f32_16x16x32_bf16 v[92:95], v[104:107], v[60:63], 0
    s_nop 7
    v_cvt_pk_bf16_f32 v112, v64, v68
    v_cvt_pk_bf16_f32 v113, v72, v76
    v_cvt_pk_bf16_f32 v114, v80, v84
    v_cvt_pk_bf16_f32 v115, v88, v92
    buffer_store_dwordx4 v[112:115], v120, s[20:23], s25 offen
    s_add_u32 s25, s25, 4194304
    v_cvt_pk_bf16_f32 v116, v65, v69
    v_cvt_pk_bf16_f32 v117, v73, v77
    v_cvt_pk_bf16_f32 v118, v81, v85
    v_cvt_pk_bf16_f32 v119, v89, v93
    buffer_store_dwordx4 v[116:119], v120, s[20:23], s25 offen
    s_add_u32 s25, s25, 4194304
    v_cvt_pk_bf16_f32 v112, v66, v70
    v_cvt_pk_bf16_f32 v113, v74, v78
    v_cvt_pk_bf16_f32 v114, v82, v86
    v_cvt_pk_bf16_f32 v115, v90, v94
    buffer_store_dwordx4 v[112:115], v120, s[20:23], s25 offen
    s_add_u32 s25, s25, 4194304
    v_cvt_pk_bf16_f32 v116, v67, v71
    v_cvt_pk_bf16_f32 v117, v75, v79
    v_cvt_pk_bf16_f32 v118, v83, v87
    v_cvt_pk_bf16_f32 v119, v91, v95
    buffer_store_dwordx4 v[116:119], v120, s[20:23], s25 offen
    s_add_u32 s25, s25, 4194304
    v_mfma_f32_16x16x32_bf16 v[64:67], v[108:111], v[32:35], 0
    v_mfma_f32_16x16x32_bf16 v[68:71], v[108:111], v[36:39], 0
    v_mfma_f32_16x16x32_bf16 v[72:75], v[108:111], v[40:43], 0
    v_mfma_f32_16x16x32_bf16 v[76:79], v[108:111], v[44:47], 0
    v_mfma_f32_16x16x32_bf16 v[80:83], v[108:111], v[48:51], 0
    v_mfma_f32_16x16x32_bf16 v[84:87], v[108:111], v[52:55], 0
    v_mfma_f32_16x16x32_bf16 v[88:91], v[108:111], v[56:59], 0
    v_mfma_f32_16x16x32_bf16 v[92:95], v[108:111], v[60:63], 0
    s_nop 7
    v_cvt_pk_bf16_f32 v112, v64, v68
    v_cvt_pk_bf16_f32 v113, v72, v76
    v_cvt_pk_bf16_f32 v114, v80, v84
    v_cvt_pk_bf16_f32 v115, v88, v92
    buffer_store_dwordx4 v[112:115], v120, s[20:23], s25 offen
    s_add_u32 s25, s25, 4194304
    v_cvt_pk_bf16_f32 v116, v65, v69
    v_cvt_pk_bf16_f32 v117, v73, v77
    v_cvt_pk_bf16_f32 v118, v81, v85
    v_cvt_pk_bf16_f32 v119, v89, v93
    buffer_store_dwordx4 v[116:119], v120, s[20:23], s25 offen
    s_add_u32 s25, s25, 4194304
    v_cvt_pk_bf16_f32 v112, v66, v70
    v_cvt_pk_bf16_f32 v113, v74, v78
    v_cvt_pk_bf16_f32 v114, v82, v86
    v_cvt_pk_bf16_f32 v115, v90, v94
    buffer_store_dwordx4 v[112:115], v120, s[20:23], s25 offen
    s_add_u32 s25, s25, 4194304
    v_cvt_pk_bf16_f32 v116, v67, v71
    v_cvt_pk_bf16_f32 v117, v75, v79
    v_cvt_pk_bf16_f32 v118, v83, v87
    v_cvt_pk_bf16_f32 v119, v91, v95
    buffer_store_dwordx4 v[116:119], v120, s[20:23], s25 offen
    s_waitcnt vmcnt(16)
    s_cmp_lt_u32 s27, 1
    s_cbranch_scc1 K1_W_LOOP
K1_END:
    s_endpgm
.p2align 8
.type k12_fused_kernel,@function
k12_fused_kernel:
    s_cmp_ge_u32 s2, 256
    s_cbranch_scc1 K12_END
    s_load_dwordx4 s[52:55], s[0:1], 0
    s_load_dwordx4 s[56:59], s[0:1], 40
    s_getpc_b64 s[90:91]
CPF_K12:
    s_sub_u32 s90, s90, CPF_K12-k12_fused_kernel
    s_subb_u32 s91, s91, 0
    v_lshlrev_b32 v8, 7, v0
    v_mov_b32 v11, s91
    v_min_u32 v9, TEXT_END-k12_fused_kernel-4, v8
    v_add_co_u32 v10, vcc, s90, v9
    v_addc_co_u32 v11, vcc, 0, v11, vcc
    global_load_dword v63, v[10:11], off
    v_lshrrev_b32 v1, 6, v0
    v_and_b32 v2, 63, v0
    v_readfirstlane_b32 s3, v1
    s_waitcnt lgkmcnt(0)
    s_cmp_lt_u32 s3, 4
    s_cbranch_scc1 K12_CONS
    v_and_b32 v64, 15, v2
    v_lshrrev_b32 v65, 4, v2
    v_lshlrev_b32 v254, 4, v2
    s_and_b32 s44, s3, 3
    s_and_b32 s20, s44, 1
    s_lshr_b32 s21, s44, 1
    s_lshl_b32 s22, s2, 1
    s_add_u32 s22, s22, s21
    s_and_b32 s23, s22, 3
    s_lshr_b32 s22, s22, 2
    s_and_b32 s24, s2, 7
    s_lshl_b32 s24, s24, 5
    s_lshr_b32 s25, s2, 3
    s_add_u32 s24, s24, s25
    s_cmp_ge_u32 s24, 167
    s_cselect_b32 s25, 1, 0
    s_mul_i32 s26, s25, 167
    s_sub_u32 s24, s24, s26
    s_mov_b32 s49, s25
    s_cmp_eq_u32 s21, 0
    s_cselect_b32 s25, s25, 1
    s_mul_i32 s26, s25, 16384000
    s_add_u32 s4, s52, s26
    s_addc_u32 s5, s53, 0
    s_and_b32 s5, s5, 0xffff
    s_mov_b32 s6, 16384000
    s_mov_b32 s7, 0x00020000
    s_mov_b32 s8, s54
    s_mov_b32 s9, s55
    s_and_b32 s9, s9, 0xffff
    s_mov_b32 s10, 16252928
    s_mov_b32 s11, 0x00020000
    s_mov_b32 s12, s58
    s_mov_b32 s13, s59
    s_and_b32 s13, s13, 0xffff
    s_mov_b32 s14, 43778048
    s_mov_b32 s15, 0x00020000
    s_add_u32 s16, s58, 50331648
    s_addc_u32 s17, s59, 0
    s_and_b32 s17, s17, 0xffff
    s_mov_b32 s18, 67108864
    s_mov_b32 s19, 0x00020000
    s_add_u32 s60, s58, 153092096
    s_addc_u32 s61, s59, 0
    s_and_b32 s61, s61, 0xffff
    s_mov_b32 s62, 32768
    s_mov_b32 s63, 0x00020000
    s_mov_b32 s28, 0x05040100
    s_mov_b32 s29, 0x07060302
    v_lshlrev_b32 v248, 14, v65
    v_lshl_add_u32 v248, v64, 4, v248
    v_and_b32 v250, 1, v65
    v_lshlrev_b32 v250, 23, v250
    v_lshl_add_u32 v250, v64, 4, v250
    v_lshrrev_b32 v66, 1, v65
    s_mov_b32 s26, 1368064
    v_mul_lo_u32 v66, v66, s26
    v_lshrrev_b32 v67, 2, v64
    s_mov_b32 s26, 21376
    v_mul_lo_u32 v67, v67, s26
    v_add_u32 v66, v66, v67
    v_mov_b32 v252, v66
    v_lshrrev_b32 v66, 1, v65
    s_mov_b32 s26, 2097152
    v_mul_lo_u32 v66, v66, s26
    v_and_b32 v67, 1, v65
    v_lshl_add_u32 v66, v67, 8, v66
    v_and_b32 v67, 1, v64
    v_lshl_add_u32 v251, v67, 4, v66
    s_mul_i32 s31, s25, 684032
    s_mul_i32 s32, s23, 524288
    s_lshl_b32 s33, s23, 8
    s_mov_b32 s40, 3
    s_xor_b32 s43, s40, s20
    s_and_b32 s43, s43, 1
    s_mul_i32 s36, s40, 85
    s_add_u32 s36, s36, s2
    s_and_b32 s36, s36, 255
    s_mul_hi_u32 s37, s36, 0x55555556
    s_mul_i32 s38, s37, 3
    s_cmp_eq_u32 s38, s36
    s_cselect_b32 s27, 1, 0
    s_cmp_lt_u32 s37, 78
    s_cselect_b32 s27, s27, 0
    s_add_u32 s37, s37, 89
    s_add_u32 s26, s21, 1
    s_cmp_eq_u32 s27, 1
    s_cselect_b32 s26, 0, s26
    s_and_b32 s36, s27, s21
    s_cselect_b32 s30, s37, s24
    s_cselect_b32 s25, 1, s49
    s_mov_b32 s27, 1
    s_cmp_eq_u32 s43, 0
    s_cbranch_scc0 K12_PL1
    s_lshl_b32 s36, s40, 7
    s_add_u32 s36, s36, s22
    s_lshr_b32 s37, s36, 9
    s_lshl_b32 s37, s37, 19
    s_and_b32 s36, s36, 511
    s_lshl_b32 s36, s36, 10
    s_add_u32 s36, s36, s37
    s_add_u32 s36, s36, s33
    buffer_load_dwordx4 v[96:99], v250, s[8:11], s36 offen
    s_add_u32 s36, s36, 0x100000
    buffer_load_dwordx4 v[100:103], v250, s[8:11], s36 offen
    s_add_u32 s36, s36, 0x100000
    buffer_load_dwordx4 v[104:107], v250, s[8:11], s36 offen
    s_add_u32 s36, s36, 0x100000
    buffer_load_dwordx4 v[108:111], v250, s[8:11], s36 offen
    s_add_u32 s36, s36, 0x100000
    buffer_load_dwordx4 v[112:115], v250, s[8:11], s36 offen
    s_add_u32 s36, s36, 0x100000
    buffer_load_dwordx4 v[116:119], v250, s[8:11], s36 offen
    s_add_u32 s36, s36, 0x100000
    buffer_load_dwordx4 v[120:123], v250, s[8:11], s36 offen
    s_add_u32 s36, s36, 0x100000
    buffer_load_dwordx4 v[124:127], v250, s[8:11], s36 offen
    s_branch K12_PL2
K12_PL1:
    s_cmp_eq_u32 s27, 0
    s_cbranch_scc1 K12_PL2
    s_mul_i32 s36, s25, 16384000
    s_add_u32 s4, s52, s36
    s_addc_u32 s5, s53, 0
    s_and_b32 s5, s5, 0xffff
    s_lshl_b32 s36, s40, 8
    s_mul_i32 s37, s30, 98304
    s_add_u32 s36, s36, s37
    buffer_load_dwordx4 v[0:3], v248, s[4:7], s36 offen
    buffer_load_dwordx4 v[4:7], v248, s[4:7], s36 offen offset:2048
    s_add_u32 s36, s36, 4096
    buffer_load_dwordx4 v[8:11], v248, s[4:7], s36 offen
    buffer_load_dwordx4 v[12:15], v248, s[4:7], s36 offen offset:2048
    s_add_u32 s36, s36, 4096
    buffer_load_dwordx4 v[16:19], v248, s[4:7], s36 offen
    buffer_load_dwordx4 v[20:23], v248, s[4:7], s36 offen offset:2048
    s_add_u32 s36, s36, 4096
    buffer_load_dwordx4 v[24:27], v248, s[4:7], s36 offen
    buffer_load_dwordx4 v[28:31], v248, s[4:7], s36 offen offset:2048
    s_add_u32 s36, s36, 53248
    buffer_load_dwordx4 v[32:35], v248, s[4:7], s36 offen
    buffer_load_dwordx4 v[36:39], v248, s[4:7], s36 offen offset:2048
    s_add_u32 s36, s36, 4096
    buffer_load_dwordx4 v[40:43], v248, s[4:7], s36 offen
    buffer_load_dwordx4 v[44:47], v248, s[4:7], s36 offen offset:2048
    s_add_u32 s36, s36, 4096
    buffer_load_dwordx4 v[48:51], v248, s[4:7], s36 offen
    buffer_load_dwordx4 v[52:55], v248, s[4:7], s36 offen offset:2048
    s_add_u32 s36, s36, 4096
    buffer_load_dwordx4 v[56:59], v248, s[4:7], s36 offen
    buffer_load_dwordx4 v[60:63], v248, s[4:7], s36 offen offset:2048
K12_PL2:
    v_and_b32 v128, 3, v64
    v_lshlrev_b32 v128, 2, v128
    v_lshrrev_b32 v130, 3, v64
    v_lshl_add_u32 v128, v130, 1, v128
    s_lshl_b32 s36, s44, 4
    s_add_u32 s36, s36, 1
    v_add_u32 v128, s36, v128
    v_bfe_u32 v129, v64, 2, 1
    v_lshlrev_b32 v131, 3, v65
    v_lshlrev_b32 v132, 5, v129
    v_mad_u32_u24 v133, v128, v131, v132
    v_mad_u32_u24 v136, v128, 0, v133
    v_mad_u32_u24 v137, v128, 1, v133
    v_mad_u32_u24 v138, v128, 2, v133
    v_mad_u32_u24 v139, v128, 3, v133
    v_mad_u32_u24 v140, v128, 4, v133
    v_mad_u32_u24 v141, v128, 5, v133
    v_mad_u32_u24 v142, v128, 6, v133
    v_mad_u32_u24 v143, v128, 7, v133
    v_and_b32 v136, 127, v136
    v_and_b32 v137, 127, v137
    v_and_b32 v138, 127, v138
    v_and_b32 v139, 127, v139
    v_and_b32 v140, 127, v140
    v_and_b32 v141, 127, v141
    v_and_b32 v142, 127, v142
    v_and_b32 v143, 127, v143
    v_cvt_f32_u32 v136, v136
    v_cvt_f32_u32 v137, v137
    v_cvt_f32_u32 v138, v138
    v_cvt_f32_u32 v139, v139
    v_cvt_f32_u32 v140, v140
    v_cvt_f32_u32 v141, v141
    v_cvt_f32_u32 v142, v142
    v_cvt_f32_u32 v143, v143
    v_mul_f32 v136, 0x3c000000, v136
    v_mul_f32 v137, 0x3c000000, v137
    v_mul_f32 v138, 0x3c000000, v138
    v_mul_f32 v139, 0x3c000000, v139
    v_mul_f32 v140, 0x3c000000, v140
    v_mul_f32 v141, 0x3c000000, v141
    v_mul_f32 v142, 0x3c000000, v142
    v_mul_f32 v143, 0x3c000000, v143
    v_cos_f32 v136, v136
    v_cos_f32 v137, v137
    v_cos_f32 v138, v138
    v_cos_f32 v139, v139
    v_cos_f32 v140, v140
    v_cos_f32 v141, v141
    v_cos_f32 v142, v142
    v_cos_f32 v143, v143
    s_nop 0
    v_cvt_pk_bf16_f32 v144, v136, v137
    v_cvt_pk_bf16_f32 v145, v138, v139
    v_cvt_pk_bf16_f32 v146, v140, v141
    v_cvt_pk_bf16_f32 v147, v142, v143
    v_lshlrev_b32 v152, 16, v144
    v_and_b32 v153, 0xffff0000, v144
    v_sub_f32 v136, v136, v152
    v_sub_f32 v137, v137, v153
    v_lshlrev_b32 v152, 16, v145
    v_and_b32 v153, 0xffff0000, v145
    v_sub_f32 v138, v138, v152
    v_sub_f32 v139, v139, v153
    v_lshlrev_b32 v152, 16, v146
    v_and_b32 v153, 0xffff0000, v146
    v_sub_f32 v140, v140, v152
    v_sub_f32 v141, v141, v153
    v_lshlrev_b32 v152, 16, v147
    v_and_b32 v153, 0xffff0000, v147
    v_sub_f32 v142, v142, v152
    v_sub_f32 v143, v143, v153
    v_cvt_pk_bf16_f32 v148, v136, v137
    v_cvt_pk_bf16_f32 v149, v138, v139
    v_cvt_pk_bf16_f32 v150, v140, v141
    v_cvt_pk_bf16_f32 v151, v142, v143
    s_lshl_b32 s37, s44, 12
    s_add_u32 s37, s37, 116736
    v_add_u32 v132, s37, v254
    ds_write_b128 v132, v[144:147]
    ds_write_b128 v132, v[148:151] offset:1024
    v_add_u32 v131, 32, v131
    v_lshlrev_b32 v132, 5, v129
    v_mad_u32_u24 v133, v128, v131, v132
    v_mad_u32_u24 v136, v128, 0, v133
    v_mad_u32_u24 v137, v128, 1, v133
    v_mad_u32_u24 v138, v128, 2, v133
    v_mad_u32_u24 v139, v128, 3, v133
    v_mad_u32_u24 v140, v128, 4, v133
    v_mad_u32_u24 v141, v128, 5, v133
    v_mad_u32_u24 v142, v128, 6, v133
    v_mad_u32_u24 v143, v128, 7, v133
    v_and_b32 v136, 127, v136
    v_and_b32 v137, 127, v137
    v_and_b32 v138, 127, v138
    v_and_b32 v139, 127, v139
    v_and_b32 v140, 127, v140
    v_and_b32 v141, 127, v141
    v_and_b32 v142, 127, v142
    v_and_b32 v143, 127, v143
    v_cvt_f32_u32 v136, v136
    v_cvt_f32_u32 v137, v137
    v_cvt_f32_u32 v138, v138
    v_cvt_f32_u32 v139, v139
    v_cvt_f32_u32 v140, v140
    v_cvt_f32_u32 v141, v141
    v_cvt_f32_u32 v142, v142
    v_cvt_f32_u32 v143, v143
    v_mul_f32 v136, 0x3c000000, v136
    v_mul_f32 v137, 0x3c000000, v137
    v_mul_f32 v138, 0x3c000000, v138
    v_mul_f32 v139, 0x3c000000, v139
    v_mul_f32 v140, 0x3c000000, v140
    v_mul_f32 v141, 0x3c000000, v141
    v_mul_f32 v142, 0x3c000000, v142
    v_mul_f32 v143, 0x3c000000, v143
    v_cos_f32 v136, v136
    v_cos_f32 v137, v137
    v_cos_f32 v138, v138
    v_cos_f32 v139, v139
    v_cos_f32 v140, v140
    v_cos_f32 v141, v141
    v_cos_f32 v142, v142
    v_cos_f32 v143, v143
    s_nop 0
    v_cvt_pk_bf16_f32 v144, v136, v137
    v_cvt_pk_bf16_f32 v145, v138, v139
    v_cvt_pk_bf16_f32 v146, v140, v141
    v_cvt_pk_bf16_f32 v147, v142, v143
    v_lshlrev_b32 v152, 16, v144
    v_and_b32 v153, 0xffff0000, v144
    v_sub_f32 v136, v136, v152
    v_sub_f32 v137, v137, v153
    v_lshlrev_b32 v152, 16, v145
    v_and_b32 v153, 0xffff0000, v145
    v_sub_f32 v138, v138, v152
    v_sub_f32 v139, v139, v153
    v_lshlrev_b32 v152, 16, v146
    v_and_b32 v153, 0xffff0000, v146
    v_sub_f32 v140, v140, v152
    v_sub_f32 v141, v141, v153
    v_lshlrev_b32 v152, 16, v147
    v_and_b32 v153, 0xffff0000, v147
    v_sub_f32 v142, v142, v152
    v_sub_f32 v143, v143, v153
    v_cvt_pk_bf16_f32 v148, v136, v137
    v_cvt_pk_bf16_f32 v149, v138, v139
    v_cvt_pk_bf16_f32 v150, v140, v141
    v_cvt_pk_bf16_f32 v151, v142, v143
    s_lshl_b32 s37, s44, 12
    s_add_u32 s37, s37, 118784
    v_add_u32 v132, s37, v254
    ds_write_b128 v132, v[144:147]
    ds_write_b128 v132, v[148:151] offset:1024
K12_TB:
    s_waitcnt lgkmcnt(0)
    s_barrier
    v_add_u32 v255, 116736, v254
    ds_read_b128 v[160:163], v255 offset:0
    ds_read_b128 v[192:195], v255 offset:1024
    ds_read_b128 v[164:167], v255 offset:2048
    ds_read_b128 v[196:199], v255 offset:3072
    ds_read_b128 v[168:171], v255 offset:4096
    ds_read_b128 v[200:203], v255 offset:5120
    ds_read_b128 v[172:175], v255 offset:6144
    ds_read_b128 v[204:207], v255 offset:7168
    s_waitcnt lgkmcnt(0)
    ds_read_b128 v[176:179], v255 offset:8192
    ds_read_b128 v[208:211], v255 offset:9216
    ds_read_b128 v[180:183], v255 offset:10240
    ds_read_b128 v[212:215], v255 offset:11264
    ds_read_b128 v[184:187], v255 offset:12288
    ds_read_b128 v[216:219], v255 offset:13312
    ds_read_b128 v[188:191], v255 offset:14336
    ds_read_b128 v[220:223], v255 offset:15360
    ds_read_b128 v[224:227], v255 offset:16384
    ds_read_b128 v[228:231], v255 offset:17408
    ds_read_b128 v[232:235], v255 offset:18432
    ds_read_b128 v[236:239], v255 offset:19456
    s_waitcnt lgkmcnt(0)
    s_barrier
    s_waitcnt vmcnt(0) lgkmcnt(0)
    s_mov_b32 s41, -1
    s_mov_b32 s34, -1
K12_PROD:
    s_mov_b32 s37, 131072
K12_TW:
    v_mov_b32 v240, 155648
    ds_read_b32 v240, v240
    s_waitcnt lgkmcnt(0)
    v_cmp_gt_u32 vcc, 2, v240
    s_sub_u32 s37, s37, 1
    s_cmp_eq_u32 s37, 0
    s_cbranch_scc1 K12_TX
    s_cbranch_vccz K12_TX
    s_sleep 2
    s_branch K12_TW
K12_TX:
    v_lshrrev_b32 v128, 4, v254
    v_lshlrev_b32 v129, 11, v128
    v_lshrrev_b32 v130, 1, v128
    v_lshlrev_b32 v130, 20, v130
    v_and_b32 v131, 1, v128
    v_lshl_add_u32 v130, v131, 7, v130
    s_mov_b32 s45, s27
    s_mov_b32 s46, s30
    s_mov_b32 s50, s25
    s_mov_b32 s51, s26
    s_add_u32 s47, s40, 1
    s_add_u32 s75, s47, 8
    s_min_u32 s75, s75, 8
    s_cmp_ge_u32 s47, s75
    s_cbranch_scc1 K12_TCHE0
K12_TCH0:
    s_xor_b32 s48, s47, s20
    s_and_b32 s48, s48, 1
    s_cmp_eq_u32 s48, 0
    s_cbranch_scc1 K12_TCHW0
    s_mul_i32 s36, s47, 85
    s_add_u32 s36, s36, s2
    s_and_b32 s36, s36, 255
    s_mul_hi_u32 s37, s36, 0x55555556
    s_mul_i32 s38, s37, 3
    s_cmp_eq_u32 s38, s36
    s_cselect_b32 s27, 1, 0
    s_cmp_lt_u32 s37, 78
    s_cselect_b32 s27, s27, 0
    s_add_u32 s37, s37, 89
    s_add_u32 s26, s21, 1
    s_cmp_eq_u32 s27, 1
    s_cselect_b32 s26, 0, s26
    s_and_b32 s36, s27, s21
    s_cselect_b32 s30, s37, s24
    s_cselect_b32 s25, 1, s49
    s_mov_b32 s27, 1
    s_cmp_eq_u32 s26, 2
    s_cbranch_scc1 K12_TCHN0
    s_cmp_eq_u32 s27, 0
    s_cbranch_scc1 K12_TCHN0
    s_mul_i32 s36, s25, 16384000
    s_add_u32 s4, s52, s36
    s_addc_u32 s5, s53, 0
    s_and_b32 s5, s5, 0xffff
    s_lshl_b32 s36, s47, 8
    s_mul_i32 s37, s30, 98304
    s_add_u32 s36, s36, s37
    buffer_load_dword v244, v129, s[4:7], s36 offen
    buffer_load_dword v245, v129, s[4:7], s36 offen offset:128
    s_branch K12_TCHN0
K12_TCHW0:
    s_lshl_b32 s36, s47, 7
    s_add_u32 s36, s36, s22
    s_lshr_b32 s37, s36, 9
    s_lshl_b32 s37, s37, 19
    s_and_b32 s36, s36, 511
    s_lshl_b32 s36, s36, 10
    s_add_u32 s36, s36, s37
    s_add_u32 s36, s36, s33
    s_mov_b64 exec, 0xffffffff
    buffer_load_dword v246, v130, s[8:11], s36 offen
    s_mov_b64 exec, -1
K12_TCHN0:
    s_add_u32 s47, s47, 1
    s_cmp_lt_u32 s47, s75
    s_cbranch_scc1 K12_TCH0
K12_TCHE0:
    s_mov_b32 s27, s45
    s_mov_b32 s30, s46
    s_mov_b32 s25, s50
    s_mov_b32 s26, s51
    s_cmp_eq_u32 s43, 0
    s_cbranch_scc1 K12_WENTRY
K12_XW:
    s_waitcnt vmcnt(0)
    s_mov_b32 s34, -1
    s_cmp_ge_u32 s41, 8
    s_cbranch_scc1 K12_SG0
    s_lshl_b32 s36, s41, 2
    s_add_u32 s37, s36, 155680
    s_mov_b64 exec, 1
    v_mov_b32 v255, s37
    v_mov_b32 v240, 1
    ds_add_rtn_u32 v240, v255, v240
    s_waitcnt lgkmcnt(0)
    v_readfirstlane_b32 s37, v240
    s_nop 3
    s_cmp_eq_u32 s37, 3
    s_cbranch_scc0 K12_SH0
    s_lshl_b32 s36, s36, 8
    v_mov_b32 v255, 1
    v_mov_b32 v240, s36
    buffer_atomic_add v255, v240, s[60:63], 0 offen sc0 sc1
    s_mov_b32 s34, s41
K12_SH0:
    s_mov_b64 exec, -1
K12_SG0:
    s_cmp_ge_u32 s34, 8
    s_cbranch_scc1 K12_EP1
    s_waitcnt vmcnt(0)
    s_cmp_ge_u32 s34, 8
    s_cbranch_scc1 K12_PB2
    v_readfirstlane_b32 s37, v255
    s_nop 3
    s_cmp_eq_u32 s37, 255
    s_cbranch_scc0 K12_PB2
    s_lshl_b32 s36, s34, 4
    s_add_u32 s36, s36, 16384
    s_mov_b64 exec, 1
    v_mov_b32 v255, 1
    v_mov_b32 v240, s36
    buffer_store_dword v255, v240, s[60:63], 0 offen sc1
    s_mov_b64 exec, -1
K12_PB2:
    s_mov_b32 s34, -1
K12_EP1:
    s_cmp_eq_u32 s27, 0
    s_cbranch_scc1 K12_XP_N
    v_perm_b32 v64, v4, v0, s28
    v_perm_b32 v68, v4, v0, s29
    v_perm_b32 v65, v12, v8, s28
    v_perm_b32 v69, v12, v8, s29
    v_perm_b32 v66, v20, v16, s28
    v_perm_b32 v70, v20, v16, s29
    v_perm_b32 v67, v28, v24, s28
    v_perm_b32 v71, v28, v24, s29
    v_perm_b32 v72, v5, v1, s28
    v_perm_b32 v76, v5, v1, s29
    v_perm_b32 v73, v13, v9, s28
    v_perm_b32 v77, v13, v9, s29
    v_perm_b32 v74, v21, v17, s28
    v_perm_b32 v78, v21, v17, s29
    v_perm_b32 v75, v29, v25, s28
    v_perm_b32 v79, v29, v25, s29
    v_perm_b32 v80, v6, v2, s28
    v_perm_b32 v84, v6, v2, s29
    v_perm_b32 v81, v14, v10, s28
    v_perm_b32 v85, v14, v10, s29
    v_perm_b32 v82, v22, v18, s28
    v_perm_b32 v86, v22, v18, s29
    v_perm_b32 v83, v30, v26, s28
    v_perm_b32 v87, v30, v26, s29
    v_perm_b32 v88, v7, v3, s28
    v_perm_b32 v92, v7, v3, s29
    v_perm_b32 v89, v15, v11, s28
    v_perm_b32 v93, v15, v11, s29
    v_perm_b32 v90, v23, v19, s28
    v_perm_b32 v94, v23, v19, s29
    v_perm_b32 v91, v31, v27, s28
    v_perm_b32 v95, v31, v27, s29
    v_perm_b32 v0, v36, v32, s28
    v_perm_b32 v4, v36, v32, s29
    v_perm_b32 v1, v44, v40, s28
    v_perm_b32 v5, v44, v40, s29
    v_perm_b32 v2, v52, v48, s28
    v_perm_b32 v6, v52, v48, s29
    v_perm_b32 v3, v60, v56, s28
    v_perm_b32 v7, v60, v56, s29
    v_perm_b32 v8, v37, v33, s28
    v_perm_b32 v12, v37, v33, s29
    v_perm_b32 v9, v45, v41, s28
    v_perm_b32 v13, v45, v41, s29
    v_perm_b32 v10, v53, v49, s28
    v_perm_b32 v14, v53, v49, s29
    v_perm_b32 v11, v61, v57, s28
    v_perm_b32 v15, v61, v57, s29
    v_perm_b32 v16, v38, v34, s28
    v_perm_b32 v20, v38, v34, s29
    v_perm_b32 v17, v46, v42, s28
    v_perm_b32 v21, v46, v42, s29
    v_perm_b32 v18, v54, v50, s28
    v_perm_b32 v22, v54, v50, s29
    v_perm_b32 v19, v62, v58, s28
    v_perm_b32 v23, v62, v58, s29
    v_perm_b32 v24, v39, v35, s28
    v_perm_b32 v28, v39, v35, s29
    v_perm_b32 v25, v47, v43, s28
    v_perm_b32 v29, v47, v43, s29
    v_perm_b32 v26, v55, v51, s28
    v_perm_b32 v30, v55, v51, s29
    v_perm_b32 v27, v63, v59, s28
    v_perm_b32 v31, v63, v59, s29
K12_XP_N:
    s_lshl_b32 s36, s40, 3
    s_sub_i32 s36, s36, 24
    s_max_i32 s36, s36, 1
    s_mov_b32 s37, 131072
K12_GL0:
    v_mov_b32 v240, 155648
    ds_read_b32 v240, v240
    s_waitcnt lgkmcnt(0)
    v_cmp_gt_u32 vcc, s36, v240
    s_sub_u32 s37, s37, 1
    s_cmp_eq_u32 s37, 0
    s_cbranch_scc1 K12_GT0
    s_cbranch_vccz K12_GT0
    s_sleep 2
    s_branch K12_GL0
K12_GT0:
    s_lshl_b32 s36, s40, 2
    s_add_u32 s36, s36, 155840
    s_mov_b64 exec, 1
    v_mov_b32 v240, s36
    v_mov_b32 v241, 1
    ds_add_u32 v240, v241
    s_mov_b64 exec, -1
    s_mov_b32 s37, 131072
K12_BL0:
    v_mov_b32 v240, s36
    ds_read_b32 v240, v240
    s_waitcnt lgkmcnt(0)
    v_cmp_gt_u32 vcc, 4, v240
    s_sub_u32 s37, s37, 1
    s_cmp_eq_u32 s37, 0
    s_cbranch_scc1 K12_BT0
    s_cbranch_vccz K12_BT0
    s_sleep 1
    s_branch K12_BL0
K12_BT0:
    s_add_u32 s42, s40, 1
    s_lshl_b32 s36, s42, 7
    s_add_u32 s36, s36, s22
    s_lshr_b32 s37, s36, 9
    s_lshl_b32 s37, s37, 19
    s_and_b32 s36, s36, 511
    s_lshl_b32 s36, s36, 10
    s_add_u32 s36, s36, s37
    s_add_u32 s36, s36, s33
    buffer_load_dwordx4 v[96:99], v250, s[8:11], s36 offen
    s_add_u32 s36, s36, 0x100000
    buffer_load_dwordx4 v[100:103], v250, s[8:11], s36 offen
    s_add_u32 s36, s36, 0x100000
    buffer_load_dwordx4 v[104:107], v250, s[8:11], s36 offen
    s_add_u32 s36, s36, 0x100000
    buffer_load_dwordx4 v[108:111], v250, s[8:11], s36 offen
    s_add_u32 s36, s36, 0x100000
    buffer_load_dwordx4 v[112:115], v250, s[8:11], s36 offen
    s_add_u32 s36, s36, 0x100000
    buffer_load_dwordx4 v[116:119], v250, s[8:11], s36 offen
    s_add_u32 s36, s36, 0x100000
    buffer_load_dwordx4 v[120:123], v250, s[8:11], s36 offen
    s_add_u32 s36, s36, 0x100000
    buffer_load_dwordx4 v[124:127], v250, s[8:11], s36 offen
    s_cmp_eq_u32 s27, 0
    s_cbranch_scc1 K12_XP_E
    s_mul_i32 s31, s25, 684032
    s_mul_i32 s39, s40, 85504
    s_add_u32 s39, s39, s31
    s_lshl_b32 s36, s30, 7
    s_add_u32 s39, s39, s36
    v_bfe_u32 v249, v254, 4, 2
    v_bfe_u32 v240, v254, 8, 1
    v_lshl_add_u32 v249, v240, 2, v249
    s_add_u32 s36, s30, 7
    s_cmp_ge_u32 s30, 160
    s_cselect_b32 s36, s36, s30
    s_cmp_eq_u32 s25, 1
    s_cselect_b32 s36, s36, s30
    s_lshr_b32 s36, s36, 1
    s_and_b32 s36, s36, 7
    v_xor_b32 v249, s36, v249
    v_lshl_add_u32 v249, v249, 4, v252
    s_cmp_eq_u32 s26, 2
    s_cselect_b32 s36, 21889024, 0
    s_add_u32 s39, s39, s36
    s_cmp_eq_u32 s26, 2
    s_cbranch_scc1 K12_XS1602_HI
    s_setprio 1
    v_mfma_f32_16x16x32_bf16 v[32:35], v[160:163], v[64:67], 0
    v_mfma_f32_16x16x32_bf16 v[36:39], v[160:163], v[68:71], 0
    v_mfma_f32_16x16x32_bf16 v[40:43], v[160:163], v[72:75], 0
    v_mfma_f32_16x16x32_bf16 v[44:47], v[160:163], v[76:79], 0
    v_mfma_f32_16x16x32_bf16 v[48:51], v[160:163], v[80:83], 0
    v_mfma_f32_16x16x32_bf16 v[52:55], v[160:163], v[84:87], 0
    v_mfma_f32_16x16x32_bf16 v[56:59], v[160:163], v[88:91], 0
    v_mfma_f32_16x16x32_bf16 v[60:63], v[160:163], v[92:95], 0
    v_mfma_f32_16x16x32_bf16 v[32:35], v[192:195], v[64:67], v[32:35]
    v_mfma_f32_16x16x32_bf16 v[36:39], v[192:195], v[68:71], v[36:39]
    v_mfma_f32_16x16x32_bf16 v[40:43], v[192:195], v[72:75], v[40:43]
    v_mfma_f32_16x16x32_bf16 v[44:47], v[192:195], v[76:79], v[44:47]
    v_mfma_f32_16x16x32_bf16 v[48:51], v[192:195], v[80:83], v[48:51]
    v_mfma_f32_16x16x32_bf16 v[52:55], v[192:195], v[84:87], v[52:55]
    v_mfma_f32_16x16x32_bf16 v[56:59], v[192:195], v[88:91], v[56:59]
    v_mfma_f32_16x16x32_bf16 v[60:63], v[192:195], v[92:95], v[60:63]
    v_mfma_f32_16x16x32_bf16 v[32:35], v[164:167], v[0:3], v[32:35]
    v_mfma_f32_16x16x32_bf16 v[36:39], v[164:167], v[4:7], v[36:39]
    v_mfma_f32_16x16x32_bf16 v[40:43], v[164:167], v[8:11], v[40:43]
    v_mfma_f32_16x16x32_bf16 v[44:47], v[164:167], v[12:15], v[44:47]
    v_mfma_f32_16x16x32_bf16 v[48:51], v[164:167], v[16:19], v[48:51]
    v_mfma_f32_16x16x32_bf16 v[52:55], v[164:167], v[20:23], v[52:55]
    v_mfma_f32_16x16x32_bf16 v[56:59], v[164:167], v[24:27], v[56:59]
    v_mfma_f32_16x16x32_bf16 v[60:63], v[164:167], v[28:31], v[60:63]
    v_mfma_f32_16x16x32_bf16 v[32:35], v[196:199], v[0:3], v[32:35]
    v_mfma_f32_16x16x32_bf16 v[36:39], v[196:199], v[4:7], v[36:39]
    v_mfma_f32_16x16x32_bf16 v[40:43], v[196:199], v[8:11], v[40:43]
    v_mfma_f32_16x16x32_bf16 v[44:47], v[196:199], v[12:15], v[44:47]
    v_mfma_f32_16x16x32_bf16 v[48:51], v[196:199], v[16:19], v[48:51]
    v_mfma_f32_16x16x32_bf16 v[52:55], v[196:199], v[20:23], v[52:55]
    v_mfma_f32_16x16x32_bf16 v[56:59], v[196:199], v[24:27], v[56:59]
    v_mfma_f32_16x16x32_bf16 v[60:63], v[196:199], v[28:31], v[60:63]
    s_setprio 0
    s_nop 7
    v_cvt_pk_bf16_f32 v240, v32, v36
    v_cvt_pk_bf16_f32 v241, v40, v44
    v_cvt_pk_bf16_f32 v242, v48, v52
    v_cvt_pk_bf16_f32 v243, v56, v60
    buffer_store_dwordx4 v[240:243], v249, s[12:15], s39 offen sc1
    s_add_u32 s39, s39, 2736128
    v_cvt_pk_bf16_f32 v244, v33, v37
    v_cvt_pk_bf16_f32 v245, v41, v45
    v_cvt_pk_bf16_f32 v246, v49, v53
    v_cvt_pk_bf16_f32 v247, v57, v61
    buffer_store_dwordx4 v[244:247], v249, s[12:15], s39 offen sc1
    s_add_u32 s39, s39, 2736128
    v_cvt_pk_bf16_f32 v240, v34, v38
    v_cvt_pk_bf16_f32 v241, v42, v46
    v_cvt_pk_bf16_f32 v242, v50, v54
    v_cvt_pk_bf16_f32 v243, v58, v62
    buffer_store_dwordx4 v[240:243], v249, s[12:15], s39 offen sc1
    s_add_u32 s39, s39, 2736128
    v_cvt_pk_bf16_f32 v244, v35, v39
    v_cvt_pk_bf16_f32 v245, v43, v47
    v_cvt_pk_bf16_f32 v246, v51, v55
    v_cvt_pk_bf16_f32 v247, v59, v63
    buffer_store_dwordx4 v[244:247], v249, s[12:15], s39 offen sc1
    s_add_u32 s39, s39, 2736128
    s_cmp_lg_u32 s26, 1
    s_cbranch_scc1 K12_UT0
    s_cmp_lt_u32 s40, 4
    s_cbranch_scc1 K12_UT0
    s_lshl_b32 s36, s40, 3
    s_sub_i32 s36, s36, 20
    s_max_i32 s36, s36, 1
    s_mov_b32 s37, 131072
K12_UL0:
    v_mov_b32 v255, 155648
    ds_read_b32 v255, v255
    s_waitcnt lgkmcnt(0)
    v_cmp_gt_u32 vcc, s36, v255
    s_sub_u32 s37, s37, 1
    s_cmp_eq_u32 s37, 0
    s_cbranch_scc1 K12_UT0
    s_cbranch_vccz K12_UT0
    s_sleep 2
    s_branch K12_UL0
K12_UT0:
    s_setprio 1
    v_mfma_f32_16x16x32_bf16 v[32:35], v[168:171], v[64:67], 0
    v_mfma_f32_16x16x32_bf16 v[36:39], v[168:171], v[68:71], 0
    v_mfma_f32_16x16x32_bf16 v[40:43], v[168:171], v[72:75], 0
    v_mfma_f32_16x16x32_bf16 v[44:47], v[168:171], v[76:79], 0
    v_mfma_f32_16x16x32_bf16 v[48:51], v[168:171], v[80:83], 0
    v_mfma_f32_16x16x32_bf16 v[52:55], v[168:171], v[84:87], 0
    v_mfma_f32_16x16x32_bf16 v[56:59], v[168:171], v[88:91], 0
    v_mfma_f32_16x16x32_bf16 v[60:63], v[168:171], v[92:95], 0
    v_mfma_f32_16x16x32_bf16 v[32:35], v[200:203], v[64:67], v[32:35]
    v_mfma_f32_16x16x32_bf16 v[36:39], v[200:203], v[68:71], v[36:39]
    v_mfma_f32_16x16x32_bf16 v[40:43], v[200:203], v[72:75], v[40:43]
    v_mfma_f32_16x16x32_bf16 v[44:47], v[200:203], v[76:79], v[44:47]
    v_mfma_f32_16x16x32_bf16 v[48:51], v[200:203], v[80:83], v[48:51]
    v_mfma_f32_16x16x32_bf16 v[52:55], v[200:203], v[84:87], v[52:55]
    v_mfma_f32_16x16x32_bf16 v[56:59], v[200:203], v[88:91], v[56:59]
    v_mfma_f32_16x16x32_bf16 v[60:63], v[200:203], v[92:95], v[60:63]
    v_mfma_f32_16x16x32_bf16 v[32:35], v[172:175], v[0:3], v[32:35]
    v_mfma_f32_16x16x32_bf16 v[36:39], v[172:175], v[4:7], v[36:39]
    v_mfma_f32_16x16x32_bf16 v[40:43], v[172:175], v[8:11], v[40:43]
    v_mfma_f32_16x16x32_bf16 v[44:47], v[172:175], v[12:15], v[44:47]
    v_mfma_f32_16x16x32_bf16 v[48:51], v[172:175], v[16:19], v[48:51]
    v_mfma_f32_16x16x32_bf16 v[52:55], v[172:175], v[20:23], v[52:55]
    v_mfma_f32_16x16x32_bf16 v[56:59], v[172:175], v[24:27], v[56:59]
    v_mfma_f32_16x16x32_bf16 v[60:63], v[172:175], v[28:31], v[60:63]
    v_mfma_f32_16x16x32_bf16 v[32:35], v[204:207], v[0:3], v[32:35]
    v_mfma_f32_16x16x32_bf16 v[36:39], v[204:207], v[4:7], v[36:39]
    v_mfma_f32_16x16x32_bf16 v[40:43], v[204:207], v[8:11], v[40:43]
    v_mfma_f32_16x16x32_bf16 v[44:47], v[204:207], v[12:15], v[44:47]
    v_mfma_f32_16x16x32_bf16 v[48:51], v[204:207], v[16:19], v[48:51]
    v_mfma_f32_16x16x32_bf16 v[52:55], v[204:207], v[20:23], v[52:55]
    v_mfma_f32_16x16x32_bf16 v[56:59], v[204:207], v[24:27], v[56:59]
    v_mfma_f32_16x16x32_bf16 v[60:63], v[204:207], v[28:31], v[60:63]
    s_setprio 0
    s_nop 7
    v_cvt_pk_bf16_f32 v240, v32, v36
    v_cvt_pk_bf16_f32 v241, v40, v44
    v_cvt_pk_bf16_f32 v242, v48, v52
    v_cvt_pk_bf16_f32 v243, v56, v60
    buffer_store_dwordx4 v[240:243], v249, s[12:15], s39 offen sc1
    s_add_u32 s39, s39, 2736128
    v_cvt_pk_bf16_f32 v244, v33, v37
    v_cvt_pk_bf16_f32 v245, v41, v45
    v_cvt_pk_bf16_f32 v246, v49, v53
    v_cvt_pk_bf16_f32 v247, v57, v61
    buffer_store_dwordx4 v[244:247], v249, s[12:15], s39 offen sc1
    s_add_u32 s39, s39, 2736128
    v_cvt_pk_bf16_f32 v240, v34, v38
    v_cvt_pk_bf16_f32 v241, v42, v46
    v_cvt_pk_bf16_f32 v242, v50, v54
    v_cvt_pk_bf16_f32 v243, v58, v62
    buffer_store_dwordx4 v[240:243], v249, s[12:15], s39 offen sc1
    s_add_u32 s39, s39, 2736128
    v_cvt_pk_bf16_f32 v244, v35, v39
    v_cvt_pk_bf16_f32 v245, v43, v47
    v_cvt_pk_bf16_f32 v246, v51, v55
    v_cvt_pk_bf16_f32 v247, v59, v63
    buffer_store_dwordx4 v[244:247], v249, s[12:15], s39 offen sc1
    s_add_u32 s39, s39, 2736128
    s_cmp_eq_u32 s26, 1
    s_cbranch_scc1 K12_XS1602_END
    s_cmp_lg_u32 s26, 0
    s_cbranch_scc1 K12_UT1
    s_cmp_lt_u32 s40, 4
    s_cbranch_scc1 K12_UT1
    s_lshl_b32 s36, s40, 3
    s_sub_i32 s36, s36, 20
    s_max_i32 s36, s36, 1
    s_mov_b32 s37, 131072
K12_UL1:
    v_mov_b32 v255, 155648
    ds_read_b32 v255, v255
    s_waitcnt lgkmcnt(0)
    v_cmp_gt_u32 vcc, s36, v255
    s_sub_u32 s37, s37, 1
    s_cmp_eq_u32 s37, 0
    s_cbranch_scc1 K12_UT1
    s_cbranch_vccz K12_UT1
    s_sleep 2
    s_branch K12_UL1
K12_UT1:
K12_XS1602_HI:
    s_setprio 1
    v_mfma_f32_16x16x32_bf16 v[32:35], v[176:179], v[64:67], 0
    v_mfma_f32_16x16x32_bf16 v[36:39], v[176:179], v[68:71], 0
    v_mfma_f32_16x16x32_bf16 v[40:43], v[176:179], v[72:75], 0
    v_mfma_f32_16x16x32_bf16 v[44:47], v[176:179], v[76:79], 0
    v_mfma_f32_16x16x32_bf16 v[48:51], v[176:179], v[80:83], 0
    v_mfma_f32_16x16x32_bf16 v[52:55], v[176:179], v[84:87], 0
    v_mfma_f32_16x16x32_bf16 v[56:59], v[176:179], v[88:91], 0
    v_mfma_f32_16x16x32_bf16 v[60:63], v[176:179], v[92:95], 0
    v_mfma_f32_16x16x32_bf16 v[32:35], v[208:211], v[64:67], v[32:35]
    v_mfma_f32_16x16x32_bf16 v[36:39], v[208:211], v[68:71], v[36:39]
    v_mfma_f32_16x16x32_bf16 v[40:43], v[208:211], v[72:75], v[40:43]
    v_mfma_f32_16x16x32_bf16 v[44:47], v[208:211], v[76:79], v[44:47]
    v_mfma_f32_16x16x32_bf16 v[48:51], v[208:211], v[80:83], v[48:51]
    v_mfma_f32_16x16x32_bf16 v[52:55], v[208:211], v[84:87], v[52:55]
    v_mfma_f32_16x16x32_bf16 v[56:59], v[208:211], v[88:91], v[56:59]
    v_mfma_f32_16x16x32_bf16 v[60:63], v[208:211], v[92:95], v[60:63]
    v_mfma_f32_16x16x32_bf16 v[32:35], v[180:183], v[0:3], v[32:35]
    v_mfma_f32_16x16x32_bf16 v[36:39], v[180:183], v[4:7], v[36:39]
    v_mfma_f32_16x16x32_bf16 v[40:43], v[180:183], v[8:11], v[40:43]
    v_mfma_f32_16x16x32_bf16 v[44:47], v[180:183], v[12:15], v[44:47]
    v_mfma_f32_16x16x32_bf16 v[48:51], v[180:183], v[16:19], v[48:51]
    v_mfma_f32_16x16x32_bf16 v[52:55], v[180:183], v[20:23], v[52:55]
    v_mfma_f32_16x16x32_bf16 v[56:59], v[180:183], v[24:27], v[56:59]
    v_mfma_f32_16x16x32_bf16 v[60:63], v[180:183], v[28:31], v[60:63]
    v_mfma_f32_16x16x32_bf16 v[32:35], v[212:215], v[0:3], v[32:35]
    v_mfma_f32_16x16x32_bf16 v[36:39], v[212:215], v[4:7], v[36:39]
    v_mfma_f32_16x16x32_bf16 v[40:43], v[212:215], v[8:11], v[40:43]
    v_mfma_f32_16x16x32_bf16 v[44:47], v[212:215], v[12:15], v[44:47]
    v_mfma_f32_16x16x32_bf16 v[48:51], v[212:215], v[16:19], v[48:51]
    v_mfma_f32_16x16x32_bf16 v[52:55], v[212:215], v[20:23], v[52:55]
    v_mfma_f32_16x16x32_bf16 v[56:59], v[212:215], v[24:27], v[56:59]
    v_mfma_f32_16x16x32_bf16 v[60:63], v[212:215], v[28:31], v[60:63]
    s_setprio 0
    s_nop 7
    v_cvt_pk_bf16_f32 v240, v32, v36
    v_cvt_pk_bf16_f32 v241, v40, v44
    v_cvt_pk_bf16_f32 v242, v48, v52
    v_cvt_pk_bf16_f32 v243, v56, v60
    buffer_store_dwordx4 v[240:243], v249, s[12:15], s39 offen sc1
    s_add_u32 s39, s39, 2736128
    v_cvt_pk_bf16_f32 v244, v33, v37
    v_cvt_pk_bf16_f32 v245, v41, v45
    v_cvt_pk_bf16_f32 v246, v49, v53
    v_cvt_pk_bf16_f32 v247, v57, v61
    buffer_store_dwordx4 v[244:247], v249, s[12:15], s39 offen sc1
    s_add_u32 s39, s39, 2736128
    v_cvt_pk_bf16_f32 v240, v34, v38
    v_cvt_pk_bf16_f32 v241, v42, v46
    v_cvt_pk_bf16_f32 v242, v50, v54
    v_cvt_pk_bf16_f32 v243, v58, v62
    buffer_store_dwordx4 v[240:243], v249, s[12:15], s39 offen sc1
    s_add_u32 s39, s39, 2736128
    v_cvt_pk_bf16_f32 v244, v35, v39
    v_cvt_pk_bf16_f32 v245, v43, v47
    v_cvt_pk_bf16_f32 v246, v51, v55
    v_cvt_pk_bf16_f32 v247, v59, v63
    buffer_store_dwordx4 v[244:247], v249, s[12:15], s39 offen sc1
    s_add_u32 s39, s39, 2736128
    s_cmp_lg_u32 s26, 2
    s_cbranch_scc1 K12_UT2
    s_cmp_lt_u32 s40, 4
    s_cbranch_scc1 K12_UT2
    s_lshl_b32 s36, s40, 3
    s_sub_i32 s36, s36, 20
    s_max_i32 s36, s36, 1
    s_mov_b32 s37, 131072
K12_UL2:
    v_mov_b32 v255, 155648
    ds_read_b32 v255, v255
    s_waitcnt lgkmcnt(0)
    v_cmp_gt_u32 vcc, s36, v255
    s_sub_u32 s37, s37, 1
    s_cmp_eq_u32 s37, 0
    s_cbranch_scc1 K12_UT2
    s_cbranch_vccz K12_UT2
    s_sleep 2
    s_branch K12_UL2
K12_UT2:
    s_setprio 1
    v_mfma_f32_16x16x32_bf16 v[32:35], v[184:187], v[64:67], 0
    v_mfma_f32_16x16x32_bf16 v[36:39], v[184:187], v[68:71], 0
    v_mfma_f32_16x16x32_bf16 v[40:43], v[184:187], v[72:75], 0
    v_mfma_f32_16x16x32_bf16 v[44:47], v[184:187], v[76:79], 0
    v_mfma_f32_16x16x32_bf16 v[48:51], v[184:187], v[80:83], 0
    v_mfma_f32_16x16x32_bf16 v[52:55], v[184:187], v[84:87], 0
    v_mfma_f32_16x16x32_bf16 v[56:59], v[184:187], v[88:91], 0
    v_mfma_f32_16x16x32_bf16 v[60:63], v[184:187], v[92:95], 0
    v_mfma_f32_16x16x32_bf16 v[32:35], v[216:219], v[64:67], v[32:35]
    v_mfma_f32_16x16x32_bf16 v[36:39], v[216:219], v[68:71], v[36:39]
    v_mfma_f32_16x16x32_bf16 v[40:43], v[216:219], v[72:75], v[40:43]
    v_mfma_f32_16x16x32_bf16 v[44:47], v[216:219], v[76:79], v[44:47]
    v_mfma_f32_16x16x32_bf16 v[48:51], v[216:219], v[80:83], v[48:51]
    v_mfma_f32_16x16x32_bf16 v[52:55], v[216:219], v[84:87], v[52:55]
    v_mfma_f32_16x16x32_bf16 v[56:59], v[216:219], v[88:91], v[56:59]
    v_mfma_f32_16x16x32_bf16 v[60:63], v[216:219], v[92:95], v[60:63]
    v_mfma_f32_16x16x32_bf16 v[32:35], v[188:191], v[0:3], v[32:35]
    v_mfma_f32_16x16x32_bf16 v[36:39], v[188:191], v[4:7], v[36:39]
    v_mfma_f32_16x16x32_bf16 v[40:43], v[188:191], v[8:11], v[40:43]
    v_mfma_f32_16x16x32_bf16 v[44:47], v[188:191], v[12:15], v[44:47]
    v_mfma_f32_16x16x32_bf16 v[48:51], v[188:191], v[16:19], v[48:51]
    v_mfma_f32_16x16x32_bf16 v[52:55], v[188:191], v[20:23], v[52:55]
    v_mfma_f32_16x16x32_bf16 v[56:59], v[188:191], v[24:27], v[56:59]
    v_mfma_f32_16x16x32_bf16 v[60:63], v[188:191], v[28:31], v[60:63]
    v_mfma_f32_16x16x32_bf16 v[32:35], v[220:223], v[0:3], v[32:35]
    v_mfma_f32_16x16x32_bf16 v[36:39], v[220:223], v[4:7], v[36:39]
    v_mfma_f32_16x16x32_bf16 v[40:43], v[220:223], v[8:11], v[40:43]
    v_mfma_f32_16x16x32_bf16 v[44:47], v[220:223], v[12:15], v[44:47]
    v_mfma_f32_16x16x32_bf16 v[48:51], v[220:223], v[16:19], v[48:51]
    v_mfma_f32_16x16x32_bf16 v[52:55], v[220:223], v[20:23], v[52:55]
    v_mfma_f32_16x16x32_bf16 v[56:59], v[220:223], v[24:27], v[56:59]
    v_mfma_f32_16x16x32_bf16 v[60:63], v[220:223], v[28:31], v[60:63]
    s_setprio 0
    s_nop 7
    v_cvt_pk_bf16_f32 v240, v32, v36
    v_cvt_pk_bf16_f32 v241, v40, v44
    v_cvt_pk_bf16_f32 v242, v48, v52
    v_cvt_pk_bf16_f32 v243, v56, v60
    buffer_store_dwordx4 v[240:243], v249, s[12:15], s39 offen sc1
    s_add_u32 s39, s39, 2736128
    v_cvt_pk_bf16_f32 v244, v33, v37
    v_cvt_pk_bf16_f32 v245, v41, v45
    v_cvt_pk_bf16_f32 v246, v49, v53
    v_cvt_pk_bf16_f32 v247, v57, v61
    buffer_store_dwordx4 v[244:247], v249, s[12:15], s39 offen sc1
    s_add_u32 s39, s39, 2736128
    v_cvt_pk_bf16_f32 v240, v34, v38
    v_cvt_pk_bf16_f32 v241, v42, v46
    v_cvt_pk_bf16_f32 v242, v50, v54
    v_cvt_pk_bf16_f32 v243, v58, v62
    buffer_store_dwordx4 v[240:243], v249, s[12:15], s39 offen sc1
    s_add_u32 s39, s39, 2736128
    v_cvt_pk_bf16_f32 v244, v35, v39
    v_cvt_pk_bf16_f32 v245, v43, v47
    v_cvt_pk_bf16_f32 v246, v51, v55
    v_cvt_pk_bf16_f32 v247, v59, v63
    buffer_store_dwordx4 v[244:247], v249, s[12:15], s39 offen sc1
K12_XS1602_END:
    s_mov_b32 s41, s40
    s_add_u32 s40, s40, 1
    s_cmp_eq_u32 s41, 3
    s_cbranch_scc0 K12_ES3
    s_waitcnt vmcnt(0)
    s_mov_b32 s34, -1
    s_cmp_ge_u32 s41, 8
    s_cbranch_scc1 K12_SG4
    s_lshl_b32 s36, s41, 2
    s_add_u32 s37, s36, 155680
    s_mov_b64 exec, 1
    v_mov_b32 v255, s37
    v_mov_b32 v240, 1
    ds_add_rtn_u32 v240, v255, v240
    s_waitcnt lgkmcnt(0)
    v_readfirstlane_b32 s37, v240
    s_nop 3
    s_cmp_eq_u32 s37, 3
    s_cbranch_scc0 K12_SH4
    s_lshl_b32 s36, s36, 8
    v_mov_b32 v255, 1
    v_mov_b32 v240, s36
    buffer_atomic_add v255, v240, s[60:63], 0 offen sc0 sc1
    s_mov_b32 s34, s41
K12_SH4:
    s_mov_b64 exec, -1
K12_SG4:
    s_waitcnt vmcnt(0)
    s_cmp_ge_u32 s34, 8
    s_cbranch_scc1 K12_PB5
    v_readfirstlane_b32 s37, v255
    s_nop 3
    s_cmp_eq_u32 s37, 255
    s_cbranch_scc0 K12_PB5
    s_lshl_b32 s36, s34, 4
    s_add_u32 s36, s36, 16384
    s_mov_b64 exec, 1
    v_mov_b32 v255, 1
    v_mov_b32 v240, s36
    buffer_store_dword v255, v240, s[60:63], 0 offen sc1
    s_mov_b64 exec, -1
K12_PB5:
    s_mov_b32 s34, -1
    s_mov_b32 s41, -1
K12_ES3:
    s_waitcnt vmcnt(8)
    s_branch K12_XP_F
K12_XP_E:
    s_mov_b32 s41, s40
    s_add_u32 s40, s40, 1
    s_cmp_eq_u32 s41, 3
    s_cbranch_scc0 K12_ES6
    s_waitcnt vmcnt(0)
    s_mov_b32 s34, -1
    s_cmp_ge_u32 s41, 8
    s_cbranch_scc1 K12_SG7
    s_lshl_b32 s36, s41, 2
    s_add_u32 s37, s36, 155680
    s_mov_b64 exec, 1
    v_mov_b32 v255, s37
    v_mov_b32 v240, 1
    ds_add_rtn_u32 v240, v255, v240
    s_waitcnt lgkmcnt(0)
    v_readfirstlane_b32 s37, v240
    s_nop 3
    s_cmp_eq_u32 s37, 3
    s_cbranch_scc0 K12_SH7
    s_lshl_b32 s36, s36, 8
    v_mov_b32 v255, 1
    v_mov_b32 v240, s36
    buffer_atomic_add v255, v240, s[60:63], 0 offen sc0 sc1
    s_mov_b32 s34, s41
K12_SH7:
    s_mov_b64 exec, -1
K12_SG7:
    s_waitcnt vmcnt(0)
    s_cmp_ge_u32 s34, 8
    s_cbranch_scc1 K12_PB8
    v_readfirstlane_b32 s37, v255
    s_nop 3
    s_cmp_eq_u32 s37, 255
    s_cbranch_scc0 K12_PB8
    s_lshl_b32 s36, s34, 4
    s_add_u32 s36, s36, 16384
    s_mov_b64 exec, 1
    v_mov_b32 v255, 1
    v_mov_b32 v240, s36
    buffer_store_dword v255, v240, s[60:63], 0 offen sc1
    s_mov_b64 exec, -1
K12_PB8:
    s_mov_b32 s34, -1
    s_mov_b32 s41, -1
K12_ES6:
    s_waitcnt vmcnt(0)
K12_XP_F:
    s_cmp_ge_u32 s34, 8
    s_cbranch_scc1 K12_PB9
    v_readfirstlane_b32 s37, v255
    s_nop 3
    s_cmp_eq_u32 s37, 255
    s_cbranch_scc0 K12_PB9
    s_lshl_b32 s36, s34, 4
    s_add_u32 s36, s36, 16384
    s_mov_b64 exec, 1
    v_mov_b32 v255, 1
    v_mov_b32 v240, s36
    buffer_store_dword v255, v240, s[60:63], 0 offen sc1
    s_mov_b64 exec, -1
K12_PB9:
    s_cmp_ge_u32 s40, 8
    s_cbranch_scc1 K12_PFIN
K12_WENTRY:
    s_waitcnt vmcnt(0)
    s_mov_b32 s34, -1
    s_cmp_ge_u32 s41, 8
    s_cbranch_scc1 K12_SG10
    s_lshl_b32 s36, s41, 2
    s_add_u32 s37, s36, 155680
    s_mov_b64 exec, 1
    v_mov_b32 v255, s37
    v_mov_b32 v240, 1
    ds_add_rtn_u32 v240, v255, v240
    s_waitcnt lgkmcnt(0)
    v_readfirstlane_b32 s37, v240
    s_nop 3
    s_cmp_eq_u32 s37, 3
    s_cbranch_scc0 K12_SH10
    s_lshl_b32 s36, s36, 8
    v_mov_b32 v255, 1
    v_mov_b32 v240, s36
    buffer_atomic_add v255, v240, s[60:63], 0 offen sc0 sc1
    s_mov_b32 s34, s41
K12_SH10:
    s_mov_b64 exec, -1
K12_SG10:
    s_cmp_ge_u32 s34, 8
    s_cbranch_scc1 K12_EP11
    s_waitcnt vmcnt(0)
    s_cmp_ge_u32 s34, 8
    s_cbranch_scc1 K12_PB12
    v_readfirstlane_b32 s37, v255
    s_nop 3
    s_cmp_eq_u32 s37, 255
    s_cbranch_scc0 K12_PB12
    s_lshl_b32 s36, s34, 4
    s_add_u32 s36, s36, 16384
    s_mov_b64 exec, 1
    v_mov_b32 v255, 1
    v_mov_b32 v240, s36
    buffer_store_dword v255, v240, s[60:63], 0 offen sc1
    s_mov_b64 exec, -1
K12_PB12:
    s_mov_b32 s34, -1
K12_EP11:
    v_perm_b32 v64, v100, v96, s28
    v_perm_b32 v68, v100, v96, s29
    v_perm_b32 v65, v108, v104, s28
    v_perm_b32 v69, v108, v104, s29
    v_perm_b32 v66, v116, v112, s28
    v_perm_b32 v70, v116, v112, s29
    v_perm_b32 v67, v124, v120, s28
    v_perm_b32 v71, v124, v120, s29
    v_perm_b32 v72, v101, v97, s28
    v_perm_b32 v76, v101, v97, s29
    v_perm_b32 v73, v109, v105, s28
    v_perm_b32 v77, v109, v105, s29
    v_perm_b32 v74, v117, v113, s28
    v_perm_b32 v78, v117, v113, s29
    v_perm_b32 v75, v125, v121, s28
    v_perm_b32 v79, v125, v121, s29
    v_perm_b32 v80, v102, v98, s28
    v_perm_b32 v84, v102, v98, s29
    v_perm_b32 v81, v110, v106, s28
    v_perm_b32 v85, v110, v106, s29
    v_perm_b32 v82, v118, v114, s28
    v_perm_b32 v86, v118, v114, s29
    v_perm_b32 v83, v126, v122, s28
    v_perm_b32 v87, v126, v122, s29
    v_perm_b32 v88, v103, v99, s28
    v_perm_b32 v92, v103, v99, s29
    v_perm_b32 v89, v111, v107, s28
    v_perm_b32 v93, v111, v107, s29
    v_perm_b32 v90, v119, v115, s28
    v_perm_b32 v94, v119, v115, s29
    v_perm_b32 v91, v127, v123, s28
    v_perm_b32 v95, v127, v123, s29
    s_lshl_b32 s36, s40, 3
    s_sub_i32 s36, s36, 24
    s_max_i32 s36, s36, 1
    s_mov_b32 s37, 131072
K12_GL1:
    v_mov_b32 v240, 155648
    ds_read_b32 v240, v240
    s_waitcnt lgkmcnt(0)
    v_cmp_gt_u32 vcc, s36, v240
    s_sub_u32 s37, s37, 1
    s_cmp_eq_u32 s37, 0
    s_cbranch_scc1 K12_GT1
    s_cbranch_vccz K12_GT1
    s_sleep 2
    s_branch K12_GL1
K12_GT1:
    s_lshl_b32 s36, s40, 2
    s_add_u32 s36, s36, 155840
    s_mov_b64 exec, 1
    v_mov_b32 v240, s36
    v_mov_b32 v241, 1
    ds_add_u32 v240, v241
    s_mov_b64 exec, -1
    s_mov_b32 s37, 131072
K12_BL1:
    v_mov_b32 v240, s36
    ds_read_b32 v240, v240
    s_waitcnt lgkmcnt(0)
    v_cmp_gt_u32 vcc, 4, v240
    s_sub_u32 s37, s37, 1
    s_cmp_eq_u32 s37, 0
    s_cbranch_scc1 K12_BT1
    s_cbranch_vccz K12_BT1
    s_sleep 1
    s_branch K12_BL1
K12_BT1:
    s_add_u32 s42, s40, 1
    s_mul_i32 s36, s42, 85
    s_add_u32 s36, s36, s2
    s_and_b32 s36, s36, 255
    s_mul_hi_u32 s37, s36, 0x55555556
    s_mul_i32 s38, s37, 3
    s_cmp_eq_u32 s38, s36
    s_cselect_b32 s27, 1, 0
    s_cmp_lt_u32 s37, 78
    s_cselect_b32 s27, s27, 0
    s_add_u32 s37, s37, 89
    s_add_u32 s26, s21, 1
    s_cmp_eq_u32 s27, 1
    s_cselect_b32 s26, 0, s26
    s_and_b32 s36, s27, s21
    s_cselect_b32 s30, s37, s24
    s_cselect_b32 s25, 1, s49
    s_mov_b32 s27, 1
    s_cmp_eq_u32 s27, 0
    s_cbranch_scc1 K12_WP_N
    s_mul_i32 s36, s25, 16384000
    s_add_u32 s4, s52, s36
    s_addc_u32 s5, s53, 0
    s_and_b32 s5, s5, 0xffff
    s_lshl_b32 s36, s42, 8
    s_mul_i32 s37, s30, 98304
    s_add_u32 s36, s36, s37
    buffer_load_dwordx4 v[0:3], v248, s[4:7], s36 offen
    buffer_load_dwordx4 v[4:7], v248, s[4:7], s36 offen offset:2048
    s_add_u32 s36, s36, 4096
    buffer_load_dwordx4 v[8:11], v248, s[4:7], s36 offen
    buffer_load_dwordx4 v[12:15], v248, s[4:7], s36 offen offset:2048
    s_add_u32 s36, s36, 4096
    buffer_load_dwordx4 v[16:19], v248, s[4:7], s36 offen
    buffer_load_dwordx4 v[20:23], v248, s[4:7], s36 offen offset:2048
    s_add_u32 s36, s36, 4096
    buffer_load_dwordx4 v[24:27], v248, s[4:7], s36 offen
    buffer_load_dwordx4 v[28:31], v248, s[4:7], s36 offen offset:2048
    s_add_u32 s36, s36, 53248
    buffer_load_dwordx4 v[32:35], v248, s[4:7], s36 offen
    buffer_load_dwordx4 v[36:39], v248, s[4:7], s36 offen offset:2048
    s_add_u32 s36, s36, 4096
    buffer_load_dwordx4 v[40:43], v248, s[4:7], s36 offen
    buffer_load_dwordx4 v[44:47], v248, s[4:7], s36 offen offset:2048
    s_add_u32 s36, s36, 4096
    buffer_load_dwordx4 v[48:51], v248, s[4:7], s36 offen
    buffer_load_dwordx4 v[52:55], v248, s[4:7], s36 offen offset:2048
    s_add_u32 s36, s36, 4096
    buffer_load_dwordx4 v[56:59], v248, s[4:7], s36 offen
    buffer_load_dwordx4 v[60:63], v248, s[4:7], s36 offen offset:2048
    s_branch K12_WP_M
K12_WP_N:
K12_WP_M:
    s_lshl_b32 s36, s40, 7
    s_add_u32 s36, s36, s22
    s_and_b32 s37, s36, 3
    s_lshr_b32 s38, s36, 1
    s_and_b32 s38, s38, 4
    s_or_b32 s37, s37, s38
    v_bfe_u32 v253, v254, 5, 3
    v_xor_b32 v253, s37, v253
    v_lshl_add_u32 v253, v253, 5, v251
    s_lshl_b32 s36, s36, 9
    s_add_u32 s39, s36, s32
    s_setprio 1
    v_mfma_f32_16x16x32_bf16 v[128:131], v[224:227], v[64:67], 0
    v_mfma_f32_16x16x32_bf16 v[132:135], v[224:227], v[68:71], 0
    v_mfma_f32_16x16x32_bf16 v[136:139], v[224:227], v[72:75], 0
    v_mfma_f32_16x16x32_bf16 v[140:143], v[224:227], v[76:79], 0
    v_mfma_f32_16x16x32_bf16 v[144:147], v[224:227], v[80:83], 0
    v_mfma_f32_16x16x32_bf16 v[148:151], v[224:227], v[84:87], 0
    v_mfma_f32_16x16x32_bf16 v[152:155], v[224:227], v[88:91], 0
    v_mfma_f32_16x16x32_bf16 v[156:159], v[224:227], v[92:95], 0
    s_setprio 0
    s_nop 7
    v_cvt_pk_bf16_f32 v240, v128, v132
    v_cvt_pk_bf16_f32 v241, v136, v140
    v_cvt_pk_bf16_f32 v242, v144, v148
    v_cvt_pk_bf16_f32 v243, v152, v156
    buffer_store_dwordx4 v[240:243], v253, s[16:19], s39 offen sc1
    s_add_u32 s39, s39, 4194304
    v_cvt_pk_bf16_f32 v244, v129, v133
    v_cvt_pk_bf16_f32 v245, v137, v141
    v_cvt_pk_bf16_f32 v246, v145, v149
    v_cvt_pk_bf16_f32 v247, v153, v157
    buffer_store_dwordx4 v[244:247], v253, s[16:19], s39 offen sc1
    s_add_u32 s39, s39, 4194304
    v_cvt_pk_bf16_f32 v240, v130, v134
    v_cvt_pk_bf16_f32 v241, v138, v142
    v_cvt_pk_bf16_f32 v242, v146, v150
    v_cvt_pk_bf16_f32 v243, v154, v158
    buffer_store_dwordx4 v[240:243], v253, s[16:19], s39 offen sc1
    s_add_u32 s39, s39, 4194304
    v_cvt_pk_bf16_f32 v244, v131, v135
    v_cvt_pk_bf16_f32 v245, v139, v143
    v_cvt_pk_bf16_f32 v246, v147, v151
    v_cvt_pk_bf16_f32 v247, v155, v159
    buffer_store_dwordx4 v[244:247], v253, s[16:19], s39 offen sc1
    s_add_u32 s39, s39, 4194304
    s_setprio 1
    v_mfma_f32_16x16x32_bf16 v[128:131], v[228:231], v[64:67], 0
    v_mfma_f32_16x16x32_bf16 v[132:135], v[228:231], v[68:71], 0
    v_mfma_f32_16x16x32_bf16 v[136:139], v[228:231], v[72:75], 0
    v_mfma_f32_16x16x32_bf16 v[140:143], v[228:231], v[76:79], 0
    v_mfma_f32_16x16x32_bf16 v[144:147], v[228:231], v[80:83], 0
    v_mfma_f32_16x16x32_bf16 v[148:151], v[228:231], v[84:87], 0
    v_mfma_f32_16x16x32_bf16 v[152:155], v[228:231], v[88:91], 0
    v_mfma_f32_16x16x32_bf16 v[156:159], v[228:231], v[92:95], 0
    s_setprio 0
    s_nop 7
    v_cvt_pk_bf16_f32 v240, v128, v132
    v_cvt_pk_bf16_f32 v241, v136, v140
    v_cvt_pk_bf16_f32 v242, v144, v148
    v_cvt_pk_bf16_f32 v243, v152, v156
    buffer_store_dwordx4 v[240:243], v253, s[16:19], s39 offen sc1
    s_add_u32 s39, s39, 4194304
    v_cvt_pk_bf16_f32 v244, v129, v133
    v_cvt_pk_bf16_f32 v245, v137, v141
    v_cvt_pk_bf16_f32 v246, v145, v149
    v_cvt_pk_bf16_f32 v247, v153, v157
    buffer_store_dwordx4 v[244:247], v253, s[16:19], s39 offen sc1
    s_add_u32 s39, s39, 4194304
    v_cvt_pk_bf16_f32 v240, v130, v134
    v_cvt_pk_bf16_f32 v241, v138, v142
    v_cvt_pk_bf16_f32 v242, v146, v150
    v_cvt_pk_bf16_f32 v243, v154, v158
    buffer_store_dwordx4 v[240:243], v253, s[16:19], s39 offen sc1
    s_add_u32 s39, s39, 4194304
    v_cvt_pk_bf16_f32 v244, v131, v135
    v_cvt_pk_bf16_f32 v245, v139, v143
    v_cvt_pk_bf16_f32 v246, v147, v151
    v_cvt_pk_bf16_f32 v247, v155, v159
    buffer_store_dwordx4 v[244:247], v253, s[16:19], s39 offen sc1
    s_add_u32 s39, s39, 4194304
    s_cmp_lt_u32 s40, 4
    s_cbranch_scc1 K12_UT3
    s_lshl_b32 s36, s40, 3
    s_sub_i32 s36, s36, 20
    s_max_i32 s36, s36, 1
    s_mov_b32 s37, 131072
K12_UL3:
    v_mov_b32 v255, 155648
    ds_read_b32 v255, v255
    s_waitcnt lgkmcnt(0)
    v_cmp_gt_u32 vcc, s36, v255
    s_sub_u32 s37, s37, 1
    s_cmp_eq_u32 s37, 0
    s_cbranch_scc1 K12_UT3
    s_cbranch_vccz K12_UT3
    s_sleep 2
    s_branch K12_UL3
K12_UT3:
    s_setprio 1
    v_mfma_f32_16x16x32_bf16 v[128:131], v[232:235], v[64:67], 0
    v_mfma_f32_16x16x32_bf16 v[132:135], v[232:235], v[68:71], 0
    v_mfma_f32_16x16x32_bf16 v[136:139], v[232:235], v[72:75], 0
    v_mfma_f32_16x16x32_bf16 v[140:143], v[232:235], v[76:79], 0
    v_mfma_f32_16x16x32_bf16 v[144:147], v[232:235], v[80:83], 0
    v_mfma_f32_16x16x32_bf16 v[148:151], v[232:235], v[84:87], 0
    v_mfma_f32_16x16x32_bf16 v[152:155], v[232:235], v[88:91], 0
    v_mfma_f32_16x16x32_bf16 v[156:159], v[232:235], v[92:95], 0
    s_setprio 0
    s_nop 7
    v_cvt_pk_bf16_f32 v240, v128, v132
    v_cvt_pk_bf16_f32 v241, v136, v140
    v_cvt_pk_bf16_f32 v242, v144, v148
    v_cvt_pk_bf16_f32 v243, v152, v156
    buffer_store_dwordx4 v[240:243], v253, s[16:19], s39 offen sc1
    s_add_u32 s39, s39, 4194304
    v_cvt_pk_bf16_f32 v244, v129, v133
    v_cvt_pk_bf16_f32 v245, v137, v141
    v_cvt_pk_bf16_f32 v246, v145, v149
    v_cvt_pk_bf16_f32 v247, v153, v157
    buffer_store_dwordx4 v[244:247], v253, s[16:19], s39 offen sc1
    s_add_u32 s39, s39, 4194304
    v_cvt_pk_bf16_f32 v240, v130, v134
    v_cvt_pk_bf16_f32 v241, v138, v142
    v_cvt_pk_bf16_f32 v242, v146, v150
    v_cvt_pk_bf16_f32 v243, v154, v158
    buffer_store_dwordx4 v[240:243], v253, s[16:19], s39 offen sc1
    s_add_u32 s39, s39, 4194304
    v_cvt_pk_bf16_f32 v244, v131, v135
    v_cvt_pk_bf16_f32 v245, v139, v143
    v_cvt_pk_bf16_f32 v246, v147, v151
    v_cvt_pk_bf16_f32 v247, v155, v159
    buffer_store_dwordx4 v[244:247], v253, s[16:19], s39 offen sc1
    s_add_u32 s39, s39, 4194304
    s_setprio 1
    v_mfma_f32_16x16x32_bf16 v[128:131], v[236:239], v[64:67], 0
    v_mfma_f32_16x16x32_bf16 v[132:135], v[236:239], v[68:71], 0
    v_mfma_f32_16x16x32_bf16 v[136:139], v[236:239], v[72:75], 0
    v_mfma_f32_16x16x32_bf16 v[140:143], v[236:239], v[76:79], 0
    v_mfma_f32_16x16x32_bf16 v[144:147], v[236:239], v[80:83], 0
    v_mfma_f32_16x16x32_bf16 v[148:151], v[236:239], v[84:87], 0
    v_mfma_f32_16x16x32_bf16 v[152:155], v[236:239], v[88:91], 0
    v_mfma_f32_16x16x32_bf16 v[156:159], v[236:239], v[92:95], 0
    s_setprio 0
    s_nop 7
    v_cvt_pk_bf16_f32 v240, v128, v132
    v_cvt_pk_bf16_f32 v241, v136, v140
    v_cvt_pk_bf16_f32 v242, v144, v148
    v_cvt_pk_bf16_f32 v243, v152, v156
    buffer_store_dwordx4 v[240:243], v253, s[16:19], s39 offen sc1
    s_add_u32 s39, s39, 4194304
    v_cvt_pk_bf16_f32 v244, v129, v133
    v_cvt_pk_bf16_f32 v245, v137, v141
    v_cvt_pk_bf16_f32 v246, v145, v149
    v_cvt_pk_bf16_f32 v247, v153, v157
    buffer_store_dwordx4 v[244:247], v253, s[16:19], s39 offen sc1
    s_add_u32 s39, s39, 4194304
    v_cvt_pk_bf16_f32 v240, v130, v134
    v_cvt_pk_bf16_f32 v241, v138, v142
    v_cvt_pk_bf16_f32 v242, v146, v150
    v_cvt_pk_bf16_f32 v243, v154, v158
    buffer_store_dwordx4 v[240:243], v253, s[16:19], s39 offen sc1
    s_add_u32 s39, s39, 4194304
    v_cvt_pk_bf16_f32 v244, v131, v135
    v_cvt_pk_bf16_f32 v245, v139, v143
    v_cvt_pk_bf16_f32 v246, v147, v151
    v_cvt_pk_bf16_f32 v247, v155, v159
    buffer_store_dwordx4 v[244:247], v253, s[16:19], s39 offen sc1
    s_mov_b32 s41, s40
    s_add_u32 s40, s40, 1
    s_cmp_eq_u32 s41, 3
    s_cbranch_scc0 K12_ES13
    s_waitcnt vmcnt(0)
    s_mov_b32 s34, -1
    s_cmp_ge_u32 s41, 8
    s_cbranch_scc1 K12_SG14
    s_lshl_b32 s36, s41, 2
    s_add_u32 s37, s36, 155680
    s_mov_b64 exec, 1
    v_mov_b32 v255, s37
    v_mov_b32 v240, 1
    ds_add_rtn_u32 v240, v255, v240
    s_waitcnt lgkmcnt(0)
    v_readfirstlane_b32 s37, v240
    s_nop 3
    s_cmp_eq_u32 s37, 3
    s_cbranch_scc0 K12_SH14
    s_lshl_b32 s36, s36, 8
    v_mov_b32 v255, 1
    v_mov_b32 v240, s36
    buffer_atomic_add v255, v240, s[60:63], 0 offen sc0 sc1
    s_mov_b32 s34, s41
K12_SH14:
    s_mov_b64 exec, -1
K12_SG14:
    s_waitcnt vmcnt(0)
    s_cmp_ge_u32 s34, 8
    s_cbranch_scc1 K12_PB15
    v_readfirstlane_b32 s37, v255
    s_nop 3
    s_cmp_eq_u32 s37, 255
    s_cbranch_scc0 K12_PB15
    s_lshl_b32 s36, s34, 4
    s_add_u32 s36, s36, 16384
    s_mov_b64 exec, 1
    v_mov_b32 v255, 1
    v_mov_b32 v240, s36
    buffer_store_dword v255, v240, s[60:63], 0 offen sc1
    s_mov_b64 exec, -1
K12_PB15:
    s_mov_b32 s34, -1
    s_mov_b32 s41, -1
K12_ES13:
    s_waitcnt vmcnt(16)
    s_cmp_ge_u32 s34, 8
    s_cbranch_scc1 K12_PB16
    v_readfirstlane_b32 s37, v255
    s_nop 3
    s_cmp_eq_u32 s37, 255
    s_cbranch_scc0 K12_PB16
    s_lshl_b32 s36, s34, 4
    s_add_u32 s36, s36, 16384
    s_mov_b64 exec, 1
    v_mov_b32 v255, 1
    v_mov_b32 v240, s36
    buffer_store_dword v255, v240, s[60:63], 0 offen sc1
    s_mov_b64 exec, -1
K12_PB16:
    s_cmp_lt_u32 s40, 8
    s_cbranch_scc1 K12_XW
K12_PFIN:
    s_waitcnt vmcnt(0)
    s_mov_b32 s34, -1
    s_cmp_ge_u32 s41, 8
    s_cbranch_scc1 K12_SG17
    s_lshl_b32 s36, s41, 2
    s_add_u32 s37, s36, 155680
    s_mov_b64 exec, 1
    v_mov_b32 v255, s37
    v_mov_b32 v240, 1
    ds_add_rtn_u32 v240, v255, v240
    s_waitcnt lgkmcnt(0)
    v_readfirstlane_b32 s37, v240
    s_nop 3
    s_cmp_eq_u32 s37, 3
    s_cbranch_scc0 K12_SH17
    s_lshl_b32 s36, s36, 8
    v_mov_b32 v255, 1
    v_mov_b32 v240, s36
    buffer_atomic_add v255, v240, s[60:63], 0 offen sc0 sc1
    s_mov_b32 s34, s41
K12_SH17:
    s_mov_b64 exec, -1
K12_SG17:
    s_waitcnt vmcnt(0)
    s_cmp_ge_u32 s34, 8
    s_cbranch_scc1 K12_PB18
    v_readfirstlane_b32 s37, v255
    s_nop 3
    s_cmp_eq_u32 s37, 255
    s_cbranch_scc0 K12_PB18
    s_lshl_b32 s36, s34, 4
    s_add_u32 s36, s36, 16384
    s_mov_b64 exec, 1
    v_mov_b32 v255, 1
    v_mov_b32 v240, s36
    buffer_store_dword v255, v240, s[60:63], 0 offen sc1
    s_mov_b64 exec, -1
K12_PB18:
    s_endpgm
K12_CONS:
    s_and_b32 s6, s2, 7
    s_lshl_b32 s6, s6, 2
    s_lshr_b32 s7, s2, 6
    s_add_u32 s6, s6, s7
    s_mov_b32 s51, s6
    s_mov_b32 s27, s6
    s_lshr_b32 s7, s2, 3
    s_and_b32 s7, s7, 7
    s_lshr_b32 s20, s7, 2
    s_and_b32 s21, s7, 3
    s_lshl_b32 s22, s6, 1
    s_add_u32 s22, s22, s20
    s_lshl_b32 s23, s6, 2
    s_add_u32 s23, s23, s21
    s_mul_i32 s24, s22, 684032
    s_mul_i32 s25, s23, 524288
    s_add_u32 s25, s25, 50331648
    s_mul_i32 s26, s22, 342016
    s_add_u32 s26, s26, 118489088
    s_add_u32 s8, s58, s24
    s_addc_u32 s9, s59, 0
    s_and_b32 s9, s9, 0xffff
    s_mov_b32 s10, 684032
    s_mov_b32 s11, 0x00020000
    s_add_u32 s12, s58, s25
    s_addc_u32 s13, s59, 0
    s_and_b32 s13, s13, 0xffff
    s_mov_b32 s14, 524288
    s_mov_b32 s15, 0x00020000
    s_add_u32 s16, s58, s26
    s_addc_u32 s17, s59, 0
    s_and_b32 s17, s17, 0xffff
    s_mov_b32 s18, 342016
    s_mov_b32 s19, 0x00020000
    s_add_u32 s4, s58, 153108480
    s_addc_u32 s5, s59, 0
    s_and_b32 s5, s5, 0xffff
    s_cmp_eq_u32 s3, 0
    s_cselect_b32 s6, 128, 0
    s_mov_b32 s7, 0x00020000
    s_mov_b32 s46, 155712
    s_cselect_b32 s46, s46, 155776
    s_mov_b32 s47, 155712
    s_cselect_b32 s47, s47, 155744
    s_cselect_b32 s45, 4, 0
    s_mov_b32 s50, s45
    v_and_b32 v8, 15, v2
    v_lshrrev_b32 v9, 4, v2
    v_lshlrev_b32 v1, 4, v2
    s_mul_i32 s30, s3, 5120
    s_mov_b32 s36, s30
    s_lshl_b32 s31, s3, 12
    s_add_u32 s37, s31, 22528
    s_lshr_b32 s28, s3, 1
    s_and_b32 s29, s3, 1
    s_lshl_b32 s33, s29, 9
    s_add_u32 s33, s33, 20480
    s_mul_i32 s38, s28, 896
    s_add_u32 s38, s38, s33
    s_lshl_b32 s34, s51, 1
    s_add_u32 s34, s34, s28
    s_mul_i32 s34, s34, 684032
    s_add_u32 s64, s58, s34
    s_addc_u32 s65, s59, 0
    s_and_b32 s65, s65, 0xffff
    s_mov_b32 s66, 684032
    s_mov_b32 s67, 0x00020000
    s_mov_b32 s44, 0xffffff
    s_cmp_eq_u32 s29, 0
    s_cselect_b32 s44, -1, s44
    s_mov_b32 s45, 0
    v_lshrrev_b32 v10, 1, v8
    v_xor_b32 v10, v10, v9
    v_lshlrev_b32 v10, 4, v10
    v_lshl_add_u32 v2, v8, 7, v10
    v_xor_b32 v3, 64, v2
    v_lshrrev_b32 v10, 2, v8
    v_lshl_add_u32 v11, v9, 3, v10
    v_lshlrev_b32 v11, 9, v11
    v_and_b32 v12, 1, v9
    v_lshl_or_b32 v10, v12, 2, v10
    s_lshl_b32 s28, s3, 1
    v_xor_b32 v10, s28, v10
    v_lshl_add_u32 v11, v10, 5, v11
    v_and_b32 v10, 3, v8
    v_lshl_add_u32 v11, v10, 3, v11
    v_add_u32 v4, 22528, v11
    s_lshl_b32 s28, s20, 5
    v_xor_b32 v4, s28, v4
    v_and_b32 v10, 3, v8
    v_lshlrev_b32 v10, 2, v10
    v_add_u32 v5, 155648, v10
    s_lshl_b32 s28, s3, 2
    s_add_u32 s28, s28, 155648
    v_mov_b32 v7, s28
    s_mov_b32 s35, 0x80008000
    s_mov_b32 s62, 0
    s_mov_b32 s63, 0
    s_mov_b32 s39, 0
    s_add_u32 m0, s39, s36
    s_nop 0
    buffer_load_dwordx4 v1, s[8:11], s30 offen sc1 lds
    buffer_load_dwordx4 v1, s[8:11], s30 offen offset:1024 sc1 lds
    buffer_load_dwordx4 v1, s[8:11], s30 offen offset:2048 sc1 lds
    buffer_load_dwordx4 v1, s[8:11], s30 offen offset:3072 sc1 lds
    s_add_u32 m0, m0, 4096
    s_add_u32 s34, s30, 4096
    buffer_load_dwordx4 v1, s[8:11], s34 offen sc1 lds
    s_add_u32 m0, s39, s37
    s_add_u32 s30, s30, 21376
    buffer_load_dwordx4 v1, s[12:15], s31 offen sc1 lds
    buffer_load_dwordx4 v1, s[12:15], s31 offen offset:1024 sc1 lds
    buffer_load_dwordx4 v1, s[12:15], s31 offen offset:2048 sc1 lds
    buffer_load_dwordx4 v1, s[12:15], s31 offen offset:3072 sc1 lds
    s_add_u32 m0, s39, s38
    s_mov_b64 exec, s[44:45]
    buffer_load_dwordx4 v1, s[64:67], s33 offen sc1 lds
    s_mov_b64 exec, -1
    s_add_u32 s31, s31, 16384
    s_add_u32 s33, s33, 21376
    s_add_u32 s39, s39, 38912
    s_add_u32 m0, s39, s36
    s_nop 0
    buffer_load_dwordx4 v1, s[8:11], s30 offen sc1 lds
    buffer_load_dwordx4 v1, s[8:11], s30 offen offset:1024 sc1 lds
    buffer_load_dwordx4 v1, s[8:11], s30 offen offset:2048 sc1 lds
    buffer_load_dwordx4 v1, s[8:11], s30 offen offset:3072 sc1 lds
    s_add_u32 m0, m0, 4096
    s_add_u32 s34, s30, 4096
    buffer_load_dwordx4 v1, s[8:11], s34 offen sc1 lds
    s_add_u32 m0, s39, s37
    s_add_u32 s30, s30, 21376
    buffer_load_dwordx4 v1, s[12:15], s31 offen sc1 lds
    buffer_load_dwordx4 v1, s[12:15], s31 offen offset:1024 sc1 lds
    buffer_load_dwordx4 v1, s[12:15], s31 offen offset:2048 sc1 lds
    buffer_load_dwordx4 v1, s[12:15], s31 offen offset:3072 sc1 lds
    s_add_u32 m0, s39, s38
    s_mov_b64 exec, s[44:45]
    buffer_load_dwordx4 v1, s[64:67], s33 offen sc1 lds
    s_mov_b64 exec, -1
    s_add_u32 s31, s31, 16384
    s_add_u32 s33, s33, 21376
    s_add_u32 s39, s39, 38912
    s_add_u32 m0, s39, s36
    s_nop 0
    buffer_load_dwordx4 v1, s[8:11], s30 offen sc1 lds
    buffer_load_dwordx4 v1, s[8:11], s30 offen offset:1024 sc1 lds
    buffer_load_dwordx4 v1, s[8:11], s30 offen offset:2048 sc1 lds
    buffer_load_dwordx4 v1, s[8:11], s30 offen offset:3072 sc1 lds
    s_add_u32 m0, m0, 4096
    s_add_u32 s34, s30, 4096
    buffer_load_dwordx4 v1, s[8:11], s34 offen sc1 lds
    s_add_u32 m0, s39, s37
    s_add_u32 s30, s30, 21376
    buffer_load_dwordx4 v1, s[12:15], s31 offen sc1 lds
    buffer_load_dwordx4 v1, s[12:15], s31 offen offset:1024 sc1 lds
    buffer_load_dwordx4 v1, s[12:15], s31 offen offset:2048 sc1 lds
    buffer_load_dwordx4 v1, s[12:15], s31 offen offset:3072 sc1 lds
    s_add_u32 m0, s39, s38
    s_mov_b64 exec, s[44:45]
    buffer_load_dwordx4 v1, s[64:67], s33 offen sc1 lds
    s_mov_b64 exec, -1
    s_add_u32 s31, s31, 16384
    s_add_u32 s33, s33, 21376
    s_add_u32 s39, s39, 38912
    s_mov_b32 m0, s46
    s_mov_b64 exec, 0xff
    buffer_load_dword v1, s[4:7], 0 offen sc1 lds
    s_mov_b64 exec, -1
    v_lshrrev_b32 v9, 4, v1
    v_and_b32 v8, 15, v9
    v_lshrrev_b32 v9, 4, v9
    v_and_b32 v10, 3, v8
    v_lshlrev_b32 v10, 2, v10
    v_lshrrev_b32 v12, 3, v8
    v_lshl_add_u32 v10, v12, 1, v10
    s_lshl_b32 s28, s3, 4
    s_add_u32 s28, s28, 1
    v_add_u32 v10, s28, v10
    v_bfe_u32 v11, v8, 2, 1
    v_and_b32 v13, 1, v9
    v_lshlrev_b32 v13, 3, v13
    v_mul_u32_u24 v14, 96, v11
    v_mad_u32_u24 v15, v10, v13, v14
    v_mad_u32_u24 v16, v10, 0, v15
    v_mad_u32_u24 v17, v10, 1, v15
    v_mad_u32_u24 v18, v10, 2, v15
    v_mad_u32_u24 v19, v10, 3, v15
    v_mad_u32_u24 v20, v10, 4, v15
    v_mad_u32_u24 v21, v10, 5, v15
    v_mad_u32_u24 v22, v10, 6, v15
    v_mad_u32_u24 v23, v10, 7, v15
    v_and_b32 v16, 127, v16
    v_and_b32 v17, 127, v17
    v_and_b32 v18, 127, v18
    v_and_b32 v19, 127, v19
    v_and_b32 v20, 127, v20
    v_and_b32 v21, 127, v21
    v_and_b32 v22, 127, v22
    v_and_b32 v23, 127, v23
    v_cvt_f32_u32 v16, v16
    v_cvt_f32_u32 v17, v17
    v_cvt_f32_u32 v18, v18
    v_cvt_f32_u32 v19, v19
    v_cvt_f32_u32 v20, v20
    v_cvt_f32_u32 v21, v21
    v_cvt_f32_u32 v22, v22
    v_cvt_f32_u32 v23, v23
    v_mul_f32 v16, 0x3c000000, v16
    v_mul_f32 v17, 0x3c000000, v17
    v_mul_f32 v18, 0x3c000000, v18
    v_mul_f32 v19, 0x3c000000, v19
    v_mul_f32 v20, 0x3c000000, v20
    v_mul_f32 v21, 0x3c000000, v21
    v_mul_f32 v22, 0x3c000000, v22
    v_mul_f32 v23, 0x3c000000, v23
    v_cos_f32 v16, v16
    v_cos_f32 v17, v17
    v_cos_f32 v18, v18
    v_cos_f32 v19, v19
    v_cos_f32 v20, v20
    v_cos_f32 v21, v21
    v_cos_f32 v22, v22
    v_cos_f32 v23, v23
    s_nop 0
    v_cvt_pk_bf16_f32 v24, v16, v17
    v_cvt_pk_bf16_f32 v25, v18, v19
    v_cvt_pk_bf16_f32 v26, v20, v21
    v_cvt_pk_bf16_f32 v27, v22, v23
    v_lshlrev_b32 v32, 16, v24
    v_and_b32 v33, 0xffff0000, v24
    v_sub_f32 v16, v16, v32
    v_sub_f32 v17, v17, v33
    v_lshlrev_b32 v32, 16, v25
    v_and_b32 v33, 0xffff0000, v25
    v_sub_f32 v18, v18, v32
    v_sub_f32 v19, v19, v33
    v_lshlrev_b32 v32, 16, v26
    v_and_b32 v33, 0xffff0000, v26
    v_sub_f32 v20, v20, v32
    v_sub_f32 v21, v21, v33
    v_lshlrev_b32 v32, 16, v27
    v_and_b32 v33, 0xffff0000, v27
    v_sub_f32 v22, v22, v32
    v_sub_f32 v23, v23, v33
    v_cvt_pk_bf16_f32 v28, v16, v17
    v_cvt_pk_bf16_f32 v29, v18, v19
    v_cvt_pk_bf16_f32 v30, v20, v21
    v_cvt_pk_bf16_f32 v31, v22, v23
    v_cmp_lt_u32 vcc, 1, v9
    s_lshl_b32 s28, s3, 10
    s_add_u32 s28, s28, 133120
    v_add_u32 v14, s28, v1
    v_cndmask_b32 v24, v24, v28, vcc
    v_cndmask_b32 v25, v25, v29, vcc
    v_cndmask_b32 v26, v26, v30, vcc
    v_cndmask_b32 v27, v27, v31, vcc
    ds_write_b128 v14, v[24:27]
    v_mov_b32 v12, 0
    v_mov_b32 v13, 0
    v_mov_b32 v14, 0
    v_mov_b32 v15, 0
    s_mul_i32 s28, s3, 38912
    s_add_u32 s28, s28, 22272
    v_add_u32 v16, s28, v1
    s_mov_b64 exec, 0xffff
    ds_write_b128 v16, v[12:15]
    s_mov_b64 exec, -1
    s_lshl_b32 s28, s3, 2
    s_add_u32 s28, s28, 155648
    v_mov_b32 v16, s28
    ds_write_b32 v16, v12
    s_lshl_b32 s28, s3, 3
    s_add_u32 s28, s28, 155680
    v_mov_b32 v16, s28
    ds_write_b64 v16, v[12:13]
    s_lshl_b32 s28, s3, 3
    s_add_u32 s28, s28, 155712
    v_mov_b32 v16, s28
    ds_write_b64 v16, v[12:13]
    s_lshl_b32 s28, s3, 3
    s_add_u32 s28, s28, 155840
    v_mov_b32 v16, s28
    ds_write_b64 v16, v[12:13]
    v_mov_b32 v16, 155664
    ds_write_b32 v16, v12
    v_mov_b32 v16, 155744
    v_mov_b32 v17, 1
    ds_write_b32 v16, v17
    s_waitcnt lgkmcnt(0)
    s_barrier
    v_mov_b32 v80, 0
    v_mov_b32 v81, 0
    v_mov_b32 v82, 0
    v_mov_b32 v83, 0
    v_mov_b32 v84, 0
    v_mov_b32 v85, 0
    v_mov_b32 v86, 0
    v_mov_b32 v87, 0
    v_mov_b32 v88, 0
    v_mov_b32 v89, 0
    v_mov_b32 v90, 0
    v_mov_b32 v91, 0
    v_mov_b32 v92, 0
    v_mov_b32 v93, 0
    v_mov_b32 v94, 0
    v_mov_b32 v95, 0
    v_mov_b32 v96, 0
    v_mov_b32 v97, 0
    v_mov_b32 v98, 0
    v_mov_b32 v99, 0
    v_mov_b32 v100, 0
    v_mov_b32 v101, 0
    v_mov_b32 v102, 0
    v_mov_b32 v103, 0
    v_mov_b32 v104, 0
    v_mov_b32 v105, 0
    v_mov_b32 v106, 0
    v_mov_b32 v107, 0
    v_mov_b32 v108, 0
    v_mov_b32 v109, 0
    v_mov_b32 v110, 0
    v_mov_b32 v111, 0
    v_mov_b32 v112, 0
    v_mov_b32 v113, 0
    v_mov_b32 v114, 0
    v_mov_b32 v115, 0
    v_mov_b32 v116, 0
    v_mov_b32 v117, 0
    v_mov_b32 v118, 0
    v_mov_b32 v119, 0
    v_mov_b32 v120, 0
    v_mov_b32 v121, 0
    v_mov_b32 v122, 0
    v_mov_b32 v123, 0
    v_mov_b32 v124, 0
    v_mov_b32 v125, 0
    v_mov_b32 v126, 0
    v_mov_b32 v127, 0
    v_mov_b32 v128, 0
    v_mov_b32 v129, 0
    v_mov_b32 v130, 0
    v_mov_b32 v131, 0
    v_mov_b32 v132, 0
    v_mov_b32 v133, 0
    v_mov_b32 v134, 0
    v_mov_b32 v135, 0
    v_mov_b32 v136, 0
    v_mov_b32 v137, 0
    v_mov_b32 v138, 0
    v_mov_b32 v139, 0
    v_mov_b32 v140, 0
    v_mov_b32 v141, 0
    v_mov_b32 v142, 0
    v_mov_b32 v143, 0
    v_mov_b32 v144, 0
    v_mov_b32 v145, 0
    v_mov_b32 v146, 0
    v_mov_b32 v147, 0
    v_mov_b32 v148, 0
    v_mov_b32 v149, 0
    v_mov_b32 v150, 0
    v_mov_b32 v151, 0
    v_mov_b32 v152, 0
    v_mov_b32 v153, 0
    v_mov_b32 v154, 0
    v_mov_b32 v155, 0
    v_mov_b32 v156, 0
    v_mov_b32 v157, 0
    v_mov_b32 v158, 0
    v_mov_b32 v159, 0
    v_mov_b32 v160, 0
    v_mov_b32 v161, 0
    v_mov_b32 v162, 0
    v_mov_b32 v163, 0
    v_mov_b32 v164, 0
    v_mov_b32 v165, 0
    v_mov_b32 v166, 0
    v_mov_b32 v167, 0
    v_mov_b32 v168, 0
    v_mov_b32 v169, 0
    v_mov_b32 v170, 0
    v_mov_b32 v171, 0
    v_mov_b32 v172, 0
    v_mov_b32 v173, 0
    v_mov_b32 v174, 0
    v_mov_b32 v175, 0
    v_mov_b32 v176, 0
    v_mov_b32 v177, 0
    v_mov_b32 v178, 0
    v_mov_b32 v179, 0
    v_mov_b32 v180, 0
    v_mov_b32 v181, 0
    v_mov_b32 v182, 0
    v_mov_b32 v183, 0
    v_mov_b32 v184, 0
    v_mov_b32 v185, 0
    v_mov_b32 v186, 0
    v_mov_b32 v187, 0
    v_mov_b32 v188, 0
    v_mov_b32 v189, 0
    v_mov_b32 v190, 0
    v_mov_b32 v191, 0
    v_mov_b32 v192, 0
    v_mov_b32 v193, 0
    v_mov_b32 v194, 0
    v_mov_b32 v195, 0
    v_mov_b32 v196, 0
    v_mov_b32 v197, 0
    v_mov_b32 v198, 0
    v_mov_b32 v199, 0
    v_mov_b32 v200, 0
    v_mov_b32 v201, 0
    v_mov_b32 v202, 0
    v_mov_b32 v203, 0
    v_mov_b32 v204, 0
    v_mov_b32 v205, 0
    v_mov_b32 v206, 0
    v_mov_b32 v207, 0
    v_mov_b32 v208, 0
    v_mov_b32 v209, 0
    v_mov_b32 v210, 0
    v_mov_b32 v211, 0
    v_mov_b32 v212, 0
    v_mov_b32 v213, 0
    v_mov_b32 v214, 0
    v_mov_b32 v215, 0
    v_mov_b32 v216, 0
    v_mov_b32 v217, 0
    v_mov_b32 v218, 0
    v_mov_b32 v219, 0
    v_mov_b32 v220, 0
    v_mov_b32 v221, 0
    v_mov_b32 v222, 0
    v_mov_b32 v223, 0
    v_mov_b32 v224, 0
    v_mov_b32 v225, 0
    v_mov_b32 v226, 0
    v_mov_b32 v227, 0
    v_mov_b32 v228, 0
    v_mov_b32 v229, 0
    v_mov_b32 v230, 0
    v_mov_b32 v231, 0
    v_mov_b32 v232, 0
    v_mov_b32 v233, 0
    v_mov_b32 v234, 0
    v_mov_b32 v235, 0
    v_mov_b32 v236, 0
    v_mov_b32 v237, 0
    v_mov_b32 v238, 0
    v_mov_b32 v239, 0
    v_mov_b32 v240, 0
    v_mov_b32 v241, 0
    v_mov_b32 v242, 0
    v_mov_b32 v243, 0
    v_mov_b32 v244, 0
    v_mov_b32 v245, 0
    v_mov_b32 v246, 0
    v_mov_b32 v247, 0
    s_barrier
    s_mov_b32 s40, 2
    v_mov_b32 v0, s40
    s_waitcnt vmcnt(21)
    ds_write_b32 v7, v0
    s_branch K12_S0
K12_Q0:
    ds_read_b64_tr_b16 v[40:41], v4 offset:0
    ds_read_b64_tr_b16 v[42:43], v4 offset:2048
    ds_read_b64_tr_b16 v[44:45], v4 offset:256
    ds_read_b64_tr_b16 v[46:47], v4 offset:2304
    v_xor_b32 v4, 32, v4
    ds_read_b64_tr_b16 v[48:49], v4 offset:0
    ds_read_b64_tr_b16 v[50:51], v4 offset:2048
    ds_read_b64_tr_b16 v[52:53], v4 offset:256
    ds_read_b64_tr_b16 v[54:55], v4 offset:2304
    v_xor_b32 v4, 32, v4
    ds_read_b128 v[8:11], v2 offset:0
    ds_read_b128 v[12:15], v3 offset:0
    ds_read_b128 v[16:19], v2 offset:2048
    ds_read_b128 v[20:23], v3 offset:2048
    ds_read_b128 v[32:35], v2 offset:6144
    ds_read_b128 v[36:39], v3 offset:6144
    ds_read_b32 v68, v5
    s_waitcnt lgkmcnt(7)
    v_xor_b32 v72, s35, v44
    v_xor_b32 v73, s35, v45
    v_xor_b32 v74, s35, v46
    v_xor_b32 v75, s35, v47
    v_xor_b32 v76, s35, v52
    v_xor_b32 v77, s35, v53
    v_xor_b32 v78, s35, v54
    v_xor_b32 v79, s35, v55
    s_mov_b32 s41, 0
    s_mov_b32 s42, 38912
    s_mov_b32 s39, 0
    s_mov_b32 s29, 116736
K12_LOOP:
    s_waitcnt lgkmcnt(2)
    v_mfma_f32_16x16x32_bf16 v[80:83], v[8:11], v[40:43], v[80:83]
    ds_read_b128 v[24:27], v2 offset:4096
    v_xor_b32 v72, s35, v44
    v_xor_b32 v73, s35, v45
    v_mfma_f32_16x16x32_bf16 v[84:87], v[8:11], v[44:47], v[84:87]
    ds_read_b128 v[28:31], v3 offset:4096
    v_xor_b32 v74, s35, v46
    v_xor_b32 v75, s35, v47
    v_mfma_f32_16x16x32_bf16 v[88:91], v[8:11], v[48:51], v[88:91]
    s_waitcnt lgkmcnt(2)
    v_cmp_gt_u32 vcc, s40, v68
    s_add_u32 s49, s39, 2
    s_lshr_b32 s49, s49, 1
    v_xor_b32 v76, s35, v52
    v_xor_b32 v77, s35, v53
    v_mfma_f32_16x16x32_bf16 v[92:95], v[8:11], v[52:55], v[92:95]
    s_cbranch_vccnz K12_S1
K12_Q1:
    s_mul_i32 s48, s49, s50
    s_add_u32 s48, s48, s47
    v_xor_b32 v78, s35, v54
    v_xor_b32 v79, s35, v55
    v_mfma_f32_16x16x32_bf16 v[80:83], v[12:15], v[72:75], v[80:83]
    s_add_u32 m0, s29, s36
    s_nop 0
    buffer_load_dwordx4 v1, s[8:11], s30 offen sc1 lds
    v_mfma_f32_16x16x32_bf16 v[84:87], v[12:15], v[40:43], v[84:87]
    s_cmp_lt_u32 s49, 8
    s_cselect_b32 s48, s48, 155744
    v_mfma_f32_16x16x32_bf16 v[88:91], v[12:15], v[76:79], v[88:91]
    s_cmp_ge_u32 s49, 3
    s_cselect_b32 s48, s48, 155744
    v_mfma_f32_16x16x32_bf16 v[92:95], v[12:15], v[48:51], v[92:95]
    v_mfma_f32_16x16x32_bf16 v[96:99], v[16:19], v[40:43], v[96:99]
    ds_read_b128 v[8:11], v2 offset:8192
    v_mfma_f32_16x16x32_bf16 v[100:103], v[16:19], v[44:47], v[100:103]
    ds_read_b128 v[12:15], v3 offset:8192
    v_mfma_f32_16x16x32_bf16 v[104:107], v[16:19], v[48:51], v[104:107]
    buffer_load_dwordx4 v1, s[8:11], s30 offen offset:1024 sc1 lds
    v_mfma_f32_16x16x32_bf16 v[108:111], v[16:19], v[52:55], v[108:111]
    v_mfma_f32_16x16x32_bf16 v[96:99], v[20:23], v[72:75], v[96:99]
    v_mfma_f32_16x16x32_bf16 v[100:103], v[20:23], v[40:43], v[100:103]
    v_mfma_f32_16x16x32_bf16 v[104:107], v[20:23], v[76:79], v[104:107]
    buffer_load_dwordx4 v1, s[8:11], s30 offen offset:2048 sc1 lds
    v_mfma_f32_16x16x32_bf16 v[108:111], v[20:23], v[48:51], v[108:111]
    s_waitcnt lgkmcnt(2)
    v_mfma_f32_16x16x32_bf16 v[112:115], v[24:27], v[40:43], v[112:115]
    ds_read_b128 v[16:19], v2 offset:10240
    v_mfma_f32_16x16x32_bf16 v[116:119], v[24:27], v[44:47], v[116:119]
    ds_read_b128 v[20:23], v3 offset:10240
    v_mfma_f32_16x16x32_bf16 v[120:123], v[24:27], v[48:51], v[120:123]
    v_mfma_f32_16x16x32_bf16 v[124:127], v[24:27], v[52:55], v[124:127]
    v_mfma_f32_16x16x32_bf16 v[112:115], v[28:31], v[72:75], v[112:115]
    buffer_load_dwordx4 v1, s[8:11], s30 offen offset:3072 sc1 lds
    v_mfma_f32_16x16x32_bf16 v[116:119], v[28:31], v[40:43], v[116:119]
    v_mfma_f32_16x16x32_bf16 v[120:123], v[28:31], v[76:79], v[120:123]
    v_mfma_f32_16x16x32_bf16 v[124:127], v[28:31], v[48:51], v[124:127]
    v_mfma_f32_16x16x32_bf16 v[128:131], v[32:35], v[40:43], v[128:131]
    ds_read_b128 v[24:27], v2 offset:12288
    v_mfma_f32_16x16x32_bf16 v[132:135], v[32:35], v[44:47], v[132:135]
    ds_read_b128 v[28:31], v3 offset:12288
    v_mfma_f32_16x16x32_bf16 v[136:139], v[32:35], v[48:51], v[136:139]
    s_add_u32 m0, m0, 4096
    s_add_u32 s34, s30, 4096
    buffer_load_dwordx4 v1, s[8:11], s34 offen sc1 lds
    v_mfma_f32_16x16x32_bf16 v[140:143], v[32:35], v[52:55], v[140:143]
    v_mfma_f32_16x16x32_bf16 v[128:131], v[36:39], v[72:75], v[128:131]
    v_mfma_f32_16x16x32_bf16 v[132:135], v[36:39], v[40:43], v[132:135]
    v_mfma_f32_16x16x32_bf16 v[136:139], v[36:39], v[76:79], v[136:139]
    s_add_u32 m0, s29, s37
    s_add_u32 s30, s30, 21376
    buffer_load_dwordx4 v1, s[12:15], s31 offen sc1 lds
    v_mfma_f32_16x16x32_bf16 v[140:143], v[36:39], v[48:51], v[140:143]
    s_waitcnt lgkmcnt(4)
    v_mfma_f32_16x16x32_bf16 v[144:147], v[8:11], v[40:43], v[144:147]
    ds_read_b128 v[32:35], v2 offset:14336
    v_mfma_f32_16x16x32_bf16 v[148:151], v[8:11], v[44:47], v[148:151]
    ds_read_b128 v[36:39], v3 offset:14336
    v_mfma_f32_16x16x32_bf16 v[152:155], v[8:11], v[48:51], v[152:155]
    v_mfma_f32_16x16x32_bf16 v[156:159], v[8:11], v[52:55], v[156:159]
    v_mfma_f32_16x16x32_bf16 v[144:147], v[12:15], v[72:75], v[144:147]
    buffer_load_dwordx4 v1, s[12:15], s31 offen offset:1024 sc1 lds
    v_mfma_f32_16x16x32_bf16 v[148:151], v[12:15], v[40:43], v[148:151]
    v_mfma_f32_16x16x32_bf16 v[152:155], v[12:15], v[76:79], v[152:155]
    v_mfma_f32_16x16x32_bf16 v[156:159], v[12:15], v[48:51], v[156:159]
    s_waitcnt lgkmcnt(4)
    v_mfma_f32_16x16x32_bf16 v[160:163], v[16:19], v[40:43], v[160:163]
    ds_read_b128 v[8:11], v2 offset:16384
    v_mfma_f32_16x16x32_bf16 v[164:167], v[16:19], v[44:47], v[164:167]
    ds_read_b128 v[12:15], v3 offset:16384
    v_mfma_f32_16x16x32_bf16 v[168:171], v[16:19], v[48:51], v[168:171]
    buffer_load_dwordx4 v1, s[12:15], s31 offen offset:2048 sc1 lds
    v_mfma_f32_16x16x32_bf16 v[172:175], v[16:19], v[52:55], v[172:175]
    s_add_u32 s40, s40, 1
    s_mov_b32 s51, s40
    v_mov_b32 v0, s40
    v_mfma_f32_16x16x32_bf16 v[160:163], v[20:23], v[72:75], v[160:163]
    s_waitcnt vmcnt(19)
    ds_write_b32 v7, v0
    v_mfma_f32_16x16x32_bf16 v[164:167], v[20:23], v[40:43], v[164:167]
    v_mfma_f32_16x16x32_bf16 v[168:171], v[20:23], v[76:79], v[168:171]
    buffer_load_dwordx4 v1, s[12:15], s31 offen offset:3072 sc1 lds
    v_mfma_f32_16x16x32_bf16 v[172:175], v[20:23], v[48:51], v[172:175]
    s_waitcnt lgkmcnt(5)
    v_mfma_f32_16x16x32_bf16 v[176:179], v[24:27], v[40:43], v[176:179]
    ds_read_b128 v[16:19], v2 offset:18432
    v_mfma_f32_16x16x32_bf16 v[180:183], v[24:27], v[44:47], v[180:183]
    ds_read_b128 v[20:23], v3 offset:18432
    v_mov_b32 v0, s48
    v_mfma_f32_16x16x32_bf16 v[184:187], v[24:27], v[48:51], v[184:187]
    ds_read_b32 v0, v0
    v_mfma_f32_16x16x32_bf16 v[188:191], v[24:27], v[52:55], v[188:191]
    v_mfma_f32_16x16x32_bf16 v[176:179], v[28:31], v[72:75], v[176:179]
    s_add_u32 m0, s29, s38
    s_mov_b64 exec, s[44:45]
    buffer_load_dwordx4 v1, s[64:67], s33 offen sc1 lds
    s_mov_b64 exec, -1
    s_add_u32 s31, s31, 16384
    s_add_u32 s33, s33, 21376
    v_mfma_f32_16x16x32_bf16 v[180:183], v[28:31], v[40:43], v[180:183]
    v_mfma_f32_16x16x32_bf16 v[184:187], v[28:31], v[76:79], v[184:187]
    v_mfma_f32_16x16x32_bf16 v[188:191], v[28:31], v[48:51], v[188:191]
    s_waitcnt lgkmcnt(0)
    v_cmp_eq_u32 vcc, 0, v0
    v_mfma_f32_16x16x32_bf16 v[192:195], v[32:35], v[40:43], v[192:195]
    ds_read_b128 v[24:27], v2 offset:20480
    v_mfma_f32_16x16x32_bf16 v[196:199], v[32:35], v[44:47], v[196:199]
    ds_read_b128 v[28:31], v3 offset:20480
    s_cbranch_vccnz K12_F2
K12_G2:
    v_mfma_f32_16x16x32_bf16 v[200:203], v[32:35], v[48:51], v[200:203]
    s_sub_u32 s43, s42, s41
    s_add_u32 s40, s40, 1
    v_add_u32 v2, s43, v2
    v_mfma_f32_16x16x32_bf16 v[204:207], v[32:35], v[52:55], v[204:207]
    v_add_u32 v3, s43, v3
    v_add_u32 v4, s43, v4
    v_mov_b32 v0, s40
    v_mfma_f32_16x16x32_bf16 v[192:195], v[36:39], v[72:75], v[192:195]
    ds_write_b32 v7, v0
    v_mfma_f32_16x16x32_bf16 v[196:199], v[36:39], v[40:43], v[196:199]
    v_mfma_f32_16x16x32_bf16 v[200:203], v[36:39], v[76:79], v[200:203]
    v_mfma_f32_16x16x32_bf16 v[204:207], v[36:39], v[48:51], v[204:207]
    ds_read_b32 v56, v5
    v_mfma_f32_16x16x32_bf16 v[208:211], v[8:11], v[40:43], v[208:211]
    v_mfma_f32_16x16x32_bf16 v[212:215], v[8:11], v[44:47], v[212:215]
    v_mfma_f32_16x16x32_bf16 v[216:219], v[8:11], v[48:51], v[216:219]
    v_mfma_f32_16x16x32_bf16 v[220:223], v[8:11], v[52:55], v[220:223]
    s_waitcnt lgkmcnt(0)
    v_cmp_gt_u32 vcc, s51, v56
    v_mfma_f32_16x16x32_bf16 v[208:211], v[12:15], v[72:75], v[208:211]
    v_mfma_f32_16x16x32_bf16 v[212:215], v[12:15], v[40:43], v[212:215]
    s_cbranch_vccnz K12_S3
K12_Q3:
    v_mfma_f32_16x16x32_bf16 v[216:219], v[12:15], v[76:79], v[216:219]
    ds_read_b64_tr_b16 v[56:57], v4 offset:0
    v_mfma_f32_16x16x32_bf16 v[220:223], v[12:15], v[48:51], v[220:223]
    ds_read_b64_tr_b16 v[58:59], v4 offset:2048
    v_mfma_f32_16x16x32_bf16 v[224:227], v[16:19], v[40:43], v[224:227]
    ds_read_b64_tr_b16 v[60:61], v4 offset:256
    ds_read_b128 v[8:11], v2 offset:0
    v_mfma_f32_16x16x32_bf16 v[228:231], v[16:19], v[44:47], v[228:231]
    ds_read_b64_tr_b16 v[62:63], v4 offset:2304
    ds_read_b128 v[12:15], v3 offset:0
    v_mfma_f32_16x16x32_bf16 v[232:235], v[16:19], v[48:51], v[232:235]
    v_xor_b32 v4, 32, v4
    ds_read_b128 v[32:35], v2 offset:6144
    v_mfma_f32_16x16x32_bf16 v[236:239], v[16:19], v[52:55], v[236:239]
    ds_read_b64_tr_b16 v[64:65], v4 offset:0
    ds_read_b128 v[36:39], v3 offset:6144
    v_mfma_f32_16x16x32_bf16 v[224:227], v[20:23], v[72:75], v[224:227]
    ds_read_b64_tr_b16 v[66:67], v4 offset:2048
    ds_read_b32 v52, v5
    v_mfma_f32_16x16x32_bf16 v[228:231], v[20:23], v[40:43], v[228:231]
    ds_read_b64_tr_b16 v[68:69], v4 offset:256
    ds_read_b64_tr_b16 v[70:71], v4 offset:2304
    v_xor_b32 v4, 32, v4
    v_mfma_f32_16x16x32_bf16 v[232:235], v[20:23], v[76:79], v[232:235]
    v_mfma_f32_16x16x32_bf16 v[236:239], v[20:23], v[48:51], v[236:239]
    v_mfma_f32_16x16x32_bf16 v[240:243], v[24:27], v[40:43], v[240:243]
    ds_read_b128 v[16:19], v2 offset:2048
    v_mfma_f32_16x16x32_bf16 v[244:247], v[24:27], v[44:47], v[244:247]
    ds_read_b128 v[20:23], v3 offset:2048
    v_mfma_f32_16x16x32_bf16 v[240:243], v[28:31], v[72:75], v[240:243]
    s_mov_b32 s29, s41
    s_mov_b32 s41, s42
    s_add_u32 s42, s42, 38912
    v_mfma_f32_16x16x32_bf16 v[244:247], v[28:31], v[40:43], v[244:247]
    s_cmp_eq_u32 s42, 155648
    s_cselect_b32 s42, 0, s42
    s_waitcnt lgkmcnt(2)
    v_mfma_f32_16x16x32_bf16 v[80:83], v[8:11], v[56:59], v[80:83]
    ds_read_b128 v[24:27], v2 offset:4096
    v_xor_b32 v72, s35, v60
    v_xor_b32 v73, s35, v61
    v_mfma_f32_16x16x32_bf16 v[84:87], v[8:11], v[60:63], v[84:87]
    ds_read_b128 v[28:31], v3 offset:4096
    v_xor_b32 v74, s35, v62
    v_xor_b32 v75, s35, v63
    v_mfma_f32_16x16x32_bf16 v[88:91], v[8:11], v[64:67], v[88:91]
    s_waitcnt lgkmcnt(2)
    v_cmp_gt_u32 vcc, s40, v52
    v_xor_b32 v76, s35, v68
    v_xor_b32 v77, s35, v69
    v_mfma_f32_16x16x32_bf16 v[92:95], v[8:11], v[68:71], v[92:95]
    s_cbranch_vccnz K12_S4
K12_Q4:
    v_xor_b32 v78, s35, v70
    v_xor_b32 v79, s35, v71
    v_mfma_f32_16x16x32_bf16 v[80:83], v[12:15], v[72:75], v[80:83]
    s_add_u32 m0, s29, s36
    s_nop 0
    buffer_load_dwordx4 v1, s[8:11], s30 offen sc1 lds
    v_mfma_f32_16x16x32_bf16 v[84:87], v[12:15], v[56:59], v[84:87]
    v_mfma_f32_16x16x32_bf16 v[88:91], v[12:15], v[76:79], v[88:91]
    v_mfma_f32_16x16x32_bf16 v[92:95], v[12:15], v[64:67], v[92:95]
    v_mfma_f32_16x16x32_bf16 v[96:99], v[16:19], v[56:59], v[96:99]
    ds_read_b128 v[8:11], v2 offset:8192
    v_mfma_f32_16x16x32_bf16 v[100:103], v[16:19], v[60:63], v[100:103]
    ds_read_b128 v[12:15], v3 offset:8192
    v_mfma_f32_16x16x32_bf16 v[104:107], v[16:19], v[64:67], v[104:107]
    buffer_load_dwordx4 v1, s[8:11], s30 offen offset:1024 sc1 lds
    v_mfma_f32_16x16x32_bf16 v[108:111], v[16:19], v[68:71], v[108:111]
    v_mfma_f32_16x16x32_bf16 v[96:99], v[20:23], v[72:75], v[96:99]
    v_mfma_f32_16x16x32_bf16 v[100:103], v[20:23], v[56:59], v[100:103]
    v_mfma_f32_16x16x32_bf16 v[104:107], v[20:23], v[76:79], v[104:107]
    buffer_load_dwordx4 v1, s[8:11], s30 offen offset:2048 sc1 lds
    v_mfma_f32_16x16x32_bf16 v[108:111], v[20:23], v[64:67], v[108:111]
    s_waitcnt lgkmcnt(2)
    v_mfma_f32_16x16x32_bf16 v[112:115], v[24:27], v[56:59], v[112:115]
    ds_read_b128 v[16:19], v2 offset:10240
    v_mfma_f32_16x16x32_bf16 v[116:119], v[24:27], v[60:63], v[116:119]
    ds_read_b128 v[20:23], v3 offset:10240
    v_mfma_f32_16x16x32_bf16 v[120:123], v[24:27], v[64:67], v[120:123]
    v_mfma_f32_16x16x32_bf16 v[124:127], v[24:27], v[68:71], v[124:127]
    v_mfma_f32_16x16x32_bf16 v[112:115], v[28:31], v[72:75], v[112:115]
    buffer_load_dwordx4 v1, s[8:11], s30 offen offset:3072 sc1 lds
    v_mfma_f32_16x16x32_bf16 v[116:119], v[28:31], v[56:59], v[116:119]
    v_mfma_f32_16x16x32_bf16 v[120:123], v[28:31], v[76:79], v[120:123]
    v_mfma_f32_16x16x32_bf16 v[124:127], v[28:31], v[64:67], v[124:127]
    v_mfma_f32_16x16x32_bf16 v[128:131], v[32:35], v[56:59], v[128:131]
    ds_read_b128 v[24:27], v2 offset:12288
    v_mfma_f32_16x16x32_bf16 v[132:135], v[32:35], v[60:63], v[132:135]
    ds_read_b128 v[28:31], v3 offset:12288
    v_mfma_f32_16x16x32_bf16 v[136:139], v[32:35], v[64:67], v[136:139]
    s_add_u32 m0, m0, 4096
    s_add_u32 s34, s30, 4096
    buffer_load_dwordx4 v1, s[8:11], s34 offen sc1 lds
    v_mfma_f32_16x16x32_bf16 v[140:143], v[32:35], v[68:71], v[140:143]
    v_mfma_f32_16x16x32_bf16 v[128:131], v[36:39], v[72:75], v[128:131]
    v_mfma_f32_16x16x32_bf16 v[132:135], v[36:39], v[56:59], v[132:135]
    v_mfma_f32_16x16x32_bf16 v[136:139], v[36:39], v[76:79], v[136:139]
    s_add_u32 m0, s29, s37
    s_add_u32 s30, s30, 21376
    buffer_load_dwordx4 v1, s[12:15], s31 offen sc1 lds
    v_mfma_f32_16x16x32_bf16 v[140:143], v[36:39], v[64:67], v[140:143]
    s_waitcnt lgkmcnt(4)
    v_mfma_f32_16x16x32_bf16 v[144:147], v[8:11], v[56:59], v[144:147]
    ds_read_b128 v[32:35], v2 offset:14336
    v_mfma_f32_16x16x32_bf16 v[148:151], v[8:11], v[60:63], v[148:151]
    ds_read_b128 v[36:39], v3 offset:14336
    v_mfma_f32_16x16x32_bf16 v[152:155], v[8:11], v[64:67], v[152:155]
    v_mfma_f32_16x16x32_bf16 v[156:159], v[8:11], v[68:71], v[156:159]
    v_mfma_f32_16x16x32_bf16 v[144:147], v[12:15], v[72:75], v[144:147]
    buffer_load_dwordx4 v1, s[12:15], s31 offen offset:1024 sc1 lds
    v_mfma_f32_16x16x32_bf16 v[148:151], v[12:15], v[56:59], v[148:151]
    v_mfma_f32_16x16x32_bf16 v[152:155], v[12:15], v[76:79], v[152:155]
    v_mfma_f32_16x16x32_bf16 v[156:159], v[12:15], v[64:67], v[156:159]
    s_waitcnt lgkmcnt(4)
    v_mfma_f32_16x16x32_bf16 v[160:163], v[16:19], v[56:59], v[160:163]
    ds_read_b128 v[8:11], v2 offset:16384
    v_mfma_f32_16x16x32_bf16 v[164:167], v[16:19], v[60:63], v[164:167]
    ds_read_b128 v[12:15], v3 offset:16384
    v_mfma_f32_16x16x32_bf16 v[168:171], v[16:19], v[64:67], v[168:171]
    buffer_load_dwordx4 v1, s[12:15], s31 offen offset:2048 sc1 lds
    v_mfma_f32_16x16x32_bf16 v[172:175], v[16:19], v[68:71], v[172:175]
    s_add_u32 s40, s40, 1
    s_mov_b32 s51, s40
    v_mov_b32 v0, s40
    v_mfma_f32_16x16x32_bf16 v[160:163], v[20:23], v[72:75], v[160:163]
    s_waitcnt vmcnt(19)
    ds_write_b32 v7, v0
    v_mfma_f32_16x16x32_bf16 v[164:167], v[20:23], v[56:59], v[164:167]
    v_mfma_f32_16x16x32_bf16 v[168:171], v[20:23], v[76:79], v[168:171]
    buffer_load_dwordx4 v1, s[12:15], s31 offen offset:3072 sc1 lds
    v_mfma_f32_16x16x32_bf16 v[172:175], v[20:23], v[64:67], v[172:175]
    s_waitcnt lgkmcnt(5)
    v_mfma_f32_16x16x32_bf16 v[176:179], v[24:27], v[56:59], v[176:179]
    ds_read_b128 v[16:19], v2 offset:18432
    v_mfma_f32_16x16x32_bf16 v[180:183], v[24:27], v[60:63], v[180:183]
    ds_read_b128 v[20:23], v3 offset:18432
    v_mfma_f32_16x16x32_bf16 v[184:187], v[24:27], v[64:67], v[184:187]
    v_mfma_f32_16x16x32_bf16 v[188:191], v[24:27], v[68:71], v[188:191]
    v_mfma_f32_16x16x32_bf16 v[176:179], v[28:31], v[72:75], v[176:179]
    s_add_u32 m0, s29, s38
    s_mov_b64 exec, s[44:45]
    buffer_load_dwordx4 v1, s[64:67], s33 offen sc1 lds
    s_mov_b64 exec, -1
    s_add_u32 s31, s31, 16384
    s_add_u32 s33, s33, 21376
    v_mfma_f32_16x16x32_bf16 v[180:183], v[28:31], v[56:59], v[180:183]
    v_mfma_f32_16x16x32_bf16 v[184:187], v[28:31], v[76:79], v[184:187]
    s_mov_b32 m0, s46
    s_mov_b64 exec, 0xff
    buffer_load_dword v1, s[4:7], 0 offen sc1 lds
    s_mov_b64 exec, -1
    v_mfma_f32_16x16x32_bf16 v[188:191], v[28:31], v[64:67], v[188:191]
    s_waitcnt lgkmcnt(5)
    v_mfma_f32_16x16x32_bf16 v[192:195], v[32:35], v[56:59], v[192:195]
    ds_read_b128 v[24:27], v2 offset:20480
    v_mfma_f32_16x16x32_bf16 v[196:199], v[32:35], v[60:63], v[196:199]
    ds_read_b128 v[28:31], v3 offset:20480
    v_mfma_f32_16x16x32_bf16 v[200:203], v[32:35], v[64:67], v[200:203]
    s_sub_u32 s43, s42, s41
    s_add_u32 s40, s40, 1
    v_add_u32 v2, s43, v2
    v_mfma_f32_16x16x32_bf16 v[204:207], v[32:35], v[68:71], v[204:207]
    v_add_u32 v3, s43, v3
    v_add_u32 v4, s43, v4
    v_mov_b32 v0, s40
    v_mfma_f32_16x16x32_bf16 v[192:195], v[36:39], v[72:75], v[192:195]
    ds_write_b32 v7, v0
    v_mfma_f32_16x16x32_bf16 v[196:199], v[36:39], v[56:59], v[196:199]
    v_mfma_f32_16x16x32_bf16 v[200:203], v[36:39], v[76:79], v[200:203]
    v_mfma_f32_16x16x32_bf16 v[204:207], v[36:39], v[64:67], v[204:207]
    ds_read_b32 v40, v5
    s_waitcnt lgkmcnt(7)
    v_mfma_f32_16x16x32_bf16 v[208:211], v[8:11], v[56:59], v[208:211]
    v_mfma_f32_16x16x32_bf16 v[212:215], v[8:11], v[60:63], v[212:215]
    v_mfma_f32_16x16x32_bf16 v[216:219], v[8:11], v[64:67], v[216:219]
    v_mfma_f32_16x16x32_bf16 v[220:223], v[8:11], v[68:71], v[220:223]
    s_waitcnt lgkmcnt(0)
    v_cmp_gt_u32 vcc, s51, v40
    v_mfma_f32_16x16x32_bf16 v[208:211], v[12:15], v[72:75], v[208:211]
    v_mfma_f32_16x16x32_bf16 v[212:215], v[12:15], v[56:59], v[212:215]
    s_cbranch_vccnz K12_S5
K12_Q5:
    v_mfma_f32_16x16x32_bf16 v[216:219], v[12:15], v[76:79], v[216:219]
    ds_read_b64_tr_b16 v[40:41], v4 offset:0
    v_mfma_f32_16x16x32_bf16 v[220:223], v[12:15], v[64:67], v[220:223]
    ds_read_b64_tr_b16 v[42:43], v4 offset:2048
    v_mfma_f32_16x16x32_bf16 v[224:227], v[16:19], v[56:59], v[224:227]
    ds_read_b64_tr_b16 v[44:45], v4 offset:256
    ds_read_b128 v[8:11], v2 offset:0
    v_mfma_f32_16x16x32_bf16 v[228:231], v[16:19], v[60:63], v[228:231]
    ds_read_b64_tr_b16 v[46:47], v4 offset:2304
    ds_read_b128 v[12:15], v3 offset:0
    v_mfma_f32_16x16x32_bf16 v[232:235], v[16:19], v[64:67], v[232:235]
    v_xor_b32 v4, 32, v4
    ds_read_b128 v[32:35], v2 offset:6144
    v_mfma_f32_16x16x32_bf16 v[236:239], v[16:19], v[68:71], v[236:239]
    ds_read_b64_tr_b16 v[48:49], v4 offset:0
    ds_read_b128 v[36:39], v3 offset:6144
    v_mfma_f32_16x16x32_bf16 v[224:227], v[20:23], v[72:75], v[224:227]
    ds_read_b64_tr_b16 v[50:51], v4 offset:2048
    ds_read_b32 v68, v5
    v_mfma_f32_16x16x32_bf16 v[228:231], v[20:23], v[56:59], v[228:231]
    ds_read_b64_tr_b16 v[52:53], v4 offset:256
    ds_read_b64_tr_b16 v[54:55], v4 offset:2304
    v_xor_b32 v4, 32, v4
    v_mfma_f32_16x16x32_bf16 v[232:235], v[20:23], v[76:79], v[232:235]
    v_mfma_f32_16x16x32_bf16 v[236:239], v[20:23], v[64:67], v[236:239]
    v_mfma_f32_16x16x32_bf16 v[240:243], v[24:27], v[56:59], v[240:243]
    ds_read_b128 v[16:19], v2 offset:2048
    v_mfma_f32_16x16x32_bf16 v[244:247], v[24:27], v[60:63], v[244:247]
    ds_read_b128 v[20:23], v3 offset:2048
    v_mfma_f32_16x16x32_bf16 v[240:243], v[28:31], v[72:75], v[240:243]
    s_mov_b32 s29, s41
    s_mov_b32 s41, s42
    s_add_u32 s42, s42, 38912
    v_mfma_f32_16x16x32_bf16 v[244:247], v[28:31], v[56:59], v[244:247]
    s_cmp_eq_u32 s42, 155648
    s_cselect_b32 s42, 0, s42
    s_add_u32 s39, s39, 1
    s_cmp_lt_u32 s39, 15
    s_cbranch_scc1 K12_LOOP
    s_waitcnt lgkmcnt(2)
    v_mfma_f32_16x16x32_bf16 v[80:83], v[8:11], v[40:43], v[80:83]
    ds_read_b128 v[24:27], v2 offset:4096
    v_xor_b32 v72, s35, v44
    v_xor_b32 v73, s35, v45
    v_mfma_f32_16x16x32_bf16 v[84:87], v[8:11], v[44:47], v[84:87]
    ds_read_b128 v[28:31], v3 offset:4096
    v_xor_b32 v74, s35, v46
    v_xor_b32 v75, s35, v47
    v_mfma_f32_16x16x32_bf16 v[88:91], v[8:11], v[48:51], v[88:91]
    s_waitcnt lgkmcnt(2)
    v_cmp_gt_u32 vcc, s40, v68
    s_add_u32 s49, s39, 2
    s_lshr_b32 s49, s49, 1
    v_xor_b32 v76, s35, v52
    v_xor_b32 v77, s35, v53
    v_mfma_f32_16x16x32_bf16 v[92:95], v[8:11], v[52:55], v[92:95]
    s_cbranch_vccnz K12_S6
K12_Q6:
    s_mul_i32 s48, s49, s50
    s_add_u32 s48, s48, s47
    v_xor_b32 v78, s35, v54
    v_xor_b32 v79, s35, v55
    v_mfma_f32_16x16x32_bf16 v[80:83], v[12:15], v[72:75], v[80:83]
    s_add_u32 m0, s29, s36
    s_nop 0
    buffer_load_dwordx4 v1, s[8:11], s30 offen sc1 lds
    v_mfma_f32_16x16x32_bf16 v[84:87], v[12:15], v[40:43], v[84:87]
    s_cmp_lt_u32 s49, 8
    s_cselect_b32 s48, s48, 155744
    v_mfma_f32_16x16x32_bf16 v[88:91], v[12:15], v[76:79], v[88:91]
    s_cmp_ge_u32 s49, 3
    s_cselect_b32 s48, s48, 155744
    v_mfma_f32_16x16x32_bf16 v[92:95], v[12:15], v[48:51], v[92:95]
    v_mfma_f32_16x16x32_bf16 v[96:99], v[16:19], v[40:43], v[96:99]
    ds_read_b128 v[8:11], v2 offset:8192
    v_mfma_f32_16x16x32_bf16 v[100:103], v[16:19], v[44:47], v[100:103]
    ds_read_b128 v[12:15], v3 offset:8192
    v_mfma_f32_16x16x32_bf16 v[104:107], v[16:19], v[48:51], v[104:107]
    buffer_load_dwordx4 v1, s[8:11], s30 offen offset:1024 sc1 lds
    v_mfma_f32_16x16x32_bf16 v[108:111], v[16:19], v[52:55], v[108:111]
    v_mfma_f32_16x16x32_bf16 v[96:99], v[20:23], v[72:75], v[96:99]
    v_mfma_f32_16x16x32_bf16 v[100:103], v[20:23], v[40:43], v[100:103]
    v_mfma_f32_16x16x32_bf16 v[104:107], v[20:23], v[76:79], v[104:107]
    buffer_load_dwordx4 v1, s[8:11], s30 offen offset:2048 sc1 lds
    v_mfma_f32_16x16x32_bf16 v[108:111], v[20:23], v[48:51], v[108:111]
    s_waitcnt lgkmcnt(2)
    v_mfma_f32_16x16x32_bf16 v[112:115], v[24:27], v[40:43], v[112:115]
    ds_read_b128 v[16:19], v2 offset:10240
    v_mfma_f32_16x16x32_bf16 v[116:119], v[24:27], v[44:47], v[116:119]
    ds_read_b128 v[20:23], v3 offset:10240
    v_mfma_f32_16x16x32_bf16 v[120:123], v[24:27], v[48:51], v[120:123]
    v_mfma_f32_16x16x32_bf16 v[124:127], v[24:27], v[52:55], v[124:127]
    v_mfma_f32_16x16x32_bf16 v[112:115], v[28:31], v[72:75], v[112:115]
    buffer_load_dwordx4 v1, s[8:11], s30 offen offset:3072 sc1 lds
    v_mfma_f32_16x16x32_bf16 v[116:119], v[28:31], v[40:43], v[116:119]
    v_mfma_f32_16x16x32_bf16 v[120:123], v[28:31], v[76:79], v[120:123]
    v_mfma_f32_16x16x32_bf16 v[124:127], v[28:31], v[48:51], v[124:127]
    v_mfma_f32_16x16x32_bf16 v[128:131], v[32:35], v[40:43], v[128:131]
    ds_read_b128 v[24:27], v2 offset:12288
    v_mfma_f32_16x16x32_bf16 v[132:135], v[32:35], v[44:47], v[132:135]
    ds_read_b128 v[28:31], v3 offset:12288
    v_mfma_f32_16x16x32_bf16 v[136:139], v[32:35], v[48:51], v[136:139]
    s_add_u32 m0, m0, 4096
    s_add_u32 s34, s30, 4096
    buffer_load_dwordx4 v1, s[8:11], s34 offen sc1 lds
    v_mfma_f32_16x16x32_bf16 v[140:143], v[32:35], v[52:55], v[140:143]
    v_mfma_f32_16x16x32_bf16 v[128:131], v[36:39], v[72:75], v[128:131]
    v_mfma_f32_16x16x32_bf16 v[132:135], v[36:39], v[40:43], v[132:135]
    v_mfma_f32_16x16x32_bf16 v[136:139], v[36:39], v[76:79], v[136:139]
    s_add_u32 m0, s29, s37
    s_add_u32 s30, s30, 21376
    buffer_load_dwordx4 v1, s[12:15], s31 offen sc1 lds
    v_mfma_f32_16x16x32_bf16 v[140:143], v[36:39], v[48:51], v[140:143]
    s_waitcnt lgkmcnt(4)
    v_mfma_f32_16x16x32_bf16 v[144:147], v[8:11], v[40:43], v[144:147]
    ds_read_b128 v[32:35], v2 offset:14336
    v_mfma_f32_16x16x32_bf16 v[148:151], v[8:11], v[44:47], v[148:151]
    ds_read_b128 v[36:39], v3 offset:14336
    v_mfma_f32_16x16x32_bf16 v[152:155], v[8:11], v[48:51], v[152:155]
    v_mfma_f32_16x16x32_bf16 v[156:159], v[8:11], v[52:55], v[156:159]
    v_mfma_f32_16x16x32_bf16 v[144:147], v[12:15], v[72:75], v[144:147]
    buffer_load_dwordx4 v1, s[12:15], s31 offen offset:1024 sc1 lds
    v_mfma_f32_16x16x32_bf16 v[148:151], v[12:15], v[40:43], v[148:151]
    v_mfma_f32_16x16x32_bf16 v[152:155], v[12:15], v[76:79], v[152:155]
    v_mfma_f32_16x16x32_bf16 v[156:159], v[12:15], v[48:51], v[156:159]
    s_waitcnt lgkmcnt(4)
    v_mfma_f32_16x16x32_bf16 v[160:163], v[16:19], v[40:43], v[160:163]
    ds_read_b128 v[8:11], v2 offset:16384
    v_mfma_f32_16x16x32_bf16 v[164:167], v[16:19], v[44:47], v[164:167]
    ds_read_b128 v[12:15], v3 offset:16384
    v_mfma_f32_16x16x32_bf16 v[168:171], v[16:19], v[48:51], v[168:171]
    buffer_load_dwordx4 v1, s[12:15], s31 offen offset:2048 sc1 lds
    v_mfma_f32_16x16x32_bf16 v[172:175], v[16:19], v[52:55], v[172:175]
    s_add_u32 s40, s40, 1
    s_mov_b32 s51, s40
    v_mov_b32 v0, s40
    v_mfma_f32_16x16x32_bf16 v[160:163], v[20:23], v[72:75], v[160:163]
    s_waitcnt vmcnt(19)
    ds_write_b32 v7, v0
    v_mfma_f32_16x16x32_bf16 v[164:167], v[20:23], v[40:43], v[164:167]
    v_mfma_f32_16x16x32_bf16 v[168:171], v[20:23], v[76:79], v[168:171]
    buffer_load_dwordx4 v1, s[12:15], s31 offen offset:3072 sc1 lds
    v_mfma_f32_16x16x32_bf16 v[172:175], v[20:23], v[48:51], v[172:175]
    s_waitcnt lgkmcnt(5)
    v_mfma_f32_16x16x32_bf16 v[176:179], v[24:27], v[40:43], v[176:179]
    ds_read_b128 v[16:19], v2 offset:18432
    v_mfma_f32_16x16x32_bf16 v[180:183], v[24:27], v[44:47], v[180:183]
    ds_read_b128 v[20:23], v3 offset:18432
    v_mov_b32 v0, s48
    v_mfma_f32_16x16x32_bf16 v[184:187], v[24:27], v[48:51], v[184:187]
    ds_read_b32 v0, v0
    v_mfma_f32_16x16x32_bf16 v[188:191], v[24:27], v[52:55], v[188:191]
    v_mfma_f32_16x16x32_bf16 v[176:179], v[28:31], v[72:75], v[176:179]
    s_add_u32 m0, s29, s38
    s_mov_b64 exec, s[44:45]
    buffer_load_dwordx4 v1, s[64:67], s33 offen sc1 lds
    s_mov_b64 exec, -1
    s_add_u32 s31, s31, 16384
    s_add_u32 s33, s33, 21376
    v_mfma_f32_16x16x32_bf16 v[180:183], v[28:31], v[40:43], v[180:183]
    v_mfma_f32_16x16x32_bf16 v[184:187], v[28:31], v[76:79], v[184:187]
    v_mfma_f32_16x16x32_bf16 v[188:191], v[28:31], v[48:51], v[188:191]
    s_waitcnt lgkmcnt(0)
    v_cmp_eq_u32 vcc, 0, v0
    v_mfma_f32_16x16x32_bf16 v[192:195], v[32:35], v[40:43], v[192:195]
    ds_read_b128 v[24:27], v2 offset:20480
    v_mfma_f32_16x16x32_bf16 v[196:199], v[32:35], v[44:47], v[196:199]
    ds_read_b128 v[28:31], v3 offset:20480
    s_cbranch_vccnz K12_F7
K12_G7:
    v_mfma_f32_16x16x32_bf16 v[200:203], v[32:35], v[48:51], v[200:203]
    s_sub_u32 s43, s42, s41
    s_add_u32 s40, s40, 1
    v_add_u32 v2, s43, v2
    v_mfma_f32_16x16x32_bf16 v[204:207], v[32:35], v[52:55], v[204:207]
    v_add_u32 v3, s43, v3
    v_add_u32 v4, s43, v4
    v_mov_b32 v0, s40
    v_mfma_f32_16x16x32_bf16 v[192:195], v[36:39], v[72:75], v[192:195]
    ds_write_b32 v7, v0
    v_mfma_f32_16x16x32_bf16 v[196:199], v[36:39], v[40:43], v[196:199]
    v_mfma_f32_16x16x32_bf16 v[200:203], v[36:39], v[76:79], v[200:203]
    v_mfma_f32_16x16x32_bf16 v[204:207], v[36:39], v[48:51], v[204:207]
    ds_read_b32 v56, v5
    v_mfma_f32_16x16x32_bf16 v[208:211], v[8:11], v[40:43], v[208:211]
    v_mfma_f32_16x16x32_bf16 v[212:215], v[8:11], v[44:47], v[212:215]
    v_mfma_f32_16x16x32_bf16 v[216:219], v[8:11], v[48:51], v[216:219]
    v_mfma_f32_16x16x32_bf16 v[220:223], v[8:11], v[52:55], v[220:223]
    s_waitcnt lgkmcnt(0)
    v_cmp_gt_u32 vcc, s51, v56
    v_mfma_f32_16x16x32_bf16 v[208:211], v[12:15], v[72:75], v[208:211]
    v_mfma_f32_16x16x32_bf16 v[212:215], v[12:15], v[40:43], v[212:215]
    s_cbranch_vccnz K12_S8
K12_Q8:
    v_mfma_f32_16x16x32_bf16 v[216:219], v[12:15], v[76:79], v[216:219]
    ds_read_b64_tr_b16 v[56:57], v4 offset:0
    v_mfma_f32_16x16x32_bf16 v[220:223], v[12:15], v[48:51], v[220:223]
    ds_read_b64_tr_b16 v[58:59], v4 offset:2048
    v_mfma_f32_16x16x32_bf16 v[224:227], v[16:19], v[40:43], v[224:227]
    ds_read_b64_tr_b16 v[60:61], v4 offset:256
    ds_read_b128 v[8:11], v2 offset:0
    v_mfma_f32_16x16x32_bf16 v[228:231], v[16:19], v[44:47], v[228:231]
    ds_read_b64_tr_b16 v[62:63], v4 offset:2304
    ds_read_b128 v[12:15], v3 offset:0
    v_mfma_f32_16x16x32_bf16 v[232:235], v[16:19], v[48:51], v[232:235]
    v_xor_b32 v4, 32, v4
    ds_read_b128 v[32:35], v2 offset:6144
    v_mfma_f32_16x16x32_bf16 v[236:239], v[16:19], v[52:55], v[236:239]
    ds_read_b64_tr_b16 v[64:65], v4 offset:0
    ds_read_b128 v[36:39], v3 offset:6144
    v_mfma_f32_16x16x32_bf16 v[224:227], v[20:23], v[72:75], v[224:227]
    ds_read_b64_tr_b16 v[66:67], v4 offset:2048
    ds_read_b32 v52, v5
    v_mfma_f32_16x16x32_bf16 v[228:231], v[20:23], v[40:43], v[228:231]
    ds_read_b64_tr_b16 v[68:69], v4 offset:256
    ds_read_b64_tr_b16 v[70:71], v4 offset:2304
    v_xor_b32 v4, 32, v4
    v_mfma_f32_16x16x32_bf16 v[232:235], v[20:23], v[76:79], v[232:235]
    v_mfma_f32_16x16x32_bf16 v[236:239], v[20:23], v[48:51], v[236:239]
    v_mfma_f32_16x16x32_bf16 v[240:243], v[24:27], v[40:43], v[240:243]
    ds_read_b128 v[16:19], v2 offset:2048
    v_mfma_f32_16x16x32_bf16 v[244:247], v[24:27], v[44:47], v[244:247]
    ds_read_b128 v[20:23], v3 offset:2048
    v_mfma_f32_16x16x32_bf16 v[240:243], v[28:31], v[72:75], v[240:243]
    s_mov_b32 s29, s41
    s_mov_b32 s41, s42
    s_add_u32 s42, s42, 38912
    v_mfma_f32_16x16x32_bf16 v[244:247], v[28:31], v[40:43], v[244:247]
    s_cmp_eq_u32 s42, 155648
    s_cselect_b32 s42, 0, s42
    s_waitcnt lgkmcnt(2)
    v_mfma_f32_16x16x32_bf16 v[80:83], v[8:11], v[56:59], v[80:83]
    ds_read_b128 v[24:27], v2 offset:4096
    v_xor_b32 v72, s35, v60
    v_xor_b32 v73, s35, v61
    v_mfma_f32_16x16x32_bf16 v[84:87], v[8:11], v[60:63], v[84:87]
    ds_read_b128 v[28:31], v3 offset:4096
    v_xor_b32 v74, s35, v62
    v_xor_b32 v75, s35, v63
    v_mfma_f32_16x16x32_bf16 v[88:91], v[8:11], v[64:67], v[88:91]
    v_xor_b32 v76, s35, v68
    v_xor_b32 v77, s35, v69
    v_mfma_f32_16x16x32_bf16 v[92:95], v[8:11], v[68:71], v[92:95]
    v_xor_b32 v78, s35, v70
    v_xor_b32 v79, s35, v71
    v_mfma_f32_16x16x32_bf16 v[80:83], v[12:15], v[72:75], v[80:83]
    v_lshrrev_b32 v0, 4, v1
    v_and_b32 v5, 15, v0
    v_mfma_f32_16x16x32_bf16 v[84:87], v[12:15], v[56:59], v[84:87]
    v_lshrrev_b32 v0, 4, v0
    s_lshl_b32 s28, s21, 7
    v_mfma_f32_16x16x32_bf16 v[88:91], v[12:15], v[76:79], v[88:91]
    s_lshl_b32 s29, s3, 5
    s_add_u32 s28, s28, s29
    v_mfma_f32_16x16x32_bf16 v[92:95], v[12:15], v[64:67], v[92:95]
    v_add_u32 v5, s28, v5
    v_lshlrev_b32 v5, 2, v5
    s_waitcnt lgkmcnt(2)
    v_mfma_f32_16x16x32_bf16 v[96:99], v[16:19], v[56:59], v[96:99]
    ds_read_b128 v[8:11], v2 offset:8192
    v_lshl_add_u32 v5, v0, 13, v5
    s_lshl_b32 s28, s20, 6
    v_mfma_f32_16x16x32_bf16 v[100:103], v[16:19], v[60:63], v[100:103]
    ds_read_b128 v[12:15], v3 offset:8192
    v_xor_b32 v5, s28, v5
    v_xor_b32 v7, 64, v5
    v_mfma_f32_16x16x32_bf16 v[104:107], v[16:19], v[64:67], v[104:107]
    v_mfma_f32_16x16x32_bf16 v[108:111], v[16:19], v[68:71], v[108:111]
    s_mov_b32 s38, 0
    v_cvt_pk_bf16_f32 v48, v80, v84
    buffer_store_dword v48, v5, s[16:19], s38 offen offset:0 sc1
    v_cvt_pk_bf16_f32 v49, v88, v92
    buffer_store_dword v49, v7, s[16:19], s38 offen offset:0 sc1
    v_mfma_f32_16x16x32_bf16 v[96:99], v[20:23], v[72:75], v[96:99]
    v_cvt_pk_bf16_f32 v50, v81, v85
    buffer_store_dword v50, v5, s[16:19], s38 offen offset:2048 sc1
    v_mfma_f32_16x16x32_bf16 v[100:103], v[20:23], v[56:59], v[100:103]
    v_cvt_pk_bf16_f32 v51, v89, v93
    buffer_store_dword v51, v7, s[16:19], s38 offen offset:2048 sc1
    v_mfma_f32_16x16x32_bf16 v[104:107], v[20:23], v[76:79], v[104:107]
    s_mov_b32 s38, 4096
    v_cvt_pk_bf16_f32 v52, v82, v86
    buffer_store_dword v52, v5, s[16:19], s38 offen offset:0 sc1
    v_cvt_pk_bf16_f32 v53, v90, v94
    buffer_store_dword v53, v7, s[16:19], s38 offen offset:0 sc1
    v_mfma_f32_16x16x32_bf16 v[108:111], v[20:23], v[64:67], v[108:111]
    v_cvt_pk_bf16_f32 v54, v83, v87
    buffer_store_dword v54, v5, s[16:19], s38 offen offset:2048 sc1
    s_waitcnt lgkmcnt(2)
    v_mfma_f32_16x16x32_bf16 v[112:115], v[24:27], v[56:59], v[112:115]
    ds_read_b128 v[16:19], v2 offset:10240
    v_cvt_pk_bf16_f32 v55, v91, v95
    buffer_store_dword v55, v7, s[16:19], s38 offen offset:2048 sc1
    v_mfma_f32_16x16x32_bf16 v[116:119], v[24:27], v[60:63], v[116:119]
    ds_read_b128 v[20:23], v3 offset:10240
    v_mfma_f32_16x16x32_bf16 v[120:123], v[24:27], v[64:67], v[120:123]
    v_mfma_f32_16x16x32_bf16 v[124:127], v[24:27], v[68:71], v[124:127]
    s_mov_b32 s38, 32768
    v_cvt_pk_bf16_f32 v40, v96, v100
    buffer_store_dword v40, v5, s[16:19], s38 offen offset:0 sc1
    v_cvt_pk_bf16_f32 v41, v104, v108
    buffer_store_dword v41, v7, s[16:19], s38 offen offset:0 sc1
    v_mfma_f32_16x16x32_bf16 v[112:115], v[28:31], v[72:75], v[112:115]
    v_cvt_pk_bf16_f32 v42, v97, v101
    buffer_store_dword v42, v5, s[16:19], s38 offen offset:2048 sc1
    v_mfma_f32_16x16x32_bf16 v[116:119], v[28:31], v[56:59], v[116:119]
    v_cvt_pk_bf16_f32 v43, v105, v109
    buffer_store_dword v43, v7, s[16:19], s38 offen offset:2048 sc1
    v_mfma_f32_16x16x32_bf16 v[120:123], v[28:31], v[76:79], v[120:123]
    s_mov_b32 s38, 36864
    v_cvt_pk_bf16_f32 v44, v98, v102
    buffer_store_dword v44, v5, s[16:19], s38 offen offset:0 sc1
    v_cvt_pk_bf16_f32 v45, v106, v110
    buffer_store_dword v45, v7, s[16:19], s38 offen offset:0 sc1
    v_mfma_f32_16x16x32_bf16 v[124:127], v[28:31], v[64:67], v[124:127]
    v_cvt_pk_bf16_f32 v46, v99, v103
    buffer_store_dword v46, v5, s[16:19], s38 offen offset:2048 sc1
    v_mfma_f32_16x16x32_bf16 v[128:131], v[32:35], v[56:59], v[128:131]
    ds_read_b128 v[24:27], v2 offset:12288
    v_cvt_pk_bf16_f32 v47, v107, v111
    buffer_store_dword v47, v7, s[16:19], s38 offen offset:2048 sc1
    v_mfma_f32_16x16x32_bf16 v[132:135], v[32:35], v[60:63], v[132:135]
    ds_read_b128 v[28:31], v3 offset:12288
    v_mfma_f32_16x16x32_bf16 v[136:139], v[32:35], v[64:67], v[136:139]
    v_mfma_f32_16x16x32_bf16 v[140:143], v[32:35], v[68:71], v[140:143]
    s_mov_b32 s38, 65536
    v_cvt_pk_bf16_f32 v48, v112, v116
    buffer_store_dword v48, v5, s[16:19], s38 offen offset:0 sc1
    v_cvt_pk_bf16_f32 v49, v120, v124
    buffer_store_dword v49, v7, s[16:19], s38 offen offset:0 sc1
    v_mfma_f32_16x16x32_bf16 v[128:131], v[36:39], v[72:75], v[128:131]
    v_cvt_pk_bf16_f32 v50, v113, v117
    buffer_store_dword v50, v5, s[16:19], s38 offen offset:2048 sc1
    v_mfma_f32_16x16x32_bf16 v[132:135], v[36:39], v[56:59], v[132:135]
    v_cvt_pk_bf16_f32 v51, v121, v125
    buffer_store_dword v51, v7, s[16:19], s38 offen offset:2048 sc1
    v_mfma_f32_16x16x32_bf16 v[136:139], v[36:39], v[76:79], v[136:139]
    s_mov_b32 s38, 69632
    v_cvt_pk_bf16_f32 v52, v114, v118
    buffer_store_dword v52, v5, s[16:19], s38 offen offset:0 sc1
    v_cvt_pk_bf16_f32 v53, v122, v126
    buffer_store_dword v53, v7, s[16:19], s38 offen offset:0 sc1
    v_mfma_f32_16x16x32_bf16 v[140:143], v[36:39], v[64:67], v[140:143]
    v_cvt_pk_bf16_f32 v54, v115, v119
    buffer_store_dword v54, v5, s[16:19], s38 offen offset:2048 sc1
    s_waitcnt lgkmcnt(4)
    v_mfma_f32_16x16x32_bf16 v[144:147], v[8:11], v[56:59], v[144:147]
    ds_read_b128 v[32:35], v2 offset:14336
    v_cvt_pk_bf16_f32 v55, v123, v127
    buffer_store_dword v55, v7, s[16:19], s38 offen offset:2048 sc1
    v_mfma_f32_16x16x32_bf16 v[148:151], v[8:11], v[60:63], v[148:151]
    ds_read_b128 v[36:39], v3 offset:14336
    v_mfma_f32_16x16x32_bf16 v[152:155], v[8:11], v[64:67], v[152:155]
    v_mfma_f32_16x16x32_bf16 v[156:159], v[8:11], v[68:71], v[156:159]
    s_mov_b32 s38, 98304
    v_cvt_pk_bf16_f32 v40, v128, v132
    buffer_store_dword v40, v5, s[16:19], s38 offen offset:0 sc1
    v_cvt_pk_bf16_f32 v41, v136, v140
    buffer_store_dword v41, v7, s[16:19], s38 offen offset:0 sc1
    v_mfma_f32_16x16x32_bf16 v[144:147], v[12:15], v[72:75], v[144:147]
    v_cvt_pk_bf16_f32 v42, v129, v133
    buffer_store_dword v42, v5, s[16:19], s38 offen offset:2048 sc1
    v_mfma_f32_16x16x32_bf16 v[148:151], v[12:15], v[56:59], v[148:151]
    v_cvt_pk_bf16_f32 v43, v137, v141
    buffer_store_dword v43, v7, s[16:19], s38 offen offset:2048 sc1
    v_mfma_f32_16x16x32_bf16 v[152:155], v[12:15], v[76:79], v[152:155]
    s_mov_b32 s38, 102400
    v_cvt_pk_bf16_f32 v44, v130, v134
    buffer_store_dword v44, v5, s[16:19], s38 offen offset:0 sc1
    v_cvt_pk_bf16_f32 v45, v138, v142
    buffer_store_dword v45, v7, s[16:19], s38 offen offset:0 sc1
    v_mfma_f32_16x16x32_bf16 v[156:159], v[12:15], v[64:67], v[156:159]
    v_cvt_pk_bf16_f32 v46, v131, v135
    buffer_store_dword v46, v5, s[16:19], s38 offen offset:2048 sc1
    s_waitcnt lgkmcnt(4)
    v_mfma_f32_16x16x32_bf16 v[160:163], v[16:19], v[56:59], v[160:163]
    ds_read_b128 v[8:11], v2 offset:16384
    v_cvt_pk_bf16_f32 v47, v139, v143
    buffer_store_dword v47, v7, s[16:19], s38 offen offset:2048 sc1
    v_mfma_f32_16x16x32_bf16 v[164:167], v[16:19], v[60:63], v[164:167]
    ds_read_b128 v[12:15], v3 offset:16384
    v_mfma_f32_16x16x32_bf16 v[168:171], v[16:19], v[64:67], v[168:171]
    v_mfma_f32_16x16x32_bf16 v[172:175], v[16:19], v[68:71], v[172:175]
    s_mov_b32 s38, 131072
    v_cvt_pk_bf16_f32 v48, v144, v148
    buffer_store_dword v48, v5, s[16:19], s38 offen offset:0 sc1
    v_cvt_pk_bf16_f32 v49, v152, v156
    buffer_store_dword v49, v7, s[16:19], s38 offen offset:0 sc1
    v_mfma_f32_16x16x32_bf16 v[160:163], v[20:23], v[72:75], v[160:163]
    v_cvt_pk_bf16_f32 v50, v145, v149
    buffer_store_dword v50, v5, s[16:19], s38 offen offset:2048 sc1
    v_mfma_f32_16x16x32_bf16 v[164:167], v[20:23], v[56:59], v[164:167]
    v_cvt_pk_bf16_f32 v51, v153, v157
    buffer_store_dword v51, v7, s[16:19], s38 offen offset:2048 sc1
    v_mfma_f32_16x16x32_bf16 v[168:171], v[20:23], v[76:79], v[168:171]
    s_mov_b32 s38, 135168
    v_cvt_pk_bf16_f32 v52, v146, v150
    buffer_store_dword v52, v5, s[16:19], s38 offen offset:0 sc1
    v_cvt_pk_bf16_f32 v53, v154, v158
    buffer_store_dword v53, v7, s[16:19], s38 offen offset:0 sc1
    v_mfma_f32_16x16x32_bf16 v[172:175], v[20:23], v[64:67], v[172:175]
    v_cvt_pk_bf16_f32 v54, v147, v151
    buffer_store_dword v54, v5, s[16:19], s38 offen offset:2048 sc1
    s_waitcnt lgkmcnt(4)
    v_mfma_f32_16x16x32_bf16 v[176:179], v[24:27], v[56:59], v[176:179]
    ds_read_b128 v[16:19], v2 offset:18432
    v_cvt_pk_bf16_f32 v55, v155, v159
    buffer_store_dword v55, v7, s[16:19], s38 offen offset:2048 sc1
    v_mfma_f32_16x16x32_bf16 v[180:183], v[24:27], v[60:63], v[180:183]
    ds_read_b128 v[20:23], v3 offset:18432
    v_mfma_f32_16x16x32_bf16 v[184:187], v[24:27], v[64:67], v[184:187]
    v_mfma_f32_16x16x32_bf16 v[188:191], v[24:27], v[68:71], v[188:191]
    s_mov_b32 s38, 163840
    v_cvt_pk_bf16_f32 v40, v160, v164
    buffer_store_dword v40, v5, s[16:19], s38 offen offset:0 sc1
    v_cvt_pk_bf16_f32 v41, v168, v172
    buffer_store_dword v41, v7, s[16:19], s38 offen offset:0 sc1
    v_mfma_f32_16x16x32_bf16 v[176:179], v[28:31], v[72:75], v[176:179]
    v_cvt_pk_bf16_f32 v42, v161, v165
    buffer_store_dword v42, v5, s[16:19], s38 offen offset:2048 sc1
    v_mfma_f32_16x16x32_bf16 v[180:183], v[28:31], v[56:59], v[180:183]
    v_cvt_pk_bf16_f32 v43, v169, v173
    buffer_store_dword v43, v7, s[16:19], s38 offen offset:2048 sc1
    v_mfma_f32_16x16x32_bf16 v[184:187], v[28:31], v[76:79], v[184:187]
    s_mov_b32 s38, 167936
    v_cvt_pk_bf16_f32 v44, v162, v166
    buffer_store_dword v44, v5, s[16:19], s38 offen offset:0 sc1
    v_cvt_pk_bf16_f32 v45, v170, v174
    buffer_store_dword v45, v7, s[16:19], s38 offen offset:0 sc1
    v_mfma_f32_16x16x32_bf16 v[188:191], v[28:31], v[64:67], v[188:191]
    v_cvt_pk_bf16_f32 v46, v163, v167
    buffer_store_dword v46, v5, s[16:19], s38 offen offset:2048 sc1
    s_waitcnt lgkmcnt(4)
    v_mfma_f32_16x16x32_bf16 v[192:195], v[32:35], v[56:59], v[192:195]
    ds_read_b128 v[24:27], v2 offset:20480
    v_cvt_pk_bf16_f32 v47, v171, v175
    buffer_store_dword v47, v7, s[16:19], s38 offen offset:2048 sc1
    v_mfma_f32_16x16x32_bf16 v[196:199], v[32:35], v[60:63], v[196:199]
    ds_read_b128 v[28:31], v3 offset:20480
    v_mfma_f32_16x16x32_bf16 v[200:203], v[32:35], v[64:67], v[200:203]
    v_mfma_f32_16x16x32_bf16 v[204:207], v[32:35], v[68:71], v[204:207]
    s_mov_b32 s38, 196608
    v_cvt_pk_bf16_f32 v48, v176, v180
    buffer_store_dword v48, v5, s[16:19], s38 offen offset:0 sc1
    v_cvt_pk_bf16_f32 v49, v184, v188
    buffer_store_dword v49, v7, s[16:19], s38 offen offset:0 sc1
    v_mfma_f32_16x16x32_bf16 v[192:195], v[36:39], v[72:75], v[192:195]
    v_cvt_pk_bf16_f32 v50, v177, v181
    buffer_store_dword v50, v5, s[16:19], s38 offen offset:2048 sc1
    v_mfma_f32_16x16x32_bf16 v[196:199], v[36:39], v[56:59], v[196:199]
    v_cvt_pk_bf16_f32 v51, v185, v189
    buffer_store_dword v51, v7, s[16:19], s38 offen offset:2048 sc1
    v_mfma_f32_16x16x32_bf16 v[200:203], v[36:39], v[76:79], v[200:203]
    s_mov_b32 s38, 200704
    v_cvt_pk_bf16_f32 v52, v178, v182
    buffer_store_dword v52, v5, s[16:19], s38 offen offset:0 sc1
    v_cvt_pk_bf16_f32 v53, v186, v190
    buffer_store_dword v53, v7, s[16:19], s38 offen offset:0 sc1
    v_mfma_f32_16x16x32_bf16 v[204:207], v[36:39], v[64:67], v[204:207]
    v_cvt_pk_bf16_f32 v54, v179, v183
    buffer_store_dword v54, v5, s[16:19], s38 offen offset:2048 sc1
    s_waitcnt lgkmcnt(4)
    v_mfma_f32_16x16x32_bf16 v[208:211], v[8:11], v[56:59], v[208:211]
    v_cvt_pk_bf16_f32 v55, v187, v191
    buffer_store_dword v55, v7, s[16:19], s38 offen offset:2048 sc1
    v_mfma_f32_16x16x32_bf16 v[212:215], v[8:11], v[60:63], v[212:215]
    v_mfma_f32_16x16x32_bf16 v[216:219], v[8:11], v[64:67], v[216:219]
    v_mfma_f32_16x16x32_bf16 v[220:223], v[8:11], v[68:71], v[220:223]
    s_mov_b32 s38, 229376
    v_cvt_pk_bf16_f32 v40, v192, v196
    buffer_store_dword v40, v5, s[16:19], s38 offen offset:0 sc1
    v_cvt_pk_bf16_f32 v41, v200, v204
    buffer_store_dword v41, v7, s[16:19], s38 offen offset:0 sc1
    v_mfma_f32_16x16x32_bf16 v[208:211], v[12:15], v[72:75], v[208:211]
    v_cvt_pk_bf16_f32 v42, v193, v197
    buffer_store_dword v42, v5, s[16:19], s38 offen offset:2048 sc1
    v_mfma_f32_16x16x32_bf16 v[212:215], v[12:15], v[56:59], v[212:215]
    v_cvt_pk_bf16_f32 v43, v201, v205
    buffer_store_dword v43, v7, s[16:19], s38 offen offset:2048 sc1
    v_mfma_f32_16x16x32_bf16 v[216:219], v[12:15], v[76:79], v[216:219]
    s_mov_b32 s38, 233472
    v_cvt_pk_bf16_f32 v44, v194, v198
    buffer_store_dword v44, v5, s[16:19], s38 offen offset:0 sc1
    v_cvt_pk_bf16_f32 v45, v202, v206
    buffer_store_dword v45, v7, s[16:19], s38 offen offset:0 sc1
    v_mfma_f32_16x16x32_bf16 v[220:223], v[12:15], v[64:67], v[220:223]
    v_cvt_pk_bf16_f32 v46, v195, v199
    buffer_store_dword v46, v5, s[16:19], s38 offen offset:2048 sc1
    s_waitcnt lgkmcnt(2)
    v_mfma_f32_16x16x32_bf16 v[224:227], v[16:19], v[56:59], v[224:227]
    v_cvt_pk_bf16_f32 v47, v203, v207
    buffer_store_dword v47, v7, s[16:19], s38 offen offset:2048 sc1
    v_mfma_f32_16x16x32_bf16 v[228:231], v[16:19], v[60:63], v[228:231]
    v_mfma_f32_16x16x32_bf16 v[232:235], v[16:19], v[64:67], v[232:235]
    v_mfma_f32_16x16x32_bf16 v[236:239], v[16:19], v[68:71], v[236:239]
    s_mov_b32 s38, 262144
    v_cvt_pk_bf16_f32 v48, v208, v212
    buffer_store_dword v48, v5, s[16:19], s38 offen offset:0 sc1
    v_cvt_pk_bf16_f32 v49, v216, v220
    buffer_store_dword v49, v7, s[16:19], s38 offen offset:0 sc1
    v_mfma_f32_16x16x32_bf16 v[224:227], v[20:23], v[72:75], v[224:227]
    v_cvt_pk_bf16_f32 v50, v209, v213
    buffer_store_dword v50, v5, s[16:19], s38 offen offset:2048 sc1
    v_mfma_f32_16x16x32_bf16 v[228:231], v[20:23], v[56:59], v[228:231]
    v_cvt_pk_bf16_f32 v51, v217, v221
    buffer_store_dword v51, v7, s[16:19], s38 offen offset:2048 sc1
    v_mfma_f32_16x16x32_bf16 v[232:235], v[20:23], v[76:79], v[232:235]
    s_mov_b32 s38, 266240
    v_cvt_pk_bf16_f32 v52, v210, v214
    buffer_store_dword v52, v5, s[16:19], s38 offen offset:0 sc1
    v_cvt_pk_bf16_f32 v53, v218, v222
    buffer_store_dword v53, v7, s[16:19], s38 offen offset:0 sc1
    v_mfma_f32_16x16x32_bf16 v[236:239], v[20:23], v[64:67], v[236:239]
    v_cvt_pk_bf16_f32 v54, v211, v215
    buffer_store_dword v54, v5, s[16:19], s38 offen offset:2048 sc1
    s_waitcnt lgkmcnt(0)
    v_mfma_f32_16x16x32_bf16 v[240:243], v[24:27], v[56:59], v[240:243]
    v_cvt_pk_bf16_f32 v55, v219, v223
    buffer_store_dword v55, v7, s[16:19], s38 offen offset:2048 sc1
    v_mfma_f32_16x16x32_bf16 v[244:247], v[24:27], v[60:63], v[244:247]
    v_mfma_f32_16x16x32_bf16 v[240:243], v[28:31], v[72:75], v[240:243]
    v_mfma_f32_16x16x32_bf16 v[244:247], v[28:31], v[56:59], v[244:247]
    s_mov_b32 s38, 294912
    v_cvt_pk_bf16_f32 v40, v224, v228
    buffer_store_dword v40, v5, s[16:19], s38 offen offset:0 sc1
    v_cvt_pk_bf16_f32 v41, v232, v236
    buffer_store_dword v41, v7, s[16:19], s38 offen offset:0 sc1
    v_cvt_pk_bf16_f32 v42, v225, v229
    buffer_store_dword v42, v5, s[16:19], s38 offen offset:2048 sc1
    v_cvt_pk_bf16_f32 v43, v233, v237
    buffer_store_dword v43, v7, s[16:19], s38 offen offset:2048 sc1
    s_mov_b32 s38, 299008
    v_cvt_pk_bf16_f32 v44, v226, v230
    buffer_store_dword v44, v5, s[16:19], s38 offen offset:0 sc1
    v_cvt_pk_bf16_f32 v45, v234, v238
    buffer_store_dword v45, v7, s[16:19], s38 offen offset:0 sc1
    v_cvt_pk_bf16_f32 v46, v227, v231
    buffer_store_dword v46, v5, s[16:19], s38 offen offset:2048 sc1
    v_cvt_pk_bf16_f32 v47, v235, v239
    buffer_store_dword v47, v7, s[16:19], s38 offen offset:2048 sc1
    s_nop 7
    s_lshl_b32 s34, s27, 1
    s_mul_i32 s34, s34, 342016
    s_add_u32 s34, s34, 118489088
    s_add_u32 s64, s58, s34
    s_addc_u32 s65, s59, 0
    s_and_b32 s65, s65, 0xffff
    s_mov_b32 s66, 684032
    s_mov_b32 s67, 0x00020000
    v_lshrrev_b32 v8, 8, v1
    v_lshlrev_b32 v9, 13, v8
    v_sub_u32 v9, v5, v9
    v_lshlrev_b32 v8, 2, v8
    v_add_u32 v8, 160, v8
    v_add_u32 v10, 0, v8
    v_add_u32 v11, 160, v10
    v_cmp_gt_u32 vcc, 167, v10
    s_nop 1
    v_cndmask_b32 v11, v11, v10, vcc
    v_cmp_gt_u32 vcc, 174, v10
    v_mov_b32 v12, 0x7ffff
    s_nop 0
    v_cndmask_b32 v11, v12, v11, vcc
    v_lshl_add_u32 v16, v11, 11, v9
    v_add_u32 v10, 1, v8
    v_add_u32 v11, 160, v10
    v_cmp_gt_u32 vcc, 167, v10
    s_nop 1
    v_cndmask_b32 v11, v11, v10, vcc
    v_cmp_gt_u32 vcc, 174, v10
    v_mov_b32 v12, 0x7ffff
    s_nop 0
    v_cndmask_b32 v11, v12, v11, vcc
    v_lshl_add_u32 v17, v11, 11, v9
    v_add_u32 v10, 2, v8
    v_add_u32 v11, 160, v10
    v_cmp_gt_u32 vcc, 167, v10
    s_nop 1
    v_cndmask_b32 v11, v11, v10, vcc
    v_cmp_gt_u32 vcc, 174, v10
    v_mov_b32 v12, 0x7ffff
    s_nop 0
    v_cndmask_b32 v11, v12, v11, vcc
    v_lshl_add_u32 v18, v11, 11, v9
    v_add_u32 v10, 3, v8
    v_add_u32 v11, 160, v10
    v_cmp_gt_u32 vcc, 167, v10
    s_nop 1
    v_cndmask_b32 v11, v11, v10, vcc
    v_cmp_gt_u32 vcc, 174, v10
    v_mov_b32 v12, 0x7ffff
    s_nop 0
    v_cndmask_b32 v11, v12, v11, vcc
    v_lshl_add_u32 v19, v11, 11, v9
    v_cvt_pk_bf16_f32 v20, v240, v244
    buffer_store_dword v20, v16, s[64:67], 0 offen sc1
    v_cvt_pk_bf16_f32 v21, v241, v245
    buffer_store_dword v21, v17, s[64:67], 0 offen sc1
    v_cvt_pk_bf16_f32 v22, v242, v246
    buffer_store_dword v22, v18, s[64:67], 0 offen sc1
    v_cvt_pk_bf16_f32 v23, v243, v247
    buffer_store_dword v23, v19, s[64:67], 0 offen sc1
    s_endpgm
K12_S0:
    s_mov_b32 s61, 16384
    s_add_u32 s62, s62, 1
K12_S0_L:
    ds_read_b32 v56, v5
    s_waitcnt lgkmcnt(0)
    v_cmp_gt_u32 vcc, s40, v56
    s_sub_u32 s61, s61, 1
    s_cmp_eq_u32 s61, 0
    s_cbranch_scc1 K12_Q0
    s_cbranch_vccz K12_Q0
    s_branch K12_S0_L
K12_S1:
    s_mov_b32 s61, 16384
    s_add_u32 s62, s62, 1
K12_S1_L:
    ds_read_b32 v68, v5
    s_waitcnt lgkmcnt(0)
    v_cmp_gt_u32 vcc, s40, v68
    s_sub_u32 s61, s61, 1
    s_cmp_eq_u32 s61, 0
    s_cbranch_scc1 K12_Q1
    s_cbranch_vccz K12_Q1
    s_branch K12_S1_L
K12_F2:
    s_mov_b32 s61, 16384
    s_add_u32 s63, s63, 1
K12_F2_L:
    s_mov_b32 m0, s46
    s_mov_b64 exec, 0xff
    buffer_load_dword v1, s[4:7], 0 offen sc1 lds
    s_mov_b64 exec, -1
    s_waitcnt vmcnt(0)
    v_mov_b32 v0, s48
    ds_read_b32 v0, v0
    s_waitcnt lgkmcnt(0)
    v_cmp_eq_u32 vcc, 0, v0
    s_sub_u32 s61, s61, 1
    s_cmp_eq_u32 s61, 0
    s_cbranch_scc1 K12_F2_X
    s_cbranch_vccz K12_F2_X
    s_sleep 2
    s_branch K12_F2_L
K12_F2_X:
    s_branch K12_G2
K12_S3:
    s_mov_b32 s61, 16384
    s_add_u32 s62, s62, 1
K12_S3_L:
    ds_read_b32 v56, v5
    s_waitcnt lgkmcnt(0)
    v_cmp_gt_u32 vcc, s51, v56
    s_sub_u32 s61, s61, 1
    s_cmp_eq_u32 s61, 0
    s_cbranch_scc1 K12_Q3
    s_cbranch_vccz K12_Q3
    s_branch K12_S3_L
K12_S4:
    s_mov_b32 s61, 16384
    s_add_u32 s62, s62, 1
K12_S4_L:
    ds_read_b32 v52, v5
    s_waitcnt lgkmcnt(0)
    v_cmp_gt_u32 vcc, s40, v52
    s_sub_u32 s61, s61, 1
    s_cmp_eq_u32 s61, 0
    s_cbranch_scc1 K12_Q4
    s_cbranch_vccz K12_Q4
    s_branch K12_S4_L
K12_S5:
    s_mov_b32 s61, 16384
    s_add_u32 s62, s62, 1
K12_S5_L:
    ds_read_b32 v40, v5
    s_waitcnt lgkmcnt(0)
    v_cmp_gt_u32 vcc, s51, v40
    s_sub_u32 s61, s61, 1
    s_cmp_eq_u32 s61, 0
    s_cbranch_scc1 K12_Q5
    s_cbranch_vccz K12_Q5
    s_branch K12_S5_L
K12_S6:
    s_mov_b32 s61, 16384
    s_add_u32 s62, s62, 1
K12_S6_L:
    ds_read_b32 v68, v5
    s_waitcnt lgkmcnt(0)
    v_cmp_gt_u32 vcc, s40, v68
    s_sub_u32 s61, s61, 1
    s_cmp_eq_u32 s61, 0
    s_cbranch_scc1 K12_Q6
    s_cbranch_vccz K12_Q6
    s_branch K12_S6_L
K12_F7:
    s_mov_b32 s61, 16384
    s_add_u32 s63, s63, 1
K12_F7_L:
    s_mov_b32 m0, s46
    s_mov_b64 exec, 0xff
    buffer_load_dword v1, s[4:7], 0 offen sc1 lds
    s_mov_b64 exec, -1
    s_waitcnt vmcnt(0)
    v_mov_b32 v0, s48
    ds_read_b32 v0, v0
    s_waitcnt lgkmcnt(0)
    v_cmp_eq_u32 vcc, 0, v0
    s_sub_u32 s61, s61, 1
    s_cmp_eq_u32 s61, 0
    s_cbranch_scc1 K12_F7_X
    s_cbranch_vccz K12_F7_X
    s_sleep 2
    s_branch K12_F7_L
K12_F7_X:
    s_branch K12_G7
K12_S8:
    s_mov_b32 s61, 16384
    s_add_u32 s62, s62, 1
K12_S8_L:
    ds_read_b32 v56, v5
    s_waitcnt lgkmcnt(0)
    v_cmp_gt_u32 vcc, s51, v56
    s_sub_u32 s61, s61, 1
    s_cmp_eq_u32 s61, 0
    s_cbranch_scc1 K12_Q8
    s_cbranch_vccz K12_Q8
    s_branch K12_S8_L
K12_END:
    s_endpgm
.p2align 8
.type k34_out_kernel,@function
k34_out_kernel:
    s_cmp_ge_u32 s2, 256
    s_cbranch_scc1 K34_END
    s_load_dwordx2 s[4:5], s[0:1], 48
    s_load_dwordx4 s[40:43], s[0:1], 16
    s_load_dwordx2 s[44:45], s[0:1], 32
    v_lshrrev_b32 v1, 6, v0
    v_and_b32 v2, 63, v0
    v_readfirstlane_b32 s3, v1
    s_and_b32 s6, s2, 15
    s_lshr_b32 s7, s2, 4
    s_lshr_b32 s20, s6, 3
    s_and_b32 s21, s6, 7
    s_mul_i32 s22, s7, 11
    s_mul_i32 s23, s7, 10
    s_add_u32 s23, s23, 7
    s_cmp_lt_u32 s7, 7
    s_cselect_b32 s22, s22, s23
    s_cselect_b32 s23, 11, 10
    s_add_u32 s22, s22, s3
    v_and_b32 v3, 15, v2
    v_lshrrev_b32 v4, 4, v2
    v_lshlrev_b32 v5, 4, v2
    s_mov_b32 s24, 2736128
    v_mul_lo_u32 v6, v4, s24
    v_lshl_add_u32 v6, v3, 4, v6
    s_mul_i32 s25, s20, 167
    s_add_u32 s25, s25, s22
    s_lshl_b32 s25, s25, 11
    s_lshl_b32 s24, s21, 8
    s_add_u32 s25, s25, s24
    s_waitcnt lgkmcnt(0)
    s_add_u32 s8, s4, 118489088
    s_addc_u32 s9, s5, 0
    s_and_b32 s9, s9, 0xffff
    s_mov_b32 s10, 21889024
    s_mov_b32 s11, 0x00020000
    s_add_u32 s12, s4, 153616384
    s_addc_u32 s13, s5, 0
    s_and_b32 s13, s13, 0xffff
    s_mov_b32 s14, 131072
    s_mov_b32 s15, 0x00020000
    s_cmp_lt_u32 s3, s23
    s_cbranch_scc0 K34_NOLOAD
    buffer_load_dwordx4 v[16:19], v6, s[8:11], s25 offen
    s_add_u32 s25, s25, 684032
    buffer_load_dwordx4 v[20:23], v6, s[8:11], s25 offen
    s_add_u32 s25, s25, 684032
    buffer_load_dwordx4 v[24:27], v6, s[8:11], s25 offen
    s_add_u32 s25, s25, 684032
    buffer_load_dwordx4 v[28:31], v6, s[8:11], s25 offen
    s_add_u32 s25, s25, 8892416
    buffer_load_dwordx4 v[32:35], v6, s[8:11], s25 offen
    s_add_u32 s25, s25, 684032
    buffer_load_dwordx4 v[36:39], v6, s[8:11], s25 offen
    s_add_u32 s25, s25, 684032
    buffer_load_dwordx4 v[40:43], v6, s[8:11], s25 offen
    s_add_u32 s25, s25, 684032
    buffer_load_dwordx4 v[44:47], v6, s[8:11], s25 offen
K34_NOLOAD:
    s_cmp_lg_u32 s3, 0
    s_cbranch_scc1 K34_TAB
    s_mov_b32 s16, s40
    s_mov_b32 s17, s41
    s_and_b32 s17, s17, 0xffff
    s_mov_b32 s18, 1024
    s_mov_b32 s19, 0x00020000
    s_mov_b32 s28, s42
    s_mov_b32 s29, s43
    s_and_b32 s29, s29, 0xffff
    s_mov_b32 s30, 1024
    s_mov_b32 s31, 0x00020000
    s_lshl_b32 s24, s21, 7
    v_lshlrev_b32 v8, 1, v2
    buffer_load_ushort v152, v8, s[16:19], s24 offen
    buffer_load_ushort v153, v8, s[28:31], s24 offen
    s_branch K34_TABDONE
K34_TAB:
    s_cmp_ge_u32 s3, 7
    s_cbranch_scc1 K34_TABDONE
    s_sub_u32 s27, s3, 1
    s_lshr_b32 s28, s27, 1
    s_and_b32 s29, s27, 1
    s_lshl_b32 s30, s28, 4
    v_add_u32 v8, s30, v3
    s_lshl_b32 s30, s29, 5
    s_add_u32 s30, s30, 1
    v_lshlrev_b32 v9, 3, v4
    v_add_u32 v9, s30, v9
    v_mul_u32_u24 v9, v8, v9
    v_lshlrev_b32 v8, 1, v8
    v_mad_u32_u24 v48, v8, 0, v9
    v_mad_u32_u24 v49, v8, 0, v9
    v_add_u32 v49, 32, v49
    v_mad_u32_u24 v50, v8, 1, v9
    v_mad_u32_u24 v51, v8, 1, v9
    v_add_u32 v51, 32, v51
    v_mad_u32_u24 v52, v8, 2, v9
    v_mad_u32_u24 v53, v8, 2, v9
    v_add_u32 v53, 32, v53
    v_mad_u32_u24 v54, v8, 3, v9
    v_mad_u32_u24 v55, v8, 3, v9
    v_add_u32 v55, 32, v55
    v_and_b32 v48, 127, v48
    v_and_b32 v49, 127, v49
    v_and_b32 v50, 127, v50
    v_and_b32 v51, 127, v51
    v_and_b32 v52, 127, v52
    v_and_b32 v53, 127, v53
    v_and_b32 v54, 127, v54
    v_and_b32 v55, 127, v55
    v_cvt_f32_u32 v48, v48
    v_cvt_f32_u32 v49, v49
    v_cvt_f32_u32 v50, v50
    v_cvt_f32_u32 v51, v51
    v_cvt_f32_u32 v52, v52
    v_cvt_f32_u32 v53, v53
    v_cvt_f32_u32 v54, v54
    v_cvt_f32_u32 v55, v55
    v_mul_f32 v48, 0x3c000000, v48
    v_mul_f32 v49, 0x3c000000, v49
    v_mul_f32 v50, 0x3c000000, v50
    v_mul_f32 v51, 0x3c000000, v51
    v_mul_f32 v52, 0x3c000000, v52
    v_mul_f32 v53, 0x3c000000, v53
    v_mul_f32 v54, 0x3c000000, v54
    v_mul_f32 v55, 0x3c000000, v55
    v_cos_f32 v48, v48
    v_cos_f32 v49, v49
    v_cos_f32 v50, v50
    v_cos_f32 v51, v51
    v_cos_f32 v52, v52
    v_cos_f32 v53, v53
    v_cos_f32 v54, v54
    v_cos_f32 v55, v55
    s_nop 0
    v_mul_f32 v48, 0x3d000000, v48
    v_mul_f32 v49, 0x3d000000, v49
    v_mul_f32 v50, 0x3d000000, v50
    v_mul_f32 v51, 0x3d000000, v51
    v_mul_f32 v52, 0x3d000000, v52
    v_mul_f32 v53, 0x3d000000, v53
    v_mul_f32 v54, 0x3d000000, v54
    v_mul_f32 v55, 0x3d000000, v55
    v_cvt_pk_bf16_f32 v56, v48, v49
    v_cvt_pk_bf16_f32 v57, v50, v51
    v_cvt_pk_bf16_f32 v58, v52, v53
    v_cvt_pk_bf16_f32 v59, v54, v55
    v_lshlrev_b32 v64, 16, v56
    v_and_b32 v65, 0xffff0000, v56
    v_sub_f32 v48, v48, v64
    v_sub_f32 v49, v49, v65
    v_lshlrev_b32 v64, 16, v57
    v_and_b32 v65, 0xffff0000, v57
    v_sub_f32 v50, v50, v64
    v_sub_f32 v51, v51, v65
    v_lshlrev_b32 v64, 16, v58
    v_and_b32 v65, 0xffff0000, v58
    v_sub_f32 v52, v52, v64
    v_sub_f32 v53, v53, v65
    v_lshlrev_b32 v64, 16, v59
    v_and_b32 v65, 0xffff0000, v59
    v_sub_f32 v54, v54, v64
    v_sub_f32 v55, v55, v65
    v_cvt_pk_bf16_f32 v60, v48, v49
    v_cvt_pk_bf16_f32 v61, v50, v51
    v_cvt_pk_bf16_f32 v62, v52, v53
    v_cvt_pk_bf16_f32 v63, v54, v55
    s_lshl_b32 s30, s27, 11
    v_add_u32 v10, s30, v5
    ds_write_b128 v10, v[56:59]
    ds_write_b128 v10, v[60:63] offset:1024
K34_TABDONE:
    s_waitcnt lgkmcnt(0)
    s_barrier
    s_cmp_lt_u32 s3, s23
    s_cbranch_scc0 K34_IDLE
    ds_read_b128 v[48:51], v5 offset:0
    ds_read_b128 v[52:55], v5 offset:1024
    ds_read_b128 v[56:59], v5 offset:2048
    ds_read_b128 v[60:63], v5 offset:3072
    ds_read_b128 v[64:67], v5 offset:4096
    ds_read_b128 v[68:71], v5 offset:5120
    ds_read_b128 v[72:75], v5 offset:6144
    ds_read_b128 v[76:79], v5 offset:7168
    ds_read_b128 v[80:83], v5 offset:8192
    ds_read_b128 v[84:87], v5 offset:9216
    ds_read_b128 v[88:91], v5 offset:10240
    ds_read_b128 v[92:95], v5 offset:11264
    s_waitcnt vmcnt(0)
    v_swap_b32 v17, v20
    v_swap_b32 v18, v24
    v_swap_b32 v19, v28
    v_swap_b32 v22, v25
    v_swap_b32 v23, v29
    v_swap_b32 v27, v30
    v_swap_b32 v33, v36
    v_swap_b32 v34, v40
    v_swap_b32 v35, v44
    v_swap_b32 v38, v41
    v_swap_b32 v39, v45
    v_swap_b32 v43, v46
    s_waitcnt lgkmcnt(0)
    s_mul_i32 s24, s22, 48
    s_sub_u32 s24, 7985, s24
    s_cmp_ge_u32 s24, 48
    s_cbranch_scc1 K34_FULL
    v_add_u32 v7, 0, v3
    v_cmp_gt_u32 vcc, s24, v7
    s_nop 1
    v_cndmask_b32 v48, 0, v48, vcc
    v_cndmask_b32 v49, 0, v49, vcc
    v_cndmask_b32 v50, 0, v50, vcc
    v_cndmask_b32 v51, 0, v51, vcc
    v_cndmask_b32 v52, 0, v52, vcc
    v_cndmask_b32 v53, 0, v53, vcc
    v_cndmask_b32 v54, 0, v54, vcc
    v_cndmask_b32 v55, 0, v55, vcc
    v_cndmask_b32 v56, 0, v56, vcc
    v_cndmask_b32 v57, 0, v57, vcc
    v_cndmask_b32 v58, 0, v58, vcc
    v_cndmask_b32 v59, 0, v59, vcc
    v_cndmask_b32 v60, 0, v60, vcc
    v_cndmask_b32 v61, 0, v61, vcc
    v_cndmask_b32 v62, 0, v62, vcc
    v_cndmask_b32 v63, 0, v63, vcc
    v_add_u32 v7, 16, v3
    v_cmp_gt_u32 vcc, s24, v7
    s_nop 1
    v_cndmask_b32 v64, 0, v64, vcc
    v_cndmask_b32 v65, 0, v65, vcc
    v_cndmask_b32 v66, 0, v66, vcc
    v_cndmask_b32 v67, 0, v67, vcc
    v_cndmask_b32 v68, 0, v68, vcc
    v_cndmask_b32 v69, 0, v69, vcc
    v_cndmask_b32 v70, 0, v70, vcc
    v_cndmask_b32 v71, 0, v71, vcc
    v_cndmask_b32 v72, 0, v72, vcc
    v_cndmask_b32 v73, 0, v73, vcc
    v_cndmask_b32 v74, 0, v74, vcc
    v_cndmask_b32 v75, 0, v75, vcc
    v_cndmask_b32 v76, 0, v76, vcc
    v_cndmask_b32 v77, 0, v77, vcc
    v_cndmask_b32 v78, 0, v78, vcc
    v_cndmask_b32 v79, 0, v79, vcc
    v_add_u32 v7, 32, v3
    v_cmp_gt_u32 vcc, s24, v7
    s_nop 1
    v_cndmask_b32 v80, 0, v80, vcc
    v_cndmask_b32 v81, 0, v81, vcc
    v_cndmask_b32 v82, 0, v82, vcc
    v_cndmask_b32 v83, 0, v83, vcc
    v_cndmask_b32 v84, 0, v84, vcc
    v_cndmask_b32 v85, 0, v85, vcc
    v_cndmask_b32 v86, 0, v86, vcc
    v_cndmask_b32 v87, 0, v87, vcc
    v_cndmask_b32 v88, 0, v88, vcc
    v_cndmask_b32 v89, 0, v89, vcc
    v_cndmask_b32 v90, 0, v90, vcc
    v_cndmask_b32 v91, 0, v91, vcc
    v_cndmask_b32 v92, 0, v92, vcc
    v_cndmask_b32 v93, 0, v93, vcc
    v_cndmask_b32 v94, 0, v94, vcc
    v_cndmask_b32 v95, 0, v95, vcc
K34_FULL:
    s_nop 1
    v_mfma_f32_16x16x32_bf16 v[96:99], v[48:51], v[16:19], 0
    v_mfma_f32_16x16x32_bf16 v[100:103], v[48:51], v[20:23], 0
    v_mfma_f32_16x16x32_bf16 v[104:107], v[48:51], v[24:27], 0
    v_mfma_f32_16x16x32_bf16 v[108:111], v[48:51], v[28:31], 0
    v_mfma_f32_16x16x32_bf16 v[96:99], v[52:55], v[16:19], v[96:99]
    v_mfma_f32_16x16x32_bf16 v[100:103], v[52:55], v[20:23], v[100:103]
    v_mfma_f32_16x16x32_bf16 v[104:107], v[52:55], v[24:27], v[104:107]
    v_mfma_f32_16x16x32_bf16 v[108:111], v[52:55], v[28:31], v[108:111]
    v_mfma_f32_16x16x32_bf16 v[96:99], v[56:59], v[32:35], v[96:99]
    v_mfma_f32_16x16x32_bf16 v[100:103], v[56:59], v[36:39], v[100:103]
    v_mfma_f32_16x16x32_bf16 v[104:107], v[56:59], v[40:43], v[104:107]
    v_mfma_f32_16x16x32_bf16 v[108:111], v[56:59], v[44:47], v[108:111]
    v_mfma_f32_16x16x32_bf16 v[96:99], v[60:63], v[32:35], v[96:99]
    v_mfma_f32_16x16x32_bf16 v[100:103], v[60:63], v[36:39], v[100:103]
    v_mfma_f32_16x16x32_bf16 v[104:107], v[60:63], v[40:43], v[104:107]
    v_mfma_f32_16x16x32_bf16 v[108:111], v[60:63], v[44:47], v[108:111]
    v_mfma_f32_16x16x32_bf16 v[112:115], v[64:67], v[16:19], 0
    v_mfma_f32_16x16x32_bf16 v[116:119], v[64:67], v[20:23], 0
    v_mfma_f32_16x16x32_bf16 v[120:123], v[64:67], v[24:27], 0
    v_mfma_f32_16x16x32_bf16 v[124:127], v[64:67], v[28:31], 0
    v_mfma_f32_16x16x32_bf16 v[112:115], v[68:71], v[16:19], v[112:115]
    v_mfma_f32_16x16x32_bf16 v[116:119], v[68:71], v[20:23], v[116:119]
    v_mfma_f32_16x16x32_bf16 v[120:123], v[68:71], v[24:27], v[120:123]
    v_mfma_f32_16x16x32_bf16 v[124:127], v[68:71], v[28:31], v[124:127]
    v_mfma_f32_16x16x32_bf16 v[112:115], v[72:75], v[32:35], v[112:115]
    v_mfma_f32_16x16x32_bf16 v[116:119], v[72:75], v[36:39], v[116:119]
    v_mfma_f32_16x16x32_bf16 v[120:123], v[72:75], v[40:43], v[120:123]
    v_mfma_f32_16x16x32_bf16 v[124:127], v[72:75], v[44:47], v[124:127]
    v_mfma_f32_16x16x32_bf16 v[112:115], v[76:79], v[32:35], v[112:115]
    v_mfma_f32_16x16x32_bf16 v[116:119], v[76:79], v[36:39], v[116:119]
    v_mfma_f32_16x16x32_bf16 v[120:123], v[76:79], v[40:43], v[120:123]
    v_mfma_f32_16x16x32_bf16 v[124:127], v[76:79], v[44:47], v[124:127]
    v_mfma_f32_16x16x32_bf16 v[128:131], v[80:83], v[16:19], 0
    v_mfma_f32_16x16x32_bf16 v[132:135], v[80:83], v[20:23], 0
    v_mfma_f32_16x16x32_bf16 v[136:139], v[80:83], v[24:27], 0
    v_mfma_f32_16x16x32_bf16 v[140:143], v[80:83], v[28:31], 0
    v_mfma_f32_16x16x32_bf16 v[128:131], v[84:87], v[16:19], v[128:131]
    v_mfma_f32_16x16x32_bf16 v[132:135], v[84:87], v[20:23], v[132:135]
    v_mfma_f32_16x16x32_bf16 v[136:139], v[84:87], v[24:27], v[136:139]
    v_mfma_f32_16x16x32_bf16 v[140:143], v[84:87], v[28:31], v[140:143]
    v_mfma_f32_16x16x32_bf16 v[128:131], v[88:91], v[32:35], v[128:131]
    v_mfma_f32_16x16x32_bf16 v[132:135], v[88:91], v[36:39], v[132:135]
    v_mfma_f32_16x16x32_bf16 v[136:139], v[88:91], v[40:43], v[136:139]
    v_mfma_f32_16x16x32_bf16 v[140:143], v[88:91], v[44:47], v[140:143]
    v_mfma_f32_16x16x32_bf16 v[128:131], v[92:95], v[32:35], v[128:131]
    v_mfma_f32_16x16x32_bf16 v[132:135], v[92:95], v[36:39], v[132:135]
    v_mfma_f32_16x16x32_bf16 v[136:139], v[92:95], v[40:43], v[136:139]
    v_mfma_f32_16x16x32_bf16 v[140:143], v[92:95], v[44:47], v[140:143]
    s_nop 7
    v_mov_b32 v16, v96
    v_mul_f32 v20, v96, v96
    v_mov_b32 v17, v100
    v_mul_f32 v21, v100, v100
    v_mov_b32 v18, v104
    v_mul_f32 v22, v104, v104
    v_mov_b32 v19, v108
    v_mul_f32 v23, v108, v108
    v_add_f32 v16, v16, v97
    v_fmac_f32 v20, v97, v97
    v_add_f32 v17, v17, v101
    v_fmac_f32 v21, v101, v101
    v_add_f32 v18, v18, v105
    v_fmac_f32 v22, v105, v105
    v_add_f32 v19, v19, v109
    v_fmac_f32 v23, v109, v109
    v_add_f32 v16, v16, v98
    v_fmac_f32 v20, v98, v98
    v_add_f32 v17, v17, v102
    v_fmac_f32 v21, v102, v102
    v_add_f32 v18, v18, v106
    v_fmac_f32 v22, v106, v106
    v_add_f32 v19, v19, v110
    v_fmac_f32 v23, v110, v110
    v_add_f32 v16, v16, v99
    v_fmac_f32 v20, v99, v99
    v_add_f32 v17, v17, v103
    v_fmac_f32 v21, v103, v103
    v_add_f32 v18, v18, v107
    v_fmac_f32 v22, v107, v107
    v_add_f32 v19, v19, v111
    v_fmac_f32 v23, v111, v111
    v_add_f32 v16, v16, v112
    v_fmac_f32 v20, v112, v112
    v_add_f32 v17, v17, v116
    v_fmac_f32 v21, v116, v116
    v_add_f32 v18, v18, v120
    v_fmac_f32 v22, v120, v120
    v_add_f32 v19, v19, v124
    v_fmac_f32 v23, v124, v124
    v_add_f32 v16, v16, v113
    v_fmac_f32 v20, v113, v113
    v_add_f32 v17, v17, v117
    v_fmac_f32 v21, v117, v117
    v_add_f32 v18, v18, v121
    v_fmac_f32 v22, v121, v121
    v_add_f32 v19, v19, v125
    v_fmac_f32 v23, v125, v125
    v_add_f32 v16, v16, v114
    v_fmac_f32 v20, v114, v114
    v_add_f32 v17, v17, v118
    v_fmac_f32 v21, v118, v118
    v_add_f32 v18, v18, v122
    v_fmac_f32 v22, v122, v122
    v_add_f32 v19, v19, v126
    v_fmac_f32 v23, v126, v126
    v_add_f32 v16, v16, v115
    v_fmac_f32 v20, v115, v115
    v_add_f32 v17, v17, v119
    v_fmac_f32 v21, v119, v119
    v_add_f32 v18, v18, v123
    v_fmac_f32 v22, v123, v123
    v_add_f32 v19, v19, v127
    v_fmac_f32 v23, v127, v127
    v_add_f32 v16, v16, v128
    v_fmac_f32 v20, v128, v128
    v_add_f32 v17, v17, v132
    v_fmac_f32 v21, v132, v132
    v_add_f32 v18, v18, v136
    v_fmac_f32 v22, v136, v136
    v_add_f32 v19, v19, v140
    v_fmac_f32 v23, v140, v140
    v_add_f32 v16, v16, v129
    v_fmac_f32 v20, v129, v129
    v_add_f32 v17, v17, v133
    v_fmac_f32 v21, v133, v133
    v_add_f32 v18, v18, v137
    v_fmac_f32 v22, v137, v137
    v_add_f32 v19, v19, v141
    v_fmac_f32 v23, v141, v141
    v_add_f32 v16, v16, v130
    v_fmac_f32 v20, v130, v130
    v_add_f32 v17, v17, v134
    v_fmac_f32 v21, v134, v134
    v_add_f32 v18, v18, v138
    v_fmac_f32 v22, v138, v138
    v_add_f32 v19, v19, v142
    v_fmac_f32 v23, v142, v142
    v_add_f32 v16, v16, v131
    v_fmac_f32 v20, v131, v131
    v_add_f32 v17, v17, v135
    v_fmac_f32 v21, v135, v135
    v_add_f32 v18, v18, v139
    v_fmac_f32 v22, v139, v139
    v_add_f32 v19, v19, v143
    v_fmac_f32 v23, v143, v143
    v_mov_b32 v24, v16
    v_mov_b32 v25, v17
    v_mov_b32 v26, v18
    v_mov_b32 v27, v19
    v_mov_b32 v28, v20
    v_mov_b32 v29, v21
    v_mov_b32 v30, v22
    v_mov_b32 v31, v23
    s_nop 0
    v_permlane32_swap_b32 v16, v24
    v_permlane32_swap_b32 v17, v25
    v_permlane32_swap_b32 v18, v26
    v_permlane32_swap_b32 v19, v27
    v_permlane32_swap_b32 v20, v28
    v_permlane32_swap_b32 v21, v29
    v_permlane32_swap_b32 v22, v30
    v_permlane32_swap_b32 v23, v31
    v_add_f32 v16, v16, v24
    v_add_f32 v17, v17, v25
    v_add_f32 v18, v18, v26
    v_add_f32 v19, v19, v27
    v_add_f32 v20, v20, v28
    v_add_f32 v21, v21, v29
    v_add_f32 v22, v22, v30
    v_add_f32 v23, v23, v31
    v_mov_b32 v24, v16
    v_mov_b32 v25, v17
    v_mov_b32 v26, v18
    v_mov_b32 v27, v19
    v_mov_b32 v28, v20
    v_mov_b32 v29, v21
    v_mov_b32 v30, v22
    v_mov_b32 v31, v23
    s_nop 0
    v_permlane16_swap_b32 v16, v24
    v_permlane16_swap_b32 v17, v25
    v_permlane16_swap_b32 v18, v26
    v_permlane16_swap_b32 v19, v27
    v_permlane16_swap_b32 v20, v28
    v_permlane16_swap_b32 v21, v29
    v_permlane16_swap_b32 v22, v30
    v_permlane16_swap_b32 v23, v31
    v_add_f32 v16, v16, v24
    v_add_f32 v17, v17, v25
    v_add_f32 v18, v18, v26
    v_add_f32 v19, v19, v27
    v_add_f32 v20, v20, v28
    v_add_f32 v21, v21, v29
    v_add_f32 v22, v22, v30
    v_add_f32 v23, v23, v31
    s_branch K34_WR
K34_IDLE:
    v_mov_b32 v16, 0
    v_mov_b32 v17, 0
    v_mov_b32 v18, 0
    v_mov_b32 v19, 0
    v_mov_b32 v20, 0
    v_mov_b32 v21, 0
    v_mov_b32 v22, 0
    v_mov_b32 v23, 0
K34_WR:
    s_lshl_b32 s24, s3, 9
    v_lshlrev_b32 v7, 4, v3
    v_add_u32 v7, s24, v7
    ds_write_b128 v7, v[16:19] offset:12288
    ds_write_b128 v7, v[20:23] offset:12544
    s_waitcnt lgkmcnt(0)
    s_barrier
    s_cmp_lg_u32 s3, 0
    s_cbranch_scc1 K34_WAIT
    v_lshlrev_b32 v7, 2, v2
    ds_read_b32 v16, v7 offset:12288
    ds_read_b32 v17, v7 offset:12800
    ds_read_b32 v18, v7 offset:13312
    ds_read_b32 v19, v7 offset:13824
    ds_read_b32 v20, v7 offset:14336
    ds_read_b32 v21, v7 offset:14848
    ds_read_b32 v22, v7 offset:15360
    ds_read_b32 v23, v7 offset:15872
    ds_read_b32 v24, v7 offset:16384
    ds_read_b32 v25, v7 offset:16896
    ds_read_b32 v26, v7 offset:17408
    ds_read_b32 v27, v7 offset:17920
    s_waitcnt lgkmcnt(0)
    ds_read_b32 v32, v7 offset:12544
    ds_read_b32 v33, v7 offset:13056
    ds_read_b32 v34, v7 offset:13568
    ds_read_b32 v35, v7 offset:14080
    ds_read_b32 v36, v7 offset:14592
    ds_read_b32 v37, v7 offset:15104
    ds_read_b32 v38, v7 offset:15616
    ds_read_b32 v39, v7 offset:16128
    ds_read_b32 v40, v7 offset:16640
    ds_read_b32 v41, v7 offset:17152
    ds_read_b32 v42, v7 offset:17664
    ds_read_b32 v43, v7 offset:18176
    v_add_f32 v16, v16, v17
    v_add_f32 v16, v16, v18
    v_add_f32 v16, v16, v19
    v_add_f32 v16, v16, v20
    v_add_f32 v16, v16, v21
    v_add_f32 v16, v16, v22
    v_add_f32 v16, v16, v23
    v_add_f32 v16, v16, v24
    v_add_f32 v16, v16, v25
    v_add_f32 v16, v16, v26
    v_add_f32 v16, v16, v27
    s_waitcnt lgkmcnt(0)
    v_add_f32 v32, v32, v33
    v_add_f32 v32, v32, v34
    v_add_f32 v32, v32, v35
    v_add_f32 v32, v32, v36
    v_add_f32 v32, v32, v37
    v_add_f32 v32, v32, v38
    v_add_f32 v32, v32, v39
    v_add_f32 v32, v32, v40
    v_add_f32 v32, v32, v41
    v_add_f32 v32, v32, v42
    v_add_f32 v32, v32, v43
    s_lshl_b32 s24, s6, 4
    s_add_u32 s24, s24, s7
    s_lshl_b32 s24, s24, 9
    buffer_store_dword v16, v7, s[12:15], s24 offen sc1
    buffer_store_dword v32, v7, s[12:15], s24 offen offset:256 sc1
    s_mov_b32 s26, 20000
K34_POLL:
    s_lshl_b32 s24, s6, 13
    buffer_load_dword v16, v7, s[12:15], s24 offen offset:0 sc1
    buffer_load_dword v32, v7, s[12:15], s24 offen offset:256 sc1
    buffer_load_dword v17, v7, s[12:15], s24 offen offset:512 sc1
    buffer_load_dword v33, v7, s[12:15], s24 offen offset:768 sc1
    buffer_load_dword v18, v7, s[12:15], s24 offen offset:1024 sc1
    buffer_load_dword v34, v7, s[12:15], s24 offen offset:1280 sc1
    buffer_load_dword v19, v7, s[12:15], s24 offen offset:1536 sc1
    buffer_load_dword v35, v7, s[12:15], s24 offen offset:1792 sc1
    buffer_load_dword v20, v7, s[12:15], s24 offen offset:2048 sc1
    buffer_load_dword v36, v7, s[12:15], s24 offen offset:2304 sc1
    buffer_load_dword v21, v7, s[12:15], s24 offen offset:2560 sc1
    buffer_load_dword v37, v7, s[12:15], s24 offen offset:2816 sc1
    buffer_load_dword v22, v7, s[12:15], s24 offen offset:3072 sc1
    buffer_load_dword v38, v7, s[12:15], s24 offen offset:3328 sc1
    buffer_load_dword v23, v7, s[12:15], s24 offen offset:3584 sc1
    buffer_load_dword v39, v7, s[12:15], s24 offen offset:3840 sc1
    s_add_u32 s24, s24, 4096
    buffer_load_dword v24, v7, s[12:15], s24 offen offset:0 sc1
    buffer_load_dword v40, v7, s[12:15], s24 offen offset:256 sc1
    buffer_load_dword v25, v7, s[12:15], s24 offen offset:512 sc1
    buffer_load_dword v41, v7, s[12:15], s24 offen offset:768 sc1
    buffer_load_dword v26, v7, s[12:15], s24 offen offset:1024 sc1
    buffer_load_dword v42, v7, s[12:15], s24 offen offset:1280 sc1
    buffer_load_dword v27, v7, s[12:15], s24 offen offset:1536 sc1
    buffer_load_dword v43, v7, s[12:15], s24 offen offset:1792 sc1
    buffer_load_dword v28, v7, s[12:15], s24 offen offset:2048 sc1
    buffer_load_dword v44, v7, s[12:15], s24 offen offset:2304 sc1
    buffer_load_dword v29, v7, s[12:15], s24 offen offset:2560 sc1
    buffer_load_dword v45, v7, s[12:15], s24 offen offset:2816 sc1
    buffer_load_dword v30, v7, s[12:15], s24 offen offset:3072 sc1
    buffer_load_dword v46, v7, s[12:15], s24 offen offset:3328 sc1
    buffer_load_dword v31, v7, s[12:15], s24 offen offset:3584 sc1
    buffer_load_dword v47, v7, s[12:15], s24 offen offset:3840 sc1
    s_waitcnt vmcnt(0)
    v_max3_u32 v48, v16, v17, v18
    v_max3_u32 v48, v48, v19, v20
    v_max3_u32 v48, v48, v21, v22
    v_max3_u32 v48, v48, v23, v24
    v_max3_u32 v48, v48, v25, v26
    v_max3_u32 v48, v48, v27, v28
    v_max3_u32 v48, v48, v29, v30
    v_max3_u32 v48, v48, v31, v32
    v_max3_u32 v48, v48, v33, v34
    v_max3_u32 v48, v48, v35, v36
    v_max3_u32 v48, v48, v37, v38
    v_max3_u32 v48, v48, v39, v40
    v_max3_u32 v48, v48, v41, v42
    v_max3_u32 v48, v48, v43, v44
    v_max3_u32 v48, v48, v45, v46
    v_max_u32 v48, v48, v47
    v_cmp_eq_u32 vcc, -1, v48
    s_sub_u32 s26, s26, 1
    s_cmp_eq_u32 s26, 0
    s_cbranch_scc1 K34_GOT
    s_cbranch_vccz K34_GOT
    s_sleep 1
    s_branch K34_POLL
K34_GOT:
    v_add_f32 v16, v16, v24
    v_add_f32 v32, v32, v40
    v_add_f32 v17, v17, v25
    v_add_f32 v33, v33, v41
    v_add_f32 v18, v18, v26
    v_add_f32 v34, v34, v42
    v_add_f32 v19, v19, v27
    v_add_f32 v35, v35, v43
    v_add_f32 v20, v20, v28
    v_add_f32 v36, v36, v44
    v_add_f32 v21, v21, v29
    v_add_f32 v37, v37, v45
    v_add_f32 v22, v22, v30
    v_add_f32 v38, v38, v46
    v_add_f32 v23, v23, v31
    v_add_f32 v39, v39, v47
    v_add_f32 v16, v16, v20
    v_add_f32 v32, v32, v36
    v_add_f32 v17, v17, v21
    v_add_f32 v33, v33, v37
    v_add_f32 v18, v18, v22
    v_add_f32 v34, v34, v38
    v_add_f32 v19, v19, v23
    v_add_f32 v35, v35, v39
    v_add_f32 v16, v16, v18
    v_add_f32 v32, v32, v34
    v_add_f32 v17, v17, v19
    v_add_f32 v33, v33, v35
    v_add_f32 v16, v16, v17
    v_add_f32 v32, v32, v33
    v_mul_f32 v11, 0x39035177, v16
    v_mul_f32 v12, 0x39035177, v32
    v_fma_f32 v12, -v11, v11, v12
    v_max_f32 v12, 0, v12
    v_add_f32 v12, 0x3727c5ac, v12
    v_sqrt_f32 v12, v12
    v_lshlrev_b32 v9, 16, v152
    v_rcp_f32 v12, v12
    v_lshlrev_b32 v10, 16, v153
    v_mul_f32 v9, v9, v12
    v_fma_f32 v10, -v11, v9, v10
    ds_write_b32 v7, v9 offset:18432
    ds_write_b32 v7, v10 offset:18688
    s_waitcnt lgkmcnt(0)
K34_WAIT:
    s_barrier
    s_cmp_lt_u32 s3, s23
    s_cbranch_scc0 K34_END
    v_lshlrev_b32 v7, 4, v3
    ds_read_b128 v[144:147], v7 offset:18432
    ds_read_b128 v[148:151], v7 offset:18688
    s_mul_i32 s24, s20, 8176640
    s_add_u32 s16, s44, s24
    s_addc_u32 s17, s45, 0
    s_and_b32 s17, s17, 0xffff
    s_mov_b32 s18, 8176640
    s_mov_b32 s19, 0x00020000
    v_lshlrev_b32 v7, 12, v4
    v_lshl_add_u32 v7, v3, 3, v7
    s_lshl_b32 s24, s21, 7
    v_add_u32 v7, s24, v7
    s_mul_i32 s25, s22, 49152
    s_mov_b32 s30, 0xc0135761
    s_mov_b32 s31, 0xbdd2d3e8
    v_mov_b32 v15, s30
    s_waitcnt lgkmcnt(0)
    v_fma_f32 v16, v96, v144, v148
    v_fma_f32 v17, v100, v145, v149
    v_fma_f32 v18, v104, v146, v150
    v_fma_f32 v19, v108, v147, v151
    v_fma_f32 v20, v97, v144, v148
    v_fma_f32 v21, v101, v145, v149
    v_fma_f32 v22, v105, v146, v150
    v_fma_f32 v23, v109, v147, v151
    v_mul_f32 v24, v16, v16
    v_mul_f32 v25, v17, v17
    v_mul_f32 v26, v18, v18
    v_mul_f32 v27, v19, v19
    v_mul_f32 v28, v20, v20
    v_mul_f32 v29, v21, v21
    v_mul_f32 v30, v22, v22
    v_mul_f32 v31, v23, v23
    v_fma_f32 v24, v24, s31, v15
    v_fma_f32 v25, v25, s31, v15
    v_fma_f32 v26, v26, s31, v15
    v_fma_f32 v27, v27, s31, v15
    v_fma_f32 v28, v28, s31, v15
    v_fma_f32 v29, v29, s31, v15
    v_fma_f32 v30, v30, s31, v15
    v_fma_f32 v31, v31, s31, v15
    v_mul_f32 v24, v24, v16
    v_mul_f32 v25, v25, v17
    v_mul_f32 v26, v26, v18
    v_mul_f32 v27, v27, v19
    v_mul_f32 v28, v28, v20
    v_mul_f32 v29, v29, v21
    v_mul_f32 v30, v30, v22
    v_mul_f32 v31, v31, v23
    v_exp_f32 v24, v24
    v_exp_f32 v25, v25
    v_exp_f32 v26, v26
    v_exp_f32 v27, v27
    v_exp_f32 v28, v28
    v_exp_f32 v29, v29
    v_exp_f32 v30, v30
    v_exp_f32 v31, v31
    v_add_f32 v24, 1.0, v24
    v_add_f32 v25, 1.0, v25
    v_add_f32 v26, 1.0, v26
    v_add_f32 v27, 1.0, v27
    v_add_f32 v28, 1.0, v28
    v_add_f32 v29, 1.0, v29
    v_add_f32 v30, 1.0, v30
    v_add_f32 v31, 1.0, v31
    v_rcp_f32 v24, v24
    v_rcp_f32 v25, v25
    v_rcp_f32 v26, v26
    v_rcp_f32 v27, v27
    v_rcp_f32 v28, v28
    v_rcp_f32 v29, v29
    v_rcp_f32 v30, v30
    v_rcp_f32 v31, v31
    v_mul_f32 v16, v16, v24
    v_mul_f32 v17, v17, v25
    v_mul_f32 v18, v18, v26
    v_mul_f32 v19, v19, v27
    v_mul_f32 v20, v20, v28
    v_mul_f32 v21, v21, v29
    v_mul_f32 v22, v22, v30
    v_mul_f32 v23, v23, v31
    v_cvt_pk_bf16_f32 v32, v16, v17
    v_cvt_pk_bf16_f32 v33, v18, v19
    buffer_store_dwordx2 v[32:33], v7, s[16:19], s25 offen offset:0 sc1
    v_cvt_pk_bf16_f32 v34, v20, v21
    v_cvt_pk_bf16_f32 v35, v22, v23
    buffer_store_dwordx2 v[34:35], v7, s[16:19], s25 offen offset:1024 sc1
    s_add_u32 s25, s25, 2048
    v_fma_f32 v36, v98, v144, v148
    v_fma_f32 v37, v102, v145, v149
    v_fma_f32 v38, v106, v146, v150
    v_fma_f32 v39, v110, v147, v151
    v_fma_f32 v40, v99, v144, v148
    v_fma_f32 v41, v103, v145, v149
    v_fma_f32 v42, v107, v146, v150
    v_fma_f32 v43, v111, v147, v151
    v_mul_f32 v44, v36, v36
    v_mul_f32 v45, v37, v37
    v_mul_f32 v46, v38, v38
    v_mul_f32 v47, v39, v39
    v_mul_f32 v48, v40, v40
    v_mul_f32 v49, v41, v41
    v_mul_f32 v50, v42, v42
    v_mul_f32 v51, v43, v43
    v_fma_f32 v44, v44, s31, v15
    v_fma_f32 v45, v45, s31, v15
    v_fma_f32 v46, v46, s31, v15
    v_fma_f32 v47, v47, s31, v15
    v_fma_f32 v48, v48, s31, v15
    v_fma_f32 v49, v49, s31, v15
    v_fma_f32 v50, v50, s31, v15
    v_fma_f32 v51, v51, s31, v15
    v_mul_f32 v44, v44, v36
    v_mul_f32 v45, v45, v37
    v_mul_f32 v46, v46, v38
    v_mul_f32 v47, v47, v39
    v_mul_f32 v48, v48, v40
    v_mul_f32 v49, v49, v41
    v_mul_f32 v50, v50, v42
    v_mul_f32 v51, v51, v43
    v_exp_f32 v44, v44
    v_exp_f32 v45, v45
    v_exp_f32 v46, v46
    v_exp_f32 v47, v47
    v_exp_f32 v48, v48
    v_exp_f32 v49, v49
    v_exp_f32 v50, v50
    v_exp_f32 v51, v51
    v_add_f32 v44, 1.0, v44
    v_add_f32 v45, 1.0, v45
    v_add_f32 v46, 1.0, v46
    v_add_f32 v47, 1.0, v47
    v_add_f32 v48, 1.0, v48
    v_add_f32 v49, 1.0, v49
    v_add_f32 v50, 1.0, v50
    v_add_f32 v51, 1.0, v51
    v_rcp_f32 v44, v44
    v_rcp_f32 v45, v45
    v_rcp_f32 v46, v46
    v_rcp_f32 v47, v47
    v_rcp_f32 v48, v48
    v_rcp_f32 v49, v49
    v_rcp_f32 v50, v50
    v_rcp_f32 v51, v51
    v_mul_f32 v36, v36, v44
    v_mul_f32 v37, v37, v45
    v_mul_f32 v38, v38, v46
    v_mul_f32 v39, v39, v47
    v_mul_f32 v40, v40, v48
    v_mul_f32 v41, v41, v49
    v_mul_f32 v42, v42, v50
    v_mul_f32 v43, v43, v51
    v_cvt_pk_bf16_f32 v52, v36, v37
    v_cvt_pk_bf16_f32 v53, v38, v39
    buffer_store_dwordx2 v[52:53], v7, s[16:19], s25 offen offset:0 sc1
    v_cvt_pk_bf16_f32 v54, v40, v41
    v_cvt_pk_bf16_f32 v55, v42, v43
    buffer_store_dwordx2 v[54:55], v7, s[16:19], s25 offen offset:1024 sc1
    s_add_u32 s25, s25, 2048
    s_add_u32 s25, s25, 12288
    v_fma_f32 v16, v112, v144, v148
    v_fma_f32 v17, v116, v145, v149
    v_fma_f32 v18, v120, v146, v150
    v_fma_f32 v19, v124, v147, v151
    v_fma_f32 v20, v113, v144, v148
    v_fma_f32 v21, v117, v145, v149
    v_fma_f32 v22, v121, v146, v150
    v_fma_f32 v23, v125, v147, v151
    v_mul_f32 v24, v16, v16
    v_mul_f32 v25, v17, v17
    v_mul_f32 v26, v18, v18
    v_mul_f32 v27, v19, v19
    v_mul_f32 v28, v20, v20
    v_mul_f32 v29, v21, v21
    v_mul_f32 v30, v22, v22
    v_mul_f32 v31, v23, v23
    v_fma_f32 v24, v24, s31, v15
    v_fma_f32 v25, v25, s31, v15
    v_fma_f32 v26, v26, s31, v15
    v_fma_f32 v27, v27, s31, v15
    v_fma_f32 v28, v28, s31, v15
    v_fma_f32 v29, v29, s31, v15
    v_fma_f32 v30, v30, s31, v15
    v_fma_f32 v31, v31, s31, v15
    v_mul_f32 v24, v24, v16
    v_mul_f32 v25, v25, v17
    v_mul_f32 v26, v26, v18
    v_mul_f32 v27, v27, v19
    v_mul_f32 v28, v28, v20
    v_mul_f32 v29, v29, v21
    v_mul_f32 v30, v30, v22
    v_mul_f32 v31, v31, v23
    v_exp_f32 v24, v24
    v_exp_f32 v25, v25
    v_exp_f32 v26, v26
    v_exp_f32 v27, v27
    v_exp_f32 v28, v28
    v_exp_f32 v29, v29
    v_exp_f32 v30, v30
    v_exp_f32 v31, v31
    v_add_f32 v24, 1.0, v24
    v_add_f32 v25, 1.0, v25
    v_add_f32 v26, 1.0, v26
    v_add_f32 v27, 1.0, v27
    v_add_f32 v28, 1.0, v28
    v_add_f32 v29, 1.0, v29
    v_add_f32 v30, 1.0, v30
    v_add_f32 v31, 1.0, v31
    v_rcp_f32 v24, v24
    v_rcp_f32 v25, v25
    v_rcp_f32 v26, v26
    v_rcp_f32 v27, v27
    v_rcp_f32 v28, v28
    v_rcp_f32 v29, v29
    v_rcp_f32 v30, v30
    v_rcp_f32 v31, v31
    v_mul_f32 v16, v16, v24
    v_mul_f32 v17, v17, v25
    v_mul_f32 v18, v18, v26
    v_mul_f32 v19, v19, v27
    v_mul_f32 v20, v20, v28
    v_mul_f32 v21, v21, v29
    v_mul_f32 v22, v22, v30
    v_mul_f32 v23, v23, v31
    v_cvt_pk_bf16_f32 v32, v16, v17
    v_cvt_pk_bf16_f32 v33, v18, v19
    buffer_store_dwordx2 v[32:33], v7, s[16:19], s25 offen offset:0 sc1
    v_cvt_pk_bf16_f32 v34, v20, v21
    v_cvt_pk_bf16_f32 v35, v22, v23
    buffer_store_dwordx2 v[34:35], v7, s[16:19], s25 offen offset:1024 sc1
    s_add_u32 s25, s25, 2048
    v_fma_f32 v36, v114, v144, v148
    v_fma_f32 v37, v118, v145, v149
    v_fma_f32 v38, v122, v146, v150
    v_fma_f32 v39, v126, v147, v151
    v_fma_f32 v40, v115, v144, v148
    v_fma_f32 v41, v119, v145, v149
    v_fma_f32 v42, v123, v146, v150
    v_fma_f32 v43, v127, v147, v151
    v_mul_f32 v44, v36, v36
    v_mul_f32 v45, v37, v37
    v_mul_f32 v46, v38, v38
    v_mul_f32 v47, v39, v39
    v_mul_f32 v48, v40, v40
    v_mul_f32 v49, v41, v41
    v_mul_f32 v50, v42, v42
    v_mul_f32 v51, v43, v43
    v_fma_f32 v44, v44, s31, v15
    v_fma_f32 v45, v45, s31, v15
    v_fma_f32 v46, v46, s31, v15
    v_fma_f32 v47, v47, s31, v15
    v_fma_f32 v48, v48, s31, v15
    v_fma_f32 v49, v49, s31, v15
    v_fma_f32 v50, v50, s31, v15
    v_fma_f32 v51, v51, s31, v15
    v_mul_f32 v44, v44, v36
    v_mul_f32 v45, v45, v37
    v_mul_f32 v46, v46, v38
    v_mul_f32 v47, v47, v39
    v_mul_f32 v48, v48, v40
    v_mul_f32 v49, v49, v41
    v_mul_f32 v50, v50, v42
    v_mul_f32 v51, v51, v43
    v_exp_f32 v44, v44
    v_exp_f32 v45, v45
    v_exp_f32 v46, v46
    v_exp_f32 v47, v47
    v_exp_f32 v48, v48
    v_exp_f32 v49, v49
    v_exp_f32 v50, v50
    v_exp_f32 v51, v51
    v_add_f32 v44, 1.0, v44
    v_add_f32 v45, 1.0, v45
    v_add_f32 v46, 1.0, v46
    v_add_f32 v47, 1.0, v47
    v_add_f32 v48, 1.0, v48
    v_add_f32 v49, 1.0, v49
    v_add_f32 v50, 1.0, v50
    v_add_f32 v51, 1.0, v51
    v_rcp_f32 v44, v44
    v_rcp_f32 v45, v45
    v_rcp_f32 v46, v46
    v_rcp_f32 v47, v47
    v_rcp_f32 v48, v48
    v_rcp_f32 v49, v49
    v_rcp_f32 v50, v50
    v_rcp_f32 v51, v51
    v_mul_f32 v36, v36, v44
    v_mul_f32 v37, v37, v45
    v_mul_f32 v38, v38, v46
    v_mul_f32 v39, v39, v47
    v_mul_f32 v40, v40, v48
    v_mul_f32 v41, v41, v49
    v_mul_f32 v42, v42, v50
    v_mul_f32 v43, v43, v51
    v_cvt_pk_bf16_f32 v52, v36, v37
    v_cvt_pk_bf16_f32 v53, v38, v39
    buffer_store_dwordx2 v[52:53], v7, s[16:19], s25 offen offset:0 sc1
    v_cvt_pk_bf16_f32 v54, v40, v41
    v_cvt_pk_bf16_f32 v55, v42, v43
    buffer_store_dwordx2 v[54:55], v7, s[16:19], s25 offen offset:1024 sc1
    s_add_u32 s25, s25, 2048
    s_add_u32 s25, s25, 12288
    v_fma_f32 v16, v128, v144, v148
    v_fma_f32 v17, v132, v145, v149
    v_fma_f32 v18, v136, v146, v150
    v_fma_f32 v19, v140, v147, v151
    v_fma_f32 v20, v129, v144, v148
    v_fma_f32 v21, v133, v145, v149
    v_fma_f32 v22, v137, v146, v150
    v_fma_f32 v23, v141, v147, v151
    v_mul_f32 v24, v16, v16
    v_mul_f32 v25, v17, v17
    v_mul_f32 v26, v18, v18
    v_mul_f32 v27, v19, v19
    v_mul_f32 v28, v20, v20
    v_mul_f32 v29, v21, v21
    v_mul_f32 v30, v22, v22
    v_mul_f32 v31, v23, v23
    v_fma_f32 v24, v24, s31, v15
    v_fma_f32 v25, v25, s31, v15
    v_fma_f32 v26, v26, s31, v15
    v_fma_f32 v27, v27, s31, v15
    v_fma_f32 v28, v28, s31, v15
    v_fma_f32 v29, v29, s31, v15
    v_fma_f32 v30, v30, s31, v15
    v_fma_f32 v31, v31, s31, v15
    v_mul_f32 v24, v24, v16
    v_mul_f32 v25, v25, v17
    v_mul_f32 v26, v26, v18
    v_mul_f32 v27, v27, v19
    v_mul_f32 v28, v28, v20
    v_mul_f32 v29, v29, v21
    v_mul_f32 v30, v30, v22
    v_mul_f32 v31, v31, v23
    v_exp_f32 v24, v24
    v_exp_f32 v25, v25
    v_exp_f32 v26, v26
    v_exp_f32 v27, v27
    v_exp_f32 v28, v28
    v_exp_f32 v29, v29
    v_exp_f32 v30, v30
    v_exp_f32 v31, v31
    v_add_f32 v24, 1.0, v24
    v_add_f32 v25, 1.0, v25
    v_add_f32 v26, 1.0, v26
    v_add_f32 v27, 1.0, v27
    v_add_f32 v28, 1.0, v28
    v_add_f32 v29, 1.0, v29
    v_add_f32 v30, 1.0, v30
    v_add_f32 v31, 1.0, v31
    v_rcp_f32 v24, v24
    v_rcp_f32 v25, v25
    v_rcp_f32 v26, v26
    v_rcp_f32 v27, v27
    v_rcp_f32 v28, v28
    v_rcp_f32 v29, v29
    v_rcp_f32 v30, v30
    v_rcp_f32 v31, v31
    v_mul_f32 v16, v16, v24
    v_mul_f32 v17, v17, v25
    v_mul_f32 v18, v18, v26
    v_mul_f32 v19, v19, v27
    v_mul_f32 v20, v20, v28
    v_mul_f32 v21, v21, v29
    v_mul_f32 v22, v22, v30
    v_mul_f32 v23, v23, v31
    v_cvt_pk_bf16_f32 v32, v16, v17
    v_cvt_pk_bf16_f32 v33, v18, v19
    buffer_store_dwordx2 v[32:33], v7, s[16:19], s25 offen offset:0 sc1
    v_cvt_pk_bf16_f32 v34, v20, v21
    v_cvt_pk_bf16_f32 v35, v22, v23
    buffer_store_dwordx2 v[34:35], v7, s[16:19], s25 offen offset:1024 sc1
    s_add_u32 s25, s25, 2048
    v_fma_f32 v36, v130, v144, v148
    v_fma_f32 v37, v134, v145, v149
    v_fma_f32 v38, v138, v146, v150
    v_fma_f32 v39, v142, v147, v151
    v_fma_f32 v40, v131, v144, v148
    v_fma_f32 v41, v135, v145, v149
    v_fma_f32 v42, v139, v146, v150
    v_fma_f32 v43, v143, v147, v151
    v_mul_f32 v44, v36, v36
    v_mul_f32 v45, v37, v37
    v_mul_f32 v46, v38, v38
    v_mul_f32 v47, v39, v39
    v_mul_f32 v48, v40, v40
    v_mul_f32 v49, v41, v41
    v_mul_f32 v50, v42, v42
    v_mul_f32 v51, v43, v43
    v_fma_f32 v44, v44, s31, v15
    v_fma_f32 v45, v45, s31, v15
    v_fma_f32 v46, v46, s31, v15
    v_fma_f32 v47, v47, s31, v15
    v_fma_f32 v48, v48, s31, v15
    v_fma_f32 v49, v49, s31, v15
    v_fma_f32 v50, v50, s31, v15
    v_fma_f32 v51, v51, s31, v15
    v_mul_f32 v44, v44, v36
    v_mul_f32 v45, v45, v37
    v_mul_f32 v46, v46, v38
    v_mul_f32 v47, v47, v39
    v_mul_f32 v48, v48, v40
    v_mul_f32 v49, v49, v41
    v_mul_f32 v50, v50, v42
    v_mul_f32 v51, v51, v43
    v_exp_f32 v44, v44
    v_exp_f32 v45, v45
    v_exp_f32 v46, v46
    v_exp_f32 v47, v47
    v_exp_f32 v48, v48
    v_exp_f32 v49, v49
    v_exp_f32 v50, v50
    v_exp_f32 v51, v51
    v_add_f32 v44, 1.0, v44
    v_add_f32 v45, 1.0, v45
    v_add_f32 v46, 1.0, v46
    v_add_f32 v47, 1.0, v47
    v_add_f32 v48, 1.0, v48
    v_add_f32 v49, 1.0, v49
    v_add_f32 v50, 1.0, v50
    v_add_f32 v51, 1.0, v51
    v_rcp_f32 v44, v44
    v_rcp_f32 v45, v45
    v_rcp_f32 v46, v46
    v_rcp_f32 v47, v47
    v_rcp_f32 v48, v48
    v_rcp_f32 v49, v49
    v_rcp_f32 v50, v50
    v_rcp_f32 v51, v51
    v_mul_f32 v36, v36, v44
    v_mul_f32 v37, v37, v45
    v_mul_f32 v38, v38, v46
    v_mul_f32 v39, v39, v47
    v_mul_f32 v40, v40, v48
    v_mul_f32 v41, v41, v49
    v_mul_f32 v42, v42, v50
    v_mul_f32 v43, v43, v51
    v_cvt_pk_bf16_f32 v52, v36, v37
    v_cvt_pk_bf16_f32 v53, v38, v39
    buffer_store_dwordx2 v[52:53], v7, s[16:19], s25 offen offset:0 sc1
    v_cvt_pk_bf16_f32 v54, v40, v41
    v_cvt_pk_bf16_f32 v55, v42, v43
    buffer_store_dwordx2 v[54:55], v7, s[16:19], s25 offen offset:1024 sc1
    s_add_u32 s25, s25, 2048
    s_add_u32 s25, s25, 12288
K34_END:
    s_endpgm
TEXT_END:
.section .rodata,"a"
.p2align 6
.amdhsa_kernel k1_xform_kernel
  .amdhsa_next_free_vgpr 128
  .amdhsa_next_free_sgpr 96
  .amdhsa_accum_offset 128
  .amdhsa_group_segment_fixed_size 0
  .amdhsa_kernarg_size 56
  .amdhsa_user_sgpr_count 2
  .amdhsa_user_sgpr_kernarg_segment_ptr 1
  .amdhsa_system_sgpr_workgroup_id_x 1
.end_amdhsa_kernel
.p2align 6
.amdhsa_kernel k12_fused_kernel
  .amdhsa_next_free_vgpr 256
  .amdhsa_next_free_sgpr 96
  .amdhsa_accum_offset 256
  .amdhsa_group_segment_fixed_size 0
  .amdhsa_kernarg_size 56
  .amdhsa_user_sgpr_count 2
  .amdhsa_user_sgpr_kernarg_segment_ptr 1
  .amdhsa_system_sgpr_workgroup_id_x 1
.end_amdhsa_kernel
.p2align 6
.amdhsa_kernel k34_out_kernel
  .amdhsa_next_free_vgpr 168
  .amdhsa_next_free_sgpr 96
  .amdhsa_accum_offset 168
  .amdhsa_group_segment_fixed_size 0
  .amdhsa_kernarg_size 56
  .amdhsa_user_sgpr_count 2
  .amdhsa_user_sgpr_kernarg_segment_ptr 1
  .amdhsa_system_sgpr_workgroup_id_x 1
.end_amdhsa_kernel
```

```asm
; @launch kernel=k1_xform_kernel grid=(636,1,1) block=(256,1,1) lds=16384
; @launch kernel=k12_fused_kernel grid=(256,1,1) block=(512,1,1) lds=155872
; @launch kernel=k34_out_kernel grid=(256,1,1) block=(768,1,1) lds=18944
.amdgcn_target "amdgcn-amd-amdhsa--gfx950"
.text
.globl k1_xform_kernel
.globl k12_fused_kernel
.globl k34_out_kernel
.p2align 8
.type k1_xform_kernel,@function
k1_xform_kernel:
    s_cmp_ge_u32 s2, 636
    s_cbranch_scc1 K1_END
    s_load_dwordx4 s[4:7], s[0:1], 0
    s_load_dwordx2 s[8:9], s[0:1], 48
    s_cmp_lt_u32 s2, 8
    s_cbranch_scc0 K1_NOCPF
    s_getpc_b64 s[90:91]
CPF_K1:
    s_sub_u32 s90, s90, CPF_K1-k1_xform_kernel
    s_subb_u32 s91, s91, 0
    v_lshlrev_b32 v8, 7, v0
    v_mov_b32 v11, s91
    v_min_u32 v9, TEXT_END-k1_xform_kernel-4, v8
    v_add_co_u32 v10, vcc, s90, v9
    v_addc_co_u32 v11, vcc, 0, v11, vcc
    global_load_dword v63, v[10:11], off
    v_mov_b32 v11, s91
    v_add_u32 v8, 32768, v8
    v_min_u32 v9, TEXT_END-k1_xform_kernel-4, v8
    v_add_co_u32 v10, vcc, s90, v9
    v_addc_co_u32 v11, vcc, 0, v11, vcc
    global_load_dword v63, v[10:11], off
K1_NOCPF:
    v_lshrrev_b32 v120, 6, v0
    v_and_b32 v121, 63, v0
    v_readfirstlane_b32 s3, v120
    v_and_b32 v122, 15, v121
    v_lshrrev_b32 v123, 4, v121
    s_mov_b32 s28, 0x05040100
    s_mov_b32 s29, 0x07060302
    v_and_b32 v124, 3, v122
    v_lshlrev_b32 v124, 2, v124
    v_lshrrev_b32 v125, 3, v122
    v_lshl_add_u32 v124, v125, 1, v124
    s_lshl_b32 s10, s3, 4
    s_add_u32 s10, s10, 1
    v_add_u32 v124, s10, v124
    v_bfe_u32 v125, v122, 2, 1
    v_lshlrev_b32 v121, 4, v121
    s_waitcnt lgkmcnt(0)
    s_or_b32 s10, s2, s3
    s_cmp_eq_u32 s10, 0
    s_cbranch_scc0 K1_NOCLR
    s_add_u32 s12, s8, 153092096
    s_addc_u32 s13, s9, 0
    s_and_b32 s13, s13, 0xffff
    s_mov_b32 s14, 32768
    s_mov_b32 s15, 0x00020000
    v_lshrrev_b32 v118, 4, v121
    v_lshlrev_b32 v119, 10, v118
    v_mov_b32 v117, 0
    s_mov_b64 exec, 0xffff
    buffer_store_dword v117, v119, s[12:15], 0 offen
    v_lshlrev_b32 v119, 4, v118
    v_add_u32 v119, 16384, v119
    buffer_store_dword v117, v119, s[12:15], 0 offen
    s_mov_b64 exec, -1
K1_NOCLR:
    s_cmp_lt_u32 s2, 32
    s_cbranch_scc0 K1_NOFILL
    s_add_u32 s12, s8, 153616384
    s_addc_u32 s13, s9, 0
    s_and_b32 s13, s13, 0xffff
    s_mov_b32 s14, 131072
    s_mov_b32 s15, 0x00020000
    s_lshl_b32 s10, s2, 2
    s_add_u32 s10, s10, s3
    s_lshl_b32 s10, s10, 10
    v_mov_b32 v112, -1
    v_mov_b32 v113, -1
    v_mov_b32 v114, -1
    v_mov_b32 v115, -1
    buffer_store_dwordx4 v[112:115], v121, s[12:15], s10 offen
K1_NOFILL:
    s_add_u32 s10, s2, 384
    s_sub_u32 s11, s2, 252
    s_cmp_lt_u32 s2, 252
    s_cselect_b32 s2, s10, s11
    s_cmp_lt_u32 s2, 384
    s_cbranch_scc1 K1_W
    s_sub_u32 s11, s2, 384
    s_mul_hi_u32 s13, s11, 1431655766
    s_mul_i32 s12, s13, 3
    s_sub_u32 s12, s11, s12
    s_mov_b32 s11, s13
    s_cmp_ge_u32 s11, 42
    s_cselect_b32 s13, 1, 0
    s_mul_i32 s14, s13, 42
    s_sub_u32 s11, s11, s14
    s_lshl_b32 s11, s11, 2
    s_add_u32 s11, s11, s3
    s_mul_i32 s14, s13, 16384000
    s_add_u32 s16, s4, s14
    s_addc_u32 s17, s5, 0
    s_and_b32 s17, s17, 0xffff
    s_mov_b32 s18, 16384000
    s_mov_b32 s19, 0x00020000
    s_mov_b32 s20, s8
    s_mov_b32 s21, s9
    s_and_b32 s21, s21, 0xffff
    s_mov_b32 s22, 43778048
    s_mov_b32 s23, 0x00020000
    v_lshlrev_b32 v126, 14, v123
    v_lshl_add_u32 v126, v122, 4, v126
    s_mul_i32 s15, s11, 98304
    s_lshl_b32 s24, s12, 8
    s_add_u32 s15, s15, s24
    buffer_load_dwordx4 v[0:3], v126, s[16:19], s15 offen
    buffer_load_dwordx4 v[4:7], v126, s[16:19], s15 offen offset:2048
    s_add_u32 s15, s15, 4096
    buffer_load_dwordx4 v[8:11], v126, s[16:19], s15 offen
    buffer_load_dwordx4 v[12:15], v126, s[16:19], s15 offen offset:2048
    s_add_u32 s15, s15, 4096
    buffer_load_dwordx4 v[16:19], v126, s[16:19], s15 offen
    buffer_load_dwordx4 v[20:23], v126, s[16:19], s15 offen offset:2048
    s_add_u32 s15, s15, 4096
    buffer_load_dwordx4 v[24:27], v126, s[16:19], s15 offen
    buffer_load_dwordx4 v[28:31], v126, s[16:19], s15 offen offset:2048
    s_add_u32 s15, s15, 53248
    buffer_load_dwordx4 v[32:35], v126, s[16:19], s15 offen
    buffer_load_dwordx4 v[36:39], v126, s[16:19], s15 offen offset:2048
    s_add_u32 s15, s15, 4096
    buffer_load_dwordx4 v[40:43], v126, s[16:19], s15 offen
    buffer_load_dwordx4 v[44:47], v126, s[16:19], s15 offen offset:2048
    s_add_u32 s15, s15, 4096
    buffer_load_dwordx4 v[48:51], v126, s[16:19], s15 offen
    buffer_load_dwordx4 v[52:55], v126, s[16:19], s15 offen offset:2048
    s_add_u32 s15, s15, 4096
    buffer_load_dwordx4 v[56:59], v126, s[16:19], s15 offen
    buffer_load_dwordx4 v[60:63], v126, s[16:19], s15 offen offset:2048
    v_lshlrev_b32 v127, 3, v123
    v_lshlrev_b32 v112, 5, v125
    v_mad_u32_u24 v113, v124, v127, v112
    v_mad_u32_u24 v64, v124, 0, v113
    v_mad_u32_u24 v65, v124, 1, v113
    v_mad_u32_u24 v66, v124, 2, v113
    v_mad_u32_u24 v67, v124, 3, v113
    v_mad_u32_u24 v68, v124, 4, v113
    v_mad_u32_u24 v69, v124, 5, v113
    v_mad_u32_u24 v70, v124, 6, v113
    v_mad_u32_u24 v71, v124, 7, v113
    v_and_b32 v64, 127, v64
    v_and_b32 v65, 127, v65
    v_and_b32 v66, 127, v66
    v_and_b32 v67, 127, v67
    v_and_b32 v68, 127, v68
    v_and_b32 v69, 127, v69
    v_and_b32 v70, 127, v70
    v_and_b32 v71, 127, v71
    v_cvt_f32_u32 v64, v64
    v_cvt_f32_u32 v65, v65
    v_cvt_f32_u32 v66, v66
    v_cvt_f32_u32 v67, v67
    v_cvt_f32_u32 v68, v68
    v_cvt_f32_u32 v69, v69
    v_cvt_f32_u32 v70, v70
    v_cvt_f32_u32 v71, v71
    v_mul_f32 v64, 0x3c000000, v64
    v_mul_f32 v65, 0x3c000000, v65
    v_mul_f32 v66, 0x3c000000, v66
    v_mul_f32 v67, 0x3c000000, v67
    v_mul_f32 v68, 0x3c000000, v68
    v_mul_f32 v69, 0x3c000000, v69
    v_mul_f32 v70, 0x3c000000, v70
    v_mul_f32 v71, 0x3c000000, v71
    v_cos_f32 v64, v64
    v_cos_f32 v65, v65
    v_cos_f32 v66, v66
    v_cos_f32 v67, v67
    v_cos_f32 v68, v68
    v_cos_f32 v69, v69
    v_cos_f32 v70, v70
    v_cos_f32 v71, v71
    s_nop 0
    v_cvt_pk_bf16_f32 v72, v64, v65
    v_cvt_pk_bf16_f32 v73, v66, v67
    v_cvt_pk_bf16_f32 v74, v68, v69
    v_cvt_pk_bf16_f32 v75, v70, v71
    v_lshlrev_b32 v80, 16, v72
    v_and_b32 v81, 0xffff0000, v72
    v_sub_f32 v64, v64, v80
    v_sub_f32 v65, v65, v81
    v_lshlrev_b32 v80, 16, v73
    v_and_b32 v81, 0xffff0000, v73
    v_sub_f32 v66, v66, v80
    v_sub_f32 v67, v67, v81
    v_lshlrev_b32 v80, 16, v74
    v_and_b32 v81, 0xffff0000, v74
    v_sub_f32 v68, v68, v80
    v_sub_f32 v69, v69, v81
    v_lshlrev_b32 v80, 16, v75
    v_and_b32 v81, 0xffff0000, v75
    v_sub_f32 v70, v70, v80
    v_sub_f32 v71, v71, v81
    v_cvt_pk_bf16_f32 v76, v64, v65
    v_cvt_pk_bf16_f32 v77, v66, v67
    v_cvt_pk_bf16_f32 v78, v68, v69
    v_cvt_pk_bf16_f32 v79, v70, v71
    s_lshl_b32 s24, s3, 12
    v_add_u32 v114, s24, v121
    ds_write_b128 v114, v[72:75] offset:0
    ds_write_b128 v114, v[76:79] offset:1024
    v_add_u32 v127, 32, v127
    v_lshlrev_b32 v112, 5, v125
    v_mad_u32_u24 v113, v124, v127, v112
    v_mad_u32_u24 v64, v124, 0, v113
    v_mad_u32_u24 v65, v124, 1, v113
    v_mad_u32_u24 v66, v124, 2, v113
    v_mad_u32_u24 v67, v124, 3, v113
    v_mad_u32_u24 v68, v124, 4, v113
    v_mad_u32_u24 v69, v124, 5, v113
    v_mad_u32_u24 v70, v124, 6, v113
    v_mad_u32_u24 v71, v124, 7, v113
    v_and_b32 v64, 127, v64
    v_and_b32 v65, 127, v65
    v_and_b32 v66, 127, v66
    v_and_b32 v67, 127, v67
    v_and_b32 v68, 127, v68
    v_and_b32 v69, 127, v69
    v_and_b32 v70, 127, v70
    v_and_b32 v71, 127, v71
    v_cvt_f32_u32 v64, v64
    v_cvt_f32_u32 v65, v65
    v_cvt_f32_u32 v66, v66
    v_cvt_f32_u32 v67, v67
    v_cvt_f32_u32 v68, v68
    v_cvt_f32_u32 v69, v69
    v_cvt_f32_u32 v70, v70
    v_cvt_f32_u32 v71, v71
    v_mul_f32 v64, 0x3c000000, v64
    v_mul_f32 v65, 0x3c000000, v65
    v_mul_f32 v66, 0x3c000000, v66
    v_mul_f32 v67, 0x3c000000, v67
    v_mul_f32 v68, 0x3c000000, v68
    v_mul_f32 v69, 0x3c000000, v69
    v_mul_f32 v70, 0x3c000000, v70
    v_mul_f32 v71, 0x3c000000, v71
    v_cos_f32 v64, v64
    v_cos_f32 v65, v65
    v_cos_f32 v66, v66
    v_cos_f32 v67, v67
    v_cos_f32 v68, v68
    v_cos_f32 v69, v69
    v_cos_f32 v70, v70
    v_cos_f32 v71, v71
    s_nop 0
    v_cvt_pk_bf16_f32 v72, v64, v65
    v_cvt_pk_bf16_f32 v73, v66, v67
    v_cvt_pk_bf16_f32 v74, v68, v69
    v_cvt_pk_bf16_f32 v75, v70, v71
    v_lshlrev_b32 v80, 16, v72
    v_and_b32 v81, 0xffff0000, v72
    v_sub_f32 v64, v64, v80
    v_sub_f32 v65, v65, v81
    v_lshlrev_b32 v80, 16, v73
    v_and_b32 v81, 0xffff0000, v73
    v_sub_f32 v66, v66, v80
    v_sub_f32 v67, v67, v81
    v_lshlrev_b32 v80, 16, v74
    v_and_b32 v81, 0xffff0000, v74
    v_sub_f32 v68, v68, v80
    v_sub_f32 v69, v69, v81
    v_lshlrev_b32 v80, 16, v75
    v_and_b32 v81, 0xffff0000, v75
    v_sub_f32 v70, v70, v80
    v_sub_f32 v71, v71, v81
    v_cvt_pk_bf16_f32 v76, v64, v65
    v_cvt_pk_bf16_f32 v77, v66, v67
    v_cvt_pk_bf16_f32 v78, v68, v69
    v_cvt_pk_bf16_f32 v79, v70, v71
    s_lshl_b32 s24, s3, 12
    v_add_u32 v114, s24, v121
    ds_write_b128 v114, v[72:75] offset:2048
    ds_write_b128 v114, v[76:79] offset:3072
    v_lshrrev_b32 v112, 1, v123
    s_mov_b32 s24, 1368064
    v_mul_lo_u32 v112, v112, s24
    v_lshrrev_b32 v113, 2, v122
    s_mov_b32 s24, 21376
    v_mul_lo_u32 v113, v113, s24
    v_add_u32 v112, v112, v113
    v_and_b32 v113, 3, v122
    v_and_b32 v114, 1, v123
    v_lshl_add_u32 v113, v114, 2, v113
    s_add_u32 s24, s11, 7
    s_cmp_ge_u32 s11, 160
    s_cselect_b32 s24, s24, s11
    s_cmp_eq_u32 s13, 1
    s_cselect_b32 s24, s24, s11
    s_lshr_b32 s24, s24, 1
    s_and_b32 s24, s24, 7
    v_xor_b32 v113, s24, v113
    v_lshl_add_u32 v120, v113, 4, v112
    s_mul_i32 s25, s13, 684032
    s_mul_i32 s24, s12, 85504
    s_add_u32 s25, s25, s24
    s_lshl_b32 s24, s11, 7
    s_add_u32 s25, s25, s24
    s_waitcnt lgkmcnt(0)
    s_barrier
    s_cmp_ge_u32 s11, 167
    s_cbranch_scc1 K1_END
    s_waitcnt vmcnt(8)
    v_perm_b32 v64, v4, v0, s28
    v_perm_b32 v68, v4, v0, s29
    v_perm_b32 v65, v12, v8, s28
    v_perm_b32 v69, v12, v8, s29
    v_perm_b32 v66, v20, v16, s28
    v_perm_b32 v70, v20, v16, s29
    v_perm_b32 v67, v28, v24, s28
    v_perm_b32 v71, v28, v24, s29
    v_perm_b32 v72, v5, v1, s28
    v_perm_b32 v76, v5, v1, s29
    v_perm_b32 v73, v13, v9, s28
    v_perm_b32 v77, v13, v9, s29
    v_perm_b32 v74, v21, v17, s28
    v_perm_b32 v78, v21, v17, s29
    v_perm_b32 v75, v29, v25, s28
    v_perm_b32 v79, v29, v25, s29
    v_perm_b32 v80, v6, v2, s28
    v_perm_b32 v84, v6, v2, s29
    v_perm_b32 v81, v14, v10, s28
    v_perm_b32 v85, v14, v10, s29
    v_perm_b32 v82, v22, v18, s28
    v_perm_b32 v86, v22, v18, s29
    v_perm_b32 v83, v30, v26, s28
    v_perm_b32 v87, v30, v26, s29
    v_perm_b32 v88, v7, v3, s28
    v_perm_b32 v92, v7, v3, s29
    v_perm_b32 v89, v15, v11, s28
    v_perm_b32 v93, v15, v11, s29
    v_perm_b32 v90, v23, v19, s28
    v_perm_b32 v94, v23, v19, s29
    v_perm_b32 v91, v31, v27, s28
    v_perm_b32 v95, v31, v27, s29
    s_waitcnt vmcnt(0)
    v_perm_b32 v0, v36, v32, s28
    v_perm_b32 v4, v36, v32, s29
    v_perm_b32 v1, v44, v40, s28
    v_perm_b32 v5, v44, v40, s29
    v_perm_b32 v2, v52, v48, s28
    v_perm_b32 v6, v52, v48, s29
    v_perm_b32 v3, v60, v56, s28
    v_perm_b32 v7, v60, v56, s29
    v_perm_b32 v8, v37, v33, s28
    v_perm_b32 v12, v37, v33, s29
    v_perm_b32 v9, v45, v41, s28
    v_perm_b32 v13, v45, v41, s29
    v_perm_b32 v10, v53, v49, s28
    v_perm_b32 v14, v53, v49, s29
    v_perm_b32 v11, v61, v57, s28
    v_perm_b32 v15, v61, v57, s29
    v_perm_b32 v16, v38, v34, s28
    v_perm_b32 v20, v38, v34, s29
    v_perm_b32 v17, v46, v42, s28
    v_perm_b32 v21, v46, v42, s29
    v_perm_b32 v18, v54, v50, s28
    v_perm_b32 v22, v54, v50, s29
    v_perm_b32 v19, v62, v58, s28
    v_perm_b32 v23, v62, v58, s29
    v_perm_b32 v24, v39, v35, s28
    v_perm_b32 v28, v39, v35, s29
    v_perm_b32 v25, v47, v43, s28
    v_perm_b32 v29, v47, v43, s29
    v_perm_b32 v26, v55, v51, s28
    v_perm_b32 v30, v55, v51, s29
    v_perm_b32 v27, v63, v59, s28
    v_perm_b32 v31, v63, v59, s29
    ds_read_b128 v[96:99], v121 offset:0
    ds_read_b128 v[100:103], v121 offset:1024
    ds_read_b128 v[104:107], v121 offset:2048
    ds_read_b128 v[108:111], v121 offset:3072
    s_waitcnt lgkmcnt(3)
    v_mfma_f32_16x16x32_bf16 v[32:35], v[96:99], v[64:67], 0
    v_mfma_f32_16x16x32_bf16 v[36:39], v[96:99], v[68:71], 0
    v_mfma_f32_16x16x32_bf16 v[40:43], v[96:99], v[72:75], 0
    v_mfma_f32_16x16x32_bf16 v[44:47], v[96:99], v[76:79], 0
    v_mfma_f32_16x16x32_bf16 v[48:51], v[96:99], v[80:83], 0
    v_mfma_f32_16x16x32_bf16 v[52:55], v[96:99], v[84:87], 0
    v_mfma_f32_16x16x32_bf16 v[56:59], v[96:99], v[88:91], 0
    v_mfma_f32_16x16x32_bf16 v[60:63], v[96:99], v[92:95], 0
    s_waitcnt lgkmcnt(2)
    v_mfma_f32_16x16x32_bf16 v[32:35], v[100:103], v[64:67], v[32:35]
    v_mfma_f32_16x16x32_bf16 v[36:39], v[100:103], v[68:71], v[36:39]
    v_mfma_f32_16x16x32_bf16 v[40:43], v[100:103], v[72:75], v[40:43]
    v_mfma_f32_16x16x32_bf16 v[44:47], v[100:103], v[76:79], v[44:47]
    v_mfma_f32_16x16x32_bf16 v[48:51], v[100:103], v[80:83], v[48:51]
    v_mfma_f32_16x16x32_bf16 v[52:55], v[100:103], v[84:87], v[52:55]
    v_mfma_f32_16x16x32_bf16 v[56:59], v[100:103], v[88:91], v[56:59]
    v_mfma_f32_16x16x32_bf16 v[60:63], v[100:103], v[92:95], v[60:63]
    s_waitcnt lgkmcnt(1)
    v_mfma_f32_16x16x32_bf16 v[32:35], v[104:107], v[0:3], v[32:35]
    v_mfma_f32_16x16x32_bf16 v[36:39], v[104:107], v[4:7], v[36:39]
    v_mfma_f32_16x16x32_bf16 v[40:43], v[104:107], v[8:11], v[40:43]
    v_mfma_f32_16x16x32_bf16 v[44:47], v[104:107], v[12:15], v[44:47]
    v_mfma_f32_16x16x32_bf16 v[48:51], v[104:107], v[16:19], v[48:51]
    v_mfma_f32_16x16x32_bf16 v[52:55], v[104:107], v[20:23], v[52:55]
    v_mfma_f32_16x16x32_bf16 v[56:59], v[104:107], v[24:27], v[56:59]
    v_mfma_f32_16x16x32_bf16 v[60:63], v[104:107], v[28:31], v[60:63]
    s_waitcnt lgkmcnt(0)
    v_mfma_f32_16x16x32_bf16 v[32:35], v[108:111], v[0:3], v[32:35]
    v_mfma_f32_16x16x32_bf16 v[36:39], v[108:111], v[4:7], v[36:39]
    v_mfma_f32_16x16x32_bf16 v[40:43], v[108:111], v[8:11], v[40:43]
    v_mfma_f32_16x16x32_bf16 v[44:47], v[108:111], v[12:15], v[44:47]
    v_mfma_f32_16x16x32_bf16 v[48:51], v[108:111], v[16:19], v[48:51]
    v_mfma_f32_16x16x32_bf16 v[52:55], v[108:111], v[20:23], v[52:55]
    v_mfma_f32_16x16x32_bf16 v[56:59], v[108:111], v[24:27], v[56:59]
    v_mfma_f32_16x16x32_bf16 v[60:63], v[108:111], v[28:31], v[60:63]
    s_nop 7
    v_cvt_pk_bf16_f32 v112, v32, v36
    v_cvt_pk_bf16_f32 v113, v40, v44
    v_cvt_pk_bf16_f32 v114, v48, v52
    v_cvt_pk_bf16_f32 v115, v56, v60
    buffer_store_dwordx4 v[112:115], v120, s[20:23], s25 offen
    s_add_u32 s25, s25, 2736128
    v_cvt_pk_bf16_f32 v116, v33, v37
    v_cvt_pk_bf16_f32 v117, v41, v45
    v_cvt_pk_bf16_f32 v118, v49, v53
    v_cvt_pk_bf16_f32 v119, v57, v61
    buffer_store_dwordx4 v[116:119], v120, s[20:23], s25 offen
    s_add_u32 s25, s25, 2736128
    v_cvt_pk_bf16_f32 v112, v34, v38
    v_cvt_pk_bf16_f32 v113, v42, v46
    v_cvt_pk_bf16_f32 v114, v50, v54
    v_cvt_pk_bf16_f32 v115, v58, v62
    buffer_store_dwordx4 v[112:115], v120, s[20:23], s25 offen
    s_add_u32 s25, s25, 2736128
    v_cvt_pk_bf16_f32 v116, v35, v39
    v_cvt_pk_bf16_f32 v117, v43, v47
    v_cvt_pk_bf16_f32 v118, v51, v55
    v_cvt_pk_bf16_f32 v119, v59, v63
    buffer_store_dwordx4 v[116:119], v120, s[20:23], s25 offen
    s_add_u32 s25, s25, 2736128
    ds_read_b128 v[96:99], v121 offset:4096
    ds_read_b128 v[100:103], v121 offset:5120
    ds_read_b128 v[104:107], v121 offset:6144
    ds_read_b128 v[108:111], v121 offset:7168
    s_waitcnt lgkmcnt(3)
    v_mfma_f32_16x16x32_bf16 v[32:35], v[96:99], v[64:67], 0
    v_mfma_f32_16x16x32_bf16 v[36:39], v[96:99], v[68:71], 0
    v_mfma_f32_16x16x32_bf16 v[40:43], v[96:99], v[72:75], 0
    v_mfma_f32_16x16x32_bf16 v[44:47], v[96:99], v[76:79], 0
    v_mfma_f32_16x16x32_bf16 v[48:51], v[96:99], v[80:83], 0
    v_mfma_f32_16x16x32_bf16 v[52:55], v[96:99], v[84:87], 0
    v_mfma_f32_16x16x32_bf16 v[56:59], v[96:99], v[88:91], 0
    v_mfma_f32_16x16x32_bf16 v[60:63], v[96:99], v[92:95], 0
    s_waitcnt lgkmcnt(2)
    v_mfma_f32_16x16x32_bf16 v[32:35], v[100:103], v[64:67], v[32:35]
    v_mfma_f32_16x16x32_bf16 v[36:39], v[100:103], v[68:71], v[36:39]
    v_mfma_f32_16x16x32_bf16 v[40:43], v[100:103], v[72:75], v[40:43]
    v_mfma_f32_16x16x32_bf16 v[44:47], v[100:103], v[76:79], v[44:47]
    v_mfma_f32_16x16x32_bf16 v[48:51], v[100:103], v[80:83], v[48:51]
    v_mfma_f32_16x16x32_bf16 v[52:55], v[100:103], v[84:87], v[52:55]
    v_mfma_f32_16x16x32_bf16 v[56:59], v[100:103], v[88:91], v[56:59]
    v_mfma_f32_16x16x32_bf16 v[60:63], v[100:103], v[92:95], v[60:63]
    s_waitcnt lgkmcnt(1)
    v_mfma_f32_16x16x32_bf16 v[32:35], v[104:107], v[0:3], v[32:35]
    v_mfma_f32_16x16x32_bf16 v[36:39], v[104:107], v[4:7], v[36:39]
    v_mfma_f32_16x16x32_bf16 v[40:43], v[104:107], v[8:11], v[40:43]
    v_mfma_f32_16x16x32_bf16 v[44:47], v[104:107], v[12:15], v[44:47]
    v_mfma_f32_16x16x32_bf16 v[48:51], v[104:107], v[16:19], v[48:51]
    v_mfma_f32_16x16x32_bf16 v[52:55], v[104:107], v[20:23], v[52:55]
    v_mfma_f32_16x16x32_bf16 v[56:59], v[104:107], v[24:27], v[56:59]
    v_mfma_f32_16x16x32_bf16 v[60:63], v[104:107], v[28:31], v[60:63]
    s_waitcnt lgkmcnt(0)
    v_mfma_f32_16x16x32_bf16 v[32:35], v[108:111], v[0:3], v[32:35]
    v_mfma_f32_16x16x32_bf16 v[36:39], v[108:111], v[4:7], v[36:39]
    v_mfma_f32_16x16x32_bf16 v[40:43], v[108:111], v[8:11], v[40:43]
    v_mfma_f32_16x16x32_bf16 v[44:47], v[108:111], v[12:15], v[44:47]
    v_mfma_f32_16x16x32_bf16 v[48:51], v[108:111], v[16:19], v[48:51]
    v_mfma_f32_16x16x32_bf16 v[52:55], v[108:111], v[20:23], v[52:55]
    v_mfma_f32_16x16x32_bf16 v[56:59], v[108:111], v[24:27], v[56:59]
    v_mfma_f32_16x16x32_bf16 v[60:63], v[108:111], v[28:31], v[60:63]
    s_nop 7
    v_cvt_pk_bf16_f32 v112, v32, v36
    v_cvt_pk_bf16_f32 v113, v40, v44
    v_cvt_pk_bf16_f32 v114, v48, v52
    v_cvt_pk_bf16_f32 v115, v56, v60
    buffer_store_dwordx4 v[112:115], v120, s[20:23], s25 offen
    s_add_u32 s25, s25, 2736128
    v_cvt_pk_bf16_f32 v116, v33, v37
    v_cvt_pk_bf16_f32 v117, v41, v45
    v_cvt_pk_bf16_f32 v118, v49, v53
    v_cvt_pk_bf16_f32 v119, v57, v61
    buffer_store_dwordx4 v[116:119], v120, s[20:23], s25 offen
    s_add_u32 s25, s25, 2736128
    v_cvt_pk_bf16_f32 v112, v34, v38
    v_cvt_pk_bf16_f32 v113, v42, v46
    v_cvt_pk_bf16_f32 v114, v50, v54
    v_cvt_pk_bf16_f32 v115, v58, v62
    buffer_store_dwordx4 v[112:115], v120, s[20:23], s25 offen
    s_add_u32 s25, s25, 2736128
    v_cvt_pk_bf16_f32 v116, v35, v39
    v_cvt_pk_bf16_f32 v117, v43, v47
    v_cvt_pk_bf16_f32 v118, v51, v55
    v_cvt_pk_bf16_f32 v119, v59, v63
    buffer_store_dwordx4 v[116:119], v120, s[20:23], s25 offen
    s_add_u32 s25, s25, 2736128
    ds_read_b128 v[96:99], v121 offset:8192
    ds_read_b128 v[100:103], v121 offset:9216
    ds_read_b128 v[104:107], v121 offset:10240
    ds_read_b128 v[108:111], v121 offset:11264
    s_waitcnt lgkmcnt(3)
    v_mfma_f32_16x16x32_bf16 v[32:35], v[96:99], v[64:67], 0
    v_mfma_f32_16x16x32_bf16 v[36:39], v[96:99], v[68:71], 0
    v_mfma_f32_16x16x32_bf16 v[40:43], v[96:99], v[72:75], 0
    v_mfma_f32_16x16x32_bf16 v[44:47], v[96:99], v[76:79], 0
    v_mfma_f32_16x16x32_bf16 v[48:51], v[96:99], v[80:83], 0
    v_mfma_f32_16x16x32_bf16 v[52:55], v[96:99], v[84:87], 0
    v_mfma_f32_16x16x32_bf16 v[56:59], v[96:99], v[88:91], 0
    v_mfma_f32_16x16x32_bf16 v[60:63], v[96:99], v[92:95], 0
    s_waitcnt lgkmcnt(2)
    v_mfma_f32_16x16x32_bf16 v[32:35], v[100:103], v[64:67], v[32:35]
    v_mfma_f32_16x16x32_bf16 v[36:39], v[100:103], v[68:71], v[36:39]
    v_mfma_f32_16x16x32_bf16 v[40:43], v[100:103], v[72:75], v[40:43]
    v_mfma_f32_16x16x32_bf16 v[44:47], v[100:103], v[76:79], v[44:47]
    v_mfma_f32_16x16x32_bf16 v[48:51], v[100:103], v[80:83], v[48:51]
    v_mfma_f32_16x16x32_bf16 v[52:55], v[100:103], v[84:87], v[52:55]
    v_mfma_f32_16x16x32_bf16 v[56:59], v[100:103], v[88:91], v[56:59]
    v_mfma_f32_16x16x32_bf16 v[60:63], v[100:103], v[92:95], v[60:63]
    s_waitcnt lgkmcnt(1)
    v_mfma_f32_16x16x32_bf16 v[32:35], v[104:107], v[0:3], v[32:35]
    v_mfma_f32_16x16x32_bf16 v[36:39], v[104:107], v[4:7], v[36:39]
    v_mfma_f32_16x16x32_bf16 v[40:43], v[104:107], v[8:11], v[40:43]
    v_mfma_f32_16x16x32_bf16 v[44:47], v[104:107], v[12:15], v[44:47]
    v_mfma_f32_16x16x32_bf16 v[48:51], v[104:107], v[16:19], v[48:51]
    v_mfma_f32_16x16x32_bf16 v[52:55], v[104:107], v[20:23], v[52:55]
    v_mfma_f32_16x16x32_bf16 v[56:59], v[104:107], v[24:27], v[56:59]
    v_mfma_f32_16x16x32_bf16 v[60:63], v[104:107], v[28:31], v[60:63]
    s_waitcnt lgkmcnt(0)
    v_mfma_f32_16x16x32_bf16 v[32:35], v[108:111], v[0:3], v[32:35]
    v_mfma_f32_16x16x32_bf16 v[36:39], v[108:111], v[4:7], v[36:39]
    v_mfma_f32_16x16x32_bf16 v[40:43], v[108:111], v[8:11], v[40:43]
    v_mfma_f32_16x16x32_bf16 v[44:47], v[108:111], v[12:15], v[44:47]
    v_mfma_f32_16x16x32_bf16 v[48:51], v[108:111], v[16:19], v[48:51]
    v_mfma_f32_16x16x32_bf16 v[52:55], v[108:111], v[20:23], v[52:55]
    v_mfma_f32_16x16x32_bf16 v[56:59], v[108:111], v[24:27], v[56:59]
    v_mfma_f32_16x16x32_bf16 v[60:63], v[108:111], v[28:31], v[60:63]
    s_nop 7
    v_cvt_pk_bf16_f32 v112, v32, v36
    v_cvt_pk_bf16_f32 v113, v40, v44
    v_cvt_pk_bf16_f32 v114, v48, v52
    v_cvt_pk_bf16_f32 v115, v56, v60
    buffer_store_dwordx4 v[112:115], v120, s[20:23], s25 offen
    s_add_u32 s25, s25, 2736128
    v_cvt_pk_bf16_f32 v116, v33, v37
    v_cvt_pk_bf16_f32 v117, v41, v45
    v_cvt_pk_bf16_f32 v118, v49, v53
    v_cvt_pk_bf16_f32 v119, v57, v61
    buffer_store_dwordx4 v[116:119], v120, s[20:23], s25 offen
    s_add_u32 s25, s25, 2736128
    v_cvt_pk_bf16_f32 v112, v34, v38
    v_cvt_pk_bf16_f32 v113, v42, v46
    v_cvt_pk_bf16_f32 v114, v50, v54
    v_cvt_pk_bf16_f32 v115, v58, v62
    buffer_store_dwordx4 v[112:115], v120, s[20:23], s25 offen
    s_add_u32 s25, s25, 2736128
    v_cvt_pk_bf16_f32 v116, v35, v39
    v_cvt_pk_bf16_f32 v117, v43, v47
    v_cvt_pk_bf16_f32 v118, v51, v55
    v_cvt_pk_bf16_f32 v119, v59, v63
    buffer_store_dwordx4 v[116:119], v120, s[20:23], s25 offen
    s_add_u32 s25, s25, 2736128
    ds_read_b128 v[96:99], v121 offset:12288
    ds_read_b128 v[100:103], v121 offset:13312
    ds_read_b128 v[104:107], v121 offset:14336
    ds_read_b128 v[108:111], v121 offset:15360
    s_waitcnt lgkmcnt(3)
    v_mfma_f32_16x16x32_bf16 v[32:35], v[96:99], v[64:67], 0
    v_mfma_f32_16x16x32_bf16 v[36:39], v[96:99], v[68:71], 0
    v_mfma_f32_16x16x32_bf16 v[40:43], v[96:99], v[72:75], 0
    v_mfma_f32_16x16x32_bf16 v[44:47], v[96:99], v[76:79], 0
    v_mfma_f32_16x16x32_bf16 v[48:51], v[96:99], v[80:83], 0
    v_mfma_f32_16x16x32_bf16 v[52:55], v[96:99], v[84:87], 0
    v_mfma_f32_16x16x32_bf16 v[56:59], v[96:99], v[88:91], 0
    v_mfma_f32_16x16x32_bf16 v[60:63], v[96:99], v[92:95], 0
    s_waitcnt lgkmcnt(2)
    v_mfma_f32_16x16x32_bf16 v[32:35], v[100:103], v[64:67], v[32:35]
    v_mfma_f32_16x16x32_bf16 v[36:39], v[100:103], v[68:71], v[36:39]
    v_mfma_f32_16x16x32_bf16 v[40:43], v[100:103], v[72:75], v[40:43]
    v_mfma_f32_16x16x32_bf16 v[44:47], v[100:103], v[76:79], v[44:47]
    v_mfma_f32_16x16x32_bf16 v[48:51], v[100:103], v[80:83], v[48:51]
    v_mfma_f32_16x16x32_bf16 v[52:55], v[100:103], v[84:87], v[52:55]
    v_mfma_f32_16x16x32_bf16 v[56:59], v[100:103], v[88:91], v[56:59]
    v_mfma_f32_16x16x32_bf16 v[60:63], v[100:103], v[92:95], v[60:63]
    s_waitcnt lgkmcnt(1)
    v_mfma_f32_16x16x32_bf16 v[32:35], v[104:107], v[0:3], v[32:35]
    v_mfma_f32_16x16x32_bf16 v[36:39], v[104:107], v[4:7], v[36:39]
    v_mfma_f32_16x16x32_bf16 v[40:43], v[104:107], v[8:11], v[40:43]
    v_mfma_f32_16x16x32_bf16 v[44:47], v[104:107], v[12:15], v[44:47]
    v_mfma_f32_16x16x32_bf16 v[48:51], v[104:107], v[16:19], v[48:51]
    v_mfma_f32_16x16x32_bf16 v[52:55], v[104:107], v[20:23], v[52:55]
    v_mfma_f32_16x16x32_bf16 v[56:59], v[104:107], v[24:27], v[56:59]
    v_mfma_f32_16x16x32_bf16 v[60:63], v[104:107], v[28:31], v[60:63]
    s_waitcnt lgkmcnt(0)
    v_mfma_f32_16x16x32_bf16 v[32:35], v[108:111], v[0:3], v[32:35]
    v_mfma_f32_16x16x32_bf16 v[36:39], v[108:111], v[4:7], v[36:39]
    v_mfma_f32_16x16x32_bf16 v[40:43], v[108:111], v[8:11], v[40:43]
    v_mfma_f32_16x16x32_bf16 v[44:47], v[108:111], v[12:15], v[44:47]
    v_mfma_f32_16x16x32_bf16 v[48:51], v[108:111], v[16:19], v[48:51]
    v_mfma_f32_16x16x32_bf16 v[52:55], v[108:111], v[20:23], v[52:55]
    v_mfma_f32_16x16x32_bf16 v[56:59], v[108:111], v[24:27], v[56:59]
    v_mfma_f32_16x16x32_bf16 v[60:63], v[108:111], v[28:31], v[60:63]
    s_nop 7
    v_cvt_pk_bf16_f32 v112, v32, v36
    v_cvt_pk_bf16_f32 v113, v40, v44
    v_cvt_pk_bf16_f32 v114, v48, v52
    v_cvt_pk_bf16_f32 v115, v56, v60
    buffer_store_dwordx4 v[112:115], v120, s[20:23], s25 offen
    s_add_u32 s25, s25, 2736128
    v_cvt_pk_bf16_f32 v116, v33, v37
    v_cvt_pk_bf16_f32 v117, v41, v45
    v_cvt_pk_bf16_f32 v118, v49, v53
    v_cvt_pk_bf16_f32 v119, v57, v61
    buffer_store_dwordx4 v[116:119], v120, s[20:23], s25 offen
    s_add_u32 s25, s25, 2736128
    v_cvt_pk_bf16_f32 v112, v34, v38
    v_cvt_pk_bf16_f32 v113, v42, v46
    v_cvt_pk_bf16_f32 v114, v50, v54
    v_cvt_pk_bf16_f32 v115, v58, v62
    buffer_store_dwordx4 v[112:115], v120, s[20:23], s25 offen
    s_add_u32 s25, s25, 2736128
    v_cvt_pk_bf16_f32 v116, v35, v39
    v_cvt_pk_bf16_f32 v117, v43, v47
    v_cvt_pk_bf16_f32 v118, v51, v55
    v_cvt_pk_bf16_f32 v119, v59, v63
    buffer_store_dwordx4 v[116:119], v120, s[20:23], s25 offen
    s_endpgm
K1_W:
    s_mov_b32 s16, s6
    s_mov_b32 s17, s7
    s_and_b32 s17, s17, 0xffff
    s_mov_b32 s18, 16252928
    s_mov_b32 s19, 0x00020000
    s_add_u32 s20, s8, 50331648
    s_addc_u32 s21, s9, 0
    s_and_b32 s21, s21, 0xffff
    s_mov_b32 s22, 67108864
    s_mov_b32 s23, 0x00020000
    s_mul_i32 s11, s2, 1
    s_lshr_b32 s12, s11, 9
    s_and_b32 s13, s11, 511
    s_lshl_b32 s14, s12, 19
    s_lshl_b32 s15, s13, 10
    s_add_u32 s14, s14, s15
    s_lshl_b32 s15, s3, 8
    s_add_u32 s14, s14, s15
    v_and_b32 v126, 1, v123
    v_lshlrev_b32 v126, 23, v126
    v_lshl_add_u32 v126, v122, 4, v126
    s_mov_b32 s15, s14
    buffer_load_dwordx4 v[0:3], v126, s[16:19], s15 offen
    s_add_u32 s15, s15, 0x100000
    buffer_load_dwordx4 v[4:7], v126, s[16:19], s15 offen
    s_add_u32 s15, s15, 0x100000
    buffer_load_dwordx4 v[8:11], v126, s[16:19], s15 offen
    s_add_u32 s15, s15, 0x100000
    buffer_load_dwordx4 v[12:15], v126, s[16:19], s15 offen
    s_add_u32 s15, s15, 0x100000
    buffer_load_dwordx4 v[16:19], v126, s[16:19], s15 offen
    s_add_u32 s15, s15, 0x100000
    buffer_load_dwordx4 v[20:23], v126, s[16:19], s15 offen
    s_add_u32 s15, s15, 0x100000
    buffer_load_dwordx4 v[24:27], v126, s[16:19], s15 offen
    s_add_u32 s15, s15, 0x100000
    buffer_load_dwordx4 v[28:31], v126, s[16:19], s15 offen
    v_and_b32 v127, 1, v123
    v_lshlrev_b32 v127, 3, v127
    v_mul_u32_u24 v112, 96, v125
    v_mad_u32_u24 v113, v124, v127, v112
    v_mad_u32_u24 v64, v124, 0, v113
    v_mad_u32_u24 v65, v124, 1, v113
    v_mad_u32_u24 v66, v124, 2, v113
    v_mad_u32_u24 v67, v124, 3, v113
    v_mad_u32_u24 v68, v124, 4, v113
    v_mad_u32_u24 v69, v124, 5, v113
    v_mad_u32_u24 v70, v124, 6, v113
    v_mad_u32_u24 v71, v124, 7, v113
    v_and_b32 v64, 127, v64
    v_and_b32 v65, 127, v65
    v_and_b32 v66, 127, v66
    v_and_b32 v67, 127, v67
    v_and_b32 v68, 127, v68
    v_and_b32 v69, 127, v69
    v_and_b32 v70, 127, v70
    v_and_b32 v71, 127, v71
    v_cvt_f32_u32 v64, v64
    v_cvt_f32_u32 v65, v65
    v_cvt_f32_u32 v66, v66
    v_cvt_f32_u32 v67, v67
    v_cvt_f32_u32 v68, v68
    v_cvt_f32_u32 v69, v69
    v_cvt_f32_u32 v70, v70
    v_cvt_f32_u32 v71, v71
    v_mul_f32 v64, 0x3c000000, v64
    v_mul_f32 v65, 0x3c000000, v65
    v_mul_f32 v66, 0x3c000000, v66
    v_mul_f32 v67, 0x3c000000, v67
    v_mul_f32 v68, 0x3c000000, v68
    v_mul_f32 v69, 0x3c000000, v69
    v_mul_f32 v70, 0x3c000000, v70
    v_mul_f32 v71, 0x3c000000, v71
    v_cos_f32 v64, v64
    v_cos_f32 v65, v65
    v_cos_f32 v66, v66
    v_cos_f32 v67, v67
    v_cos_f32 v68, v68
    v_cos_f32 v69, v69
    v_cos_f32 v70, v70
    v_cos_f32 v71, v71
    s_nop 0
    v_cvt_pk_bf16_f32 v72, v64, v65
    v_cvt_pk_bf16_f32 v73, v66, v67
    v_cvt_pk_bf16_f32 v74, v68, v69
    v_cvt_pk_bf16_f32 v75, v70, v71
    v_lshlrev_b32 v80, 16, v72
    v_and_b32 v81, 0xffff0000, v72
    v_sub_f32 v64, v64, v80
    v_sub_f32 v65, v65, v81
    v_lshlrev_b32 v80, 16, v73
    v_and_b32 v81, 0xffff0000, v73
    v_sub_f32 v66, v66, v80
    v_sub_f32 v67, v67, v81
    v_lshlrev_b32 v80, 16, v74
    v_and_b32 v81, 0xffff0000, v74
    v_sub_f32 v68, v68, v80
    v_sub_f32 v69, v69, v81
    v_lshlrev_b32 v80, 16, v75
    v_and_b32 v81, 0xffff0000, v75
    v_sub_f32 v70, v70, v80
    v_sub_f32 v71, v71, v81
    v_cvt_pk_bf16_f32 v76, v64, v65
    v_cvt_pk_bf16_f32 v77, v66, v67
    v_cvt_pk_bf16_f32 v78, v68, v69
    v_cvt_pk_bf16_f32 v79, v70, v71
    v_cmp_lt_u32 vcc, 1, v123
    s_lshl_b32 s24, s3, 10
    v_add_u32 v114, s24, v121
    v_cndmask_b32 v72, v72, v76, vcc
    v_cndmask_b32 v73, v73, v77, vcc
    v_cndmask_b32 v74, v74, v78, vcc
    v_cndmask_b32 v75, v75, v79, vcc
    ds_write_b128 v114, v[72:75]
    v_lshrrev_b32 v112, 1, v123
    s_mov_b32 s24, 2097152
    v_mul_lo_u32 v112, v112, s24
    v_and_b32 v113, 1, v123
    v_lshl_add_u32 v112, v113, 8, v112
    v_and_b32 v113, 1, v122
    v_lshl_add_u32 v124, v113, 4, v112
    v_lshrrev_b32 v125, 1, v122
    s_mul_i32 s26, s3, 524288
    s_lshl_b32 s24, s11, 9
    s_add_u32 s26, s26, s24
    s_waitcnt lgkmcnt(0)
    s_barrier
    ds_read_b128 v[96:99], v121 offset:0
    ds_read_b128 v[100:103], v121 offset:1024
    ds_read_b128 v[104:107], v121 offset:2048
    ds_read_b128 v[108:111], v121 offset:3072
    s_mov_b32 s27, 0
    s_waitcnt vmcnt(0) lgkmcnt(0)
K1_W_LOOP:
    s_add_u32 s24, s11, s27
    s_and_b32 s30, s24, 3
    s_lshr_b32 s24, s24, 1
    s_and_b32 s24, s24, 4
    s_or_b32 s30, s30, s24
    v_xor_b32 v112, s30, v125
    v_lshl_add_u32 v120, v112, 5, v124
    s_lshl_b32 s25, s27, 9
    s_add_u32 s25, s25, s26
    v_perm_b32 v32, v4, v0, s28
    v_perm_b32 v36, v4, v0, s29
    v_perm_b32 v33, v12, v8, s28
    v_perm_b32 v37, v12, v8, s29
    v_perm_b32 v34, v20, v16, s28
    v_perm_b32 v38, v20, v16, s29
    v_perm_b32 v35, v28, v24, s28
    v_perm_b32 v39, v28, v24, s29
    v_perm_b32 v40, v5, v1, s28
    v_perm_b32 v44, v5, v1, s29
    v_perm_b32 v41, v13, v9, s28
    v_perm_b32 v45, v13, v9, s29
    v_perm_b32 v42, v21, v17, s28
    v_perm_b32 v46, v21, v17, s29
    v_perm_b32 v43, v29, v25, s28
    v_perm_b32 v47, v29, v25, s29
    v_perm_b32 v48, v6, v2, s28
    v_perm_b32 v52, v6, v2, s29
    v_perm_b32 v49, v14, v10, s28
    v_perm_b32 v53, v14, v10, s29
    v_perm_b32 v50, v22, v18, s28
    v_perm_b32 v54, v22, v18, s29
    v_perm_b32 v51, v30, v26, s28
    v_perm_b32 v55, v30, v26, s29
    v_perm_b32 v56, v7, v3, s28
    v_perm_b32 v60, v7, v3, s29
    v_perm_b32 v57, v15, v11, s28
    v_perm_b32 v61, v15, v11, s29
    v_perm_b32 v58, v23, v19, s28
    v_perm_b32 v62, v23, v19, s29
    v_perm_b32 v59, v31, v27, s28
    v_perm_b32 v63, v31, v27, s29
    s_add_u32 s27, s27, 1
    s_add_u32 s14, s14, 1024
    s_cmp_ge_u32 s27, 1
    s_cbranch_scc1 K1_W_NOLOAD
    s_mov_b32 s15, s14
    buffer_load_dwordx4 v[0:3], v126, s[16:19], s15 offen
    s_add_u32 s15, s15, 0x100000
    buffer_load_dwordx4 v[4:7], v126, s[16:19], s15 offen
    s_add_u32 s15, s15, 0x100000
    buffer_load_dwordx4 v[8:11], v126, s[16:19], s15 offen
    s_add_u32 s15, s15, 0x100000
    buffer_load_dwordx4 v[12:15], v126, s[16:19], s15 offen
    s_add_u32 s15, s15, 0x100000
    buffer_load_dwordx4 v[16:19], v126, s[16:19], s15 offen
    s_add_u32 s15, s15, 0x100000
    buffer_load_dwordx4 v[20:23], v126, s[16:19], s15 offen
    s_add_u32 s15, s15, 0x100000
    buffer_load_dwordx4 v[24:27], v126, s[16:19], s15 offen
    s_add_u32 s15, s15, 0x100000
    buffer_load_dwordx4 v[28:31], v126, s[16:19], s15 offen
K1_W_NOLOAD:
    v_mfma_f32_16x16x32_bf16 v[64:67], v[96:99], v[32:35], 0
    v_mfma_f32_16x16x32_bf16 v[68:71], v[96:99], v[36:39], 0
    v_mfma_f32_16x16x32_bf16 v[72:75], v[96:99], v[40:43], 0
    v_mfma_f32_16x16x32_bf16 v[76:79], v[96:99], v[44:47], 0
    v_mfma_f32_16x16x32_bf16 v[80:83], v[96:99], v[48:51], 0
    v_mfma_f32_16x16x32_bf16 v[84:87], v[96:99], v[52:55], 0
    v_mfma_f32_16x16x32_bf16 v[88:91], v[96:99], v[56:59], 0
    v_mfma_f32_16x16x32_bf16 v[92:95], v[96:99], v[60:63], 0
    s_nop 7
    v_cvt_pk_bf16_f32 v112, v64, v68
    v_cvt_pk_bf16_f32 v113, v72, v76
    v_cvt_pk_bf16_f32 v114, v80, v84
    v_cvt_pk_bf16_f32 v115, v88, v92
    buffer_store_dwordx4 v[112:115], v120, s[20:23], s25 offen
    s_add_u32 s25, s25, 4194304
    v_cvt_pk_bf16_f32 v116, v65, v69
    v_cvt_pk_bf16_f32 v117, v73, v77
    v_cvt_pk_bf16_f32 v118, v81, v85
    v_cvt_pk_bf16_f32 v119, v89, v93
    buffer_store_dwordx4 v[116:119], v120, s[20:23], s25 offen
    s_add_u32 s25, s25, 4194304
    v_cvt_pk_bf16_f32 v112, v66, v70
    v_cvt_pk_bf16_f32 v113, v74, v78
    v_cvt_pk_bf16_f32 v114, v82, v86
    v_cvt_pk_bf16_f32 v115, v90, v94
    buffer_store_dwordx4 v[112:115], v120, s[20:23], s25 offen
    s_add_u32 s25, s25, 4194304
    v_cvt_pk_bf16_f32 v116, v67, v71
    v_cvt_pk_bf16_f32 v117, v75, v79
    v_cvt_pk_bf16_f32 v118, v83, v87
    v_cvt_pk_bf16_f32 v119, v91, v95
    buffer_store_dwordx4 v[116:119], v120, s[20:23], s25 offen
    s_add_u32 s25, s25, 4194304
    v_mfma_f32_16x16x32_bf16 v[64:67], v[100:103], v[32:35], 0
    v_mfma_f32_16x16x32_bf16 v[68:71], v[100:103], v[36:39], 0
    v_mfma_f32_16x16x32_bf16 v[72:75], v[100:103], v[40:43], 0
    v_mfma_f32_16x16x32_bf16 v[76:79], v[100:103], v[44:47], 0
    v_mfma_f32_16x16x32_bf16 v[80:83], v[100:103], v[48:51], 0
    v_mfma_f32_16x16x32_bf16 v[84:87], v[100:103], v[52:55], 0
    v_mfma_f32_16x16x32_bf16 v[88:91], v[100:103], v[56:59], 0
    v_mfma_f32_16x16x32_bf16 v[92:95], v[100:103], v[60:63], 0
    s_nop 7
    v_cvt_pk_bf16_f32 v112, v64, v68
    v_cvt_pk_bf16_f32 v113, v72, v76
    v_cvt_pk_bf16_f32 v114, v80, v84
    v_cvt_pk_bf16_f32 v115, v88, v92
    buffer_store_dwordx4 v[112:115], v120, s[20:23], s25 offen
    s_add_u32 s25, s25, 4194304
    v_cvt_pk_bf16_f32 v116, v65, v69
    v_cvt_pk_bf16_f32 v117, v73, v77
    v_cvt_pk_bf16_f32 v118, v81, v85
    v_cvt_pk_bf16_f32 v119, v89, v93
    buffer_store_dwordx4 v[116:119], v120, s[20:23], s25 offen
    s_add_u32 s25, s25, 4194304
    v_cvt_pk_bf16_f32 v112, v66, v70
    v_cvt_pk_bf16_f32 v113, v74, v78
    v_cvt_pk_bf16_f32 v114, v82, v86
    v_cvt_pk_bf16_f32 v115, v90, v94
    buffer_store_dwordx4 v[112:115], v120, s[20:23], s25 offen
    s_add_u32 s25, s25, 4194304
    v_cvt_pk_bf16_f32 v116, v67, v71
    v_cvt_pk_bf16_f32 v117, v75, v79
    v_cvt_pk_bf16_f32 v118, v83, v87
    v_cvt_pk_bf16_f32 v119, v91, v95
    buffer_store_dwordx4 v[116:119], v120, s[20:23], s25 offen
    s_add_u32 s25, s25, 4194304
    v_mfma_f32_16x16x32_bf16 v[64:67], v[104:107], v[32:35], 0
    v_mfma_f32_16x16x32_bf16 v[68:71], v[104:107], v[36:39], 0
    v_mfma_f32_16x16x32_bf16 v[72:75], v[104:107], v[40:43], 0
    v_mfma_f32_16x16x32_bf16 v[76:79], v[104:107], v[44:47], 0
    v_mfma_f32_16x16x32_bf16 v[80:83], v[104:107], v[48:51], 0
    v_mfma_f32_16x16x32_bf16 v[84:87], v[104:107], v[52:55], 0
    v_mfma_f32_16x16x32_bf16 v[88:91], v[104:107], v[56:59], 0
    v_mfma_f32_16x16x32_bf16 v[92:95], v[104:107], v[60:63], 0
    s_nop 7
    v_cvt_pk_bf16_f32 v112, v64, v68
    v_cvt_pk_bf16_f32 v113, v72, v76
    v_cvt_pk_bf16_f32 v114, v80, v84
    v_cvt_pk_bf16_f32 v115, v88, v92
    buffer_store_dwordx4 v[112:115], v120, s[20:23], s25 offen
    s_add_u32 s25, s25, 4194304
    v_cvt_pk_bf16_f32 v116, v65, v69
    v_cvt_pk_bf16_f32 v117, v73, v77
    v_cvt_pk_bf16_f32 v118, v81, v85
    v_cvt_pk_bf16_f32 v119, v89, v93
    buffer_store_dwordx4 v[116:119], v120, s[20:23], s25 offen
    s_add_u32 s25, s25, 4194304
    v_cvt_pk_bf16_f32 v112, v66, v70
    v_cvt_pk_bf16_f32 v113, v74, v78
    v_cvt_pk_bf16_f32 v114, v82, v86
    v_cvt_pk_bf16_f32 v115, v90, v94
    buffer_store_dwordx4 v[112:115], v120, s[20:23], s25 offen
    s_add_u32 s25, s25, 4194304
    v_cvt_pk_bf16_f32 v116, v67, v71
    v_cvt_pk_bf16_f32 v117, v75, v79
    v_cvt_pk_bf16_f32 v118, v83, v87
    v_cvt_pk_bf16_f32 v119, v91, v95
    buffer_store_dwordx4 v[116:119], v120, s[20:23], s25 offen
    s_add_u32 s25, s25, 4194304
    v_mfma_f32_16x16x32_bf16 v[64:67], v[108:111], v[32:35], 0
    v_mfma_f32_16x16x32_bf16 v[68:71], v[108:111], v[36:39], 0
    v_mfma_f32_16x16x32_bf16 v[72:75], v[108:111], v[40:43], 0
    v_mfma_f32_16x16x32_bf16 v[76:79], v[108:111], v[44:47], 0
    v_mfma_f32_16x16x32_bf16 v[80:83], v[108:111], v[48:51], 0
    v_mfma_f32_16x16x32_bf16 v[84:87], v[108:111], v[52:55], 0
    v_mfma_f32_16x16x32_bf16 v[88:91], v[108:111], v[56:59], 0
    v_mfma_f32_16x16x32_bf16 v[92:95], v[108:111], v[60:63], 0
    s_nop 7
    v_cvt_pk_bf16_f32 v112, v64, v68
    v_cvt_pk_bf16_f32 v113, v72, v76
    v_cvt_pk_bf16_f32 v114, v80, v84
    v_cvt_pk_bf16_f32 v115, v88, v92
    buffer_store_dwordx4 v[112:115], v120, s[20:23], s25 offen
    s_add_u32 s25, s25, 4194304
    v_cvt_pk_bf16_f32 v116, v65, v69
    v_cvt_pk_bf16_f32 v117, v73, v77
    v_cvt_pk_bf16_f32 v118, v81, v85
    v_cvt_pk_bf16_f32 v119, v89, v93
    buffer_store_dwordx4 v[116:119], v120, s[20:23], s25 offen
    s_add_u32 s25, s25, 4194304
    v_cvt_pk_bf16_f32 v112, v66, v70
    v_cvt_pk_bf16_f32 v113, v74, v78
    v_cvt_pk_bf16_f32 v114, v82, v86
    v_cvt_pk_bf16_f32 v115, v90, v94
    buffer_store_dwordx4 v[112:115], v120, s[20:23], s25 offen
    s_add_u32 s25, s25, 4194304
    v_cvt_pk_bf16_f32 v116, v67, v71
    v_cvt_pk_bf16_f32 v117, v75, v79
    v_cvt_pk_bf16_f32 v118, v83, v87
    v_cvt_pk_bf16_f32 v119, v91, v95
    buffer_store_dwordx4 v[116:119], v120, s[20:23], s25 offen
    s_waitcnt vmcnt(16)
    s_cmp_lt_u32 s27, 1
    s_cbranch_scc1 K1_W_LOOP
K1_END:
    s_endpgm
.p2align 8
.type k12_fused_kernel,@function
k12_fused_kernel:
    s_cmp_ge_u32 s2, 256
    s_cbranch_scc1 K12_END
    s_load_dwordx4 s[52:55], s[0:1], 0
    s_load_dwordx4 s[56:59], s[0:1], 40
    s_getpc_b64 s[90:91]
CPF_K12:
    s_sub_u32 s90, s90, CPF_K12-k12_fused_kernel
    s_subb_u32 s91, s91, 0
    v_lshlrev_b32 v8, 7, v0
    v_mov_b32 v11, s91
    v_min_u32 v9, TEXT_END-k12_fused_kernel-4, v8
    v_add_co_u32 v10, vcc, s90, v9
    v_addc_co_u32 v11, vcc, 0, v11, vcc
    global_load_dword v63, v[10:11], off
    v_lshrrev_b32 v1, 6, v0
    v_and_b32 v2, 63, v0
    v_readfirstlane_b32 s3, v1
    s_waitcnt lgkmcnt(0)
    s_cmp_lt_u32 s3, 4
    s_cbranch_scc1 K12_CONS
    v_and_b32 v64, 15, v2
    v_lshrrev_b32 v65, 4, v2
    v_lshlrev_b32 v254, 4, v2
    s_and_b32 s44, s3, 3
    s_and_b32 s20, s44, 1
    s_lshr_b32 s21, s44, 1
    s_lshl_b32 s22, s2, 1
    s_add_u32 s22, s22, s21
    s_and_b32 s23, s22, 3
    s_lshr_b32 s22, s22, 2
    s_and_b32 s24, s2, 7
    s_lshl_b32 s24, s24, 5
    s_lshr_b32 s25, s2, 3
    s_add_u32 s24, s24, s25
    s_cmp_ge_u32 s24, 167
    s_cselect_b32 s25, 1, 0
    s_mul_i32 s26, s25, 167
    s_sub_u32 s24, s24, s26
    s_mov_b32 s49, s25
    s_cmp_eq_u32 s21, 0
    s_cselect_b32 s25, s25, 1
    s_mul_i32 s26, s25, 16384000
    s_add_u32 s4, s52, s26
    s_addc_u32 s5, s53, 0
    s_and_b32 s5, s5, 0xffff
    s_mov_b32 s6, 16384000
    s_mov_b32 s7, 0x00020000
    s_mov_b32 s8, s54
    s_mov_b32 s9, s55
    s_and_b32 s9, s9, 0xffff
    s_mov_b32 s10, 16252928
    s_mov_b32 s11, 0x00020000
    s_mov_b32 s12, s58
    s_mov_b32 s13, s59
    s_and_b32 s13, s13, 0xffff
    s_mov_b32 s14, 43778048
    s_mov_b32 s15, 0x00020000
    s_add_u32 s16, s58, 50331648
    s_addc_u32 s17, s59, 0
    s_and_b32 s17, s17, 0xffff
    s_mov_b32 s18, 67108864
    s_mov_b32 s19, 0x00020000
    s_add_u32 s60, s58, 153092096
    s_addc_u32 s61, s59, 0
    s_and_b32 s61, s61, 0xffff
    s_mov_b32 s62, 32768
    s_mov_b32 s63, 0x00020000
    s_mov_b32 s28, 0x05040100
    s_mov_b32 s29, 0x07060302
    v_lshlrev_b32 v248, 14, v65
    v_lshl_add_u32 v248, v64, 4, v248
    v_and_b32 v250, 1, v65
    v_lshlrev_b32 v250, 23, v250
    v_lshl_add_u32 v250, v64, 4, v250
    v_lshrrev_b32 v66, 1, v65
    s_mov_b32 s26, 1368064
    v_mul_lo_u32 v66, v66, s26
    v_lshrrev_b32 v67, 2, v64
    s_mov_b32 s26, 21376
    v_mul_lo_u32 v67, v67, s26
    v_add_u32 v66, v66, v67
    v_mov_b32 v252, v66
    v_lshrrev_b32 v66, 1, v65
    s_mov_b32 s26, 2097152
    v_mul_lo_u32 v66, v66, s26
    v_and_b32 v67, 1, v65
    v_lshl_add_u32 v66, v67, 8, v66
    v_and_b32 v67, 1, v64
    v_lshl_add_u32 v251, v67, 4, v66
    s_mul_i32 s31, s25, 684032
    s_mul_i32 s32, s23, 524288
    s_lshl_b32 s33, s23, 8
    s_mov_b32 s40, 3
    s_xor_b32 s43, s40, s20
    s_and_b32 s43, s43, 1
    s_mul_i32 s36, s40, 85
    s_add_u32 s36, s36, s2
    s_and_b32 s36, s36, 255
    s_mul_hi_u32 s37, s36, 0x55555556
    s_mul_i32 s38, s37, 3
    s_cmp_eq_u32 s38, s36
    s_cselect_b32 s27, 1, 0
    s_cmp_lt_u32 s37, 78
    s_cselect_b32 s27, s27, 0
    s_add_u32 s37, s37, 89
    s_add_u32 s26, s21, 1
    s_cmp_eq_u32 s27, 1
    s_cselect_b32 s26, 0, s26
    s_and_b32 s36, s27, s21
    s_cselect_b32 s30, s37, s24
    s_cselect_b32 s25, 1, s49
    s_mov_b32 s27, 1
    s_cmp_eq_u32 s43, 0
    s_cbranch_scc0 K12_PL1
    s_lshl_b32 s36, s40, 7
    s_add_u32 s36, s36, s22
    s_lshr_b32 s37, s36, 9
    s_lshl_b32 s37, s37, 19
    s_and_b32 s36, s36, 511
    s_lshl_b32 s36, s36, 10
    s_add_u32 s36, s36, s37
    s_add_u32 s36, s36, s33
    buffer_load_dwordx4 v[96:99], v250, s[8:11], s36 offen
    s_add_u32 s36, s36, 0x100000
    buffer_load_dwordx4 v[100:103], v250, s[8:11], s36 offen
    s_add_u32 s36, s36, 0x100000
    buffer_load_dwordx4 v[104:107], v250, s[8:11], s36 offen
    s_add_u32 s36, s36, 0x100000
    buffer_load_dwordx4 v[108:111], v250, s[8:11], s36 offen
    s_add_u32 s36, s36, 0x100000
    buffer_load_dwordx4 v[112:115], v250, s[8:11], s36 offen
    s_add_u32 s36, s36, 0x100000
    buffer_load_dwordx4 v[116:119], v250, s[8:11], s36 offen
    s_add_u32 s36, s36, 0x100000
    buffer_load_dwordx4 v[120:123], v250, s[8:11], s36 offen
    s_add_u32 s36, s36, 0x100000
    buffer_load_dwordx4 v[124:127], v250, s[8:11], s36 offen
    s_branch K12_PL2
K12_PL1:
    s_cmp_eq_u32 s27, 0
    s_cbranch_scc1 K12_PL2
    s_mul_i32 s36, s25, 16384000
    s_add_u32 s4, s52, s36
    s_addc_u32 s5, s53, 0
    s_and_b32 s5, s5, 0xffff
    s_lshl_b32 s36, s40, 8
    s_mul_i32 s37, s30, 98304
    s_add_u32 s36, s36, s37
    buffer_load_dwordx4 v[0:3], v248, s[4:7], s36 offen
    buffer_load_dwordx4 v[4:7], v248, s[4:7], s36 offen offset:2048
    s_add_u32 s36, s36, 4096
    buffer_load_dwordx4 v[8:11], v248, s[4:7], s36 offen
    buffer_load_dwordx4 v[12:15], v248, s[4:7], s36 offen offset:2048
    s_add_u32 s36, s36, 4096
    buffer_load_dwordx4 v[16:19], v248, s[4:7], s36 offen
    buffer_load_dwordx4 v[20:23], v248, s[4:7], s36 offen offset:2048
    s_add_u32 s36, s36, 4096
    buffer_load_dwordx4 v[24:27], v248, s[4:7], s36 offen
    buffer_load_dwordx4 v[28:31], v248, s[4:7], s36 offen offset:2048
    s_add_u32 s36, s36, 53248
    buffer_load_dwordx4 v[32:35], v248, s[4:7], s36 offen
    buffer_load_dwordx4 v[36:39], v248, s[4:7], s36 offen offset:2048
    s_add_u32 s36, s36, 4096
    buffer_load_dwordx4 v[40:43], v248, s[4:7], s36 offen
    buffer_load_dwordx4 v[44:47], v248, s[4:7], s36 offen offset:2048
    s_add_u32 s36, s36, 4096
    buffer_load_dwordx4 v[48:51], v248, s[4:7], s36 offen
    buffer_load_dwordx4 v[52:55], v248, s[4:7], s36 offen offset:2048
    s_add_u32 s36, s36, 4096
    buffer_load_dwordx4 v[56:59], v248, s[4:7], s36 offen
    buffer_load_dwordx4 v[60:63], v248, s[4:7], s36 offen offset:2048
K12_PL2:
    v_lshrrev_b32 v128, 4, v254
    v_lshlrev_b32 v129, 11, v128
    v_lshrrev_b32 v130, 1, v128
    v_lshlrev_b32 v130, 20, v130
    v_and_b32 v131, 1, v128
    v_lshl_add_u32 v130, v131, 7, v130
    s_mov_b32 s45, s27
    s_mov_b32 s46, s30
    s_mov_b32 s50, s25
    s_mov_b32 s51, s26
    s_add_u32 s47, s40, 1
    s_add_u32 s75, s47, 8
    s_min_u32 s75, s75, 8
    s_cmp_ge_u32 s47, s75
    s_cbranch_scc1 K12_TCHE0
K12_TCH0:
    s_xor_b32 s48, s47, s20
    s_and_b32 s48, s48, 1
    s_cmp_eq_u32 s48, 0
    s_cbranch_scc1 K12_TCHW0
    s_mul_i32 s36, s47, 85
    s_add_u32 s36, s36, s2
    s_and_b32 s36, s36, 255
    s_mul_hi_u32 s37, s36, 0x55555556
    s_mul_i32 s38, s37, 3
    s_cmp_eq_u32 s38, s36
    s_cselect_b32 s27, 1, 0
    s_cmp_lt_u32 s37, 78
    s_cselect_b32 s27, s27, 0
    s_add_u32 s37, s37, 89
    s_add_u32 s26, s21, 1
    s_cmp_eq_u32 s27, 1
    s_cselect_b32 s26, 0, s26
    s_and_b32 s36, s27, s21
    s_cselect_b32 s30, s37, s24
    s_cselect_b32 s25, 1, s49
    s_mov_b32 s27, 1
    s_cmp_eq_u32 s26, 2
    s_cbranch_scc1 K12_TCHN0
    s_cmp_eq_u32 s27, 0
    s_cbranch_scc1 K12_TCHN0
    s_mul_i32 s36, s25, 16384000
    s_add_u32 s4, s52, s36
    s_addc_u32 s5, s53, 0
    s_and_b32 s5, s5, 0xffff
    s_lshl_b32 s36, s47, 8
    s_mul_i32 s37, s30, 98304
    s_add_u32 s36, s36, s37
    buffer_load_dword v244, v129, s[4:7], s36 offen
    buffer_load_dword v245, v129, s[4:7], s36 offen offset:128
    s_branch K12_TCHN0
K12_TCHW0:
    s_lshl_b32 s36, s47, 7
    s_add_u32 s36, s36, s22
    s_lshr_b32 s37, s36, 9
    s_lshl_b32 s37, s37, 19
    s_and_b32 s36, s36, 511
    s_lshl_b32 s36, s36, 10
    s_add_u32 s36, s36, s37
    s_add_u32 s36, s36, s33
    s_mov_b64 exec, 0xffffffff
    buffer_load_dword v246, v130, s[8:11], s36 offen
    s_mov_b64 exec, -1
K12_TCHN0:
    s_add_u32 s47, s47, 1
    s_cmp_lt_u32 s47, s75
    s_cbranch_scc1 K12_TCH0
K12_TCHE0:
    s_mov_b32 s27, s45
    s_mov_b32 s30, s46
    s_mov_b32 s25, s50
    s_mov_b32 s26, s51
    v_and_b32 v128, 3, v64
    v_lshlrev_b32 v128, 2, v128
    v_lshrrev_b32 v130, 3, v64
    v_lshl_add_u32 v128, v130, 1, v128
    s_lshl_b32 s36, s44, 4
    s_add_u32 s36, s36, 1
    v_add_u32 v128, s36, v128
    v_bfe_u32 v129, v64, 2, 1
    v_lshlrev_b32 v131, 3, v65
    v_lshlrev_b32 v132, 5, v129
    v_mad_u32_u24 v133, v128, v131, v132
    v_mad_u32_u24 v136, v128, 0, v133
    v_mad_u32_u24 v137, v128, 1, v133
    v_mad_u32_u24 v138, v128, 2, v133
    v_mad_u32_u24 v139, v128, 3, v133
    v_mad_u32_u24 v140, v128, 4, v133
    v_mad_u32_u24 v141, v128, 5, v133
    v_mad_u32_u24 v142, v128, 6, v133
    v_mad_u32_u24 v143, v128, 7, v133
    v_and_b32 v136, 127, v136
    v_and_b32 v137, 127, v137
    v_and_b32 v138, 127, v138
    v_and_b32 v139, 127, v139
    v_and_b32 v140, 127, v140
    v_and_b32 v141, 127, v141
    v_and_b32 v142, 127, v142
    v_and_b32 v143, 127, v143
    v_cvt_f32_u32 v136, v136
    v_cvt_f32_u32 v137, v137
    v_cvt_f32_u32 v138, v138
    v_cvt_f32_u32 v139, v139
    v_cvt_f32_u32 v140, v140
    v_cvt_f32_u32 v141, v141
    v_cvt_f32_u32 v142, v142
    v_cvt_f32_u32 v143, v143
    v_mul_f32 v136, 0x3c000000, v136
    v_mul_f32 v137, 0x3c000000, v137
    v_mul_f32 v138, 0x3c000000, v138
    v_mul_f32 v139, 0x3c000000, v139
    v_mul_f32 v140, 0x3c000000, v140
    v_mul_f32 v141, 0x3c000000, v141
    v_mul_f32 v142, 0x3c000000, v142
    v_mul_f32 v143, 0x3c000000, v143
    v_cos_f32 v136, v136
    v_cos_f32 v137, v137
    v_cos_f32 v138, v138
    v_cos_f32 v139, v139
    v_cos_f32 v140, v140
    v_cos_f32 v141, v141
    v_cos_f32 v142, v142
    v_cos_f32 v143, v143
    s_nop 0
    v_cvt_pk_bf16_f32 v144, v136, v137
    v_cvt_pk_bf16_f32 v145, v138, v139
    v_cvt_pk_bf16_f32 v146, v140, v141
    v_cvt_pk_bf16_f32 v147, v142, v143
    v_lshlrev_b32 v152, 16, v144
    v_and_b32 v153, 0xffff0000, v144
    v_sub_f32 v136, v136, v152
    v_sub_f32 v137, v137, v153
    v_lshlrev_b32 v152, 16, v145
    v_and_b32 v153, 0xffff0000, v145
    v_sub_f32 v138, v138, v152
    v_sub_f32 v139, v139, v153
    v_lshlrev_b32 v152, 16, v146
    v_and_b32 v153, 0xffff0000, v146
    v_sub_f32 v140, v140, v152
    v_sub_f32 v141, v141, v153
    v_lshlrev_b32 v152, 16, v147
    v_and_b32 v153, 0xffff0000, v147
    v_sub_f32 v142, v142, v152
    v_sub_f32 v143, v143, v153
    v_cvt_pk_bf16_f32 v148, v136, v137
    v_cvt_pk_bf16_f32 v149, v138, v139
    v_cvt_pk_bf16_f32 v150, v140, v141
    v_cvt_pk_bf16_f32 v151, v142, v143
    s_lshl_b32 s37, s44, 12
    s_add_u32 s37, s37, 116736
    v_add_u32 v132, s37, v254
    ds_write_b128 v132, v[144:147]
    ds_write_b128 v132, v[148:151] offset:1024
    v_add_u32 v131, 32, v131
    v_lshlrev_b32 v132, 5, v129
    v_mad_u32_u24 v133, v128, v131, v132
    v_mad_u32_u24 v136, v128, 0, v133
    v_mad_u32_u24 v137, v128, 1, v133
    v_mad_u32_u24 v138, v128, 2, v133
    v_mad_u32_u24 v139, v128, 3, v133
    v_mad_u32_u24 v140, v128, 4, v133
    v_mad_u32_u24 v141, v128, 5, v133
    v_mad_u32_u24 v142, v128, 6, v133
    v_mad_u32_u24 v143, v128, 7, v133
    v_and_b32 v136, 127, v136
    v_and_b32 v137, 127, v137
    v_and_b32 v138, 127, v138
    v_and_b32 v139, 127, v139
    v_and_b32 v140, 127, v140
    v_and_b32 v141, 127, v141
    v_and_b32 v142, 127, v142
    v_and_b32 v143, 127, v143
    v_cvt_f32_u32 v136, v136
    v_cvt_f32_u32 v137, v137
    v_cvt_f32_u32 v138, v138
    v_cvt_f32_u32 v139, v139
    v_cvt_f32_u32 v140, v140
    v_cvt_f32_u32 v141, v141
    v_cvt_f32_u32 v142, v142
    v_cvt_f32_u32 v143, v143
    v_mul_f32 v136, 0x3c000000, v136
    v_mul_f32 v137, 0x3c000000, v137
    v_mul_f32 v138, 0x3c000000, v138
    v_mul_f32 v139, 0x3c000000, v139
    v_mul_f32 v140, 0x3c000000, v140
    v_mul_f32 v141, 0x3c000000, v141
    v_mul_f32 v142, 0x3c000000, v142
    v_mul_f32 v143, 0x3c000000, v143
    v_cos_f32 v136, v136
    v_cos_f32 v137, v137
    v_cos_f32 v138, v138
    v_cos_f32 v139, v139
    v_cos_f32 v140, v140
    v_cos_f32 v141, v141
    v_cos_f32 v142, v142
    v_cos_f32 v143, v143
    s_nop 0
    v_cvt_pk_bf16_f32 v144, v136, v137
    v_cvt_pk_bf16_f32 v145, v138, v139
    v_cvt_pk_bf16_f32 v146, v140, v141
    v_cvt_pk_bf16_f32 v147, v142, v143
    v_lshlrev_b32 v152, 16, v144
    v_and_b32 v153, 0xffff0000, v144
    v_sub_f32 v136, v136, v152
    v_sub_f32 v137, v137, v153
    v_lshlrev_b32 v152, 16, v145
    v_and_b32 v153, 0xffff0000, v145
    v_sub_f32 v138, v138, v152
    v_sub_f32 v139, v139, v153
    v_lshlrev_b32 v152, 16, v146
    v_and_b32 v153, 0xffff0000, v146
    v_sub_f32 v140, v140, v152
    v_sub_f32 v141, v141, v153
    v_lshlrev_b32 v152, 16, v147
    v_and_b32 v153, 0xffff0000, v147
    v_sub_f32 v142, v142, v152
    v_sub_f32 v143, v143, v153
    v_cvt_pk_bf16_f32 v148, v136, v137
    v_cvt_pk_bf16_f32 v149, v138, v139
    v_cvt_pk_bf16_f32 v150, v140, v141
    v_cvt_pk_bf16_f32 v151, v142, v143
    s_lshl_b32 s37, s44, 12
    s_add_u32 s37, s37, 118784
    v_add_u32 v132, s37, v254
    ds_write_b128 v132, v[144:147]
    ds_write_b128 v132, v[148:151] offset:1024
K12_TB:
    s_waitcnt lgkmcnt(0)
    s_barrier
    v_add_u32 v255, 116736, v254
    ds_read_b128 v[160:163], v255 offset:0
    ds_read_b128 v[192:195], v255 offset:1024
    ds_read_b128 v[164:167], v255 offset:2048
    ds_read_b128 v[196:199], v255 offset:3072
    ds_read_b128 v[168:171], v255 offset:4096
    ds_read_b128 v[200:203], v255 offset:5120
    ds_read_b128 v[172:175], v255 offset:6144
    ds_read_b128 v[204:207], v255 offset:7168
    s_waitcnt lgkmcnt(0)
    ds_read_b128 v[176:179], v255 offset:8192
    ds_read_b128 v[208:211], v255 offset:9216
    ds_read_b128 v[180:183], v255 offset:10240
    ds_read_b128 v[212:215], v255 offset:11264
    ds_read_b128 v[184:187], v255 offset:12288
    ds_read_b128 v[216:219], v255 offset:13312
    ds_read_b128 v[188:191], v255 offset:14336
    ds_read_b128 v[220:223], v255 offset:15360
    ds_read_b128 v[224:227], v255 offset:16384
    ds_read_b128 v[228:231], v255 offset:17408
    ds_read_b128 v[232:235], v255 offset:18432
    ds_read_b128 v[236:239], v255 offset:19456
    s_waitcnt lgkmcnt(0)
    s_barrier
    s_waitcnt vmcnt(0) lgkmcnt(0)
    s_mov_b32 s41, -1
    s_mov_b32 s34, -1
K12_PROD:
    s_cmp_eq_u32 s43, 0
    s_cbranch_scc1 K12_WENTRY
K12_XW:
    s_waitcnt vmcnt(0)
    s_mov_b32 s34, -1
    s_cmp_ge_u32 s41, 8
    s_cbranch_scc1 K12_SG0
    s_lshl_b32 s36, s41, 2
    s_add_u32 s37, s36, 155680
    s_mov_b64 exec, 1
    v_mov_b32 v255, s37
    v_mov_b32 v240, 1
    ds_add_rtn_u32 v240, v255, v240
    s_waitcnt lgkmcnt(0)
    v_readfirstlane_b32 s37, v240
    s_nop 3
    s_cmp_eq_u32 s37, 3
    s_cbranch_scc0 K12_SH0
    s_lshl_b32 s36, s36, 8
    v_mov_b32 v255, 1
    v_mov_b32 v240, s36
    buffer_atomic_add v255, v240, s[60:63], 0 offen sc0 sc1
    s_mov_b32 s34, s41
K12_SH0:
    s_mov_b64 exec, -1
K12_SG0:
    s_cmp_ge_u32 s34, 8
    s_cbranch_scc1 K12_EP1
    s_waitcnt vmcnt(0)
    s_cmp_ge_u32 s34, 8
    s_cbranch_scc1 K12_PB2
    v_readfirstlane_b32 s37, v255
    s_nop 3
    s_cmp_eq_u32 s37, 255
    s_cbranch_scc0 K12_PB2
    s_lshl_b32 s36, s34, 4
    s_add_u32 s36, s36, 16384
    s_mov_b64 exec, 1
    v_mov_b32 v255, 1
    v_mov_b32 v240, s36
    buffer_store_dword v255, v240, s[60:63], 0 offen sc1
    s_mov_b64 exec, -1
K12_PB2:
    s_mov_b32 s34, -1
K12_EP1:
    s_cmp_eq_u32 s27, 0
    s_cbranch_scc1 K12_XP_N
    v_perm_b32 v64, v4, v0, s28
    v_perm_b32 v68, v4, v0, s29
    v_perm_b32 v65, v12, v8, s28
    v_perm_b32 v69, v12, v8, s29
    v_perm_b32 v66, v20, v16, s28
    v_perm_b32 v70, v20, v16, s29
    v_perm_b32 v67, v28, v24, s28
    v_perm_b32 v71, v28, v24, s29
    v_perm_b32 v72, v5, v1, s28
    v_perm_b32 v76, v5, v1, s29
    v_perm_b32 v73, v13, v9, s28
    v_perm_b32 v77, v13, v9, s29
    v_perm_b32 v74, v21, v17, s28
    v_perm_b32 v78, v21, v17, s29
    v_perm_b32 v75, v29, v25, s28
    v_perm_b32 v79, v29, v25, s29
    v_perm_b32 v80, v6, v2, s28
    v_perm_b32 v84, v6, v2, s29
    v_perm_b32 v81, v14, v10, s28
    v_perm_b32 v85, v14, v10, s29
    v_perm_b32 v82, v22, v18, s28
    v_perm_b32 v86, v22, v18, s29
    v_perm_b32 v83, v30, v26, s28
    v_perm_b32 v87, v30, v26, s29
    v_perm_b32 v88, v7, v3, s28
    v_perm_b32 v92, v7, v3, s29
    v_perm_b32 v89, v15, v11, s28
    v_perm_b32 v93, v15, v11, s29
    v_perm_b32 v90, v23, v19, s28
    v_perm_b32 v94, v23, v19, s29
    v_perm_b32 v91, v31, v27, s28
    v_perm_b32 v95, v31, v27, s29
    v_perm_b32 v0, v36, v32, s28
    v_perm_b32 v4, v36, v32, s29
    v_perm_b32 v1, v44, v40, s28
    v_perm_b32 v5, v44, v40, s29
    v_perm_b32 v2, v52, v48, s28
    v_perm_b32 v6, v52, v48, s29
    v_perm_b32 v3, v60, v56, s28
    v_perm_b32 v7, v60, v56, s29
    v_perm_b32 v8, v37, v33, s28
    v_perm_b32 v12, v37, v33, s29
    v_perm_b32 v9, v45, v41, s28
    v_perm_b32 v13, v45, v41, s29
    v_perm_b32 v10, v53, v49, s28
    v_perm_b32 v14, v53, v49, s29
    v_perm_b32 v11, v61, v57, s28
    v_perm_b32 v15, v61, v57, s29
    v_perm_b32 v16, v38, v34, s28
    v_perm_b32 v20, v38, v34, s29
    v_perm_b32 v17, v46, v42, s28
    v_perm_b32 v21, v46, v42, s29
    v_perm_b32 v18, v54, v50, s28
    v_perm_b32 v22, v54, v50, s29
    v_perm_b32 v19, v62, v58, s28
    v_perm_b32 v23, v62, v58, s29
    v_perm_b32 v24, v39, v35, s28
    v_perm_b32 v28, v39, v35, s29
    v_perm_b32 v25, v47, v43, s28
    v_perm_b32 v29, v47, v43, s29
    v_perm_b32 v26, v55, v51, s28
    v_perm_b32 v30, v55, v51, s29
    v_perm_b32 v27, v63, v59, s28
    v_perm_b32 v31, v63, v59, s29
K12_XP_N:
    s_lshl_b32 s36, s40, 3
    s_sub_i32 s36, s36, 24
    s_max_i32 s36, s36, 1
    s_mov_b32 s37, 131072
K12_GL0:
    v_mov_b32 v240, 155648
    ds_read_b32 v240, v240
    s_waitcnt lgkmcnt(0)
    v_cmp_gt_u32 vcc, s36, v240
    s_sub_u32 s37, s37, 1
    s_cmp_eq_u32 s37, 0
    s_cbranch_scc1 K12_GT0
    s_cbranch_vccz K12_GT0
    s_sleep 2
    s_branch K12_GL0
K12_GT0:
    s_lshl_b32 s36, s40, 2
    s_add_u32 s36, s36, 155840
    s_mov_b64 exec, 1
    v_mov_b32 v240, s36
    v_mov_b32 v241, 1
    ds_add_u32 v240, v241
    s_mov_b64 exec, -1
    s_mov_b32 s37, 131072
K12_BL0:
    v_mov_b32 v240, s36
    ds_read_b32 v240, v240
    s_waitcnt lgkmcnt(0)
    v_cmp_gt_u32 vcc, 4, v240
    s_sub_u32 s37, s37, 1
    s_cmp_eq_u32 s37, 0
    s_cbranch_scc1 K12_BT0
    s_cbranch_vccz K12_BT0
    s_sleep 1
    s_branch K12_BL0
K12_BT0:
    s_add_u32 s42, s40, 1
    s_lshl_b32 s36, s42, 7
    s_add_u32 s36, s36, s22
    s_lshr_b32 s37, s36, 9
    s_lshl_b32 s37, s37, 19
    s_and_b32 s36, s36, 511
    s_lshl_b32 s36, s36, 10
    s_add_u32 s36, s36, s37
    s_add_u32 s36, s36, s33
    buffer_load_dwordx4 v[96:99], v250, s[8:11], s36 offen
    s_add_u32 s36, s36, 0x100000
    buffer_load_dwordx4 v[100:103], v250, s[8:11], s36 offen
    s_add_u32 s36, s36, 0x100000
    buffer_load_dwordx4 v[104:107], v250, s[8:11], s36 offen
    s_add_u32 s36, s36, 0x100000
    buffer_load_dwordx4 v[108:111], v250, s[8:11], s36 offen
    s_add_u32 s36, s36, 0x100000
    buffer_load_dwordx4 v[112:115], v250, s[8:11], s36 offen
    s_add_u32 s36, s36, 0x100000
    buffer_load_dwordx4 v[116:119], v250, s[8:11], s36 offen
    s_add_u32 s36, s36, 0x100000
    buffer_load_dwordx4 v[120:123], v250, s[8:11], s36 offen
    s_add_u32 s36, s36, 0x100000
    buffer_load_dwordx4 v[124:127], v250, s[8:11], s36 offen
    s_cmp_eq_u32 s27, 0
    s_cbranch_scc1 K12_XP_E
    s_mul_i32 s31, s25, 684032
    s_mul_i32 s39, s40, 85504
    s_add_u32 s39, s39, s31
    s_lshl_b32 s36, s30, 7
    s_add_u32 s39, s39, s36
    v_bfe_u32 v249, v254, 4, 2
    v_bfe_u32 v240, v254, 8, 1
    v_lshl_add_u32 v249, v240, 2, v249
    s_add_u32 s36, s30, 7
    s_cmp_ge_u32 s30, 160
    s_cselect_b32 s36, s36, s30
    s_cmp_eq_u32 s25, 1
    s_cselect_b32 s36, s36, s30
    s_lshr_b32 s36, s36, 1
    s_and_b32 s36, s36, 7
    v_xor_b32 v249, s36, v249
    v_lshl_add_u32 v249, v249, 4, v252
    s_cmp_eq_u32 s26, 2
    s_cselect_b32 s36, 21889024, 0
    s_add_u32 s39, s39, s36
    s_cmp_eq_u32 s26, 2
    s_cbranch_scc1 K12_XS1589_HI
    s_setprio 1
    v_mfma_f32_16x16x32_bf16 v[32:35], v[160:163], v[64:67], 0
    v_mfma_f32_16x16x32_bf16 v[36:39], v[160:163], v[68:71], 0
    v_mfma_f32_16x16x32_bf16 v[40:43], v[160:163], v[72:75], 0
    v_mfma_f32_16x16x32_bf16 v[44:47], v[160:163], v[76:79], 0
    v_mfma_f32_16x16x32_bf16 v[48:51], v[160:163], v[80:83], 0
    v_mfma_f32_16x16x32_bf16 v[52:55], v[160:163], v[84:87], 0
    v_mfma_f32_16x16x32_bf16 v[56:59], v[160:163], v[88:91], 0
    v_mfma_f32_16x16x32_bf16 v[60:63], v[160:163], v[92:95], 0
    v_mfma_f32_16x16x32_bf16 v[32:35], v[192:195], v[64:67], v[32:35]
    v_mfma_f32_16x16x32_bf16 v[36:39], v[192:195], v[68:71], v[36:39]
    v_mfma_f32_16x16x32_bf16 v[40:43], v[192:195], v[72:75], v[40:43]
    v_mfma_f32_16x16x32_bf16 v[44:47], v[192:195], v[76:79], v[44:47]
    v_mfma_f32_16x16x32_bf16 v[48:51], v[192:195], v[80:83], v[48:51]
    v_mfma_f32_16x16x32_bf16 v[52:55], v[192:195], v[84:87], v[52:55]
    v_mfma_f32_16x16x32_bf16 v[56:59], v[192:195], v[88:91], v[56:59]
    v_mfma_f32_16x16x32_bf16 v[60:63], v[192:195], v[92:95], v[60:63]
    v_mfma_f32_16x16x32_bf16 v[32:35], v[164:167], v[0:3], v[32:35]
    v_mfma_f32_16x16x32_bf16 v[36:39], v[164:167], v[4:7], v[36:39]
    v_mfma_f32_16x16x32_bf16 v[40:43], v[164:167], v[8:11], v[40:43]
    v_mfma_f32_16x16x32_bf16 v[44:47], v[164:167], v[12:15], v[44:47]
    v_mfma_f32_16x16x32_bf16 v[48:51], v[164:167], v[16:19], v[48:51]
    v_mfma_f32_16x16x32_bf16 v[52:55], v[164:167], v[20:23], v[52:55]
    v_mfma_f32_16x16x32_bf16 v[56:59], v[164:167], v[24:27], v[56:59]
    v_mfma_f32_16x16x32_bf16 v[60:63], v[164:167], v[28:31], v[60:63]
    v_mfma_f32_16x16x32_bf16 v[32:35], v[196:199], v[0:3], v[32:35]
    v_mfma_f32_16x16x32_bf16 v[36:39], v[196:199], v[4:7], v[36:39]
    v_mfma_f32_16x16x32_bf16 v[40:43], v[196:199], v[8:11], v[40:43]
    v_mfma_f32_16x16x32_bf16 v[44:47], v[196:199], v[12:15], v[44:47]
    v_mfma_f32_16x16x32_bf16 v[48:51], v[196:199], v[16:19], v[48:51]
    v_mfma_f32_16x16x32_bf16 v[52:55], v[196:199], v[20:23], v[52:55]
    v_mfma_f32_16x16x32_bf16 v[56:59], v[196:199], v[24:27], v[56:59]
    v_mfma_f32_16x16x32_bf16 v[60:63], v[196:199], v[28:31], v[60:63]
    s_setprio 0
    s_nop 7
    v_cvt_pk_bf16_f32 v240, v32, v36
    v_cvt_pk_bf16_f32 v241, v40, v44
    v_cvt_pk_bf16_f32 v242, v48, v52
    v_cvt_pk_bf16_f32 v243, v56, v60
    buffer_store_dwordx4 v[240:243], v249, s[12:15], s39 offen sc1
    s_add_u32 s39, s39, 2736128
    v_cvt_pk_bf16_f32 v244, v33, v37
    v_cvt_pk_bf16_f32 v245, v41, v45
    v_cvt_pk_bf16_f32 v246, v49, v53
    v_cvt_pk_bf16_f32 v247, v57, v61
    buffer_store_dwordx4 v[244:247], v249, s[12:15], s39 offen sc1
    s_add_u32 s39, s39, 2736128
    v_cvt_pk_bf16_f32 v240, v34, v38
    v_cvt_pk_bf16_f32 v241, v42, v46
    v_cvt_pk_bf16_f32 v242, v50, v54
    v_cvt_pk_bf16_f32 v243, v58, v62
    buffer_store_dwordx4 v[240:243], v249, s[12:15], s39 offen sc1
    s_add_u32 s39, s39, 2736128
    v_cvt_pk_bf16_f32 v244, v35, v39
    v_cvt_pk_bf16_f32 v245, v43, v47
    v_cvt_pk_bf16_f32 v246, v51, v55
    v_cvt_pk_bf16_f32 v247, v59, v63
    buffer_store_dwordx4 v[244:247], v249, s[12:15], s39 offen sc1
    s_add_u32 s39, s39, 2736128
    s_cmp_lg_u32 s26, 1
    s_cbranch_scc1 K12_UT0
    s_cmp_lt_u32 s40, 4
    s_cbranch_scc1 K12_UT0
    s_lshl_b32 s36, s40, 3
    s_sub_i32 s36, s36, 20
    s_max_i32 s36, s36, 1
    s_mov_b32 s37, 131072
K12_UL0:
    v_mov_b32 v255, 155648
    ds_read_b32 v255, v255
    s_waitcnt lgkmcnt(0)
    v_cmp_gt_u32 vcc, s36, v255
    s_sub_u32 s37, s37, 1
    s_cmp_eq_u32 s37, 0
    s_cbranch_scc1 K12_UT0
    s_cbranch_vccz K12_UT0
    s_sleep 2
    s_branch K12_UL0
K12_UT0:
    s_setprio 1
    v_mfma_f32_16x16x32_bf16 v[32:35], v[168:171], v[64:67], 0
    v_mfma_f32_16x16x32_bf16 v[36:39], v[168:171], v[68:71], 0
    v_mfma_f32_16x16x32_bf16 v[40:43], v[168:171], v[72:75], 0
    v_mfma_f32_16x16x32_bf16 v[44:47], v[168:171], v[76:79], 0
    v_mfma_f32_16x16x32_bf16 v[48:51], v[168:171], v[80:83], 0
    v_mfma_f32_16x16x32_bf16 v[52:55], v[168:171], v[84:87], 0
    v_mfma_f32_16x16x32_bf16 v[56:59], v[168:171], v[88:91], 0
    v_mfma_f32_16x16x32_bf16 v[60:63], v[168:171], v[92:95], 0
    v_mfma_f32_16x16x32_bf16 v[32:35], v[200:203], v[64:67], v[32:35]
    v_mfma_f32_16x16x32_bf16 v[36:39], v[200:203], v[68:71], v[36:39]
    v_mfma_f32_16x16x32_bf16 v[40:43], v[200:203], v[72:75], v[40:43]
    v_mfma_f32_16x16x32_bf16 v[44:47], v[200:203], v[76:79], v[44:47]
    v_mfma_f32_16x16x32_bf16 v[48:51], v[200:203], v[80:83], v[48:51]
    v_mfma_f32_16x16x32_bf16 v[52:55], v[200:203], v[84:87], v[52:55]
    v_mfma_f32_16x16x32_bf16 v[56:59], v[200:203], v[88:91], v[56:59]
    v_mfma_f32_16x16x32_bf16 v[60:63], v[200:203], v[92:95], v[60:63]
    v_mfma_f32_16x16x32_bf16 v[32:35], v[172:175], v[0:3], v[32:35]
    v_mfma_f32_16x16x32_bf16 v[36:39], v[172:175], v[4:7], v[36:39]
    v_mfma_f32_16x16x32_bf16 v[40:43], v[172:175], v[8:11], v[40:43]
    v_mfma_f32_16x16x32_bf16 v[44:47], v[172:175], v[12:15], v[44:47]
    v_mfma_f32_16x16x32_bf16 v[48:51], v[172:175], v[16:19], v[48:51]
    v_mfma_f32_16x16x32_bf16 v[52:55], v[172:175], v[20:23], v[52:55]
    v_mfma_f32_16x16x32_bf16 v[56:59], v[172:175], v[24:27], v[56:59]
    v_mfma_f32_16x16x32_bf16 v[60:63], v[172:175], v[28:31], v[60:63]
    v_mfma_f32_16x16x32_bf16 v[32:35], v[204:207], v[0:3], v[32:35]
    v_mfma_f32_16x16x32_bf16 v[36:39], v[204:207], v[4:7], v[36:39]
    v_mfma_f32_16x16x32_bf16 v[40:43], v[204:207], v[8:11], v[40:43]
    v_mfma_f32_16x16x32_bf16 v[44:47], v[204:207], v[12:15], v[44:47]
    v_mfma_f32_16x16x32_bf16 v[48:51], v[204:207], v[16:19], v[48:51]
    v_mfma_f32_16x16x32_bf16 v[52:55], v[204:207], v[20:23], v[52:55]
    v_mfma_f32_16x16x32_bf16 v[56:59], v[204:207], v[24:27], v[56:59]
    v_mfma_f32_16x16x32_bf16 v[60:63], v[204:207], v[28:31], v[60:63]
    s_setprio 0
    s_nop 7
    v_cvt_pk_bf16_f32 v240, v32, v36
    v_cvt_pk_bf16_f32 v241, v40, v44
    v_cvt_pk_bf16_f32 v242, v48, v52
    v_cvt_pk_bf16_f32 v243, v56, v60
    buffer_store_dwordx4 v[240:243], v249, s[12:15], s39 offen sc1
    s_add_u32 s39, s39, 2736128
    v_cvt_pk_bf16_f32 v244, v33, v37
    v_cvt_pk_bf16_f32 v245, v41, v45
    v_cvt_pk_bf16_f32 v246, v49, v53
    v_cvt_pk_bf16_f32 v247, v57, v61
    buffer_store_dwordx4 v[244:247], v249, s[12:15], s39 offen sc1
    s_add_u32 s39, s39, 2736128
    v_cvt_pk_bf16_f32 v240, v34, v38
    v_cvt_pk_bf16_f32 v241, v42, v46
    v_cvt_pk_bf16_f32 v242, v50, v54
    v_cvt_pk_bf16_f32 v243, v58, v62
    buffer_store_dwordx4 v[240:243], v249, s[12:15], s39 offen sc1
    s_add_u32 s39, s39, 2736128
    v_cvt_pk_bf16_f32 v244, v35, v39
    v_cvt_pk_bf16_f32 v245, v43, v47
    v_cvt_pk_bf16_f32 v246, v51, v55
    v_cvt_pk_bf16_f32 v247, v59, v63
    buffer_store_dwordx4 v[244:247], v249, s[12:15], s39 offen sc1
    s_add_u32 s39, s39, 2736128
    s_cmp_eq_u32 s26, 1
    s_cbranch_scc1 K12_XS1589_END
    s_cmp_lg_u32 s26, 0
    s_cbranch_scc1 K12_UT1
    s_cmp_lt_u32 s40, 4
    s_cbranch_scc1 K12_UT1
    s_lshl_b32 s36, s40, 3
    s_sub_i32 s36, s36, 20
    s_max_i32 s36, s36, 1
    s_mov_b32 s37, 131072
K12_UL1:
    v_mov_b32 v255, 155648
    ds_read_b32 v255, v255
    s_waitcnt lgkmcnt(0)
    v_cmp_gt_u32 vcc, s36, v255
    s_sub_u32 s37, s37, 1
    s_cmp_eq_u32 s37, 0
    s_cbranch_scc1 K12_UT1
    s_cbranch_vccz K12_UT1
    s_sleep 2
    s_branch K12_UL1
K12_UT1:
K12_XS1589_HI:
    s_setprio 1
    v_mfma_f32_16x16x32_bf16 v[32:35], v[176:179], v[64:67], 0
    v_mfma_f32_16x16x32_bf16 v[36:39], v[176:179], v[68:71], 0
    v_mfma_f32_16x16x32_bf16 v[40:43], v[176:179], v[72:75], 0
    v_mfma_f32_16x16x32_bf16 v[44:47], v[176:179], v[76:79], 0
    v_mfma_f32_16x16x32_bf16 v[48:51], v[176:179], v[80:83], 0
    v_mfma_f32_16x16x32_bf16 v[52:55], v[176:179], v[84:87], 0
    v_mfma_f32_16x16x32_bf16 v[56:59], v[176:179], v[88:91], 0
    v_mfma_f32_16x16x32_bf16 v[60:63], v[176:179], v[92:95], 0
    v_mfma_f32_16x16x32_bf16 v[32:35], v[208:211], v[64:67], v[32:35]
    v_mfma_f32_16x16x32_bf16 v[36:39], v[208:211], v[68:71], v[36:39]
    v_mfma_f32_16x16x32_bf16 v[40:43], v[208:211], v[72:75], v[40:43]
    v_mfma_f32_16x16x32_bf16 v[44:47], v[208:211], v[76:79], v[44:47]
    v_mfma_f32_16x16x32_bf16 v[48:51], v[208:211], v[80:83], v[48:51]
    v_mfma_f32_16x16x32_bf16 v[52:55], v[208:211], v[84:87], v[52:55]
    v_mfma_f32_16x16x32_bf16 v[56:59], v[208:211], v[88:91], v[56:59]
    v_mfma_f32_16x16x32_bf16 v[60:63], v[208:211], v[92:95], v[60:63]
    v_mfma_f32_16x16x32_bf16 v[32:35], v[180:183], v[0:3], v[32:35]
    v_mfma_f32_16x16x32_bf16 v[36:39], v[180:183], v[4:7], v[36:39]
    v_mfma_f32_16x16x32_bf16 v[40:43], v[180:183], v[8:11], v[40:43]
    v_mfma_f32_16x16x32_bf16 v[44:47], v[180:183], v[12:15], v[44:47]
    v_mfma_f32_16x16x32_bf16 v[48:51], v[180:183], v[16:19], v[48:51]
    v_mfma_f32_16x16x32_bf16 v[52:55], v[180:183], v[20:23], v[52:55]
    v_mfma_f32_16x16x32_bf16 v[56:59], v[180:183], v[24:27], v[56:59]
    v_mfma_f32_16x16x32_bf16 v[60:63], v[180:183], v[28:31], v[60:63]
    v_mfma_f32_16x16x32_bf16 v[32:35], v[212:215], v[0:3], v[32:35]
    v_mfma_f32_16x16x32_bf16 v[36:39], v[212:215], v[4:7], v[36:39]
    v_mfma_f32_16x16x32_bf16 v[40:43], v[212:215], v[8:11], v[40:43]
    v_mfma_f32_16x16x32_bf16 v[44:47], v[212:215], v[12:15], v[44:47]
    v_mfma_f32_16x16x32_bf16 v[48:51], v[212:215], v[16:19], v[48:51]
    v_mfma_f32_16x16x32_bf16 v[52:55], v[212:215], v[20:23], v[52:55]
    v_mfma_f32_16x16x32_bf16 v[56:59], v[212:215], v[24:27], v[56:59]
    v_mfma_f32_16x16x32_bf16 v[60:63], v[212:215], v[28:31], v[60:63]
    s_setprio 0
    s_nop 7
    v_cvt_pk_bf16_f32 v240, v32, v36
    v_cvt_pk_bf16_f32 v241, v40, v44
    v_cvt_pk_bf16_f32 v242, v48, v52
    v_cvt_pk_bf16_f32 v243, v56, v60
    buffer_store_dwordx4 v[240:243], v249, s[12:15], s39 offen sc1
    s_add_u32 s39, s39, 2736128
    v_cvt_pk_bf16_f32 v244, v33, v37
    v_cvt_pk_bf16_f32 v245, v41, v45
    v_cvt_pk_bf16_f32 v246, v49, v53
    v_cvt_pk_bf16_f32 v247, v57, v61
    buffer_store_dwordx4 v[244:247], v249, s[12:15], s39 offen sc1
    s_add_u32 s39, s39, 2736128
    v_cvt_pk_bf16_f32 v240, v34, v38
    v_cvt_pk_bf16_f32 v241, v42, v46
    v_cvt_pk_bf16_f32 v242, v50, v54
    v_cvt_pk_bf16_f32 v243, v58, v62
    buffer_store_dwordx4 v[240:243], v249, s[12:15], s39 offen sc1
    s_add_u32 s39, s39, 2736128
    v_cvt_pk_bf16_f32 v244, v35, v39
    v_cvt_pk_bf16_f32 v245, v43, v47
    v_cvt_pk_bf16_f32 v246, v51, v55
    v_cvt_pk_bf16_f32 v247, v59, v63
    buffer_store_dwordx4 v[244:247], v249, s[12:15], s39 offen sc1
    s_add_u32 s39, s39, 2736128
    s_cmp_lg_u32 s26, 2
    s_cbranch_scc1 K12_UT2
    s_cmp_lt_u32 s40, 4
    s_cbranch_scc1 K12_UT2
    s_lshl_b32 s36, s40, 3
    s_sub_i32 s36, s36, 20
    s_max_i32 s36, s36, 1
    s_mov_b32 s37, 131072
K12_UL2:
    v_mov_b32 v255, 155648
    ds_read_b32 v255, v255
    s_waitcnt lgkmcnt(0)
    v_cmp_gt_u32 vcc, s36, v255
    s_sub_u32 s37, s37, 1
    s_cmp_eq_u32 s37, 0
    s_cbranch_scc1 K12_UT2
    s_cbranch_vccz K12_UT2
    s_sleep 2
    s_branch K12_UL2
K12_UT2:
    s_setprio 1
    v_mfma_f32_16x16x32_bf16 v[32:35], v[184:187], v[64:67], 0
    v_mfma_f32_16x16x32_bf16 v[36:39], v[184:187], v[68:71], 0
    v_mfma_f32_16x16x32_bf16 v[40:43], v[184:187], v[72:75], 0
    v_mfma_f32_16x16x32_bf16 v[44:47], v[184:187], v[76:79], 0
    v_mfma_f32_16x16x32_bf16 v[48:51], v[184:187], v[80:83], 0
    v_mfma_f32_16x16x32_bf16 v[52:55], v[184:187], v[84:87], 0
    v_mfma_f32_16x16x32_bf16 v[56:59], v[184:187], v[88:91], 0
    v_mfma_f32_16x16x32_bf16 v[60:63], v[184:187], v[92:95], 0
    v_mfma_f32_16x16x32_bf16 v[32:35], v[216:219], v[64:67], v[32:35]
    v_mfma_f32_16x16x32_bf16 v[36:39], v[216:219], v[68:71], v[36:39]
    v_mfma_f32_16x16x32_bf16 v[40:43], v[216:219], v[72:75], v[40:43]
    v_mfma_f32_16x16x32_bf16 v[44:47], v[216:219], v[76:79], v[44:47]
    v_mfma_f32_16x16x32_bf16 v[48:51], v[216:219], v[80:83], v[48:51]
    v_mfma_f32_16x16x32_bf16 v[52:55], v[216:219], v[84:87], v[52:55]
    v_mfma_f32_16x16x32_bf16 v[56:59], v[216:219], v[88:91], v[56:59]
    v_mfma_f32_16x16x32_bf16 v[60:63], v[216:219], v[92:95], v[60:63]
    v_mfma_f32_16x16x32_bf16 v[32:35], v[188:191], v[0:3], v[32:35]
    v_mfma_f32_16x16x32_bf16 v[36:39], v[188:191], v[4:7], v[36:39]
    v_mfma_f32_16x16x32_bf16 v[40:43], v[188:191], v[8:11], v[40:43]
    v_mfma_f32_16x16x32_bf16 v[44:47], v[188:191], v[12:15], v[44:47]
    v_mfma_f32_16x16x32_bf16 v[48:51], v[188:191], v[16:19], v[48:51]
    v_mfma_f32_16x16x32_bf16 v[52:55], v[188:191], v[20:23], v[52:55]
    v_mfma_f32_16x16x32_bf16 v[56:59], v[188:191], v[24:27], v[56:59]
    v_mfma_f32_16x16x32_bf16 v[60:63], v[188:191], v[28:31], v[60:63]
    v_mfma_f32_16x16x32_bf16 v[32:35], v[220:223], v[0:3], v[32:35]
    v_mfma_f32_16x16x32_bf16 v[36:39], v[220:223], v[4:7], v[36:39]
    v_mfma_f32_16x16x32_bf16 v[40:43], v[220:223], v[8:11], v[40:43]
    v_mfma_f32_16x16x32_bf16 v[44:47], v[220:223], v[12:15], v[44:47]
    v_mfma_f32_16x16x32_bf16 v[48:51], v[220:223], v[16:19], v[48:51]
    v_mfma_f32_16x16x32_bf16 v[52:55], v[220:223], v[20:23], v[52:55]
    v_mfma_f32_16x16x32_bf16 v[56:59], v[220:223], v[24:27], v[56:59]
    v_mfma_f32_16x16x32_bf16 v[60:63], v[220:223], v[28:31], v[60:63]
    s_setprio 0
    s_nop 7
    v_cvt_pk_bf16_f32 v240, v32, v36
    v_cvt_pk_bf16_f32 v241, v40, v44
    v_cvt_pk_bf16_f32 v242, v48, v52
    v_cvt_pk_bf16_f32 v243, v56, v60
    buffer_store_dwordx4 v[240:243], v249, s[12:15], s39 offen sc1
    s_add_u32 s39, s39, 2736128
    v_cvt_pk_bf16_f32 v244, v33, v37
    v_cvt_pk_bf16_f32 v245, v41, v45
    v_cvt_pk_bf16_f32 v246, v49, v53
    v_cvt_pk_bf16_f32 v247, v57, v61
    buffer_store_dwordx4 v[244:247], v249, s[12:15], s39 offen sc1
    s_add_u32 s39, s39, 2736128
    v_cvt_pk_bf16_f32 v240, v34, v38
    v_cvt_pk_bf16_f32 v241, v42, v46
    v_cvt_pk_bf16_f32 v242, v50, v54
    v_cvt_pk_bf16_f32 v243, v58, v62
    buffer_store_dwordx4 v[240:243], v249, s[12:15], s39 offen sc1
    s_add_u32 s39, s39, 2736128
    v_cvt_pk_bf16_f32 v244, v35, v39
    v_cvt_pk_bf16_f32 v245, v43, v47
    v_cvt_pk_bf16_f32 v246, v51, v55
    v_cvt_pk_bf16_f32 v247, v59, v63
    buffer_store_dwordx4 v[244:247], v249, s[12:15], s39 offen sc1
K12_XS1589_END:
    s_mov_b32 s41, s40
    s_add_u32 s40, s40, 1
    s_cmp_eq_u32 s41, 3
    s_cbranch_scc0 K12_ES3
    s_waitcnt vmcnt(0)
    s_mov_b32 s34, -1
    s_cmp_ge_u32 s41, 8
    s_cbranch_scc1 K12_SG4
    s_lshl_b32 s36, s41, 2
    s_add_u32 s37, s36, 155680
    s_mov_b64 exec, 1
    v_mov_b32 v255, s37
    v_mov_b32 v240, 1
    ds_add_rtn_u32 v240, v255, v240
    s_waitcnt lgkmcnt(0)
    v_readfirstlane_b32 s37, v240
    s_nop 3
    s_cmp_eq_u32 s37, 3
    s_cbranch_scc0 K12_SH4
    s_lshl_b32 s36, s36, 8
    v_mov_b32 v255, 1
    v_mov_b32 v240, s36
    buffer_atomic_add v255, v240, s[60:63], 0 offen sc0 sc1
    s_mov_b32 s34, s41
K12_SH4:
    s_mov_b64 exec, -1
K12_SG4:
    s_waitcnt vmcnt(0)
    s_cmp_ge_u32 s34, 8
    s_cbranch_scc1 K12_PB5
    v_readfirstlane_b32 s37, v255
    s_nop 3
    s_cmp_eq_u32 s37, 255
    s_cbranch_scc0 K12_PB5
    s_lshl_b32 s36, s34, 4
    s_add_u32 s36, s36, 16384
    s_mov_b64 exec, 1
    v_mov_b32 v255, 1
    v_mov_b32 v240, s36
    buffer_store_dword v255, v240, s[60:63], 0 offen sc1
    s_mov_b64 exec, -1
K12_PB5:
    s_mov_b32 s34, -1
    s_mov_b32 s41, -1
K12_ES3:
    s_waitcnt vmcnt(8)
    s_branch K12_XP_F
K12_XP_E:
    s_mov_b32 s41, s40
    s_add_u32 s40, s40, 1
    s_cmp_eq_u32 s41, 3
    s_cbranch_scc0 K12_ES6
    s_waitcnt vmcnt(0)
    s_mov_b32 s34, -1
    s_cmp_ge_u32 s41, 8
    s_cbranch_scc1 K12_SG7
    s_lshl_b32 s36, s41, 2
    s_add_u32 s37, s36, 155680
    s_mov_b64 exec, 1
    v_mov_b32 v255, s37
    v_mov_b32 v240, 1
    ds_add_rtn_u32 v240, v255, v240
    s_waitcnt lgkmcnt(0)
    v_readfirstlane_b32 s37, v240
    s_nop 3
    s_cmp_eq_u32 s37, 3
    s_cbranch_scc0 K12_SH7
    s_lshl_b32 s36, s36, 8
    v_mov_b32 v255, 1
    v_mov_b32 v240, s36
    buffer_atomic_add v255, v240, s[60:63], 0 offen sc0 sc1
    s_mov_b32 s34, s41
K12_SH7:
    s_mov_b64 exec, -1
K12_SG7:
    s_waitcnt vmcnt(0)
    s_cmp_ge_u32 s34, 8
    s_cbranch_scc1 K12_PB8
    v_readfirstlane_b32 s37, v255
    s_nop 3
    s_cmp_eq_u32 s37, 255
    s_cbranch_scc0 K12_PB8
    s_lshl_b32 s36, s34, 4
    s_add_u32 s36, s36, 16384
    s_mov_b64 exec, 1
    v_mov_b32 v255, 1
    v_mov_b32 v240, s36
    buffer_store_dword v255, v240, s[60:63], 0 offen sc1
    s_mov_b64 exec, -1
K12_PB8:
    s_mov_b32 s34, -1
    s_mov_b32 s41, -1
K12_ES6:
    s_waitcnt vmcnt(0)
K12_XP_F:
    s_cmp_ge_u32 s34, 8
    s_cbranch_scc1 K12_PB9
    v_readfirstlane_b32 s37, v255
    s_nop 3
    s_cmp_eq_u32 s37, 255
    s_cbranch_scc0 K12_PB9
    s_lshl_b32 s36, s34, 4
    s_add_u32 s36, s36, 16384
    s_mov_b64 exec, 1
    v_mov_b32 v255, 1
    v_mov_b32 v240, s36
    buffer_store_dword v255, v240, s[60:63], 0 offen sc1
    s_mov_b64 exec, -1
K12_PB9:
    s_cmp_ge_u32 s40, 8
    s_cbranch_scc1 K12_PFIN
K12_WENTRY:
    s_waitcnt vmcnt(0)
    s_mov_b32 s34, -1
    s_cmp_ge_u32 s41, 8
    s_cbranch_scc1 K12_SG10
    s_lshl_b32 s36, s41, 2
    s_add_u32 s37, s36, 155680
    s_mov_b64 exec, 1
    v_mov_b32 v255, s37
    v_mov_b32 v240, 1
    ds_add_rtn_u32 v240, v255, v240
    s_waitcnt lgkmcnt(0)
    v_readfirstlane_b32 s37, v240
    s_nop 3
    s_cmp_eq_u32 s37, 3
    s_cbranch_scc0 K12_SH10
    s_lshl_b32 s36, s36, 8
    v_mov_b32 v255, 1
    v_mov_b32 v240, s36
    buffer_atomic_add v255, v240, s[60:63], 0 offen sc0 sc1
    s_mov_b32 s34, s41
K12_SH10:
    s_mov_b64 exec, -1
K12_SG10:
    s_cmp_ge_u32 s34, 8
    s_cbranch_scc1 K12_EP11
    s_waitcnt vmcnt(0)
    s_cmp_ge_u32 s34, 8
    s_cbranch_scc1 K12_PB12
    v_readfirstlane_b32 s37, v255
    s_nop 3
    s_cmp_eq_u32 s37, 255
    s_cbranch_scc0 K12_PB12
    s_lshl_b32 s36, s34, 4
    s_add_u32 s36, s36, 16384
    s_mov_b64 exec, 1
    v_mov_b32 v255, 1
    v_mov_b32 v240, s36
    buffer_store_dword v255, v240, s[60:63], 0 offen sc1
    s_mov_b64 exec, -1
K12_PB12:
    s_mov_b32 s34, -1
K12_EP11:
    v_perm_b32 v64, v100, v96, s28
    v_perm_b32 v68, v100, v96, s29
    v_perm_b32 v65, v108, v104, s28
    v_perm_b32 v69, v108, v104, s29
    v_perm_b32 v66, v116, v112, s28
    v_perm_b32 v70, v116, v112, s29
    v_perm_b32 v67, v124, v120, s28
    v_perm_b32 v71, v124, v120, s29
    v_perm_b32 v72, v101, v97, s28
    v_perm_b32 v76, v101, v97, s29
    v_perm_b32 v73, v109, v105, s28
    v_perm_b32 v77, v109, v105, s29
    v_perm_b32 v74, v117, v113, s28
    v_perm_b32 v78, v117, v113, s29
    v_perm_b32 v75, v125, v121, s28
    v_perm_b32 v79, v125, v121, s29
    v_perm_b32 v80, v102, v98, s28
    v_perm_b32 v84, v102, v98, s29
    v_perm_b32 v81, v110, v106, s28
    v_perm_b32 v85, v110, v106, s29
    v_perm_b32 v82, v118, v114, s28
    v_perm_b32 v86, v118, v114, s29
    v_perm_b32 v83, v126, v122, s28
    v_perm_b32 v87, v126, v122, s29
    v_perm_b32 v88, v103, v99, s28
    v_perm_b32 v92, v103, v99, s29
    v_perm_b32 v89, v111, v107, s28
    v_perm_b32 v93, v111, v107, s29
    v_perm_b32 v90, v119, v115, s28
    v_perm_b32 v94, v119, v115, s29
    v_perm_b32 v91, v127, v123, s28
    v_perm_b32 v95, v127, v123, s29
    s_lshl_b32 s36, s40, 3
    s_sub_i32 s36, s36, 24
    s_max_i32 s36, s36, 1
    s_mov_b32 s37, 131072
K12_GL1:
    v_mov_b32 v240, 155648
    ds_read_b32 v240, v240
    s_waitcnt lgkmcnt(0)
    v_cmp_gt_u32 vcc, s36, v240
    s_sub_u32 s37, s37, 1
    s_cmp_eq_u32 s37, 0
    s_cbranch_scc1 K12_GT1
    s_cbranch_vccz K12_GT1
    s_sleep 2
    s_branch K12_GL1
K12_GT1:
    s_lshl_b32 s36, s40, 2
    s_add_u32 s36, s36, 155840
    s_mov_b64 exec, 1
    v_mov_b32 v240, s36
    v_mov_b32 v241, 1
    ds_add_u32 v240, v241
    s_mov_b64 exec, -1
    s_mov_b32 s37, 131072
K12_BL1:
    v_mov_b32 v240, s36
    ds_read_b32 v240, v240
    s_waitcnt lgkmcnt(0)
    v_cmp_gt_u32 vcc, 4, v240
    s_sub_u32 s37, s37, 1
    s_cmp_eq_u32 s37, 0
    s_cbranch_scc1 K12_BT1
    s_cbranch_vccz K12_BT1
    s_sleep 1
    s_branch K12_BL1
K12_BT1:
    s_add_u32 s42, s40, 1
    s_mul_i32 s36, s42, 85
    s_add_u32 s36, s36, s2
    s_and_b32 s36, s36, 255
    s_mul_hi_u32 s37, s36, 0x55555556
    s_mul_i32 s38, s37, 3
    s_cmp_eq_u32 s38, s36
    s_cselect_b32 s27, 1, 0
    s_cmp_lt_u32 s37, 78
    s_cselect_b32 s27, s27, 0
    s_add_u32 s37, s37, 89
    s_add_u32 s26, s21, 1
    s_cmp_eq_u32 s27, 1
    s_cselect_b32 s26, 0, s26
    s_and_b32 s36, s27, s21
    s_cselect_b32 s30, s37, s24
    s_cselect_b32 s25, 1, s49
    s_mov_b32 s27, 1
    s_cmp_eq_u32 s27, 0
    s_cbranch_scc1 K12_WP_N
    s_mul_i32 s36, s25, 16384000
    s_add_u32 s4, s52, s36
    s_addc_u32 s5, s53, 0
    s_and_b32 s5, s5, 0xffff
    s_lshl_b32 s36, s42, 8
    s_mul_i32 s37, s30, 98304
    s_add_u32 s36, s36, s37
    buffer_load_dwordx4 v[0:3], v248, s[4:7], s36 offen
    buffer_load_dwordx4 v[4:7], v248, s[4:7], s36 offen offset:2048
    s_add_u32 s36, s36, 4096
    buffer_load_dwordx4 v[8:11], v248, s[4:7], s36 offen
    buffer_load_dwordx4 v[12:15], v248, s[4:7], s36 offen offset:2048
    s_add_u32 s36, s36, 4096
    buffer_load_dwordx4 v[16:19], v248, s[4:7], s36 offen
    buffer_load_dwordx4 v[20:23], v248, s[4:7], s36 offen offset:2048
    s_add_u32 s36, s36, 4096
    buffer_load_dwordx4 v[24:27], v248, s[4:7], s36 offen
    buffer_load_dwordx4 v[28:31], v248, s[4:7], s36 offen offset:2048
    s_add_u32 s36, s36, 53248
    buffer_load_dwordx4 v[32:35], v248, s[4:7], s36 offen
    buffer_load_dwordx4 v[36:39], v248, s[4:7], s36 offen offset:2048
    s_add_u32 s36, s36, 4096
    buffer_load_dwordx4 v[40:43], v248, s[4:7], s36 offen
    buffer_load_dwordx4 v[44:47], v248, s[4:7], s36 offen offset:2048
    s_add_u32 s36, s36, 4096
    buffer_load_dwordx4 v[48:51], v248, s[4:7], s36 offen
    buffer_load_dwordx4 v[52:55], v248, s[4:7], s36 offen offset:2048
    s_add_u32 s36, s36, 4096
    buffer_load_dwordx4 v[56:59], v248, s[4:7], s36 offen
    buffer_load_dwordx4 v[60:63], v248, s[4:7], s36 offen offset:2048
    s_branch K12_WP_M
K12_WP_N:
K12_WP_M:
    s_lshl_b32 s36, s40, 7
    s_add_u32 s36, s36, s22
    s_and_b32 s37, s36, 3
    s_lshr_b32 s38, s36, 1
    s_and_b32 s38, s38, 4
    s_or_b32 s37, s37, s38
    v_bfe_u32 v253, v254, 5, 3
    v_xor_b32 v253, s37, v253
    v_lshl_add_u32 v253, v253, 5, v251
    s_lshl_b32 s36, s36, 9
    s_add_u32 s39, s36, s32
    s_setprio 1
    v_mfma_f32_16x16x32_bf16 v[128:131], v[224:227], v[64:67], 0
    v_mfma_f32_16x16x32_bf16 v[132:135], v[224:227], v[68:71], 0
    v_mfma_f32_16x16x32_bf16 v[136:139], v[224:227], v[72:75], 0
    v_mfma_f32_16x16x32_bf16 v[140:143], v[224:227], v[76:79], 0
    v_mfma_f32_16x16x32_bf16 v[144:147], v[224:227], v[80:83], 0
    v_mfma_f32_16x16x32_bf16 v[148:151], v[224:227], v[84:87], 0
    v_mfma_f32_16x16x32_bf16 v[152:155], v[224:227], v[88:91], 0
    v_mfma_f32_16x16x32_bf16 v[156:159], v[224:227], v[92:95], 0
    s_setprio 0
    s_nop 7
    v_cvt_pk_bf16_f32 v240, v128, v132
    v_cvt_pk_bf16_f32 v241, v136, v140
    v_cvt_pk_bf16_f32 v242, v144, v148
    v_cvt_pk_bf16_f32 v243, v152, v156
    buffer_store_dwordx4 v[240:243], v253, s[16:19], s39 offen sc1
    s_add_u32 s39, s39, 4194304
    v_cvt_pk_bf16_f32 v244, v129, v133
    v_cvt_pk_bf16_f32 v245, v137, v141
    v_cvt_pk_bf16_f32 v246, v145, v149
    v_cvt_pk_bf16_f32 v247, v153, v157
    buffer_store_dwordx4 v[244:247], v253, s[16:19], s39 offen sc1
    s_add_u32 s39, s39, 4194304
    v_cvt_pk_bf16_f32 v240, v130, v134
    v_cvt_pk_bf16_f32 v241, v138, v142
    v_cvt_pk_bf16_f32 v242, v146, v150
    v_cvt_pk_bf16_f32 v243, v154, v158
    buffer_store_dwordx4 v[240:243], v253, s[16:19], s39 offen sc1
    s_add_u32 s39, s39, 4194304
    v_cvt_pk_bf16_f32 v244, v131, v135
    v_cvt_pk_bf16_f32 v245, v139, v143
    v_cvt_pk_bf16_f32 v246, v147, v151
    v_cvt_pk_bf16_f32 v247, v155, v159
    buffer_store_dwordx4 v[244:247], v253, s[16:19], s39 offen sc1
    s_add_u32 s39, s39, 4194304
    s_setprio 1
    v_mfma_f32_16x16x32_bf16 v[128:131], v[228:231], v[64:67], 0
    v_mfma_f32_16x16x32_bf16 v[132:135], v[228:231], v[68:71], 0
    v_mfma_f32_16x16x32_bf16 v[136:139], v[228:231], v[72:75], 0
    v_mfma_f32_16x16x32_bf16 v[140:143], v[228:231], v[76:79], 0
    v_mfma_f32_16x16x32_bf16 v[144:147], v[228:231], v[80:83], 0
    v_mfma_f32_16x16x32_bf16 v[148:151], v[228:231], v[84:87], 0
    v_mfma_f32_16x16x32_bf16 v[152:155], v[228:231], v[88:91], 0
    v_mfma_f32_16x16x32_bf16 v[156:159], v[228:231], v[92:95], 0
    s_setprio 0
    s_nop 7
    v_cvt_pk_bf16_f32 v240, v128, v132
    v_cvt_pk_bf16_f32 v241, v136, v140
    v_cvt_pk_bf16_f32 v242, v144, v148
    v_cvt_pk_bf16_f32 v243, v152, v156
    buffer_store_dwordx4 v[240:243], v253, s[16:19], s39 offen sc1
    s_add_u32 s39, s39, 4194304
    v_cvt_pk_bf16_f32 v244, v129, v133
    v_cvt_pk_bf16_f32 v245, v137, v141
    v_cvt_pk_bf16_f32 v246, v145, v149
    v_cvt_pk_bf16_f32 v247, v153, v157
    buffer_store_dwordx4 v[244:247], v253, s[16:19], s39 offen sc1
    s_add_u32 s39, s39, 4194304
    v_cvt_pk_bf16_f32 v240, v130, v134
    v_cvt_pk_bf16_f32 v241, v138, v142
    v_cvt_pk_bf16_f32 v242, v146, v150
    v_cvt_pk_bf16_f32 v243, v154, v158
    buffer_store_dwordx4 v[240:243], v253, s[16:19], s39 offen sc1
    s_add_u32 s39, s39, 4194304
    v_cvt_pk_bf16_f32 v244, v131, v135
    v_cvt_pk_bf16_f32 v245, v139, v143
    v_cvt_pk_bf16_f32 v246, v147, v151
    v_cvt_pk_bf16_f32 v247, v155, v159
    buffer_store_dwordx4 v[244:247], v253, s[16:19], s39 offen sc1
    s_add_u32 s39, s39, 4194304
    s_cmp_lt_u32 s40, 4
    s_cbranch_scc1 K12_UT3
    s_lshl_b32 s36, s40, 3
    s_sub_i32 s36, s36, 20
    s_max_i32 s36, s36, 1
    s_mov_b32 s37, 131072
K12_UL3:
    v_mov_b32 v255, 155648
    ds_read_b32 v255, v255
    s_waitcnt lgkmcnt(0)
    v_cmp_gt_u32 vcc, s36, v255
    s_sub_u32 s37, s37, 1
    s_cmp_eq_u32 s37, 0
    s_cbranch_scc1 K12_UT3
    s_cbranch_vccz K12_UT3
    s_sleep 2
    s_branch K12_UL3
K12_UT3:
    s_setprio 1
    v_mfma_f32_16x16x32_bf16 v[128:131], v[232:235], v[64:67], 0
    v_mfma_f32_16x16x32_bf16 v[132:135], v[232:235], v[68:71], 0
    v_mfma_f32_16x16x32_bf16 v[136:139], v[232:235], v[72:75], 0
    v_mfma_f32_16x16x32_bf16 v[140:143], v[232:235], v[76:79], 0
    v_mfma_f32_16x16x32_bf16 v[144:147], v[232:235], v[80:83], 0
    v_mfma_f32_16x16x32_bf16 v[148:151], v[232:235], v[84:87], 0
    v_mfma_f32_16x16x32_bf16 v[152:155], v[232:235], v[88:91], 0
    v_mfma_f32_16x16x32_bf16 v[156:159], v[232:235], v[92:95], 0
    s_setprio 0
    s_nop 7
    v_cvt_pk_bf16_f32 v240, v128, v132
    v_cvt_pk_bf16_f32 v241, v136, v140
    v_cvt_pk_bf16_f32 v242, v144, v148
    v_cvt_pk_bf16_f32 v243, v152, v156
    buffer_store_dwordx4 v[240:243], v253, s[16:19], s39 offen sc1
    s_add_u32 s39, s39, 4194304
    v_cvt_pk_bf16_f32 v244, v129, v133
    v_cvt_pk_bf16_f32 v245, v137, v141
    v_cvt_pk_bf16_f32 v246, v145, v149
    v_cvt_pk_bf16_f32 v247, v153, v157
    buffer_store_dwordx4 v[244:247], v253, s[16:19], s39 offen sc1
    s_add_u32 s39, s39, 4194304
    v_cvt_pk_bf16_f32 v240, v130, v134
    v_cvt_pk_bf16_f32 v241, v138, v142
    v_cvt_pk_bf16_f32 v242, v146, v150
    v_cvt_pk_bf16_f32 v243, v154, v158
    buffer_store_dwordx4 v[240:243], v253, s[16:19], s39 offen sc1
    s_add_u32 s39, s39, 4194304
    v_cvt_pk_bf16_f32 v244, v131, v135
    v_cvt_pk_bf16_f32 v245, v139, v143
    v_cvt_pk_bf16_f32 v246, v147, v151
    v_cvt_pk_bf16_f32 v247, v155, v159
    buffer_store_dwordx4 v[244:247], v253, s[16:19], s39 offen sc1
    s_add_u32 s39, s39, 4194304
    s_setprio 1
    v_mfma_f32_16x16x32_bf16 v[128:131], v[236:239], v[64:67], 0
    v_mfma_f32_16x16x32_bf16 v[132:135], v[236:239], v[68:71], 0
    v_mfma_f32_16x16x32_bf16 v[136:139], v[236:239], v[72:75], 0
    v_mfma_f32_16x16x32_bf16 v[140:143], v[236:239], v[76:79], 0
    v_mfma_f32_16x16x32_bf16 v[144:147], v[236:239], v[80:83], 0
    v_mfma_f32_16x16x32_bf16 v[148:151], v[236:239], v[84:87], 0
    v_mfma_f32_16x16x32_bf16 v[152:155], v[236:239], v[88:91], 0
    v_mfma_f32_16x16x32_bf16 v[156:159], v[236:239], v[92:95], 0
    s_setprio 0
    s_nop 7
    v_cvt_pk_bf16_f32 v240, v128, v132
    v_cvt_pk_bf16_f32 v241, v136, v140
    v_cvt_pk_bf16_f32 v242, v144, v148
    v_cvt_pk_bf16_f32 v243, v152, v156
    buffer_store_dwordx4 v[240:243], v253, s[16:19], s39 offen sc1
    s_add_u32 s39, s39, 4194304
    v_cvt_pk_bf16_f32 v244, v129, v133
    v_cvt_pk_bf16_f32 v245, v137, v141
    v_cvt_pk_bf16_f32 v246, v145, v149
    v_cvt_pk_bf16_f32 v247, v153, v157
    buffer_store_dwordx4 v[244:247], v253, s[16:19], s39 offen sc1
    s_add_u32 s39, s39, 4194304
    v_cvt_pk_bf16_f32 v240, v130, v134
    v_cvt_pk_bf16_f32 v241, v138, v142
    v_cvt_pk_bf16_f32 v242, v146, v150
    v_cvt_pk_bf16_f32 v243, v154, v158
    buffer_store_dwordx4 v[240:243], v253, s[16:19], s39 offen sc1
    s_add_u32 s39, s39, 4194304
    v_cvt_pk_bf16_f32 v244, v131, v135
    v_cvt_pk_bf16_f32 v245, v139, v143
    v_cvt_pk_bf16_f32 v246, v147, v151
    v_cvt_pk_bf16_f32 v247, v155, v159
    buffer_store_dwordx4 v[244:247], v253, s[16:19], s39 offen sc1
    s_mov_b32 s41, s40
    s_add_u32 s40, s40, 1
    s_cmp_eq_u32 s41, 3
    s_cbranch_scc0 K12_ES13
    s_waitcnt vmcnt(0)
    s_mov_b32 s34, -1
    s_cmp_ge_u32 s41, 8
    s_cbranch_scc1 K12_SG14
    s_lshl_b32 s36, s41, 2
    s_add_u32 s37, s36, 155680
    s_mov_b64 exec, 1
    v_mov_b32 v255, s37
    v_mov_b32 v240, 1
    ds_add_rtn_u32 v240, v255, v240
    s_waitcnt lgkmcnt(0)
    v_readfirstlane_b32 s37, v240
    s_nop 3
    s_cmp_eq_u32 s37, 3
    s_cbranch_scc0 K12_SH14
    s_lshl_b32 s36, s36, 8
    v_mov_b32 v255, 1
    v_mov_b32 v240, s36
    buffer_atomic_add v255, v240, s[60:63], 0 offen sc0 sc1
    s_mov_b32 s34, s41
K12_SH14:
    s_mov_b64 exec, -1
K12_SG14:
    s_waitcnt vmcnt(0)
    s_cmp_ge_u32 s34, 8
    s_cbranch_scc1 K12_PB15
    v_readfirstlane_b32 s37, v255
    s_nop 3
    s_cmp_eq_u32 s37, 255
    s_cbranch_scc0 K12_PB15
    s_lshl_b32 s36, s34, 4
    s_add_u32 s36, s36, 16384
    s_mov_b64 exec, 1
    v_mov_b32 v255, 1
    v_mov_b32 v240, s36
    buffer_store_dword v255, v240, s[60:63], 0 offen sc1
    s_mov_b64 exec, -1
K12_PB15:
    s_mov_b32 s34, -1
    s_mov_b32 s41, -1
K12_ES13:
    s_waitcnt vmcnt(16)
    s_cmp_ge_u32 s34, 8
    s_cbranch_scc1 K12_PB16
    v_readfirstlane_b32 s37, v255
    s_nop 3
    s_cmp_eq_u32 s37, 255
    s_cbranch_scc0 K12_PB16
    s_lshl_b32 s36, s34, 4
    s_add_u32 s36, s36, 16384
    s_mov_b64 exec, 1
    v_mov_b32 v255, 1
    v_mov_b32 v240, s36
    buffer_store_dword v255, v240, s[60:63], 0 offen sc1
    s_mov_b64 exec, -1
K12_PB16:
    s_cmp_lt_u32 s40, 8
    s_cbranch_scc1 K12_XW
K12_PFIN:
    s_waitcnt vmcnt(0)
    s_mov_b32 s34, -1
    s_cmp_ge_u32 s41, 8
    s_cbranch_scc1 K12_SG17
    s_lshl_b32 s36, s41, 2
    s_add_u32 s37, s36, 155680
    s_mov_b64 exec, 1
    v_mov_b32 v255, s37
    v_mov_b32 v240, 1
    ds_add_rtn_u32 v240, v255, v240
    s_waitcnt lgkmcnt(0)
    v_readfirstlane_b32 s37, v240
    s_nop 3
    s_cmp_eq_u32 s37, 3
    s_cbranch_scc0 K12_SH17
    s_lshl_b32 s36, s36, 8
    v_mov_b32 v255, 1
    v_mov_b32 v240, s36
    buffer_atomic_add v255, v240, s[60:63], 0 offen sc0 sc1
    s_mov_b32 s34, s41
K12_SH17:
    s_mov_b64 exec, -1
K12_SG17:
    s_waitcnt vmcnt(0)
    s_cmp_ge_u32 s34, 8
    s_cbranch_scc1 K12_PB18
    v_readfirstlane_b32 s37, v255
    s_nop 3
    s_cmp_eq_u32 s37, 255
    s_cbranch_scc0 K12_PB18
    s_lshl_b32 s36, s34, 4
    s_add_u32 s36, s36, 16384
    s_mov_b64 exec, 1
    v_mov_b32 v255, 1
    v_mov_b32 v240, s36
    buffer_store_dword v255, v240, s[60:63], 0 offen sc1
    s_mov_b64 exec, -1
K12_PB18:
    s_endpgm
K12_CONS:
    s_and_b32 s6, s2, 7
    s_lshl_b32 s6, s6, 2
    s_lshr_b32 s7, s2, 6
    s_add_u32 s6, s6, s7
    s_mov_b32 s51, s6
    s_mov_b32 s27, s6
    s_lshr_b32 s7, s2, 3
    s_and_b32 s7, s7, 7
    s_lshr_b32 s20, s7, 2
    s_and_b32 s21, s7, 3
    s_lshl_b32 s22, s6, 1
    s_add_u32 s22, s22, s20
    s_lshl_b32 s23, s6, 2
    s_add_u32 s23, s23, s21
    s_mul_i32 s24, s22, 684032
    s_mul_i32 s25, s23, 524288
    s_add_u32 s25, s25, 50331648
    s_mul_i32 s26, s22, 342016
    s_add_u32 s26, s26, 118489088
    s_add_u32 s8, s58, s24
    s_addc_u32 s9, s59, 0
    s_and_b32 s9, s9, 0xffff
    s_mov_b32 s10, 684032
    s_mov_b32 s11, 0x00020000
    s_add_u32 s12, s58, s25
    s_addc_u32 s13, s59, 0
    s_and_b32 s13, s13, 0xffff
    s_mov_b32 s14, 524288
    s_mov_b32 s15, 0x00020000
    s_add_u32 s16, s58, s26
    s_addc_u32 s17, s59, 0
    s_and_b32 s17, s17, 0xffff
    s_mov_b32 s18, 342016
    s_mov_b32 s19, 0x00020000
    s_add_u32 s4, s58, 153108480
    s_addc_u32 s5, s59, 0
    s_and_b32 s5, s5, 0xffff
    s_cmp_eq_u32 s3, 0
    s_cselect_b32 s6, 128, 0
    s_mov_b32 s7, 0x00020000
    s_mov_b32 s46, 155712
    s_cselect_b32 s46, s46, 155776
    s_mov_b32 s47, 155712
    s_cselect_b32 s47, s47, 155744
    s_cselect_b32 s45, 4, 0
    s_mov_b32 s50, s45
    v_and_b32 v8, 15, v2
    v_lshrrev_b32 v9, 4, v2
    v_lshlrev_b32 v1, 4, v2
    s_mul_i32 s30, s3, 5120
    s_mov_b32 s36, s30
    s_lshl_b32 s31, s3, 12
    s_add_u32 s37, s31, 22528
    s_lshr_b32 s28, s3, 1
    s_and_b32 s29, s3, 1
    s_lshl_b32 s33, s29, 9
    s_add_u32 s33, s33, 20480
    s_mul_i32 s38, s28, 896
    s_add_u32 s38, s38, s33
    s_lshl_b32 s34, s51, 1
    s_add_u32 s34, s34, s28
    s_mul_i32 s34, s34, 684032
    s_add_u32 s64, s58, s34
    s_addc_u32 s65, s59, 0
    s_and_b32 s65, s65, 0xffff
    s_mov_b32 s66, 684032
    s_mov_b32 s67, 0x00020000
    s_mov_b32 s44, 0xffffff
    s_cmp_eq_u32 s29, 0
    s_cselect_b32 s44, -1, s44
    s_mov_b32 s45, 0
    v_lshrrev_b32 v10, 1, v8
    v_xor_b32 v10, v10, v9
    v_lshlrev_b32 v10, 4, v10
    v_lshl_add_u32 v2, v8, 7, v10
    v_xor_b32 v3, 64, v2
    v_lshrrev_b32 v10, 2, v8
    v_lshl_add_u32 v11, v9, 3, v10
    v_lshlrev_b32 v11, 9, v11
    v_and_b32 v12, 1, v9
    v_lshl_or_b32 v10, v12, 2, v10
    s_lshl_b32 s28, s3, 1
    v_xor_b32 v10, s28, v10
    v_lshl_add_u32 v11, v10, 5, v11
    v_and_b32 v10, 3, v8
    v_lshl_add_u32 v11, v10, 3, v11
    v_add_u32 v4, 22528, v11
    s_lshl_b32 s28, s20, 5
    v_xor_b32 v4, s28, v4
    v_and_b32 v10, 3, v8
    v_lshlrev_b32 v10, 2, v10
    v_add_u32 v5, 155648, v10
    s_lshl_b32 s28, s3, 2
    s_add_u32 s28, s28, 155648
    v_mov_b32 v7, s28
    s_mov_b32 s35, 0x80008000
    s_mov_b32 s62, 0
    s_mov_b32 s63, 0
    s_mov_b32 s39, 0
    s_add_u32 m0, s39, s36
    s_nop 0
    buffer_load_dwordx4 v1, s[8:11], s30 offen sc1 lds
    buffer_load_dwordx4 v1, s[8:11], s30 offen offset:1024 sc1 lds
    buffer_load_dwordx4 v1, s[8:11], s30 offen offset:2048 sc1 lds
    buffer_load_dwordx4 v1, s[8:11], s30 offen offset:3072 sc1 lds
    s_add_u32 m0, m0, 4096
    s_add_u32 s34, s30, 4096
    buffer_load_dwordx4 v1, s[8:11], s34 offen sc1 lds
    s_add_u32 m0, s39, s37
    s_add_u32 s30, s30, 21376
    buffer_load_dwordx4 v1, s[12:15], s31 offen sc1 lds
    buffer_load_dwordx4 v1, s[12:15], s31 offen offset:1024 sc1 lds
    buffer_load_dwordx4 v1, s[12:15], s31 offen offset:2048 sc1 lds
    buffer_load_dwordx4 v1, s[12:15], s31 offen offset:3072 sc1 lds
    s_add_u32 m0, s39, s38
    s_mov_b64 exec, s[44:45]
    buffer_load_dwordx4 v1, s[64:67], s33 offen sc1 lds
    s_mov_b64 exec, -1
    s_add_u32 s31, s31, 16384
    s_add_u32 s33, s33, 21376
    s_add_u32 s39, s39, 38912
    s_add_u32 m0, s39, s36
    s_nop 0
    buffer_load_dwordx4 v1, s[8:11], s30 offen sc1 lds
    buffer_load_dwordx4 v1, s[8:11], s30 offen offset:1024 sc1 lds
    buffer_load_dwordx4 v1, s[8:11], s30 offen offset:2048 sc1 lds
    buffer_load_dwordx4 v1, s[8:11], s30 offen offset:3072 sc1 lds
    s_add_u32 m0, m0, 4096
    s_add_u32 s34, s30, 4096
    buffer_load_dwordx4 v1, s[8:11], s34 offen sc1 lds
    s_add_u32 m0, s39, s37
    s_add_u32 s30, s30, 21376
    buffer_load_dwordx4 v1, s[12:15], s31 offen sc1 lds
    buffer_load_dwordx4 v1, s[12:15], s31 offen offset:1024 sc1 lds
    buffer_load_dwordx4 v1, s[12:15], s31 offen offset:2048 sc1 lds
    buffer_load_dwordx4 v1, s[12:15], s31 offen offset:3072 sc1 lds
    s_add_u32 m0, s39, s38
    s_mov_b64 exec, s[44:45]
    buffer_load_dwordx4 v1, s[64:67], s33 offen sc1 lds
    s_mov_b64 exec, -1
    s_add_u32 s31, s31, 16384
    s_add_u32 s33, s33, 21376
    s_add_u32 s39, s39, 38912
    s_add_u32 m0, s39, s36
    s_nop 0
    buffer_load_dwordx4 v1, s[8:11], s30 offen sc1 lds
    buffer_load_dwordx4 v1, s[8:11], s30 offen offset:1024 sc1 lds
    buffer_load_dwordx4 v1, s[8:11], s30 offen offset:2048 sc1 lds
    buffer_load_dwordx4 v1, s[8:11], s30 offen offset:3072 sc1 lds
    s_add_u32 m0, m0, 4096
    s_add_u32 s34, s30, 4096
    buffer_load_dwordx4 v1, s[8:11], s34 offen sc1 lds
    s_add_u32 m0, s39, s37
    s_add_u32 s30, s30, 21376
    buffer_load_dwordx4 v1, s[12:15], s31 offen sc1 lds
    buffer_load_dwordx4 v1, s[12:15], s31 offen offset:1024 sc1 lds
    buffer_load_dwordx4 v1, s[12:15], s31 offen offset:2048 sc1 lds
    buffer_load_dwordx4 v1, s[12:15], s31 offen offset:3072 sc1 lds
    s_add_u32 m0, s39, s38
    s_mov_b64 exec, s[44:45]
    buffer_load_dwordx4 v1, s[64:67], s33 offen sc1 lds
    s_mov_b64 exec, -1
    s_add_u32 s31, s31, 16384
    s_add_u32 s33, s33, 21376
    s_add_u32 s39, s39, 38912
    s_mov_b32 m0, s46
    s_mov_b64 exec, 0xff
    buffer_load_dword v1, s[4:7], 0 offen sc1 lds
    s_mov_b64 exec, -1
    v_lshrrev_b32 v9, 4, v1
    v_and_b32 v8, 15, v9
    v_lshrrev_b32 v9, 4, v9
    v_and_b32 v10, 3, v8
    v_lshlrev_b32 v10, 2, v10
    v_lshrrev_b32 v12, 3, v8
    v_lshl_add_u32 v10, v12, 1, v10
    s_lshl_b32 s28, s3, 4
    s_add_u32 s28, s28, 1
    v_add_u32 v10, s28, v10
    v_bfe_u32 v11, v8, 2, 1
    v_and_b32 v13, 1, v9
    v_lshlrev_b32 v13, 3, v13
    v_mul_u32_u24 v14, 96, v11
    v_mad_u32_u24 v15, v10, v13, v14
    v_mad_u32_u24 v16, v10, 0, v15
    v_mad_u32_u24 v17, v10, 1, v15
    v_mad_u32_u24 v18, v10, 2, v15
    v_mad_u32_u24 v19, v10, 3, v15
    v_mad_u32_u24 v20, v10, 4, v15
    v_mad_u32_u24 v21, v10, 5, v15
    v_mad_u32_u24 v22, v10, 6, v15
    v_mad_u32_u24 v23, v10, 7, v15
    v_and_b32 v16, 127, v16
    v_and_b32 v17, 127, v17
    v_and_b32 v18, 127, v18
    v_and_b32 v19, 127, v19
    v_and_b32 v20, 127, v20
    v_and_b32 v21, 127, v21
    v_and_b32 v22, 127, v22
    v_and_b32 v23, 127, v23
    v_cvt_f32_u32 v16, v16
    v_cvt_f32_u32 v17, v17
    v_cvt_f32_u32 v18, v18
    v_cvt_f32_u32 v19, v19
    v_cvt_f32_u32 v20, v20
    v_cvt_f32_u32 v21, v21
    v_cvt_f32_u32 v22, v22
    v_cvt_f32_u32 v23, v23
    v_mul_f32 v16, 0x3c000000, v16
    v_mul_f32 v17, 0x3c000000, v17
    v_mul_f32 v18, 0x3c000000, v18
    v_mul_f32 v19, 0x3c000000, v19
    v_mul_f32 v20, 0x3c000000, v20
    v_mul_f32 v21, 0x3c000000, v21
    v_mul_f32 v22, 0x3c000000, v22
    v_mul_f32 v23, 0x3c000000, v23
    v_cos_f32 v16, v16
    v_cos_f32 v17, v17
    v_cos_f32 v18, v18
    v_cos_f32 v19, v19
    v_cos_f32 v20, v20
    v_cos_f32 v21, v21
    v_cos_f32 v22, v22
    v_cos_f32 v23, v23
    s_nop 0
    v_cvt_pk_bf16_f32 v24, v16, v17
    v_cvt_pk_bf16_f32 v25, v18, v19
    v_cvt_pk_bf16_f32 v26, v20, v21
    v_cvt_pk_bf16_f32 v27, v22, v23
    v_lshlrev_b32 v32, 16, v24
    v_and_b32 v33, 0xffff0000, v24
    v_sub_f32 v16, v16, v32
    v_sub_f32 v17, v17, v33
    v_lshlrev_b32 v32, 16, v25
    v_and_b32 v33, 0xffff0000, v25
    v_sub_f32 v18, v18, v32
    v_sub_f32 v19, v19, v33
    v_lshlrev_b32 v32, 16, v26
    v_and_b32 v33, 0xffff0000, v26
    v_sub_f32 v20, v20, v32
    v_sub_f32 v21, v21, v33
    v_lshlrev_b32 v32, 16, v27
    v_and_b32 v33, 0xffff0000, v27
    v_sub_f32 v22, v22, v32
    v_sub_f32 v23, v23, v33
    v_cvt_pk_bf16_f32 v28, v16, v17
    v_cvt_pk_bf16_f32 v29, v18, v19
    v_cvt_pk_bf16_f32 v30, v20, v21
    v_cvt_pk_bf16_f32 v31, v22, v23
    v_cmp_lt_u32 vcc, 1, v9
    s_lshl_b32 s28, s3, 10
    s_add_u32 s28, s28, 133120
    v_add_u32 v14, s28, v1
    v_cndmask_b32 v24, v24, v28, vcc
    v_cndmask_b32 v25, v25, v29, vcc
    v_cndmask_b32 v26, v26, v30, vcc
    v_cndmask_b32 v27, v27, v31, vcc
    ds_write_b128 v14, v[24:27]
    v_mov_b32 v12, 0
    v_mov_b32 v13, 0
    v_mov_b32 v14, 0
    v_mov_b32 v15, 0
    s_mul_i32 s28, s3, 38912
    s_add_u32 s28, s28, 22272
    v_add_u32 v16, s28, v1
    s_mov_b64 exec, 0xffff
    ds_write_b128 v16, v[12:15]
    s_mov_b64 exec, -1
    s_lshl_b32 s28, s3, 2
    s_add_u32 s28, s28, 155648
    v_mov_b32 v16, s28
    ds_write_b32 v16, v12
    s_lshl_b32 s28, s3, 3
    s_add_u32 s28, s28, 155680
    v_mov_b32 v16, s28
    ds_write_b64 v16, v[12:13]
    s_lshl_b32 s28, s3, 3
    s_add_u32 s28, s28, 155712
    v_mov_b32 v16, s28
    ds_write_b64 v16, v[12:13]
    s_lshl_b32 s28, s3, 3
    s_add_u32 s28, s28, 155840
    v_mov_b32 v16, s28
    ds_write_b64 v16, v[12:13]
    v_mov_b32 v16, 155664
    ds_write_b32 v16, v12
    v_mov_b32 v16, 155744
    v_mov_b32 v17, 1
    ds_write_b32 v16, v17
    s_waitcnt lgkmcnt(0)
    s_barrier
    v_mov_b32 v80, 0
    v_mov_b32 v81, 0
    v_mov_b32 v82, 0
    v_mov_b32 v83, 0
    v_mov_b32 v84, 0
    v_mov_b32 v85, 0
    v_mov_b32 v86, 0
    v_mov_b32 v87, 0
    v_mov_b32 v88, 0
    v_mov_b32 v89, 0
    v_mov_b32 v90, 0
    v_mov_b32 v91, 0
    v_mov_b32 v92, 0
    v_mov_b32 v93, 0
    v_mov_b32 v94, 0
    v_mov_b32 v95, 0
    v_mov_b32 v96, 0
    v_mov_b32 v97, 0
    v_mov_b32 v98, 0
    v_mov_b32 v99, 0
    v_mov_b32 v100, 0
    v_mov_b32 v101, 0
    v_mov_b32 v102, 0
    v_mov_b32 v103, 0
    v_mov_b32 v104, 0
    v_mov_b32 v105, 0
    v_mov_b32 v106, 0
    v_mov_b32 v107, 0
    v_mov_b32 v108, 0
    v_mov_b32 v109, 0
    v_mov_b32 v110, 0
    v_mov_b32 v111, 0
    v_mov_b32 v112, 0
    v_mov_b32 v113, 0
    v_mov_b32 v114, 0
    v_mov_b32 v115, 0
    v_mov_b32 v116, 0
    v_mov_b32 v117, 0
    v_mov_b32 v118, 0
    v_mov_b32 v119, 0
    v_mov_b32 v120, 0
    v_mov_b32 v121, 0
    v_mov_b32 v122, 0
    v_mov_b32 v123, 0
    v_mov_b32 v124, 0
    v_mov_b32 v125, 0
    v_mov_b32 v126, 0
    v_mov_b32 v127, 0
    v_mov_b32 v128, 0
    v_mov_b32 v129, 0
    v_mov_b32 v130, 0
    v_mov_b32 v131, 0
    v_mov_b32 v132, 0
    v_mov_b32 v133, 0
    v_mov_b32 v134, 0
    v_mov_b32 v135, 0
    v_mov_b32 v136, 0
    v_mov_b32 v137, 0
    v_mov_b32 v138, 0
    v_mov_b32 v139, 0
    v_mov_b32 v140, 0
    v_mov_b32 v141, 0
    v_mov_b32 v142, 0
    v_mov_b32 v143, 0
    v_mov_b32 v144, 0
    v_mov_b32 v145, 0
    v_mov_b32 v146, 0
    v_mov_b32 v147, 0
    v_mov_b32 v148, 0
    v_mov_b32 v149, 0
    v_mov_b32 v150, 0
    v_mov_b32 v151, 0
    v_mov_b32 v152, 0
    v_mov_b32 v153, 0
    v_mov_b32 v154, 0
    v_mov_b32 v155, 0
    v_mov_b32 v156, 0
    v_mov_b32 v157, 0
    v_mov_b32 v158, 0
    v_mov_b32 v159, 0
    v_mov_b32 v160, 0
    v_mov_b32 v161, 0
    v_mov_b32 v162, 0
    v_mov_b32 v163, 0
    v_mov_b32 v164, 0
    v_mov_b32 v165, 0
    v_mov_b32 v166, 0
    v_mov_b32 v167, 0
    v_mov_b32 v168, 0
    v_mov_b32 v169, 0
    v_mov_b32 v170, 0
    v_mov_b32 v171, 0
    v_mov_b32 v172, 0
    v_mov_b32 v173, 0
    v_mov_b32 v174, 0
    v_mov_b32 v175, 0
    v_mov_b32 v176, 0
    v_mov_b32 v177, 0
    v_mov_b32 v178, 0
    v_mov_b32 v179, 0
    v_mov_b32 v180, 0
    v_mov_b32 v181, 0
    v_mov_b32 v182, 0
    v_mov_b32 v183, 0
    v_mov_b32 v184, 0
    v_mov_b32 v185, 0
    v_mov_b32 v186, 0
    v_mov_b32 v187, 0
    v_mov_b32 v188, 0
    v_mov_b32 v189, 0
    v_mov_b32 v190, 0
    v_mov_b32 v191, 0
    v_mov_b32 v192, 0
    v_mov_b32 v193, 0
    v_mov_b32 v194, 0
    v_mov_b32 v195, 0
    v_mov_b32 v196, 0
    v_mov_b32 v197, 0
    v_mov_b32 v198, 0
    v_mov_b32 v199, 0
    v_mov_b32 v200, 0
    v_mov_b32 v201, 0
    v_mov_b32 v202, 0
    v_mov_b32 v203, 0
    v_mov_b32 v204, 0
    v_mov_b32 v205, 0
    v_mov_b32 v206, 0
    v_mov_b32 v207, 0
    v_mov_b32 v208, 0
    v_mov_b32 v209, 0
    v_mov_b32 v210, 0
    v_mov_b32 v211, 0
    v_mov_b32 v212, 0
    v_mov_b32 v213, 0
    v_mov_b32 v214, 0
    v_mov_b32 v215, 0
    v_mov_b32 v216, 0
    v_mov_b32 v217, 0
    v_mov_b32 v218, 0
    v_mov_b32 v219, 0
    v_mov_b32 v220, 0
    v_mov_b32 v221, 0
    v_mov_b32 v222, 0
    v_mov_b32 v223, 0
    v_mov_b32 v224, 0
    v_mov_b32 v225, 0
    v_mov_b32 v226, 0
    v_mov_b32 v227, 0
    v_mov_b32 v228, 0
    v_mov_b32 v229, 0
    v_mov_b32 v230, 0
    v_mov_b32 v231, 0
    v_mov_b32 v232, 0
    v_mov_b32 v233, 0
    v_mov_b32 v234, 0
    v_mov_b32 v235, 0
    v_mov_b32 v236, 0
    v_mov_b32 v237, 0
    v_mov_b32 v238, 0
    v_mov_b32 v239, 0
    v_mov_b32 v240, 0
    v_mov_b32 v241, 0
    v_mov_b32 v242, 0
    v_mov_b32 v243, 0
    v_mov_b32 v244, 0
    v_mov_b32 v245, 0
    v_mov_b32 v246, 0
    v_mov_b32 v247, 0
    s_barrier
    s_mov_b32 s40, 2
    v_mov_b32 v0, s40
    s_waitcnt vmcnt(21)
    ds_write_b32 v7, v0
    s_branch K12_S0
K12_Q0:
    ds_read_b64_tr_b16 v[40:41], v4 offset:0
    ds_read_b64_tr_b16 v[42:43], v4 offset:2048
    ds_read_b64_tr_b16 v[44:45], v4 offset:256
    ds_read_b64_tr_b16 v[46:47], v4 offset:2304
    v_xor_b32 v4, 32, v4
    ds_read_b64_tr_b16 v[48:49], v4 offset:0
    ds_read_b64_tr_b16 v[50:51], v4 offset:2048
    ds_read_b64_tr_b16 v[52:53], v4 offset:256
    ds_read_b64_tr_b16 v[54:55], v4 offset:2304
    v_xor_b32 v4, 32, v4
    ds_read_b128 v[8:11], v2 offset:0
    ds_read_b128 v[12:15], v3 offset:0
    ds_read_b128 v[16:19], v2 offset:2048
    ds_read_b128 v[20:23], v3 offset:2048
    ds_read_b128 v[32:35], v2 offset:6144
    ds_read_b128 v[36:39], v3 offset:6144
    ds_read_b32 v68, v5
    s_waitcnt lgkmcnt(7)
    v_xor_b32 v72, s35, v44
    v_xor_b32 v73, s35, v45
    v_xor_b32 v74, s35, v46
    v_xor_b32 v75, s35, v47
    v_xor_b32 v76, s35, v52
    v_xor_b32 v77, s35, v53
    v_xor_b32 v78, s35, v54
    v_xor_b32 v79, s35, v55
    s_mov_b32 s41, 0
    s_mov_b32 s42, 38912
    s_mov_b32 s39, 0
    s_mov_b32 s29, 116736
K12_LOOP:
    s_waitcnt lgkmcnt(2)
    v_mfma_f32_16x16x32_bf16 v[80:83], v[8:11], v[40:43], v[80:83]
    ds_read_b128 v[24:27], v2 offset:4096
    v_xor_b32 v72, s35, v44
    v_xor_b32 v73, s35, v45
    v_mfma_f32_16x16x32_bf16 v[84:87], v[8:11], v[44:47], v[84:87]
    ds_read_b128 v[28:31], v3 offset:4096
    v_xor_b32 v74, s35, v46
    v_xor_b32 v75, s35, v47
    v_mfma_f32_16x16x32_bf16 v[88:91], v[8:11], v[48:51], v[88:91]
    s_waitcnt lgkmcnt(2)
    v_cmp_gt_u32 vcc, s40, v68
    s_add_u32 s49, s39, 2
    s_lshr_b32 s49, s49, 1
    v_xor_b32 v76, s35, v52
    v_xor_b32 v77, s35, v53
    v_mfma_f32_16x16x32_bf16 v[92:95], v[8:11], v[52:55], v[92:95]
    s_cbranch_vccnz K12_S1
K12_Q1:
    s_mul_i32 s48, s49, s50
    s_add_u32 s48, s48, s47
    v_xor_b32 v78, s35, v54
    v_xor_b32 v79, s35, v55
    v_mfma_f32_16x16x32_bf16 v[80:83], v[12:15], v[72:75], v[80:83]
    s_add_u32 m0, s29, s36
    s_nop 0
    buffer_load_dwordx4 v1, s[8:11], s30 offen sc1 lds
    v_mfma_f32_16x16x32_bf16 v[84:87], v[12:15], v[40:43], v[84:87]
    s_cmp_lt_u32 s49, 8
    s_cselect_b32 s48, s48, 155744
    v_mfma_f32_16x16x32_bf16 v[88:91], v[12:15], v[76:79], v[88:91]
    s_cmp_ge_u32 s49, 3
    s_cselect_b32 s48, s48, 155744
    v_mfma_f32_16x16x32_bf16 v[92:95], v[12:15], v[48:51], v[92:95]
    v_mfma_f32_16x16x32_bf16 v[96:99], v[16:19], v[40:43], v[96:99]
    ds_read_b128 v[8:11], v2 offset:8192
    v_mfma_f32_16x16x32_bf16 v[100:103], v[16:19], v[44:47], v[100:103]
    ds_read_b128 v[12:15], v3 offset:8192
    v_mfma_f32_16x16x32_bf16 v[104:107], v[16:19], v[48:51], v[104:107]
    buffer_load_dwordx4 v1, s[8:11], s30 offen offset:1024 sc1 lds
    v_mfma_f32_16x16x32_bf16 v[108:111], v[16:19], v[52:55], v[108:111]
    v_mfma_f32_16x16x32_bf16 v[96:99], v[20:23], v[72:75], v[96:99]
    v_mfma_f32_16x16x32_bf16 v[100:103], v[20:23], v[40:43], v[100:103]
    v_mfma_f32_16x16x32_bf16 v[104:107], v[20:23], v[76:79], v[104:107]
    buffer_load_dwordx4 v1, s[8:11], s30 offen offset:2048 sc1 lds
    v_mfma_f32_16x16x32_bf16 v[108:111], v[20:23], v[48:51], v[108:111]
    s_waitcnt lgkmcnt(2)
    v_mfma_f32_16x16x32_bf16 v[112:115], v[24:27], v[40:43], v[112:115]
    ds_read_b128 v[16:19], v2 offset:10240
    v_mfma_f32_16x16x32_bf16 v[116:119], v[24:27], v[44:47], v[116:119]
    ds_read_b128 v[20:23], v3 offset:10240
    v_mfma_f32_16x16x32_bf16 v[120:123], v[24:27], v[48:51], v[120:123]
    v_mfma_f32_16x16x32_bf16 v[124:127], v[24:27], v[52:55], v[124:127]
    v_mfma_f32_16x16x32_bf16 v[112:115], v[28:31], v[72:75], v[112:115]
    buffer_load_dwordx4 v1, s[8:11], s30 offen offset:3072 sc1 lds
    v_mfma_f32_16x16x32_bf16 v[116:119], v[28:31], v[40:43], v[116:119]
    v_mfma_f32_16x16x32_bf16 v[120:123], v[28:31], v[76:79], v[120:123]
    v_mfma_f32_16x16x32_bf16 v[124:127], v[28:31], v[48:51], v[124:127]
    v_mfma_f32_16x16x32_bf16 v[128:131], v[32:35], v[40:43], v[128:131]
    ds_read_b128 v[24:27], v2 offset:12288
    v_mfma_f32_16x16x32_bf16 v[132:135], v[32:35], v[44:47], v[132:135]
    ds_read_b128 v[28:31], v3 offset:12288
    v_mfma_f32_16x16x32_bf16 v[136:139], v[32:35], v[48:51], v[136:139]
    s_add_u32 m0, m0, 4096
    s_add_u32 s34, s30, 4096
    buffer_load_dwordx4 v1, s[8:11], s34 offen sc1 lds
    v_mfma_f32_16x16x32_bf16 v[140:143], v[32:35], v[52:55], v[140:143]
    v_mfma_f32_16x16x32_bf16 v[128:131], v[36:39], v[72:75], v[128:131]
    v_mfma_f32_16x16x32_bf16 v[132:135], v[36:39], v[40:43], v[132:135]
    v_mfma_f32_16x16x32_bf16 v[136:139], v[36:39], v[76:79], v[136:139]
    s_add_u32 m0, s29, s37
    s_add_u32 s30, s30, 21376
    buffer_load_dwordx4 v1, s[12:15], s31 offen sc1 lds
    v_mfma_f32_16x16x32_bf16 v[140:143], v[36:39], v[48:51], v[140:143]
    s_waitcnt lgkmcnt(4)
    v_mfma_f32_16x16x32_bf16 v[144:147], v[8:11], v[40:43], v[144:147]
    ds_read_b128 v[32:35], v2 offset:14336
    v_mfma_f32_16x16x32_bf16 v[148:151], v[8:11], v[44:47], v[148:151]
    ds_read_b128 v[36:39], v3 offset:14336
    v_mfma_f32_16x16x32_bf16 v[152:155], v[8:11], v[48:51], v[152:155]
    v_mfma_f32_16x16x32_bf16 v[156:159], v[8:11], v[52:55], v[156:159]
    s_add_u32 s40, s40, 1
    s_mov_b32 s51, s40
    v_mov_b32 v0, s40
    v_mfma_f32_16x16x32_bf16 v[144:147], v[12:15], v[72:75], v[144:147]
    s_waitcnt vmcnt(17)
    ds_write_b32 v7, v0
    buffer_load_dwordx4 v1, s[12:15], s31 offen offset:1024 sc1 lds
    v_mfma_f32_16x16x32_bf16 v[148:151], v[12:15], v[40:43], v[148:151]
    v_mfma_f32_16x16x32_bf16 v[152:155], v[12:15], v[76:79], v[152:155]
    v_mfma_f32_16x16x32_bf16 v[156:159], v[12:15], v[48:51], v[156:159]
    s_waitcnt lgkmcnt(5)
    v_mfma_f32_16x16x32_bf16 v[160:163], v[16:19], v[40:43], v[160:163]
    ds_read_b128 v[8:11], v2 offset:16384
    v_mfma_f32_16x16x32_bf16 v[164:167], v[16:19], v[44:47], v[164:167]
    ds_read_b128 v[12:15], v3 offset:16384
    v_mfma_f32_16x16x32_bf16 v[168:171], v[16:19], v[48:51], v[168:171]
    buffer_load_dwordx4 v1, s[12:15], s31 offen offset:2048 sc1 lds
    v_mfma_f32_16x16x32_bf16 v[172:175], v[16:19], v[52:55], v[172:175]
    v_mfma_f32_16x16x32_bf16 v[160:163], v[20:23], v[72:75], v[160:163]
    v_mfma_f32_16x16x32_bf16 v[164:167], v[20:23], v[40:43], v[164:167]
    v_mfma_f32_16x16x32_bf16 v[168:171], v[20:23], v[76:79], v[168:171]
    buffer_load_dwordx4 v1, s[12:15], s31 offen offset:3072 sc1 lds
    v_mfma_f32_16x16x32_bf16 v[172:175], v[20:23], v[48:51], v[172:175]
    s_waitcnt lgkmcnt(5)
    v_mfma_f32_16x16x32_bf16 v[176:179], v[24:27], v[40:43], v[176:179]
    ds_read_b128 v[16:19], v2 offset:18432
    v_mfma_f32_16x16x32_bf16 v[180:183], v[24:27], v[44:47], v[180:183]
    ds_read_b128 v[20:23], v3 offset:18432
    v_mov_b32 v0, s48
    v_mfma_f32_16x16x32_bf16 v[184:187], v[24:27], v[48:51], v[184:187]
    ds_read_b32 v0, v0
    v_mfma_f32_16x16x32_bf16 v[188:191], v[24:27], v[52:55], v[188:191]
    v_mfma_f32_16x16x32_bf16 v[176:179], v[28:31], v[72:75], v[176:179]
    s_add_u32 m0, s29, s38
    s_mov_b64 exec, s[44:45]
    buffer_load_dwordx4 v1, s[64:67], s33 offen sc1 lds
    s_mov_b64 exec, -1
    s_add_u32 s31, s31, 16384
    s_add_u32 s33, s33, 21376
    v_mfma_f32_16x16x32_bf16 v[180:183], v[28:31], v[40:43], v[180:183]
    v_mfma_f32_16x16x32_bf16 v[184:187], v[28:31], v[76:79], v[184:187]
    v_mfma_f32_16x16x32_bf16 v[188:191], v[28:31], v[48:51], v[188:191]
    s_waitcnt lgkmcnt(0)
    v_cmp_eq_u32 vcc, 0, v0
    v_mfma_f32_16x16x32_bf16 v[192:195], v[32:35], v[40:43], v[192:195]
    ds_read_b128 v[24:27], v2 offset:20480
    v_mfma_f32_16x16x32_bf16 v[196:199], v[32:35], v[44:47], v[196:199]
    ds_read_b128 v[28:31], v3 offset:20480
    s_cbranch_vccnz K12_F2
K12_G2:
    v_mfma_f32_16x16x32_bf16 v[200:203], v[32:35], v[48:51], v[200:203]
    s_sub_u32 s43, s42, s41
    s_add_u32 s40, s40, 1
    v_add_u32 v2, s43, v2
    v_mfma_f32_16x16x32_bf16 v[204:207], v[32:35], v[52:55], v[204:207]
    v_add_u32 v3, s43, v3
    v_add_u32 v4, s43, v4
    v_mov_b32 v0, s40
    v_mfma_f32_16x16x32_bf16 v[192:195], v[36:39], v[72:75], v[192:195]
    ds_write_b32 v7, v0
    v_mfma_f32_16x16x32_bf16 v[196:199], v[36:39], v[40:43], v[196:199]
    v_mfma_f32_16x16x32_bf16 v[200:203], v[36:39], v[76:79], v[200:203]
    v_mfma_f32_16x16x32_bf16 v[204:207], v[36:39], v[48:51], v[204:207]
    ds_read_b32 v56, v5
    v_mfma_f32_16x16x32_bf16 v[208:211], v[8:11], v[40:43], v[208:211]
    v_mfma_f32_16x16x32_bf16 v[212:215], v[8:11], v[44:47], v[212:215]
    v_mfma_f32_16x16x32_bf16 v[216:219], v[8:11], v[48:51], v[216:219]
    v_mfma_f32_16x16x32_bf16 v[220:223], v[8:11], v[52:55], v[220:223]
    s_waitcnt lgkmcnt(0)
    v_cmp_gt_u32 vcc, s51, v56
    v_mfma_f32_16x16x32_bf16 v[208:211], v[12:15], v[72:75], v[208:211]
    v_mfma_f32_16x16x32_bf16 v[212:215], v[12:15], v[40:43], v[212:215]
    s_cbranch_vccnz K12_S3
K12_Q3:
    v_mfma_f32_16x16x32_bf16 v[216:219], v[12:15], v[76:79], v[216:219]
    ds_read_b64_tr_b16 v[56:57], v4 offset:0
    v_mfma_f32_16x16x32_bf16 v[220:223], v[12:15], v[48:51], v[220:223]
    ds_read_b64_tr_b16 v[58:59], v4 offset:2048
    v_mfma_f32_16x16x32_bf16 v[224:227], v[16:19], v[40:43], v[224:227]
    ds_read_b64_tr_b16 v[60:61], v4 offset:256
    ds_read_b128 v[8:11], v2 offset:0
    v_mfma_f32_16x16x32_bf16 v[228:231], v[16:19], v[44:47], v[228:231]
    ds_read_b64_tr_b16 v[62:63], v4 offset:2304
    ds_read_b128 v[12:15], v3 offset:0
    v_mfma_f32_16x16x32_bf16 v[232:235], v[16:19], v[48:51], v[232:235]
    v_xor_b32 v4, 32, v4
    ds_read_b128 v[32:35], v2 offset:6144
    v_mfma_f32_16x16x32_bf16 v[236:239], v[16:19], v[52:55], v[236:239]
    ds_read_b64_tr_b16 v[64:65], v4 offset:0
    ds_read_b128 v[36:39], v3 offset:6144
    v_mfma_f32_16x16x32_bf16 v[224:227], v[20:23], v[72:75], v[224:227]
    ds_read_b64_tr_b16 v[66:67], v4 offset:2048
    ds_read_b32 v52, v5
    v_mfma_f32_16x16x32_bf16 v[228:231], v[20:23], v[40:43], v[228:231]
    ds_read_b64_tr_b16 v[68:69], v4 offset:256
    ds_read_b64_tr_b16 v[70:71], v4 offset:2304
    v_xor_b32 v4, 32, v4
    v_mfma_f32_16x16x32_bf16 v[232:235], v[20:23], v[76:79], v[232:235]
    v_mfma_f32_16x16x32_bf16 v[236:239], v[20:23], v[48:51], v[236:239]
    v_mfma_f32_16x16x32_bf16 v[240:243], v[24:27], v[40:43], v[240:243]
    ds_read_b128 v[16:19], v2 offset:2048
    v_mfma_f32_16x16x32_bf16 v[244:247], v[24:27], v[44:47], v[244:247]
    ds_read_b128 v[20:23], v3 offset:2048
    v_mfma_f32_16x16x32_bf16 v[240:243], v[28:31], v[72:75], v[240:243]
    s_mov_b32 s29, s41
    s_mov_b32 s41, s42
    s_add_u32 s42, s42, 38912
    v_mfma_f32_16x16x32_bf16 v[244:247], v[28:31], v[40:43], v[244:247]
    s_cmp_eq_u32 s42, 155648
    s_cselect_b32 s42, 0, s42
    s_waitcnt lgkmcnt(2)
    v_mfma_f32_16x16x32_bf16 v[80:83], v[8:11], v[56:59], v[80:83]
    ds_read_b128 v[24:27], v2 offset:4096
    v_xor_b32 v72, s35, v60
    v_xor_b32 v73, s35, v61
    v_mfma_f32_16x16x32_bf16 v[84:87], v[8:11], v[60:63], v[84:87]
    ds_read_b128 v[28:31], v3 offset:4096
    v_xor_b32 v74, s35, v62
    v_xor_b32 v75, s35, v63
    v_mfma_f32_16x16x32_bf16 v[88:91], v[8:11], v[64:67], v[88:91]
    s_waitcnt lgkmcnt(2)
    v_cmp_gt_u32 vcc, s40, v52
    v_xor_b32 v76, s35, v68
    v_xor_b32 v77, s35, v69
    v_mfma_f32_16x16x32_bf16 v[92:95], v[8:11], v[68:71], v[92:95]
    s_cbranch_vccnz K12_S4
K12_Q4:
    v_xor_b32 v78, s35, v70
    v_xor_b32 v79, s35, v71
    v_mfma_f32_16x16x32_bf16 v[80:83], v[12:15], v[72:75], v[80:83]
    s_add_u32 m0, s29, s36
    s_nop 0
    buffer_load_dwordx4 v1, s[8:11], s30 offen sc1 lds
    v_mfma_f32_16x16x32_bf16 v[84:87], v[12:15], v[56:59], v[84:87]
    v_mfma_f32_16x16x32_bf16 v[88:91], v[12:15], v[76:79], v[88:91]
    v_mfma_f32_16x16x32_bf16 v[92:95], v[12:15], v[64:67], v[92:95]
    v_mfma_f32_16x16x32_bf16 v[96:99], v[16:19], v[56:59], v[96:99]
    ds_read_b128 v[8:11], v2 offset:8192
    v_mfma_f32_16x16x32_bf16 v[100:103], v[16:19], v[60:63], v[100:103]
    ds_read_b128 v[12:15], v3 offset:8192
    v_mfma_f32_16x16x32_bf16 v[104:107], v[16:19], v[64:67], v[104:107]
    buffer_load_dwordx4 v1, s[8:11], s30 offen offset:1024 sc1 lds
    v_mfma_f32_16x16x32_bf16 v[108:111], v[16:19], v[68:71], v[108:111]
    v_mfma_f32_16x16x32_bf16 v[96:99], v[20:23], v[72:75], v[96:99]
    v_mfma_f32_16x16x32_bf16 v[100:103], v[20:23], v[56:59], v[100:103]
    v_mfma_f32_16x16x32_bf16 v[104:107], v[20:23], v[76:79], v[104:107]
    buffer_load_dwordx4 v1, s[8:11], s30 offen offset:2048 sc1 lds
    v_mfma_f32_16x16x32_bf16 v[108:111], v[20:23], v[64:67], v[108:111]
    s_waitcnt lgkmcnt(2)
    v_mfma_f32_16x16x32_bf16 v[112:115], v[24:27], v[56:59], v[112:115]
    ds_read_b128 v[16:19], v2 offset:10240
    v_mfma_f32_16x16x32_bf16 v[116:119], v[24:27], v[60:63], v[116:119]
    ds_read_b128 v[20:23], v3 offset:10240
    v_mfma_f32_16x16x32_bf16 v[120:123], v[24:27], v[64:67], v[120:123]
    v_mfma_f32_16x16x32_bf16 v[124:127], v[24:27], v[68:71], v[124:127]
    v_mfma_f32_16x16x32_bf16 v[112:115], v[28:31], v[72:75], v[112:115]
    buffer_load_dwordx4 v1, s[8:11], s30 offen offset:3072 sc1 lds
    v_mfma_f32_16x16x32_bf16 v[116:119], v[28:31], v[56:59], v[116:119]
    v_mfma_f32_16x16x32_bf16 v[120:123], v[28:31], v[76:79], v[120:123]
    v_mfma_f32_16x16x32_bf16 v[124:127], v[28:31], v[64:67], v[124:127]
    v_mfma_f32_16x16x32_bf16 v[128:131], v[32:35], v[56:59], v[128:131]
    ds_read_b128 v[24:27], v2 offset:12288
    v_mfma_f32_16x16x32_bf16 v[132:135], v[32:35], v[60:63], v[132:135]
    ds_read_b128 v[28:31], v3 offset:12288
    v_mfma_f32_16x16x32_bf16 v[136:139], v[32:35], v[64:67], v[136:139]
    s_add_u32 m0, m0, 4096
    s_add_u32 s34, s30, 4096
    buffer_load_dwordx4 v1, s[8:11], s34 offen sc1 lds
    v_mfma_f32_16x16x32_bf16 v[140:143], v[32:35], v[68:71], v[140:143]
    v_mfma_f32_16x16x32_bf16 v[128:131], v[36:39], v[72:75], v[128:131]
    v_mfma_f32_16x16x32_bf16 v[132:135], v[36:39], v[56:59], v[132:135]
    v_mfma_f32_16x16x32_bf16 v[136:139], v[36:39], v[76:79], v[136:139]
    s_add_u32 m0, s29, s37
    s_add_u32 s30, s30, 21376
    buffer_load_dwordx4 v1, s[12:15], s31 offen sc1 lds
    v_mfma_f32_16x16x32_bf16 v[140:143], v[36:39], v[64:67], v[140:143]
    s_waitcnt lgkmcnt(4)
    v_mfma_f32_16x16x32_bf16 v[144:147], v[8:11], v[56:59], v[144:147]
    ds_read_b128 v[32:35], v2 offset:14336
    v_mfma_f32_16x16x32_bf16 v[148:151], v[8:11], v[60:63], v[148:151]
    ds_read_b128 v[36:39], v3 offset:14336
    v_mfma_f32_16x16x32_bf16 v[152:155], v[8:11], v[64:67], v[152:155]
    v_mfma_f32_16x16x32_bf16 v[156:159], v[8:11], v[68:71], v[156:159]
    s_add_u32 s40, s40, 1
    s_mov_b32 s51, s40
    v_mov_b32 v0, s40
    v_mfma_f32_16x16x32_bf16 v[144:147], v[12:15], v[72:75], v[144:147]
    s_waitcnt vmcnt(17)
    ds_write_b32 v7, v0
    buffer_load_dwordx4 v1, s[12:15], s31 offen offset:1024 sc1 lds
    v_mfma_f32_16x16x32_bf16 v[148:151], v[12:15], v[56:59], v[148:151]
    v_mfma_f32_16x16x32_bf16 v[152:155], v[12:15], v[76:79], v[152:155]
    v_mfma_f32_16x16x32_bf16 v[156:159], v[12:15], v[64:67], v[156:159]
    s_waitcnt lgkmcnt(5)
    v_mfma_f32_16x16x32_bf16 v[160:163], v[16:19], v[56:59], v[160:163]
    ds_read_b128 v[8:11], v2 offset:16384
    v_mfma_f32_16x16x32_bf16 v[164:167], v[16:19], v[60:63], v[164:167]
    ds_read_b128 v[12:15], v3 offset:16384
    v_mfma_f32_16x16x32_bf16 v[168:171], v[16:19], v[64:67], v[168:171]
    buffer_load_dwordx4 v1, s[12:15], s31 offen offset:2048 sc1 lds
    v_mfma_f32_16x16x32_bf16 v[172:175], v[16:19], v[68:71], v[172:175]
    v_mfma_f32_16x16x32_bf16 v[160:163], v[20:23], v[72:75], v[160:163]
    v_mfma_f32_16x16x32_bf16 v[164:167], v[20:23], v[56:59], v[164:167]
    v_mfma_f32_16x16x32_bf16 v[168:171], v[20:23], v[76:79], v[168:171]
    buffer_load_dwordx4 v1, s[12:15], s31 offen offset:3072 sc1 lds
    v_mfma_f32_16x16x32_bf16 v[172:175], v[20:23], v[64:67], v[172:175]
    s_waitcnt lgkmcnt(5)
    v_mfma_f32_16x16x32_bf16 v[176:179], v[24:27], v[56:59], v[176:179]
    ds_read_b128 v[16:19], v2 offset:18432
    v_mfma_f32_16x16x32_bf16 v[180:183], v[24:27], v[60:63], v[180:183]
    ds_read_b128 v[20:23], v3 offset:18432
    v_mfma_f32_16x16x32_bf16 v[184:187], v[24:27], v[64:67], v[184:187]
    v_mfma_f32_16x16x32_bf16 v[188:191], v[24:27], v[68:71], v[188:191]
    v_mfma_f32_16x16x32_bf16 v[176:179], v[28:31], v[72:75], v[176:179]
    s_add_u32 m0, s29, s38
    s_mov_b64 exec, s[44:45]
    buffer_load_dwordx4 v1, s[64:67], s33 offen sc1 lds
    s_mov_b64 exec, -1
    s_add_u32 s31, s31, 16384
    s_add_u32 s33, s33, 21376
    v_mfma_f32_16x16x32_bf16 v[180:183], v[28:31], v[56:59], v[180:183]
    v_mfma_f32_16x16x32_bf16 v[184:187], v[28:31], v[76:79], v[184:187]
    s_mov_b32 m0, s46
    s_mov_b64 exec, 0xff
    buffer_load_dword v1, s[4:7], 0 offen sc1 lds
    s_mov_b64 exec, -1
    v_mfma_f32_16x16x32_bf16 v[188:191], v[28:31], v[64:67], v[188:191]
    s_waitcnt lgkmcnt(5)
    v_mfma_f32_16x16x32_bf16 v[192:195], v[32:35], v[56:59], v[192:195]
    ds_read_b128 v[24:27], v2 offset:20480
    v_mfma_f32_16x16x32_bf16 v[196:199], v[32:35], v[60:63], v[196:199]
    ds_read_b128 v[28:31], v3 offset:20480
    v_mfma_f32_16x16x32_bf16 v[200:203], v[32:35], v[64:67], v[200:203]
    s_sub_u32 s43, s42, s41
    s_add_u32 s40, s40, 1
    v_add_u32 v2, s43, v2
    v_mfma_f32_16x16x32_bf16 v[204:207], v[32:35], v[68:71], v[204:207]
    v_add_u32 v3, s43, v3
    v_add_u32 v4, s43, v4
    v_mov_b32 v0, s40
    v_mfma_f32_16x16x32_bf16 v[192:195], v[36:39], v[72:75], v[192:195]
    ds_write_b32 v7, v0
    v_mfma_f32_16x16x32_bf16 v[196:199], v[36:39], v[56:59], v[196:199]
    v_mfma_f32_16x16x32_bf16 v[200:203], v[36:39], v[76:79], v[200:203]
    v_mfma_f32_16x16x32_bf16 v[204:207], v[36:39], v[64:67], v[204:207]
    ds_read_b32 v40, v5
    s_waitcnt lgkmcnt(6)
    v_mfma_f32_16x16x32_bf16 v[208:211], v[8:11], v[56:59], v[208:211]
    v_mfma_f32_16x16x32_bf16 v[212:215], v[8:11], v[60:63], v[212:215]
    v_mfma_f32_16x16x32_bf16 v[216:219], v[8:11], v[64:67], v[216:219]
    v_mfma_f32_16x16x32_bf16 v[220:223], v[8:11], v[68:71], v[220:223]
    s_waitcnt lgkmcnt(0)
    v_cmp_gt_u32 vcc, s51, v40
    v_mfma_f32_16x16x32_bf16 v[208:211], v[12:15], v[72:75], v[208:211]
    v_mfma_f32_16x16x32_bf16 v[212:215], v[12:15], v[56:59], v[212:215]
    s_cbranch_vccnz K12_S5
K12_Q5:
    v_mfma_f32_16x16x32_bf16 v[216:219], v[12:15], v[76:79], v[216:219]
    ds_read_b64_tr_b16 v[40:41], v4 offset:0
    v_mfma_f32_16x16x32_bf16 v[220:223], v[12:15], v[64:67], v[220:223]
    ds_read_b64_tr_b16 v[42:43], v4 offset:2048
    v_mfma_f32_16x16x32_bf16 v[224:227], v[16:19], v[56:59], v[224:227]
    ds_read_b64_tr_b16 v[44:45], v4 offset:256
    ds_read_b128 v[8:11], v2 offset:0
    v_mfma_f32_16x16x32_bf16 v[228:231], v[16:19], v[60:63], v[228:231]
    ds_read_b64_tr_b16 v[46:47], v4 offset:2304
    ds_read_b128 v[12:15], v3 offset:0
    v_mfma_f32_16x16x32_bf16 v[232:235], v[16:19], v[64:67], v[232:235]
    v_xor_b32 v4, 32, v4
    ds_read_b128 v[32:35], v2 offset:6144
    v_mfma_f32_16x16x32_bf16 v[236:239], v[16:19], v[68:71], v[236:239]
    ds_read_b64_tr_b16 v[48:49], v4 offset:0
    ds_read_b128 v[36:39], v3 offset:6144
    v_mfma_f32_16x16x32_bf16 v[224:227], v[20:23], v[72:75], v[224:227]
    ds_read_b64_tr_b16 v[50:51], v4 offset:2048
    ds_read_b32 v68, v5
    v_mfma_f32_16x16x32_bf16 v[228:231], v[20:23], v[56:59], v[228:231]
    ds_read_b64_tr_b16 v[52:53], v4 offset:256
    ds_read_b64_tr_b16 v[54:55], v4 offset:2304
    v_xor_b32 v4, 32, v4
    v_mfma_f32_16x16x32_bf16 v[232:235], v[20:23], v[76:79], v[232:235]
    v_mfma_f32_16x16x32_bf16 v[236:239], v[20:23], v[64:67], v[236:239]
    v_mfma_f32_16x16x32_bf16 v[240:243], v[24:27], v[56:59], v[240:243]
    ds_read_b128 v[16:19], v2 offset:2048
    v_mfma_f32_16x16x32_bf16 v[244:247], v[24:27], v[60:63], v[244:247]
    ds_read_b128 v[20:23], v3 offset:2048
    v_mfma_f32_16x16x32_bf16 v[240:243], v[28:31], v[72:75], v[240:243]
    s_mov_b32 s29, s41
    s_mov_b32 s41, s42
    s_add_u32 s42, s42, 38912
    v_mfma_f32_16x16x32_bf16 v[244:247], v[28:31], v[56:59], v[244:247]
    s_cmp_eq_u32 s42, 155648
    s_cselect_b32 s42, 0, s42
    s_add_u32 s39, s39, 1
    s_cmp_lt_u32 s39, 15
    s_cbranch_scc1 K12_LOOP
    s_waitcnt lgkmcnt(2)
    v_mfma_f32_16x16x32_bf16 v[80:83], v[8:11], v[40:43], v[80:83]
    ds_read_b128 v[24:27], v2 offset:4096
    v_xor_b32 v72, s35, v44
    v_xor_b32 v73, s35, v45
    v_mfma_f32_16x16x32_bf16 v[84:87], v[8:11], v[44:47], v[84:87]
    ds_read_b128 v[28:31], v3 offset:4096
    v_xor_b32 v74, s35, v46
    v_xor_b32 v75, s35, v47
    v_mfma_f32_16x16x32_bf16 v[88:91], v[8:11], v[48:51], v[88:91]
    s_waitcnt lgkmcnt(2)
    v_cmp_gt_u32 vcc, s40, v68
    s_add_u32 s49, s39, 2
    s_lshr_b32 s49, s49, 1
    v_xor_b32 v76, s35, v52
    v_xor_b32 v77, s35, v53
    v_mfma_f32_16x16x32_bf16 v[92:95], v[8:11], v[52:55], v[92:95]
    s_cbranch_vccnz K12_S6
K12_Q6:
    s_mul_i32 s48, s49, s50
    s_add_u32 s48, s48, s47
    v_xor_b32 v78, s35, v54
    v_xor_b32 v79, s35, v55
    v_mfma_f32_16x16x32_bf16 v[80:83], v[12:15], v[72:75], v[80:83]
    s_add_u32 m0, s29, s36
    s_nop 0
    buffer_load_dwordx4 v1, s[8:11], s30 offen sc1 lds
    v_mfma_f32_16x16x32_bf16 v[84:87], v[12:15], v[40:43], v[84:87]
    s_cmp_lt_u32 s49, 8
    s_cselect_b32 s48, s48, 155744
    v_mfma_f32_16x16x32_bf16 v[88:91], v[12:15], v[76:79], v[88:91]
    s_cmp_ge_u32 s49, 3
    s_cselect_b32 s48, s48, 155744
    v_mfma_f32_16x16x32_bf16 v[92:95], v[12:15], v[48:51], v[92:95]
    v_mfma_f32_16x16x32_bf16 v[96:99], v[16:19], v[40:43], v[96:99]
    ds_read_b128 v[8:11], v2 offset:8192
    v_mfma_f32_16x16x32_bf16 v[100:103], v[16:19], v[44:47], v[100:103]
    ds_read_b128 v[12:15], v3 offset:8192
    v_mfma_f32_16x16x32_bf16 v[104:107], v[16:19], v[48:51], v[104:107]
    buffer_load_dwordx4 v1, s[8:11], s30 offen offset:1024 sc1 lds
    v_mfma_f32_16x16x32_bf16 v[108:111], v[16:19], v[52:55], v[108:111]
    v_mfma_f32_16x16x32_bf16 v[96:99], v[20:23], v[72:75], v[96:99]
    v_mfma_f32_16x16x32_bf16 v[100:103], v[20:23], v[40:43], v[100:103]
    v_mfma_f32_16x16x32_bf16 v[104:107], v[20:23], v[76:79], v[104:107]
    buffer_load_dwordx4 v1, s[8:11], s30 offen offset:2048 sc1 lds
    v_mfma_f32_16x16x32_bf16 v[108:111], v[20:23], v[48:51], v[108:111]
    s_waitcnt lgkmcnt(2)
    v_mfma_f32_16x16x32_bf16 v[112:115], v[24:27], v[40:43], v[112:115]
    ds_read_b128 v[16:19], v2 offset:10240
    v_mfma_f32_16x16x32_bf16 v[116:119], v[24:27], v[44:47], v[116:119]
    ds_read_b128 v[20:23], v3 offset:10240
    v_mfma_f32_16x16x32_bf16 v[120:123], v[24:27], v[48:51], v[120:123]
    v_mfma_f32_16x16x32_bf16 v[124:127], v[24:27], v[52:55], v[124:127]
    v_mfma_f32_16x16x32_bf16 v[112:115], v[28:31], v[72:75], v[112:115]
    buffer_load_dwordx4 v1, s[8:11], s30 offen offset:3072 sc1 lds
    v_mfma_f32_16x16x32_bf16 v[116:119], v[28:31], v[40:43], v[116:119]
    v_mfma_f32_16x16x32_bf16 v[120:123], v[28:31], v[76:79], v[120:123]
    v_mfma_f32_16x16x32_bf16 v[124:127], v[28:31], v[48:51], v[124:127]
    v_mfma_f32_16x16x32_bf16 v[128:131], v[32:35], v[40:43], v[128:131]
    ds_read_b128 v[24:27], v2 offset:12288
    v_mfma_f32_16x16x32_bf16 v[132:135], v[32:35], v[44:47], v[132:135]
    ds_read_b128 v[28:31], v3 offset:12288
    v_mfma_f32_16x16x32_bf16 v[136:139], v[32:35], v[48:51], v[136:139]
    s_add_u32 m0, m0, 4096
    s_add_u32 s34, s30, 4096
    buffer_load_dwordx4 v1, s[8:11], s34 offen sc1 lds
    v_mfma_f32_16x16x32_bf16 v[140:143], v[32:35], v[52:55], v[140:143]
    v_mfma_f32_16x16x32_bf16 v[128:131], v[36:39], v[72:75], v[128:131]
    v_mfma_f32_16x16x32_bf16 v[132:135], v[36:39], v[40:43], v[132:135]
    v_mfma_f32_16x16x32_bf16 v[136:139], v[36:39], v[76:79], v[136:139]
    s_add_u32 m0, s29, s37
    s_add_u32 s30, s30, 21376
    buffer_load_dwordx4 v1, s[12:15], s31 offen sc1 lds
    v_mfma_f32_16x16x32_bf16 v[140:143], v[36:39], v[48:51], v[140:143]
    s_waitcnt lgkmcnt(4)
    v_mfma_f32_16x16x32_bf16 v[144:147], v[8:11], v[40:43], v[144:147]
    ds_read_b128 v[32:35], v2 offset:14336
    v_mfma_f32_16x16x32_bf16 v[148:151], v[8:11], v[44:47], v[148:151]
    ds_read_b128 v[36:39], v3 offset:14336
    v_mfma_f32_16x16x32_bf16 v[152:155], v[8:11], v[48:51], v[152:155]
    v_mfma_f32_16x16x32_bf16 v[156:159], v[8:11], v[52:55], v[156:159]
    s_add_u32 s40, s40, 1
    s_mov_b32 s51, s40
    v_mov_b32 v0, s40
    v_mfma_f32_16x16x32_bf16 v[144:147], v[12:15], v[72:75], v[144:147]
    s_waitcnt vmcnt(17)
    ds_write_b32 v7, v0
    buffer_load_dwordx4 v1, s[12:15], s31 offen offset:1024 sc1 lds
    v_mfma_f32_16x16x32_bf16 v[148:151], v[12:15], v[40:43], v[148:151]
    v_mfma_f32_16x16x32_bf16 v[152:155], v[12:15], v[76:79], v[152:155]
    v_mfma_f32_16x16x32_bf16 v[156:159], v[12:15], v[48:51], v[156:159]
    s_waitcnt lgkmcnt(5)
    v_mfma_f32_16x16x32_bf16 v[160:163], v[16:19], v[40:43], v[160:163]
    ds_read_b128 v[8:11], v2 offset:16384
    v_mfma_f32_16x16x32_bf16 v[164:167], v[16:19], v[44:47], v[164:167]
    ds_read_b128 v[12:15], v3 offset:16384
    v_mfma_f32_16x16x32_bf16 v[168:171], v[16:19], v[48:51], v[168:171]
    buffer_load_dwordx4 v1, s[12:15], s31 offen offset:2048 sc1 lds
    v_mfma_f32_16x16x32_bf16 v[172:175], v[16:19], v[52:55], v[172:175]
    v_mfma_f32_16x16x32_bf16 v[160:163], v[20:23], v[72:75], v[160:163]
    v_mfma_f32_16x16x32_bf16 v[164:167], v[20:23], v[40:43], v[164:167]
    v_mfma_f32_16x16x32_bf16 v[168:171], v[20:23], v[76:79], v[168:171]
    buffer_load_dwordx4 v1, s[12:15], s31 offen offset:3072 sc1 lds
    v_mfma_f32_16x16x32_bf16 v[172:175], v[20:23], v[48:51], v[172:175]
    s_waitcnt lgkmcnt(5)
    v_mfma_f32_16x16x32_bf16 v[176:179], v[24:27], v[40:43], v[176:179]
    ds_read_b128 v[16:19], v2 offset:18432
    v_mfma_f32_16x16x32_bf16 v[180:183], v[24:27], v[44:47], v[180:183]
    ds_read_b128 v[20:23], v3 offset:18432
    v_mov_b32 v0, s48
    v_mfma_f32_16x16x32_bf16 v[184:187], v[24:27], v[48:51], v[184:187]
    ds_read_b32 v0, v0
    v_mfma_f32_16x16x32_bf16 v[188:191], v[24:27], v[52:55], v[188:191]
    v_mfma_f32_16x16x32_bf16 v[176:179], v[28:31], v[72:75], v[176:179]
    s_add_u32 m0, s29, s38
    s_mov_b64 exec, s[44:45]
    buffer_load_dwordx4 v1, s[64:67], s33 offen sc1 lds
    s_mov_b64 exec, -1
    s_add_u32 s31, s31, 16384
    s_add_u32 s33, s33, 21376
    v_mfma_f32_16x16x32_bf16 v[180:183], v[28:31], v[40:43], v[180:183]
    v_mfma_f32_16x16x32_bf16 v[184:187], v[28:31], v[76:79], v[184:187]
    v_mfma_f32_16x16x32_bf16 v[188:191], v[28:31], v[48:51], v[188:191]
    s_waitcnt lgkmcnt(0)
    v_cmp_eq_u32 vcc, 0, v0
    v_mfma_f32_16x16x32_bf16 v[192:195], v[32:35], v[40:43], v[192:195]
    ds_read_b128 v[24:27], v2 offset:20480
    v_mfma_f32_16x16x32_bf16 v[196:199], v[32:35], v[44:47], v[196:199]
    ds_read_b128 v[28:31], v3 offset:20480
    s_cbranch_vccnz K12_F7
K12_G7:
    v_mfma_f32_16x16x32_bf16 v[200:203], v[32:35], v[48:51], v[200:203]
    s_sub_u32 s43, s42, s41
    s_add_u32 s40, s40, 1
    v_add_u32 v2, s43, v2
    v_mfma_f32_16x16x32_bf16 v[204:207], v[32:35], v[52:55], v[204:207]
    v_add_u32 v3, s43, v3
    v_add_u32 v4, s43, v4
    v_mov_b32 v0, s40
    v_mfma_f32_16x16x32_bf16 v[192:195], v[36:39], v[72:75], v[192:195]
    ds_write_b32 v7, v0
    v_mfma_f32_16x16x32_bf16 v[196:199], v[36:39], v[40:43], v[196:199]
    v_mfma_f32_16x16x32_bf16 v[200:203], v[36:39], v[76:79], v[200:203]
    v_mfma_f32_16x16x32_bf16 v[204:207], v[36:39], v[48:51], v[204:207]
    ds_read_b32 v56, v5
    v_mfma_f32_16x16x32_bf16 v[208:211], v[8:11], v[40:43], v[208:211]
    v_mfma_f32_16x16x32_bf16 v[212:215], v[8:11], v[44:47], v[212:215]
    v_mfma_f32_16x16x32_bf16 v[216:219], v[8:11], v[48:51], v[216:219]
    v_mfma_f32_16x16x32_bf16 v[220:223], v[8:11], v[52:55], v[220:223]
    s_waitcnt lgkmcnt(0)
    v_cmp_gt_u32 vcc, s51, v56
    v_mfma_f32_16x16x32_bf16 v[208:211], v[12:15], v[72:75], v[208:211]
    v_mfma_f32_16x16x32_bf16 v[212:215], v[12:15], v[40:43], v[212:215]
    s_cbranch_vccnz K12_S8
K12_Q8:
    v_mfma_f32_16x16x32_bf16 v[216:219], v[12:15], v[76:79], v[216:219]
    ds_read_b64_tr_b16 v[56:57], v4 offset:0
    v_mfma_f32_16x16x32_bf16 v[220:223], v[12:15], v[48:51], v[220:223]
    ds_read_b64_tr_b16 v[58:59], v4 offset:2048
    v_mfma_f32_16x16x32_bf16 v[224:227], v[16:19], v[40:43], v[224:227]
    ds_read_b64_tr_b16 v[60:61], v4 offset:256
    ds_read_b128 v[8:11], v2 offset:0
    v_mfma_f32_16x16x32_bf16 v[228:231], v[16:19], v[44:47], v[228:231]
    ds_read_b64_tr_b16 v[62:63], v4 offset:2304
    ds_read_b128 v[12:15], v3 offset:0
    v_mfma_f32_16x16x32_bf16 v[232:235], v[16:19], v[48:51], v[232:235]
    v_xor_b32 v4, 32, v4
    ds_read_b128 v[32:35], v2 offset:6144
    v_mfma_f32_16x16x32_bf16 v[236:239], v[16:19], v[52:55], v[236:239]
    ds_read_b64_tr_b16 v[64:65], v4 offset:0
    ds_read_b128 v[36:39], v3 offset:6144
    v_mfma_f32_16x16x32_bf16 v[224:227], v[20:23], v[72:75], v[224:227]
    ds_read_b64_tr_b16 v[66:67], v4 offset:2048
    ds_read_b32 v52, v5
    v_mfma_f32_16x16x32_bf16 v[228:231], v[20:23], v[40:43], v[228:231]
    ds_read_b64_tr_b16 v[68:69], v4 offset:256
    ds_read_b64_tr_b16 v[70:71], v4 offset:2304
    v_xor_b32 v4, 32, v4
    v_mfma_f32_16x16x32_bf16 v[232:235], v[20:23], v[76:79], v[232:235]
    v_mfma_f32_16x16x32_bf16 v[236:239], v[20:23], v[48:51], v[236:239]
    v_mfma_f32_16x16x32_bf16 v[240:243], v[24:27], v[40:43], v[240:243]
    ds_read_b128 v[16:19], v2 offset:2048
    v_mfma_f32_16x16x32_bf16 v[244:247], v[24:27], v[44:47], v[244:247]
    ds_read_b128 v[20:23], v3 offset:2048
    v_mfma_f32_16x16x32_bf16 v[240:243], v[28:31], v[72:75], v[240:243]
    s_mov_b32 s29, s41
    s_mov_b32 s41, s42
    s_add_u32 s42, s42, 38912
    v_mfma_f32_16x16x32_bf16 v[244:247], v[28:31], v[40:43], v[244:247]
    s_cmp_eq_u32 s42, 155648
    s_cselect_b32 s42, 0, s42
    s_waitcnt lgkmcnt(2)
    v_mfma_f32_16x16x32_bf16 v[80:83], v[8:11], v[56:59], v[80:83]
    ds_read_b128 v[24:27], v2 offset:4096
    v_xor_b32 v72, s35, v60
    v_xor_b32 v73, s35, v61
    v_mfma_f32_16x16x32_bf16 v[84:87], v[8:11], v[60:63], v[84:87]
    ds_read_b128 v[28:31], v3 offset:4096
    v_xor_b32 v74, s35, v62
    v_xor_b32 v75, s35, v63
    v_mfma_f32_16x16x32_bf16 v[88:91], v[8:11], v[64:67], v[88:91]
    v_xor_b32 v76, s35, v68
    v_xor_b32 v77, s35, v69
    v_mfma_f32_16x16x32_bf16 v[92:95], v[8:11], v[68:71], v[92:95]
    v_xor_b32 v78, s35, v70
    v_xor_b32 v79, s35, v71
    v_mfma_f32_16x16x32_bf16 v[80:83], v[12:15], v[72:75], v[80:83]
    v_lshrrev_b32 v0, 4, v1
    v_and_b32 v5, 15, v0
    v_mfma_f32_16x16x32_bf16 v[84:87], v[12:15], v[56:59], v[84:87]
    v_lshrrev_b32 v0, 4, v0
    s_lshl_b32 s28, s21, 7
    v_mfma_f32_16x16x32_bf16 v[88:91], v[12:15], v[76:79], v[88:91]
    s_lshl_b32 s29, s3, 5
    s_add_u32 s28, s28, s29
    v_mfma_f32_16x16x32_bf16 v[92:95], v[12:15], v[64:67], v[92:95]
    v_add_u32 v5, s28, v5
    v_lshlrev_b32 v5, 2, v5
    s_waitcnt lgkmcnt(2)
    v_mfma_f32_16x16x32_bf16 v[96:99], v[16:19], v[56:59], v[96:99]
    ds_read_b128 v[8:11], v2 offset:8192
    v_lshl_add_u32 v5, v0, 13, v5
    s_lshl_b32 s28, s20, 6
    v_mfma_f32_16x16x32_bf16 v[100:103], v[16:19], v[60:63], v[100:103]
    ds_read_b128 v[12:15], v3 offset:8192
    v_xor_b32 v5, s28, v5
    v_xor_b32 v7, 64, v5
    v_mfma_f32_16x16x32_bf16 v[104:107], v[16:19], v[64:67], v[104:107]
    v_mfma_f32_16x16x32_bf16 v[108:111], v[16:19], v[68:71], v[108:111]
    s_mov_b32 s38, 0
    v_cvt_pk_bf16_f32 v48, v80, v84
    buffer_store_dword v48, v5, s[16:19], s38 offen offset:0 sc1
    v_cvt_pk_bf16_f32 v49, v88, v92
    buffer_store_dword v49, v7, s[16:19], s38 offen offset:0 sc1
    v_mfma_f32_16x16x32_bf16 v[96:99], v[20:23], v[72:75], v[96:99]
    v_cvt_pk_bf16_f32 v50, v81, v85
    buffer_store_dword v50, v5, s[16:19], s38 offen offset:2048 sc1
    v_mfma_f32_16x16x32_bf16 v[100:103], v[20:23], v[56:59], v[100:103]
    v_cvt_pk_bf16_f32 v51, v89, v93
    buffer_store_dword v51, v7, s[16:19], s38 offen offset:2048 sc1
    v_mfma_f32_16x16x32_bf16 v[104:107], v[20:23], v[76:79], v[104:107]
    s_mov_b32 s38, 4096
    v_cvt_pk_bf16_f32 v52, v82, v86
    buffer_store_dword v52, v5, s[16:19], s38 offen offset:0 sc1
    v_cvt_pk_bf16_f32 v53, v90, v94
    buffer_store_dword v53, v7, s[16:19], s38 offen offset:0 sc1
    v_mfma_f32_16x16x32_bf16 v[108:111], v[20:23], v[64:67], v[108:111]
    v_cvt_pk_bf16_f32 v54, v83, v87
    buffer_store_dword v54, v5, s[16:19], s38 offen offset:2048 sc1
    s_waitcnt lgkmcnt(2)
    v_mfma_f32_16x16x32_bf16 v[112:115], v[24:27], v[56:59], v[112:115]
    ds_read_b128 v[16:19], v2 offset:10240
    v_cvt_pk_bf16_f32 v55, v91, v95
    buffer_store_dword v55, v7, s[16:19], s38 offen offset:2048 sc1
    v_mfma_f32_16x16x32_bf16 v[116:119], v[24:27], v[60:63], v[116:119]
    ds_read_b128 v[20:23], v3 offset:10240
    v_mfma_f32_16x16x32_bf16 v[120:123], v[24:27], v[64:67], v[120:123]
    v_mfma_f32_16x16x32_bf16 v[124:127], v[24:27], v[68:71], v[124:127]
    s_mov_b32 s38, 32768
    v_cvt_pk_bf16_f32 v40, v96, v100
    buffer_store_dword v40, v5, s[16:19], s38 offen offset:0 sc1
    v_cvt_pk_bf16_f32 v41, v104, v108
    buffer_store_dword v41, v7, s[16:19], s38 offen offset:0 sc1
    v_mfma_f32_16x16x32_bf16 v[112:115], v[28:31], v[72:75], v[112:115]
    v_cvt_pk_bf16_f32 v42, v97, v101
    buffer_store_dword v42, v5, s[16:19], s38 offen offset:2048 sc1
    v_mfma_f32_16x16x32_bf16 v[116:119], v[28:31], v[56:59], v[116:119]
    v_cvt_pk_bf16_f32 v43, v105, v109
    buffer_store_dword v43, v7, s[16:19], s38 offen offset:2048 sc1
    v_mfma_f32_16x16x32_bf16 v[120:123], v[28:31], v[76:79], v[120:123]
    s_mov_b32 s38, 36864
    v_cvt_pk_bf16_f32 v44, v98, v102
    buffer_store_dword v44, v5, s[16:19], s38 offen offset:0 sc1
    v_cvt_pk_bf16_f32 v45, v106, v110
    buffer_store_dword v45, v7, s[16:19], s38 offen offset:0 sc1
    v_mfma_f32_16x16x32_bf16 v[124:127], v[28:31], v[64:67], v[124:127]
    v_cvt_pk_bf16_f32 v46, v99, v103
    buffer_store_dword v46, v5, s[16:19], s38 offen offset:2048 sc1
    v_mfma_f32_16x16x32_bf16 v[128:131], v[32:35], v[56:59], v[128:131]
    ds_read_b128 v[24:27], v2 offset:12288
    v_cvt_pk_bf16_f32 v47, v107, v111
    buffer_store_dword v47, v7, s[16:19], s38 offen offset:2048 sc1
    v_mfma_f32_16x16x32_bf16 v[132:135], v[32:35], v[60:63], v[132:135]
    ds_read_b128 v[28:31], v3 offset:12288
    v_mfma_f32_16x16x32_bf16 v[136:139], v[32:35], v[64:67], v[136:139]
    v_mfma_f32_16x16x32_bf16 v[140:143], v[32:35], v[68:71], v[140:143]
    s_mov_b32 s38, 65536
    v_cvt_pk_bf16_f32 v48, v112, v116
    buffer_store_dword v48, v5, s[16:19], s38 offen offset:0 sc1
    v_cvt_pk_bf16_f32 v49, v120, v124
    buffer_store_dword v49, v7, s[16:19], s38 offen offset:0 sc1
    v_mfma_f32_16x16x32_bf16 v[128:131], v[36:39], v[72:75], v[128:131]
    v_cvt_pk_bf16_f32 v50, v113, v117
    buffer_store_dword v50, v5, s[16:19], s38 offen offset:2048 sc1
    v_mfma_f32_16x16x32_bf16 v[132:135], v[36:39], v[56:59], v[132:135]
    v_cvt_pk_bf16_f32 v51, v121, v125
    buffer_store_dword v51, v7, s[16:19], s38 offen offset:2048 sc1
    v_mfma_f32_16x16x32_bf16 v[136:139], v[36:39], v[76:79], v[136:139]
    s_mov_b32 s38, 69632
    v_cvt_pk_bf16_f32 v52, v114, v118
    buffer_store_dword v52, v5, s[16:19], s38 offen offset:0 sc1
    v_cvt_pk_bf16_f32 v53, v122, v126
    buffer_store_dword v53, v7, s[16:19], s38 offen offset:0 sc1
    v_mfma_f32_16x16x32_bf16 v[140:143], v[36:39], v[64:67], v[140:143]
    v_cvt_pk_bf16_f32 v54, v115, v119
    buffer_store_dword v54, v5, s[16:19], s38 offen offset:2048 sc1
    s_waitcnt lgkmcnt(4)
    v_mfma_f32_16x16x32_bf16 v[144:147], v[8:11], v[56:59], v[144:147]
    ds_read_b128 v[32:35], v2 offset:14336
    v_cvt_pk_bf16_f32 v55, v123, v127
    buffer_store_dword v55, v7, s[16:19], s38 offen offset:2048 sc1
    v_mfma_f32_16x16x32_bf16 v[148:151], v[8:11], v[60:63], v[148:151]
    ds_read_b128 v[36:39], v3 offset:14336
    v_mfma_f32_16x16x32_bf16 v[152:155], v[8:11], v[64:67], v[152:155]
    v_mfma_f32_16x16x32_bf16 v[156:159], v[8:11], v[68:71], v[156:159]
    s_mov_b32 s38, 98304
    v_cvt_pk_bf16_f32 v40, v128, v132
    buffer_store_dword v40, v5, s[16:19], s38 offen offset:0 sc1
    v_cvt_pk_bf16_f32 v41, v136, v140
    buffer_store_dword v41, v7, s[16:19], s38 offen offset:0 sc1
    v_mfma_f32_16x16x32_bf16 v[144:147], v[12:15], v[72:75], v[144:147]
    v_cvt_pk_bf16_f32 v42, v129, v133
    buffer_store_dword v42, v5, s[16:19], s38 offen offset:2048 sc1
    v_mfma_f32_16x16x32_bf16 v[148:151], v[12:15], v[56:59], v[148:151]
    v_cvt_pk_bf16_f32 v43, v137, v141
    buffer_store_dword v43, v7, s[16:19], s38 offen offset:2048 sc1
    v_mfma_f32_16x16x32_bf16 v[152:155], v[12:15], v[76:79], v[152:155]
    s_mov_b32 s38, 102400
    v_cvt_pk_bf16_f32 v44, v130, v134
    buffer_store_dword v44, v5, s[16:19], s38 offen offset:0 sc1
    v_cvt_pk_bf16_f32 v45, v138, v142
    buffer_store_dword v45, v7, s[16:19], s38 offen offset:0 sc1
    v_mfma_f32_16x16x32_bf16 v[156:159], v[12:15], v[64:67], v[156:159]
    v_cvt_pk_bf16_f32 v46, v131, v135
    buffer_store_dword v46, v5, s[16:19], s38 offen offset:2048 sc1
    s_waitcnt lgkmcnt(4)
    v_mfma_f32_16x16x32_bf16 v[160:163], v[16:19], v[56:59], v[160:163]
    ds_read_b128 v[8:11], v2 offset:16384
    v_cvt_pk_bf16_f32 v47, v139, v143
    buffer_store_dword v47, v7, s[16:19], s38 offen offset:2048 sc1
    v_mfma_f32_16x16x32_bf16 v[164:167], v[16:19], v[60:63], v[164:167]
    ds_read_b128 v[12:15], v3 offset:16384
    v_mfma_f32_16x16x32_bf16 v[168:171], v[16:19], v[64:67], v[168:171]
    v_mfma_f32_16x16x32_bf16 v[172:175], v[16:19], v[68:71], v[172:175]
    s_mov_b32 s38, 131072
    v_cvt_pk_bf16_f32 v48, v144, v148
    buffer_store_dword v48, v5, s[16:19], s38 offen offset:0 sc1
    v_cvt_pk_bf16_f32 v49, v152, v156
    buffer_store_dword v49, v7, s[16:19], s38 offen offset:0 sc1
    v_mfma_f32_16x16x32_bf16 v[160:163], v[20:23], v[72:75], v[160:163]
    v_cvt_pk_bf16_f32 v50, v145, v149
    buffer_store_dword v50, v5, s[16:19], s38 offen offset:2048 sc1
    v_mfma_f32_16x16x32_bf16 v[164:167], v[20:23], v[56:59], v[164:167]
    v_cvt_pk_bf16_f32 v51, v153, v157
    buffer_store_dword v51, v7, s[16:19], s38 offen offset:2048 sc1
    v_mfma_f32_16x16x32_bf16 v[168:171], v[20:23], v[76:79], v[168:171]
    s_mov_b32 s38, 135168
    v_cvt_pk_bf16_f32 v52, v146, v150
    buffer_store_dword v52, v5, s[16:19], s38 offen offset:0 sc1
    v_cvt_pk_bf16_f32 v53, v154, v158
    buffer_store_dword v53, v7, s[16:19], s38 offen offset:0 sc1
    v_mfma_f32_16x16x32_bf16 v[172:175], v[20:23], v[64:67], v[172:175]
    v_cvt_pk_bf16_f32 v54, v147, v151
    buffer_store_dword v54, v5, s[16:19], s38 offen offset:2048 sc1
    s_waitcnt lgkmcnt(4)
    v_mfma_f32_16x16x32_bf16 v[176:179], v[24:27], v[56:59], v[176:179]
    ds_read_b128 v[16:19], v2 offset:18432
    v_cvt_pk_bf16_f32 v55, v155, v159
    buffer_store_dword v55, v7, s[16:19], s38 offen offset:2048 sc1
    v_mfma_f32_16x16x32_bf16 v[180:183], v[24:27], v[60:63], v[180:183]
    ds_read_b128 v[20:23], v3 offset:18432
    v_mfma_f32_16x16x32_bf16 v[184:187], v[24:27], v[64:67], v[184:187]
    v_mfma_f32_16x16x32_bf16 v[188:191], v[24:27], v[68:71], v[188:191]
    s_mov_b32 s38, 163840
    v_cvt_pk_bf16_f32 v40, v160, v164
    buffer_store_dword v40, v5, s[16:19], s38 offen offset:0 sc1
    v_cvt_pk_bf16_f32 v41, v168, v172
    buffer_store_dword v41, v7, s[16:19], s38 offen offset:0 sc1
    v_mfma_f32_16x16x32_bf16 v[176:179], v[28:31], v[72:75], v[176:179]
    v_cvt_pk_bf16_f32 v42, v161, v165
    buffer_store_dword v42, v5, s[16:19], s38 offen offset:2048 sc1
    v_mfma_f32_16x16x32_bf16 v[180:183], v[28:31], v[56:59], v[180:183]
    v_cvt_pk_bf16_f32 v43, v169, v173
    buffer_store_dword v43, v7, s[16:19], s38 offen offset:2048 sc1
    v_mfma_f32_16x16x32_bf16 v[184:187], v[28:31], v[76:79], v[184:187]
    s_mov_b32 s38, 167936
    v_cvt_pk_bf16_f32 v44, v162, v166
    buffer_store_dword v44, v5, s[16:19], s38 offen offset:0 sc1
    v_cvt_pk_bf16_f32 v45, v170, v174
    buffer_store_dword v45, v7, s[16:19], s38 offen offset:0 sc1
    v_mfma_f32_16x16x32_bf16 v[188:191], v[28:31], v[64:67], v[188:191]
    v_cvt_pk_bf16_f32 v46, v163, v167
    buffer_store_dword v46, v5, s[16:19], s38 offen offset:2048 sc1
    s_waitcnt lgkmcnt(4)
    v_mfma_f32_16x16x32_bf16 v[192:195], v[32:35], v[56:59], v[192:195]
    ds_read_b128 v[24:27], v2 offset:20480
    v_cvt_pk_bf16_f32 v47, v171, v175
    buffer_store_dword v47, v7, s[16:19], s38 offen offset:2048 sc1
    v_mfma_f32_16x16x32_bf16 v[196:199], v[32:35], v[60:63], v[196:199]
    ds_read_b128 v[28:31], v3 offset:20480
    v_mfma_f32_16x16x32_bf16 v[200:203], v[32:35], v[64:67], v[200:203]
    v_mfma_f32_16x16x32_bf16 v[204:207], v[32:35], v[68:71], v[204:207]
    s_mov_b32 s38, 196608
    v_cvt_pk_bf16_f32 v48, v176, v180
    buffer_store_dword v48, v5, s[16:19], s38 offen offset:0 sc1
    v_cvt_pk_bf16_f32 v49, v184, v188
    buffer_store_dword v49, v7, s[16:19], s38 offen offset:0 sc1
    v_mfma_f32_16x16x32_bf16 v[192:195], v[36:39], v[72:75], v[192:195]
    v_cvt_pk_bf16_f32 v50, v177, v181
    buffer_store_dword v50, v5, s[16:19], s38 offen offset:2048 sc1
    v_mfma_f32_16x16x32_bf16 v[196:199], v[36:39], v[56:59], v[196:199]
    v_cvt_pk_bf16_f32 v51, v185, v189
    buffer_store_dword v51, v7, s[16:19], s38 offen offset:2048 sc1
    v_mfma_f32_16x16x32_bf16 v[200:203], v[36:39], v[76:79], v[200:203]
    s_mov_b32 s38, 200704
    v_cvt_pk_bf16_f32 v52, v178, v182
    buffer_store_dword v52, v5, s[16:19], s38 offen offset:0 sc1
    v_cvt_pk_bf16_f32 v53, v186, v190
    buffer_store_dword v53, v7, s[16:19], s38 offen offset:0 sc1
    v_mfma_f32_16x16x32_bf16 v[204:207], v[36:39], v[64:67], v[204:207]
    v_cvt_pk_bf16_f32 v54, v179, v183
    buffer_store_dword v54, v5, s[16:19], s38 offen offset:2048 sc1
    s_waitcnt lgkmcnt(4)
    v_mfma_f32_16x16x32_bf16 v[208:211], v[8:11], v[56:59], v[208:211]
    v_cvt_pk_bf16_f32 v55, v187, v191
    buffer_store_dword v55, v7, s[16:19], s38 offen offset:2048 sc1
    v_mfma_f32_16x16x32_bf16 v[212:215], v[8:11], v[60:63], v[212:215]
    v_mfma_f32_16x16x32_bf16 v[216:219], v[8:11], v[64:67], v[216:219]
    v_mfma_f32_16x16x32_bf16 v[220:223], v[8:11], v[68:71], v[220:223]
    s_mov_b32 s38, 229376
    v_cvt_pk_bf16_f32 v40, v192, v196
    buffer_store_dword v40, v5, s[16:19], s38 offen offset:0 sc1
    v_cvt_pk_bf16_f32 v41, v200, v204
    buffer_store_dword v41, v7, s[16:19], s38 offen offset:0 sc1
    v_mfma_f32_16x16x32_bf16 v[208:211], v[12:15], v[72:75], v[208:211]
    v_cvt_pk_bf16_f32 v42, v193, v197
    buffer_store_dword v42, v5, s[16:19], s38 offen offset:2048 sc1
    v_mfma_f32_16x16x32_bf16 v[212:215], v[12:15], v[56:59], v[212:215]
    v_cvt_pk_bf16_f32 v43, v201, v205
    buffer_store_dword v43, v7, s[16:19], s38 offen offset:2048 sc1
    v_mfma_f32_16x16x32_bf16 v[216:219], v[12:15], v[76:79], v[216:219]
    s_mov_b32 s38, 233472
    v_cvt_pk_bf16_f32 v44, v194, v198
    buffer_store_dword v44, v5, s[16:19], s38 offen offset:0 sc1
    v_cvt_pk_bf16_f32 v45, v202, v206
    buffer_store_dword v45, v7, s[16:19], s38 offen offset:0 sc1
    v_mfma_f32_16x16x32_bf16 v[220:223], v[12:15], v[64:67], v[220:223]
    v_cvt_pk_bf16_f32 v46, v195, v199
    buffer_store_dword v46, v5, s[16:19], s38 offen offset:2048 sc1
    s_waitcnt lgkmcnt(2)
    v_mfma_f32_16x16x32_bf16 v[224:227], v[16:19], v[56:59], v[224:227]
    v_cvt_pk_bf16_f32 v47, v203, v207
    buffer_store_dword v47, v7, s[16:19], s38 offen offset:2048 sc1
    v_mfma_f32_16x16x32_bf16 v[228:231], v[16:19], v[60:63], v[228:231]
    v_mfma_f32_16x16x32_bf16 v[232:235], v[16:19], v[64:67], v[232:235]
    v_mfma_f32_16x16x32_bf16 v[236:239], v[16:19], v[68:71], v[236:239]
    s_mov_b32 s38, 262144
    v_cvt_pk_bf16_f32 v48, v208, v212
    buffer_store_dword v48, v5, s[16:19], s38 offen offset:0 sc1
    v_cvt_pk_bf16_f32 v49, v216, v220
    buffer_store_dword v49, v7, s[16:19], s38 offen offset:0 sc1
    v_mfma_f32_16x16x32_bf16 v[224:227], v[20:23], v[72:75], v[224:227]
    v_cvt_pk_bf16_f32 v50, v209, v213
    buffer_store_dword v50, v5, s[16:19], s38 offen offset:2048 sc1
    v_mfma_f32_16x16x32_bf16 v[228:231], v[20:23], v[56:59], v[228:231]
    v_cvt_pk_bf16_f32 v51, v217, v221
    buffer_store_dword v51, v7, s[16:19], s38 offen offset:2048 sc1
    v_mfma_f32_16x16x32_bf16 v[232:235], v[20:23], v[76:79], v[232:235]
    s_mov_b32 s38, 266240
    v_cvt_pk_bf16_f32 v52, v210, v214
    buffer_store_dword v52, v5, s[16:19], s38 offen offset:0 sc1
    v_cvt_pk_bf16_f32 v53, v218, v222
    buffer_store_dword v53, v7, s[16:19], s38 offen offset:0 sc1
    v_mfma_f32_16x16x32_bf16 v[236:239], v[20:23], v[64:67], v[236:239]
    v_cvt_pk_bf16_f32 v54, v211, v215
    buffer_store_dword v54, v5, s[16:19], s38 offen offset:2048 sc1
    s_waitcnt lgkmcnt(0)
    v_mfma_f32_16x16x32_bf16 v[240:243], v[24:27], v[56:59], v[240:243]
    v_cvt_pk_bf16_f32 v55, v219, v223
    buffer_store_dword v55, v7, s[16:19], s38 offen offset:2048 sc1
    v_mfma_f32_16x16x32_bf16 v[244:247], v[24:27], v[60:63], v[244:247]
    v_mfma_f32_16x16x32_bf16 v[240:243], v[28:31], v[72:75], v[240:243]
    v_mfma_f32_16x16x32_bf16 v[244:247], v[28:31], v[56:59], v[244:247]
    s_mov_b32 s38, 294912
    v_cvt_pk_bf16_f32 v40, v224, v228
    buffer_store_dword v40, v5, s[16:19], s38 offen offset:0 sc1
    v_cvt_pk_bf16_f32 v41, v232, v236
    buffer_store_dword v41, v7, s[16:19], s38 offen offset:0 sc1
    v_cvt_pk_bf16_f32 v42, v225, v229
    buffer_store_dword v42, v5, s[16:19], s38 offen offset:2048 sc1
    v_cvt_pk_bf16_f32 v43, v233, v237
    buffer_store_dword v43, v7, s[16:19], s38 offen offset:2048 sc1
    s_mov_b32 s38, 299008
    v_cvt_pk_bf16_f32 v44, v226, v230
    buffer_store_dword v44, v5, s[16:19], s38 offen offset:0 sc1
    v_cvt_pk_bf16_f32 v45, v234, v238
    buffer_store_dword v45, v7, s[16:19], s38 offen offset:0 sc1
    v_cvt_pk_bf16_f32 v46, v227, v231
    buffer_store_dword v46, v5, s[16:19], s38 offen offset:2048 sc1
    v_cvt_pk_bf16_f32 v47, v235, v239
    buffer_store_dword v47, v7, s[16:19], s38 offen offset:2048 sc1
    s_nop 7
    s_lshl_b32 s34, s27, 1
    s_mul_i32 s34, s34, 342016
    s_add_u32 s34, s34, 118489088
    s_add_u32 s64, s58, s34
    s_addc_u32 s65, s59, 0
    s_and_b32 s65, s65, 0xffff
    s_mov_b32 s66, 684032
    s_mov_b32 s67, 0x00020000
    v_lshrrev_b32 v8, 8, v1
    v_lshlrev_b32 v9, 13, v8
    v_sub_u32 v9, v5, v9
    v_lshlrev_b32 v8, 2, v8
    v_add_u32 v8, 160, v8
    v_add_u32 v10, 0, v8
    v_add_u32 v11, 160, v10
    v_cmp_gt_u32 vcc, 167, v10
    s_nop 1
    v_cndmask_b32 v11, v11, v10, vcc
    v_cmp_gt_u32 vcc, 174, v10
    v_mov_b32 v12, 0x7ffff
    s_nop 0
    v_cndmask_b32 v11, v12, v11, vcc
    v_lshl_add_u32 v16, v11, 11, v9
    v_add_u32 v10, 1, v8
    v_add_u32 v11, 160, v10
    v_cmp_gt_u32 vcc, 167, v10
    s_nop 1
    v_cndmask_b32 v11, v11, v10, vcc
    v_cmp_gt_u32 vcc, 174, v10
    v_mov_b32 v12, 0x7ffff
    s_nop 0
    v_cndmask_b32 v11, v12, v11, vcc
    v_lshl_add_u32 v17, v11, 11, v9
    v_add_u32 v10, 2, v8
    v_add_u32 v11, 160, v10
    v_cmp_gt_u32 vcc, 167, v10
    s_nop 1
    v_cndmask_b32 v11, v11, v10, vcc
    v_cmp_gt_u32 vcc, 174, v10
    v_mov_b32 v12, 0x7ffff
    s_nop 0
    v_cndmask_b32 v11, v12, v11, vcc
    v_lshl_add_u32 v18, v11, 11, v9
    v_add_u32 v10, 3, v8
    v_add_u32 v11, 160, v10
    v_cmp_gt_u32 vcc, 167, v10
    s_nop 1
    v_cndmask_b32 v11, v11, v10, vcc
    v_cmp_gt_u32 vcc, 174, v10
    v_mov_b32 v12, 0x7ffff
    s_nop 0
    v_cndmask_b32 v11, v12, v11, vcc
    v_lshl_add_u32 v19, v11, 11, v9
    v_cvt_pk_bf16_f32 v20, v240, v244
    buffer_store_dword v20, v16, s[64:67], 0 offen sc1
    v_cvt_pk_bf16_f32 v21, v241, v245
    buffer_store_dword v21, v17, s[64:67], 0 offen sc1
    v_cvt_pk_bf16_f32 v22, v242, v246
    buffer_store_dword v22, v18, s[64:67], 0 offen sc1
    v_cvt_pk_bf16_f32 v23, v243, v247
    buffer_store_dword v23, v19, s[64:67], 0 offen sc1
    s_endpgm
K12_S0:
    s_mov_b32 s61, 16384
    s_add_u32 s62, s62, 1
K12_S0_L:
    ds_read_b32 v56, v5
    s_waitcnt lgkmcnt(0)
    v_cmp_gt_u32 vcc, s40, v56
    s_sub_u32 s61, s61, 1
    s_cmp_eq_u32 s61, 0
    s_cbranch_scc1 K12_Q0
    s_cbranch_vccz K12_Q0
    s_branch K12_S0_L
K12_S1:
    s_mov_b32 s61, 16384
    s_add_u32 s62, s62, 1
K12_S1_L:
    ds_read_b32 v68, v5
    s_waitcnt lgkmcnt(0)
    v_cmp_gt_u32 vcc, s40, v68
    s_sub_u32 s61, s61, 1
    s_cmp_eq_u32 s61, 0
    s_cbranch_scc1 K12_Q1
    s_cbranch_vccz K12_Q1
    s_branch K12_S1_L
K12_F2:
    s_mov_b32 s61, 16384
    s_add_u32 s63, s63, 1
K12_F2_L:
    s_mov_b32 m0, s46
    s_mov_b64 exec, 0xff
    buffer_load_dword v1, s[4:7], 0 offen sc1 lds
    s_mov_b64 exec, -1
    s_waitcnt vmcnt(0)
    v_mov_b32 v0, s48
    ds_read_b32 v0, v0
    s_waitcnt lgkmcnt(0)
    v_cmp_eq_u32 vcc, 0, v0
    s_sub_u32 s61, s61, 1
    s_cmp_eq_u32 s61, 0
    s_cbranch_scc1 K12_F2_X
    s_cbranch_vccz K12_F2_X
    s_sleep 2
    s_branch K12_F2_L
K12_F2_X:
    s_branch K12_G2
K12_S3:
    s_mov_b32 s61, 16384
    s_add_u32 s62, s62, 1
K12_S3_L:
    ds_read_b32 v56, v5
    s_waitcnt lgkmcnt(0)
    v_cmp_gt_u32 vcc, s51, v56
    s_sub_u32 s61, s61, 1
    s_cmp_eq_u32 s61, 0
    s_cbranch_scc1 K12_Q3
    s_cbranch_vccz K12_Q3
    s_branch K12_S3_L
K12_S4:
    s_mov_b32 s61, 16384
    s_add_u32 s62, s62, 1
K12_S4_L:
    ds_read_b32 v52, v5
    s_waitcnt lgkmcnt(0)
    v_cmp_gt_u32 vcc, s40, v52
    s_sub_u32 s61, s61, 1
    s_cmp_eq_u32 s61, 0
    s_cbranch_scc1 K12_Q4
    s_cbranch_vccz K12_Q4
    s_branch K12_S4_L
K12_S5:
    s_mov_b32 s61, 16384
    s_add_u32 s62, s62, 1
K12_S5_L:
    ds_read_b32 v40, v5
    s_waitcnt lgkmcnt(0)
    v_cmp_gt_u32 vcc, s51, v40
    s_sub_u32 s61, s61, 1
    s_cmp_eq_u32 s61, 0
    s_cbranch_scc1 K12_Q5
    s_cbranch_vccz K12_Q5
    s_branch K12_S5_L
K12_S6:
    s_mov_b32 s61, 16384
    s_add_u32 s62, s62, 1
K12_S6_L:
    ds_read_b32 v68, v5
    s_waitcnt lgkmcnt(0)
    v_cmp_gt_u32 vcc, s40, v68
    s_sub_u32 s61, s61, 1
    s_cmp_eq_u32 s61, 0
    s_cbranch_scc1 K12_Q6
    s_cbranch_vccz K12_Q6
    s_branch K12_S6_L
K12_F7:
    s_mov_b32 s61, 16384
    s_add_u32 s63, s63, 1
K12_F7_L:
    s_mov_b32 m0, s46
    s_mov_b64 exec, 0xff
    buffer_load_dword v1, s[4:7], 0 offen sc1 lds
    s_mov_b64 exec, -1
    s_waitcnt vmcnt(0)
    v_mov_b32 v0, s48
    ds_read_b32 v0, v0
    s_waitcnt lgkmcnt(0)
    v_cmp_eq_u32 vcc, 0, v0
    s_sub_u32 s61, s61, 1
    s_cmp_eq_u32 s61, 0
    s_cbranch_scc1 K12_F7_X
    s_cbranch_vccz K12_F7_X
    s_sleep 2
    s_branch K12_F7_L
K12_F7_X:
    s_branch K12_G7
K12_S8:
    s_mov_b32 s61, 16384
    s_add_u32 s62, s62, 1
K12_S8_L:
    ds_read_b32 v56, v5
    s_waitcnt lgkmcnt(0)
    v_cmp_gt_u32 vcc, s51, v56
    s_sub_u32 s61, s61, 1
    s_cmp_eq_u32 s61, 0
    s_cbranch_scc1 K12_Q8
    s_cbranch_vccz K12_Q8
    s_branch K12_S8_L
K12_END:
    s_endpgm
.p2align 8
.type k34_out_kernel,@function
k34_out_kernel:
    s_cmp_ge_u32 s2, 256
    s_cbranch_scc1 K34_END
    s_load_dwordx2 s[4:5], s[0:1], 48
    s_load_dwordx4 s[40:43], s[0:1], 16
    s_load_dwordx2 s[44:45], s[0:1], 32
    v_lshrrev_b32 v1, 6, v0
    v_and_b32 v2, 63, v0
    v_readfirstlane_b32 s3, v1
    s_and_b32 s6, s2, 15
    s_lshr_b32 s7, s2, 4
    s_lshr_b32 s20, s6, 3
    s_and_b32 s21, s6, 7
    s_mul_i32 s22, s7, 11
    s_mul_i32 s23, s7, 10
    s_add_u32 s23, s23, 7
    s_cmp_lt_u32 s7, 7
    s_cselect_b32 s22, s22, s23
    s_cselect_b32 s23, 11, 10
    s_add_u32 s22, s22, s3
    v_and_b32 v3, 15, v2
    v_lshrrev_b32 v4, 4, v2
    v_lshlrev_b32 v5, 4, v2
    s_mov_b32 s24, 2736128
    v_mul_lo_u32 v6, v4, s24
    v_lshl_add_u32 v6, v3, 4, v6
    s_mul_i32 s25, s20, 167
    s_add_u32 s25, s25, s22
    s_lshl_b32 s25, s25, 11
    s_lshl_b32 s24, s21, 8
    s_add_u32 s25, s25, s24
    s_waitcnt lgkmcnt(0)
    s_add_u32 s8, s4, 118489088
    s_addc_u32 s9, s5, 0
    s_and_b32 s9, s9, 0xffff
    s_mov_b32 s10, 21889024
    s_mov_b32 s11, 0x00020000
    s_add_u32 s12, s4, 153616384
    s_addc_u32 s13, s5, 0
    s_and_b32 s13, s13, 0xffff
    s_mov_b32 s14, 131072
    s_mov_b32 s15, 0x00020000
    s_cmp_lt_u32 s3, s23
    s_cbranch_scc0 K34_NOLOAD
    buffer_load_dwordx4 v[16:19], v6, s[8:11], s25 offen
    s_add_u32 s25, s25, 684032
    buffer_load_dwordx4 v[20:23], v6, s[8:11], s25 offen
    s_add_u32 s25, s25, 684032
    buffer_load_dwordx4 v[24:27], v6, s[8:11], s25 offen
    s_add_u32 s25, s25, 684032
    buffer_load_dwordx4 v[28:31], v6, s[8:11], s25 offen
    s_add_u32 s25, s25, 8892416
    buffer_load_dwordx4 v[32:35], v6, s[8:11], s25 offen
    s_add_u32 s25, s25, 684032
    buffer_load_dwordx4 v[36:39], v6, s[8:11], s25 offen
    s_add_u32 s25, s25, 684032
    buffer_load_dwordx4 v[40:43], v6, s[8:11], s25 offen
    s_add_u32 s25, s25, 684032
    buffer_load_dwordx4 v[44:47], v6, s[8:11], s25 offen
K34_NOLOAD:
    s_cmp_lg_u32 s3, 0
    s_cbranch_scc1 K34_TAB
    s_mov_b32 s16, s40
    s_mov_b32 s17, s41
    s_and_b32 s17, s17, 0xffff
    s_mov_b32 s18, 1024
    s_mov_b32 s19, 0x00020000
    s_mov_b32 s28, s42
    s_mov_b32 s29, s43
    s_and_b32 s29, s29, 0xffff
    s_mov_b32 s30, 1024
    s_mov_b32 s31, 0x00020000
    s_lshl_b32 s24, s21, 7
    v_lshlrev_b32 v8, 1, v2
    buffer_load_ushort v152, v8, s[16:19], s24 offen
    buffer_load_ushort v153, v8, s[28:31], s24 offen
    s_branch K34_TABDONE
K34_TAB:
    s_cmp_ge_u32 s3, 7
    s_cbranch_scc1 K34_TABDONE
    s_sub_u32 s27, s3, 1
    s_lshr_b32 s28, s27, 1
    s_and_b32 s29, s27, 1
    s_lshl_b32 s30, s28, 4
    v_add_u32 v8, s30, v3
    s_lshl_b32 s30, s29, 5
    s_add_u32 s30, s30, 1
    v_lshlrev_b32 v9, 3, v4
    v_add_u32 v9, s30, v9
    v_mul_u32_u24 v9, v8, v9
    v_lshlrev_b32 v8, 1, v8
    v_mad_u32_u24 v48, v8, 0, v9
    v_mad_u32_u24 v49, v8, 0, v9
    v_add_u32 v49, 32, v49
    v_mad_u32_u24 v50, v8, 1, v9
    v_mad_u32_u24 v51, v8, 1, v9
    v_add_u32 v51, 32, v51
    v_mad_u32_u24 v52, v8, 2, v9
    v_mad_u32_u24 v53, v8, 2, v9
    v_add_u32 v53, 32, v53
    v_mad_u32_u24 v54, v8, 3, v9
    v_mad_u32_u24 v55, v8, 3, v9
    v_add_u32 v55, 32, v55
    v_and_b32 v48, 127, v48
    v_and_b32 v49, 127, v49
    v_and_b32 v50, 127, v50
    v_and_b32 v51, 127, v51
    v_and_b32 v52, 127, v52
    v_and_b32 v53, 127, v53
    v_and_b32 v54, 127, v54
    v_and_b32 v55, 127, v55
    v_cvt_f32_u32 v48, v48
    v_cvt_f32_u32 v49, v49
    v_cvt_f32_u32 v50, v50
    v_cvt_f32_u32 v51, v51
    v_cvt_f32_u32 v52, v52
    v_cvt_f32_u32 v53, v53
    v_cvt_f32_u32 v54, v54
    v_cvt_f32_u32 v55, v55
    v_mul_f32 v48, 0x3c000000, v48
    v_mul_f32 v49, 0x3c000000, v49
    v_mul_f32 v50, 0x3c000000, v50
    v_mul_f32 v51, 0x3c000000, v51
    v_mul_f32 v52, 0x3c000000, v52
    v_mul_f32 v53, 0x3c000000, v53
    v_mul_f32 v54, 0x3c000000, v54
    v_mul_f32 v55, 0x3c000000, v55
    v_cos_f32 v48, v48
    v_cos_f32 v49, v49
    v_cos_f32 v50, v50
    v_cos_f32 v51, v51
    v_cos_f32 v52, v52
    v_cos_f32 v53, v53
    v_cos_f32 v54, v54
    v_cos_f32 v55, v55
    s_nop 0
    v_mul_f32 v48, 0x3d000000, v48
    v_mul_f32 v49, 0x3d000000, v49
    v_mul_f32 v50, 0x3d000000, v50
    v_mul_f32 v51, 0x3d000000, v51
    v_mul_f32 v52, 0x3d000000, v52
    v_mul_f32 v53, 0x3d000000, v53
    v_mul_f32 v54, 0x3d000000, v54
    v_mul_f32 v55, 0x3d000000, v55
    v_cvt_pk_bf16_f32 v56, v48, v49
    v_cvt_pk_bf16_f32 v57, v50, v51
    v_cvt_pk_bf16_f32 v58, v52, v53
    v_cvt_pk_bf16_f32 v59, v54, v55
    v_lshlrev_b32 v64, 16, v56
    v_and_b32 v65, 0xffff0000, v56
    v_sub_f32 v48, v48, v64
    v_sub_f32 v49, v49, v65
    v_lshlrev_b32 v64, 16, v57
    v_and_b32 v65, 0xffff0000, v57
    v_sub_f32 v50, v50, v64
    v_sub_f32 v51, v51, v65
    v_lshlrev_b32 v64, 16, v58
    v_and_b32 v65, 0xffff0000, v58
    v_sub_f32 v52, v52, v64
    v_sub_f32 v53, v53, v65
    v_lshlrev_b32 v64, 16, v59
    v_and_b32 v65, 0xffff0000, v59
    v_sub_f32 v54, v54, v64
    v_sub_f32 v55, v55, v65
    v_cvt_pk_bf16_f32 v60, v48, v49
    v_cvt_pk_bf16_f32 v61, v50, v51
    v_cvt_pk_bf16_f32 v62, v52, v53
    v_cvt_pk_bf16_f32 v63, v54, v55
    s_lshl_b32 s30, s27, 11
    v_add_u32 v10, s30, v5
    ds_write_b128 v10, v[56:59]
    ds_write_b128 v10, v[60:63] offset:1024
K34_TABDONE:
    s_waitcnt lgkmcnt(0)
    s_barrier
    s_cmp_lt_u32 s3, s23
    s_cbranch_scc0 K34_IDLE
    ds_read_b128 v[48:51], v5 offset:0
    ds_read_b128 v[52:55], v5 offset:1024
    ds_read_b128 v[56:59], v5 offset:2048
    ds_read_b128 v[60:63], v5 offset:3072
    ds_read_b128 v[64:67], v5 offset:4096
    ds_read_b128 v[68:71], v5 offset:5120
    ds_read_b128 v[72:75], v5 offset:6144
    ds_read_b128 v[76:79], v5 offset:7168
    ds_read_b128 v[80:83], v5 offset:8192
    ds_read_b128 v[84:87], v5 offset:9216
    ds_read_b128 v[88:91], v5 offset:10240
    ds_read_b128 v[92:95], v5 offset:11264
    s_waitcnt vmcnt(0)
    v_swap_b32 v17, v20
    v_swap_b32 v18, v24
    v_swap_b32 v19, v28
    v_swap_b32 v22, v25
    v_swap_b32 v23, v29
    v_swap_b32 v27, v30
    v_swap_b32 v33, v36
    v_swap_b32 v34, v40
    v_swap_b32 v35, v44
    v_swap_b32 v38, v41
    v_swap_b32 v39, v45
    v_swap_b32 v43, v46
    s_waitcnt lgkmcnt(0)
    s_mul_i32 s24, s22, 48
    s_sub_u32 s24, 7985, s24
    s_cmp_ge_u32 s24, 48
    s_cbranch_scc1 K34_FULL
    v_add_u32 v7, 0, v3
    v_cmp_gt_u32 vcc, s24, v7
    s_nop 1
    v_cndmask_b32 v48, 0, v48, vcc
    v_cndmask_b32 v49, 0, v49, vcc
    v_cndmask_b32 v50, 0, v50, vcc
    v_cndmask_b32 v51, 0, v51, vcc
    v_cndmask_b32 v52, 0, v52, vcc
    v_cndmask_b32 v53, 0, v53, vcc
    v_cndmask_b32 v54, 0, v54, vcc
    v_cndmask_b32 v55, 0, v55, vcc
    v_cndmask_b32 v56, 0, v56, vcc
    v_cndmask_b32 v57, 0, v57, vcc
    v_cndmask_b32 v58, 0, v58, vcc
    v_cndmask_b32 v59, 0, v59, vcc
    v_cndmask_b32 v60, 0, v60, vcc
    v_cndmask_b32 v61, 0, v61, vcc
    v_cndmask_b32 v62, 0, v62, vcc
    v_cndmask_b32 v63, 0, v63, vcc
    v_add_u32 v7, 16, v3
    v_cmp_gt_u32 vcc, s24, v7
    s_nop 1
    v_cndmask_b32 v64, 0, v64, vcc
    v_cndmask_b32 v65, 0, v65, vcc
    v_cndmask_b32 v66, 0, v66, vcc
    v_cndmask_b32 v67, 0, v67, vcc
    v_cndmask_b32 v68, 0, v68, vcc
    v_cndmask_b32 v69, 0, v69, vcc
    v_cndmask_b32 v70, 0, v70, vcc
    v_cndmask_b32 v71, 0, v71, vcc
    v_cndmask_b32 v72, 0, v72, vcc
    v_cndmask_b32 v73, 0, v73, vcc
    v_cndmask_b32 v74, 0, v74, vcc
    v_cndmask_b32 v75, 0, v75, vcc
    v_cndmask_b32 v76, 0, v76, vcc
    v_cndmask_b32 v77, 0, v77, vcc
    v_cndmask_b32 v78, 0, v78, vcc
    v_cndmask_b32 v79, 0, v79, vcc
    v_add_u32 v7, 32, v3
    v_cmp_gt_u32 vcc, s24, v7
    s_nop 1
    v_cndmask_b32 v80, 0, v80, vcc
    v_cndmask_b32 v81, 0, v81, vcc
    v_cndmask_b32 v82, 0, v82, vcc
    v_cndmask_b32 v83, 0, v83, vcc
    v_cndmask_b32 v84, 0, v84, vcc
    v_cndmask_b32 v85, 0, v85, vcc
    v_cndmask_b32 v86, 0, v86, vcc
    v_cndmask_b32 v87, 0, v87, vcc
    v_cndmask_b32 v88, 0, v88, vcc
    v_cndmask_b32 v89, 0, v89, vcc
    v_cndmask_b32 v90, 0, v90, vcc
    v_cndmask_b32 v91, 0, v91, vcc
    v_cndmask_b32 v92, 0, v92, vcc
    v_cndmask_b32 v93, 0, v93, vcc
    v_cndmask_b32 v94, 0, v94, vcc
    v_cndmask_b32 v95, 0, v95, vcc
K34_FULL:
    s_nop 1
    v_mfma_f32_16x16x32_bf16 v[96:99], v[48:51], v[16:19], 0
    v_mfma_f32_16x16x32_bf16 v[100:103], v[48:51], v[20:23], 0
    v_mfma_f32_16x16x32_bf16 v[104:107], v[48:51], v[24:27], 0
    v_mfma_f32_16x16x32_bf16 v[108:111], v[48:51], v[28:31], 0
    v_mfma_f32_16x16x32_bf16 v[96:99], v[52:55], v[16:19], v[96:99]
    v_mfma_f32_16x16x32_bf16 v[100:103], v[52:55], v[20:23], v[100:103]
    v_mfma_f32_16x16x32_bf16 v[104:107], v[52:55], v[24:27], v[104:107]
    v_mfma_f32_16x16x32_bf16 v[108:111], v[52:55], v[28:31], v[108:111]
    v_mfma_f32_16x16x32_bf16 v[96:99], v[56:59], v[32:35], v[96:99]
    v_mfma_f32_16x16x32_bf16 v[100:103], v[56:59], v[36:39], v[100:103]
    v_mfma_f32_16x16x32_bf16 v[104:107], v[56:59], v[40:43], v[104:107]
    v_mfma_f32_16x16x32_bf16 v[108:111], v[56:59], v[44:47], v[108:111]
    v_mfma_f32_16x16x32_bf16 v[96:99], v[60:63], v[32:35], v[96:99]
    v_mfma_f32_16x16x32_bf16 v[100:103], v[60:63], v[36:39], v[100:103]
    v_mfma_f32_16x16x32_bf16 v[104:107], v[60:63], v[40:43], v[104:107]
    v_mfma_f32_16x16x32_bf16 v[108:111], v[60:63], v[44:47], v[108:111]
    v_mfma_f32_16x16x32_bf16 v[112:115], v[64:67], v[16:19], 0
    v_mfma_f32_16x16x32_bf16 v[116:119], v[64:67], v[20:23], 0
    v_mfma_f32_16x16x32_bf16 v[120:123], v[64:67], v[24:27], 0
    v_mfma_f32_16x16x32_bf16 v[124:127], v[64:67], v[28:31], 0
    v_mfma_f32_16x16x32_bf16 v[112:115], v[68:71], v[16:19], v[112:115]
    v_mfma_f32_16x16x32_bf16 v[116:119], v[68:71], v[20:23], v[116:119]
    v_mfma_f32_16x16x32_bf16 v[120:123], v[68:71], v[24:27], v[120:123]
    v_mfma_f32_16x16x32_bf16 v[124:127], v[68:71], v[28:31], v[124:127]
    v_mfma_f32_16x16x32_bf16 v[112:115], v[72:75], v[32:35], v[112:115]
    v_mfma_f32_16x16x32_bf16 v[116:119], v[72:75], v[36:39], v[116:119]
    v_mfma_f32_16x16x32_bf16 v[120:123], v[72:75], v[40:43], v[120:123]
    v_mfma_f32_16x16x32_bf16 v[124:127], v[72:75], v[44:47], v[124:127]
    v_mfma_f32_16x16x32_bf16 v[112:115], v[76:79], v[32:35], v[112:115]
    v_mfma_f32_16x16x32_bf16 v[116:119], v[76:79], v[36:39], v[116:119]
    v_mfma_f32_16x16x32_bf16 v[120:123], v[76:79], v[40:43], v[120:123]
    v_mfma_f32_16x16x32_bf16 v[124:127], v[76:79], v[44:47], v[124:127]
    v_mfma_f32_16x16x32_bf16 v[128:131], v[80:83], v[16:19], 0
    v_mfma_f32_16x16x32_bf16 v[132:135], v[80:83], v[20:23], 0
    v_mfma_f32_16x16x32_bf16 v[136:139], v[80:83], v[24:27], 0
    v_mfma_f32_16x16x32_bf16 v[140:143], v[80:83], v[28:31], 0
    v_mfma_f32_16x16x32_bf16 v[128:131], v[84:87], v[16:19], v[128:131]
    v_mfma_f32_16x16x32_bf16 v[132:135], v[84:87], v[20:23], v[132:135]
    v_mfma_f32_16x16x32_bf16 v[136:139], v[84:87], v[24:27], v[136:139]
    v_mfma_f32_16x16x32_bf16 v[140:143], v[84:87], v[28:31], v[140:143]
    v_mfma_f32_16x16x32_bf16 v[128:131], v[88:91], v[32:35], v[128:131]
    v_mfma_f32_16x16x32_bf16 v[132:135], v[88:91], v[36:39], v[132:135]
    v_mfma_f32_16x16x32_bf16 v[136:139], v[88:91], v[40:43], v[136:139]
    v_mfma_f32_16x16x32_bf16 v[140:143], v[88:91], v[44:47], v[140:143]
    v_mfma_f32_16x16x32_bf16 v[128:131], v[92:95], v[32:35], v[128:131]
    v_mfma_f32_16x16x32_bf16 v[132:135], v[92:95], v[36:39], v[132:135]
    v_mfma_f32_16x16x32_bf16 v[136:139], v[92:95], v[40:43], v[136:139]
    v_mfma_f32_16x16x32_bf16 v[140:143], v[92:95], v[44:47], v[140:143]
    s_nop 7
    v_mov_b32 v16, v96
    v_mul_f32 v20, v96, v96
    v_mov_b32 v17, v100
    v_mul_f32 v21, v100, v100
    v_mov_b32 v18, v104
    v_mul_f32 v22, v104, v104
    v_mov_b32 v19, v108
    v_mul_f32 v23, v108, v108
    v_add_f32 v16, v16, v97
    v_fmac_f32 v20, v97, v97
    v_add_f32 v17, v17, v101
    v_fmac_f32 v21, v101, v101
    v_add_f32 v18, v18, v105
    v_fmac_f32 v22, v105, v105
    v_add_f32 v19, v19, v109
    v_fmac_f32 v23, v109, v109
    v_add_f32 v16, v16, v98
    v_fmac_f32 v20, v98, v98
    v_add_f32 v17, v17, v102
    v_fmac_f32 v21, v102, v102
    v_add_f32 v18, v18, v106
    v_fmac_f32 v22, v106, v106
    v_add_f32 v19, v19, v110
    v_fmac_f32 v23, v110, v110
    v_add_f32 v16, v16, v99
    v_fmac_f32 v20, v99, v99
    v_add_f32 v17, v17, v103
    v_fmac_f32 v21, v103, v103
    v_add_f32 v18, v18, v107
    v_fmac_f32 v22, v107, v107
    v_add_f32 v19, v19, v111
    v_fmac_f32 v23, v111, v111
    v_add_f32 v16, v16, v112
    v_fmac_f32 v20, v112, v112
    v_add_f32 v17, v17, v116
    v_fmac_f32 v21, v116, v116
    v_add_f32 v18, v18, v120
    v_fmac_f32 v22, v120, v120
    v_add_f32 v19, v19, v124
    v_fmac_f32 v23, v124, v124
    v_add_f32 v16, v16, v113
    v_fmac_f32 v20, v113, v113
    v_add_f32 v17, v17, v117
    v_fmac_f32 v21, v117, v117
    v_add_f32 v18, v18, v121
    v_fmac_f32 v22, v121, v121
    v_add_f32 v19, v19, v125
    v_fmac_f32 v23, v125, v125
    v_add_f32 v16, v16, v114
    v_fmac_f32 v20, v114, v114
    v_add_f32 v17, v17, v118
    v_fmac_f32 v21, v118, v118
    v_add_f32 v18, v18, v122
    v_fmac_f32 v22, v122, v122
    v_add_f32 v19, v19, v126
    v_fmac_f32 v23, v126, v126
    v_add_f32 v16, v16, v115
    v_fmac_f32 v20, v115, v115
    v_add_f32 v17, v17, v119
    v_fmac_f32 v21, v119, v119
    v_add_f32 v18, v18, v123
    v_fmac_f32 v22, v123, v123
    v_add_f32 v19, v19, v127
    v_fmac_f32 v23, v127, v127
    v_add_f32 v16, v16, v128
    v_fmac_f32 v20, v128, v128
    v_add_f32 v17, v17, v132
    v_fmac_f32 v21, v132, v132
    v_add_f32 v18, v18, v136
    v_fmac_f32 v22, v136, v136
    v_add_f32 v19, v19, v140
    v_fmac_f32 v23, v140, v140
    v_add_f32 v16, v16, v129
    v_fmac_f32 v20, v129, v129
    v_add_f32 v17, v17, v133
    v_fmac_f32 v21, v133, v133
    v_add_f32 v18, v18, v137
    v_fmac_f32 v22, v137, v137
    v_add_f32 v19, v19, v141
    v_fmac_f32 v23, v141, v141
    v_add_f32 v16, v16, v130
    v_fmac_f32 v20, v130, v130
    v_add_f32 v17, v17, v134
    v_fmac_f32 v21, v134, v134
    v_add_f32 v18, v18, v138
    v_fmac_f32 v22, v138, v138
    v_add_f32 v19, v19, v142
    v_fmac_f32 v23, v142, v142
    v_add_f32 v16, v16, v131
    v_fmac_f32 v20, v131, v131
    v_add_f32 v17, v17, v135
    v_fmac_f32 v21, v135, v135
    v_add_f32 v18, v18, v139
    v_fmac_f32 v22, v139, v139
    v_add_f32 v19, v19, v143
    v_fmac_f32 v23, v143, v143
    v_mov_b32 v24, v16
    v_mov_b32 v25, v17
    v_mov_b32 v26, v18
    v_mov_b32 v27, v19
    v_mov_b32 v28, v20
    v_mov_b32 v29, v21
    v_mov_b32 v30, v22
    v_mov_b32 v31, v23
    s_nop 0
    v_permlane32_swap_b32 v16, v24
    v_permlane32_swap_b32 v17, v25
    v_permlane32_swap_b32 v18, v26
    v_permlane32_swap_b32 v19, v27
    v_permlane32_swap_b32 v20, v28
    v_permlane32_swap_b32 v21, v29
    v_permlane32_swap_b32 v22, v30
    v_permlane32_swap_b32 v23, v31
    v_add_f32 v16, v16, v24
    v_add_f32 v17, v17, v25
    v_add_f32 v18, v18, v26
    v_add_f32 v19, v19, v27
    v_add_f32 v20, v20, v28
    v_add_f32 v21, v21, v29
    v_add_f32 v22, v22, v30
    v_add_f32 v23, v23, v31
    v_mov_b32 v24, v16
    v_mov_b32 v25, v17
    v_mov_b32 v26, v18
    v_mov_b32 v27, v19
    v_mov_b32 v28, v20
    v_mov_b32 v29, v21
    v_mov_b32 v30, v22
    v_mov_b32 v31, v23
    s_nop 0
    v_permlane16_swap_b32 v16, v24
    v_permlane16_swap_b32 v17, v25
    v_permlane16_swap_b32 v18, v26
    v_permlane16_swap_b32 v19, v27
    v_permlane16_swap_b32 v20, v28
    v_permlane16_swap_b32 v21, v29
    v_permlane16_swap_b32 v22, v30
    v_permlane16_swap_b32 v23, v31
    v_add_f32 v16, v16, v24
    v_add_f32 v17, v17, v25
    v_add_f32 v18, v18, v26
    v_add_f32 v19, v19, v27
    v_add_f32 v20, v20, v28
    v_add_f32 v21, v21, v29
    v_add_f32 v22, v22, v30
    v_add_f32 v23, v23, v31
    s_branch K34_WR
K34_IDLE:
    v_mov_b32 v16, 0
    v_mov_b32 v17, 0
    v_mov_b32 v18, 0
    v_mov_b32 v19, 0
    v_mov_b32 v20, 0
    v_mov_b32 v21, 0
    v_mov_b32 v22, 0
    v_mov_b32 v23, 0
K34_WR:
    s_lshl_b32 s24, s3, 9
    v_lshlrev_b32 v7, 4, v3
    v_add_u32 v7, s24, v7
    ds_write_b128 v7, v[16:19] offset:12288
    ds_write_b128 v7, v[20:23] offset:12544
    s_waitcnt lgkmcnt(0)
    s_barrier
    s_cmp_lg_u32 s3, 0
    s_cbranch_scc1 K34_WAIT
    v_lshlrev_b32 v7, 2, v2
    ds_read_b32 v16, v7 offset:12288
    ds_read_b32 v17, v7 offset:12800
    ds_read_b32 v18, v7 offset:13312
    ds_read_b32 v19, v7 offset:13824
    ds_read_b32 v20, v7 offset:14336
    ds_read_b32 v21, v7 offset:14848
    ds_read_b32 v22, v7 offset:15360
    ds_read_b32 v23, v7 offset:15872
    ds_read_b32 v24, v7 offset:16384
    ds_read_b32 v25, v7 offset:16896
    ds_read_b32 v26, v7 offset:17408
    ds_read_b32 v27, v7 offset:17920
    s_waitcnt lgkmcnt(0)
    ds_read_b32 v32, v7 offset:12544
    ds_read_b32 v33, v7 offset:13056
    ds_read_b32 v34, v7 offset:13568
    ds_read_b32 v35, v7 offset:14080
    ds_read_b32 v36, v7 offset:14592
    ds_read_b32 v37, v7 offset:15104
    ds_read_b32 v38, v7 offset:15616
    ds_read_b32 v39, v7 offset:16128
    ds_read_b32 v40, v7 offset:16640
    ds_read_b32 v41, v7 offset:17152
    ds_read_b32 v42, v7 offset:17664
    ds_read_b32 v43, v7 offset:18176
    v_add_f32 v16, v16, v17
    v_add_f32 v16, v16, v18
    v_add_f32 v16, v16, v19
    v_add_f32 v16, v16, v20
    v_add_f32 v16, v16, v21
    v_add_f32 v16, v16, v22
    v_add_f32 v16, v16, v23
    v_add_f32 v16, v16, v24
    v_add_f32 v16, v16, v25
    v_add_f32 v16, v16, v26
    v_add_f32 v16, v16, v27
    s_waitcnt lgkmcnt(0)
    v_add_f32 v32, v32, v33
    v_add_f32 v32, v32, v34
    v_add_f32 v32, v32, v35
    v_add_f32 v32, v32, v36
    v_add_f32 v32, v32, v37
    v_add_f32 v32, v32, v38
    v_add_f32 v32, v32, v39
    v_add_f32 v32, v32, v40
    v_add_f32 v32, v32, v41
    v_add_f32 v32, v32, v42
    v_add_f32 v32, v32, v43
    s_lshl_b32 s24, s6, 4
    s_add_u32 s24, s24, s7
    s_lshl_b32 s24, s24, 9
    buffer_store_dword v16, v7, s[12:15], s24 offen sc1
    buffer_store_dword v32, v7, s[12:15], s24 offen offset:256 sc1
    s_mov_b32 s26, 20000
K34_POLL:
    s_lshl_b32 s24, s6, 13
    buffer_load_dword v16, v7, s[12:15], s24 offen offset:0 sc1
    buffer_load_dword v32, v7, s[12:15], s24 offen offset:256 sc1
    buffer_load_dword v17, v7, s[12:15], s24 offen offset:512 sc1
    buffer_load_dword v33, v7, s[12:15], s24 offen offset:768 sc1
    buffer_load_dword v18, v7, s[12:15], s24 offen offset:1024 sc1
    buffer_load_dword v34, v7, s[12:15], s24 offen offset:1280 sc1
    buffer_load_dword v19, v7, s[12:15], s24 offen offset:1536 sc1
    buffer_load_dword v35, v7, s[12:15], s24 offen offset:1792 sc1
    buffer_load_dword v20, v7, s[12:15], s24 offen offset:2048 sc1
    buffer_load_dword v36, v7, s[12:15], s24 offen offset:2304 sc1
    buffer_load_dword v21, v7, s[12:15], s24 offen offset:2560 sc1
    buffer_load_dword v37, v7, s[12:15], s24 offen offset:2816 sc1
    buffer_load_dword v22, v7, s[12:15], s24 offen offset:3072 sc1
    buffer_load_dword v38, v7, s[12:15], s24 offen offset:3328 sc1
    buffer_load_dword v23, v7, s[12:15], s24 offen offset:3584 sc1
    buffer_load_dword v39, v7, s[12:15], s24 offen offset:3840 sc1
    s_add_u32 s24, s24, 4096
    buffer_load_dword v24, v7, s[12:15], s24 offen offset:0 sc1
    buffer_load_dword v40, v7, s[12:15], s24 offen offset:256 sc1
    buffer_load_dword v25, v7, s[12:15], s24 offen offset:512 sc1
    buffer_load_dword v41, v7, s[12:15], s24 offen offset:768 sc1
    buffer_load_dword v26, v7, s[12:15], s24 offen offset:1024 sc1
    buffer_load_dword v42, v7, s[12:15], s24 offen offset:1280 sc1
    buffer_load_dword v27, v7, s[12:15], s24 offen offset:1536 sc1
    buffer_load_dword v43, v7, s[12:15], s24 offen offset:1792 sc1
    buffer_load_dword v28, v7, s[12:15], s24 offen offset:2048 sc1
    buffer_load_dword v44, v7, s[12:15], s24 offen offset:2304 sc1
    buffer_load_dword v29, v7, s[12:15], s24 offen offset:2560 sc1
    buffer_load_dword v45, v7, s[12:15], s24 offen offset:2816 sc1
    buffer_load_dword v30, v7, s[12:15], s24 offen offset:3072 sc1
    buffer_load_dword v46, v7, s[12:15], s24 offen offset:3328 sc1
    buffer_load_dword v31, v7, s[12:15], s24 offen offset:3584 sc1
    buffer_load_dword v47, v7, s[12:15], s24 offen offset:3840 sc1
    s_waitcnt vmcnt(0)
    v_max3_u32 v48, v16, v17, v18
    v_max3_u32 v48, v48, v19, v20
    v_max3_u32 v48, v48, v21, v22
    v_max3_u32 v48, v48, v23, v24
    v_max3_u32 v48, v48, v25, v26
    v_max3_u32 v48, v48, v27, v28
    v_max3_u32 v48, v48, v29, v30
    v_max3_u32 v48, v48, v31, v32
    v_max3_u32 v48, v48, v33, v34
    v_max3_u32 v48, v48, v35, v36
    v_max3_u32 v48, v48, v37, v38
    v_max3_u32 v48, v48, v39, v40
    v_max3_u32 v48, v48, v41, v42
    v_max3_u32 v48, v48, v43, v44
    v_max3_u32 v48, v48, v45, v46
    v_max_u32 v48, v48, v47
    v_cmp_eq_u32 vcc, -1, v48
    s_sub_u32 s26, s26, 1
    s_cmp_eq_u32 s26, 0
    s_cbranch_scc1 K34_GOT
    s_cbranch_vccz K34_GOT
    s_sleep 1
    s_branch K34_POLL
K34_GOT:
    v_add_f32 v16, v16, v24
    v_add_f32 v32, v32, v40
    v_add_f32 v17, v17, v25
    v_add_f32 v33, v33, v41
    v_add_f32 v18, v18, v26
    v_add_f32 v34, v34, v42
    v_add_f32 v19, v19, v27
    v_add_f32 v35, v35, v43
    v_add_f32 v20, v20, v28
    v_add_f32 v36, v36, v44
    v_add_f32 v21, v21, v29
    v_add_f32 v37, v37, v45
    v_add_f32 v22, v22, v30
    v_add_f32 v38, v38, v46
    v_add_f32 v23, v23, v31
    v_add_f32 v39, v39, v47
    v_add_f32 v16, v16, v20
    v_add_f32 v32, v32, v36
    v_add_f32 v17, v17, v21
    v_add_f32 v33, v33, v37
    v_add_f32 v18, v18, v22
    v_add_f32 v34, v34, v38
    v_add_f32 v19, v19, v23
    v_add_f32 v35, v35, v39
    v_add_f32 v16, v16, v18
    v_add_f32 v32, v32, v34
    v_add_f32 v17, v17, v19
    v_add_f32 v33, v33, v35
    v_add_f32 v16, v16, v17
    v_add_f32 v32, v32, v33
    v_mul_f32 v11, 0x39035177, v16
    v_mul_f32 v12, 0x39035177, v32
    v_fma_f32 v12, -v11, v11, v12
    v_max_f32 v12, 0, v12
    v_add_f32 v12, 0x3727c5ac, v12
    v_sqrt_f32 v12, v12
    v_lshlrev_b32 v9, 16, v152
    v_rcp_f32 v12, v12
    v_lshlrev_b32 v10, 16, v153
    v_mul_f32 v9, v9, v12
    v_fma_f32 v10, -v11, v9, v10
    ds_write_b32 v7, v9 offset:18432
    ds_write_b32 v7, v10 offset:18688
    s_waitcnt lgkmcnt(0)
K34_WAIT:
    s_barrier
    s_cmp_lt_u32 s3, s23
    s_cbranch_scc0 K34_END
    v_lshlrev_b32 v7, 4, v3
    ds_read_b128 v[144:147], v7 offset:18432
    ds_read_b128 v[148:151], v7 offset:18688
    s_mul_i32 s24, s20, 8176640
    s_add_u32 s16, s44, s24
    s_addc_u32 s17, s45, 0
    s_and_b32 s17, s17, 0xffff
    s_mov_b32 s18, 8176640
    s_mov_b32 s19, 0x00020000
    v_lshlrev_b32 v7, 12, v4
    v_lshl_add_u32 v7, v3, 3, v7
    s_lshl_b32 s24, s21, 7
    v_add_u32 v7, s24, v7
    s_mul_i32 s25, s22, 49152
    s_mov_b32 s30, 0xc0135761
    s_mov_b32 s31, 0xbdd2d3e8
    v_mov_b32 v15, s30
    s_waitcnt lgkmcnt(0)
    v_fma_f32 v16, v96, v144, v148
    v_fma_f32 v17, v100, v145, v149
    v_fma_f32 v18, v104, v146, v150
    v_fma_f32 v19, v108, v147, v151
    v_fma_f32 v20, v97, v144, v148
    v_fma_f32 v21, v101, v145, v149
    v_fma_f32 v22, v105, v146, v150
    v_fma_f32 v23, v109, v147, v151
    v_mul_f32 v24, v16, v16
    v_mul_f32 v25, v17, v17
    v_mul_f32 v26, v18, v18
    v_mul_f32 v27, v19, v19
    v_mul_f32 v28, v20, v20
    v_mul_f32 v29, v21, v21
    v_mul_f32 v30, v22, v22
    v_mul_f32 v31, v23, v23
    v_fma_f32 v24, v24, s31, v15
    v_fma_f32 v25, v25, s31, v15
    v_fma_f32 v26, v26, s31, v15
    v_fma_f32 v27, v27, s31, v15
    v_fma_f32 v28, v28, s31, v15
    v_fma_f32 v29, v29, s31, v15
    v_fma_f32 v30, v30, s31, v15
    v_fma_f32 v31, v31, s31, v15
    v_mul_f32 v24, v24, v16
    v_mul_f32 v25, v25, v17
    v_mul_f32 v26, v26, v18
    v_mul_f32 v27, v27, v19
    v_mul_f32 v28, v28, v20
    v_mul_f32 v29, v29, v21
    v_mul_f32 v30, v30, v22
    v_mul_f32 v31, v31, v23
    v_exp_f32 v24, v24
    v_exp_f32 v25, v25
    v_exp_f32 v26, v26
    v_exp_f32 v27, v27
    v_exp_f32 v28, v28
    v_exp_f32 v29, v29
    v_exp_f32 v30, v30
    v_exp_f32 v31, v31
    v_add_f32 v24, 1.0, v24
    v_add_f32 v25, 1.0, v25
    v_add_f32 v26, 1.0, v26
    v_add_f32 v27, 1.0, v27
    v_add_f32 v28, 1.0, v28
    v_add_f32 v29, 1.0, v29
    v_add_f32 v30, 1.0, v30
    v_add_f32 v31, 1.0, v31
    v_rcp_f32 v24, v24
    v_rcp_f32 v25, v25
    v_rcp_f32 v26, v26
    v_rcp_f32 v27, v27
    v_rcp_f32 v28, v28
    v_rcp_f32 v29, v29
    v_rcp_f32 v30, v30
    v_rcp_f32 v31, v31
    v_mul_f32 v16, v16, v24
    v_mul_f32 v17, v17, v25
    v_mul_f32 v18, v18, v26
    v_mul_f32 v19, v19, v27
    v_mul_f32 v20, v20, v28
    v_mul_f32 v21, v21, v29
    v_mul_f32 v22, v22, v30
    v_mul_f32 v23, v23, v31
    v_cvt_pk_bf16_f32 v32, v16, v17
    v_cvt_pk_bf16_f32 v33, v18, v19
    buffer_store_dwordx2 v[32:33], v7, s[16:19], s25 offen offset:0 sc1
    v_cvt_pk_bf16_f32 v34, v20, v21
    v_cvt_pk_bf16_f32 v35, v22, v23
    buffer_store_dwordx2 v[34:35], v7, s[16:19], s25 offen offset:1024 sc1
    s_add_u32 s25, s25, 2048
    v_fma_f32 v36, v98, v144, v148
    v_fma_f32 v37, v102, v145, v149
    v_fma_f32 v38, v106, v146, v150
    v_fma_f32 v39, v110, v147, v151
    v_fma_f32 v40, v99, v144, v148
    v_fma_f32 v41, v103, v145, v149
    v_fma_f32 v42, v107, v146, v150
    v_fma_f32 v43, v111, v147, v151
    v_mul_f32 v44, v36, v36
    v_mul_f32 v45, v37, v37
    v_mul_f32 v46, v38, v38
    v_mul_f32 v47, v39, v39
    v_mul_f32 v48, v40, v40
    v_mul_f32 v49, v41, v41
    v_mul_f32 v50, v42, v42
    v_mul_f32 v51, v43, v43
    v_fma_f32 v44, v44, s31, v15
    v_fma_f32 v45, v45, s31, v15
    v_fma_f32 v46, v46, s31, v15
    v_fma_f32 v47, v47, s31, v15
    v_fma_f32 v48, v48, s31, v15
    v_fma_f32 v49, v49, s31, v15
    v_fma_f32 v50, v50, s31, v15
    v_fma_f32 v51, v51, s31, v15
    v_mul_f32 v44, v44, v36
    v_mul_f32 v45, v45, v37
    v_mul_f32 v46, v46, v38
    v_mul_f32 v47, v47, v39
    v_mul_f32 v48, v48, v40
    v_mul_f32 v49, v49, v41
    v_mul_f32 v50, v50, v42
    v_mul_f32 v51, v51, v43
    v_exp_f32 v44, v44
    v_exp_f32 v45, v45
    v_exp_f32 v46, v46
    v_exp_f32 v47, v47
    v_exp_f32 v48, v48
    v_exp_f32 v49, v49
    v_exp_f32 v50, v50
    v_exp_f32 v51, v51
    v_add_f32 v44, 1.0, v44
    v_add_f32 v45, 1.0, v45
    v_add_f32 v46, 1.0, v46
    v_add_f32 v47, 1.0, v47
    v_add_f32 v48, 1.0, v48
    v_add_f32 v49, 1.0, v49
    v_add_f32 v50, 1.0, v50
    v_add_f32 v51, 1.0, v51
    v_rcp_f32 v44, v44
    v_rcp_f32 v45, v45
    v_rcp_f32 v46, v46
    v_rcp_f32 v47, v47
    v_rcp_f32 v48, v48
    v_rcp_f32 v49, v49
    v_rcp_f32 v50, v50
    v_rcp_f32 v51, v51
    v_mul_f32 v36, v36, v44
    v_mul_f32 v37, v37, v45
    v_mul_f32 v38, v38, v46
    v_mul_f32 v39, v39, v47
    v_mul_f32 v40, v40, v48
    v_mul_f32 v41, v41, v49
    v_mul_f32 v42, v42, v50
    v_mul_f32 v43, v43, v51
    v_cvt_pk_bf16_f32 v52, v36, v37
    v_cvt_pk_bf16_f32 v53, v38, v39
    buffer_store_dwordx2 v[52:53], v7, s[16:19], s25 offen offset:0 sc1
    v_cvt_pk_bf16_f32 v54, v40, v41
    v_cvt_pk_bf16_f32 v55, v42, v43
    buffer_store_dwordx2 v[54:55], v7, s[16:19], s25 offen offset:1024 sc1
    s_add_u32 s25, s25, 2048
    s_add_u32 s25, s25, 12288
    v_fma_f32 v16, v112, v144, v148
    v_fma_f32 v17, v116, v145, v149
    v_fma_f32 v18, v120, v146, v150
    v_fma_f32 v19, v124, v147, v151
    v_fma_f32 v20, v113, v144, v148
    v_fma_f32 v21, v117, v145, v149
    v_fma_f32 v22, v121, v146, v150
    v_fma_f32 v23, v125, v147, v151
    v_mul_f32 v24, v16, v16
    v_mul_f32 v25, v17, v17
    v_mul_f32 v26, v18, v18
    v_mul_f32 v27, v19, v19
    v_mul_f32 v28, v20, v20
    v_mul_f32 v29, v21, v21
    v_mul_f32 v30, v22, v22
    v_mul_f32 v31, v23, v23
    v_fma_f32 v24, v24, s31, v15
    v_fma_f32 v25, v25, s31, v15
    v_fma_f32 v26, v26, s31, v15
    v_fma_f32 v27, v27, s31, v15
    v_fma_f32 v28, v28, s31, v15
    v_fma_f32 v29, v29, s31, v15
    v_fma_f32 v30, v30, s31, v15
    v_fma_f32 v31, v31, s31, v15
    v_mul_f32 v24, v24, v16
    v_mul_f32 v25, v25, v17
    v_mul_f32 v26, v26, v18
    v_mul_f32 v27, v27, v19
    v_mul_f32 v28, v28, v20
    v_mul_f32 v29, v29, v21
    v_mul_f32 v30, v30, v22
    v_mul_f32 v31, v31, v23
    v_exp_f32 v24, v24
    v_exp_f32 v25, v25
    v_exp_f32 v26, v26
    v_exp_f32 v27, v27
    v_exp_f32 v28, v28
    v_exp_f32 v29, v29
    v_exp_f32 v30, v30
    v_exp_f32 v31, v31
    v_add_f32 v24, 1.0, v24
    v_add_f32 v25, 1.0, v25
    v_add_f32 v26, 1.0, v26
    v_add_f32 v27, 1.0, v27
    v_add_f32 v28, 1.0, v28
    v_add_f32 v29, 1.0, v29
    v_add_f32 v30, 1.0, v30
    v_add_f32 v31, 1.0, v31
    v_rcp_f32 v24, v24
    v_rcp_f32 v25, v25
    v_rcp_f32 v26, v26
    v_rcp_f32 v27, v27
    v_rcp_f32 v28, v28
    v_rcp_f32 v29, v29
    v_rcp_f32 v30, v30
    v_rcp_f32 v31, v31
    v_mul_f32 v16, v16, v24
    v_mul_f32 v17, v17, v25
    v_mul_f32 v18, v18, v26
    v_mul_f32 v19, v19, v27
    v_mul_f32 v20, v20, v28
    v_mul_f32 v21, v21, v29
    v_mul_f32 v22, v22, v30
    v_mul_f32 v23, v23, v31
    v_cvt_pk_bf16_f32 v32, v16, v17
    v_cvt_pk_bf16_f32 v33, v18, v19
    buffer_store_dwordx2 v[32:33], v7, s[16:19], s25 offen offset:0 sc1
    v_cvt_pk_bf16_f32 v34, v20, v21
    v_cvt_pk_bf16_f32 v35, v22, v23
    buffer_store_dwordx2 v[34:35], v7, s[16:19], s25 offen offset:1024 sc1
    s_add_u32 s25, s25, 2048
    v_fma_f32 v36, v114, v144, v148
    v_fma_f32 v37, v118, v145, v149
    v_fma_f32 v38, v122, v146, v150
    v_fma_f32 v39, v126, v147, v151
    v_fma_f32 v40, v115, v144, v148
    v_fma_f32 v41, v119, v145, v149
    v_fma_f32 v42, v123, v146, v150
    v_fma_f32 v43, v127, v147, v151
    v_mul_f32 v44, v36, v36
    v_mul_f32 v45, v37, v37
    v_mul_f32 v46, v38, v38
    v_mul_f32 v47, v39, v39
    v_mul_f32 v48, v40, v40
    v_mul_f32 v49, v41, v41
    v_mul_f32 v50, v42, v42
    v_mul_f32 v51, v43, v43
    v_fma_f32 v44, v44, s31, v15
    v_fma_f32 v45, v45, s31, v15
    v_fma_f32 v46, v46, s31, v15
    v_fma_f32 v47, v47, s31, v15
    v_fma_f32 v48, v48, s31, v15
    v_fma_f32 v49, v49, s31, v15
    v_fma_f32 v50, v50, s31, v15
    v_fma_f32 v51, v51, s31, v15
    v_mul_f32 v44, v44, v36
    v_mul_f32 v45, v45, v37
    v_mul_f32 v46, v46, v38
    v_mul_f32 v47, v47, v39
    v_mul_f32 v48, v48, v40
    v_mul_f32 v49, v49, v41
    v_mul_f32 v50, v50, v42
    v_mul_f32 v51, v51, v43
    v_exp_f32 v44, v44
    v_exp_f32 v45, v45
    v_exp_f32 v46, v46
    v_exp_f32 v47, v47
    v_exp_f32 v48, v48
    v_exp_f32 v49, v49
    v_exp_f32 v50, v50
    v_exp_f32 v51, v51
    v_add_f32 v44, 1.0, v44
    v_add_f32 v45, 1.0, v45
    v_add_f32 v46, 1.0, v46
    v_add_f32 v47, 1.0, v47
    v_add_f32 v48, 1.0, v48
    v_add_f32 v49, 1.0, v49
    v_add_f32 v50, 1.0, v50
    v_add_f32 v51, 1.0, v51
    v_rcp_f32 v44, v44
    v_rcp_f32 v45, v45
    v_rcp_f32 v46, v46
    v_rcp_f32 v47, v47
    v_rcp_f32 v48, v48
    v_rcp_f32 v49, v49
    v_rcp_f32 v50, v50
    v_rcp_f32 v51, v51
    v_mul_f32 v36, v36, v44
    v_mul_f32 v37, v37, v45
    v_mul_f32 v38, v38, v46
    v_mul_f32 v39, v39, v47
    v_mul_f32 v40, v40, v48
    v_mul_f32 v41, v41, v49
    v_mul_f32 v42, v42, v50
    v_mul_f32 v43, v43, v51
    v_cvt_pk_bf16_f32 v52, v36, v37
    v_cvt_pk_bf16_f32 v53, v38, v39
    buffer_store_dwordx2 v[52:53], v7, s[16:19], s25 offen offset:0 sc1
    v_cvt_pk_bf16_f32 v54, v40, v41
    v_cvt_pk_bf16_f32 v55, v42, v43
    buffer_store_dwordx2 v[54:55], v7, s[16:19], s25 offen offset:1024 sc1
    s_add_u32 s25, s25, 2048
    s_add_u32 s25, s25, 12288
    v_fma_f32 v16, v128, v144, v148
    v_fma_f32 v17, v132, v145, v149
    v_fma_f32 v18, v136, v146, v150
    v_fma_f32 v19, v140, v147, v151
    v_fma_f32 v20, v129, v144, v148
    v_fma_f32 v21, v133, v145, v149
    v_fma_f32 v22, v137, v146, v150
    v_fma_f32 v23, v141, v147, v151
    v_mul_f32 v24, v16, v16
    v_mul_f32 v25, v17, v17
    v_mul_f32 v26, v18, v18
    v_mul_f32 v27, v19, v19
    v_mul_f32 v28, v20, v20
    v_mul_f32 v29, v21, v21
    v_mul_f32 v30, v22, v22
    v_mul_f32 v31, v23, v23
    v_fma_f32 v24, v24, s31, v15
    v_fma_f32 v25, v25, s31, v15
    v_fma_f32 v26, v26, s31, v15
    v_fma_f32 v27, v27, s31, v15
    v_fma_f32 v28, v28, s31, v15
    v_fma_f32 v29, v29, s31, v15
    v_fma_f32 v30, v30, s31, v15
    v_fma_f32 v31, v31, s31, v15
    v_mul_f32 v24, v24, v16
    v_mul_f32 v25, v25, v17
    v_mul_f32 v26, v26, v18
    v_mul_f32 v27, v27, v19
    v_mul_f32 v28, v28, v20
    v_mul_f32 v29, v29, v21
    v_mul_f32 v30, v30, v22
    v_mul_f32 v31, v31, v23
    v_exp_f32 v24, v24
    v_exp_f32 v25, v25
    v_exp_f32 v26, v26
    v_exp_f32 v27, v27
    v_exp_f32 v28, v28
    v_exp_f32 v29, v29
    v_exp_f32 v30, v30
    v_exp_f32 v31, v31
    v_add_f32 v24, 1.0, v24
    v_add_f32 v25, 1.0, v25
    v_add_f32 v26, 1.0, v26
    v_add_f32 v27, 1.0, v27
    v_add_f32 v28, 1.0, v28
    v_add_f32 v29, 1.0, v29
    v_add_f32 v30, 1.0, v30
    v_add_f32 v31, 1.0, v31
    v_rcp_f32 v24, v24
    v_rcp_f32 v25, v25
    v_rcp_f32 v26, v26
    v_rcp_f32 v27, v27
    v_rcp_f32 v28, v28
    v_rcp_f32 v29, v29
    v_rcp_f32 v30, v30
    v_rcp_f32 v31, v31
    v_mul_f32 v16, v16, v24
    v_mul_f32 v17, v17, v25
    v_mul_f32 v18, v18, v26
    v_mul_f32 v19, v19, v27
    v_mul_f32 v20, v20, v28
    v_mul_f32 v21, v21, v29
    v_mul_f32 v22, v22, v30
    v_mul_f32 v23, v23, v31
    v_cvt_pk_bf16_f32 v32, v16, v17
    v_cvt_pk_bf16_f32 v33, v18, v19
    buffer_store_dwordx2 v[32:33], v7, s[16:19], s25 offen offset:0 sc1
    v_cvt_pk_bf16_f32 v34, v20, v21
    v_cvt_pk_bf16_f32 v35, v22, v23
    buffer_store_dwordx2 v[34:35], v7, s[16:19], s25 offen offset:1024 sc1
    s_add_u32 s25, s25, 2048
    v_fma_f32 v36, v130, v144, v148
    v_fma_f32 v37, v134, v145, v149
    v_fma_f32 v38, v138, v146, v150
    v_fma_f32 v39, v142, v147, v151
    v_fma_f32 v40, v131, v144, v148
    v_fma_f32 v41, v135, v145, v149
    v_fma_f32 v42, v139, v146, v150
    v_fma_f32 v43, v143, v147, v151
    v_mul_f32 v44, v36, v36
    v_mul_f32 v45, v37, v37
    v_mul_f32 v46, v38, v38
    v_mul_f32 v47, v39, v39
    v_mul_f32 v48, v40, v40
    v_mul_f32 v49, v41, v41
    v_mul_f32 v50, v42, v42
    v_mul_f32 v51, v43, v43
    v_fma_f32 v44, v44, s31, v15
    v_fma_f32 v45, v45, s31, v15
    v_fma_f32 v46, v46, s31, v15
    v_fma_f32 v47, v47, s31, v15
    v_fma_f32 v48, v48, s31, v15
    v_fma_f32 v49, v49, s31, v15
    v_fma_f32 v50, v50, s31, v15
    v_fma_f32 v51, v51, s31, v15
    v_mul_f32 v44, v44, v36
    v_mul_f32 v45, v45, v37
    v_mul_f32 v46, v46, v38
    v_mul_f32 v47, v47, v39
    v_mul_f32 v48, v48, v40
    v_mul_f32 v49, v49, v41
    v_mul_f32 v50, v50, v42
    v_mul_f32 v51, v51, v43
    v_exp_f32 v44, v44
    v_exp_f32 v45, v45
    v_exp_f32 v46, v46
    v_exp_f32 v47, v47
    v_exp_f32 v48, v48
    v_exp_f32 v49, v49
    v_exp_f32 v50, v50
    v_exp_f32 v51, v51
    v_add_f32 v44, 1.0, v44
    v_add_f32 v45, 1.0, v45
    v_add_f32 v46, 1.0, v46
    v_add_f32 v47, 1.0, v47
    v_add_f32 v48, 1.0, v48
    v_add_f32 v49, 1.0, v49
    v_add_f32 v50, 1.0, v50
    v_add_f32 v51, 1.0, v51
    v_rcp_f32 v44, v44
    v_rcp_f32 v45, v45
    v_rcp_f32 v46, v46
    v_rcp_f32 v47, v47
    v_rcp_f32 v48, v48
    v_rcp_f32 v49, v49
    v_rcp_f32 v50, v50
    v_rcp_f32 v51, v51
    v_mul_f32 v36, v36, v44
    v_mul_f32 v37, v37, v45
    v_mul_f32 v38, v38, v46
    v_mul_f32 v39, v39, v47
    v_mul_f32 v40, v40, v48
    v_mul_f32 v41, v41, v49
    v_mul_f32 v42, v42, v50
    v_mul_f32 v43, v43, v51
    v_cvt_pk_bf16_f32 v52, v36, v37
    v_cvt_pk_bf16_f32 v53, v38, v39
    buffer_store_dwordx2 v[52:53], v7, s[16:19], s25 offen offset:0 sc1
    v_cvt_pk_bf16_f32 v54, v40, v41
    v_cvt_pk_bf16_f32 v55, v42, v43
    buffer_store_dwordx2 v[54:55], v7, s[16:19], s25 offen offset:1024 sc1
    s_add_u32 s25, s25, 2048
    s_add_u32 s25, s25, 12288
K34_END:
    s_endpgm
TEXT_END:
.section .rodata,"a"
.p2align 6
.amdhsa_kernel k1_xform_kernel
  .amdhsa_next_free_vgpr 128
  .amdhsa_next_free_sgpr 96
  .amdhsa_accum_offset 128
  .amdhsa_group_segment_fixed_size 0
  .amdhsa_kernarg_size 56
  .amdhsa_user_sgpr_count 2
  .amdhsa_user_sgpr_kernarg_segment_ptr 1
  .amdhsa_system_sgpr_workgroup_id_x 1
.end_amdhsa_kernel
.p2align 6
.amdhsa_kernel k12_fused_kernel
  .amdhsa_next_free_vgpr 256
  .amdhsa_next_free_sgpr 96
  .amdhsa_accum_offset 256
  .amdhsa_group_segment_fixed_size 0
  .amdhsa_kernarg_size 56
  .amdhsa_user_sgpr_count 2
  .amdhsa_user_sgpr_kernarg_segment_ptr 1
  .amdhsa_system_sgpr_workgroup_id_x 1
.end_amdhsa_kernel
.p2align 6
.amdhsa_kernel k34_out_kernel
  .amdhsa_next_free_vgpr 168
  .amdhsa_next_free_sgpr 96
  .amdhsa_accum_offset 168
  .amdhsa_group_segment_fixed_size 0
  .amdhsa_kernarg_size 56
  .amdhsa_user_sgpr_count 2
  .amdhsa_user_sgpr_kernarg_segment_ptr 1
  .amdhsa_system_sgpr_workgroup_id_x 1
.end_amdhsa_kernel
```

```asm
; @launch kernel=k1_xform_kernel grid=(636,1,1) block=(256,1,1) lds=16384
; @launch kernel=k12_fused_kernel grid=(256,1,1) block=(512,1,1) lds=155872
; @launch kernel=k34_out_kernel grid=(256,1,1) block=(768,1,1) lds=18944
.amdgcn_target "amdgcn-amd-amdhsa--gfx950"
.text
.globl k1_xform_kernel
.globl k12_fused_kernel
.globl k34_out_kernel
.p2align 8
.type k1_xform_kernel,@function
k1_xform_kernel:
    s_cmp_ge_u32 s2, 636
    s_cbranch_scc1 K1_END
    s_load_dwordx4 s[4:7], s[0:1], 0
    s_load_dwordx2 s[8:9], s[0:1], 48
    s_cmp_lt_u32 s2, 8
    s_cbranch_scc0 K1_NOCPF
    s_getpc_b64 s[90:91]
CPF_K1:
    s_sub_u32 s90, s90, CPF_K1-k1_xform_kernel
    s_subb_u32 s91, s91, 0
    v_lshlrev_b32 v8, 7, v0
    v_mov_b32 v11, s91
    v_min_u32 v9, TEXT_END-k1_xform_kernel-4, v8
    v_add_co_u32 v10, vcc, s90, v9
    v_addc_co_u32 v11, vcc, 0, v11, vcc
    global_load_dword v63, v[10:11], off
    v_mov_b32 v11, s91
    v_add_u32 v8, 32768, v8
    v_min_u32 v9, TEXT_END-k1_xform_kernel-4, v8
    v_add_co_u32 v10, vcc, s90, v9
    v_addc_co_u32 v11, vcc, 0, v11, vcc
    global_load_dword v63, v[10:11], off
K1_NOCPF:
    v_lshrrev_b32 v120, 6, v0
    v_and_b32 v121, 63, v0
    v_readfirstlane_b32 s3, v120
    v_and_b32 v122, 15, v121
    v_lshrrev_b32 v123, 4, v121
    s_mov_b32 s28, 0x05040100
    s_mov_b32 s29, 0x07060302
    v_and_b32 v124, 3, v122
    v_lshlrev_b32 v124, 2, v124
    v_lshrrev_b32 v125, 3, v122
    v_lshl_add_u32 v124, v125, 1, v124
    s_lshl_b32 s10, s3, 4
    s_add_u32 s10, s10, 1
    v_add_u32 v124, s10, v124
    v_bfe_u32 v125, v122, 2, 1
    v_lshlrev_b32 v121, 4, v121
    s_waitcnt lgkmcnt(0)
    s_or_b32 s10, s2, s3
    s_cmp_eq_u32 s10, 0
    s_cbranch_scc0 K1_NOCLR
    s_add_u32 s12, s8, 153092096
    s_addc_u32 s13, s9, 0
    s_and_b32 s13, s13, 0xffff
    s_mov_b32 s14, 32768
    s_mov_b32 s15, 0x00020000
    v_lshrrev_b32 v118, 4, v121
    v_lshlrev_b32 v119, 10, v118
    v_mov_b32 v117, 0
    s_mov_b64 exec, 0xffff
    buffer_store_dword v117, v119, s[12:15], 0 offen
    v_lshlrev_b32 v119, 4, v118
    v_add_u32 v119, 16384, v119
    buffer_store_dword v117, v119, s[12:15], 0 offen
    s_mov_b64 exec, -1
K1_NOCLR:
    s_cmp_lt_u32 s2, 32
    s_cbranch_scc0 K1_NOFILL
    s_add_u32 s12, s8, 153616384
    s_addc_u32 s13, s9, 0
    s_and_b32 s13, s13, 0xffff
    s_mov_b32 s14, 131072
    s_mov_b32 s15, 0x00020000
    s_lshl_b32 s10, s2, 2
    s_add_u32 s10, s10, s3
    s_lshl_b32 s10, s10, 10
    v_mov_b32 v112, -1
    v_mov_b32 v113, -1
    v_mov_b32 v114, -1
    v_mov_b32 v115, -1
    buffer_store_dwordx4 v[112:115], v121, s[12:15], s10 offen
K1_NOFILL:
    s_add_u32 s10, s2, 384
    s_sub_u32 s11, s2, 252
    s_cmp_lt_u32 s2, 252
    s_cselect_b32 s2, s10, s11
    s_cmp_lt_u32 s2, 384
    s_cbranch_scc1 K1_W
    s_sub_u32 s11, s2, 384
    s_mul_hi_u32 s13, s11, 1431655766
    s_mul_i32 s12, s13, 3
    s_sub_u32 s12, s11, s12
    s_mov_b32 s11, s13
    s_cmp_ge_u32 s11, 42
    s_cselect_b32 s13, 1, 0
    s_mul_i32 s14, s13, 42
    s_sub_u32 s11, s11, s14
    s_lshl_b32 s11, s11, 2
    s_add_u32 s11, s11, s3
    s_mul_i32 s14, s13, 16384000
    s_add_u32 s16, s4, s14
    s_addc_u32 s17, s5, 0
    s_and_b32 s17, s17, 0xffff
    s_mov_b32 s18, 16384000
    s_mov_b32 s19, 0x00020000
    s_mov_b32 s20, s8
    s_mov_b32 s21, s9
    s_and_b32 s21, s21, 0xffff
    s_mov_b32 s22, 43778048
    s_mov_b32 s23, 0x00020000
    v_lshlrev_b32 v126, 14, v123
    v_lshl_add_u32 v126, v122, 4, v126
    s_mul_i32 s15, s11, 98304
    s_lshl_b32 s24, s12, 8
    s_add_u32 s15, s15, s24
    buffer_load_dwordx4 v[0:3], v126, s[16:19], s15 offen
    buffer_load_dwordx4 v[4:7], v126, s[16:19], s15 offen offset:2048
    s_add_u32 s15, s15, 4096
    buffer_load_dwordx4 v[8:11], v126, s[16:19], s15 offen
    buffer_load_dwordx4 v[12:15], v126, s[16:19], s15 offen offset:2048
    s_add_u32 s15, s15, 4096
    buffer_load_dwordx4 v[16:19], v126, s[16:19], s15 offen
    buffer_load_dwordx4 v[20:23], v126, s[16:19], s15 offen offset:2048
    s_add_u32 s15, s15, 4096
    buffer_load_dwordx4 v[24:27], v126, s[16:19], s15 offen
    buffer_load_dwordx4 v[28:31], v126, s[16:19], s15 offen offset:2048
    s_add_u32 s15, s15, 53248
    buffer_load_dwordx4 v[32:35], v126, s[16:19], s15 offen
    buffer_load_dwordx4 v[36:39], v126, s[16:19], s15 offen offset:2048
    s_add_u32 s15, s15, 4096
    buffer_load_dwordx4 v[40:43], v126, s[16:19], s15 offen
    buffer_load_dwordx4 v[44:47], v126, s[16:19], s15 offen offset:2048
    s_add_u32 s15, s15, 4096
    buffer_load_dwordx4 v[48:51], v126, s[16:19], s15 offen
    buffer_load_dwordx4 v[52:55], v126, s[16:19], s15 offen offset:2048
    s_add_u32 s15, s15, 4096
    buffer_load_dwordx4 v[56:59], v126, s[16:19], s15 offen
    buffer_load_dwordx4 v[60:63], v126, s[16:19], s15 offen offset:2048
    v_lshlrev_b32 v127, 3, v123
    v_lshlrev_b32 v112, 5, v125
    v_mad_u32_u24 v113, v124, v127, v112
    v_mad_u32_u24 v64, v124, 0, v113
    v_mad_u32_u24 v65, v124, 1, v113
    v_mad_u32_u24 v66, v124, 2, v113
    v_mad_u32_u24 v67, v124, 3, v113
    v_mad_u32_u24 v68, v124, 4, v113
    v_mad_u32_u24 v69, v124, 5, v113
    v_mad_u32_u24 v70, v124, 6, v113
    v_mad_u32_u24 v71, v124, 7, v113
    v_and_b32 v64, 127, v64
    v_and_b32 v65, 127, v65
    v_and_b32 v66, 127, v66
    v_and_b32 v67, 127, v67
    v_and_b32 v68, 127, v68
    v_and_b32 v69, 127, v69
    v_and_b32 v70, 127, v70
    v_and_b32 v71, 127, v71
    v_cvt_f32_u32 v64, v64
    v_cvt_f32_u32 v65, v65
    v_cvt_f32_u32 v66, v66
    v_cvt_f32_u32 v67, v67
    v_cvt_f32_u32 v68, v68
    v_cvt_f32_u32 v69, v69
    v_cvt_f32_u32 v70, v70
    v_cvt_f32_u32 v71, v71
    v_mul_f32 v64, 0x3c000000, v64
    v_mul_f32 v65, 0x3c000000, v65
    v_mul_f32 v66, 0x3c000000, v66
    v_mul_f32 v67, 0x3c000000, v67
    v_mul_f32 v68, 0x3c000000, v68
    v_mul_f32 v69, 0x3c000000, v69
    v_mul_f32 v70, 0x3c000000, v70
    v_mul_f32 v71, 0x3c000000, v71
    v_cos_f32 v64, v64
    v_cos_f32 v65, v65
    v_cos_f32 v66, v66
    v_cos_f32 v67, v67
    v_cos_f32 v68, v68
    v_cos_f32 v69, v69
    v_cos_f32 v70, v70
    v_cos_f32 v71, v71
    s_nop 0
    v_cvt_pk_bf16_f32 v72, v64, v65
    v_cvt_pk_bf16_f32 v73, v66, v67
    v_cvt_pk_bf16_f32 v74, v68, v69
    v_cvt_pk_bf16_f32 v75, v70, v71
    v_lshlrev_b32 v80, 16, v72
    v_and_b32 v81, 0xffff0000, v72
    v_sub_f32 v64, v64, v80
    v_sub_f32 v65, v65, v81
    v_lshlrev_b32 v80, 16, v73
    v_and_b32 v81, 0xffff0000, v73
    v_sub_f32 v66, v66, v80
    v_sub_f32 v67, v67, v81
    v_lshlrev_b32 v80, 16, v74
    v_and_b32 v81, 0xffff0000, v74
    v_sub_f32 v68, v68, v80
    v_sub_f32 v69, v69, v81
    v_lshlrev_b32 v80, 16, v75
    v_and_b32 v81, 0xffff0000, v75
    v_sub_f32 v70, v70, v80
    v_sub_f32 v71, v71, v81
    v_cvt_pk_bf16_f32 v76, v64, v65
    v_cvt_pk_bf16_f32 v77, v66, v67
    v_cvt_pk_bf16_f32 v78, v68, v69
    v_cvt_pk_bf16_f32 v79, v70, v71
    s_lshl_b32 s24, s3, 12
    v_add_u32 v114, s24, v121
    ds_write_b128 v114, v[72:75] offset:0
    ds_write_b128 v114, v[76:79] offset:1024
    v_add_u32 v127, 32, v127
    v_lshlrev_b32 v112, 5, v125
    v_mad_u32_u24 v113, v124, v127, v112
    v_mad_u32_u24 v64, v124, 0, v113
    v_mad_u32_u24 v65, v124, 1, v113
    v_mad_u32_u24 v66, v124, 2, v113
    v_mad_u32_u24 v67, v124, 3, v113
    v_mad_u32_u24 v68, v124, 4, v113
    v_mad_u32_u24 v69, v124, 5, v113
    v_mad_u32_u24 v70, v124, 6, v113
    v_mad_u32_u24 v71, v124, 7, v113
    v_and_b32 v64, 127, v64
    v_and_b32 v65, 127, v65
    v_and_b32 v66, 127, v66
    v_and_b32 v67, 127, v67
    v_and_b32 v68, 127, v68
    v_and_b32 v69, 127, v69
    v_and_b32 v70, 127, v70
    v_and_b32 v71, 127, v71
    v_cvt_f32_u32 v64, v64
    v_cvt_f32_u32 v65, v65
    v_cvt_f32_u32 v66, v66
    v_cvt_f32_u32 v67, v67
    v_cvt_f32_u32 v68, v68
    v_cvt_f32_u32 v69, v69
    v_cvt_f32_u32 v70, v70
    v_cvt_f32_u32 v71, v71
    v_mul_f32 v64, 0x3c000000, v64
    v_mul_f32 v65, 0x3c000000, v65
    v_mul_f32 v66, 0x3c000000, v66
    v_mul_f32 v67, 0x3c000000, v67
    v_mul_f32 v68, 0x3c000000, v68
    v_mul_f32 v69, 0x3c000000, v69
    v_mul_f32 v70, 0x3c000000, v70
    v_mul_f32 v71, 0x3c000000, v71
    v_cos_f32 v64, v64
    v_cos_f32 v65, v65
    v_cos_f32 v66, v66
    v_cos_f32 v67, v67
    v_cos_f32 v68, v68
    v_cos_f32 v69, v69
    v_cos_f32 v70, v70
    v_cos_f32 v71, v71
    s_nop 0
    v_cvt_pk_bf16_f32 v72, v64, v65
    v_cvt_pk_bf16_f32 v73, v66, v67
    v_cvt_pk_bf16_f32 v74, v68, v69
    v_cvt_pk_bf16_f32 v75, v70, v71
    v_lshlrev_b32 v80, 16, v72
    v_and_b32 v81, 0xffff0000, v72
    v_sub_f32 v64, v64, v80
    v_sub_f32 v65, v65, v81
    v_lshlrev_b32 v80, 16, v73
    v_and_b32 v81, 0xffff0000, v73
    v_sub_f32 v66, v66, v80
    v_sub_f32 v67, v67, v81
    v_lshlrev_b32 v80, 16, v74
    v_and_b32 v81, 0xffff0000, v74
    v_sub_f32 v68, v68, v80
    v_sub_f32 v69, v69, v81
    v_lshlrev_b32 v80, 16, v75
    v_and_b32 v81, 0xffff0000, v75
    v_sub_f32 v70, v70, v80
    v_sub_f32 v71, v71, v81
    v_cvt_pk_bf16_f32 v76, v64, v65
    v_cvt_pk_bf16_f32 v77, v66, v67
    v_cvt_pk_bf16_f32 v78, v68, v69
    v_cvt_pk_bf16_f32 v79, v70, v71
    s_lshl_b32 s24, s3, 12
    v_add_u32 v114, s24, v121
    ds_write_b128 v114, v[72:75] offset:2048
    ds_write_b128 v114, v[76:79] offset:3072
    v_lshrrev_b32 v112, 1, v123
    s_mov_b32 s24, 1368064
    v_mul_lo_u32 v112, v112, s24
    v_lshrrev_b32 v113, 2, v122
    s_mov_b32 s24, 21376
    v_mul_lo_u32 v113, v113, s24
    v_add_u32 v112, v112, v113
    v_and_b32 v113, 3, v122
    v_and_b32 v114, 1, v123
    v_lshl_add_u32 v113, v114, 2, v113
    s_add_u32 s24, s11, 7
    s_cmp_ge_u32 s11, 160
    s_cselect_b32 s24, s24, s11
    s_cmp_eq_u32 s13, 1
    s_cselect_b32 s24, s24, s11
    s_lshr_b32 s24, s24, 1
    s_and_b32 s24, s24, 7
    v_xor_b32 v113, s24, v113
    v_lshl_add_u32 v120, v113, 4, v112
    s_mul_i32 s25, s13, 684032
    s_mul_i32 s24, s12, 85504
    s_add_u32 s25, s25, s24
    s_lshl_b32 s24, s11, 7
    s_add_u32 s25, s25, s24
    s_waitcnt lgkmcnt(0)
    s_barrier
    s_cmp_ge_u32 s11, 167
    s_cbranch_scc1 K1_END
    s_waitcnt vmcnt(8)
    v_perm_b32 v64, v4, v0, s28
    v_perm_b32 v68, v4, v0, s29
    v_perm_b32 v65, v12, v8, s28
    v_perm_b32 v69, v12, v8, s29
    v_perm_b32 v66, v20, v16, s28
    v_perm_b32 v70, v20, v16, s29
    v_perm_b32 v67, v28, v24, s28
    v_perm_b32 v71, v28, v24, s29
    v_perm_b32 v72, v5, v1, s28
    v_perm_b32 v76, v5, v1, s29
    v_perm_b32 v73, v13, v9, s28
    v_perm_b32 v77, v13, v9, s29
    v_perm_b32 v74, v21, v17, s28
    v_perm_b32 v78, v21, v17, s29
    v_perm_b32 v75, v29, v25, s28
    v_perm_b32 v79, v29, v25, s29
    v_perm_b32 v80, v6, v2, s28
    v_perm_b32 v84, v6, v2, s29
    v_perm_b32 v81, v14, v10, s28
    v_perm_b32 v85, v14, v10, s29
    v_perm_b32 v82, v22, v18, s28
    v_perm_b32 v86, v22, v18, s29
    v_perm_b32 v83, v30, v26, s28
    v_perm_b32 v87, v30, v26, s29
    v_perm_b32 v88, v7, v3, s28
    v_perm_b32 v92, v7, v3, s29
    v_perm_b32 v89, v15, v11, s28
    v_perm_b32 v93, v15, v11, s29
    v_perm_b32 v90, v23, v19, s28
    v_perm_b32 v94, v23, v19, s29
    v_perm_b32 v91, v31, v27, s28
    v_perm_b32 v95, v31, v27, s29
    s_waitcnt vmcnt(0)
    v_perm_b32 v0, v36, v32, s28
    v_perm_b32 v4, v36, v32, s29
    v_perm_b32 v1, v44, v40, s28
    v_perm_b32 v5, v44, v40, s29
    v_perm_b32 v2, v52, v48, s28
    v_perm_b32 v6, v52, v48, s29
    v_perm_b32 v3, v60, v56, s28
    v_perm_b32 v7, v60, v56, s29
    v_perm_b32 v8, v37, v33, s28
    v_perm_b32 v12, v37, v33, s29
    v_perm_b32 v9, v45, v41, s28
    v_perm_b32 v13, v45, v41, s29
    v_perm_b32 v10, v53, v49, s28
    v_perm_b32 v14, v53, v49, s29
    v_perm_b32 v11, v61, v57, s28
    v_perm_b32 v15, v61, v57, s29
    v_perm_b32 v16, v38, v34, s28
    v_perm_b32 v20, v38, v34, s29
    v_perm_b32 v17, v46, v42, s28
    v_perm_b32 v21, v46, v42, s29
    v_perm_b32 v18, v54, v50, s28
    v_perm_b32 v22, v54, v50, s29
    v_perm_b32 v19, v62, v58, s28
    v_perm_b32 v23, v62, v58, s29
    v_perm_b32 v24, v39, v35, s28
    v_perm_b32 v28, v39, v35, s29
    v_perm_b32 v25, v47, v43, s28
    v_perm_b32 v29, v47, v43, s29
    v_perm_b32 v26, v55, v51, s28
    v_perm_b32 v30, v55, v51, s29
    v_perm_b32 v27, v63, v59, s28
    v_perm_b32 v31, v63, v59, s29
    ds_read_b128 v[96:99], v121 offset:0
    ds_read_b128 v[100:103], v121 offset:1024
    ds_read_b128 v[104:107], v121 offset:2048
    ds_read_b128 v[108:111], v121 offset:3072
    s_waitcnt lgkmcnt(3)
    v_mfma_f32_16x16x32_bf16 v[32:35], v[96:99], v[64:67], 0
    v_mfma_f32_16x16x32_bf16 v[36:39], v[96:99], v[68:71], 0
    v_mfma_f32_16x16x32_bf16 v[40:43], v[96:99], v[72:75], 0
    v_mfma_f32_16x16x32_bf16 v[44:47], v[96:99], v[76:79], 0
    v_mfma_f32_16x16x32_bf16 v[48:51], v[96:99], v[80:83], 0
    v_mfma_f32_16x16x32_bf16 v[52:55], v[96:99], v[84:87], 0
    v_mfma_f32_16x16x32_bf16 v[56:59], v[96:99], v[88:91], 0
    v_mfma_f32_16x16x32_bf16 v[60:63], v[96:99], v[92:95], 0
    s_waitcnt lgkmcnt(2)
    v_mfma_f32_16x16x32_bf16 v[32:35], v[100:103], v[64:67], v[32:35]
    v_mfma_f32_16x16x32_bf16 v[36:39], v[100:103], v[68:71], v[36:39]
    v_mfma_f32_16x16x32_bf16 v[40:43], v[100:103], v[72:75], v[40:43]
    v_mfma_f32_16x16x32_bf16 v[44:47], v[100:103], v[76:79], v[44:47]
    v_mfma_f32_16x16x32_bf16 v[48:51], v[100:103], v[80:83], v[48:51]
    v_mfma_f32_16x16x32_bf16 v[52:55], v[100:103], v[84:87], v[52:55]
    v_mfma_f32_16x16x32_bf16 v[56:59], v[100:103], v[88:91], v[56:59]
    v_mfma_f32_16x16x32_bf16 v[60:63], v[100:103], v[92:95], v[60:63]
    s_waitcnt lgkmcnt(1)
    v_mfma_f32_16x16x32_bf16 v[32:35], v[104:107], v[0:3], v[32:35]
    v_mfma_f32_16x16x32_bf16 v[36:39], v[104:107], v[4:7], v[36:39]
    v_mfma_f32_16x16x32_bf16 v[40:43], v[104:107], v[8:11], v[40:43]
    v_mfma_f32_16x16x32_bf16 v[44:47], v[104:107], v[12:15], v[44:47]
    v_mfma_f32_16x16x32_bf16 v[48:51], v[104:107], v[16:19], v[48:51]
    v_mfma_f32_16x16x32_bf16 v[52:55], v[104:107], v[20:23], v[52:55]
    v_mfma_f32_16x16x32_bf16 v[56:59], v[104:107], v[24:27], v[56:59]
    v_mfma_f32_16x16x32_bf16 v[60:63], v[104:107], v[28:31], v[60:63]
    s_waitcnt lgkmcnt(0)
    v_mfma_f32_16x16x32_bf16 v[32:35], v[108:111], v[0:3], v[32:35]
    v_mfma_f32_16x16x32_bf16 v[36:39], v[108:111], v[4:7], v[36:39]
    v_mfma_f32_16x16x32_bf16 v[40:43], v[108:111], v[8:11], v[40:43]
    v_mfma_f32_16x16x32_bf16 v[44:47], v[108:111], v[12:15], v[44:47]
    v_mfma_f32_16x16x32_bf16 v[48:51], v[108:111], v[16:19], v[48:51]
    v_mfma_f32_16x16x32_bf16 v[52:55], v[108:111], v[20:23], v[52:55]
    v_mfma_f32_16x16x32_bf16 v[56:59], v[108:111], v[24:27], v[56:59]
    v_mfma_f32_16x16x32_bf16 v[60:63], v[108:111], v[28:31], v[60:63]
    s_nop 7
    v_cvt_pk_bf16_f32 v112, v32, v36
    v_cvt_pk_bf16_f32 v113, v40, v44
    v_cvt_pk_bf16_f32 v114, v48, v52
    v_cvt_pk_bf16_f32 v115, v56, v60
    buffer_store_dwordx4 v[112:115], v120, s[20:23], s25 offen
    s_add_u32 s25, s25, 2736128
    v_cvt_pk_bf16_f32 v116, v33, v37
    v_cvt_pk_bf16_f32 v117, v41, v45
    v_cvt_pk_bf16_f32 v118, v49, v53
    v_cvt_pk_bf16_f32 v119, v57, v61
    buffer_store_dwordx4 v[116:119], v120, s[20:23], s25 offen
    s_add_u32 s25, s25, 2736128
    v_cvt_pk_bf16_f32 v112, v34, v38
    v_cvt_pk_bf16_f32 v113, v42, v46
    v_cvt_pk_bf16_f32 v114, v50, v54
    v_cvt_pk_bf16_f32 v115, v58, v62
    buffer_store_dwordx4 v[112:115], v120, s[20:23], s25 offen
    s_add_u32 s25, s25, 2736128
    v_cvt_pk_bf16_f32 v116, v35, v39
    v_cvt_pk_bf16_f32 v117, v43, v47
    v_cvt_pk_bf16_f32 v118, v51, v55
    v_cvt_pk_bf16_f32 v119, v59, v63
    buffer_store_dwordx4 v[116:119], v120, s[20:23], s25 offen
    s_add_u32 s25, s25, 2736128
    ds_read_b128 v[96:99], v121 offset:4096
    ds_read_b128 v[100:103], v121 offset:5120
    ds_read_b128 v[104:107], v121 offset:6144
    ds_read_b128 v[108:111], v121 offset:7168
    s_waitcnt lgkmcnt(3)
    v_mfma_f32_16x16x32_bf16 v[32:35], v[96:99], v[64:67], 0
    v_mfma_f32_16x16x32_bf16 v[36:39], v[96:99], v[68:71], 0
    v_mfma_f32_16x16x32_bf16 v[40:43], v[96:99], v[72:75], 0
    v_mfma_f32_16x16x32_bf16 v[44:47], v[96:99], v[76:79], 0
    v_mfma_f32_16x16x32_bf16 v[48:51], v[96:99], v[80:83], 0
    v_mfma_f32_16x16x32_bf16 v[52:55], v[96:99], v[84:87], 0
    v_mfma_f32_16x16x32_bf16 v[56:59], v[96:99], v[88:91], 0
    v_mfma_f32_16x16x32_bf16 v[60:63], v[96:99], v[92:95], 0
    s_waitcnt lgkmcnt(2)
    v_mfma_f32_16x16x32_bf16 v[32:35], v[100:103], v[64:67], v[32:35]
    v_mfma_f32_16x16x32_bf16 v[36:39], v[100:103], v[68:71], v[36:39]
    v_mfma_f32_16x16x32_bf16 v[40:43], v[100:103], v[72:75], v[40:43]
    v_mfma_f32_16x16x32_bf16 v[44:47], v[100:103], v[76:79], v[44:47]
    v_mfma_f32_16x16x32_bf16 v[48:51], v[100:103], v[80:83], v[48:51]
    v_mfma_f32_16x16x32_bf16 v[52:55], v[100:103], v[84:87], v[52:55]
    v_mfma_f32_16x16x32_bf16 v[56:59], v[100:103], v[88:91], v[56:59]
    v_mfma_f32_16x16x32_bf16 v[60:63], v[100:103], v[92:95], v[60:63]
    s_waitcnt lgkmcnt(1)
    v_mfma_f32_16x16x32_bf16 v[32:35], v[104:107], v[0:3], v[32:35]
    v_mfma_f32_16x16x32_bf16 v[36:39], v[104:107], v[4:7], v[36:39]
    v_mfma_f32_16x16x32_bf16 v[40:43], v[104:107], v[8:11], v[40:43]
    v_mfma_f32_16x16x32_bf16 v[44:47], v[104:107], v[12:15], v[44:47]
    v_mfma_f32_16x16x32_bf16 v[48:51], v[104:107], v[16:19], v[48:51]
    v_mfma_f32_16x16x32_bf16 v[52:55], v[104:107], v[20:23], v[52:55]
    v_mfma_f32_16x16x32_bf16 v[56:59], v[104:107], v[24:27], v[56:59]
    v_mfma_f32_16x16x32_bf16 v[60:63], v[104:107], v[28:31], v[60:63]
    s_waitcnt lgkmcnt(0)
    v_mfma_f32_16x16x32_bf16 v[32:35], v[108:111], v[0:3], v[32:35]
    v_mfma_f32_16x16x32_bf16 v[36:39], v[108:111], v[4:7], v[36:39]
    v_mfma_f32_16x16x32_bf16 v[40:43], v[108:111], v[8:11], v[40:43]
    v_mfma_f32_16x16x32_bf16 v[44:47], v[108:111], v[12:15], v[44:47]
    v_mfma_f32_16x16x32_bf16 v[48:51], v[108:111], v[16:19], v[48:51]
    v_mfma_f32_16x16x32_bf16 v[52:55], v[108:111], v[20:23], v[52:55]
    v_mfma_f32_16x16x32_bf16 v[56:59], v[108:111], v[24:27], v[56:59]
    v_mfma_f32_16x16x32_bf16 v[60:63], v[108:111], v[28:31], v[60:63]
    s_nop 7
    v_cvt_pk_bf16_f32 v112, v32, v36
    v_cvt_pk_bf16_f32 v113, v40, v44
    v_cvt_pk_bf16_f32 v114, v48, v52
    v_cvt_pk_bf16_f32 v115, v56, v60
    buffer_store_dwordx4 v[112:115], v120, s[20:23], s25 offen
    s_add_u32 s25, s25, 2736128
    v_cvt_pk_bf16_f32 v116, v33, v37
    v_cvt_pk_bf16_f32 v117, v41, v45
    v_cvt_pk_bf16_f32 v118, v49, v53
    v_cvt_pk_bf16_f32 v119, v57, v61
    buffer_store_dwordx4 v[116:119], v120, s[20:23], s25 offen
    s_add_u32 s25, s25, 2736128
    v_cvt_pk_bf16_f32 v112, v34, v38
    v_cvt_pk_bf16_f32 v113, v42, v46
    v_cvt_pk_bf16_f32 v114, v50, v54
    v_cvt_pk_bf16_f32 v115, v58, v62
    buffer_store_dwordx4 v[112:115], v120, s[20:23], s25 offen
    s_add_u32 s25, s25, 2736128
    v_cvt_pk_bf16_f32 v116, v35, v39
    v_cvt_pk_bf16_f32 v117, v43, v47
    v_cvt_pk_bf16_f32 v118, v51, v55
    v_cvt_pk_bf16_f32 v119, v59, v63
    buffer_store_dwordx4 v[116:119], v120, s[20:23], s25 offen
    s_add_u32 s25, s25, 2736128
    ds_read_b128 v[96:99], v121 offset:8192
    ds_read_b128 v[100:103], v121 offset:9216
    ds_read_b128 v[104:107], v121 offset:10240
    ds_read_b128 v[108:111], v121 offset:11264
    s_waitcnt lgkmcnt(3)
    v_mfma_f32_16x16x32_bf16 v[32:35], v[96:99], v[64:67], 0
    v_mfma_f32_16x16x32_bf16 v[36:39], v[96:99], v[68:71], 0
    v_mfma_f32_16x16x32_bf16 v[40:43], v[96:99], v[72:75], 0
    v_mfma_f32_16x16x32_bf16 v[44:47], v[96:99], v[76:79], 0
    v_mfma_f32_16x16x32_bf16 v[48:51], v[96:99], v[80:83], 0
    v_mfma_f32_16x16x32_bf16 v[52:55], v[96:99], v[84:87], 0
    v_mfma_f32_16x16x32_bf16 v[56:59], v[96:99], v[88:91], 0
    v_mfma_f32_16x16x32_bf16 v[60:63], v[96:99], v[92:95], 0
    s_waitcnt lgkmcnt(2)
    v_mfma_f32_16x16x32_bf16 v[32:35], v[100:103], v[64:67], v[32:35]
    v_mfma_f32_16x16x32_bf16 v[36:39], v[100:103], v[68:71], v[36:39]
    v_mfma_f32_16x16x32_bf16 v[40:43], v[100:103], v[72:75], v[40:43]
    v_mfma_f32_16x16x32_bf16 v[44:47], v[100:103], v[76:79], v[44:47]
    v_mfma_f32_16x16x32_bf16 v[48:51], v[100:103], v[80:83], v[48:51]
    v_mfma_f32_16x16x32_bf16 v[52:55], v[100:103], v[84:87], v[52:55]
    v_mfma_f32_16x16x32_bf16 v[56:59], v[100:103], v[88:91], v[56:59]
    v_mfma_f32_16x16x32_bf16 v[60:63], v[100:103], v[92:95], v[60:63]
    s_waitcnt lgkmcnt(1)
    v_mfma_f32_16x16x32_bf16 v[32:35], v[104:107], v[0:3], v[32:35]
    v_mfma_f32_16x16x32_bf16 v[36:39], v[104:107], v[4:7], v[36:39]
    v_mfma_f32_16x16x32_bf16 v[40:43], v[104:107], v[8:11], v[40:43]
    v_mfma_f32_16x16x32_bf16 v[44:47], v[104:107], v[12:15], v[44:47]
    v_mfma_f32_16x16x32_bf16 v[48:51], v[104:107], v[16:19], v[48:51]
    v_mfma_f32_16x16x32_bf16 v[52:55], v[104:107], v[20:23], v[52:55]
    v_mfma_f32_16x16x32_bf16 v[56:59], v[104:107], v[24:27], v[56:59]
    v_mfma_f32_16x16x32_bf16 v[60:63], v[104:107], v[28:31], v[60:63]
    s_waitcnt lgkmcnt(0)
    v_mfma_f32_16x16x32_bf16 v[32:35], v[108:111], v[0:3], v[32:35]
    v_mfma_f32_16x16x32_bf16 v[36:39], v[108:111], v[4:7], v[36:39]
    v_mfma_f32_16x16x32_bf16 v[40:43], v[108:111], v[8:11], v[40:43]
    v_mfma_f32_16x16x32_bf16 v[44:47], v[108:111], v[12:15], v[44:47]
    v_mfma_f32_16x16x32_bf16 v[48:51], v[108:111], v[16:19], v[48:51]
    v_mfma_f32_16x16x32_bf16 v[52:55], v[108:111], v[20:23], v[52:55]
    v_mfma_f32_16x16x32_bf16 v[56:59], v[108:111], v[24:27], v[56:59]
    v_mfma_f32_16x16x32_bf16 v[60:63], v[108:111], v[28:31], v[60:63]
    s_nop 7
    v_cvt_pk_bf16_f32 v112, v32, v36
    v_cvt_pk_bf16_f32 v113, v40, v44
    v_cvt_pk_bf16_f32 v114, v48, v52
    v_cvt_pk_bf16_f32 v115, v56, v60
    buffer_store_dwordx4 v[112:115], v120, s[20:23], s25 offen
    s_add_u32 s25, s25, 2736128
    v_cvt_pk_bf16_f32 v116, v33, v37
    v_cvt_pk_bf16_f32 v117, v41, v45
    v_cvt_pk_bf16_f32 v118, v49, v53
    v_cvt_pk_bf16_f32 v119, v57, v61
    buffer_store_dwordx4 v[116:119], v120, s[20:23], s25 offen
    s_add_u32 s25, s25, 2736128
    v_cvt_pk_bf16_f32 v112, v34, v38
    v_cvt_pk_bf16_f32 v113, v42, v46
    v_cvt_pk_bf16_f32 v114, v50, v54
    v_cvt_pk_bf16_f32 v115, v58, v62
    buffer_store_dwordx4 v[112:115], v120, s[20:23], s25 offen
    s_add_u32 s25, s25, 2736128
    v_cvt_pk_bf16_f32 v116, v35, v39
    v_cvt_pk_bf16_f32 v117, v43, v47
    v_cvt_pk_bf16_f32 v118, v51, v55
    v_cvt_pk_bf16_f32 v119, v59, v63
    buffer_store_dwordx4 v[116:119], v120, s[20:23], s25 offen
    s_add_u32 s25, s25, 2736128
    ds_read_b128 v[96:99], v121 offset:12288
    ds_read_b128 v[100:103], v121 offset:13312
    ds_read_b128 v[104:107], v121 offset:14336
    ds_read_b128 v[108:111], v121 offset:15360
    s_waitcnt lgkmcnt(3)
    v_mfma_f32_16x16x32_bf16 v[32:35], v[96:99], v[64:67], 0
    v_mfma_f32_16x16x32_bf16 v[36:39], v[96:99], v[68:71], 0
    v_mfma_f32_16x16x32_bf16 v[40:43], v[96:99], v[72:75], 0
    v_mfma_f32_16x16x32_bf16 v[44:47], v[96:99], v[76:79], 0
    v_mfma_f32_16x16x32_bf16 v[48:51], v[96:99], v[80:83], 0
    v_mfma_f32_16x16x32_bf16 v[52:55], v[96:99], v[84:87], 0
    v_mfma_f32_16x16x32_bf16 v[56:59], v[96:99], v[88:91], 0
    v_mfma_f32_16x16x32_bf16 v[60:63], v[96:99], v[92:95], 0
    s_waitcnt lgkmcnt(2)
    v_mfma_f32_16x16x32_bf16 v[32:35], v[100:103], v[64:67], v[32:35]
    v_mfma_f32_16x16x32_bf16 v[36:39], v[100:103], v[68:71], v[36:39]
    v_mfma_f32_16x16x32_bf16 v[40:43], v[100:103], v[72:75], v[40:43]
    v_mfma_f32_16x16x32_bf16 v[44:47], v[100:103], v[76:79], v[44:47]
    v_mfma_f32_16x16x32_bf16 v[48:51], v[100:103], v[80:83], v[48:51]
    v_mfma_f32_16x16x32_bf16 v[52:55], v[100:103], v[84:87], v[52:55]
    v_mfma_f32_16x16x32_bf16 v[56:59], v[100:103], v[88:91], v[56:59]
    v_mfma_f32_16x16x32_bf16 v[60:63], v[100:103], v[92:95], v[60:63]
    s_waitcnt lgkmcnt(1)
    v_mfma_f32_16x16x32_bf16 v[32:35], v[104:107], v[0:3], v[32:35]
    v_mfma_f32_16x16x32_bf16 v[36:39], v[104:107], v[4:7], v[36:39]
    v_mfma_f32_16x16x32_bf16 v[40:43], v[104:107], v[8:11], v[40:43]
    v_mfma_f32_16x16x32_bf16 v[44:47], v[104:107], v[12:15], v[44:47]
    v_mfma_f32_16x16x32_bf16 v[48:51], v[104:107], v[16:19], v[48:51]
    v_mfma_f32_16x16x32_bf16 v[52:55], v[104:107], v[20:23], v[52:55]
    v_mfma_f32_16x16x32_bf16 v[56:59], v[104:107], v[24:27], v[56:59]
    v_mfma_f32_16x16x32_bf16 v[60:63], v[104:107], v[28:31], v[60:63]
    s_waitcnt lgkmcnt(0)
    v_mfma_f32_16x16x32_bf16 v[32:35], v[108:111], v[0:3], v[32:35]
    v_mfma_f32_16x16x32_bf16 v[36:39], v[108:111], v[4:7], v[36:39]
    v_mfma_f32_16x16x32_bf16 v[40:43], v[108:111], v[8:11], v[40:43]
    v_mfma_f32_16x16x32_bf16 v[44:47], v[108:111], v[12:15], v[44:47]
    v_mfma_f32_16x16x32_bf16 v[48:51], v[108:111], v[16:19], v[48:51]
    v_mfma_f32_16x16x32_bf16 v[52:55], v[108:111], v[20:23], v[52:55]
    v_mfma_f32_16x16x32_bf16 v[56:59], v[108:111], v[24:27], v[56:59]
    v_mfma_f32_16x16x32_bf16 v[60:63], v[108:111], v[28:31], v[60:63]
    s_nop 7
    v_cvt_pk_bf16_f32 v112, v32, v36
    v_cvt_pk_bf16_f32 v113, v40, v44
    v_cvt_pk_bf16_f32 v114, v48, v52
    v_cvt_pk_bf16_f32 v115, v56, v60
    buffer_store_dwordx4 v[112:115], v120, s[20:23], s25 offen
    s_add_u32 s25, s25, 2736128
    v_cvt_pk_bf16_f32 v116, v33, v37
    v_cvt_pk_bf16_f32 v117, v41, v45
    v_cvt_pk_bf16_f32 v118, v49, v53
    v_cvt_pk_bf16_f32 v119, v57, v61
    buffer_store_dwordx4 v[116:119], v120, s[20:23], s25 offen
    s_add_u32 s25, s25, 2736128
    v_cvt_pk_bf16_f32 v112, v34, v38
    v_cvt_pk_bf16_f32 v113, v42, v46
    v_cvt_pk_bf16_f32 v114, v50, v54
    v_cvt_pk_bf16_f32 v115, v58, v62
    buffer_store_dwordx4 v[112:115], v120, s[20:23], s25 offen
    s_add_u32 s25, s25, 2736128
    v_cvt_pk_bf16_f32 v116, v35, v39
    v_cvt_pk_bf16_f32 v117, v43, v47
    v_cvt_pk_bf16_f32 v118, v51, v55
    v_cvt_pk_bf16_f32 v119, v59, v63
    buffer_store_dwordx4 v[116:119], v120, s[20:23], s25 offen
    s_endpgm
K1_W:
    s_mov_b32 s16, s6
    s_mov_b32 s17, s7
    s_and_b32 s17, s17, 0xffff
    s_mov_b32 s18, 16252928
    s_mov_b32 s19, 0x00020000
    s_add_u32 s20, s8, 50331648
    s_addc_u32 s21, s9, 0
    s_and_b32 s21, s21, 0xffff
    s_mov_b32 s22, 67108864
    s_mov_b32 s23, 0x00020000
    s_mul_i32 s11, s2, 1
    s_lshr_b32 s12, s11, 9
    s_and_b32 s13, s11, 511
    s_lshl_b32 s14, s12, 19
    s_lshl_b32 s15, s13, 10
    s_add_u32 s14, s14, s15
    s_lshl_b32 s15, s3, 8
    s_add_u32 s14, s14, s15
    v_and_b32 v126, 1, v123
    v_lshlrev_b32 v126, 23, v126
    v_lshl_add_u32 v126, v122, 4, v126
    s_mov_b32 s15, s14
    buffer_load_dwordx4 v[0:3], v126, s[16:19], s15 offen
    s_add_u32 s15, s15, 0x100000
    buffer_load_dwordx4 v[4:7], v126, s[16:19], s15 offen
    s_add_u32 s15, s15, 0x100000
    buffer_load_dwordx4 v[8:11], v126, s[16:19], s15 offen
    s_add_u32 s15, s15, 0x100000
    buffer_load_dwordx4 v[12:15], v126, s[16:19], s15 offen
    s_add_u32 s15, s15, 0x100000
    buffer_load_dwordx4 v[16:19], v126, s[16:19], s15 offen
    s_add_u32 s15, s15, 0x100000
    buffer_load_dwordx4 v[20:23], v126, s[16:19], s15 offen
    s_add_u32 s15, s15, 0x100000
    buffer_load_dwordx4 v[24:27], v126, s[16:19], s15 offen
    s_add_u32 s15, s15, 0x100000
    buffer_load_dwordx4 v[28:31], v126, s[16:19], s15 offen
    v_and_b32 v127, 1, v123
    v_lshlrev_b32 v127, 3, v127
    v_mul_u32_u24 v112, 96, v125
    v_mad_u32_u24 v113, v124, v127, v112
    v_mad_u32_u24 v64, v124, 0, v113
    v_mad_u32_u24 v65, v124, 1, v113
    v_mad_u32_u24 v66, v124, 2, v113
    v_mad_u32_u24 v67, v124, 3, v113
    v_mad_u32_u24 v68, v124, 4, v113
    v_mad_u32_u24 v69, v124, 5, v113
    v_mad_u32_u24 v70, v124, 6, v113
    v_mad_u32_u24 v71, v124, 7, v113
    v_and_b32 v64, 127, v64
    v_and_b32 v65, 127, v65
    v_and_b32 v66, 127, v66
    v_and_b32 v67, 127, v67
    v_and_b32 v68, 127, v68
    v_and_b32 v69, 127, v69
    v_and_b32 v70, 127, v70
    v_and_b32 v71, 127, v71
    v_cvt_f32_u32 v64, v64
    v_cvt_f32_u32 v65, v65
    v_cvt_f32_u32 v66, v66
    v_cvt_f32_u32 v67, v67
    v_cvt_f32_u32 v68, v68
    v_cvt_f32_u32 v69, v69
    v_cvt_f32_u32 v70, v70
    v_cvt_f32_u32 v71, v71
    v_mul_f32 v64, 0x3c000000, v64
    v_mul_f32 v65, 0x3c000000, v65
    v_mul_f32 v66, 0x3c000000, v66
    v_mul_f32 v67, 0x3c000000, v67
    v_mul_f32 v68, 0x3c000000, v68
    v_mul_f32 v69, 0x3c000000, v69
    v_mul_f32 v70, 0x3c000000, v70
    v_mul_f32 v71, 0x3c000000, v71
    v_cos_f32 v64, v64
    v_cos_f32 v65, v65
    v_cos_f32 v66, v66
    v_cos_f32 v67, v67
    v_cos_f32 v68, v68
    v_cos_f32 v69, v69
    v_cos_f32 v70, v70
    v_cos_f32 v71, v71
    s_nop 0
    v_cvt_pk_bf16_f32 v72, v64, v65
    v_cvt_pk_bf16_f32 v73, v66, v67
    v_cvt_pk_bf16_f32 v74, v68, v69
    v_cvt_pk_bf16_f32 v75, v70, v71
    v_lshlrev_b32 v80, 16, v72
    v_and_b32 v81, 0xffff0000, v72
    v_sub_f32 v64, v64, v80
    v_sub_f32 v65, v65, v81
    v_lshlrev_b32 v80, 16, v73
    v_and_b32 v81, 0xffff0000, v73
    v_sub_f32 v66, v66, v80
    v_sub_f32 v67, v67, v81
    v_lshlrev_b32 v80, 16, v74
    v_and_b32 v81, 0xffff0000, v74
    v_sub_f32 v68, v68, v80
    v_sub_f32 v69, v69, v81
    v_lshlrev_b32 v80, 16, v75
    v_and_b32 v81, 0xffff0000, v75
    v_sub_f32 v70, v70, v80
    v_sub_f32 v71, v71, v81
    v_cvt_pk_bf16_f32 v76, v64, v65
    v_cvt_pk_bf16_f32 v77, v66, v67
    v_cvt_pk_bf16_f32 v78, v68, v69
    v_cvt_pk_bf16_f32 v79, v70, v71
    v_cmp_lt_u32 vcc, 1, v123
    s_lshl_b32 s24, s3, 10
    v_add_u32 v114, s24, v121
    v_cndmask_b32 v72, v72, v76, vcc
    v_cndmask_b32 v73, v73, v77, vcc
    v_cndmask_b32 v74, v74, v78, vcc
    v_cndmask_b32 v75, v75, v79, vcc
    ds_write_b128 v114, v[72:75]
    v_lshrrev_b32 v112, 1, v123
    s_mov_b32 s24, 2097152
    v_mul_lo_u32 v112, v112, s24
    v_and_b32 v113, 1, v123
    v_lshl_add_u32 v112, v113, 8, v112
    v_and_b32 v113, 1, v122
    v_lshl_add_u32 v124, v113, 4, v112
    v_lshrrev_b32 v125, 1, v122
    s_mul_i32 s26, s3, 524288
    s_lshl_b32 s24, s11, 9
    s_add_u32 s26, s26, s24
    s_waitcnt lgkmcnt(0)
    s_barrier
    ds_read_b128 v[96:99], v121 offset:0
    ds_read_b128 v[100:103], v121 offset:1024
    ds_read_b128 v[104:107], v121 offset:2048
    ds_read_b128 v[108:111], v121 offset:3072
    s_mov_b32 s27, 0
    s_waitcnt vmcnt(0) lgkmcnt(0)
K1_W_LOOP:
    s_add_u32 s24, s11, s27
    s_and_b32 s30, s24, 3
    s_lshr_b32 s24, s24, 1
    s_and_b32 s24, s24, 4
    s_or_b32 s30, s30, s24
    v_xor_b32 v112, s30, v125
    v_lshl_add_u32 v120, v112, 5, v124
    s_lshl_b32 s25, s27, 9
    s_add_u32 s25, s25, s26
    v_perm_b32 v32, v4, v0, s28
    v_perm_b32 v36, v4, v0, s29
    v_perm_b32 v33, v12, v8, s28
    v_perm_b32 v37, v12, v8, s29
    v_perm_b32 v34, v20, v16, s28
    v_perm_b32 v38, v20, v16, s29
    v_perm_b32 v35, v28, v24, s28
    v_perm_b32 v39, v28, v24, s29
    v_perm_b32 v40, v5, v1, s28
    v_perm_b32 v44, v5, v1, s29
    v_perm_b32 v41, v13, v9, s28
    v_perm_b32 v45, v13, v9, s29
    v_perm_b32 v42, v21, v17, s28
    v_perm_b32 v46, v21, v17, s29
    v_perm_b32 v43, v29, v25, s28
    v_perm_b32 v47, v29, v25, s29
    v_perm_b32 v48, v6, v2, s28
    v_perm_b32 v52, v6, v2, s29
    v_perm_b32 v49, v14, v10, s28
    v_perm_b32 v53, v14, v10, s29
    v_perm_b32 v50, v22, v18, s28
    v_perm_b32 v54, v22, v18, s29
    v_perm_b32 v51, v30, v26, s28
    v_perm_b32 v55, v30, v26, s29
    v_perm_b32 v56, v7, v3, s28
    v_perm_b32 v60, v7, v3, s29
    v_perm_b32 v57, v15, v11, s28
    v_perm_b32 v61, v15, v11, s29
    v_perm_b32 v58, v23, v19, s28
    v_perm_b32 v62, v23, v19, s29
    v_perm_b32 v59, v31, v27, s28
    v_perm_b32 v63, v31, v27, s29
    s_add_u32 s27, s27, 1
    s_add_u32 s14, s14, 1024
    s_cmp_ge_u32 s27, 1
    s_cbranch_scc1 K1_W_NOLOAD
    s_mov_b32 s15, s14
    buffer_load_dwordx4 v[0:3], v126, s[16:19], s15 offen
    s_add_u32 s15, s15, 0x100000
    buffer_load_dwordx4 v[4:7], v126, s[16:19], s15 offen
    s_add_u32 s15, s15, 0x100000
    buffer_load_dwordx4 v[8:11], v126, s[16:19], s15 offen
    s_add_u32 s15, s15, 0x100000
    buffer_load_dwordx4 v[12:15], v126, s[16:19], s15 offen
    s_add_u32 s15, s15, 0x100000
    buffer_load_dwordx4 v[16:19], v126, s[16:19], s15 offen
    s_add_u32 s15, s15, 0x100000
    buffer_load_dwordx4 v[20:23], v126, s[16:19], s15 offen
    s_add_u32 s15, s15, 0x100000
    buffer_load_dwordx4 v[24:27], v126, s[16:19], s15 offen
    s_add_u32 s15, s15, 0x100000
    buffer_load_dwordx4 v[28:31], v126, s[16:19], s15 offen
K1_W_NOLOAD:
    v_mfma_f32_16x16x32_bf16 v[64:67], v[96:99], v[32:35], 0
    v_mfma_f32_16x16x32_bf16 v[68:71], v[96:99], v[36:39], 0
    v_mfma_f32_16x16x32_bf16 v[72:75], v[96:99], v[40:43], 0
    v_mfma_f32_16x16x32_bf16 v[76:79], v[96:99], v[44:47], 0
    v_mfma_f32_16x16x32_bf16 v[80:83], v[96:99], v[48:51], 0
    v_mfma_f32_16x16x32_bf16 v[84:87], v[96:99], v[52:55], 0
    v_mfma_f32_16x16x32_bf16 v[88:91], v[96:99], v[56:59], 0
    v_mfma_f32_16x16x32_bf16 v[92:95], v[96:99], v[60:63], 0
    s_nop 7
    v_cvt_pk_bf16_f32 v112, v64, v68
    v_cvt_pk_bf16_f32 v113, v72, v76
    v_cvt_pk_bf16_f32 v114, v80, v84
    v_cvt_pk_bf16_f32 v115, v88, v92
    buffer_store_dwordx4 v[112:115], v120, s[20:23], s25 offen
    s_add_u32 s25, s25, 4194304
    v_cvt_pk_bf16_f32 v116, v65, v69
    v_cvt_pk_bf16_f32 v117, v73, v77
    v_cvt_pk_bf16_f32 v118, v81, v85
    v_cvt_pk_bf16_f32 v119, v89, v93
    buffer_store_dwordx4 v[116:119], v120, s[20:23], s25 offen
    s_add_u32 s25, s25, 4194304
    v_cvt_pk_bf16_f32 v112, v66, v70
    v_cvt_pk_bf16_f32 v113, v74, v78
    v_cvt_pk_bf16_f32 v114, v82, v86
    v_cvt_pk_bf16_f32 v115, v90, v94
    buffer_store_dwordx4 v[112:115], v120, s[20:23], s25 offen
    s_add_u32 s25, s25, 4194304
    v_cvt_pk_bf16_f32 v116, v67, v71
    v_cvt_pk_bf16_f32 v117, v75, v79
    v_cvt_pk_bf16_f32 v118, v83, v87
    v_cvt_pk_bf16_f32 v119, v91, v95
    buffer_store_dwordx4 v[116:119], v120, s[20:23], s25 offen
    s_add_u32 s25, s25, 4194304
    v_mfma_f32_16x16x32_bf16 v[64:67], v[100:103], v[32:35], 0
    v_mfma_f32_16x16x32_bf16 v[68:71], v[100:103], v[36:39], 0
    v_mfma_f32_16x16x32_bf16 v[72:75], v[100:103], v[40:43], 0
    v_mfma_f32_16x16x32_bf16 v[76:79], v[100:103], v[44:47], 0
    v_mfma_f32_16x16x32_bf16 v[80:83], v[100:103], v[48:51], 0
    v_mfma_f32_16x16x32_bf16 v[84:87], v[100:103], v[52:55], 0
    v_mfma_f32_16x16x32_bf16 v[88:91], v[100:103], v[56:59], 0
    v_mfma_f32_16x16x32_bf16 v[92:95], v[100:103], v[60:63], 0
    s_nop 7
    v_cvt_pk_bf16_f32 v112, v64, v68
    v_cvt_pk_bf16_f32 v113, v72, v76
    v_cvt_pk_bf16_f32 v114, v80, v84
    v_cvt_pk_bf16_f32 v115, v88, v92
    buffer_store_dwordx4 v[112:115], v120, s[20:23], s25 offen
    s_add_u32 s25, s25, 4194304
    v_cvt_pk_bf16_f32 v116, v65, v69
    v_cvt_pk_bf16_f32 v117, v73, v77
    v_cvt_pk_bf16_f32 v118, v81, v85
    v_cvt_pk_bf16_f32 v119, v89, v93
    buffer_store_dwordx4 v[116:119], v120, s[20:23], s25 offen
    s_add_u32 s25, s25, 4194304
    v_cvt_pk_bf16_f32 v112, v66, v70
    v_cvt_pk_bf16_f32 v113, v74, v78
    v_cvt_pk_bf16_f32 v114, v82, v86
    v_cvt_pk_bf16_f32 v115, v90, v94
    buffer_store_dwordx4 v[112:115], v120, s[20:23], s25 offen
    s_add_u32 s25, s25, 4194304
    v_cvt_pk_bf16_f32 v116, v67, v71
    v_cvt_pk_bf16_f32 v117, v75, v79
    v_cvt_pk_bf16_f32 v118, v83, v87
    v_cvt_pk_bf16_f32 v119, v91, v95
    buffer_store_dwordx4 v[116:119], v120, s[20:23], s25 offen
    s_add_u32 s25, s25, 4194304
    v_mfma_f32_16x16x32_bf16 v[64:67], v[104:107], v[32:35], 0
    v_mfma_f32_16x16x32_bf16 v[68:71], v[104:107], v[36:39], 0
    v_mfma_f32_16x16x32_bf16 v[72:75], v[104:107], v[40:43], 0
    v_mfma_f32_16x16x32_bf16 v[76:79], v[104:107], v[44:47], 0
    v_mfma_f32_16x16x32_bf16 v[80:83], v[104:107], v[48:51], 0
    v_mfma_f32_16x16x32_bf16 v[84:87], v[104:107], v[52:55], 0
    v_mfma_f32_16x16x32_bf16 v[88:91], v[104:107], v[56:59], 0
    v_mfma_f32_16x16x32_bf16 v[92:95], v[104:107], v[60:63], 0
    s_nop 7
    v_cvt_pk_bf16_f32 v112, v64, v68
    v_cvt_pk_bf16_f32 v113, v72, v76
    v_cvt_pk_bf16_f32 v114, v80, v84
    v_cvt_pk_bf16_f32 v115, v88, v92
    buffer_store_dwordx4 v[112:115], v120, s[20:23], s25 offen
    s_add_u32 s25, s25, 4194304
    v_cvt_pk_bf16_f32 v116, v65, v69
    v_cvt_pk_bf16_f32 v117, v73, v77
    v_cvt_pk_bf16_f32 v118, v81, v85
    v_cvt_pk_bf16_f32 v119, v89, v93
    buffer_store_dwordx4 v[116:119], v120, s[20:23], s25 offen
    s_add_u32 s25, s25, 4194304
    v_cvt_pk_bf16_f32 v112, v66, v70
    v_cvt_pk_bf16_f32 v113, v74, v78
    v_cvt_pk_bf16_f32 v114, v82, v86
    v_cvt_pk_bf16_f32 v115, v90, v94
    buffer_store_dwordx4 v[112:115], v120, s[20:23], s25 offen
    s_add_u32 s25, s25, 4194304
    v_cvt_pk_bf16_f32 v116, v67, v71
    v_cvt_pk_bf16_f32 v117, v75, v79
    v_cvt_pk_bf16_f32 v118, v83, v87
    v_cvt_pk_bf16_f32 v119, v91, v95
    buffer_store_dwordx4 v[116:119], v120, s[20:23], s25 offen
    s_add_u32 s25, s25, 4194304
    v_mfma_f32_16x16x32_bf16 v[64:67], v[108:111], v[32:35], 0
    v_mfma_f32_16x16x32_bf16 v[68:71], v[108:111], v[36:39], 0
    v_mfma_f32_16x16x32_bf16 v[72:75], v[108:111], v[40:43], 0
    v_mfma_f32_16x16x32_bf16 v[76:79], v[108:111], v[44:47], 0
    v_mfma_f32_16x16x32_bf16 v[80:83], v[108:111], v[48:51], 0
    v_mfma_f32_16x16x32_bf16 v[84:87], v[108:111], v[52:55], 0
    v_mfma_f32_16x16x32_bf16 v[88:91], v[108:111], v[56:59], 0
    v_mfma_f32_16x16x32_bf16 v[92:95], v[108:111], v[60:63], 0
    s_nop 7
    v_cvt_pk_bf16_f32 v112, v64, v68
    v_cvt_pk_bf16_f32 v113, v72, v76
    v_cvt_pk_bf16_f32 v114, v80, v84
    v_cvt_pk_bf16_f32 v115, v88, v92
    buffer_store_dwordx4 v[112:115], v120, s[20:23], s25 offen
    s_add_u32 s25, s25, 4194304
    v_cvt_pk_bf16_f32 v116, v65, v69
    v_cvt_pk_bf16_f32 v117, v73, v77
    v_cvt_pk_bf16_f32 v118, v81, v85
    v_cvt_pk_bf16_f32 v119, v89, v93
    buffer_store_dwordx4 v[116:119], v120, s[20:23], s25 offen
    s_add_u32 s25, s25, 4194304
    v_cvt_pk_bf16_f32 v112, v66, v70
    v_cvt_pk_bf16_f32 v113, v74, v78
    v_cvt_pk_bf16_f32 v114, v82, v86
    v_cvt_pk_bf16_f32 v115, v90, v94
    buffer_store_dwordx4 v[112:115], v120, s[20:23], s25 offen
    s_add_u32 s25, s25, 4194304
    v_cvt_pk_bf16_f32 v116, v67, v71
    v_cvt_pk_bf16_f32 v117, v75, v79
    v_cvt_pk_bf16_f32 v118, v83, v87
    v_cvt_pk_bf16_f32 v119, v91, v95
    buffer_store_dwordx4 v[116:119], v120, s[20:23], s25 offen
    s_waitcnt vmcnt(16)
    s_cmp_lt_u32 s27, 1
    s_cbranch_scc1 K1_W_LOOP
K1_END:
    s_endpgm
.p2align 8
.type k12_fused_kernel,@function
k12_fused_kernel:
    s_cmp_ge_u32 s2, 256
    s_cbranch_scc1 K12_END
    s_load_dwordx4 s[52:55], s[0:1], 0
    s_load_dwordx4 s[56:59], s[0:1], 40
    s_getpc_b64 s[90:91]
CPF_K12:
    s_sub_u32 s90, s90, CPF_K12-k12_fused_kernel
    s_subb_u32 s91, s91, 0
    v_lshlrev_b32 v8, 7, v0
    v_mov_b32 v11, s91
    v_min_u32 v9, TEXT_END-k12_fused_kernel-4, v8
    v_add_co_u32 v10, vcc, s90, v9
    v_addc_co_u32 v11, vcc, 0, v11, vcc
    global_load_dword v63, v[10:11], off
    v_lshrrev_b32 v1, 6, v0
    v_and_b32 v2, 63, v0
    v_readfirstlane_b32 s3, v1
    s_waitcnt lgkmcnt(0)
    s_cmp_lt_u32 s3, 4
    s_cbranch_scc1 K12_CONS
    v_and_b32 v64, 15, v2
    v_lshrrev_b32 v65, 4, v2
    v_lshlrev_b32 v254, 4, v2
    s_and_b32 s44, s3, 3
    s_and_b32 s20, s44, 1
    s_lshr_b32 s21, s44, 1
    s_lshl_b32 s22, s2, 1
    s_add_u32 s22, s22, s21
    s_and_b32 s23, s22, 3
    s_lshr_b32 s22, s22, 2
    s_and_b32 s24, s2, 7
    s_lshl_b32 s24, s24, 5
    s_lshr_b32 s25, s2, 3
    s_add_u32 s24, s24, s25
    s_cmp_ge_u32 s24, 167
    s_cselect_b32 s25, 1, 0
    s_mul_i32 s26, s25, 167
    s_sub_u32 s24, s24, s26
    s_mov_b32 s49, s25
    s_cmp_eq_u32 s21, 0
    s_cselect_b32 s25, s25, 1
    s_mul_i32 s26, s25, 16384000
    s_add_u32 s4, s52, s26
    s_addc_u32 s5, s53, 0
    s_and_b32 s5, s5, 0xffff
    s_mov_b32 s6, 16384000
    s_mov_b32 s7, 0x00020000
    s_mov_b32 s8, s54
    s_mov_b32 s9, s55
    s_and_b32 s9, s9, 0xffff
    s_mov_b32 s10, 16252928
    s_mov_b32 s11, 0x00020000
    s_mov_b32 s12, s58
    s_mov_b32 s13, s59
    s_and_b32 s13, s13, 0xffff
    s_mov_b32 s14, 43778048
    s_mov_b32 s15, 0x00020000
    s_add_u32 s16, s58, 50331648
    s_addc_u32 s17, s59, 0
    s_and_b32 s17, s17, 0xffff
    s_mov_b32 s18, 67108864
    s_mov_b32 s19, 0x00020000
    s_add_u32 s60, s58, 153092096
    s_addc_u32 s61, s59, 0
    s_and_b32 s61, s61, 0xffff
    s_mov_b32 s62, 32768
    s_mov_b32 s63, 0x00020000
    s_mov_b32 s28, 0x05040100
    s_mov_b32 s29, 0x07060302
    v_lshlrev_b32 v248, 14, v65
    v_lshl_add_u32 v248, v64, 4, v248
    v_and_b32 v250, 1, v65
    v_lshlrev_b32 v250, 23, v250
    v_lshl_add_u32 v250, v64, 4, v250
    v_lshrrev_b32 v66, 1, v65
    s_mov_b32 s26, 1368064
    v_mul_lo_u32 v66, v66, s26
    v_lshrrev_b32 v67, 2, v64
    s_mov_b32 s26, 21376
    v_mul_lo_u32 v67, v67, s26
    v_add_u32 v66, v66, v67
    v_mov_b32 v252, v66
    v_lshrrev_b32 v66, 1, v65
    s_mov_b32 s26, 2097152
    v_mul_lo_u32 v66, v66, s26
    v_and_b32 v67, 1, v65
    v_lshl_add_u32 v66, v67, 8, v66
    v_and_b32 v67, 1, v64
    v_lshl_add_u32 v251, v67, 4, v66
    s_mul_i32 s31, s25, 684032
    s_mul_i32 s32, s23, 524288
    s_lshl_b32 s33, s23, 8
    s_mov_b32 s40, 3
    s_xor_b32 s43, s40, s20
    s_and_b32 s43, s43, 1
    s_mul_i32 s36, s40, 85
    s_add_u32 s36, s36, s2
    s_and_b32 s36, s36, 255
    s_mul_hi_u32 s37, s36, 0x55555556
    s_mul_i32 s38, s37, 3
    s_cmp_eq_u32 s38, s36
    s_cselect_b32 s27, 1, 0
    s_cmp_lt_u32 s37, 78
    s_cselect_b32 s27, s27, 0
    s_add_u32 s37, s37, 89
    s_add_u32 s26, s21, 1
    s_cmp_eq_u32 s27, 1
    s_cselect_b32 s26, 0, s26
    s_and_b32 s36, s27, s21
    s_cselect_b32 s30, s37, s24
    s_cselect_b32 s25, 1, s49
    s_mov_b32 s27, 1
    s_cmp_eq_u32 s43, 0
    s_cbranch_scc0 K12_PL1
    s_lshl_b32 s36, s40, 7
    s_add_u32 s36, s36, s22
    s_lshr_b32 s37, s36, 9
    s_lshl_b32 s37, s37, 19
    s_and_b32 s36, s36, 511
    s_lshl_b32 s36, s36, 10
    s_add_u32 s36, s36, s37
    s_add_u32 s36, s36, s33
    buffer_load_dwordx4 v[96:99], v250, s[8:11], s36 offen
    s_add_u32 s36, s36, 0x100000
    buffer_load_dwordx4 v[100:103], v250, s[8:11], s36 offen
    s_add_u32 s36, s36, 0x100000
    buffer_load_dwordx4 v[104:107], v250, s[8:11], s36 offen
    s_add_u32 s36, s36, 0x100000
    buffer_load_dwordx4 v[108:111], v250, s[8:11], s36 offen
    s_add_u32 s36, s36, 0x100000
    buffer_load_dwordx4 v[112:115], v250, s[8:11], s36 offen
    s_add_u32 s36, s36, 0x100000
    buffer_load_dwordx4 v[116:119], v250, s[8:11], s36 offen
    s_add_u32 s36, s36, 0x100000
    buffer_load_dwordx4 v[120:123], v250, s[8:11], s36 offen
    s_add_u32 s36, s36, 0x100000
    buffer_load_dwordx4 v[124:127], v250, s[8:11], s36 offen
    s_branch K12_PL2
K12_PL1:
    s_cmp_eq_u32 s27, 0
    s_cbranch_scc1 K12_PL2
    s_mul_i32 s36, s25, 16384000
    s_add_u32 s4, s52, s36
    s_addc_u32 s5, s53, 0
    s_and_b32 s5, s5, 0xffff
    s_lshl_b32 s36, s40, 8
    s_mul_i32 s37, s30, 98304
    s_add_u32 s36, s36, s37
    buffer_load_dwordx4 v[0:3], v248, s[4:7], s36 offen
    buffer_load_dwordx4 v[4:7], v248, s[4:7], s36 offen offset:2048
    s_add_u32 s36, s36, 4096
    buffer_load_dwordx4 v[8:11], v248, s[4:7], s36 offen
    buffer_load_dwordx4 v[12:15], v248, s[4:7], s36 offen offset:2048
    s_add_u32 s36, s36, 4096
    buffer_load_dwordx4 v[16:19], v248, s[4:7], s36 offen
    buffer_load_dwordx4 v[20:23], v248, s[4:7], s36 offen offset:2048
    s_add_u32 s36, s36, 4096
    buffer_load_dwordx4 v[24:27], v248, s[4:7], s36 offen
    buffer_load_dwordx4 v[28:31], v248, s[4:7], s36 offen offset:2048
    s_add_u32 s36, s36, 53248
    buffer_load_dwordx4 v[32:35], v248, s[4:7], s36 offen
    buffer_load_dwordx4 v[36:39], v248, s[4:7], s36 offen offset:2048
    s_add_u32 s36, s36, 4096
    buffer_load_dwordx4 v[40:43], v248, s[4:7], s36 offen
    buffer_load_dwordx4 v[44:47], v248, s[4:7], s36 offen offset:2048
    s_add_u32 s36, s36, 4096
    buffer_load_dwordx4 v[48:51], v248, s[4:7], s36 offen
    buffer_load_dwordx4 v[52:55], v248, s[4:7], s36 offen offset:2048
    s_add_u32 s36, s36, 4096
    buffer_load_dwordx4 v[56:59], v248, s[4:7], s36 offen
    buffer_load_dwordx4 v[60:63], v248, s[4:7], s36 offen offset:2048
K12_PL2:
    v_lshrrev_b32 v128, 4, v254
    v_lshlrev_b32 v129, 11, v128
    v_lshrrev_b32 v130, 1, v128
    v_lshlrev_b32 v130, 20, v130
    v_and_b32 v131, 1, v128
    v_lshl_add_u32 v130, v131, 7, v130
    s_mov_b32 s45, s27
    s_mov_b32 s46, s30
    s_mov_b32 s50, s25
    s_mov_b32 s51, s26
    s_add_u32 s47, s40, 1
    s_add_u32 s75, s47, 8
    s_min_u32 s75, s75, 8
    s_cmp_ge_u32 s47, s75
    s_cbranch_scc1 K12_TCHE0
K12_TCH0:
    s_xor_b32 s48, s47, s20
    s_and_b32 s48, s48, 1
    s_cmp_eq_u32 s48, 0
    s_cbranch_scc1 K12_TCHW0
    s_mul_i32 s36, s47, 85
    s_add_u32 s36, s36, s2
    s_and_b32 s36, s36, 255
    s_mul_hi_u32 s37, s36, 0x55555556
    s_mul_i32 s38, s37, 3
    s_cmp_eq_u32 s38, s36
    s_cselect_b32 s27, 1, 0
    s_cmp_lt_u32 s37, 78
    s_cselect_b32 s27, s27, 0
    s_add_u32 s37, s37, 89
    s_add_u32 s26, s21, 1
    s_cmp_eq_u32 s27, 1
    s_cselect_b32 s26, 0, s26
    s_and_b32 s36, s27, s21
    s_cselect_b32 s30, s37, s24
    s_cselect_b32 s25, 1, s49
    s_mov_b32 s27, 1
    s_cmp_eq_u32 s26, 2
    s_cbranch_scc1 K12_TCHN0
    s_cmp_eq_u32 s27, 0
    s_cbranch_scc1 K12_TCHN0
    s_mul_i32 s36, s25, 16384000
    s_add_u32 s4, s52, s36
    s_addc_u32 s5, s53, 0
    s_and_b32 s5, s5, 0xffff
    s_lshl_b32 s36, s47, 8
    s_mul_i32 s37, s30, 98304
    s_add_u32 s36, s36, s37
    buffer_load_dword v244, v129, s[4:7], s36 offen
    buffer_load_dword v245, v129, s[4:7], s36 offen offset:128
    s_branch K12_TCHN0
K12_TCHW0:
    s_lshl_b32 s36, s47, 7
    s_add_u32 s36, s36, s22
    s_lshr_b32 s37, s36, 9
    s_lshl_b32 s37, s37, 19
    s_and_b32 s36, s36, 511
    s_lshl_b32 s36, s36, 10
    s_add_u32 s36, s36, s37
    s_add_u32 s36, s36, s33
    s_mov_b64 exec, 0xffffffff
    buffer_load_dword v246, v130, s[8:11], s36 offen
    s_mov_b64 exec, -1
K12_TCHN0:
    s_add_u32 s47, s47, 1
    s_cmp_lt_u32 s47, s75
    s_cbranch_scc1 K12_TCH0
K12_TCHE0:
    s_mov_b32 s27, s45
    s_mov_b32 s30, s46
    s_mov_b32 s25, s50
    s_mov_b32 s26, s51
    v_and_b32 v128, 3, v64
    v_lshlrev_b32 v128, 2, v128
    v_lshrrev_b32 v130, 3, v64
    v_lshl_add_u32 v128, v130, 1, v128
    s_lshl_b32 s36, s44, 4
    s_add_u32 s36, s36, 1
    v_add_u32 v128, s36, v128
    v_bfe_u32 v129, v64, 2, 1
    v_lshlrev_b32 v131, 3, v65
    v_lshlrev_b32 v132, 5, v129
    v_mad_u32_u24 v133, v128, v131, v132
    v_mad_u32_u24 v136, v128, 0, v133
    v_mad_u32_u24 v137, v128, 1, v133
    v_mad_u32_u24 v138, v128, 2, v133
    v_mad_u32_u24 v139, v128, 3, v133
    v_mad_u32_u24 v140, v128, 4, v133
    v_mad_u32_u24 v141, v128, 5, v133
    v_mad_u32_u24 v142, v128, 6, v133
    v_mad_u32_u24 v143, v128, 7, v133
    v_and_b32 v136, 127, v136
    v_and_b32 v137, 127, v137
    v_and_b32 v138, 127, v138
    v_and_b32 v139, 127, v139
    v_and_b32 v140, 127, v140
    v_and_b32 v141, 127, v141
    v_and_b32 v142, 127, v142
    v_and_b32 v143, 127, v143
    v_cvt_f32_u32 v136, v136
    v_cvt_f32_u32 v137, v137
    v_cvt_f32_u32 v138, v138
    v_cvt_f32_u32 v139, v139
    v_cvt_f32_u32 v140, v140
    v_cvt_f32_u32 v141, v141
    v_cvt_f32_u32 v142, v142
    v_cvt_f32_u32 v143, v143
    v_mul_f32 v136, 0x3c000000, v136
    v_mul_f32 v137, 0x3c000000, v137
    v_mul_f32 v138, 0x3c000000, v138
    v_mul_f32 v139, 0x3c000000, v139
    v_mul_f32 v140, 0x3c000000, v140
    v_mul_f32 v141, 0x3c000000, v141
    v_mul_f32 v142, 0x3c000000, v142
    v_mul_f32 v143, 0x3c000000, v143
    v_cos_f32 v136, v136
    v_cos_f32 v137, v137
    v_cos_f32 v138, v138
    v_cos_f32 v139, v139
    v_cos_f32 v140, v140
    v_cos_f32 v141, v141
    v_cos_f32 v142, v142
    v_cos_f32 v143, v143
    s_nop 0
    v_cvt_pk_bf16_f32 v144, v136, v137
    v_cvt_pk_bf16_f32 v145, v138, v139
    v_cvt_pk_bf16_f32 v146, v140, v141
    v_cvt_pk_bf16_f32 v147, v142, v143
    v_lshlrev_b32 v152, 16, v144
    v_and_b32 v153, 0xffff0000, v144
    v_sub_f32 v136, v136, v152
    v_sub_f32 v137, v137, v153
    v_lshlrev_b32 v152, 16, v145
    v_and_b32 v153, 0xffff0000, v145
    v_sub_f32 v138, v138, v152
    v_sub_f32 v139, v139, v153
    v_lshlrev_b32 v152, 16, v146
    v_and_b32 v153, 0xffff0000, v146
    v_sub_f32 v140, v140, v152
    v_sub_f32 v141, v141, v153
    v_lshlrev_b32 v152, 16, v147
    v_and_b32 v153, 0xffff0000, v147
    v_sub_f32 v142, v142, v152
    v_sub_f32 v143, v143, v153
    v_cvt_pk_bf16_f32 v148, v136, v137
    v_cvt_pk_bf16_f32 v149, v138, v139
    v_cvt_pk_bf16_f32 v150, v140, v141
    v_cvt_pk_bf16_f32 v151, v142, v143
    s_lshl_b32 s37, s44, 12
    s_add_u32 s37, s37, 116736
    v_add_u32 v132, s37, v254
    ds_write_b128 v132, v[144:147]
    ds_write_b128 v132, v[148:151] offset:1024
    v_add_u32 v131, 32, v131
    v_lshlrev_b32 v132, 5, v129
    v_mad_u32_u24 v133, v128, v131, v132
    v_mad_u32_u24 v136, v128, 0, v133
    v_mad_u32_u24 v137, v128, 1, v133
    v_mad_u32_u24 v138, v128, 2, v133
    v_mad_u32_u24 v139, v128, 3, v133
    v_mad_u32_u24 v140, v128, 4, v133
    v_mad_u32_u24 v141, v128, 5, v133
    v_mad_u32_u24 v142, v128, 6, v133
    v_mad_u32_u24 v143, v128, 7, v133
    v_and_b32 v136, 127, v136
    v_and_b32 v137, 127, v137
    v_and_b32 v138, 127, v138
    v_and_b32 v139, 127, v139
    v_and_b32 v140, 127, v140
    v_and_b32 v141, 127, v141
    v_and_b32 v142, 127, v142
    v_and_b32 v143, 127, v143
    v_cvt_f32_u32 v136, v136
    v_cvt_f32_u32 v137, v137
    v_cvt_f32_u32 v138, v138
    v_cvt_f32_u32 v139, v139
    v_cvt_f32_u32 v140, v140
    v_cvt_f32_u32 v141, v141
    v_cvt_f32_u32 v142, v142
    v_cvt_f32_u32 v143, v143
    v_mul_f32 v136, 0x3c000000, v136
    v_mul_f32 v137, 0x3c000000, v137
    v_mul_f32 v138, 0x3c000000, v138
    v_mul_f32 v139, 0x3c000000, v139
    v_mul_f32 v140, 0x3c000000, v140
    v_mul_f32 v141, 0x3c000000, v141
    v_mul_f32 v142, 0x3c000000, v142
    v_mul_f32 v143, 0x3c000000, v143
    v_cos_f32 v136, v136
    v_cos_f32 v137, v137
    v_cos_f32 v138, v138
    v_cos_f32 v139, v139
    v_cos_f32 v140, v140
    v_cos_f32 v141, v141
    v_cos_f32 v142, v142
    v_cos_f32 v143, v143
    s_nop 0
    v_cvt_pk_bf16_f32 v144, v136, v137
    v_cvt_pk_bf16_f32 v145, v138, v139
    v_cvt_pk_bf16_f32 v146, v140, v141
    v_cvt_pk_bf16_f32 v147, v142, v143
    v_lshlrev_b32 v152, 16, v144
    v_and_b32 v153, 0xffff0000, v144
    v_sub_f32 v136, v136, v152
    v_sub_f32 v137, v137, v153
    v_lshlrev_b32 v152, 16, v145
    v_and_b32 v153, 0xffff0000, v145
    v_sub_f32 v138, v138, v152
    v_sub_f32 v139, v139, v153
    v_lshlrev_b32 v152, 16, v146
    v_and_b32 v153, 0xffff0000, v146
    v_sub_f32 v140, v140, v152
    v_sub_f32 v141, v141, v153
    v_lshlrev_b32 v152, 16, v147
    v_and_b32 v153, 0xffff0000, v147
    v_sub_f32 v142, v142, v152
    v_sub_f32 v143, v143, v153
    v_cvt_pk_bf16_f32 v148, v136, v137
    v_cvt_pk_bf16_f32 v149, v138, v139
    v_cvt_pk_bf16_f32 v150, v140, v141
    v_cvt_pk_bf16_f32 v151, v142, v143
    s_lshl_b32 s37, s44, 12
    s_add_u32 s37, s37, 118784
    v_add_u32 v132, s37, v254
    ds_write_b128 v132, v[144:147]
    ds_write_b128 v132, v[148:151] offset:1024
K12_TB:
    s_waitcnt lgkmcnt(0)
    s_barrier
    v_add_u32 v255, 116736, v254
    ds_read_b128 v[160:163], v255 offset:0
    ds_read_b128 v[192:195], v255 offset:1024
    ds_read_b128 v[164:167], v255 offset:2048
    ds_read_b128 v[196:199], v255 offset:3072
    ds_read_b128 v[168:171], v255 offset:4096
    ds_read_b128 v[200:203], v255 offset:5120
    ds_read_b128 v[172:175], v255 offset:6144
    ds_read_b128 v[204:207], v255 offset:7168
    s_waitcnt lgkmcnt(0)
    ds_read_b128 v[176:179], v255 offset:8192
    ds_read_b128 v[208:211], v255 offset:9216
    ds_read_b128 v[180:183], v255 offset:10240
    ds_read_b128 v[212:215], v255 offset:11264
    ds_read_b128 v[184:187], v255 offset:12288
    ds_read_b128 v[216:219], v255 offset:13312
    ds_read_b128 v[188:191], v255 offset:14336
    ds_read_b128 v[220:223], v255 offset:15360
    ds_read_b128 v[224:227], v255 offset:16384
    ds_read_b128 v[228:231], v255 offset:17408
    ds_read_b128 v[232:235], v255 offset:18432
    ds_read_b128 v[236:239], v255 offset:19456
    s_waitcnt lgkmcnt(0)
    s_barrier
    s_waitcnt vmcnt(0) lgkmcnt(0)
    s_mov_b32 s41, -1
    s_mov_b32 s34, -1
K12_PROD:
    s_cmp_eq_u32 s43, 0
    s_cbranch_scc1 K12_WENTRY
K12_XW:
    s_waitcnt vmcnt(0)
    s_mov_b32 s34, -1
    s_cmp_ge_u32 s41, 8
    s_cbranch_scc1 K12_SG0
    s_lshl_b32 s36, s41, 2
    s_add_u32 s37, s36, 155680
    s_mov_b64 exec, 1
    v_mov_b32 v255, s37
    v_mov_b32 v240, 1
    ds_add_rtn_u32 v240, v255, v240
    s_waitcnt lgkmcnt(0)
    v_readfirstlane_b32 s37, v240
    s_nop 3
    s_cmp_eq_u32 s37, 3
    s_cbranch_scc0 K12_SH0
    s_lshl_b32 s36, s36, 8
    v_mov_b32 v255, 1
    v_mov_b32 v240, s36
    buffer_atomic_add v255, v240, s[60:63], 0 offen sc0 sc1
    s_mov_b32 s34, s41
K12_SH0:
    s_mov_b64 exec, -1
K12_SG0:
    s_cmp_ge_u32 s34, 8
    s_cbranch_scc1 K12_EP1
    s_waitcnt vmcnt(0)
    s_cmp_ge_u32 s34, 8
    s_cbranch_scc1 K12_PB2
    v_readfirstlane_b32 s37, v255
    s_nop 3
    s_cmp_eq_u32 s37, 255
    s_cbranch_scc0 K12_PB2
    s_lshl_b32 s36, s34, 4
    s_add_u32 s36, s36, 16384
    s_mov_b64 exec, 1
    v_mov_b32 v255, 1
    v_mov_b32 v240, s36
    buffer_store_dword v255, v240, s[60:63], 0 offen sc1
    s_mov_b64 exec, -1
K12_PB2:
    s_mov_b32 s34, -1
K12_EP1:
    s_cmp_eq_u32 s27, 0
    s_cbranch_scc1 K12_XP_N
    v_perm_b32 v64, v4, v0, s28
    v_perm_b32 v68, v4, v0, s29
    v_perm_b32 v65, v12, v8, s28
    v_perm_b32 v69, v12, v8, s29
    v_perm_b32 v66, v20, v16, s28
    v_perm_b32 v70, v20, v16, s29
    v_perm_b32 v67, v28, v24, s28
    v_perm_b32 v71, v28, v24, s29
    v_perm_b32 v72, v5, v1, s28
    v_perm_b32 v76, v5, v1, s29
    v_perm_b32 v73, v13, v9, s28
    v_perm_b32 v77, v13, v9, s29
    v_perm_b32 v74, v21, v17, s28
    v_perm_b32 v78, v21, v17, s29
    v_perm_b32 v75, v29, v25, s28
    v_perm_b32 v79, v29, v25, s29
    v_perm_b32 v80, v6, v2, s28
    v_perm_b32 v84, v6, v2, s29
    v_perm_b32 v81, v14, v10, s28
    v_perm_b32 v85, v14, v10, s29
    v_perm_b32 v82, v22, v18, s28
    v_perm_b32 v86, v22, v18, s29
    v_perm_b32 v83, v30, v26, s28
    v_perm_b32 v87, v30, v26, s29
    v_perm_b32 v88, v7, v3, s28
    v_perm_b32 v92, v7, v3, s29
    v_perm_b32 v89, v15, v11, s28
    v_perm_b32 v93, v15, v11, s29
    v_perm_b32 v90, v23, v19, s28
    v_perm_b32 v94, v23, v19, s29
    v_perm_b32 v91, v31, v27, s28
    v_perm_b32 v95, v31, v27, s29
    v_perm_b32 v0, v36, v32, s28
    v_perm_b32 v4, v36, v32, s29
    v_perm_b32 v1, v44, v40, s28
    v_perm_b32 v5, v44, v40, s29
    v_perm_b32 v2, v52, v48, s28
    v_perm_b32 v6, v52, v48, s29
    v_perm_b32 v3, v60, v56, s28
    v_perm_b32 v7, v60, v56, s29
    v_perm_b32 v8, v37, v33, s28
    v_perm_b32 v12, v37, v33, s29
    v_perm_b32 v9, v45, v41, s28
    v_perm_b32 v13, v45, v41, s29
    v_perm_b32 v10, v53, v49, s28
    v_perm_b32 v14, v53, v49, s29
    v_perm_b32 v11, v61, v57, s28
    v_perm_b32 v15, v61, v57, s29
    v_perm_b32 v16, v38, v34, s28
    v_perm_b32 v20, v38, v34, s29
    v_perm_b32 v17, v46, v42, s28
    v_perm_b32 v21, v46, v42, s29
    v_perm_b32 v18, v54, v50, s28
    v_perm_b32 v22, v54, v50, s29
    v_perm_b32 v19, v62, v58, s28
    v_perm_b32 v23, v62, v58, s29
    v_perm_b32 v24, v39, v35, s28
    v_perm_b32 v28, v39, v35, s29
    v_perm_b32 v25, v47, v43, s28
    v_perm_b32 v29, v47, v43, s29
    v_perm_b32 v26, v55, v51, s28
    v_perm_b32 v30, v55, v51, s29
    v_perm_b32 v27, v63, v59, s28
    v_perm_b32 v31, v63, v59, s29
K12_XP_N:
    s_lshl_b32 s36, s40, 3
    s_sub_i32 s36, s36, 24
    s_max_i32 s36, s36, 1
    s_mov_b32 s37, 131072
K12_GL0:
    v_mov_b32 v240, 155648
    ds_read_b32 v240, v240
    s_waitcnt lgkmcnt(0)
    v_cmp_gt_u32 vcc, s36, v240
    s_sub_u32 s37, s37, 1
    s_cmp_eq_u32 s37, 0
    s_cbranch_scc1 K12_GT0
    s_cbranch_vccz K12_GT0
    s_sleep 2
    s_branch K12_GL0
K12_GT0:
    s_lshl_b32 s36, s40, 2
    s_add_u32 s36, s36, 155840
    s_mov_b64 exec, 1
    v_mov_b32 v240, s36
    v_mov_b32 v241, 1
    ds_add_u32 v240, v241
    s_mov_b64 exec, -1
    s_mov_b32 s37, 131072
K12_BL1:
    v_mov_b32 v240, s36
    ds_read_b32 v240, v240
    s_waitcnt lgkmcnt(0)
    v_cmp_gt_u32 vcc, 4, v240
    s_sub_u32 s37, s37, 1
    s_cmp_eq_u32 s37, 0
    s_cbranch_scc1 K12_BT1
    s_cbranch_vccz K12_BT1
    s_sleep 1
    s_branch K12_BL1
K12_BT1:
    s_add_u32 s42, s40, 1
    s_lshl_b32 s36, s42, 7
    s_add_u32 s36, s36, s22
    s_lshr_b32 s37, s36, 9
    s_lshl_b32 s37, s37, 19
    s_and_b32 s36, s36, 511
    s_lshl_b32 s36, s36, 10
    s_add_u32 s36, s36, s37
    s_add_u32 s36, s36, s33
    buffer_load_dwordx4 v[96:99], v250, s[8:11], s36 offen
    s_add_u32 s36, s36, 0x100000
    buffer_load_dwordx4 v[100:103], v250, s[8:11], s36 offen
    s_add_u32 s36, s36, 0x100000
    buffer_load_dwordx4 v[104:107], v250, s[8:11], s36 offen
    s_add_u32 s36, s36, 0x100000
    buffer_load_dwordx4 v[108:111], v250, s[8:11], s36 offen
    s_add_u32 s36, s36, 0x100000
    buffer_load_dwordx4 v[112:115], v250, s[8:11], s36 offen
    s_add_u32 s36, s36, 0x100000
    buffer_load_dwordx4 v[116:119], v250, s[8:11], s36 offen
    s_add_u32 s36, s36, 0x100000
    buffer_load_dwordx4 v[120:123], v250, s[8:11], s36 offen
    s_add_u32 s36, s36, 0x100000
    buffer_load_dwordx4 v[124:127], v250, s[8:11], s36 offen
    s_cmp_eq_u32 s27, 0
    s_cbranch_scc1 K12_XP_E
    s_mul_i32 s31, s25, 684032
    s_mul_i32 s39, s40, 85504
    s_add_u32 s39, s39, s31
    s_lshl_b32 s36, s30, 7
    s_add_u32 s39, s39, s36
    v_bfe_u32 v249, v254, 4, 2
    v_bfe_u32 v240, v254, 8, 1
    v_lshl_add_u32 v249, v240, 2, v249
    s_add_u32 s36, s30, 7
    s_cmp_ge_u32 s30, 160
    s_cselect_b32 s36, s36, s30
    s_cmp_eq_u32 s25, 1
    s_cselect_b32 s36, s36, s30
    s_lshr_b32 s36, s36, 1
    s_and_b32 s36, s36, 7
    v_xor_b32 v249, s36, v249
    v_lshl_add_u32 v249, v249, 4, v252
    s_cmp_eq_u32 s26, 2
    s_cselect_b32 s36, 21889024, 0
    s_add_u32 s39, s39, s36
    s_cmp_eq_u32 s26, 2
    s_cbranch_scc1 K12_XS1589_HI
    s_setprio 1
    v_mfma_f32_16x16x32_bf16 v[32:35], v[160:163], v[64:67], 0
    v_mfma_f32_16x16x32_bf16 v[36:39], v[160:163], v[68:71], 0
    v_mfma_f32_16x16x32_bf16 v[40:43], v[160:163], v[72:75], 0
    v_mfma_f32_16x16x32_bf16 v[44:47], v[160:163], v[76:79], 0
    v_mfma_f32_16x16x32_bf16 v[48:51], v[160:163], v[80:83], 0
    v_mfma_f32_16x16x32_bf16 v[52:55], v[160:163], v[84:87], 0
    v_mfma_f32_16x16x32_bf16 v[56:59], v[160:163], v[88:91], 0
    v_mfma_f32_16x16x32_bf16 v[60:63], v[160:163], v[92:95], 0
    v_mfma_f32_16x16x32_bf16 v[32:35], v[192:195], v[64:67], v[32:35]
    v_mfma_f32_16x16x32_bf16 v[36:39], v[192:195], v[68:71], v[36:39]
    v_mfma_f32_16x16x32_bf16 v[40:43], v[192:195], v[72:75], v[40:43]
    v_mfma_f32_16x16x32_bf16 v[44:47], v[192:195], v[76:79], v[44:47]
    v_mfma_f32_16x16x32_bf16 v[48:51], v[192:195], v[80:83], v[48:51]
    v_mfma_f32_16x16x32_bf16 v[52:55], v[192:195], v[84:87], v[52:55]
    v_mfma_f32_16x16x32_bf16 v[56:59], v[192:195], v[88:91], v[56:59]
    v_mfma_f32_16x16x32_bf16 v[60:63], v[192:195], v[92:95], v[60:63]
    v_mfma_f32_16x16x32_bf16 v[32:35], v[164:167], v[0:3], v[32:35]
    v_mfma_f32_16x16x32_bf16 v[36:39], v[164:167], v[4:7], v[36:39]
    v_mfma_f32_16x16x32_bf16 v[40:43], v[164:167], v[8:11], v[40:43]
    v_mfma_f32_16x16x32_bf16 v[44:47], v[164:167], v[12:15], v[44:47]
    v_mfma_f32_16x16x32_bf16 v[48:51], v[164:167], v[16:19], v[48:51]
    v_mfma_f32_16x16x32_bf16 v[52:55], v[164:167], v[20:23], v[52:55]
    v_mfma_f32_16x16x32_bf16 v[56:59], v[164:167], v[24:27], v[56:59]
    v_mfma_f32_16x16x32_bf16 v[60:63], v[164:167], v[28:31], v[60:63]
    v_mfma_f32_16x16x32_bf16 v[32:35], v[196:199], v[0:3], v[32:35]
    v_mfma_f32_16x16x32_bf16 v[36:39], v[196:199], v[4:7], v[36:39]
    v_mfma_f32_16x16x32_bf16 v[40:43], v[196:199], v[8:11], v[40:43]
    v_mfma_f32_16x16x32_bf16 v[44:47], v[196:199], v[12:15], v[44:47]
    v_mfma_f32_16x16x32_bf16 v[48:51], v[196:199], v[16:19], v[48:51]
    v_mfma_f32_16x16x32_bf16 v[52:55], v[196:199], v[20:23], v[52:55]
    v_mfma_f32_16x16x32_bf16 v[56:59], v[196:199], v[24:27], v[56:59]
    v_mfma_f32_16x16x32_bf16 v[60:63], v[196:199], v[28:31], v[60:63]
    s_setprio 0
    s_nop 7
    v_cvt_pk_bf16_f32 v240, v32, v36
    v_cvt_pk_bf16_f32 v241, v40, v44
    v_cvt_pk_bf16_f32 v242, v48, v52
    v_cvt_pk_bf16_f32 v243, v56, v60
    buffer_store_dwordx4 v[240:243], v249, s[12:15], s39 offen sc1
    s_add_u32 s39, s39, 2736128
    v_cvt_pk_bf16_f32 v244, v33, v37
    v_cvt_pk_bf16_f32 v245, v41, v45
    v_cvt_pk_bf16_f32 v246, v49, v53
    v_cvt_pk_bf16_f32 v247, v57, v61
    buffer_store_dwordx4 v[244:247], v249, s[12:15], s39 offen sc1
    s_add_u32 s39, s39, 2736128
    v_cvt_pk_bf16_f32 v240, v34, v38
    v_cvt_pk_bf16_f32 v241, v42, v46
    v_cvt_pk_bf16_f32 v242, v50, v54
    v_cvt_pk_bf16_f32 v243, v58, v62
    buffer_store_dwordx4 v[240:243], v249, s[12:15], s39 offen sc1
    s_add_u32 s39, s39, 2736128
    v_cvt_pk_bf16_f32 v244, v35, v39
    v_cvt_pk_bf16_f32 v245, v43, v47
    v_cvt_pk_bf16_f32 v246, v51, v55
    v_cvt_pk_bf16_f32 v247, v59, v63
    buffer_store_dwordx4 v[244:247], v249, s[12:15], s39 offen sc1
    s_add_u32 s39, s39, 2736128
    s_cmp_lg_u32 s26, 1
    s_cbranch_scc1 K12_UT0
    s_cmp_lt_u32 s40, 4
    s_cbranch_scc1 K12_UT0
    s_lshl_b32 s36, s40, 3
    s_sub_i32 s36, s36, 20
    s_max_i32 s36, s36, 1
    s_mov_b32 s37, 131072
K12_UL0:
    v_mov_b32 v240, 155648
    ds_read_b32 v240, v240
    s_waitcnt lgkmcnt(0)
    v_cmp_gt_u32 vcc, s36, v240
    s_sub_u32 s37, s37, 1
    s_cmp_eq_u32 s37, 0
    s_cbranch_scc1 K12_UT0
    s_cbranch_vccz K12_UT0
    s_sleep 2
    s_branch K12_UL0
K12_UT0:
    s_setprio 1
    v_mfma_f32_16x16x32_bf16 v[32:35], v[168:171], v[64:67], 0
    v_mfma_f32_16x16x32_bf16 v[36:39], v[168:171], v[68:71], 0
    v_mfma_f32_16x16x32_bf16 v[40:43], v[168:171], v[72:75], 0
    v_mfma_f32_16x16x32_bf16 v[44:47], v[168:171], v[76:79], 0
    v_mfma_f32_16x16x32_bf16 v[48:51], v[168:171], v[80:83], 0
    v_mfma_f32_16x16x32_bf16 v[52:55], v[168:171], v[84:87], 0
    v_mfma_f32_16x16x32_bf16 v[56:59], v[168:171], v[88:91], 0
    v_mfma_f32_16x16x32_bf16 v[60:63], v[168:171], v[92:95], 0
    v_mfma_f32_16x16x32_bf16 v[32:35], v[200:203], v[64:67], v[32:35]
    v_mfma_f32_16x16x32_bf16 v[36:39], v[200:203], v[68:71], v[36:39]
    v_mfma_f32_16x16x32_bf16 v[40:43], v[200:203], v[72:75], v[40:43]
    v_mfma_f32_16x16x32_bf16 v[44:47], v[200:203], v[76:79], v[44:47]
    v_mfma_f32_16x16x32_bf16 v[48:51], v[200:203], v[80:83], v[48:51]
    v_mfma_f32_16x16x32_bf16 v[52:55], v[200:203], v[84:87], v[52:55]
    v_mfma_f32_16x16x32_bf16 v[56:59], v[200:203], v[88:91], v[56:59]
    v_mfma_f32_16x16x32_bf16 v[60:63], v[200:203], v[92:95], v[60:63]
    v_mfma_f32_16x16x32_bf16 v[32:35], v[172:175], v[0:3], v[32:35]
    v_mfma_f32_16x16x32_bf16 v[36:39], v[172:175], v[4:7], v[36:39]
    v_mfma_f32_16x16x32_bf16 v[40:43], v[172:175], v[8:11], v[40:43]
    v_mfma_f32_16x16x32_bf16 v[44:47], v[172:175], v[12:15], v[44:47]
    v_mfma_f32_16x16x32_bf16 v[48:51], v[172:175], v[16:19], v[48:51]
    v_mfma_f32_16x16x32_bf16 v[52:55], v[172:175], v[20:23], v[52:55]
    v_mfma_f32_16x16x32_bf16 v[56:59], v[172:175], v[24:27], v[56:59]
    v_mfma_f32_16x16x32_bf16 v[60:63], v[172:175], v[28:31], v[60:63]
    v_mfma_f32_16x16x32_bf16 v[32:35], v[204:207], v[0:3], v[32:35]
    v_mfma_f32_16x16x32_bf16 v[36:39], v[204:207], v[4:7], v[36:39]
    v_mfma_f32_16x16x32_bf16 v[40:43], v[204:207], v[8:11], v[40:43]
    v_mfma_f32_16x16x32_bf16 v[44:47], v[204:207], v[12:15], v[44:47]
    v_mfma_f32_16x16x32_bf16 v[48:51], v[204:207], v[16:19], v[48:51]
    v_mfma_f32_16x16x32_bf16 v[52:55], v[204:207], v[20:23], v[52:55]
    v_mfma_f32_16x16x32_bf16 v[56:59], v[204:207], v[24:27], v[56:59]
    v_mfma_f32_16x16x32_bf16 v[60:63], v[204:207], v[28:31], v[60:63]
    s_setprio 0
    s_nop 7
    v_cvt_pk_bf16_f32 v240, v32, v36
    v_cvt_pk_bf16_f32 v241, v40, v44
    v_cvt_pk_bf16_f32 v242, v48, v52
    v_cvt_pk_bf16_f32 v243, v56, v60
    buffer_store_dwordx4 v[240:243], v249, s[12:15], s39 offen sc1
    s_add_u32 s39, s39, 2736128
    v_cvt_pk_bf16_f32 v244, v33, v37
    v_cvt_pk_bf16_f32 v245, v41, v45
    v_cvt_pk_bf16_f32 v246, v49, v53
    v_cvt_pk_bf16_f32 v247, v57, v61
    buffer_store_dwordx4 v[244:247], v249, s[12:15], s39 offen sc1
    s_add_u32 s39, s39, 2736128
    v_cvt_pk_bf16_f32 v240, v34, v38
    v_cvt_pk_bf16_f32 v241, v42, v46
    v_cvt_pk_bf16_f32 v242, v50, v54
    v_cvt_pk_bf16_f32 v243, v58, v62
    buffer_store_dwordx4 v[240:243], v249, s[12:15], s39 offen sc1
    s_add_u32 s39, s39, 2736128
    v_cvt_pk_bf16_f32 v244, v35, v39
    v_cvt_pk_bf16_f32 v245, v43, v47
    v_cvt_pk_bf16_f32 v246, v51, v55
    v_cvt_pk_bf16_f32 v247, v59, v63
    buffer_store_dwordx4 v[244:247], v249, s[12:15], s39 offen sc1
    s_add_u32 s39, s39, 2736128
    s_cmp_eq_u32 s26, 1
    s_cbranch_scc1 K12_XS1589_END
    s_cmp_lg_u32 s26, 0
    s_cbranch_scc1 K12_UT1
    s_cmp_lt_u32 s40, 4
    s_cbranch_scc1 K12_UT1
    s_lshl_b32 s36, s40, 3
    s_sub_i32 s36, s36, 20
    s_max_i32 s36, s36, 1
    s_mov_b32 s37, 131072
K12_UL1:
    v_mov_b32 v240, 155648
    ds_read_b32 v240, v240
    s_waitcnt lgkmcnt(0)
    v_cmp_gt_u32 vcc, s36, v240
    s_sub_u32 s37, s37, 1
    s_cmp_eq_u32 s37, 0
    s_cbranch_scc1 K12_UT1
    s_cbranch_vccz K12_UT1
    s_sleep 2
    s_branch K12_UL1
K12_UT1:
K12_XS1589_HI:
    s_setprio 1
    v_mfma_f32_16x16x32_bf16 v[32:35], v[176:179], v[64:67], 0
    v_mfma_f32_16x16x32_bf16 v[36:39], v[176:179], v[68:71], 0
    v_mfma_f32_16x16x32_bf16 v[40:43], v[176:179], v[72:75], 0
    v_mfma_f32_16x16x32_bf16 v[44:47], v[176:179], v[76:79], 0
    v_mfma_f32_16x16x32_bf16 v[48:51], v[176:179], v[80:83], 0
    v_mfma_f32_16x16x32_bf16 v[52:55], v[176:179], v[84:87], 0
    v_mfma_f32_16x16x32_bf16 v[56:59], v[176:179], v[88:91], 0
    v_mfma_f32_16x16x32_bf16 v[60:63], v[176:179], v[92:95], 0
    v_mfma_f32_16x16x32_bf16 v[32:35], v[208:211], v[64:67], v[32:35]
    v_mfma_f32_16x16x32_bf16 v[36:39], v[208:211], v[68:71], v[36:39]
    v_mfma_f32_16x16x32_bf16 v[40:43], v[208:211], v[72:75], v[40:43]
    v_mfma_f32_16x16x32_bf16 v[44:47], v[208:211], v[76:79], v[44:47]
    v_mfma_f32_16x16x32_bf16 v[48:51], v[208:211], v[80:83], v[48:51]
    v_mfma_f32_16x16x32_bf16 v[52:55], v[208:211], v[84:87], v[52:55]
    v_mfma_f32_16x16x32_bf16 v[56:59], v[208:211], v[88:91], v[56:59]
    v_mfma_f32_16x16x32_bf16 v[60:63], v[208:211], v[92:95], v[60:63]
    v_mfma_f32_16x16x32_bf16 v[32:35], v[180:183], v[0:3], v[32:35]
    v_mfma_f32_16x16x32_bf16 v[36:39], v[180:183], v[4:7], v[36:39]
    v_mfma_f32_16x16x32_bf16 v[40:43], v[180:183], v[8:11], v[40:43]
    v_mfma_f32_16x16x32_bf16 v[44:47], v[180:183], v[12:15], v[44:47]
    v_mfma_f32_16x16x32_bf16 v[48:51], v[180:183], v[16:19], v[48:51]
    v_mfma_f32_16x16x32_bf16 v[52:55], v[180:183], v[20:23], v[52:55]
    v_mfma_f32_16x16x32_bf16 v[56:59], v[180:183], v[24:27], v[56:59]
    v_mfma_f32_16x16x32_bf16 v[60:63], v[180:183], v[28:31], v[60:63]
    v_mfma_f32_16x16x32_bf16 v[32:35], v[212:215], v[0:3], v[32:35]
    v_mfma_f32_16x16x32_bf16 v[36:39], v[212:215], v[4:7], v[36:39]
    v_mfma_f32_16x16x32_bf16 v[40:43], v[212:215], v[8:11], v[40:43]
    v_mfma_f32_16x16x32_bf16 v[44:47], v[212:215], v[12:15], v[44:47]
    v_mfma_f32_16x16x32_bf16 v[48:51], v[212:215], v[16:19], v[48:51]
    v_mfma_f32_16x16x32_bf16 v[52:55], v[212:215], v[20:23], v[52:55]
    v_mfma_f32_16x16x32_bf16 v[56:59], v[212:215], v[24:27], v[56:59]
    v_mfma_f32_16x16x32_bf16 v[60:63], v[212:215], v[28:31], v[60:63]
    s_setprio 0
    s_nop 7
    v_cvt_pk_bf16_f32 v240, v32, v36
    v_cvt_pk_bf16_f32 v241, v40, v44
    v_cvt_pk_bf16_f32 v242, v48, v52
    v_cvt_pk_bf16_f32 v243, v56, v60
    buffer_store_dwordx4 v[240:243], v249, s[12:15], s39 offen sc1
    s_add_u32 s39, s39, 2736128
    v_cvt_pk_bf16_f32 v244, v33, v37
    v_cvt_pk_bf16_f32 v245, v41, v45
    v_cvt_pk_bf16_f32 v246, v49, v53
    v_cvt_pk_bf16_f32 v247, v57, v61
    buffer_store_dwordx4 v[244:247], v249, s[12:15], s39 offen sc1
    s_add_u32 s39, s39, 2736128
    v_cvt_pk_bf16_f32 v240, v34, v38
    v_cvt_pk_bf16_f32 v241, v42, v46
    v_cvt_pk_bf16_f32 v242, v50, v54
    v_cvt_pk_bf16_f32 v243, v58, v62
    buffer_store_dwordx4 v[240:243], v249, s[12:15], s39 offen sc1
    s_add_u32 s39, s39, 2736128
    v_cvt_pk_bf16_f32 v244, v35, v39
    v_cvt_pk_bf16_f32 v245, v43, v47
    v_cvt_pk_bf16_f32 v246, v51, v55
    v_cvt_pk_bf16_f32 v247, v59, v63
    buffer_store_dwordx4 v[244:247], v249, s[12:15], s39 offen sc1
    s_add_u32 s39, s39, 2736128
    s_cmp_lg_u32 s26, 2
    s_cbranch_scc1 K12_UT2
    s_cmp_lt_u32 s40, 4
    s_cbranch_scc1 K12_UT2
    s_lshl_b32 s36, s40, 3
    s_sub_i32 s36, s36, 20
    s_max_i32 s36, s36, 1
    s_mov_b32 s37, 131072
K12_UL2:
    v_mov_b32 v240, 155648
    ds_read_b32 v240, v240
    s_waitcnt lgkmcnt(0)
    v_cmp_gt_u32 vcc, s36, v240
    s_sub_u32 s37, s37, 1
    s_cmp_eq_u32 s37, 0
    s_cbranch_scc1 K12_UT2
    s_cbranch_vccz K12_UT2
    s_sleep 2
    s_branch K12_UL2
K12_UT2:
    s_setprio 1
    v_mfma_f32_16x16x32_bf16 v[32:35], v[184:187], v[64:67], 0
    v_mfma_f32_16x16x32_bf16 v[36:39], v[184:187], v[68:71], 0
    v_mfma_f32_16x16x32_bf16 v[40:43], v[184:187], v[72:75], 0
    v_mfma_f32_16x16x32_bf16 v[44:47], v[184:187], v[76:79], 0
    v_mfma_f32_16x16x32_bf16 v[48:51], v[184:187], v[80:83], 0
    v_mfma_f32_16x16x32_bf16 v[52:55], v[184:187], v[84:87], 0
    v_mfma_f32_16x16x32_bf16 v[56:59], v[184:187], v[88:91], 0
    v_mfma_f32_16x16x32_bf16 v[60:63], v[184:187], v[92:95], 0
    v_mfma_f32_16x16x32_bf16 v[32:35], v[216:219], v[64:67], v[32:35]
    v_mfma_f32_16x16x32_bf16 v[36:39], v[216:219], v[68:71], v[36:39]
    v_mfma_f32_16x16x32_bf16 v[40:43], v[216:219], v[72:75], v[40:43]
    v_mfma_f32_16x16x32_bf16 v[44:47], v[216:219], v[76:79], v[44:47]
    v_mfma_f32_16x16x32_bf16 v[48:51], v[216:219], v[80:83], v[48:51]
    v_mfma_f32_16x16x32_bf16 v[52:55], v[216:219], v[84:87], v[52:55]
    v_mfma_f32_16x16x32_bf16 v[56:59], v[216:219], v[88:91], v[56:59]
    v_mfma_f32_16x16x32_bf16 v[60:63], v[216:219], v[92:95], v[60:63]
    v_mfma_f32_16x16x32_bf16 v[32:35], v[188:191], v[0:3], v[32:35]
    v_mfma_f32_16x16x32_bf16 v[36:39], v[188:191], v[4:7], v[36:39]
    v_mfma_f32_16x16x32_bf16 v[40:43], v[188:191], v[8:11], v[40:43]
    v_mfma_f32_16x16x32_bf16 v[44:47], v[188:191], v[12:15], v[44:47]
    v_mfma_f32_16x16x32_bf16 v[48:51], v[188:191], v[16:19], v[48:51]
    v_mfma_f32_16x16x32_bf16 v[52:55], v[188:191], v[20:23], v[52:55]
    v_mfma_f32_16x16x32_bf16 v[56:59], v[188:191], v[24:27], v[56:59]
    v_mfma_f32_16x16x32_bf16 v[60:63], v[188:191], v[28:31], v[60:63]
    v_mfma_f32_16x16x32_bf16 v[32:35], v[220:223], v[0:3], v[32:35]
    v_mfma_f32_16x16x32_bf16 v[36:39], v[220:223], v[4:7], v[36:39]
    v_mfma_f32_16x16x32_bf16 v[40:43], v[220:223], v[8:11], v[40:43]
    v_mfma_f32_16x16x32_bf16 v[44:47], v[220:223], v[12:15], v[44:47]
    v_mfma_f32_16x16x32_bf16 v[48:51], v[220:223], v[16:19], v[48:51]
    v_mfma_f32_16x16x32_bf16 v[52:55], v[220:223], v[20:23], v[52:55]
    v_mfma_f32_16x16x32_bf16 v[56:59], v[220:223], v[24:27], v[56:59]
    v_mfma_f32_16x16x32_bf16 v[60:63], v[220:223], v[28:31], v[60:63]
    s_setprio 0
    s_nop 7
    v_cvt_pk_bf16_f32 v240, v32, v36
    v_cvt_pk_bf16_f32 v241, v40, v44
    v_cvt_pk_bf16_f32 v242, v48, v52
    v_cvt_pk_bf16_f32 v243, v56, v60
    buffer_store_dwordx4 v[240:243], v249, s[12:15], s39 offen sc1
    s_add_u32 s39, s39, 2736128
    v_cvt_pk_bf16_f32 v244, v33, v37
    v_cvt_pk_bf16_f32 v245, v41, v45
    v_cvt_pk_bf16_f32 v246, v49, v53
    v_cvt_pk_bf16_f32 v247, v57, v61
    buffer_store_dwordx4 v[244:247], v249, s[12:15], s39 offen sc1
    s_add_u32 s39, s39, 2736128
    v_cvt_pk_bf16_f32 v240, v34, v38
    v_cvt_pk_bf16_f32 v241, v42, v46
    v_cvt_pk_bf16_f32 v242, v50, v54
    v_cvt_pk_bf16_f32 v243, v58, v62
    buffer_store_dwordx4 v[240:243], v249, s[12:15], s39 offen sc1
    s_add_u32 s39, s39, 2736128
    v_cvt_pk_bf16_f32 v244, v35, v39
    v_cvt_pk_bf16_f32 v245, v43, v47
    v_cvt_pk_bf16_f32 v246, v51, v55
    v_cvt_pk_bf16_f32 v247, v59, v63
    buffer_store_dwordx4 v[244:247], v249, s[12:15], s39 offen sc1
K12_XS1589_END:
    s_mov_b32 s41, s40
    s_add_u32 s40, s40, 1
    s_cmp_eq_u32 s41, 3
    s_cbranch_scc0 K12_ES3
    s_waitcnt vmcnt(0)
    s_mov_b32 s34, -1
    s_cmp_ge_u32 s41, 8
    s_cbranch_scc1 K12_SG4
    s_lshl_b32 s36, s41, 2
    s_add_u32 s37, s36, 155680
    s_mov_b64 exec, 1
    v_mov_b32 v255, s37
    v_mov_b32 v240, 1
    ds_add_rtn_u32 v240, v255, v240
    s_waitcnt lgkmcnt(0)
    v_readfirstlane_b32 s37, v240
    s_nop 3
    s_cmp_eq_u32 s37, 3
    s_cbranch_scc0 K12_SH4
    s_lshl_b32 s36, s36, 8
    v_mov_b32 v255, 1
    v_mov_b32 v240, s36
    buffer_atomic_add v255, v240, s[60:63], 0 offen sc0 sc1
    s_mov_b32 s34, s41
K12_SH4:
    s_mov_b64 exec, -1
K12_SG4:
    s_waitcnt vmcnt(0)
    s_cmp_ge_u32 s34, 8
    s_cbranch_scc1 K12_PB5
    v_readfirstlane_b32 s37, v255
    s_nop 3
    s_cmp_eq_u32 s37, 255
    s_cbranch_scc0 K12_PB5
    s_lshl_b32 s36, s34, 4
    s_add_u32 s36, s36, 16384
    s_mov_b64 exec, 1
    v_mov_b32 v255, 1
    v_mov_b32 v240, s36
    buffer_store_dword v255, v240, s[60:63], 0 offen sc1
    s_mov_b64 exec, -1
K12_PB5:
    s_mov_b32 s34, -1
    s_mov_b32 s41, -1
K12_ES3:
    s_waitcnt vmcnt(8)
    s_branch K12_XP_F
K12_XP_E:
    s_mov_b32 s41, s40
    s_add_u32 s40, s40, 1
    s_cmp_eq_u32 s41, 3
    s_cbranch_scc0 K12_ES6
    s_waitcnt vmcnt(0)
    s_mov_b32 s34, -1
    s_cmp_ge_u32 s41, 8
    s_cbranch_scc1 K12_SG7
    s_lshl_b32 s36, s41, 2
    s_add_u32 s37, s36, 155680
    s_mov_b64 exec, 1
    v_mov_b32 v255, s37
    v_mov_b32 v240, 1
    ds_add_rtn_u32 v240, v255, v240
    s_waitcnt lgkmcnt(0)
    v_readfirstlane_b32 s37, v240
    s_nop 3
    s_cmp_eq_u32 s37, 3
    s_cbranch_scc0 K12_SH7
    s_lshl_b32 s36, s36, 8
    v_mov_b32 v255, 1
    v_mov_b32 v240, s36
    buffer_atomic_add v255, v240, s[60:63], 0 offen sc0 sc1
    s_mov_b32 s34, s41
K12_SH7:
    s_mov_b64 exec, -1
K12_SG7:
    s_waitcnt vmcnt(0)
    s_cmp_ge_u32 s34, 8
    s_cbranch_scc1 K12_PB8
    v_readfirstlane_b32 s37, v255
    s_nop 3
    s_cmp_eq_u32 s37, 255
    s_cbranch_scc0 K12_PB8
    s_lshl_b32 s36, s34, 4
    s_add_u32 s36, s36, 16384
    s_mov_b64 exec, 1
    v_mov_b32 v255, 1
    v_mov_b32 v240, s36
    buffer_store_dword v255, v240, s[60:63], 0 offen sc1
    s_mov_b64 exec, -1
K12_PB8:
    s_mov_b32 s34, -1
    s_mov_b32 s41, -1
K12_ES6:
    s_waitcnt vmcnt(0)
K12_XP_F:
    s_cmp_ge_u32 s34, 8
    s_cbranch_scc1 K12_PB9
    v_readfirstlane_b32 s37, v255
    s_nop 3
    s_cmp_eq_u32 s37, 255
    s_cbranch_scc0 K12_PB9
    s_lshl_b32 s36, s34, 4
    s_add_u32 s36, s36, 16384
    s_mov_b64 exec, 1
    v_mov_b32 v255, 1
    v_mov_b32 v240, s36
    buffer_store_dword v255, v240, s[60:63], 0 offen sc1
    s_mov_b64 exec, -1
K12_PB9:
    s_cmp_ge_u32 s40, 8
    s_cbranch_scc1 K12_PFIN
K12_WENTRY:
    s_waitcnt vmcnt(0)
    s_mov_b32 s34, -1
    s_cmp_ge_u32 s41, 8
    s_cbranch_scc1 K12_SG10
    s_lshl_b32 s36, s41, 2
    s_add_u32 s37, s36, 155680
    s_mov_b64 exec, 1
    v_mov_b32 v255, s37
    v_mov_b32 v240, 1
    ds_add_rtn_u32 v240, v255, v240
    s_waitcnt lgkmcnt(0)
    v_readfirstlane_b32 s37, v240
    s_nop 3
    s_cmp_eq_u32 s37, 3
    s_cbranch_scc0 K12_SH10
    s_lshl_b32 s36, s36, 8
    v_mov_b32 v255, 1
    v_mov_b32 v240, s36
    buffer_atomic_add v255, v240, s[60:63], 0 offen sc0 sc1
    s_mov_b32 s34, s41
K12_SH10:
    s_mov_b64 exec, -1
K12_SG10:
    s_cmp_ge_u32 s34, 8
    s_cbranch_scc1 K12_EP11
    s_waitcnt vmcnt(0)
    s_cmp_ge_u32 s34, 8
    s_cbranch_scc1 K12_PB12
    v_readfirstlane_b32 s37, v255
    s_nop 3
    s_cmp_eq_u32 s37, 255
    s_cbranch_scc0 K12_PB12
    s_lshl_b32 s36, s34, 4
    s_add_u32 s36, s36, 16384
    s_mov_b64 exec, 1
    v_mov_b32 v255, 1
    v_mov_b32 v240, s36
    buffer_store_dword v255, v240, s[60:63], 0 offen sc1
    s_mov_b64 exec, -1
K12_PB12:
    s_mov_b32 s34, -1
K12_EP11:
    v_perm_b32 v64, v100, v96, s28
    v_perm_b32 v68, v100, v96, s29
    v_perm_b32 v65, v108, v104, s28
    v_perm_b32 v69, v108, v104, s29
    v_perm_b32 v66, v116, v112, s28
    v_perm_b32 v70, v116, v112, s29
    v_perm_b32 v67, v124, v120, s28
    v_perm_b32 v71, v124, v120, s29
    v_perm_b32 v72, v101, v97, s28
    v_perm_b32 v76, v101, v97, s29
    v_perm_b32 v73, v109, v105, s28
    v_perm_b32 v77, v109, v105, s29
    v_perm_b32 v74, v117, v113, s28
    v_perm_b32 v78, v117, v113, s29
    v_perm_b32 v75, v125, v121, s28
    v_perm_b32 v79, v125, v121, s29
    v_perm_b32 v80, v102, v98, s28
    v_perm_b32 v84, v102, v98, s29
    v_perm_b32 v81, v110, v106, s28
    v_perm_b32 v85, v110, v106, s29
    v_perm_b32 v82, v118, v114, s28
    v_perm_b32 v86, v118, v114, s29
    v_perm_b32 v83, v126, v122, s28
    v_perm_b32 v87, v126, v122, s29
    v_perm_b32 v88, v103, v99, s28
    v_perm_b32 v92, v103, v99, s29
    v_perm_b32 v89, v111, v107, s28
    v_perm_b32 v93, v111, v107, s29
    v_perm_b32 v90, v119, v115, s28
    v_perm_b32 v94, v119, v115, s29
    v_perm_b32 v91, v127, v123, s28
    v_perm_b32 v95, v127, v123, s29
    s_lshl_b32 s36, s40, 3
    s_sub_i32 s36, s36, 24
    s_max_i32 s36, s36, 1
    s_mov_b32 s37, 131072
K12_GL2:
    v_mov_b32 v240, 155648
    ds_read_b32 v240, v240
    s_waitcnt lgkmcnt(0)
    v_cmp_gt_u32 vcc, s36, v240
    s_sub_u32 s37, s37, 1
    s_cmp_eq_u32 s37, 0
    s_cbranch_scc1 K12_GT2
    s_cbranch_vccz K12_GT2
    s_sleep 2
    s_branch K12_GL2
K12_GT2:
    s_lshl_b32 s36, s40, 2
    s_add_u32 s36, s36, 155840
    s_mov_b64 exec, 1
    v_mov_b32 v240, s36
    v_mov_b32 v241, 1
    ds_add_u32 v240, v241
    s_mov_b64 exec, -1
    s_mov_b32 s37, 131072
K12_BL3:
    v_mov_b32 v240, s36
    ds_read_b32 v240, v240
    s_waitcnt lgkmcnt(0)
    v_cmp_gt_u32 vcc, 4, v240
    s_sub_u32 s37, s37, 1
    s_cmp_eq_u32 s37, 0
    s_cbranch_scc1 K12_BT3
    s_cbranch_vccz K12_BT3
    s_sleep 1
    s_branch K12_BL3
K12_BT3:
    s_add_u32 s42, s40, 1
    s_mul_i32 s36, s42, 85
    s_add_u32 s36, s36, s2
    s_and_b32 s36, s36, 255
    s_mul_hi_u32 s37, s36, 0x55555556
    s_mul_i32 s38, s37, 3
    s_cmp_eq_u32 s38, s36
    s_cselect_b32 s27, 1, 0
    s_cmp_lt_u32 s37, 78
    s_cselect_b32 s27, s27, 0
    s_add_u32 s37, s37, 89
    s_add_u32 s26, s21, 1
    s_cmp_eq_u32 s27, 1
    s_cselect_b32 s26, 0, s26
    s_and_b32 s36, s27, s21
    s_cselect_b32 s30, s37, s24
    s_cselect_b32 s25, 1, s49
    s_mov_b32 s27, 1
    s_cmp_eq_u32 s27, 0
    s_cbranch_scc1 K12_WP_N
    s_mul_i32 s36, s25, 16384000
    s_add_u32 s4, s52, s36
    s_addc_u32 s5, s53, 0
    s_and_b32 s5, s5, 0xffff
    s_lshl_b32 s36, s42, 8
    s_mul_i32 s37, s30, 98304
    s_add_u32 s36, s36, s37
    buffer_load_dwordx4 v[0:3], v248, s[4:7], s36 offen
    buffer_load_dwordx4 v[4:7], v248, s[4:7], s36 offen offset:2048
    s_add_u32 s36, s36, 4096
    buffer_load_dwordx4 v[8:11], v248, s[4:7], s36 offen
    buffer_load_dwordx4 v[12:15], v248, s[4:7], s36 offen offset:2048
    s_add_u32 s36, s36, 4096
    buffer_load_dwordx4 v[16:19], v248, s[4:7], s36 offen
    buffer_load_dwordx4 v[20:23], v248, s[4:7], s36 offen offset:2048
    s_add_u32 s36, s36, 4096
    buffer_load_dwordx4 v[24:27], v248, s[4:7], s36 offen
    buffer_load_dwordx4 v[28:31], v248, s[4:7], s36 offen offset:2048
    s_add_u32 s36, s36, 53248
    buffer_load_dwordx4 v[32:35], v248, s[4:7], s36 offen
    buffer_load_dwordx4 v[36:39], v248, s[4:7], s36 offen offset:2048
    s_add_u32 s36, s36, 4096
    buffer_load_dwordx4 v[40:43], v248, s[4:7], s36 offen
    buffer_load_dwordx4 v[44:47], v248, s[4:7], s36 offen offset:2048
    s_add_u32 s36, s36, 4096
    buffer_load_dwordx4 v[48:51], v248, s[4:7], s36 offen
    buffer_load_dwordx4 v[52:55], v248, s[4:7], s36 offen offset:2048
    s_add_u32 s36, s36, 4096
    buffer_load_dwordx4 v[56:59], v248, s[4:7], s36 offen
    buffer_load_dwordx4 v[60:63], v248, s[4:7], s36 offen offset:2048
    s_branch K12_WP_M
K12_WP_N:
K12_WP_M:
    s_lshl_b32 s36, s40, 7
    s_add_u32 s36, s36, s22
    s_and_b32 s37, s36, 3
    s_lshr_b32 s38, s36, 1
    s_and_b32 s38, s38, 4
    s_or_b32 s37, s37, s38
    v_bfe_u32 v253, v254, 5, 3
    v_xor_b32 v253, s37, v253
    v_lshl_add_u32 v253, v253, 5, v251
    s_lshl_b32 s36, s36, 9
    s_add_u32 s39, s36, s32
    s_setprio 1
    v_mfma_f32_16x16x32_bf16 v[128:131], v[224:227], v[64:67], 0
    v_mfma_f32_16x16x32_bf16 v[132:135], v[224:227], v[68:71], 0
    v_mfma_f32_16x16x32_bf16 v[136:139], v[224:227], v[72:75], 0
    v_mfma_f32_16x16x32_bf16 v[140:143], v[224:227], v[76:79], 0
    v_mfma_f32_16x16x32_bf16 v[144:147], v[224:227], v[80:83], 0
    v_mfma_f32_16x16x32_bf16 v[148:151], v[224:227], v[84:87], 0
    v_mfma_f32_16x16x32_bf16 v[152:155], v[224:227], v[88:91], 0
    v_mfma_f32_16x16x32_bf16 v[156:159], v[224:227], v[92:95], 0
    s_setprio 0
    s_nop 7
    v_cvt_pk_bf16_f32 v240, v128, v132
    v_cvt_pk_bf16_f32 v241, v136, v140
    v_cvt_pk_bf16_f32 v242, v144, v148
    v_cvt_pk_bf16_f32 v243, v152, v156
    buffer_store_dwordx4 v[240:243], v253, s[16:19], s39 offen sc1
    s_add_u32 s39, s39, 4194304
    v_cvt_pk_bf16_f32 v244, v129, v133
    v_cvt_pk_bf16_f32 v245, v137, v141
    v_cvt_pk_bf16_f32 v246, v145, v149
    v_cvt_pk_bf16_f32 v247, v153, v157
    buffer_store_dwordx4 v[244:247], v253, s[16:19], s39 offen sc1
    s_add_u32 s39, s39, 4194304
    v_cvt_pk_bf16_f32 v240, v130, v134
    v_cvt_pk_bf16_f32 v241, v138, v142
    v_cvt_pk_bf16_f32 v242, v146, v150
    v_cvt_pk_bf16_f32 v243, v154, v158
    buffer_store_dwordx4 v[240:243], v253, s[16:19], s39 offen sc1
    s_add_u32 s39, s39, 4194304
    v_cvt_pk_bf16_f32 v244, v131, v135
    v_cvt_pk_bf16_f32 v245, v139, v143
    v_cvt_pk_bf16_f32 v246, v147, v151
    v_cvt_pk_bf16_f32 v247, v155, v159
    buffer_store_dwordx4 v[244:247], v253, s[16:19], s39 offen sc1
    s_add_u32 s39, s39, 4194304
    s_setprio 1
    v_mfma_f32_16x16x32_bf16 v[128:131], v[228:231], v[64:67], 0
    v_mfma_f32_16x16x32_bf16 v[132:135], v[228:231], v[68:71], 0
    v_mfma_f32_16x16x32_bf16 v[136:139], v[228:231], v[72:75], 0
    v_mfma_f32_16x16x32_bf16 v[140:143], v[228:231], v[76:79], 0
    v_mfma_f32_16x16x32_bf16 v[144:147], v[228:231], v[80:83], 0
    v_mfma_f32_16x16x32_bf16 v[148:151], v[228:231], v[84:87], 0
    v_mfma_f32_16x16x32_bf16 v[152:155], v[228:231], v[88:91], 0
    v_mfma_f32_16x16x32_bf16 v[156:159], v[228:231], v[92:95], 0
    s_setprio 0
    s_nop 7
    v_cvt_pk_bf16_f32 v240, v128, v132
    v_cvt_pk_bf16_f32 v241, v136, v140
    v_cvt_pk_bf16_f32 v242, v144, v148
    v_cvt_pk_bf16_f32 v243, v152, v156
    buffer_store_dwordx4 v[240:243], v253, s[16:19], s39 offen sc1
    s_add_u32 s39, s39, 4194304
    v_cvt_pk_bf16_f32 v244, v129, v133
    v_cvt_pk_bf16_f32 v245, v137, v141
    v_cvt_pk_bf16_f32 v246, v145, v149
    v_cvt_pk_bf16_f32 v247, v153, v157
    buffer_store_dwordx4 v[244:247], v253, s[16:19], s39 offen sc1
    s_add_u32 s39, s39, 4194304
    v_cvt_pk_bf16_f32 v240, v130, v134
    v_cvt_pk_bf16_f32 v241, v138, v142
    v_cvt_pk_bf16_f32 v242, v146, v150
    v_cvt_pk_bf16_f32 v243, v154, v158
    buffer_store_dwordx4 v[240:243], v253, s[16:19], s39 offen sc1
    s_add_u32 s39, s39, 4194304
    v_cvt_pk_bf16_f32 v244, v131, v135
    v_cvt_pk_bf16_f32 v245, v139, v143
    v_cvt_pk_bf16_f32 v246, v147, v151
    v_cvt_pk_bf16_f32 v247, v155, v159
    buffer_store_dwordx4 v[244:247], v253, s[16:19], s39 offen sc1
    s_add_u32 s39, s39, 4194304
    s_cmp_lt_u32 s40, 4
    s_cbranch_scc1 K12_UT3
    s_lshl_b32 s36, s40, 3
    s_sub_i32 s36, s36, 20
    s_max_i32 s36, s36, 1
    s_mov_b32 s37, 131072
K12_UL3:
    v_mov_b32 v240, 155648
    ds_read_b32 v240, v240
    s_waitcnt lgkmcnt(0)
    v_cmp_gt_u32 vcc, s36, v240
    s_sub_u32 s37, s37, 1
    s_cmp_eq_u32 s37, 0
    s_cbranch_scc1 K12_UT3
    s_cbranch_vccz K12_UT3
    s_sleep 2
    s_branch K12_UL3
K12_UT3:
    s_setprio 1
    v_mfma_f32_16x16x32_bf16 v[128:131], v[232:235], v[64:67], 0
    v_mfma_f32_16x16x32_bf16 v[132:135], v[232:235], v[68:71], 0
    v_mfma_f32_16x16x32_bf16 v[136:139], v[232:235], v[72:75], 0
    v_mfma_f32_16x16x32_bf16 v[140:143], v[232:235], v[76:79], 0
    v_mfma_f32_16x16x32_bf16 v[144:147], v[232:235], v[80:83], 0
    v_mfma_f32_16x16x32_bf16 v[148:151], v[232:235], v[84:87], 0
    v_mfma_f32_16x16x32_bf16 v[152:155], v[232:235], v[88:91], 0
    v_mfma_f32_16x16x32_bf16 v[156:159], v[232:235], v[92:95], 0
    s_setprio 0
    s_nop 7
    v_cvt_pk_bf16_f32 v240, v128, v132
    v_cvt_pk_bf16_f32 v241, v136, v140
    v_cvt_pk_bf16_f32 v242, v144, v148
    v_cvt_pk_bf16_f32 v243, v152, v156
    buffer_store_dwordx4 v[240:243], v253, s[16:19], s39 offen sc1
    s_add_u32 s39, s39, 4194304
    v_cvt_pk_bf16_f32 v244, v129, v133
    v_cvt_pk_bf16_f32 v245, v137, v141
    v_cvt_pk_bf16_f32 v246, v145, v149
    v_cvt_pk_bf16_f32 v247, v153, v157
    buffer_store_dwordx4 v[244:247], v253, s[16:19], s39 offen sc1
    s_add_u32 s39, s39, 4194304
    v_cvt_pk_bf16_f32 v240, v130, v134
    v_cvt_pk_bf16_f32 v241, v138, v142
    v_cvt_pk_bf16_f32 v242, v146, v150
    v_cvt_pk_bf16_f32 v243, v154, v158
    buffer_store_dwordx4 v[240:243], v253, s[16:19], s39 offen sc1
    s_add_u32 s39, s39, 4194304
    v_cvt_pk_bf16_f32 v244, v131, v135
    v_cvt_pk_bf16_f32 v245, v139, v143
    v_cvt_pk_bf16_f32 v246, v147, v151
    v_cvt_pk_bf16_f32 v247, v155, v159
    buffer_store_dwordx4 v[244:247], v253, s[16:19], s39 offen sc1
    s_add_u32 s39, s39, 4194304
    s_setprio 1
    v_mfma_f32_16x16x32_bf16 v[128:131], v[236:239], v[64:67], 0
    v_mfma_f32_16x16x32_bf16 v[132:135], v[236:239], v[68:71], 0
    v_mfma_f32_16x16x32_bf16 v[136:139], v[236:239], v[72:75], 0
    v_mfma_f32_16x16x32_bf16 v[140:143], v[236:239], v[76:79], 0
    v_mfma_f32_16x16x32_bf16 v[144:147], v[236:239], v[80:83], 0
    v_mfma_f32_16x16x32_bf16 v[148:151], v[236:239], v[84:87], 0
    v_mfma_f32_16x16x32_bf16 v[152:155], v[236:239], v[88:91], 0
    v_mfma_f32_16x16x32_bf16 v[156:159], v[236:239], v[92:95], 0
    s_setprio 0
    s_nop 7
    v_cvt_pk_bf16_f32 v240, v128, v132
    v_cvt_pk_bf16_f32 v241, v136, v140
    v_cvt_pk_bf16_f32 v242, v144, v148
    v_cvt_pk_bf16_f32 v243, v152, v156
    buffer_store_dwordx4 v[240:243], v253, s[16:19], s39 offen sc1
    s_add_u32 s39, s39, 4194304
    v_cvt_pk_bf16_f32 v244, v129, v133
    v_cvt_pk_bf16_f32 v245, v137, v141
    v_cvt_pk_bf16_f32 v246, v145, v149
    v_cvt_pk_bf16_f32 v247, v153, v157
    buffer_store_dwordx4 v[244:247], v253, s[16:19], s39 offen sc1
    s_add_u32 s39, s39, 4194304
    v_cvt_pk_bf16_f32 v240, v130, v134
    v_cvt_pk_bf16_f32 v241, v138, v142
    v_cvt_pk_bf16_f32 v242, v146, v150
    v_cvt_pk_bf16_f32 v243, v154, v158
    buffer_store_dwordx4 v[240:243], v253, s[16:19], s39 offen sc1
    s_add_u32 s39, s39, 4194304
    v_cvt_pk_bf16_f32 v244, v131, v135
    v_cvt_pk_bf16_f32 v245, v139, v143
    v_cvt_pk_bf16_f32 v246, v147, v151
    v_cvt_pk_bf16_f32 v247, v155, v159
    buffer_store_dwordx4 v[244:247], v253, s[16:19], s39 offen sc1
    s_mov_b32 s41, s40
    s_add_u32 s40, s40, 1
    s_cmp_eq_u32 s41, 3
    s_cbranch_scc0 K12_ES13
    s_waitcnt vmcnt(0)
    s_mov_b32 s34, -1
    s_cmp_ge_u32 s41, 8
    s_cbranch_scc1 K12_SG14
    s_lshl_b32 s36, s41, 2
    s_add_u32 s37, s36, 155680
    s_mov_b64 exec, 1
    v_mov_b32 v255, s37
    v_mov_b32 v240, 1
    ds_add_rtn_u32 v240, v255, v240
    s_waitcnt lgkmcnt(0)
    v_readfirstlane_b32 s37, v240
    s_nop 3
    s_cmp_eq_u32 s37, 3
    s_cbranch_scc0 K12_SH14
    s_lshl_b32 s36, s36, 8
    v_mov_b32 v255, 1
    v_mov_b32 v240, s36
    buffer_atomic_add v255, v240, s[60:63], 0 offen sc0 sc1
    s_mov_b32 s34, s41
K12_SH14:
    s_mov_b64 exec, -1
K12_SG14:
    s_waitcnt vmcnt(0)
    s_cmp_ge_u32 s34, 8
    s_cbranch_scc1 K12_PB15
    v_readfirstlane_b32 s37, v255
    s_nop 3
    s_cmp_eq_u32 s37, 255
    s_cbranch_scc0 K12_PB15
    s_lshl_b32 s36, s34, 4
    s_add_u32 s36, s36, 16384
    s_mov_b64 exec, 1
    v_mov_b32 v255, 1
    v_mov_b32 v240, s36
    buffer_store_dword v255, v240, s[60:63], 0 offen sc1
    s_mov_b64 exec, -1
K12_PB15:
    s_mov_b32 s34, -1
    s_mov_b32 s41, -1
K12_ES13:
    s_waitcnt vmcnt(16)
    s_cmp_ge_u32 s34, 8
    s_cbranch_scc1 K12_PB16
    v_readfirstlane_b32 s37, v255
    s_nop 3
    s_cmp_eq_u32 s37, 255
    s_cbranch_scc0 K12_PB16
    s_lshl_b32 s36, s34, 4
    s_add_u32 s36, s36, 16384
    s_mov_b64 exec, 1
    v_mov_b32 v255, 1
    v_mov_b32 v240, s36
    buffer_store_dword v255, v240, s[60:63], 0 offen sc1
    s_mov_b64 exec, -1
K12_PB16:
    s_cmp_lt_u32 s40, 8
    s_cbranch_scc1 K12_XW
K12_PFIN:
    s_waitcnt vmcnt(0)
    s_mov_b32 s34, -1
    s_cmp_ge_u32 s41, 8
    s_cbranch_scc1 K12_SG17
    s_lshl_b32 s36, s41, 2
    s_add_u32 s37, s36, 155680
    s_mov_b64 exec, 1
    v_mov_b32 v255, s37
    v_mov_b32 v240, 1
    ds_add_rtn_u32 v240, v255, v240
    s_waitcnt lgkmcnt(0)
    v_readfirstlane_b32 s37, v240
    s_nop 3
    s_cmp_eq_u32 s37, 3
    s_cbranch_scc0 K12_SH17
    s_lshl_b32 s36, s36, 8
    v_mov_b32 v255, 1
    v_mov_b32 v240, s36
    buffer_atomic_add v255, v240, s[60:63], 0 offen sc0 sc1
    s_mov_b32 s34, s41
K12_SH17:
    s_mov_b64 exec, -1
K12_SG17:
    s_waitcnt vmcnt(0)
    s_cmp_ge_u32 s34, 8
    s_cbranch_scc1 K12_PB18
    v_readfirstlane_b32 s37, v255
    s_nop 3
    s_cmp_eq_u32 s37, 255
    s_cbranch_scc0 K12_PB18
    s_lshl_b32 s36, s34, 4
    s_add_u32 s36, s36, 16384
    s_mov_b64 exec, 1
    v_mov_b32 v255, 1
    v_mov_b32 v240, s36
    buffer_store_dword v255, v240, s[60:63], 0 offen sc1
    s_mov_b64 exec, -1
K12_PB18:
    s_endpgm
K12_CONS:
    s_and_b32 s6, s2, 7
    s_lshl_b32 s6, s6, 2
    s_lshr_b32 s7, s2, 6
    s_add_u32 s6, s6, s7
    s_mov_b32 s51, s6
    s_mov_b32 s27, s6
    s_lshr_b32 s7, s2, 3
    s_and_b32 s7, s7, 7
    s_lshr_b32 s20, s7, 2
    s_and_b32 s21, s7, 3
    s_lshl_b32 s22, s6, 1
    s_add_u32 s22, s22, s20
    s_lshl_b32 s23, s6, 2
    s_add_u32 s23, s23, s21
    s_mul_i32 s24, s22, 684032
    s_mul_i32 s25, s23, 524288
    s_add_u32 s25, s25, 50331648
    s_mul_i32 s26, s22, 342016
    s_add_u32 s26, s26, 118489088
    s_add_u32 s8, s58, s24
    s_addc_u32 s9, s59, 0
    s_and_b32 s9, s9, 0xffff
    s_mov_b32 s10, 684032
    s_mov_b32 s11, 0x00020000
    s_add_u32 s12, s58, s25
    s_addc_u32 s13, s59, 0
    s_and_b32 s13, s13, 0xffff
    s_mov_b32 s14, 524288
    s_mov_b32 s15, 0x00020000
    s_add_u32 s16, s58, s26
    s_addc_u32 s17, s59, 0
    s_and_b32 s17, s17, 0xffff
    s_mov_b32 s18, 342016
    s_mov_b32 s19, 0x00020000
    s_add_u32 s4, s58, 153108480
    s_addc_u32 s5, s59, 0
    s_and_b32 s5, s5, 0xffff
    s_cmp_eq_u32 s3, 0
    s_cselect_b32 s6, 128, 0
    s_mov_b32 s7, 0x00020000
    s_mov_b32 s46, 155712
    s_cselect_b32 s46, s46, 155776
    s_mov_b32 s47, 155712
    s_cselect_b32 s47, s47, 155744
    s_cselect_b32 s45, 4, 0
    s_mov_b32 s50, s45
    v_and_b32 v8, 15, v2
    v_lshrrev_b32 v9, 4, v2
    v_lshlrev_b32 v1, 4, v2
    s_mul_i32 s30, s3, 5120
    s_mov_b32 s36, s30
    s_lshl_b32 s31, s3, 12
    s_add_u32 s37, s31, 22528
    s_lshr_b32 s28, s3, 1
    s_and_b32 s29, s3, 1
    s_lshl_b32 s33, s29, 9
    s_add_u32 s33, s33, 20480
    s_mul_i32 s38, s28, 896
    s_add_u32 s38, s38, s33
    s_lshl_b32 s34, s51, 1
    s_add_u32 s34, s34, s28
    s_mul_i32 s34, s34, 684032
    s_add_u32 s64, s58, s34
    s_addc_u32 s65, s59, 0
    s_and_b32 s65, s65, 0xffff
    s_mov_b32 s66, 684032
    s_mov_b32 s67, 0x00020000
    s_mov_b32 s44, 0xffffff
    s_cmp_eq_u32 s29, 0
    s_cselect_b32 s44, -1, s44
    s_mov_b32 s45, 0
    v_lshrrev_b32 v10, 1, v8
    v_xor_b32 v10, v10, v9
    v_lshlrev_b32 v10, 4, v10
    v_lshl_add_u32 v2, v8, 7, v10
    v_xor_b32 v3, 64, v2
    v_lshrrev_b32 v10, 2, v8
    v_lshl_add_u32 v11, v9, 3, v10
    v_lshlrev_b32 v11, 9, v11
    v_and_b32 v12, 1, v9
    v_lshl_or_b32 v10, v12, 2, v10
    s_lshl_b32 s28, s3, 1
    v_xor_b32 v10, s28, v10
    v_lshl_add_u32 v11, v10, 5, v11
    v_and_b32 v10, 3, v8
    v_lshl_add_u32 v11, v10, 3, v11
    v_add_u32 v4, 22528, v11
    s_lshl_b32 s28, s20, 5
    v_xor_b32 v4, s28, v4
    v_and_b32 v10, 3, v8
    v_lshlrev_b32 v10, 2, v10
    v_add_u32 v5, 155648, v10
    s_lshl_b32 s28, s3, 2
    s_add_u32 s28, s28, 155648
    v_mov_b32 v7, s28
    s_mov_b32 s35, 0x80008000
    s_mov_b32 s62, 0
    s_mov_b32 s63, 0
    s_mov_b32 s69, 0
    s_mov_b32 s39, 0
    s_add_u32 m0, s39, s36
    s_nop 0
    buffer_load_dwordx4 v1, s[8:11], s30 offen sc1 lds
    buffer_load_dwordx4 v1, s[8:11], s30 offen offset:1024 sc1 lds
    buffer_load_dwordx4 v1, s[8:11], s30 offen offset:2048 sc1 lds
    buffer_load_dwordx4 v1, s[8:11], s30 offen offset:3072 sc1 lds
    s_add_u32 m0, m0, 4096
    s_add_u32 s34, s30, 4096
    buffer_load_dwordx4 v1, s[8:11], s34 offen sc1 lds
    s_add_u32 m0, s39, s37
    s_add_u32 s30, s30, 21376
    buffer_load_dwordx4 v1, s[12:15], s31 offen sc1 lds
    buffer_load_dwordx4 v1, s[12:15], s31 offen offset:1024 sc1 lds
    buffer_load_dwordx4 v1, s[12:15], s31 offen offset:2048 sc1 lds
    buffer_load_dwordx4 v1, s[12:15], s31 offen offset:3072 sc1 lds
    s_add_u32 m0, s39, s38
    s_mov_b64 exec, s[44:45]
    buffer_load_dwordx4 v1, s[64:67], s33 offen sc1 lds
    s_mov_b64 exec, -1
    s_add_u32 s31, s31, 16384
    s_add_u32 s33, s33, 21376
    s_add_u32 s39, s39, 38912
    s_add_u32 m0, s39, s36
    s_nop 0
    buffer_load_dwordx4 v1, s[8:11], s30 offen sc1 lds
    buffer_load_dwordx4 v1, s[8:11], s30 offen offset:1024 sc1 lds
    buffer_load_dwordx4 v1, s[8:11], s30 offen offset:2048 sc1 lds
    buffer_load_dwordx4 v1, s[8:11], s30 offen offset:3072 sc1 lds
    s_add_u32 m0, m0, 4096
    s_add_u32 s34, s30, 4096
    buffer_load_dwordx4 v1, s[8:11], s34 offen sc1 lds
    s_add_u32 m0, s39, s37
    s_add_u32 s30, s30, 21376
    buffer_load_dwordx4 v1, s[12:15], s31 offen sc1 lds
    buffer_load_dwordx4 v1, s[12:15], s31 offen offset:1024 sc1 lds
    buffer_load_dwordx4 v1, s[12:15], s31 offen offset:2048 sc1 lds
    buffer_load_dwordx4 v1, s[12:15], s31 offen offset:3072 sc1 lds
    s_add_u32 m0, s39, s38
    s_mov_b64 exec, s[44:45]
    buffer_load_dwordx4 v1, s[64:67], s33 offen sc1 lds
    s_mov_b64 exec, -1
    s_add_u32 s31, s31, 16384
    s_add_u32 s33, s33, 21376
    s_add_u32 s39, s39, 38912
    s_add_u32 m0, s39, s36
    s_nop 0
    buffer_load_dwordx4 v1, s[8:11], s30 offen sc1 lds
    buffer_load_dwordx4 v1, s[8:11], s30 offen offset:1024 sc1 lds
    buffer_load_dwordx4 v1, s[8:11], s30 offen offset:2048 sc1 lds
    buffer_load_dwordx4 v1, s[8:11], s30 offen offset:3072 sc1 lds
    s_add_u32 m0, m0, 4096
    s_add_u32 s34, s30, 4096
    buffer_load_dwordx4 v1, s[8:11], s34 offen sc1 lds
    s_add_u32 m0, s39, s37
    s_add_u32 s30, s30, 21376
    buffer_load_dwordx4 v1, s[12:15], s31 offen sc1 lds
    buffer_load_dwordx4 v1, s[12:15], s31 offen offset:1024 sc1 lds
    buffer_load_dwordx4 v1, s[12:15], s31 offen offset:2048 sc1 lds
    buffer_load_dwordx4 v1, s[12:15], s31 offen offset:3072 sc1 lds
    s_add_u32 m0, s39, s38
    s_mov_b64 exec, s[44:45]
    buffer_load_dwordx4 v1, s[64:67], s33 offen sc1 lds
    s_mov_b64 exec, -1
    s_add_u32 s31, s31, 16384
    s_add_u32 s33, s33, 21376
    s_add_u32 s39, s39, 38912
    s_mov_b32 m0, s46
    s_mov_b64 exec, 0xff
    buffer_load_dword v1, s[4:7], 0 offen sc1 lds
    s_mov_b64 exec, -1
    v_lshrrev_b32 v9, 4, v1
    v_and_b32 v8, 15, v9
    v_lshrrev_b32 v9, 4, v9
    v_and_b32 v10, 3, v8
    v_lshlrev_b32 v10, 2, v10
    v_lshrrev_b32 v12, 3, v8
    v_lshl_add_u32 v10, v12, 1, v10
    s_lshl_b32 s28, s3, 4
    s_add_u32 s28, s28, 1
    v_add_u32 v10, s28, v10
    v_bfe_u32 v11, v8, 2, 1
    v_and_b32 v13, 1, v9
    v_lshlrev_b32 v13, 3, v13
    v_mul_u32_u24 v14, 96, v11
    v_mad_u32_u24 v15, v10, v13, v14
    v_mad_u32_u24 v16, v10, 0, v15
    v_mad_u32_u24 v17, v10, 1, v15
    v_mad_u32_u24 v18, v10, 2, v15
    v_mad_u32_u24 v19, v10, 3, v15
    v_mad_u32_u24 v20, v10, 4, v15
    v_mad_u32_u24 v21, v10, 5, v15
    v_mad_u32_u24 v22, v10, 6, v15
    v_mad_u32_u24 v23, v10, 7, v15
    v_and_b32 v16, 127, v16
    v_and_b32 v17, 127, v17
    v_and_b32 v18, 127, v18
    v_and_b32 v19, 127, v19
    v_and_b32 v20, 127, v20
    v_and_b32 v21, 127, v21
    v_and_b32 v22, 127, v22
    v_and_b32 v23, 127, v23
    v_cvt_f32_u32 v16, v16
    v_cvt_f32_u32 v17, v17
    v_cvt_f32_u32 v18, v18
    v_cvt_f32_u32 v19, v19
    v_cvt_f32_u32 v20, v20
    v_cvt_f32_u32 v21, v21
    v_cvt_f32_u32 v22, v22
    v_cvt_f32_u32 v23, v23
    v_mul_f32 v16, 0x3c000000, v16
    v_mul_f32 v17, 0x3c000000, v17
    v_mul_f32 v18, 0x3c000000, v18
    v_mul_f32 v19, 0x3c000000, v19
    v_mul_f32 v20, 0x3c000000, v20
    v_mul_f32 v21, 0x3c000000, v21
    v_mul_f32 v22, 0x3c000000, v22
    v_mul_f32 v23, 0x3c000000, v23
    v_cos_f32 v16, v16
    v_cos_f32 v17, v17
    v_cos_f32 v18, v18
    v_cos_f32 v19, v19
    v_cos_f32 v20, v20
    v_cos_f32 v21, v21
    v_cos_f32 v22, v22
    v_cos_f32 v23, v23
    s_nop 0
    v_cvt_pk_bf16_f32 v24, v16, v17
    v_cvt_pk_bf16_f32 v25, v18, v19
    v_cvt_pk_bf16_f32 v26, v20, v21
    v_cvt_pk_bf16_f32 v27, v22, v23
    v_lshlrev_b32 v32, 16, v24
    v_and_b32 v33, 0xffff0000, v24
    v_sub_f32 v16, v16, v32
    v_sub_f32 v17, v17, v33
    v_lshlrev_b32 v32, 16, v25
    v_and_b32 v33, 0xffff0000, v25
    v_sub_f32 v18, v18, v32
    v_sub_f32 v19, v19, v33
    v_lshlrev_b32 v32, 16, v26
    v_and_b32 v33, 0xffff0000, v26
    v_sub_f32 v20, v20, v32
    v_sub_f32 v21, v21, v33
    v_lshlrev_b32 v32, 16, v27
    v_and_b32 v33, 0xffff0000, v27
    v_sub_f32 v22, v22, v32
    v_sub_f32 v23, v23, v33
    v_cvt_pk_bf16_f32 v28, v16, v17
    v_cvt_pk_bf16_f32 v29, v18, v19
    v_cvt_pk_bf16_f32 v30, v20, v21
    v_cvt_pk_bf16_f32 v31, v22, v23
    v_cmp_lt_u32 vcc, 1, v9
    s_lshl_b32 s28, s3, 10
    s_add_u32 s28, s28, 133120
    v_add_u32 v14, s28, v1
    v_cndmask_b32 v24, v24, v28, vcc
    v_cndmask_b32 v25, v25, v29, vcc
    v_cndmask_b32 v26, v26, v30, vcc
    v_cndmask_b32 v27, v27, v31, vcc
    ds_write_b128 v14, v[24:27]
    v_mov_b32 v12, 0
    v_mov_b32 v13, 0
    v_mov_b32 v14, 0
    v_mov_b32 v15, 0
    s_mul_i32 s28, s3, 38912
    s_add_u32 s28, s28, 22272
    v_add_u32 v16, s28, v1
    s_mov_b64 exec, 0xffff
    ds_write_b128 v16, v[12:15]
    s_mov_b64 exec, -1
    s_lshl_b32 s28, s3, 2
    s_add_u32 s28, s28, 155648
    v_mov_b32 v16, s28
    ds_write_b32 v16, v12
    s_lshl_b32 s28, s3, 3
    s_add_u32 s28, s28, 155680
    v_mov_b32 v16, s28
    ds_write_b64 v16, v[12:13]
    s_lshl_b32 s28, s3, 3
    s_add_u32 s28, s28, 155712
    v_mov_b32 v16, s28
    ds_write_b64 v16, v[12:13]
    s_lshl_b32 s28, s3, 3
    s_add_u32 s28, s28, 155840
    v_mov_b32 v16, s28
    ds_write_b64 v16, v[12:13]
    v_mov_b32 v16, 155664
    ds_write_b32 v16, v12
    v_mov_b32 v16, 155744
    v_mov_b32 v17, 1
    ds_write_b32 v16, v17
    s_waitcnt lgkmcnt(0)
    s_barrier
    v_mov_b32 v80, 0
    v_mov_b32 v81, 0
    v_mov_b32 v82, 0
    v_mov_b32 v83, 0
    v_mov_b32 v84, 0
    v_mov_b32 v85, 0
    v_mov_b32 v86, 0
    v_mov_b32 v87, 0
    v_mov_b32 v88, 0
    v_mov_b32 v89, 0
    v_mov_b32 v90, 0
    v_mov_b32 v91, 0
    v_mov_b32 v92, 0
    v_mov_b32 v93, 0
    v_mov_b32 v94, 0
    v_mov_b32 v95, 0
    v_mov_b32 v96, 0
    v_mov_b32 v97, 0
    v_mov_b32 v98, 0
    v_mov_b32 v99, 0
    v_mov_b32 v100, 0
    v_mov_b32 v101, 0
    v_mov_b32 v102, 0
    v_mov_b32 v103, 0
    v_mov_b32 v104, 0
    v_mov_b32 v105, 0
    v_mov_b32 v106, 0
    v_mov_b32 v107, 0
    v_mov_b32 v108, 0
    v_mov_b32 v109, 0
    v_mov_b32 v110, 0
    v_mov_b32 v111, 0
    v_mov_b32 v112, 0
    v_mov_b32 v113, 0
    v_mov_b32 v114, 0
    v_mov_b32 v115, 0
    v_mov_b32 v116, 0
    v_mov_b32 v117, 0
    v_mov_b32 v118, 0
    v_mov_b32 v119, 0
    v_mov_b32 v120, 0
    v_mov_b32 v121, 0
    v_mov_b32 v122, 0
    v_mov_b32 v123, 0
    v_mov_b32 v124, 0
    v_mov_b32 v125, 0
    v_mov_b32 v126, 0
    v_mov_b32 v127, 0
    v_mov_b32 v128, 0
    v_mov_b32 v129, 0
    v_mov_b32 v130, 0
    v_mov_b32 v131, 0
    v_mov_b32 v132, 0
    v_mov_b32 v133, 0
    v_mov_b32 v134, 0
    v_mov_b32 v135, 0
    v_mov_b32 v136, 0
    v_mov_b32 v137, 0
    v_mov_b32 v138, 0
    v_mov_b32 v139, 0
    v_mov_b32 v140, 0
    v_mov_b32 v141, 0
    v_mov_b32 v142, 0
    v_mov_b32 v143, 0
    v_mov_b32 v144, 0
    v_mov_b32 v145, 0
    v_mov_b32 v146, 0
    v_mov_b32 v147, 0
    v_mov_b32 v148, 0
    v_mov_b32 v149, 0
    v_mov_b32 v150, 0
    v_mov_b32 v151, 0
    v_mov_b32 v152, 0
    v_mov_b32 v153, 0
    v_mov_b32 v154, 0
    v_mov_b32 v155, 0
    v_mov_b32 v156, 0
    v_mov_b32 v157, 0
    v_mov_b32 v158, 0
    v_mov_b32 v159, 0
    v_mov_b32 v160, 0
    v_mov_b32 v161, 0
    v_mov_b32 v162, 0
    v_mov_b32 v163, 0
    v_mov_b32 v164, 0
    v_mov_b32 v165, 0
    v_mov_b32 v166, 0
    v_mov_b32 v167, 0
    v_mov_b32 v168, 0
    v_mov_b32 v169, 0
    v_mov_b32 v170, 0
    v_mov_b32 v171, 0
    v_mov_b32 v172, 0
    v_mov_b32 v173, 0
    v_mov_b32 v174, 0
    v_mov_b32 v175, 0
    v_mov_b32 v176, 0
    v_mov_b32 v177, 0
    v_mov_b32 v178, 0
    v_mov_b32 v179, 0
    v_mov_b32 v180, 0
    v_mov_b32 v181, 0
    v_mov_b32 v182, 0
    v_mov_b32 v183, 0
    v_mov_b32 v184, 0
    v_mov_b32 v185, 0
    v_mov_b32 v186, 0
    v_mov_b32 v187, 0
    v_mov_b32 v188, 0
    v_mov_b32 v189, 0
    v_mov_b32 v190, 0
    v_mov_b32 v191, 0
    v_mov_b32 v192, 0
    v_mov_b32 v193, 0
    v_mov_b32 v194, 0
    v_mov_b32 v195, 0
    v_mov_b32 v196, 0
    v_mov_b32 v197, 0
    v_mov_b32 v198, 0
    v_mov_b32 v199, 0
    v_mov_b32 v200, 0
    v_mov_b32 v201, 0
    v_mov_b32 v202, 0
    v_mov_b32 v203, 0
    v_mov_b32 v204, 0
    v_mov_b32 v205, 0
    v_mov_b32 v206, 0
    v_mov_b32 v207, 0
    v_mov_b32 v208, 0
    v_mov_b32 v209, 0
    v_mov_b32 v210, 0
    v_mov_b32 v211, 0
    v_mov_b32 v212, 0
    v_mov_b32 v213, 0
    v_mov_b32 v214, 0
    v_mov_b32 v215, 0
    v_mov_b32 v216, 0
    v_mov_b32 v217, 0
    v_mov_b32 v218, 0
    v_mov_b32 v219, 0
    v_mov_b32 v220, 0
    v_mov_b32 v221, 0
    v_mov_b32 v222, 0
    v_mov_b32 v223, 0
    v_mov_b32 v224, 0
    v_mov_b32 v225, 0
    v_mov_b32 v226, 0
    v_mov_b32 v227, 0
    v_mov_b32 v228, 0
    v_mov_b32 v229, 0
    v_mov_b32 v230, 0
    v_mov_b32 v231, 0
    v_mov_b32 v232, 0
    v_mov_b32 v233, 0
    v_mov_b32 v234, 0
    v_mov_b32 v235, 0
    v_mov_b32 v236, 0
    v_mov_b32 v237, 0
    v_mov_b32 v238, 0
    v_mov_b32 v239, 0
    v_mov_b32 v240, 0
    v_mov_b32 v241, 0
    v_mov_b32 v242, 0
    v_mov_b32 v243, 0
    v_mov_b32 v244, 0
    v_mov_b32 v245, 0
    v_mov_b32 v246, 0
    v_mov_b32 v247, 0
    s_barrier
    s_mov_b32 s40, 2
    v_mov_b32 v0, s40
    s_waitcnt vmcnt(21)
    ds_write_b32 v7, v0
    s_branch K12_S0
K12_Q0:
    ds_read_b64_tr_b16 v[40:41], v4 offset:0
    ds_read_b64_tr_b16 v[42:43], v4 offset:2048
    ds_read_b64_tr_b16 v[44:45], v4 offset:256
    ds_read_b64_tr_b16 v[46:47], v4 offset:2304
    v_xor_b32 v4, 32, v4
    ds_read_b64_tr_b16 v[48:49], v4 offset:0
    ds_read_b64_tr_b16 v[50:51], v4 offset:2048
    ds_read_b64_tr_b16 v[52:53], v4 offset:256
    ds_read_b64_tr_b16 v[54:55], v4 offset:2304
    v_xor_b32 v4, 32, v4
    ds_read_b128 v[8:11], v2 offset:0
    ds_read_b128 v[12:15], v3 offset:0
    ds_read_b128 v[16:19], v2 offset:2048
    ds_read_b128 v[20:23], v3 offset:2048
    ds_read_b128 v[32:35], v2 offset:6144
    ds_read_b128 v[36:39], v3 offset:6144
    ds_read_b32 v68, v5
    s_waitcnt lgkmcnt(7)
    v_xor_b32 v72, s35, v44
    v_xor_b32 v73, s35, v45
    v_xor_b32 v74, s35, v46
    v_xor_b32 v75, s35, v47
    v_xor_b32 v76, s35, v52
    v_xor_b32 v77, s35, v53
    v_xor_b32 v78, s35, v54
    v_xor_b32 v79, s35, v55
    s_mov_b32 s41, 0
    s_mov_b32 s42, 38912
    s_mov_b32 s39, 0
    s_mov_b32 s29, 116736
K12_LOOP:
    s_waitcnt lgkmcnt(2)
    v_mfma_f32_16x16x32_bf16 v[80:83], v[8:11], v[40:43], v[80:83]
    ds_read_b128 v[24:27], v2 offset:4096
    v_xor_b32 v72, s35, v44
    v_xor_b32 v73, s35, v45
    v_mfma_f32_16x16x32_bf16 v[84:87], v[8:11], v[44:47], v[84:87]
    ds_read_b128 v[28:31], v3 offset:4096
    v_xor_b32 v74, s35, v46
    v_xor_b32 v75, s35, v47
    v_mfma_f32_16x16x32_bf16 v[88:91], v[8:11], v[48:51], v[88:91]
    s_waitcnt lgkmcnt(2)
    v_cmp_gt_u32 vcc, s40, v68
    s_add_u32 s49, s39, 2
    s_lshr_b32 s49, s49, 1
    v_xor_b32 v76, s35, v52
    v_xor_b32 v77, s35, v53
    v_mfma_f32_16x16x32_bf16 v[92:95], v[8:11], v[52:55], v[92:95]
    s_cbranch_vccnz K12_S1
K12_Q1:
    s_mul_i32 s48, s49, s50
    s_add_u32 s48, s48, s47
    v_xor_b32 v78, s35, v54
    v_xor_b32 v79, s35, v55
    v_mfma_f32_16x16x32_bf16 v[80:83], v[12:15], v[72:75], v[80:83]
    s_add_u32 m0, s29, s36
    s_nop 0
    buffer_load_dwordx4 v1, s[8:11], s30 offen sc1 lds
    v_mfma_f32_16x16x32_bf16 v[84:87], v[12:15], v[40:43], v[84:87]
    s_cmp_lt_u32 s49, 8
    s_cselect_b32 s48, s48, 155744
    v_mfma_f32_16x16x32_bf16 v[88:91], v[12:15], v[76:79], v[88:91]
    s_cmp_ge_u32 s49, 3
    s_cselect_b32 s48, s48, 155744
    v_mfma_f32_16x16x32_bf16 v[92:95], v[12:15], v[48:51], v[92:95]
    v_mfma_f32_16x16x32_bf16 v[96:99], v[16:19], v[40:43], v[96:99]
    ds_read_b128 v[8:11], v2 offset:8192
    v_mfma_f32_16x16x32_bf16 v[100:103], v[16:19], v[44:47], v[100:103]
    ds_read_b128 v[12:15], v3 offset:8192
    v_mfma_f32_16x16x32_bf16 v[104:107], v[16:19], v[48:51], v[104:107]
    buffer_load_dwordx4 v1, s[8:11], s30 offen offset:1024 sc1 lds
    v_mfma_f32_16x16x32_bf16 v[108:111], v[16:19], v[52:55], v[108:111]
    v_mfma_f32_16x16x32_bf16 v[96:99], v[20:23], v[72:75], v[96:99]
    v_mfma_f32_16x16x32_bf16 v[100:103], v[20:23], v[40:43], v[100:103]
    v_mfma_f32_16x16x32_bf16 v[104:107], v[20:23], v[76:79], v[104:107]
    buffer_load_dwordx4 v1, s[8:11], s30 offen offset:2048 sc1 lds
    v_mfma_f32_16x16x32_bf16 v[108:111], v[20:23], v[48:51], v[108:111]
    s_waitcnt lgkmcnt(2)
    v_mfma_f32_16x16x32_bf16 v[112:115], v[24:27], v[40:43], v[112:115]
    ds_read_b128 v[16:19], v2 offset:10240
    v_mfma_f32_16x16x32_bf16 v[116:119], v[24:27], v[44:47], v[116:119]
    ds_read_b128 v[20:23], v3 offset:10240
    v_mfma_f32_16x16x32_bf16 v[120:123], v[24:27], v[48:51], v[120:123]
    v_mfma_f32_16x16x32_bf16 v[124:127], v[24:27], v[52:55], v[124:127]
    v_mfma_f32_16x16x32_bf16 v[112:115], v[28:31], v[72:75], v[112:115]
    buffer_load_dwordx4 v1, s[8:11], s30 offen offset:3072 sc1 lds
    v_mfma_f32_16x16x32_bf16 v[116:119], v[28:31], v[40:43], v[116:119]
    v_mfma_f32_16x16x32_bf16 v[120:123], v[28:31], v[76:79], v[120:123]
    v_mfma_f32_16x16x32_bf16 v[124:127], v[28:31], v[48:51], v[124:127]
    v_mfma_f32_16x16x32_bf16 v[128:131], v[32:35], v[40:43], v[128:131]
    ds_read_b128 v[24:27], v2 offset:12288
    v_mfma_f32_16x16x32_bf16 v[132:135], v[32:35], v[44:47], v[132:135]
    ds_read_b128 v[28:31], v3 offset:12288
    v_mfma_f32_16x16x32_bf16 v[136:139], v[32:35], v[48:51], v[136:139]
    s_add_u32 m0, m0, 4096
    s_add_u32 s34, s30, 4096
    buffer_load_dwordx4 v1, s[8:11], s34 offen sc1 lds
    v_mfma_f32_16x16x32_bf16 v[140:143], v[32:35], v[52:55], v[140:143]
    v_mfma_f32_16x16x32_bf16 v[128:131], v[36:39], v[72:75], v[128:131]
    v_mfma_f32_16x16x32_bf16 v[132:135], v[36:39], v[40:43], v[132:135]
    v_mfma_f32_16x16x32_bf16 v[136:139], v[36:39], v[76:79], v[136:139]
    s_add_u32 m0, s29, s37
    s_add_u32 s30, s30, 21376
    buffer_load_dwordx4 v1, s[12:15], s31 offen sc1 lds
    v_mfma_f32_16x16x32_bf16 v[140:143], v[36:39], v[48:51], v[140:143]
    s_waitcnt lgkmcnt(4)
    v_mfma_f32_16x16x32_bf16 v[144:147], v[8:11], v[40:43], v[144:147]
    ds_read_b128 v[32:35], v2 offset:14336
    v_mfma_f32_16x16x32_bf16 v[148:151], v[8:11], v[44:47], v[148:151]
    ds_read_b128 v[36:39], v3 offset:14336
    v_mfma_f32_16x16x32_bf16 v[152:155], v[8:11], v[48:51], v[152:155]
    v_mfma_f32_16x16x32_bf16 v[156:159], v[8:11], v[52:55], v[156:159]
    s_add_u32 s40, s40, 1
    s_mov_b32 s51, s40
    v_mov_b32 v0, s40
    v_mfma_f32_16x16x32_bf16 v[144:147], v[12:15], v[72:75], v[144:147]
    s_waitcnt vmcnt(17)
    ds_write_b32 v7, v0
    buffer_load_dwordx4 v1, s[12:15], s31 offen offset:1024 sc1 lds
    v_mfma_f32_16x16x32_bf16 v[148:151], v[12:15], v[40:43], v[148:151]
    v_mfma_f32_16x16x32_bf16 v[152:155], v[12:15], v[76:79], v[152:155]
    v_mfma_f32_16x16x32_bf16 v[156:159], v[12:15], v[48:51], v[156:159]
    s_waitcnt lgkmcnt(5)
    v_mfma_f32_16x16x32_bf16 v[160:163], v[16:19], v[40:43], v[160:163]
    ds_read_b128 v[8:11], v2 offset:16384
    v_mfma_f32_16x16x32_bf16 v[164:167], v[16:19], v[44:47], v[164:167]
    ds_read_b128 v[12:15], v3 offset:16384
    v_mfma_f32_16x16x32_bf16 v[168:171], v[16:19], v[48:51], v[168:171]
    buffer_load_dwordx4 v1, s[12:15], s31 offen offset:2048 sc1 lds
    v_mfma_f32_16x16x32_bf16 v[172:175], v[16:19], v[52:55], v[172:175]
    v_mfma_f32_16x16x32_bf16 v[160:163], v[20:23], v[72:75], v[160:163]
    v_mfma_f32_16x16x32_bf16 v[164:167], v[20:23], v[40:43], v[164:167]
    v_mfma_f32_16x16x32_bf16 v[168:171], v[20:23], v[76:79], v[168:171]
    buffer_load_dwordx4 v1, s[12:15], s31 offen offset:3072 sc1 lds
    v_mfma_f32_16x16x32_bf16 v[172:175], v[20:23], v[48:51], v[172:175]
    s_waitcnt lgkmcnt(5)
    v_mfma_f32_16x16x32_bf16 v[176:179], v[24:27], v[40:43], v[176:179]
    ds_read_b128 v[16:19], v2 offset:18432
    v_mfma_f32_16x16x32_bf16 v[180:183], v[24:27], v[44:47], v[180:183]
    ds_read_b128 v[20:23], v3 offset:18432
    v_mov_b32 v0, s48
    v_mfma_f32_16x16x32_bf16 v[184:187], v[24:27], v[48:51], v[184:187]
    ds_read_b32 v0, v0
    v_mfma_f32_16x16x32_bf16 v[188:191], v[24:27], v[52:55], v[188:191]
    v_mfma_f32_16x16x32_bf16 v[176:179], v[28:31], v[72:75], v[176:179]
    s_add_u32 m0, s29, s38
    s_mov_b64 exec, s[44:45]
    buffer_load_dwordx4 v1, s[64:67], s33 offen sc1 lds
    s_mov_b64 exec, -1
    s_add_u32 s31, s31, 16384
    s_add_u32 s33, s33, 21376
    v_mfma_f32_16x16x32_bf16 v[180:183], v[28:31], v[40:43], v[180:183]
    v_mfma_f32_16x16x32_bf16 v[184:187], v[28:31], v[76:79], v[184:187]
    v_mfma_f32_16x16x32_bf16 v[188:191], v[28:31], v[48:51], v[188:191]
    s_waitcnt lgkmcnt(0)
    v_cmp_eq_u32 vcc, 0, v0
    v_mfma_f32_16x16x32_bf16 v[192:195], v[32:35], v[40:43], v[192:195]
    ds_read_b128 v[24:27], v2 offset:20480
    v_mfma_f32_16x16x32_bf16 v[196:199], v[32:35], v[44:47], v[196:199]
    ds_read_b128 v[28:31], v3 offset:20480
    s_cbranch_vccnz K12_F2
K12_G2:
    v_mfma_f32_16x16x32_bf16 v[200:203], v[32:35], v[48:51], v[200:203]
    s_sub_u32 s43, s42, s41
    s_add_u32 s40, s40, 1
    v_add_u32 v2, s43, v2
    v_mfma_f32_16x16x32_bf16 v[204:207], v[32:35], v[52:55], v[204:207]
    v_add_u32 v3, s43, v3
    v_add_u32 v4, s43, v4
    v_mov_b32 v0, s40
    v_mfma_f32_16x16x32_bf16 v[192:195], v[36:39], v[72:75], v[192:195]
    ds_write_b32 v7, v0
    v_mfma_f32_16x16x32_bf16 v[196:199], v[36:39], v[40:43], v[196:199]
    v_mfma_f32_16x16x32_bf16 v[200:203], v[36:39], v[76:79], v[200:203]
    v_mfma_f32_16x16x32_bf16 v[204:207], v[36:39], v[48:51], v[204:207]
    ds_read_b32 v56, v5
    v_mfma_f32_16x16x32_bf16 v[208:211], v[8:11], v[40:43], v[208:211]
    v_mfma_f32_16x16x32_bf16 v[212:215], v[8:11], v[44:47], v[212:215]
    v_mfma_f32_16x16x32_bf16 v[216:219], v[8:11], v[48:51], v[216:219]
    v_mfma_f32_16x16x32_bf16 v[220:223], v[8:11], v[52:55], v[220:223]
    s_waitcnt lgkmcnt(0)
    v_cmp_gt_u32 vcc, s51, v56
    v_mfma_f32_16x16x32_bf16 v[208:211], v[12:15], v[72:75], v[208:211]
    v_mfma_f32_16x16x32_bf16 v[212:215], v[12:15], v[40:43], v[212:215]
    s_cbranch_vccnz K12_S3
K12_Q3:
    v_mfma_f32_16x16x32_bf16 v[216:219], v[12:15], v[76:79], v[216:219]
    ds_read_b64_tr_b16 v[56:57], v4 offset:0
    v_mfma_f32_16x16x32_bf16 v[220:223], v[12:15], v[48:51], v[220:223]
    ds_read_b64_tr_b16 v[58:59], v4 offset:2048
    v_mfma_f32_16x16x32_bf16 v[224:227], v[16:19], v[40:43], v[224:227]
    ds_read_b64_tr_b16 v[60:61], v4 offset:256
    ds_read_b128 v[8:11], v2 offset:0
    v_mfma_f32_16x16x32_bf16 v[228:231], v[16:19], v[44:47], v[228:231]
    ds_read_b64_tr_b16 v[62:63], v4 offset:2304
    ds_read_b128 v[12:15], v3 offset:0
    v_mfma_f32_16x16x32_bf16 v[232:235], v[16:19], v[48:51], v[232:235]
    v_xor_b32 v4, 32, v4
    ds_read_b128 v[32:35], v2 offset:6144
    v_mfma_f32_16x16x32_bf16 v[236:239], v[16:19], v[52:55], v[236:239]
    ds_read_b64_tr_b16 v[64:65], v4 offset:0
    ds_read_b128 v[36:39], v3 offset:6144
    v_mfma_f32_16x16x32_bf16 v[224:227], v[20:23], v[72:75], v[224:227]
    ds_read_b64_tr_b16 v[66:67], v4 offset:2048
    ds_read_b32 v52, v5
    v_mfma_f32_16x16x32_bf16 v[228:231], v[20:23], v[40:43], v[228:231]
    ds_read_b64_tr_b16 v[68:69], v4 offset:256
    ds_read_b64_tr_b16 v[70:71], v4 offset:2304
    v_xor_b32 v4, 32, v4
    v_mfma_f32_16x16x32_bf16 v[232:235], v[20:23], v[76:79], v[232:235]
    v_mfma_f32_16x16x32_bf16 v[236:239], v[20:23], v[48:51], v[236:239]
    v_mfma_f32_16x16x32_bf16 v[240:243], v[24:27], v[40:43], v[240:243]
    ds_read_b128 v[16:19], v2 offset:2048
    v_mfma_f32_16x16x32_bf16 v[244:247], v[24:27], v[44:47], v[244:247]
    ds_read_b128 v[20:23], v3 offset:2048
    v_mfma_f32_16x16x32_bf16 v[240:243], v[28:31], v[72:75], v[240:243]
    s_mov_b32 s29, s41
    s_mov_b32 s41, s42
    s_add_u32 s42, s42, 38912
    v_mfma_f32_16x16x32_bf16 v[244:247], v[28:31], v[40:43], v[244:247]
    s_cmp_eq_u32 s42, 155648
    s_cselect_b32 s42, 0, s42
    s_waitcnt lgkmcnt(2)
    v_mfma_f32_16x16x32_bf16 v[80:83], v[8:11], v[56:59], v[80:83]
    ds_read_b128 v[24:27], v2 offset:4096
    v_xor_b32 v72, s35, v60
    v_xor_b32 v73, s35, v61
    v_mfma_f32_16x16x32_bf16 v[84:87], v[8:11], v[60:63], v[84:87]
    ds_read_b128 v[28:31], v3 offset:4096
    v_xor_b32 v74, s35, v62
    v_xor_b32 v75, s35, v63
    v_mfma_f32_16x16x32_bf16 v[88:91], v[8:11], v[64:67], v[88:91]
    s_waitcnt lgkmcnt(2)
    v_cmp_gt_u32 vcc, s40, v52
    v_xor_b32 v76, s35, v68
    v_xor_b32 v77, s35, v69
    v_mfma_f32_16x16x32_bf16 v[92:95], v[8:11], v[68:71], v[92:95]
    s_cbranch_vccnz K12_S4
K12_Q4:
    v_xor_b32 v78, s35, v70
    v_xor_b32 v79, s35, v71
    v_mfma_f32_16x16x32_bf16 v[80:83], v[12:15], v[72:75], v[80:83]
    s_add_u32 m0, s29, s36
    s_nop 0
    buffer_load_dwordx4 v1, s[8:11], s30 offen sc1 lds
    v_mfma_f32_16x16x32_bf16 v[84:87], v[12:15], v[56:59], v[84:87]
    v_mfma_f32_16x16x32_bf16 v[88:91], v[12:15], v[76:79], v[88:91]
    v_mfma_f32_16x16x32_bf16 v[92:95], v[12:15], v[64:67], v[92:95]
    v_mfma_f32_16x16x32_bf16 v[96:99], v[16:19], v[56:59], v[96:99]
    ds_read_b128 v[8:11], v2 offset:8192
    v_mfma_f32_16x16x32_bf16 v[100:103], v[16:19], v[60:63], v[100:103]
    ds_read_b128 v[12:15], v3 offset:8192
    v_mfma_f32_16x16x32_bf16 v[104:107], v[16:19], v[64:67], v[104:107]
    buffer_load_dwordx4 v1, s[8:11], s30 offen offset:1024 sc1 lds
    v_mfma_f32_16x16x32_bf16 v[108:111], v[16:19], v[68:71], v[108:111]
    v_mfma_f32_16x16x32_bf16 v[96:99], v[20:23], v[72:75], v[96:99]
    v_mfma_f32_16x16x32_bf16 v[100:103], v[20:23], v[56:59], v[100:103]
    v_mfma_f32_16x16x32_bf16 v[104:107], v[20:23], v[76:79], v[104:107]
    buffer_load_dwordx4 v1, s[8:11], s30 offen offset:2048 sc1 lds
    v_mfma_f32_16x16x32_bf16 v[108:111], v[20:23], v[64:67], v[108:111]
    s_waitcnt lgkmcnt(2)
    v_mfma_f32_16x16x32_bf16 v[112:115], v[24:27], v[56:59], v[112:115]
    ds_read_b128 v[16:19], v2 offset:10240
    v_mfma_f32_16x16x32_bf16 v[116:119], v[24:27], v[60:63], v[116:119]
    ds_read_b128 v[20:23], v3 offset:10240
    v_mfma_f32_16x16x32_bf16 v[120:123], v[24:27], v[64:67], v[120:123]
    v_mfma_f32_16x16x32_bf16 v[124:127], v[24:27], v[68:71], v[124:127]
    v_mfma_f32_16x16x32_bf16 v[112:115], v[28:31], v[72:75], v[112:115]
    buffer_load_dwordx4 v1, s[8:11], s30 offen offset:3072 sc1 lds
    v_mfma_f32_16x16x32_bf16 v[116:119], v[28:31], v[56:59], v[116:119]
    v_mfma_f32_16x16x32_bf16 v[120:123], v[28:31], v[76:79], v[120:123]
    v_mfma_f32_16x16x32_bf16 v[124:127], v[28:31], v[64:67], v[124:127]
    v_mfma_f32_16x16x32_bf16 v[128:131], v[32:35], v[56:59], v[128:131]
    ds_read_b128 v[24:27], v2 offset:12288
    v_mfma_f32_16x16x32_bf16 v[132:135], v[32:35], v[60:63], v[132:135]
    ds_read_b128 v[28:31], v3 offset:12288
    v_mfma_f32_16x16x32_bf16 v[136:139], v[32:35], v[64:67], v[136:139]
    s_add_u32 m0, m0, 4096
    s_add_u32 s34, s30, 4096
    buffer_load_dwordx4 v1, s[8:11], s34 offen sc1 lds
    v_mfma_f32_16x16x32_bf16 v[140:143], v[32:35], v[68:71], v[140:143]
    v_mfma_f32_16x16x32_bf16 v[128:131], v[36:39], v[72:75], v[128:131]
    v_mfma_f32_16x16x32_bf16 v[132:135], v[36:39], v[56:59], v[132:135]
    v_mfma_f32_16x16x32_bf16 v[136:139], v[36:39], v[76:79], v[136:139]
    s_add_u32 m0, s29, s37
    s_add_u32 s30, s30, 21376
    buffer_load_dwordx4 v1, s[12:15], s31 offen sc1 lds
    v_mfma_f32_16x16x32_bf16 v[140:143], v[36:39], v[64:67], v[140:143]
    s_waitcnt lgkmcnt(4)
    v_mfma_f32_16x16x32_bf16 v[144:147], v[8:11], v[56:59], v[144:147]
    ds_read_b128 v[32:35], v2 offset:14336
    v_mfma_f32_16x16x32_bf16 v[148:151], v[8:11], v[60:63], v[148:151]
    ds_read_b128 v[36:39], v3 offset:14336
    v_mfma_f32_16x16x32_bf16 v[152:155], v[8:11], v[64:67], v[152:155]
    v_mfma_f32_16x16x32_bf16 v[156:159], v[8:11], v[68:71], v[156:159]
    s_add_u32 s40, s40, 1
    s_mov_b32 s51, s40
    v_mov_b32 v0, s40
    v_mfma_f32_16x16x32_bf16 v[144:147], v[12:15], v[72:75], v[144:147]
    s_waitcnt vmcnt(17)
    ds_write_b32 v7, v0
    buffer_load_dwordx4 v1, s[12:15], s31 offen offset:1024 sc1 lds
    v_mfma_f32_16x16x32_bf16 v[148:151], v[12:15], v[56:59], v[148:151]
    v_mfma_f32_16x16x32_bf16 v[152:155], v[12:15], v[76:79], v[152:155]
    v_mfma_f32_16x16x32_bf16 v[156:159], v[12:15], v[64:67], v[156:159]
    s_waitcnt lgkmcnt(5)
    v_mfma_f32_16x16x32_bf16 v[160:163], v[16:19], v[56:59], v[160:163]
    ds_read_b128 v[8:11], v2 offset:16384
    v_mfma_f32_16x16x32_bf16 v[164:167], v[16:19], v[60:63], v[164:167]
    ds_read_b128 v[12:15], v3 offset:16384
    v_mfma_f32_16x16x32_bf16 v[168:171], v[16:19], v[64:67], v[168:171]
    buffer_load_dwordx4 v1, s[12:15], s31 offen offset:2048 sc1 lds
    v_mfma_f32_16x16x32_bf16 v[172:175], v[16:19], v[68:71], v[172:175]
    v_mfma_f32_16x16x32_bf16 v[160:163], v[20:23], v[72:75], v[160:163]
    v_mfma_f32_16x16x32_bf16 v[164:167], v[20:23], v[56:59], v[164:167]
    v_mfma_f32_16x16x32_bf16 v[168:171], v[20:23], v[76:79], v[168:171]
    buffer_load_dwordx4 v1, s[12:15], s31 offen offset:3072 sc1 lds
    v_mfma_f32_16x16x32_bf16 v[172:175], v[20:23], v[64:67], v[172:175]
    s_waitcnt lgkmcnt(5)
    v_mfma_f32_16x16x32_bf16 v[176:179], v[24:27], v[56:59], v[176:179]
    ds_read_b128 v[16:19], v2 offset:18432
    v_mfma_f32_16x16x32_bf16 v[180:183], v[24:27], v[60:63], v[180:183]
    ds_read_b128 v[20:23], v3 offset:18432
    v_mfma_f32_16x16x32_bf16 v[184:187], v[24:27], v[64:67], v[184:187]
    v_mfma_f32_16x16x32_bf16 v[188:191], v[24:27], v[68:71], v[188:191]
    v_mfma_f32_16x16x32_bf16 v[176:179], v[28:31], v[72:75], v[176:179]
    s_add_u32 m0, s29, s38
    s_mov_b64 exec, s[44:45]
    buffer_load_dwordx4 v1, s[64:67], s33 offen sc1 lds
    s_mov_b64 exec, -1
    s_add_u32 s31, s31, 16384
    s_add_u32 s33, s33, 21376
    v_mfma_f32_16x16x32_bf16 v[180:183], v[28:31], v[56:59], v[180:183]
    v_mfma_f32_16x16x32_bf16 v[184:187], v[28:31], v[76:79], v[184:187]
    s_mov_b32 m0, s46
    s_mov_b64 exec, 0xff
    buffer_load_dword v1, s[4:7], 0 offen sc1 lds
    s_mov_b64 exec, -1
    v_mfma_f32_16x16x32_bf16 v[188:191], v[28:31], v[64:67], v[188:191]
    s_waitcnt lgkmcnt(5)
    v_mfma_f32_16x16x32_bf16 v[192:195], v[32:35], v[56:59], v[192:195]
    ds_read_b128 v[24:27], v2 offset:20480
    v_mfma_f32_16x16x32_bf16 v[196:199], v[32:35], v[60:63], v[196:199]
    ds_read_b128 v[28:31], v3 offset:20480
    v_mfma_f32_16x16x32_bf16 v[200:203], v[32:35], v[64:67], v[200:203]
    s_sub_u32 s43, s42, s41
    s_add_u32 s40, s40, 1
    v_add_u32 v2, s43, v2
    v_mfma_f32_16x16x32_bf16 v[204:207], v[32:35], v[68:71], v[204:207]
    v_add_u32 v3, s43, v3
    v_add_u32 v4, s43, v4
    v_mov_b32 v0, s40
    v_mfma_f32_16x16x32_bf16 v[192:195], v[36:39], v[72:75], v[192:195]
    ds_write_b32 v7, v0
    v_mfma_f32_16x16x32_bf16 v[196:199], v[36:39], v[56:59], v[196:199]
    v_mfma_f32_16x16x32_bf16 v[200:203], v[36:39], v[76:79], v[200:203]
    v_mfma_f32_16x16x32_bf16 v[204:207], v[36:39], v[64:67], v[204:207]
    ds_read_b32 v40, v5
    s_waitcnt lgkmcnt(6)
    v_mfma_f32_16x16x32_bf16 v[208:211], v[8:11], v[56:59], v[208:211]
    v_mfma_f32_16x16x32_bf16 v[212:215], v[8:11], v[60:63], v[212:215]
    v_mfma_f32_16x16x32_bf16 v[216:219], v[8:11], v[64:67], v[216:219]
    v_mfma_f32_16x16x32_bf16 v[220:223], v[8:11], v[68:71], v[220:223]
    s_waitcnt lgkmcnt(0)
    v_cmp_gt_u32 vcc, s51, v40
    v_mfma_f32_16x16x32_bf16 v[208:211], v[12:15], v[72:75], v[208:211]
    v_mfma_f32_16x16x32_bf16 v[212:215], v[12:15], v[56:59], v[212:215]
    s_cbranch_vccnz K12_S5
K12_Q5:
    v_mfma_f32_16x16x32_bf16 v[216:219], v[12:15], v[76:79], v[216:219]
    ds_read_b64_tr_b16 v[40:41], v4 offset:0
    v_mfma_f32_16x16x32_bf16 v[220:223], v[12:15], v[64:67], v[220:223]
    ds_read_b64_tr_b16 v[42:43], v4 offset:2048
    v_mfma_f32_16x16x32_bf16 v[224:227], v[16:19], v[56:59], v[224:227]
    ds_read_b64_tr_b16 v[44:45], v4 offset:256
    ds_read_b128 v[8:11], v2 offset:0
    v_mfma_f32_16x16x32_bf16 v[228:231], v[16:19], v[60:63], v[228:231]
    ds_read_b64_tr_b16 v[46:47], v4 offset:2304
    ds_read_b128 v[12:15], v3 offset:0
    v_mfma_f32_16x16x32_bf16 v[232:235], v[16:19], v[64:67], v[232:235]
    v_xor_b32 v4, 32, v4
    ds_read_b128 v[32:35], v2 offset:6144
    v_mfma_f32_16x16x32_bf16 v[236:239], v[16:19], v[68:71], v[236:239]
    ds_read_b64_tr_b16 v[48:49], v4 offset:0
    ds_read_b128 v[36:39], v3 offset:6144
    v_mfma_f32_16x16x32_bf16 v[224:227], v[20:23], v[72:75], v[224:227]
    ds_read_b64_tr_b16 v[50:51], v4 offset:2048
    ds_read_b32 v68, v5
    v_mfma_f32_16x16x32_bf16 v[228:231], v[20:23], v[56:59], v[228:231]
    ds_read_b64_tr_b16 v[52:53], v4 offset:256
    ds_read_b64_tr_b16 v[54:55], v4 offset:2304
    v_xor_b32 v4, 32, v4
    v_mfma_f32_16x16x32_bf16 v[232:235], v[20:23], v[76:79], v[232:235]
    v_mfma_f32_16x16x32_bf16 v[236:239], v[20:23], v[64:67], v[236:239]
    v_mfma_f32_16x16x32_bf16 v[240:243], v[24:27], v[56:59], v[240:243]
    ds_read_b128 v[16:19], v2 offset:2048
    v_mfma_f32_16x16x32_bf16 v[244:247], v[24:27], v[60:63], v[244:247]
    ds_read_b128 v[20:23], v3 offset:2048
    v_mfma_f32_16x16x32_bf16 v[240:243], v[28:31], v[72:75], v[240:243]
    s_mov_b32 s29, s41
    s_mov_b32 s41, s42
    s_add_u32 s42, s42, 38912
    v_mfma_f32_16x16x32_bf16 v[244:247], v[28:31], v[56:59], v[244:247]
    s_cmp_eq_u32 s42, 155648
    s_cselect_b32 s42, 0, s42
    s_add_u32 s39, s39, 1
    s_cmp_lt_u32 s39, 15
    s_cbranch_scc1 K12_LOOP
    s_waitcnt lgkmcnt(2)
    v_mfma_f32_16x16x32_bf16 v[80:83], v[8:11], v[40:43], v[80:83]
    ds_read_b128 v[24:27], v2 offset:4096
    v_xor_b32 v72, s35, v44
    v_xor_b32 v73, s35, v45
    v_mfma_f32_16x16x32_bf16 v[84:87], v[8:11], v[44:47], v[84:87]
    ds_read_b128 v[28:31], v3 offset:4096
    v_xor_b32 v74, s35, v46
    v_xor_b32 v75, s35, v47
    v_mfma_f32_16x16x32_bf16 v[88:91], v[8:11], v[48:51], v[88:91]
    s_waitcnt lgkmcnt(2)
    v_cmp_gt_u32 vcc, s40, v68
    s_add_u32 s49, s39, 2
    s_lshr_b32 s49, s49, 1
    v_xor_b32 v76, s35, v52
    v_xor_b32 v77, s35, v53
    v_mfma_f32_16x16x32_bf16 v[92:95], v[8:11], v[52:55], v[92:95]
    s_cbranch_vccnz K12_S6
K12_Q6:
    s_mul_i32 s48, s49, s50
    s_add_u32 s48, s48, s47
    v_xor_b32 v78, s35, v54
    v_xor_b32 v79, s35, v55
    v_mfma_f32_16x16x32_bf16 v[80:83], v[12:15], v[72:75], v[80:83]
    s_add_u32 m0, s29, s36
    s_nop 0
    buffer_load_dwordx4 v1, s[8:11], s30 offen sc1 lds
    v_mfma_f32_16x16x32_bf16 v[84:87], v[12:15], v[40:43], v[84:87]
    s_cmp_lt_u32 s49, 8
    s_cselect_b32 s48, s48, 155744
    v_mfma_f32_16x16x32_bf16 v[88:91], v[12:15], v[76:79], v[88:91]
    s_cmp_ge_u32 s49, 3
    s_cselect_b32 s48, s48, 155744
    v_mfma_f32_16x16x32_bf16 v[92:95], v[12:15], v[48:51], v[92:95]
    v_mfma_f32_16x16x32_bf16 v[96:99], v[16:19], v[40:43], v[96:99]
    ds_read_b128 v[8:11], v2 offset:8192
    v_mfma_f32_16x16x32_bf16 v[100:103], v[16:19], v[44:47], v[100:103]
    ds_read_b128 v[12:15], v3 offset:8192
    v_mfma_f32_16x16x32_bf16 v[104:107], v[16:19], v[48:51], v[104:107]
    buffer_load_dwordx4 v1, s[8:11], s30 offen offset:1024 sc1 lds
    v_mfma_f32_16x16x32_bf16 v[108:111], v[16:19], v[52:55], v[108:111]
    v_mfma_f32_16x16x32_bf16 v[96:99], v[20:23], v[72:75], v[96:99]
    v_mfma_f32_16x16x32_bf16 v[100:103], v[20:23], v[40:43], v[100:103]
    v_mfma_f32_16x16x32_bf16 v[104:107], v[20:23], v[76:79], v[104:107]
    buffer_load_dwordx4 v1, s[8:11], s30 offen offset:2048 sc1 lds
    v_mfma_f32_16x16x32_bf16 v[108:111], v[20:23], v[48:51], v[108:111]
    s_waitcnt lgkmcnt(2)
    v_mfma_f32_16x16x32_bf16 v[112:115], v[24:27], v[40:43], v[112:115]
    ds_read_b128 v[16:19], v2 offset:10240
    v_mfma_f32_16x16x32_bf16 v[116:119], v[24:27], v[44:47], v[116:119]
    ds_read_b128 v[20:23], v3 offset:10240
    v_mfma_f32_16x16x32_bf16 v[120:123], v[24:27], v[48:51], v[120:123]
    v_mfma_f32_16x16x32_bf16 v[124:127], v[24:27], v[52:55], v[124:127]
    v_mfma_f32_16x16x32_bf16 v[112:115], v[28:31], v[72:75], v[112:115]
    buffer_load_dwordx4 v1, s[8:11], s30 offen offset:3072 sc1 lds
    v_mfma_f32_16x16x32_bf16 v[116:119], v[28:31], v[40:43], v[116:119]
    v_mfma_f32_16x16x32_bf16 v[120:123], v[28:31], v[76:79], v[120:123]
    v_mfma_f32_16x16x32_bf16 v[124:127], v[28:31], v[48:51], v[124:127]
    v_mfma_f32_16x16x32_bf16 v[128:131], v[32:35], v[40:43], v[128:131]
    ds_read_b128 v[24:27], v2 offset:12288
    v_mfma_f32_16x16x32_bf16 v[132:135], v[32:35], v[44:47], v[132:135]
    ds_read_b128 v[28:31], v3 offset:12288
    v_mfma_f32_16x16x32_bf16 v[136:139], v[32:35], v[48:51], v[136:139]
    s_add_u32 m0, m0, 4096
    s_add_u32 s34, s30, 4096
    buffer_load_dwordx4 v1, s[8:11], s34 offen sc1 lds
    v_mfma_f32_16x16x32_bf16 v[140:143], v[32:35], v[52:55], v[140:143]
    v_mfma_f32_16x16x32_bf16 v[128:131], v[36:39], v[72:75], v[128:131]
    v_mfma_f32_16x16x32_bf16 v[132:135], v[36:39], v[40:43], v[132:135]
    v_mfma_f32_16x16x32_bf16 v[136:139], v[36:39], v[76:79], v[136:139]
    s_add_u32 m0, s29, s37
    s_add_u32 s30, s30, 21376
    buffer_load_dwordx4 v1, s[12:15], s31 offen sc1 lds
    v_mfma_f32_16x16x32_bf16 v[140:143], v[36:39], v[48:51], v[140:143]
    s_waitcnt lgkmcnt(4)
    v_mfma_f32_16x16x32_bf16 v[144:147], v[8:11], v[40:43], v[144:147]
    ds_read_b128 v[32:35], v2 offset:14336
    v_mfma_f32_16x16x32_bf16 v[148:151], v[8:11], v[44:47], v[148:151]
    ds_read_b128 v[36:39], v3 offset:14336
    v_mfma_f32_16x16x32_bf16 v[152:155], v[8:11], v[48:51], v[152:155]
    v_mfma_f32_16x16x32_bf16 v[156:159], v[8:11], v[52:55], v[156:159]
    s_add_u32 s40, s40, 1
    s_mov_b32 s51, s40
    v_mov_b32 v0, s40
    v_mfma_f32_16x16x32_bf16 v[144:147], v[12:15], v[72:75], v[144:147]
    s_waitcnt vmcnt(17)
    ds_write_b32 v7, v0
    buffer_load_dwordx4 v1, s[12:15], s31 offen offset:1024 sc1 lds
    v_mfma_f32_16x16x32_bf16 v[148:151], v[12:15], v[40:43], v[148:151]
    v_mfma_f32_16x16x32_bf16 v[152:155], v[12:15], v[76:79], v[152:155]
    v_mfma_f32_16x16x32_bf16 v[156:159], v[12:15], v[48:51], v[156:159]
    s_waitcnt lgkmcnt(5)
    v_mfma_f32_16x16x32_bf16 v[160:163], v[16:19], v[40:43], v[160:163]
    ds_read_b128 v[8:11], v2 offset:16384
    v_mfma_f32_16x16x32_bf16 v[164:167], v[16:19], v[44:47], v[164:167]
    ds_read_b128 v[12:15], v3 offset:16384
    v_mfma_f32_16x16x32_bf16 v[168:171], v[16:19], v[48:51], v[168:171]
    buffer_load_dwordx4 v1, s[12:15], s31 offen offset:2048 sc1 lds
    v_mfma_f32_16x16x32_bf16 v[172:175], v[16:19], v[52:55], v[172:175]
    v_mfma_f32_16x16x32_bf16 v[160:163], v[20:23], v[72:75], v[160:163]
    v_mfma_f32_16x16x32_bf16 v[164:167], v[20:23], v[40:43], v[164:167]
    v_mfma_f32_16x16x32_bf16 v[168:171], v[20:23], v[76:79], v[168:171]
    buffer_load_dwordx4 v1, s[12:15], s31 offen offset:3072 sc1 lds
    v_mfma_f32_16x16x32_bf16 v[172:175], v[20:23], v[48:51], v[172:175]
    s_waitcnt lgkmcnt(5)
    v_mfma_f32_16x16x32_bf16 v[176:179], v[24:27], v[40:43], v[176:179]
    ds_read_b128 v[16:19], v2 offset:18432
    v_mfma_f32_16x16x32_bf16 v[180:183], v[24:27], v[44:47], v[180:183]
    ds_read_b128 v[20:23], v3 offset:18432
    v_mov_b32 v0, s48
    v_mfma_f32_16x16x32_bf16 v[184:187], v[24:27], v[48:51], v[184:187]
    ds_read_b32 v0, v0
    v_mfma_f32_16x16x32_bf16 v[188:191], v[24:27], v[52:55], v[188:191]
    v_mfma_f32_16x16x32_bf16 v[176:179], v[28:31], v[72:75], v[176:179]
    s_add_u32 m0, s29, s38
    s_mov_b64 exec, s[44:45]
    buffer_load_dwordx4 v1, s[64:67], s33 offen sc1 lds
    s_mov_b64 exec, -1
    s_add_u32 s31, s31, 16384
    s_add_u32 s33, s33, 21376
    v_mfma_f32_16x16x32_bf16 v[180:183], v[28:31], v[40:43], v[180:183]
    v_mfma_f32_16x16x32_bf16 v[184:187], v[28:31], v[76:79], v[184:187]
    v_mfma_f32_16x16x32_bf16 v[188:191], v[28:31], v[48:51], v[188:191]
    s_waitcnt lgkmcnt(0)
    v_cmp_eq_u32 vcc, 0, v0
    v_mfma_f32_16x16x32_bf16 v[192:195], v[32:35], v[40:43], v[192:195]
    ds_read_b128 v[24:27], v2 offset:20480
    v_mfma_f32_16x16x32_bf16 v[196:199], v[32:35], v[44:47], v[196:199]
    ds_read_b128 v[28:31], v3 offset:20480
    s_cbranch_vccnz K12_F7
K12_G7:
    v_mfma_f32_16x16x32_bf16 v[200:203], v[32:35], v[48:51], v[200:203]
    s_sub_u32 s43, s42, s41
    s_add_u32 s40, s40, 1
    v_add_u32 v2, s43, v2
    v_mfma_f32_16x16x32_bf16 v[204:207], v[32:35], v[52:55], v[204:207]
    v_add_u32 v3, s43, v3
    v_add_u32 v4, s43, v4
    v_mov_b32 v0, s40
    v_mfma_f32_16x16x32_bf16 v[192:195], v[36:39], v[72:75], v[192:195]
    ds_write_b32 v7, v0
    v_mfma_f32_16x16x32_bf16 v[196:199], v[36:39], v[40:43], v[196:199]
    v_mfma_f32_16x16x32_bf16 v[200:203], v[36:39], v[76:79], v[200:203]
    v_mfma_f32_16x16x32_bf16 v[204:207], v[36:39], v[48:51], v[204:207]
    ds_read_b32 v56, v5
    v_mfma_f32_16x16x32_bf16 v[208:211], v[8:11], v[40:43], v[208:211]
    v_mfma_f32_16x16x32_bf16 v[212:215], v[8:11], v[44:47], v[212:215]
    v_mfma_f32_16x16x32_bf16 v[216:219], v[8:11], v[48:51], v[216:219]
    v_mfma_f32_16x16x32_bf16 v[220:223], v[8:11], v[52:55], v[220:223]
    s_waitcnt lgkmcnt(0)
    v_cmp_gt_u32 vcc, s51, v56
    v_mfma_f32_16x16x32_bf16 v[208:211], v[12:15], v[72:75], v[208:211]
    v_mfma_f32_16x16x32_bf16 v[212:215], v[12:15], v[40:43], v[212:215]
    s_cbranch_vccnz K12_S8
K12_Q8:
    v_mfma_f32_16x16x32_bf16 v[216:219], v[12:15], v[76:79], v[216:219]
    ds_read_b64_tr_b16 v[56:57], v4 offset:0
    v_mfma_f32_16x16x32_bf16 v[220:223], v[12:15], v[48:51], v[220:223]
    ds_read_b64_tr_b16 v[58:59], v4 offset:2048
    v_mfma_f32_16x16x32_bf16 v[224:227], v[16:19], v[40:43], v[224:227]
    ds_read_b64_tr_b16 v[60:61], v4 offset:256
    ds_read_b128 v[8:11], v2 offset:0
    v_mfma_f32_16x16x32_bf16 v[228:231], v[16:19], v[44:47], v[228:231]
    ds_read_b64_tr_b16 v[62:63], v4 offset:2304
    ds_read_b128 v[12:15], v3 offset:0
    v_mfma_f32_16x16x32_bf16 v[232:235], v[16:19], v[48:51], v[232:235]
    v_xor_b32 v4, 32, v4
    ds_read_b128 v[32:35], v2 offset:6144
    v_mfma_f32_16x16x32_bf16 v[236:239], v[16:19], v[52:55], v[236:239]
    ds_read_b64_tr_b16 v[64:65], v4 offset:0
    ds_read_b128 v[36:39], v3 offset:6144
    v_mfma_f32_16x16x32_bf16 v[224:227], v[20:23], v[72:75], v[224:227]
    ds_read_b64_tr_b16 v[66:67], v4 offset:2048
    ds_read_b32 v52, v5
    v_mfma_f32_16x16x32_bf16 v[228:231], v[20:23], v[40:43], v[228:231]
    ds_read_b64_tr_b16 v[68:69], v4 offset:256
    ds_read_b64_tr_b16 v[70:71], v4 offset:2304
    v_xor_b32 v4, 32, v4
    v_mfma_f32_16x16x32_bf16 v[232:235], v[20:23], v[76:79], v[232:235]
    v_mfma_f32_16x16x32_bf16 v[236:239], v[20:23], v[48:51], v[236:239]
    v_mfma_f32_16x16x32_bf16 v[240:243], v[24:27], v[40:43], v[240:243]
    ds_read_b128 v[16:19], v2 offset:2048
    v_mfma_f32_16x16x32_bf16 v[244:247], v[24:27], v[44:47], v[244:247]
    ds_read_b128 v[20:23], v3 offset:2048
    v_mfma_f32_16x16x32_bf16 v[240:243], v[28:31], v[72:75], v[240:243]
    s_mov_b32 s29, s41
    s_mov_b32 s41, s42
    s_add_u32 s42, s42, 38912
    v_mfma_f32_16x16x32_bf16 v[244:247], v[28:31], v[40:43], v[244:247]
    s_cmp_eq_u32 s42, 155648
    s_cselect_b32 s42, 0, s42
    s_waitcnt lgkmcnt(2)
    v_mfma_f32_16x16x32_bf16 v[80:83], v[8:11], v[56:59], v[80:83]
    ds_read_b128 v[24:27], v2 offset:4096
    v_xor_b32 v72, s35, v60
    v_xor_b32 v73, s35, v61
    v_mfma_f32_16x16x32_bf16 v[84:87], v[8:11], v[60:63], v[84:87]
    ds_read_b128 v[28:31], v3 offset:4096
    v_xor_b32 v74, s35, v62
    v_xor_b32 v75, s35, v63
    v_mfma_f32_16x16x32_bf16 v[88:91], v[8:11], v[64:67], v[88:91]
    v_xor_b32 v76, s35, v68
    v_xor_b32 v77, s35, v69
    v_mfma_f32_16x16x32_bf16 v[92:95], v[8:11], v[68:71], v[92:95]
    v_xor_b32 v78, s35, v70
    v_xor_b32 v79, s35, v71
    v_mfma_f32_16x16x32_bf16 v[80:83], v[12:15], v[72:75], v[80:83]
    v_lshrrev_b32 v0, 4, v1
    v_and_b32 v5, 15, v0
    v_mfma_f32_16x16x32_bf16 v[84:87], v[12:15], v[56:59], v[84:87]
    v_lshrrev_b32 v0, 4, v0
    s_lshl_b32 s28, s21, 7
    v_mfma_f32_16x16x32_bf16 v[88:91], v[12:15], v[76:79], v[88:91]
    s_lshl_b32 s29, s3, 5
    s_add_u32 s28, s28, s29
    v_mfma_f32_16x16x32_bf16 v[92:95], v[12:15], v[64:67], v[92:95]
    v_add_u32 v5, s28, v5
    v_lshlrev_b32 v5, 2, v5
    s_waitcnt lgkmcnt(2)
    v_mfma_f32_16x16x32_bf16 v[96:99], v[16:19], v[56:59], v[96:99]
    ds_read_b128 v[8:11], v2 offset:8192
    v_lshl_add_u32 v5, v0, 13, v5
    s_lshl_b32 s28, s20, 6
    v_mfma_f32_16x16x32_bf16 v[100:103], v[16:19], v[60:63], v[100:103]
    ds_read_b128 v[12:15], v3 offset:8192
    v_xor_b32 v5, s28, v5
    v_xor_b32 v7, 64, v5
    v_mfma_f32_16x16x32_bf16 v[104:107], v[16:19], v[64:67], v[104:107]
    v_mfma_f32_16x16x32_bf16 v[108:111], v[16:19], v[68:71], v[108:111]
    s_mov_b32 s38, 0
    v_cvt_pk_bf16_f32 v48, v80, v84
    buffer_store_dword v48, v5, s[16:19], s38 offen offset:0 sc1
    v_cvt_pk_bf16_f32 v49, v88, v92
    buffer_store_dword v49, v7, s[16:19], s38 offen offset:0 sc1
    v_mfma_f32_16x16x32_bf16 v[96:99], v[20:23], v[72:75], v[96:99]
    v_cvt_pk_bf16_f32 v50, v81, v85
    buffer_store_dword v50, v5, s[16:19], s38 offen offset:2048 sc1
    v_mfma_f32_16x16x32_bf16 v[100:103], v[20:23], v[56:59], v[100:103]
    v_cvt_pk_bf16_f32 v51, v89, v93
    buffer_store_dword v51, v7, s[16:19], s38 offen offset:2048 sc1
    v_mfma_f32_16x16x32_bf16 v[104:107], v[20:23], v[76:79], v[104:107]
    s_mov_b32 s38, 4096
    v_cvt_pk_bf16_f32 v52, v82, v86
    buffer_store_dword v52, v5, s[16:19], s38 offen offset:0 sc1
    v_cvt_pk_bf16_f32 v53, v90, v94
    buffer_store_dword v53, v7, s[16:19], s38 offen offset:0 sc1
    v_mfma_f32_16x16x32_bf16 v[108:111], v[20:23], v[64:67], v[108:111]
    v_cvt_pk_bf16_f32 v54, v83, v87
    buffer_store_dword v54, v5, s[16:19], s38 offen offset:2048 sc1
    s_waitcnt lgkmcnt(2)
    v_mfma_f32_16x16x32_bf16 v[112:115], v[24:27], v[56:59], v[112:115]
    ds_read_b128 v[16:19], v2 offset:10240
    v_cvt_pk_bf16_f32 v55, v91, v95
    buffer_store_dword v55, v7, s[16:19], s38 offen offset:2048 sc1
    v_mfma_f32_16x16x32_bf16 v[116:119], v[24:27], v[60:63], v[116:119]
    ds_read_b128 v[20:23], v3 offset:10240
    v_mfma_f32_16x16x32_bf16 v[120:123], v[24:27], v[64:67], v[120:123]
    v_mfma_f32_16x16x32_bf16 v[124:127], v[24:27], v[68:71], v[124:127]
    s_mov_b32 s38, 32768
    v_cvt_pk_bf16_f32 v40, v96, v100
    buffer_store_dword v40, v5, s[16:19], s38 offen offset:0 sc1
    v_cvt_pk_bf16_f32 v41, v104, v108
    buffer_store_dword v41, v7, s[16:19], s38 offen offset:0 sc1
    v_mfma_f32_16x16x32_bf16 v[112:115], v[28:31], v[72:75], v[112:115]
    v_cvt_pk_bf16_f32 v42, v97, v101
    buffer_store_dword v42, v5, s[16:19], s38 offen offset:2048 sc1
    v_mfma_f32_16x16x32_bf16 v[116:119], v[28:31], v[56:59], v[116:119]
    v_cvt_pk_bf16_f32 v43, v105, v109
    buffer_store_dword v43, v7, s[16:19], s38 offen offset:2048 sc1
    v_mfma_f32_16x16x32_bf16 v[120:123], v[28:31], v[76:79], v[120:123]
    s_mov_b32 s38, 36864
    v_cvt_pk_bf16_f32 v44, v98, v102
    buffer_store_dword v44, v5, s[16:19], s38 offen offset:0 sc1
    v_cvt_pk_bf16_f32 v45, v106, v110
    buffer_store_dword v45, v7, s[16:19], s38 offen offset:0 sc1
    v_mfma_f32_16x16x32_bf16 v[124:127], v[28:31], v[64:67], v[124:127]
    v_cvt_pk_bf16_f32 v46, v99, v103
    buffer_store_dword v46, v5, s[16:19], s38 offen offset:2048 sc1
    v_mfma_f32_16x16x32_bf16 v[128:131], v[32:35], v[56:59], v[128:131]
    ds_read_b128 v[24:27], v2 offset:12288
    v_cvt_pk_bf16_f32 v47, v107, v111
    buffer_store_dword v47, v7, s[16:19], s38 offen offset:2048 sc1
    v_mfma_f32_16x16x32_bf16 v[132:135], v[32:35], v[60:63], v[132:135]
    ds_read_b128 v[28:31], v3 offset:12288
    v_mfma_f32_16x16x32_bf16 v[136:139], v[32:35], v[64:67], v[136:139]
    v_mfma_f32_16x16x32_bf16 v[140:143], v[32:35], v[68:71], v[140:143]
    s_mov_b32 s38, 65536
    v_cvt_pk_bf16_f32 v48, v112, v116
    buffer_store_dword v48, v5, s[16:19], s38 offen offset:0 sc1
    v_cvt_pk_bf16_f32 v49, v120, v124
    buffer_store_dword v49, v7, s[16:19], s38 offen offset:0 sc1
    v_mfma_f32_16x16x32_bf16 v[128:131], v[36:39], v[72:75], v[128:131]
    v_cvt_pk_bf16_f32 v50, v113, v117
    buffer_store_dword v50, v5, s[16:19], s38 offen offset:2048 sc1
    v_mfma_f32_16x16x32_bf16 v[132:135], v[36:39], v[56:59], v[132:135]
    v_cvt_pk_bf16_f32 v51, v121, v125
    buffer_store_dword v51, v7, s[16:19], s38 offen offset:2048 sc1
    v_mfma_f32_16x16x32_bf16 v[136:139], v[36:39], v[76:79], v[136:139]
    s_mov_b32 s38, 69632
    v_cvt_pk_bf16_f32 v52, v114, v118
    buffer_store_dword v52, v5, s[16:19], s38 offen offset:0 sc1
    v_cvt_pk_bf16_f32 v53, v122, v126
    buffer_store_dword v53, v7, s[16:19], s38 offen offset:0 sc1
    v_mfma_f32_16x16x32_bf16 v[140:143], v[36:39], v[64:67], v[140:143]
    v_cvt_pk_bf16_f32 v54, v115, v119
    buffer_store_dword v54, v5, s[16:19], s38 offen offset:2048 sc1
    s_waitcnt lgkmcnt(4)
    v_mfma_f32_16x16x32_bf16 v[144:147], v[8:11], v[56:59], v[144:147]
    ds_read_b128 v[32:35], v2 offset:14336
    v_cvt_pk_bf16_f32 v55, v123, v127
    buffer_store_dword v55, v7, s[16:19], s38 offen offset:2048 sc1
    v_mfma_f32_16x16x32_bf16 v[148:151], v[8:11], v[60:63], v[148:151]
    ds_read_b128 v[36:39], v3 offset:14336
    v_mfma_f32_16x16x32_bf16 v[152:155], v[8:11], v[64:67], v[152:155]
    v_mfma_f32_16x16x32_bf16 v[156:159], v[8:11], v[68:71], v[156:159]
    s_mov_b32 s38, 98304
    v_cvt_pk_bf16_f32 v40, v128, v132
    buffer_store_dword v40, v5, s[16:19], s38 offen offset:0 sc1
    v_cvt_pk_bf16_f32 v41, v136, v140
    buffer_store_dword v41, v7, s[16:19], s38 offen offset:0 sc1
    v_mfma_f32_16x16x32_bf16 v[144:147], v[12:15], v[72:75], v[144:147]
    v_cvt_pk_bf16_f32 v42, v129, v133
    buffer_store_dword v42, v5, s[16:19], s38 offen offset:2048 sc1
    v_mfma_f32_16x16x32_bf16 v[148:151], v[12:15], v[56:59], v[148:151]
    v_cvt_pk_bf16_f32 v43, v137, v141
    buffer_store_dword v43, v7, s[16:19], s38 offen offset:2048 sc1
    v_mfma_f32_16x16x32_bf16 v[152:155], v[12:15], v[76:79], v[152:155]
    s_mov_b32 s38, 102400
    v_cvt_pk_bf16_f32 v44, v130, v134
    buffer_store_dword v44, v5, s[16:19], s38 offen offset:0 sc1
    v_cvt_pk_bf16_f32 v45, v138, v142
    buffer_store_dword v45, v7, s[16:19], s38 offen offset:0 sc1
    v_mfma_f32_16x16x32_bf16 v[156:159], v[12:15], v[64:67], v[156:159]
    v_cvt_pk_bf16_f32 v46, v131, v135
    buffer_store_dword v46, v5, s[16:19], s38 offen offset:2048 sc1
    s_waitcnt lgkmcnt(4)
    v_mfma_f32_16x16x32_bf16 v[160:163], v[16:19], v[56:59], v[160:163]
    ds_read_b128 v[8:11], v2 offset:16384
    v_cvt_pk_bf16_f32 v47, v139, v143
    buffer_store_dword v47, v7, s[16:19], s38 offen offset:2048 sc1
    v_mfma_f32_16x16x32_bf16 v[164:167], v[16:19], v[60:63], v[164:167]
    ds_read_b128 v[12:15], v3 offset:16384
    v_mfma_f32_16x16x32_bf16 v[168:171], v[16:19], v[64:67], v[168:171]
    v_mfma_f32_16x16x32_bf16 v[172:175], v[16:19], v[68:71], v[172:175]
    s_mov_b32 s38, 131072
    v_cvt_pk_bf16_f32 v48, v144, v148
    buffer_store_dword v48, v5, s[16:19], s38 offen offset:0 sc1
    v_cvt_pk_bf16_f32 v49, v152, v156
    buffer_store_dword v49, v7, s[16:19], s38 offen offset:0 sc1
    v_mfma_f32_16x16x32_bf16 v[160:163], v[20:23], v[72:75], v[160:163]
    v_cvt_pk_bf16_f32 v50, v145, v149
    buffer_store_dword v50, v5, s[16:19], s38 offen offset:2048 sc1
    v_mfma_f32_16x16x32_bf16 v[164:167], v[20:23], v[56:59], v[164:167]
    v_cvt_pk_bf16_f32 v51, v153, v157
    buffer_store_dword v51, v7, s[16:19], s38 offen offset:2048 sc1
    v_mfma_f32_16x16x32_bf16 v[168:171], v[20:23], v[76:79], v[168:171]
    s_mov_b32 s38, 135168
    v_cvt_pk_bf16_f32 v52, v146, v150
    buffer_store_dword v52, v5, s[16:19], s38 offen offset:0 sc1
    v_cvt_pk_bf16_f32 v53, v154, v158
    buffer_store_dword v53, v7, s[16:19], s38 offen offset:0 sc1
    v_mfma_f32_16x16x32_bf16 v[172:175], v[20:23], v[64:67], v[172:175]
    v_cvt_pk_bf16_f32 v54, v147, v151
    buffer_store_dword v54, v5, s[16:19], s38 offen offset:2048 sc1
    s_waitcnt lgkmcnt(4)
    v_mfma_f32_16x16x32_bf16 v[176:179], v[24:27], v[56:59], v[176:179]
    ds_read_b128 v[16:19], v2 offset:18432
    v_cvt_pk_bf16_f32 v55, v155, v159
    buffer_store_dword v55, v7, s[16:19], s38 offen offset:2048 sc1
    v_mfma_f32_16x16x32_bf16 v[180:183], v[24:27], v[60:63], v[180:183]
    ds_read_b128 v[20:23], v3 offset:18432
    v_mfma_f32_16x16x32_bf16 v[184:187], v[24:27], v[64:67], v[184:187]
    v_mfma_f32_16x16x32_bf16 v[188:191], v[24:27], v[68:71], v[188:191]
    s_mov_b32 s38, 163840
    v_cvt_pk_bf16_f32 v40, v160, v164
    buffer_store_dword v40, v5, s[16:19], s38 offen offset:0 sc1
    v_cvt_pk_bf16_f32 v41, v168, v172
    buffer_store_dword v41, v7, s[16:19], s38 offen offset:0 sc1
    v_mfma_f32_16x16x32_bf16 v[176:179], v[28:31], v[72:75], v[176:179]
    v_cvt_pk_bf16_f32 v42, v161, v165
    buffer_store_dword v42, v5, s[16:19], s38 offen offset:2048 sc1
    v_mfma_f32_16x16x32_bf16 v[180:183], v[28:31], v[56:59], v[180:183]
    v_cvt_pk_bf16_f32 v43, v169, v173
    buffer_store_dword v43, v7, s[16:19], s38 offen offset:2048 sc1
    v_mfma_f32_16x16x32_bf16 v[184:187], v[28:31], v[76:79], v[184:187]
    s_mov_b32 s38, 167936
    v_cvt_pk_bf16_f32 v44, v162, v166
    buffer_store_dword v44, v5, s[16:19], s38 offen offset:0 sc1
    v_cvt_pk_bf16_f32 v45, v170, v174
    buffer_store_dword v45, v7, s[16:19], s38 offen offset:0 sc1
    v_mfma_f32_16x16x32_bf16 v[188:191], v[28:31], v[64:67], v[188:191]
    v_cvt_pk_bf16_f32 v46, v163, v167
    buffer_store_dword v46, v5, s[16:19], s38 offen offset:2048 sc1
    s_waitcnt lgkmcnt(4)
    v_mfma_f32_16x16x32_bf16 v[192:195], v[32:35], v[56:59], v[192:195]
    ds_read_b128 v[24:27], v2 offset:20480
    v_cvt_pk_bf16_f32 v47, v171, v175
    buffer_store_dword v47, v7, s[16:19], s38 offen offset:2048 sc1
    v_mfma_f32_16x16x32_bf16 v[196:199], v[32:35], v[60:63], v[196:199]
    ds_read_b128 v[28:31], v3 offset:20480
    v_mfma_f32_16x16x32_bf16 v[200:203], v[32:35], v[64:67], v[200:203]
    v_mfma_f32_16x16x32_bf16 v[204:207], v[32:35], v[68:71], v[204:207]
    s_mov_b32 s38, 196608
    v_cvt_pk_bf16_f32 v48, v176, v180
    buffer_store_dword v48, v5, s[16:19], s38 offen offset:0 sc1
    v_cvt_pk_bf16_f32 v49, v184, v188
    buffer_store_dword v49, v7, s[16:19], s38 offen offset:0 sc1
    v_mfma_f32_16x16x32_bf16 v[192:195], v[36:39], v[72:75], v[192:195]
    v_cvt_pk_bf16_f32 v50, v177, v181
    buffer_store_dword v50, v5, s[16:19], s38 offen offset:2048 sc1
    v_mfma_f32_16x16x32_bf16 v[196:199], v[36:39], v[56:59], v[196:199]
    v_cvt_pk_bf16_f32 v51, v185, v189
    buffer_store_dword v51, v7, s[16:19], s38 offen offset:2048 sc1
    v_mfma_f32_16x16x32_bf16 v[200:203], v[36:39], v[76:79], v[200:203]
    s_mov_b32 s38, 200704
    v_cvt_pk_bf16_f32 v52, v178, v182
    buffer_store_dword v52, v5, s[16:19], s38 offen offset:0 sc1
    v_cvt_pk_bf16_f32 v53, v186, v190
    buffer_store_dword v53, v7, s[16:19], s38 offen offset:0 sc1
    v_mfma_f32_16x16x32_bf16 v[204:207], v[36:39], v[64:67], v[204:207]
    v_cvt_pk_bf16_f32 v54, v179, v183
    buffer_store_dword v54, v5, s[16:19], s38 offen offset:2048 sc1
    s_waitcnt lgkmcnt(4)
    v_mfma_f32_16x16x32_bf16 v[208:211], v[8:11], v[56:59], v[208:211]
    v_cvt_pk_bf16_f32 v55, v187, v191
    buffer_store_dword v55, v7, s[16:19], s38 offen offset:2048 sc1
    v_mfma_f32_16x16x32_bf16 v[212:215], v[8:11], v[60:63], v[212:215]
    v_mfma_f32_16x16x32_bf16 v[216:219], v[8:11], v[64:67], v[216:219]
    v_mfma_f32_16x16x32_bf16 v[220:223], v[8:11], v[68:71], v[220:223]
    s_mov_b32 s38, 229376
    v_cvt_pk_bf16_f32 v40, v192, v196
    buffer_store_dword v40, v5, s[16:19], s38 offen offset:0 sc1
    v_cvt_pk_bf16_f32 v41, v200, v204
    buffer_store_dword v41, v7, s[16:19], s38 offen offset:0 sc1
    v_mfma_f32_16x16x32_bf16 v[208:211], v[12:15], v[72:75], v[208:211]
    v_cvt_pk_bf16_f32 v42, v193, v197
    buffer_store_dword v42, v5, s[16:19], s38 offen offset:2048 sc1
    v_mfma_f32_16x16x32_bf16 v[212:215], v[12:15], v[56:59], v[212:215]
    v_cvt_pk_bf16_f32 v43, v201, v205
    buffer_store_dword v43, v7, s[16:19], s38 offen offset:2048 sc1
    v_mfma_f32_16x16x32_bf16 v[216:219], v[12:15], v[76:79], v[216:219]
    s_mov_b32 s38, 233472
    v_cvt_pk_bf16_f32 v44, v194, v198
    buffer_store_dword v44, v5, s[16:19], s38 offen offset:0 sc1
    v_cvt_pk_bf16_f32 v45, v202, v206
    buffer_store_dword v45, v7, s[16:19], s38 offen offset:0 sc1
    v_mfma_f32_16x16x32_bf16 v[220:223], v[12:15], v[64:67], v[220:223]
    v_cvt_pk_bf16_f32 v46, v195, v199
    buffer_store_dword v46, v5, s[16:19], s38 offen offset:2048 sc1
    s_waitcnt lgkmcnt(2)
    v_mfma_f32_16x16x32_bf16 v[224:227], v[16:19], v[56:59], v[224:227]
    v_cvt_pk_bf16_f32 v47, v203, v207
    buffer_store_dword v47, v7, s[16:19], s38 offen offset:2048 sc1
    v_mfma_f32_16x16x32_bf16 v[228:231], v[16:19], v[60:63], v[228:231]
    v_mfma_f32_16x16x32_bf16 v[232:235], v[16:19], v[64:67], v[232:235]
    v_mfma_f32_16x16x32_bf16 v[236:239], v[16:19], v[68:71], v[236:239]
    s_mov_b32 s38, 262144
    v_cvt_pk_bf16_f32 v48, v208, v212
    buffer_store_dword v48, v5, s[16:19], s38 offen offset:0 sc1
    v_cvt_pk_bf16_f32 v49, v216, v220
    buffer_store_dword v49, v7, s[16:19], s38 offen offset:0 sc1
    v_mfma_f32_16x16x32_bf16 v[224:227], v[20:23], v[72:75], v[224:227]
    v_cvt_pk_bf16_f32 v50, v209, v213
    buffer_store_dword v50, v5, s[16:19], s38 offen offset:2048 sc1
    v_mfma_f32_16x16x32_bf16 v[228:231], v[20:23], v[56:59], v[228:231]
    v_cvt_pk_bf16_f32 v51, v217, v221
    buffer_store_dword v51, v7, s[16:19], s38 offen offset:2048 sc1
    v_mfma_f32_16x16x32_bf16 v[232:235], v[20:23], v[76:79], v[232:235]
    s_mov_b32 s38, 266240
    v_cvt_pk_bf16_f32 v52, v210, v214
    buffer_store_dword v52, v5, s[16:19], s38 offen offset:0 sc1
    v_cvt_pk_bf16_f32 v53, v218, v222
    buffer_store_dword v53, v7, s[16:19], s38 offen offset:0 sc1
    v_mfma_f32_16x16x32_bf16 v[236:239], v[20:23], v[64:67], v[236:239]
    v_cvt_pk_bf16_f32 v54, v211, v215
    buffer_store_dword v54, v5, s[16:19], s38 offen offset:2048 sc1
    s_waitcnt lgkmcnt(0)
    v_mfma_f32_16x16x32_bf16 v[240:243], v[24:27], v[56:59], v[240:243]
    v_cvt_pk_bf16_f32 v55, v219, v223
    buffer_store_dword v55, v7, s[16:19], s38 offen offset:2048 sc1
    v_mfma_f32_16x16x32_bf16 v[244:247], v[24:27], v[60:63], v[244:247]
    v_mfma_f32_16x16x32_bf16 v[240:243], v[28:31], v[72:75], v[240:243]
    v_mfma_f32_16x16x32_bf16 v[244:247], v[28:31], v[56:59], v[244:247]
    s_mov_b32 s38, 294912
    v_cvt_pk_bf16_f32 v40, v224, v228
    buffer_store_dword v40, v5, s[16:19], s38 offen offset:0 sc1
    v_cvt_pk_bf16_f32 v41, v232, v236
    buffer_store_dword v41, v7, s[16:19], s38 offen offset:0 sc1
    v_cvt_pk_bf16_f32 v42, v225, v229
    buffer_store_dword v42, v5, s[16:19], s38 offen offset:2048 sc1
    v_cvt_pk_bf16_f32 v43, v233, v237
    buffer_store_dword v43, v7, s[16:19], s38 offen offset:2048 sc1
    s_mov_b32 s38, 299008
    v_cvt_pk_bf16_f32 v44, v226, v230
    buffer_store_dword v44, v5, s[16:19], s38 offen offset:0 sc1
    v_cvt_pk_bf16_f32 v45, v234, v238
    buffer_store_dword v45, v7, s[16:19], s38 offen offset:0 sc1
    v_cvt_pk_bf16_f32 v46, v227, v231
    buffer_store_dword v46, v5, s[16:19], s38 offen offset:2048 sc1
    v_cvt_pk_bf16_f32 v47, v235, v239
    buffer_store_dword v47, v7, s[16:19], s38 offen offset:2048 sc1
    s_nop 7
    s_lshl_b32 s34, s27, 1
    s_mul_i32 s34, s34, 342016
    s_add_u32 s34, s34, 118489088
    s_add_u32 s64, s58, s34
    s_addc_u32 s65, s59, 0
    s_and_b32 s65, s65, 0xffff
    s_mov_b32 s66, 684032
    s_mov_b32 s67, 0x00020000
    v_lshrrev_b32 v8, 8, v1
    v_lshlrev_b32 v9, 13, v8
    v_sub_u32 v9, v5, v9
    v_lshlrev_b32 v8, 2, v8
    v_add_u32 v8, 160, v8
    v_add_u32 v10, 0, v8
    v_add_u32 v11, 160, v10
    v_cmp_gt_u32 vcc, 167, v10
    s_nop 1
    v_cndmask_b32 v11, v11, v10, vcc
    v_cmp_gt_u32 vcc, 174, v10
    v_mov_b32 v12, 0x7ffff
    s_nop 0
    v_cndmask_b32 v11, v12, v11, vcc
    v_lshl_add_u32 v16, v11, 11, v9
    v_add_u32 v10, 1, v8
    v_add_u32 v11, 160, v10
    v_cmp_gt_u32 vcc, 167, v10
    s_nop 1
    v_cndmask_b32 v11, v11, v10, vcc
    v_cmp_gt_u32 vcc, 174, v10
    v_mov_b32 v12, 0x7ffff
    s_nop 0
    v_cndmask_b32 v11, v12, v11, vcc
    v_lshl_add_u32 v17, v11, 11, v9
    v_add_u32 v10, 2, v8
    v_add_u32 v11, 160, v10
    v_cmp_gt_u32 vcc, 167, v10
    s_nop 1
    v_cndmask_b32 v11, v11, v10, vcc
    v_cmp_gt_u32 vcc, 174, v10
    v_mov_b32 v12, 0x7ffff
    s_nop 0
    v_cndmask_b32 v11, v12, v11, vcc
    v_lshl_add_u32 v18, v11, 11, v9
    v_add_u32 v10, 3, v8
    v_add_u32 v11, 160, v10
    v_cmp_gt_u32 vcc, 167, v10
    s_nop 1
    v_cndmask_b32 v11, v11, v10, vcc
    v_cmp_gt_u32 vcc, 174, v10
    v_mov_b32 v12, 0x7ffff
    s_nop 0
    v_cndmask_b32 v11, v12, v11, vcc
    v_lshl_add_u32 v19, v11, 11, v9
    v_cvt_pk_bf16_f32 v20, v240, v244
    buffer_store_dword v20, v16, s[64:67], 0 offen sc1
    v_cvt_pk_bf16_f32 v21, v241, v245
    buffer_store_dword v21, v17, s[64:67], 0 offen sc1
    v_cvt_pk_bf16_f32 v22, v242, v246
    buffer_store_dword v22, v18, s[64:67], 0 offen sc1
    v_cvt_pk_bf16_f32 v23, v243, v247
    buffer_store_dword v23, v19, s[64:67], 0 offen sc1
    s_endpgm
K12_S0:
    s_mov_b32 s61, 16384
    s_add_u32 s62, s62, 1
K12_S0_L:
    ds_read_b32 v56, v5
    s_waitcnt lgkmcnt(0)
    v_cmp_gt_u32 vcc, s40, v56
    s_sub_u32 s61, s61, 1
    s_cmp_eq_u32 s61, 0
    s_cbranch_scc1 K12_Q0
    s_cbranch_vccz K12_Q0
    s_branch K12_S0_L
K12_S1:
    s_mov_b32 s61, 16384
    s_add_u32 s62, s62, 1
K12_S1_L:
    ds_read_b32 v68, v5
    s_waitcnt lgkmcnt(0)
    v_cmp_gt_u32 vcc, s40, v68
    s_sub_u32 s61, s61, 1
    s_cmp_eq_u32 s61, 0
    s_cbranch_scc1 K12_Q1
    s_cbranch_vccz K12_Q1
    s_branch K12_S1_L
K12_F2:
    s_mov_b32 s61, 16384
    s_add_u32 s63, s63, 1
K12_F2_L:
    s_mov_b32 m0, s46
    s_mov_b64 exec, 0xff
    buffer_load_dword v1, s[4:7], 0 offen sc1 lds
    s_mov_b64 exec, -1
    s_waitcnt vmcnt(0)
    v_mov_b32 v0, s48
    ds_read_b32 v0, v0
    s_waitcnt lgkmcnt(0)
    v_cmp_eq_u32 vcc, 0, v0
    s_sub_u32 s61, s61, 1
    s_cmp_eq_u32 s61, 0
    s_cbranch_scc1 K12_F2_X
    s_cbranch_vccz K12_F2_X
    s_sleep 2
    s_branch K12_F2_L
K12_F2_X:
    s_branch K12_G2
K12_S3:
    s_mov_b32 s61, 16384
    s_add_u32 s62, s62, 1
K12_S3_L:
    ds_read_b32 v56, v5
    s_waitcnt lgkmcnt(0)
    v_cmp_gt_u32 vcc, s51, v56
    s_sub_u32 s61, s61, 1
    s_cmp_eq_u32 s61, 0
    s_cbranch_scc1 K12_Q3
    s_cbranch_vccz K12_Q3
    s_branch K12_S3_L
K12_S4:
    s_mov_b32 s61, 16384
    s_add_u32 s62, s62, 1
K12_S4_L:
    ds_read_b32 v52, v5
    s_waitcnt lgkmcnt(0)
    v_cmp_gt_u32 vcc, s40, v52
    s_sub_u32 s61, s61, 1
    s_cmp_eq_u32 s61, 0
    s_cbranch_scc1 K12_Q4
    s_cbranch_vccz K12_Q4
    s_branch K12_S4_L
K12_S5:
    s_mov_b32 s61, 16384
    s_add_u32 s62, s62, 1
K12_S5_L:
    ds_read_b32 v40, v5
    s_waitcnt lgkmcnt(0)
    v_cmp_gt_u32 vcc, s51, v40
    s_sub_u32 s61, s61, 1
    s_cmp_eq_u32 s61, 0
    s_cbranch_scc1 K12_Q5
    s_cbranch_vccz K12_Q5
    s_branch K12_S5_L
K12_S6:
    s_mov_b32 s61, 16384
    s_add_u32 s62, s62, 1
K12_S6_L:
    ds_read_b32 v68, v5
    s_waitcnt lgkmcnt(0)
    v_cmp_gt_u32 vcc, s40, v68
    s_sub_u32 s61, s61, 1
    s_cmp_eq_u32 s61, 0
    s_cbranch_scc1 K12_Q6
    s_cbranch_vccz K12_Q6
    s_branch K12_S6_L
K12_F7:
    s_mov_b32 s61, 16384
    s_add_u32 s63, s63, 1
K12_F7_L:
    s_mov_b32 m0, s46
    s_mov_b64 exec, 0xff
    buffer_load_dword v1, s[4:7], 0 offen sc1 lds
    s_mov_b64 exec, -1
    s_waitcnt vmcnt(0)
    v_mov_b32 v0, s48
    ds_read_b32 v0, v0
    s_waitcnt lgkmcnt(0)
    v_cmp_eq_u32 vcc, 0, v0
    s_sub_u32 s61, s61, 1
    s_cmp_eq_u32 s61, 0
    s_cbranch_scc1 K12_F7_X
    s_cbranch_vccz K12_F7_X
    s_sleep 2
    s_branch K12_F7_L
K12_F7_X:
    s_branch K12_G7
K12_S8:
    s_mov_b32 s61, 16384
    s_add_u32 s62, s62, 1
K12_S8_L:
    ds_read_b32 v56, v5
    s_waitcnt lgkmcnt(0)
    v_cmp_gt_u32 vcc, s51, v56
    s_sub_u32 s61, s61, 1
    s_cmp_eq_u32 s61, 0
    s_cbranch_scc1 K12_Q8
    s_cbranch_vccz K12_Q8
    s_branch K12_S8_L
K12_END:
    s_endpgm
.p2align 8
.type k34_out_kernel,@function
k34_out_kernel:
    s_cmp_ge_u32 s2, 256
    s_cbranch_scc1 K34_END
    s_load_dwordx2 s[4:5], s[0:1], 48
    s_load_dwordx4 s[40:43], s[0:1], 16
    s_load_dwordx2 s[44:45], s[0:1], 32
    v_lshrrev_b32 v1, 6, v0
    v_and_b32 v2, 63, v0
    v_readfirstlane_b32 s3, v1
    s_and_b32 s6, s2, 15
    s_lshr_b32 s7, s2, 4
    s_lshr_b32 s20, s6, 3
    s_and_b32 s21, s6, 7
    s_mul_i32 s22, s7, 11
    s_mul_i32 s23, s7, 10
    s_add_u32 s23, s23, 7
    s_cmp_lt_u32 s7, 7
    s_cselect_b32 s22, s22, s23
    s_cselect_b32 s23, 11, 10
    s_add_u32 s22, s22, s3
    v_and_b32 v3, 15, v2
    v_lshrrev_b32 v4, 4, v2
    v_lshlrev_b32 v5, 4, v2
    s_mov_b32 s24, 2736128
    v_mul_lo_u32 v6, v4, s24
    v_lshl_add_u32 v6, v3, 4, v6
    s_mul_i32 s25, s20, 167
    s_add_u32 s25, s25, s22
    s_lshl_b32 s25, s25, 11
    s_lshl_b32 s24, s21, 8
    s_add_u32 s25, s25, s24
    s_waitcnt lgkmcnt(0)
    s_add_u32 s8, s4, 118489088
    s_addc_u32 s9, s5, 0
    s_and_b32 s9, s9, 0xffff
    s_mov_b32 s10, 21889024
    s_mov_b32 s11, 0x00020000
    s_add_u32 s12, s4, 153616384
    s_addc_u32 s13, s5, 0
    s_and_b32 s13, s13, 0xffff
    s_mov_b32 s14, 131072
    s_mov_b32 s15, 0x00020000
    s_cmp_lt_u32 s3, s23
    s_cbranch_scc0 K34_NOLOAD
    buffer_load_dwordx4 v[16:19], v6, s[8:11], s25 offen
    s_add_u32 s25, s25, 684032
    buffer_load_dwordx4 v[20:23], v6, s[8:11], s25 offen
    s_add_u32 s25, s25, 684032
    buffer_load_dwordx4 v[24:27], v6, s[8:11], s25 offen
    s_add_u32 s25, s25, 684032
    buffer_load_dwordx4 v[28:31], v6, s[8:11], s25 offen
    s_add_u32 s25, s25, 8892416
    buffer_load_dwordx4 v[32:35], v6, s[8:11], s25 offen
    s_add_u32 s25, s25, 684032
    buffer_load_dwordx4 v[36:39], v6, s[8:11], s25 offen
    s_add_u32 s25, s25, 684032
    buffer_load_dwordx4 v[40:43], v6, s[8:11], s25 offen
    s_add_u32 s25, s25, 684032
    buffer_load_dwordx4 v[44:47], v6, s[8:11], s25 offen
K34_NOLOAD:
    s_cmp_lg_u32 s3, 0
    s_cbranch_scc1 K34_TAB
    s_mov_b32 s16, s40
    s_mov_b32 s17, s41
    s_and_b32 s17, s17, 0xffff
    s_mov_b32 s18, 1024
    s_mov_b32 s19, 0x00020000
    s_mov_b32 s28, s42
    s_mov_b32 s29, s43
    s_and_b32 s29, s29, 0xffff
    s_mov_b32 s30, 1024
    s_mov_b32 s31, 0x00020000
    s_lshl_b32 s24, s21, 7
    v_lshlrev_b32 v8, 1, v2
    buffer_load_ushort v152, v8, s[16:19], s24 offen
    buffer_load_ushort v153, v8, s[28:31], s24 offen
    s_branch K34_TABDONE
K34_TAB:
    s_cmp_ge_u32 s3, 7
    s_cbranch_scc1 K34_TABDONE
    s_sub_u32 s27, s3, 1
    s_lshr_b32 s28, s27, 1
    s_and_b32 s29, s27, 1
    s_lshl_b32 s30, s28, 4
    v_add_u32 v8, s30, v3
    s_lshl_b32 s30, s29, 5
    s_add_u32 s30, s30, 1
    v_lshlrev_b32 v9, 3, v4
    v_add_u32 v9, s30, v9
    v_mul_u32_u24 v9, v8, v9
    v_lshlrev_b32 v8, 1, v8
    v_mad_u32_u24 v48, v8, 0, v9
    v_mad_u32_u24 v49, v8, 0, v9
    v_add_u32 v49, 32, v49
    v_mad_u32_u24 v50, v8, 1, v9
    v_mad_u32_u24 v51, v8, 1, v9
    v_add_u32 v51, 32, v51
    v_mad_u32_u24 v52, v8, 2, v9
    v_mad_u32_u24 v53, v8, 2, v9
    v_add_u32 v53, 32, v53
    v_mad_u32_u24 v54, v8, 3, v9
    v_mad_u32_u24 v55, v8, 3, v9
    v_add_u32 v55, 32, v55
    v_and_b32 v48, 127, v48
    v_and_b32 v49, 127, v49
    v_and_b32 v50, 127, v50
    v_and_b32 v51, 127, v51
    v_and_b32 v52, 127, v52
    v_and_b32 v53, 127, v53
    v_and_b32 v54, 127, v54
    v_and_b32 v55, 127, v55
    v_cvt_f32_u32 v48, v48
    v_cvt_f32_u32 v49, v49
    v_cvt_f32_u32 v50, v50
    v_cvt_f32_u32 v51, v51
    v_cvt_f32_u32 v52, v52
    v_cvt_f32_u32 v53, v53
    v_cvt_f32_u32 v54, v54
    v_cvt_f32_u32 v55, v55
    v_mul_f32 v48, 0x3c000000, v48
    v_mul_f32 v49, 0x3c000000, v49
    v_mul_f32 v50, 0x3c000000, v50
    v_mul_f32 v51, 0x3c000000, v51
    v_mul_f32 v52, 0x3c000000, v52
    v_mul_f32 v53, 0x3c000000, v53
    v_mul_f32 v54, 0x3c000000, v54
    v_mul_f32 v55, 0x3c000000, v55
    v_cos_f32 v48, v48
    v_cos_f32 v49, v49
    v_cos_f32 v50, v50
    v_cos_f32 v51, v51
    v_cos_f32 v52, v52
    v_cos_f32 v53, v53
    v_cos_f32 v54, v54
    v_cos_f32 v55, v55
    s_nop 0
    v_mul_f32 v48, 0x3d000000, v48
    v_mul_f32 v49, 0x3d000000, v49
    v_mul_f32 v50, 0x3d000000, v50
    v_mul_f32 v51, 0x3d000000, v51
    v_mul_f32 v52, 0x3d000000, v52
    v_mul_f32 v53, 0x3d000000, v53
    v_mul_f32 v54, 0x3d000000, v54
    v_mul_f32 v55, 0x3d000000, v55
    v_cvt_pk_bf16_f32 v56, v48, v49
    v_cvt_pk_bf16_f32 v57, v50, v51
    v_cvt_pk_bf16_f32 v58, v52, v53
    v_cvt_pk_bf16_f32 v59, v54, v55
    v_lshlrev_b32 v64, 16, v56
    v_and_b32 v65, 0xffff0000, v56
    v_sub_f32 v48, v48, v64
    v_sub_f32 v49, v49, v65
    v_lshlrev_b32 v64, 16, v57
    v_and_b32 v65, 0xffff0000, v57
    v_sub_f32 v50, v50, v64
    v_sub_f32 v51, v51, v65
    v_lshlrev_b32 v64, 16, v58
    v_and_b32 v65, 0xffff0000, v58
    v_sub_f32 v52, v52, v64
    v_sub_f32 v53, v53, v65
    v_lshlrev_b32 v64, 16, v59
    v_and_b32 v65, 0xffff0000, v59
    v_sub_f32 v54, v54, v64
    v_sub_f32 v55, v55, v65
    v_cvt_pk_bf16_f32 v60, v48, v49
    v_cvt_pk_bf16_f32 v61, v50, v51
    v_cvt_pk_bf16_f32 v62, v52, v53
    v_cvt_pk_bf16_f32 v63, v54, v55
    s_lshl_b32 s30, s27, 11
    v_add_u32 v10, s30, v5
    ds_write_b128 v10, v[56:59]
    ds_write_b128 v10, v[60:63] offset:1024
K34_TABDONE:
    s_waitcnt lgkmcnt(0)
    s_barrier
    s_cmp_lt_u32 s3, s23
    s_cbranch_scc0 K34_IDLE
    ds_read_b128 v[48:51], v5 offset:0
    ds_read_b128 v[52:55], v5 offset:1024
    ds_read_b128 v[56:59], v5 offset:2048
    ds_read_b128 v[60:63], v5 offset:3072
    ds_read_b128 v[64:67], v5 offset:4096
    ds_read_b128 v[68:71], v5 offset:5120
    ds_read_b128 v[72:75], v5 offset:6144
    ds_read_b128 v[76:79], v5 offset:7168
    ds_read_b128 v[80:83], v5 offset:8192
    ds_read_b128 v[84:87], v5 offset:9216
    ds_read_b128 v[88:91], v5 offset:10240
    ds_read_b128 v[92:95], v5 offset:11264
    s_waitcnt vmcnt(0)
    v_swap_b32 v17, v20
    v_swap_b32 v18, v24
    v_swap_b32 v19, v28
    v_swap_b32 v22, v25
    v_swap_b32 v23, v29
    v_swap_b32 v27, v30
    v_swap_b32 v33, v36
    v_swap_b32 v34, v40
    v_swap_b32 v35, v44
    v_swap_b32 v38, v41
    v_swap_b32 v39, v45
    v_swap_b32 v43, v46
    s_waitcnt lgkmcnt(0)
    s_mul_i32 s24, s22, 48
    s_sub_u32 s24, 7985, s24
    s_cmp_ge_u32 s24, 48
    s_cbranch_scc1 K34_FULL
    v_add_u32 v7, 0, v3
    v_cmp_gt_u32 vcc, s24, v7
    s_nop 1
    v_cndmask_b32 v48, 0, v48, vcc
    v_cndmask_b32 v49, 0, v49, vcc
    v_cndmask_b32 v50, 0, v50, vcc
    v_cndmask_b32 v51, 0, v51, vcc
    v_cndmask_b32 v52, 0, v52, vcc
    v_cndmask_b32 v53, 0, v53, vcc
    v_cndmask_b32 v54, 0, v54, vcc
    v_cndmask_b32 v55, 0, v55, vcc
    v_cndmask_b32 v56, 0, v56, vcc
    v_cndmask_b32 v57, 0, v57, vcc
    v_cndmask_b32 v58, 0, v58, vcc
    v_cndmask_b32 v59, 0, v59, vcc
    v_cndmask_b32 v60, 0, v60, vcc
    v_cndmask_b32 v61, 0, v61, vcc
    v_cndmask_b32 v62, 0, v62, vcc
    v_cndmask_b32 v63, 0, v63, vcc
    v_add_u32 v7, 16, v3
    v_cmp_gt_u32 vcc, s24, v7
    s_nop 1
    v_cndmask_b32 v64, 0, v64, vcc
    v_cndmask_b32 v65, 0, v65, vcc
    v_cndmask_b32 v66, 0, v66, vcc
    v_cndmask_b32 v67, 0, v67, vcc
    v_cndmask_b32 v68, 0, v68, vcc
    v_cndmask_b32 v69, 0, v69, vcc
    v_cndmask_b32 v70, 0, v70, vcc
    v_cndmask_b32 v71, 0, v71, vcc
    v_cndmask_b32 v72, 0, v72, vcc
    v_cndmask_b32 v73, 0, v73, vcc
    v_cndmask_b32 v74, 0, v74, vcc
    v_cndmask_b32 v75, 0, v75, vcc
    v_cndmask_b32 v76, 0, v76, vcc
    v_cndmask_b32 v77, 0, v77, vcc
    v_cndmask_b32 v78, 0, v78, vcc
    v_cndmask_b32 v79, 0, v79, vcc
    v_add_u32 v7, 32, v3
    v_cmp_gt_u32 vcc, s24, v7
    s_nop 1
    v_cndmask_b32 v80, 0, v80, vcc
    v_cndmask_b32 v81, 0, v81, vcc
    v_cndmask_b32 v82, 0, v82, vcc
    v_cndmask_b32 v83, 0, v83, vcc
    v_cndmask_b32 v84, 0, v84, vcc
    v_cndmask_b32 v85, 0, v85, vcc
    v_cndmask_b32 v86, 0, v86, vcc
    v_cndmask_b32 v87, 0, v87, vcc
    v_cndmask_b32 v88, 0, v88, vcc
    v_cndmask_b32 v89, 0, v89, vcc
    v_cndmask_b32 v90, 0, v90, vcc
    v_cndmask_b32 v91, 0, v91, vcc
    v_cndmask_b32 v92, 0, v92, vcc
    v_cndmask_b32 v93, 0, v93, vcc
    v_cndmask_b32 v94, 0, v94, vcc
    v_cndmask_b32 v95, 0, v95, vcc
K34_FULL:
    s_nop 1
    v_mfma_f32_16x16x32_bf16 v[96:99], v[48:51], v[16:19], 0
    v_mfma_f32_16x16x32_bf16 v[100:103], v[48:51], v[20:23], 0
    v_mfma_f32_16x16x32_bf16 v[104:107], v[48:51], v[24:27], 0
    v_mfma_f32_16x16x32_bf16 v[108:111], v[48:51], v[28:31], 0
    v_mfma_f32_16x16x32_bf16 v[96:99], v[52:55], v[16:19], v[96:99]
    v_mfma_f32_16x16x32_bf16 v[100:103], v[52:55], v[20:23], v[100:103]
    v_mfma_f32_16x16x32_bf16 v[104:107], v[52:55], v[24:27], v[104:107]
    v_mfma_f32_16x16x32_bf16 v[108:111], v[52:55], v[28:31], v[108:111]
    v_mfma_f32_16x16x32_bf16 v[96:99], v[56:59], v[32:35], v[96:99]
    v_mfma_f32_16x16x32_bf16 v[100:103], v[56:59], v[36:39], v[100:103]
    v_mfma_f32_16x16x32_bf16 v[104:107], v[56:59], v[40:43], v[104:107]
    v_mfma_f32_16x16x32_bf16 v[108:111], v[56:59], v[44:47], v[108:111]
    v_mfma_f32_16x16x32_bf16 v[96:99], v[60:63], v[32:35], v[96:99]
    v_mfma_f32_16x16x32_bf16 v[100:103], v[60:63], v[36:39], v[100:103]
    v_mfma_f32_16x16x32_bf16 v[104:107], v[60:63], v[40:43], v[104:107]
    v_mfma_f32_16x16x32_bf16 v[108:111], v[60:63], v[44:47], v[108:111]
    v_mfma_f32_16x16x32_bf16 v[112:115], v[64:67], v[16:19], 0
    v_mfma_f32_16x16x32_bf16 v[116:119], v[64:67], v[20:23], 0
    v_mfma_f32_16x16x32_bf16 v[120:123], v[64:67], v[24:27], 0
    v_mfma_f32_16x16x32_bf16 v[124:127], v[64:67], v[28:31], 0
    v_mfma_f32_16x16x32_bf16 v[112:115], v[68:71], v[16:19], v[112:115]
    v_mfma_f32_16x16x32_bf16 v[116:119], v[68:71], v[20:23], v[116:119]
    v_mfma_f32_16x16x32_bf16 v[120:123], v[68:71], v[24:27], v[120:123]
    v_mfma_f32_16x16x32_bf16 v[124:127], v[68:71], v[28:31], v[124:127]
    v_mfma_f32_16x16x32_bf16 v[112:115], v[72:75], v[32:35], v[112:115]
    v_mfma_f32_16x16x32_bf16 v[116:119], v[72:75], v[36:39], v[116:119]
    v_mfma_f32_16x16x32_bf16 v[120:123], v[72:75], v[40:43], v[120:123]
    v_mfma_f32_16x16x32_bf16 v[124:127], v[72:75], v[44:47], v[124:127]
    v_mfma_f32_16x16x32_bf16 v[112:115], v[76:79], v[32:35], v[112:115]
    v_mfma_f32_16x16x32_bf16 v[116:119], v[76:79], v[36:39], v[116:119]
    v_mfma_f32_16x16x32_bf16 v[120:123], v[76:79], v[40:43], v[120:123]
    v_mfma_f32_16x16x32_bf16 v[124:127], v[76:79], v[44:47], v[124:127]
    v_mfma_f32_16x16x32_bf16 v[128:131], v[80:83], v[16:19], 0
    v_mfma_f32_16x16x32_bf16 v[132:135], v[80:83], v[20:23], 0
    v_mfma_f32_16x16x32_bf16 v[136:139], v[80:83], v[24:27], 0
    v_mfma_f32_16x16x32_bf16 v[140:143], v[80:83], v[28:31], 0
    v_mfma_f32_16x16x32_bf16 v[128:131], v[84:87], v[16:19], v[128:131]
    v_mfma_f32_16x16x32_bf16 v[132:135], v[84:87], v[20:23], v[132:135]
    v_mfma_f32_16x16x32_bf16 v[136:139], v[84:87], v[24:27], v[136:139]
    v_mfma_f32_16x16x32_bf16 v[140:143], v[84:87], v[28:31], v[140:143]
    v_mfma_f32_16x16x32_bf16 v[128:131], v[88:91], v[32:35], v[128:131]
    v_mfma_f32_16x16x32_bf16 v[132:135], v[88:91], v[36:39], v[132:135]
    v_mfma_f32_16x16x32_bf16 v[136:139], v[88:91], v[40:43], v[136:139]
    v_mfma_f32_16x16x32_bf16 v[140:143], v[88:91], v[44:47], v[140:143]
    v_mfma_f32_16x16x32_bf16 v[128:131], v[92:95], v[32:35], v[128:131]
    v_mfma_f32_16x16x32_bf16 v[132:135], v[92:95], v[36:39], v[132:135]
    v_mfma_f32_16x16x32_bf16 v[136:139], v[92:95], v[40:43], v[136:139]
    v_mfma_f32_16x16x32_bf16 v[140:143], v[92:95], v[44:47], v[140:143]
    s_nop 7
    v_mov_b32 v16, v96
    v_mul_f32 v20, v96, v96
    v_mov_b32 v17, v100
    v_mul_f32 v21, v100, v100
    v_mov_b32 v18, v104
    v_mul_f32 v22, v104, v104
    v_mov_b32 v19, v108
    v_mul_f32 v23, v108, v108
    v_add_f32 v16, v16, v97
    v_fmac_f32 v20, v97, v97
    v_add_f32 v17, v17, v101
    v_fmac_f32 v21, v101, v101
    v_add_f32 v18, v18, v105
    v_fmac_f32 v22, v105, v105
    v_add_f32 v19, v19, v109
    v_fmac_f32 v23, v109, v109
    v_add_f32 v16, v16, v98
    v_fmac_f32 v20, v98, v98
    v_add_f32 v17, v17, v102
    v_fmac_f32 v21, v102, v102
    v_add_f32 v18, v18, v106
    v_fmac_f32 v22, v106, v106
    v_add_f32 v19, v19, v110
    v_fmac_f32 v23, v110, v110
    v_add_f32 v16, v16, v99
    v_fmac_f32 v20, v99, v99
    v_add_f32 v17, v17, v103
    v_fmac_f32 v21, v103, v103
    v_add_f32 v18, v18, v107
    v_fmac_f32 v22, v107, v107
    v_add_f32 v19, v19, v111
    v_fmac_f32 v23, v111, v111
    v_add_f32 v16, v16, v112
    v_fmac_f32 v20, v112, v112
    v_add_f32 v17, v17, v116
    v_fmac_f32 v21, v116, v116
    v_add_f32 v18, v18, v120
    v_fmac_f32 v22, v120, v120
    v_add_f32 v19, v19, v124
    v_fmac_f32 v23, v124, v124
    v_add_f32 v16, v16, v113
    v_fmac_f32 v20, v113, v113
    v_add_f32 v17, v17, v117
    v_fmac_f32 v21, v117, v117
    v_add_f32 v18, v18, v121
    v_fmac_f32 v22, v121, v121
    v_add_f32 v19, v19, v125
    v_fmac_f32 v23, v125, v125
    v_add_f32 v16, v16, v114
    v_fmac_f32 v20, v114, v114
    v_add_f32 v17, v17, v118
    v_fmac_f32 v21, v118, v118
    v_add_f32 v18, v18, v122
    v_fmac_f32 v22, v122, v122
    v_add_f32 v19, v19, v126
    v_fmac_f32 v23, v126, v126
    v_add_f32 v16, v16, v115
    v_fmac_f32 v20, v115, v115
    v_add_f32 v17, v17, v119
    v_fmac_f32 v21, v119, v119
    v_add_f32 v18, v18, v123
    v_fmac_f32 v22, v123, v123
    v_add_f32 v19, v19, v127
    v_fmac_f32 v23, v127, v127
    v_add_f32 v16, v16, v128
    v_fmac_f32 v20, v128, v128
    v_add_f32 v17, v17, v132
    v_fmac_f32 v21, v132, v132
    v_add_f32 v18, v18, v136
    v_fmac_f32 v22, v136, v136
    v_add_f32 v19, v19, v140
    v_fmac_f32 v23, v140, v140
    v_add_f32 v16, v16, v129
    v_fmac_f32 v20, v129, v129
    v_add_f32 v17, v17, v133
    v_fmac_f32 v21, v133, v133
    v_add_f32 v18, v18, v137
    v_fmac_f32 v22, v137, v137
    v_add_f32 v19, v19, v141
    v_fmac_f32 v23, v141, v141
    v_add_f32 v16, v16, v130
    v_fmac_f32 v20, v130, v130
    v_add_f32 v17, v17, v134
    v_fmac_f32 v21, v134, v134
    v_add_f32 v18, v18, v138
    v_fmac_f32 v22, v138, v138
    v_add_f32 v19, v19, v142
    v_fmac_f32 v23, v142, v142
    v_add_f32 v16, v16, v131
    v_fmac_f32 v20, v131, v131
    v_add_f32 v17, v17, v135
    v_fmac_f32 v21, v135, v135
    v_add_f32 v18, v18, v139
    v_fmac_f32 v22, v139, v139
    v_add_f32 v19, v19, v143
    v_fmac_f32 v23, v143, v143
    v_mov_b32 v24, v16
    v_mov_b32 v25, v17
    v_mov_b32 v26, v18
    v_mov_b32 v27, v19
    v_mov_b32 v28, v20
    v_mov_b32 v29, v21
    v_mov_b32 v30, v22
    v_mov_b32 v31, v23
    s_nop 0
    v_permlane32_swap_b32 v16, v24
    v_permlane32_swap_b32 v17, v25
    v_permlane32_swap_b32 v18, v26
    v_permlane32_swap_b32 v19, v27
    v_permlane32_swap_b32 v20, v28
    v_permlane32_swap_b32 v21, v29
    v_permlane32_swap_b32 v22, v30
    v_permlane32_swap_b32 v23, v31
    v_add_f32 v16, v16, v24
    v_add_f32 v17, v17, v25
    v_add_f32 v18, v18, v26
    v_add_f32 v19, v19, v27
    v_add_f32 v20, v20, v28
    v_add_f32 v21, v21, v29
    v_add_f32 v22, v22, v30
    v_add_f32 v23, v23, v31
    v_mov_b32 v24, v16
    v_mov_b32 v25, v17
    v_mov_b32 v26, v18
    v_mov_b32 v27, v19
    v_mov_b32 v28, v20
    v_mov_b32 v29, v21
    v_mov_b32 v30, v22
    v_mov_b32 v31, v23
    s_nop 0
    v_permlane16_swap_b32 v16, v24
    v_permlane16_swap_b32 v17, v25
    v_permlane16_swap_b32 v18, v26
    v_permlane16_swap_b32 v19, v27
    v_permlane16_swap_b32 v20, v28
    v_permlane16_swap_b32 v21, v29
    v_permlane16_swap_b32 v22, v30
    v_permlane16_swap_b32 v23, v31
    v_add_f32 v16, v16, v24
    v_add_f32 v17, v17, v25
    v_add_f32 v18, v18, v26
    v_add_f32 v19, v19, v27
    v_add_f32 v20, v20, v28
    v_add_f32 v21, v21, v29
    v_add_f32 v22, v22, v30
    v_add_f32 v23, v23, v31
    s_branch K34_WR
K34_IDLE:
    v_mov_b32 v16, 0
    v_mov_b32 v17, 0
    v_mov_b32 v18, 0
    v_mov_b32 v19, 0
    v_mov_b32 v20, 0
    v_mov_b32 v21, 0
    v_mov_b32 v22, 0
    v_mov_b32 v23, 0
K34_WR:
    s_lshl_b32 s24, s3, 9
    v_lshlrev_b32 v7, 4, v3
    v_add_u32 v7, s24, v7
    ds_write_b128 v7, v[16:19] offset:12288
    ds_write_b128 v7, v[20:23] offset:12544
    s_waitcnt lgkmcnt(0)
    s_barrier
    s_cmp_lg_u32 s3, 0
    s_cbranch_scc1 K34_WAIT
    v_lshlrev_b32 v7, 2, v2
    ds_read_b32 v16, v7 offset:12288
    ds_read_b32 v17, v7 offset:12800
    ds_read_b32 v18, v7 offset:13312
    ds_read_b32 v19, v7 offset:13824
    ds_read_b32 v20, v7 offset:14336
    ds_read_b32 v21, v7 offset:14848
    ds_read_b32 v22, v7 offset:15360
    ds_read_b32 v23, v7 offset:15872
    ds_read_b32 v24, v7 offset:16384
    ds_read_b32 v25, v7 offset:16896
    ds_read_b32 v26, v7 offset:17408
    ds_read_b32 v27, v7 offset:17920
    s_waitcnt lgkmcnt(0)
    ds_read_b32 v32, v7 offset:12544
    ds_read_b32 v33, v7 offset:13056
    ds_read_b32 v34, v7 offset:13568
    ds_read_b32 v35, v7 offset:14080
    ds_read_b32 v36, v7 offset:14592
    ds_read_b32 v37, v7 offset:15104
    ds_read_b32 v38, v7 offset:15616
    ds_read_b32 v39, v7 offset:16128
    ds_read_b32 v40, v7 offset:16640
    ds_read_b32 v41, v7 offset:17152
    ds_read_b32 v42, v7 offset:17664
    ds_read_b32 v43, v7 offset:18176
    v_add_f32 v16, v16, v17
    v_add_f32 v16, v16, v18
    v_add_f32 v16, v16, v19
    v_add_f32 v16, v16, v20
    v_add_f32 v16, v16, v21
    v_add_f32 v16, v16, v22
    v_add_f32 v16, v16, v23
    v_add_f32 v16, v16, v24
    v_add_f32 v16, v16, v25
    v_add_f32 v16, v16, v26
    v_add_f32 v16, v16, v27
    s_waitcnt lgkmcnt(0)
    v_add_f32 v32, v32, v33
    v_add_f32 v32, v32, v34
    v_add_f32 v32, v32, v35
    v_add_f32 v32, v32, v36
    v_add_f32 v32, v32, v37
    v_add_f32 v32, v32, v38
    v_add_f32 v32, v32, v39
    v_add_f32 v32, v32, v40
    v_add_f32 v32, v32, v41
    v_add_f32 v32, v32, v42
    v_add_f32 v32, v32, v43
    s_lshl_b32 s24, s6, 4
    s_add_u32 s24, s24, s7
    s_lshl_b32 s24, s24, 9
    buffer_store_dword v16, v7, s[12:15], s24 offen sc1
    buffer_store_dword v32, v7, s[12:15], s24 offen offset:256 sc1
    s_mov_b32 s26, 20000
K34_POLL:
    s_lshl_b32 s24, s6, 13
    buffer_load_dword v16, v7, s[12:15], s24 offen offset:0 sc1
    buffer_load_dword v32, v7, s[12:15], s24 offen offset:256 sc1
    buffer_load_dword v17, v7, s[12:15], s24 offen offset:512 sc1
    buffer_load_dword v33, v7, s[12:15], s24 offen offset:768 sc1
    buffer_load_dword v18, v7, s[12:15], s24 offen offset:1024 sc1
    buffer_load_dword v34, v7, s[12:15], s24 offen offset:1280 sc1
    buffer_load_dword v19, v7, s[12:15], s24 offen offset:1536 sc1
    buffer_load_dword v35, v7, s[12:15], s24 offen offset:1792 sc1
    buffer_load_dword v20, v7, s[12:15], s24 offen offset:2048 sc1
    buffer_load_dword v36, v7, s[12:15], s24 offen offset:2304 sc1
    buffer_load_dword v21, v7, s[12:15], s24 offen offset:2560 sc1
    buffer_load_dword v37, v7, s[12:15], s24 offen offset:2816 sc1
    buffer_load_dword v22, v7, s[12:15], s24 offen offset:3072 sc1
    buffer_load_dword v38, v7, s[12:15], s24 offen offset:3328 sc1
    buffer_load_dword v23, v7, s[12:15], s24 offen offset:3584 sc1
    buffer_load_dword v39, v7, s[12:15], s24 offen offset:3840 sc1
    s_add_u32 s24, s24, 4096
    buffer_load_dword v24, v7, s[12:15], s24 offen offset:0 sc1
    buffer_load_dword v40, v7, s[12:15], s24 offen offset:256 sc1
    buffer_load_dword v25, v7, s[12:15], s24 offen offset:512 sc1
    buffer_load_dword v41, v7, s[12:15], s24 offen offset:768 sc1
    buffer_load_dword v26, v7, s[12:15], s24 offen offset:1024 sc1
    buffer_load_dword v42, v7, s[12:15], s24 offen offset:1280 sc1
    buffer_load_dword v27, v7, s[12:15], s24 offen offset:1536 sc1
    buffer_load_dword v43, v7, s[12:15], s24 offen offset:1792 sc1
    buffer_load_dword v28, v7, s[12:15], s24 offen offset:2048 sc1
    buffer_load_dword v44, v7, s[12:15], s24 offen offset:2304 sc1
    buffer_load_dword v29, v7, s[12:15], s24 offen offset:2560 sc1
    buffer_load_dword v45, v7, s[12:15], s24 offen offset:2816 sc1
    buffer_load_dword v30, v7, s[12:15], s24 offen offset:3072 sc1
    buffer_load_dword v46, v7, s[12:15], s24 offen offset:3328 sc1
    buffer_load_dword v31, v7, s[12:15], s24 offen offset:3584 sc1
    buffer_load_dword v47, v7, s[12:15], s24 offen offset:3840 sc1
    s_waitcnt vmcnt(0)
    v_max3_u32 v48, v16, v17, v18
    v_max3_u32 v48, v48, v19, v20
    v_max3_u32 v48, v48, v21, v22
    v_max3_u32 v48, v48, v23, v24
    v_max3_u32 v48, v48, v25, v26
    v_max3_u32 v48, v48, v27, v28
    v_max3_u32 v48, v48, v29, v30
    v_max3_u32 v48, v48, v31, v32
    v_max3_u32 v48, v48, v33, v34
    v_max3_u32 v48, v48, v35, v36
    v_max3_u32 v48, v48, v37, v38
    v_max3_u32 v48, v48, v39, v40
    v_max3_u32 v48, v48, v41, v42
    v_max3_u32 v48, v48, v43, v44
    v_max3_u32 v48, v48, v45, v46
    v_max_u32 v48, v48, v47
    v_cmp_eq_u32 vcc, -1, v48
    s_sub_u32 s26, s26, 1
    s_cmp_eq_u32 s26, 0
    s_cbranch_scc1 K34_GOT
    s_cbranch_vccz K34_GOT
    s_sleep 1
    s_branch K34_POLL
K34_GOT:
    v_add_f32 v16, v16, v24
    v_add_f32 v32, v32, v40
    v_add_f32 v17, v17, v25
    v_add_f32 v33, v33, v41
    v_add_f32 v18, v18, v26
    v_add_f32 v34, v34, v42
    v_add_f32 v19, v19, v27
    v_add_f32 v35, v35, v43
    v_add_f32 v20, v20, v28
    v_add_f32 v36, v36, v44
    v_add_f32 v21, v21, v29
    v_add_f32 v37, v37, v45
    v_add_f32 v22, v22, v30
    v_add_f32 v38, v38, v46
    v_add_f32 v23, v23, v31
    v_add_f32 v39, v39, v47
    v_add_f32 v16, v16, v20
    v_add_f32 v32, v32, v36
    v_add_f32 v17, v17, v21
    v_add_f32 v33, v33, v37
    v_add_f32 v18, v18, v22
    v_add_f32 v34, v34, v38
    v_add_f32 v19, v19, v23
    v_add_f32 v35, v35, v39
    v_add_f32 v16, v16, v18
    v_add_f32 v32, v32, v34
    v_add_f32 v17, v17, v19
    v_add_f32 v33, v33, v35
    v_add_f32 v16, v16, v17
    v_add_f32 v32, v32, v33
    v_mul_f32 v11, 0x39035177, v16
    v_mul_f32 v12, 0x39035177, v32
    v_fma_f32 v12, -v11, v11, v12
    v_max_f32 v12, 0, v12
    v_add_f32 v12, 0x3727c5ac, v12
    v_sqrt_f32 v12, v12
    v_lshlrev_b32 v9, 16, v152
    v_rcp_f32 v12, v12
    v_lshlrev_b32 v10, 16, v153
    v_mul_f32 v9, v9, v12
    v_fma_f32 v10, -v11, v9, v10
    ds_write_b32 v7, v9 offset:18432
    ds_write_b32 v7, v10 offset:18688
    s_waitcnt lgkmcnt(0)
K34_WAIT:
    s_barrier
    s_cmp_lt_u32 s3, s23
    s_cbranch_scc0 K34_END
    v_lshlrev_b32 v7, 4, v3
    ds_read_b128 v[144:147], v7 offset:18432
    ds_read_b128 v[148:151], v7 offset:18688
    s_mul_i32 s24, s20, 8176640
    s_add_u32 s16, s44, s24
    s_addc_u32 s17, s45, 0
    s_and_b32 s17, s17, 0xffff
    s_mov_b32 s18, 8176640
    s_mov_b32 s19, 0x00020000
    v_lshlrev_b32 v7, 12, v4
    v_lshl_add_u32 v7, v3, 3, v7
    s_lshl_b32 s24, s21, 7
    v_add_u32 v7, s24, v7
    s_mul_i32 s25, s22, 49152
    s_mov_b32 s30, 0xc0135761
    s_mov_b32 s31, 0xbdd2d3e8
    v_mov_b32 v15, s30
    s_waitcnt lgkmcnt(0)
    v_fma_f32 v16, v96, v144, v148
    v_fma_f32 v17, v100, v145, v149
    v_fma_f32 v18, v104, v146, v150
    v_fma_f32 v19, v108, v147, v151
    v_fma_f32 v20, v97, v144, v148
    v_fma_f32 v21, v101, v145, v149
    v_fma_f32 v22, v105, v146, v150
    v_fma_f32 v23, v109, v147, v151
    v_mul_f32 v24, v16, v16
    v_mul_f32 v25, v17, v17
    v_mul_f32 v26, v18, v18
    v_mul_f32 v27, v19, v19
    v_mul_f32 v28, v20, v20
    v_mul_f32 v29, v21, v21
    v_mul_f32 v30, v22, v22
    v_mul_f32 v31, v23, v23
    v_fma_f32 v24, v24, s31, v15
    v_fma_f32 v25, v25, s31, v15
    v_fma_f32 v26, v26, s31, v15
    v_fma_f32 v27, v27, s31, v15
    v_fma_f32 v28, v28, s31, v15
    v_fma_f32 v29, v29, s31, v15
    v_fma_f32 v30, v30, s31, v15
    v_fma_f32 v31, v31, s31, v15
    v_mul_f32 v24, v24, v16
    v_mul_f32 v25, v25, v17
    v_mul_f32 v26, v26, v18
    v_mul_f32 v27, v27, v19
    v_mul_f32 v28, v28, v20
    v_mul_f32 v29, v29, v21
    v_mul_f32 v30, v30, v22
    v_mul_f32 v31, v31, v23
    v_exp_f32 v24, v24
    v_exp_f32 v25, v25
    v_exp_f32 v26, v26
    v_exp_f32 v27, v27
    v_exp_f32 v28, v28
    v_exp_f32 v29, v29
    v_exp_f32 v30, v30
    v_exp_f32 v31, v31
    v_add_f32 v24, 1.0, v24
    v_add_f32 v25, 1.0, v25
    v_add_f32 v26, 1.0, v26
    v_add_f32 v27, 1.0, v27
    v_add_f32 v28, 1.0, v28
    v_add_f32 v29, 1.0, v29
    v_add_f32 v30, 1.0, v30
    v_add_f32 v31, 1.0, v31
    v_rcp_f32 v24, v24
    v_rcp_f32 v25, v25
    v_rcp_f32 v26, v26
    v_rcp_f32 v27, v27
    v_rcp_f32 v28, v28
    v_rcp_f32 v29, v29
    v_rcp_f32 v30, v30
    v_rcp_f32 v31, v31
    v_mul_f32 v16, v16, v24
    v_mul_f32 v17, v17, v25
    v_mul_f32 v18, v18, v26
    v_mul_f32 v19, v19, v27
    v_mul_f32 v20, v20, v28
    v_mul_f32 v21, v21, v29
    v_mul_f32 v22, v22, v30
    v_mul_f32 v23, v23, v31
    v_cvt_pk_bf16_f32 v32, v16, v17
    v_cvt_pk_bf16_f32 v33, v18, v19
    buffer_store_dwordx2 v[32:33], v7, s[16:19], s25 offen offset:0 sc1
    v_cvt_pk_bf16_f32 v34, v20, v21
    v_cvt_pk_bf16_f32 v35, v22, v23
    buffer_store_dwordx2 v[34:35], v7, s[16:19], s25 offen offset:1024 sc1
    s_add_u32 s25, s25, 2048
    v_fma_f32 v36, v98, v144, v148
    v_fma_f32 v37, v102, v145, v149
    v_fma_f32 v38, v106, v146, v150
    v_fma_f32 v39, v110, v147, v151
    v_fma_f32 v40, v99, v144, v148
    v_fma_f32 v41, v103, v145, v149
    v_fma_f32 v42, v107, v146, v150
    v_fma_f32 v43, v111, v147, v151
    v_mul_f32 v44, v36, v36
    v_mul_f32 v45, v37, v37
    v_mul_f32 v46, v38, v38
    v_mul_f32 v47, v39, v39
    v_mul_f32 v48, v40, v40
    v_mul_f32 v49, v41, v41
    v_mul_f32 v50, v42, v42
    v_mul_f32 v51, v43, v43
    v_fma_f32 v44, v44, s31, v15
    v_fma_f32 v45, v45, s31, v15
    v_fma_f32 v46, v46, s31, v15
    v_fma_f32 v47, v47, s31, v15
    v_fma_f32 v48, v48, s31, v15
    v_fma_f32 v49, v49, s31, v15
    v_fma_f32 v50, v50, s31, v15
    v_fma_f32 v51, v51, s31, v15
    v_mul_f32 v44, v44, v36
    v_mul_f32 v45, v45, v37
    v_mul_f32 v46, v46, v38
    v_mul_f32 v47, v47, v39
    v_mul_f32 v48, v48, v40
    v_mul_f32 v49, v49, v41
    v_mul_f32 v50, v50, v42
    v_mul_f32 v51, v51, v43
    v_exp_f32 v44, v44
    v_exp_f32 v45, v45
    v_exp_f32 v46, v46
    v_exp_f32 v47, v47
    v_exp_f32 v48, v48
    v_exp_f32 v49, v49
    v_exp_f32 v50, v50
    v_exp_f32 v51, v51
    v_add_f32 v44, 1.0, v44
    v_add_f32 v45, 1.0, v45
    v_add_f32 v46, 1.0, v46
    v_add_f32 v47, 1.0, v47
    v_add_f32 v48, 1.0, v48
    v_add_f32 v49, 1.0, v49
    v_add_f32 v50, 1.0, v50
    v_add_f32 v51, 1.0, v51
    v_rcp_f32 v44, v44
    v_rcp_f32 v45, v45
    v_rcp_f32 v46, v46
    v_rcp_f32 v47, v47
    v_rcp_f32 v48, v48
    v_rcp_f32 v49, v49
    v_rcp_f32 v50, v50
    v_rcp_f32 v51, v51
    v_mul_f32 v36, v36, v44
    v_mul_f32 v37, v37, v45
    v_mul_f32 v38, v38, v46
    v_mul_f32 v39, v39, v47
    v_mul_f32 v40, v40, v48
    v_mul_f32 v41, v41, v49
    v_mul_f32 v42, v42, v50
    v_mul_f32 v43, v43, v51
    v_cvt_pk_bf16_f32 v52, v36, v37
    v_cvt_pk_bf16_f32 v53, v38, v39
    buffer_store_dwordx2 v[52:53], v7, s[16:19], s25 offen offset:0 sc1
    v_cvt_pk_bf16_f32 v54, v40, v41
    v_cvt_pk_bf16_f32 v55, v42, v43
    buffer_store_dwordx2 v[54:55], v7, s[16:19], s25 offen offset:1024 sc1
    s_add_u32 s25, s25, 2048
    s_add_u32 s25, s25, 12288
    v_fma_f32 v16, v112, v144, v148
    v_fma_f32 v17, v116, v145, v149
    v_fma_f32 v18, v120, v146, v150
    v_fma_f32 v19, v124, v147, v151
    v_fma_f32 v20, v113, v144, v148
    v_fma_f32 v21, v117, v145, v149
    v_fma_f32 v22, v121, v146, v150
    v_fma_f32 v23, v125, v147, v151
    v_mul_f32 v24, v16, v16
    v_mul_f32 v25, v17, v17
    v_mul_f32 v26, v18, v18
    v_mul_f32 v27, v19, v19
    v_mul_f32 v28, v20, v20
    v_mul_f32 v29, v21, v21
    v_mul_f32 v30, v22, v22
    v_mul_f32 v31, v23, v23
    v_fma_f32 v24, v24, s31, v15
    v_fma_f32 v25, v25, s31, v15
    v_fma_f32 v26, v26, s31, v15
    v_fma_f32 v27, v27, s31, v15
    v_fma_f32 v28, v28, s31, v15
    v_fma_f32 v29, v29, s31, v15
    v_fma_f32 v30, v30, s31, v15
    v_fma_f32 v31, v31, s31, v15
    v_mul_f32 v24, v24, v16
    v_mul_f32 v25, v25, v17
    v_mul_f32 v26, v26, v18
    v_mul_f32 v27, v27, v19
    v_mul_f32 v28, v28, v20
    v_mul_f32 v29, v29, v21
    v_mul_f32 v30, v30, v22
    v_mul_f32 v31, v31, v23
    v_exp_f32 v24, v24
    v_exp_f32 v25, v25
    v_exp_f32 v26, v26
    v_exp_f32 v27, v27
    v_exp_f32 v28, v28
    v_exp_f32 v29, v29
    v_exp_f32 v30, v30
    v_exp_f32 v31, v31
    v_add_f32 v24, 1.0, v24
    v_add_f32 v25, 1.0, v25
    v_add_f32 v26, 1.0, v26
    v_add_f32 v27, 1.0, v27
    v_add_f32 v28, 1.0, v28
    v_add_f32 v29, 1.0, v29
    v_add_f32 v30, 1.0, v30
    v_add_f32 v31, 1.0, v31
    v_rcp_f32 v24, v24
    v_rcp_f32 v25, v25
    v_rcp_f32 v26, v26
    v_rcp_f32 v27, v27
    v_rcp_f32 v28, v28
    v_rcp_f32 v29, v29
    v_rcp_f32 v30, v30
    v_rcp_f32 v31, v31
    v_mul_f32 v16, v16, v24
    v_mul_f32 v17, v17, v25
    v_mul_f32 v18, v18, v26
    v_mul_f32 v19, v19, v27
    v_mul_f32 v20, v20, v28
    v_mul_f32 v21, v21, v29
    v_mul_f32 v22, v22, v30
    v_mul_f32 v23, v23, v31
    v_cvt_pk_bf16_f32 v32, v16, v17
    v_cvt_pk_bf16_f32 v33, v18, v19
    buffer_store_dwordx2 v[32:33], v7, s[16:19], s25 offen offset:0 sc1
    v_cvt_pk_bf16_f32 v34, v20, v21
    v_cvt_pk_bf16_f32 v35, v22, v23
    buffer_store_dwordx2 v[34:35], v7, s[16:19], s25 offen offset:1024 sc1
    s_add_u32 s25, s25, 2048
    v_fma_f32 v36, v114, v144, v148
    v_fma_f32 v37, v118, v145, v149
    v_fma_f32 v38, v122, v146, v150
    v_fma_f32 v39, v126, v147, v151
    v_fma_f32 v40, v115, v144, v148
    v_fma_f32 v41, v119, v145, v149
    v_fma_f32 v42, v123, v146, v150
    v_fma_f32 v43, v127, v147, v151
    v_mul_f32 v44, v36, v36
    v_mul_f32 v45, v37, v37
    v_mul_f32 v46, v38, v38
    v_mul_f32 v47, v39, v39
    v_mul_f32 v48, v40, v40
    v_mul_f32 v49, v41, v41
    v_mul_f32 v50, v42, v42
    v_mul_f32 v51, v43, v43
    v_fma_f32 v44, v44, s31, v15
    v_fma_f32 v45, v45, s31, v15
    v_fma_f32 v46, v46, s31, v15
    v_fma_f32 v47, v47, s31, v15
    v_fma_f32 v48, v48, s31, v15
    v_fma_f32 v49, v49, s31, v15
    v_fma_f32 v50, v50, s31, v15
    v_fma_f32 v51, v51, s31, v15
    v_mul_f32 v44, v44, v36
    v_mul_f32 v45, v45, v37
    v_mul_f32 v46, v46, v38
    v_mul_f32 v47, v47, v39
    v_mul_f32 v48, v48, v40
    v_mul_f32 v49, v49, v41
    v_mul_f32 v50, v50, v42
    v_mul_f32 v51, v51, v43
    v_exp_f32 v44, v44
    v_exp_f32 v45, v45
    v_exp_f32 v46, v46
    v_exp_f32 v47, v47
    v_exp_f32 v48, v48
    v_exp_f32 v49, v49
    v_exp_f32 v50, v50
    v_exp_f32 v51, v51
    v_add_f32 v44, 1.0, v44
    v_add_f32 v45, 1.0, v45
    v_add_f32 v46, 1.0, v46
    v_add_f32 v47, 1.0, v47
    v_add_f32 v48, 1.0, v48
    v_add_f32 v49, 1.0, v49
    v_add_f32 v50, 1.0, v50
    v_add_f32 v51, 1.0, v51
    v_rcp_f32 v44, v44
    v_rcp_f32 v45, v45
    v_rcp_f32 v46, v46
    v_rcp_f32 v47, v47
    v_rcp_f32 v48, v48
    v_rcp_f32 v49, v49
    v_rcp_f32 v50, v50
    v_rcp_f32 v51, v51
    v_mul_f32 v36, v36, v44
    v_mul_f32 v37, v37, v45
    v_mul_f32 v38, v38, v46
    v_mul_f32 v39, v39, v47
    v_mul_f32 v40, v40, v48
    v_mul_f32 v41, v41, v49
    v_mul_f32 v42, v42, v50
    v_mul_f32 v43, v43, v51
    v_cvt_pk_bf16_f32 v52, v36, v37
    v_cvt_pk_bf16_f32 v53, v38, v39
    buffer_store_dwordx2 v[52:53], v7, s[16:19], s25 offen offset:0 sc1
    v_cvt_pk_bf16_f32 v54, v40, v41
    v_cvt_pk_bf16_f32 v55, v42, v43
    buffer_store_dwordx2 v[54:55], v7, s[16:19], s25 offen offset:1024 sc1
    s_add_u32 s25, s25, 2048
    s_add_u32 s25, s25, 12288
    v_fma_f32 v16, v128, v144, v148
    v_fma_f32 v17, v132, v145, v149
    v_fma_f32 v18, v136, v146, v150
    v_fma_f32 v19, v140, v147, v151
    v_fma_f32 v20, v129, v144, v148
    v_fma_f32 v21, v133, v145, v149
    v_fma_f32 v22, v137, v146, v150
    v_fma_f32 v23, v141, v147, v151
    v_mul_f32 v24, v16, v16
    v_mul_f32 v25, v17, v17
    v_mul_f32 v26, v18, v18
    v_mul_f32 v27, v19, v19
    v_mul_f32 v28, v20, v20
    v_mul_f32 v29, v21, v21
    v_mul_f32 v30, v22, v22
    v_mul_f32 v31, v23, v23
    v_fma_f32 v24, v24, s31, v15
    v_fma_f32 v25, v25, s31, v15
    v_fma_f32 v26, v26, s31, v15
    v_fma_f32 v27, v27, s31, v15
    v_fma_f32 v28, v28, s31, v15
    v_fma_f32 v29, v29, s31, v15
    v_fma_f32 v30, v30, s31, v15
    v_fma_f32 v31, v31, s31, v15
    v_mul_f32 v24, v24, v16
    v_mul_f32 v25, v25, v17
    v_mul_f32 v26, v26, v18
    v_mul_f32 v27, v27, v19
    v_mul_f32 v28, v28, v20
    v_mul_f32 v29, v29, v21
    v_mul_f32 v30, v30, v22
    v_mul_f32 v31, v31, v23
    v_exp_f32 v24, v24
    v_exp_f32 v25, v25
    v_exp_f32 v26, v26
    v_exp_f32 v27, v27
    v_exp_f32 v28, v28
    v_exp_f32 v29, v29
    v_exp_f32 v30, v30
    v_exp_f32 v31, v31
    v_add_f32 v24, 1.0, v24
    v_add_f32 v25, 1.0, v25
    v_add_f32 v26, 1.0, v26
    v_add_f32 v27, 1.0, v27
    v_add_f32 v28, 1.0, v28
    v_add_f32 v29, 1.0, v29
    v_add_f32 v30, 1.0, v30
    v_add_f32 v31, 1.0, v31
    v_rcp_f32 v24, v24
    v_rcp_f32 v25, v25
    v_rcp_f32 v26, v26
    v_rcp_f32 v27, v27
    v_rcp_f32 v28, v28
    v_rcp_f32 v29, v29
    v_rcp_f32 v30, v30
    v_rcp_f32 v31, v31
    v_mul_f32 v16, v16, v24
    v_mul_f32 v17, v17, v25
    v_mul_f32 v18, v18, v26
    v_mul_f32 v19, v19, v27
    v_mul_f32 v20, v20, v28
    v_mul_f32 v21, v21, v29
    v_mul_f32 v22, v22, v30
    v_mul_f32 v23, v23, v31
    v_cvt_pk_bf16_f32 v32, v16, v17
    v_cvt_pk_bf16_f32 v33, v18, v19
    buffer_store_dwordx2 v[32:33], v7, s[16:19], s25 offen offset:0 sc1
    v_cvt_pk_bf16_f32 v34, v20, v21
    v_cvt_pk_bf16_f32 v35, v22, v23
    buffer_store_dwordx2 v[34:35], v7, s[16:19], s25 offen offset:1024 sc1
    s_add_u32 s25, s25, 2048
    v_fma_f32 v36, v130, v144, v148
    v_fma_f32 v37, v134, v145, v149
    v_fma_f32 v38, v138, v146, v150
    v_fma_f32 v39, v142, v147, v151
    v_fma_f32 v40, v131, v144, v148
    v_fma_f32 v41, v135, v145, v149
    v_fma_f32 v42, v139, v146, v150
    v_fma_f32 v43, v143, v147, v151
    v_mul_f32 v44, v36, v36
    v_mul_f32 v45, v37, v37
    v_mul_f32 v46, v38, v38
    v_mul_f32 v47, v39, v39
    v_mul_f32 v48, v40, v40
    v_mul_f32 v49, v41, v41
    v_mul_f32 v50, v42, v42
    v_mul_f32 v51, v43, v43
    v_fma_f32 v44, v44, s31, v15
    v_fma_f32 v45, v45, s31, v15
    v_fma_f32 v46, v46, s31, v15
    v_fma_f32 v47, v47, s31, v15
    v_fma_f32 v48, v48, s31, v15
    v_fma_f32 v49, v49, s31, v15
    v_fma_f32 v50, v50, s31, v15
    v_fma_f32 v51, v51, s31, v15
    v_mul_f32 v44, v44, v36
    v_mul_f32 v45, v45, v37
    v_mul_f32 v46, v46, v38
    v_mul_f32 v47, v47, v39
    v_mul_f32 v48, v48, v40
    v_mul_f32 v49, v49, v41
    v_mul_f32 v50, v50, v42
    v_mul_f32 v51, v51, v43
    v_exp_f32 v44, v44
    v_exp_f32 v45, v45
    v_exp_f32 v46, v46
    v_exp_f32 v47, v47
    v_exp_f32 v48, v48
    v_exp_f32 v49, v49
    v_exp_f32 v50, v50
    v_exp_f32 v51, v51
    v_add_f32 v44, 1.0, v44
    v_add_f32 v45, 1.0, v45
    v_add_f32 v46, 1.0, v46
    v_add_f32 v47, 1.0, v47
    v_add_f32 v48, 1.0, v48
    v_add_f32 v49, 1.0, v49
    v_add_f32 v50, 1.0, v50
    v_add_f32 v51, 1.0, v51
    v_rcp_f32 v44, v44
    v_rcp_f32 v45, v45
    v_rcp_f32 v46, v46
    v_rcp_f32 v47, v47
    v_rcp_f32 v48, v48
    v_rcp_f32 v49, v49
    v_rcp_f32 v50, v50
    v_rcp_f32 v51, v51
    v_mul_f32 v36, v36, v44
    v_mul_f32 v37, v37, v45
    v_mul_f32 v38, v38, v46
    v_mul_f32 v39, v39, v47
    v_mul_f32 v40, v40, v48
    v_mul_f32 v41, v41, v49
    v_mul_f32 v42, v42, v50
    v_mul_f32 v43, v43, v51
    v_cvt_pk_bf16_f32 v52, v36, v37
    v_cvt_pk_bf16_f32 v53, v38, v39
    buffer_store_dwordx2 v[52:53], v7, s[16:19], s25 offen offset:0 sc1
    v_cvt_pk_bf16_f32 v54, v40, v41
    v_cvt_pk_bf16_f32 v55, v42, v43
    buffer_store_dwordx2 v[54:55], v7, s[16:19], s25 offen offset:1024 sc1
    s_add_u32 s25, s25, 2048
    s_add_u32 s25, s25, 12288
K34_END:
    s_endpgm
TEXT_END:
.section .rodata,"a"
.p2align 6
.amdhsa_kernel k1_xform_kernel
  .amdhsa_next_free_vgpr 128
  .amdhsa_next_free_sgpr 96
  .amdhsa_accum_offset 128
  .amdhsa_group_segment_fixed_size 0
  .amdhsa_kernarg_size 56
  .amdhsa_user_sgpr_count 2
  .amdhsa_user_sgpr_kernarg_segment_ptr 1
  .amdhsa_system_sgpr_workgroup_id_x 1
.end_amdhsa_kernel
.p2align 6
.amdhsa_kernel k12_fused_kernel
  .amdhsa_next_free_vgpr 256
  .amdhsa_next_free_sgpr 96
  .amdhsa_accum_offset 256
  .amdhsa_group_segment_fixed_size 0
  .amdhsa_kernarg_size 56
  .amdhsa_user_sgpr_count 2
  .amdhsa_user_sgpr_kernarg_segment_ptr 1
  .amdhsa_system_sgpr_workgroup_id_x 1
.end_amdhsa_kernel
.p2align 6
.amdhsa_kernel k34_out_kernel
  .amdhsa_next_free_vgpr 168
  .amdhsa_next_free_sgpr 96
  .amdhsa_accum_offset 168
  .amdhsa_group_segment_fixed_size 0
  .amdhsa_kernarg_size 56
  .amdhsa_user_sgpr_count 2
  .amdhsa_user_sgpr_kernarg_segment_ptr 1
  .amdhsa_system_sgpr_workgroup_id_x 1
.end_amdhsa_kernel
```
